```python
import torch

def _softmax(x, axis=-1):
    return torch.softmax(x, dim=axis)
def _gelu(x):
    return torch.nn.functional.gelu(x, approximate="tanh")
def _silu(x):
    return torch.nn.functional.silu(x)
def _sigmoid(x):
    return torch.sigmoid(x)
def _layernorm(x, axis=-1, eps=1e-5):
    m = x.mean(dim=axis, keepdim=True)
    v = x.var(dim=axis, keepdim=True, unbiased=False)
    return (x - m) / torch.sqrt(v + eps)
def _scatter_add(tgt, idx, src, axis=0):
    return tgt.clone().index_add_(axis, idx, src)
def _segment_sum(src, seg, n):
    out = torch.zeros((n,) + src.shape[1:], dtype=src.dtype)
    return out.index_add_(0, seg, src)
def _pad(x, pw):
    flat = tuple(v for pair in reversed(pw) for v in pair)
    return torch.nn.functional.pad(x, flat)

kernel_name = 'recurrent_scan__gqa_block_cached__mixer_s_mlp__prompt'

def setup_inputs():

    _w = (lambda a: (lambda t: t.to(torch.bfloat16) if t.is_floating_point() else t)(torch.as_tensor(a)))
    def _A_setup():
        B, Sq, D = 1, 2048, 512
        Hq, Hkv, Sk, Dh = 32, 8, 2048, 128
        assert Hq % Hkv == 0, (Hq, Hkv)
        return {
            "x": _w((lambda *s: torch.randn(*s, dtype=torch.bfloat16) * 0.05)(B, Sq, D)),
            "k_cache": _w((lambda *s: torch.randn(*s, dtype=torch.bfloat16) * 0.8)(B, Hkv, Sk, Dh)),
            "v_cache": _w((lambda *s: torch.randn(*s, dtype=torch.bfloat16) * 0.8)(B, Hkv, Sk, Dh)),
            "wq": _w((lambda *s: torch.randn(*s, dtype=torch.bfloat16) * 0.8)(D, Hq * Dh) * (D ** -0.5)),
            "wo": _w((lambda *s: torch.randn(*s, dtype=torch.bfloat16) * 0.8)(Hq * Dh, D) * ((Hq * Dh) ** -0.5)),
        }
    _A_in = _A_setup()

    def _B_setup():
        B, S, D, F = 1, 2048, 512, 1792
        return {
            "x":  _w((lambda *s: torch.randn(*s, dtype=torch.bfloat16) * 0.05)(B, S, D)),
            "w1": _w((lambda *s: torch.randn(*s, dtype=torch.bfloat16) * 3.2)(D, D) * (D ** -0.5)),
            "w2": _w((lambda *s: torch.randn(*s, dtype=torch.bfloat16) * 3.2)(D, D) * (D ** -0.5)),
            "w3": _w((lambda *s: torch.randn(*s, dtype=torch.bfloat16) * 3.2)(D, F) * (D ** -0.5)),
            "w4": _w((lambda *s: torch.randn(*s, dtype=torch.bfloat16) * 1.6)(F, D) * (F ** -0.5)),
        }
    _B_in = _B_setup()

    return {
        "A_x": _A_in["x"],
        "A_k_cache": _A_in["k_cache"],
        "A_v_cache": _A_in["v_cache"],
        "A_wq": _A_in["wq"],
        "A_wo": _A_in["wo"],
        "B_x": _B_in["x"],
        "B_w1": _B_in["w1"],
        "B_w2": _B_in["w2"],
        "B_w3": _B_in["w3"],
        "B_w4": _B_in["w4"],
    }

def reference(A_x, A_k_cache, A_v_cache, A_wq, A_wo, B_x, B_w1, B_w2, B_w3, B_w4):
    def _A_ref(x, k_cache, v_cache, wq, wo):
        B, Sq, D = x.shape
        Hq, Dh = 32, 128
        Hkv = k_cache.shape[1]
        rep = Hq // Hkv
        q = (lambda x, *d: x.permute(*d))((x @ wq).reshape(B, Sq, Hq, Dh), 0, 2, 1, 3)
        k = (lambda x, n, axis: torch.repeat_interleave(x, n, dim=axis))(k_cache, rep, axis=1)
        v = (lambda x, n, axis: torch.repeat_interleave(x, n, dim=axis))(v_cache, rep, axis=1)
        scores = torch.einsum("bhqd,bhkd->bhqk", q, k) * (Dh ** -0.5)
        p = _softmax(scores, axis=-1)
        o = torch.einsum("bhqk,bhkd->bhqd", p, v)
        return (lambda x, *d: x.permute(*d))(o, 0, 2, 1, 3).reshape(B, Sq, Hq * Dh) @ wo

    def _B_ref(x, w1, w2, w3, w4):
        B, S, D = x.shape
        h = _gelu(_layernorm(x, axis=-1) @ w1)
        c = D // 4
        g0 = _pad(h[:, :, 0*c:1*c], ((0, 0), (1, 0), (0, 0)))[:, :S, :]
        g1 = _pad(h[:, :, 1*c:2*c], ((0, 0), (0, 1), (0, 0)))[:, 1:, :]
        g2 = _pad(h[:, :, 2*c:3*c], ((0, 0), (2, 0), (0, 0)))[:, :S, :]
        g3 = _pad(h[:, :, 3*c:   ], ((0, 0), (0, 2), (0, 0)))[:, 2:, :]
        hs = torch.concatenate([g0, g1, g2, g3], axis=-1) @ w2
        x1 = x + hs
        h2 = _gelu(_layernorm(x1, axis=-1) @ w3) @ w4
        return x1 + h2

    x = A_x
    xn = _layernorm(x, axis=-1)
    s = _A_ref(xn, A_k_cache, A_v_cache, A_wq, A_wo)
    g = _silu(_B_ref(xn, B_w1, B_w2, B_w3, B_w4))
    return x + s * g
```

```asm
; @launch grid=(256,1,1) block=(256,1,1) lds=163840
.amdgcn_target "amdgcn-amd-amdhsa--gfx950"
.text
.globl recurrent_scan__gqa_block_cached__mixer_s_mlp__prompt_kernel
.p2align 8
.type recurrent_scan__gqa_block_cached__mixer_s_mlp__prompt_kernel,@function
recurrent_scan__gqa_block_cached__mixer_s_mlp__prompt_kernel:
	s_load_dwordx2 s[4:5], s[0:1], 0
	s_load_dwordx2 s[16:17], s[0:1], 24
	s_cmp_ge_u32 s2, 256
	s_cbranch_scc1 L_end
	s_getpc_b64 s[56:57]
L_pc:
	s_mov_b32 s58, L_code_end-L_pc-16
	s_lshr_b32 s60, s2, 3
	v_lshlrev_b32 v29, 4, v0
	v_lshl_add_u32 v26, s60, 12, v29
	v_min_u32 v26, s58, v26
	v_mov_b32 v27, 0
	v_lshl_add_u64 v[26:27], v[26:27], 0, s[56:57]
	global_load_dwordx4 a[152:155], v[26:27], off
	v_readfirstlane_b32 s62, v0
	s_and_b32 s61, s2, 7
	v_and_b32 v0, 63, v0
	s_lshr_b32 s62, s62, 6
	s_lshl_b32 s63, s60, 2
	s_add_u32 s63, s63, s62
	v_lshrrev_b32 v27, 2, v0
	v_and_b32 v28, 3, v0
	v_lshlrev_b32 v30, 10, v27
	v_lshl_or_b32 v30, v28, 4, v30
	v_lshlrev_b32 v13, 4, v0
	s_lshl_b32 s70, s63, 14
	s_lshl_b32 s69, s63, 13
	s_lshl_b32 s73, s61, 10
	s_mov_b32 s6, 0x200000
	s_mov_b32 s7, 0x20000
	s_sub_u32 s18, 0x400000, s73
	s_mov_b32 s19, 0x20000
	v_and_b32 v32, 7, v0
	v_bfe_u32 v33, v0, 4, 2
	v_lshlrev_b32 v33, 1, v33
	v_xor_b32 v32, v32, v33
	v_lshlrev_b32 v32, 4, v32
	v_lshrrev_b32 v33, 3, v0
	v_and_b32 v34, 4, v33
	v_add_u32 v34, v34, v33
	v_lshl_add_u32 v18, v34, 13, v32
	v_lshl_add_u32 v18, s62, 8, v18
	s_mul_i32 s64, s62, 24576
	s_add_u32 s64, s64, 65536
	s_and_b32 s75, s60, 15
	s_lshl_b32 s97, s75, 18
	s_lshl_b32 s72, s75, 6
	s_or_b32 s70, s70, s72
	s_waitcnt lgkmcnt(0)
	s_add_u32 s16, s16, s73
	s_addc_u32 s17, s17, 0
	s_load_dwordx2 s[48:49], s[0:1], 96
	s_load_dwordx2 s[24:25], s[0:1], 48
	s_load_dwordx2 s[28:29], s[0:1], 56
	s_load_dwordx2 s[44:45], s[0:1], 88
	s_load_dwordx2 s[8:9], s[0:1], 8
	s_load_dwordx2 s[12:13], s[0:1], 16
	s_load_dwordx2 s[20:21], s[0:1], 32
	s_load_dwordx2 s[32:33], s[0:1], 64
	s_load_dwordx2 s[36:37], s[0:1], 72
	s_load_dwordx2 s[40:41], s[0:1], 80
	s_xor_b32 s67, s70, 0x0
	buffer_load_dwordx4 v[64:67], v30, s[4:7], s67 offen
	s_add_u32 m0, s64, 0x0
	s_xor_b32 s66, s97, 0x0
	buffer_load_dwordx4 v18, s[16:19], s66 offen offset:0 lds
	s_xor_b32 s67, s70, 0x40
	buffer_load_dwordx4 v[68:71], v30, s[4:7], s67 offen
	s_xor_b32 s66, s97, 0x1fc00
	buffer_load_dwordx4 v18, s[16:19], s66 offen offset:1024 lds
	s_xor_b32 s67, s70, 0x80
	buffer_load_dwordx4 v[72:75], v30, s[4:7], s67 offen
	s_xor_b32 s66, s97, 0x7800
	buffer_load_dwordx4 v18, s[16:19], s66 offen offset:2048 lds
	s_xor_b32 s67, s70, 0xc0
	buffer_load_dwordx4 v[76:79], v30, s[4:7], s67 offen
	s_xor_b32 s66, s97, 0x27400
	buffer_load_dwordx4 v18, s[16:19], s66 offen offset:3072 lds
	s_xor_b32 s67, s70, 0x100
	buffer_load_dwordx4 v[80:83], v30, s[4:7], s67 offen
	s_xor_b32 s67, s70, 0x140
	buffer_load_dwordx4 v[84:87], v30, s[4:7], s67 offen
	s_mov_b32 s58, L_code_end-L_pc-16
	s_mul_i32 s65, s62, 0x800
	v_mov_b32 v23, 1
	v_lshlrev_b32 v26, 1, v28
	v_xor_b32 v26, v26, v27
	v_lshl_or_b32 v26, v28, 4, v26
	v_lshlrev_b32 v26, 4, v26
	v_lshl_add_u32 v57, s62, 14, v26
	v_lshrrev_b32 v26, 4, v0
	v_lshlrev_b32 v26, 5, v26
	v_xor_b32 v56, v26, v13
	v_lshrrev_b32 v26, 5, v0
	v_and_b32 v27, 15, v0
	v_mul_u32_u24 v26, 18, v26
	v_xor_b32 v26, v26, v27
	v_bfe_u32 v27, v0, 4, 1
	v_lshl_or_b32 v26, v26, 1, v27
	v_lshlrev_b32 v26, 3, v26
	s_xor_b32 s74, s61, s75
	s_mul_i32 s73, s62, 0x4000
	s_mul_i32 s72, s74, 0x400
	s_add_u32 s73, s73, s72
	v_add_u32 v58, s73, v26
	v_xor_b32 v59, 64, v58
	v_xor_b32 v52, 0x2000, v58
	v_xor_b32 v53, 0x2000, v59
	s_lshr_b32 s73, s75, 2
	s_xor_b32 s73, s73, s62
	s_and_b32 s95, s75, 3
	s_lshl_b32 s95, s95, 15
	v_lshl_add_u32 v17, v34, 10, v32
	v_lshl_add_u32 v17, s73, 17, v17
	v_lshl_add_u32 v14, v33, 10, v32
	v_and_b32 v34, 64, v32
	v_mad_u32_u24 v16, v34, 7, v14
	v_mov_b32 v48, v14
	v_mov_b32 v49, v16
	v_lshl_add_u32 v16, s62, 17, v16
	v_lshl_add_u32 v14, s62, 7, v14
	v_mul_u32_u24 v33, 3584, v33
	v_lshl_add_u32 v32, s62, 7, v32
	v_add_u32 v15, v33, v32
	v_mov_b32 v31, 0x40000000
	s_mul_i32 s68, s60, 0x4000
	v_lshrrev_b32 v50, 2, v0
	v_lshlrev_b32 v50, 17, v50
	v_and_b32_e64 v51, 3, v0
	v_lshl_or_b32 v50, v51, 10, v50
	v_cmp_gt_u32 vcc, 0x80, v29
	s_mul_i32 s73, s63, 0x400
	s_mul_i32 s72, s61, 0x80
	s_add_u32 s73, s73, s72
	v_cndmask_b32 v50, v31, v50, vcc
	v_lshrrev_b32 v51, 9, v29
	v_cmp_eq_u32 vcc, 1, v51
	v_lshlrev_b32 v51, 2, v0
	v_add_u32 v51, 0x3ff80, v51
	v_cndmask_b32 v50, v50, v51, vcc
	v_cmp_eq_u32 vcc, 0, v0
	v_mov_b32 v22, s73
	s_add_u32 s71, s73, 0x400000
	v_cndmask_b32 v22, v31, v22, vcc
	v_cmp_eq_u32 vcc, 0, v29
	v_mov_b32 v51, 0
	s_add_u32 s87, s73, 0x600000
	v_cndmask_b32 v24, v31, 0, vcc
	v_and_b32 v26, 15, v0
	v_lshrrev_b32 v27, 4, v0
	v_xor_b32 v27, v27, v26
	v_lshlrev_b32 v27, 4, v27
	v_lshl_or_b32 v9, v26, 8, v27
	v_xor_b32 v10, 0x40, v9
	v_xor_b32 v11, 0x80, v9
	v_xor_b32 v12, 0xc0, v9
	v_lshrrev_b32 v26, 2, v0
	v_and_b32 v27, 7, v26
	v_lshlrev_b32 v27, 5, v27
	v_lshl_or_b32 v26, v26, 8, v27
	v_and_b32 v27, 3, v0
	v_lshl_or_b32 v26, v27, 3, v26
	v_xor_b32 v5, 0x8080, v26
	v_xor_b32 v6, 0x80a0, v26
	v_xor_b32 v7, 0x80c0, v26
	v_xor_b32 v8, 0x80e0, v26
	v_lshrrev_b32 v1, 2, v0
	v_bfe_u32 v26, v0, 3, 2
	v_lshlrev_b32 v26, 5, v26
	v_lshl_or_b32 v1, v1, 7, v26
	v_and_b32 v26, 3, v0
	v_lshl_or_b32 v1, v26, 3, v1
	v_add_u32 v1, s64, v1
	v_xor_b32 v2, 0x20, v1
	v_xor_b32 v3, 0x40, v1
	v_xor_b32 v4, 0x60, v1
	v_bfe_i32 v26, v0, 1, 1
	v_and_b32 v27, 0x3f803f80, v26
	v_xor_b32 v28, 0x3f803f80, v27
	v_bfe_i32 v26, v0, 0, 1
	v_and_b32 v26, 0xaaaaaaaa, v26
	v_or_b32 v31, 0x44444444, v26
	v_accvgpr_write_b32 a128, v28
	v_accvgpr_write_b32 a168, v27
	v_accvgpr_write_b32 a129, v28
	v_accvgpr_write_b32 a169, v27
	v_accvgpr_write_b32 a130, v28
	v_accvgpr_write_b32 a170, v27
	v_accvgpr_write_b32 a131, v28
	v_accvgpr_write_b32 a171, v27
	v_accvgpr_write_b32 a132, 0
	v_accvgpr_write_b32 a133, 0
	v_accvgpr_write_b32 a134, 0
	v_accvgpr_write_b32 a135, 0
	v_accvgpr_write_b32 a136, 0
	v_accvgpr_write_b32 a137, 0
	v_accvgpr_write_b32 a138, 0
	v_accvgpr_write_b32 a139, 0
	s_mul_i32 s84, s63, 0x4000
	s_mul_i32 s72, s61, 0x800
	s_add_u32 s84, s84, s72
	s_mul_i32 s86, s63, 0x4000
	s_add_u32 s86, s86, 0x200000
	s_mul_i32 s85, s61, 0x400
	s_mul_i32 s72, s86, 0x1
	s_add_u32 s85, s85, s72
	s_mul_i32 s88, s60, 0x80000
	s_mul_i32 s72, s61, 0x800
	s_add_u32 s88, s88, s72
	s_mul_i32 s72, s62, 0x20000
	s_add_u32 s88, s88, s72
	s_mul_i32 s89, s60, 0x80000
	s_mul_i32 s72, s61, 0x10000
	s_add_u32 s89, s89, s72
	s_mul_i32 s72, s62, 0x4000
	s_add_u32 s89, s89, s72
	s_mul_i32 s90, s60, 0x1000
	s_mul_i32 s72, s61, 0x80
	s_add_u32 s90, s90, s72
	s_add_u32 s90, s90, 0x440000
	s_mul_i32 s91, s60, 0x1000
	s_mul_i32 s72, s62, 0x100
	s_add_u32 s91, s91, s72
	s_mul_i32 s72, s61, 0x4
	s_add_u32 s91, s91, s72
	s_add_u32 s91, s91, 0x440000
	s_mul_i32 s92, s63, 0x4000
	s_mul_i32 s72, s61, 0x40
	s_add_u32 s92, s92, s72
	s_mul_i32 s93, s63, 0x400
	s_mul_i32 s94, s63, 0x3800
	s_mul_i32 s96, s63, 0x1000
	s_lshr_b32 s79, s63, 1
	s_lshl_b32 s79, s79, 13
	s_mov_b32 s76, 0xbdd2d3e8
	s_mov_b32 s77, 0xbdd2d3e8
	s_mov_b32 s78, 0
	s_waitcnt lgkmcnt(0)
	s_mov_b32 s50, 0x10000000
	s_mov_b32 s51, 0x20000
	s_mul_i32 s73, s61, 0x80
	s_add_u32 s24, s24, s73
	s_addc_u32 s25, s25, 0
	s_sub_u32 s26, 0x80000, s73
	s_mov_b32 s27, 0x20000
	s_mul_i32 s73, s61, 0x40
	s_add_u32 s28, s28, s73
	s_addc_u32 s29, s29, 0
	s_sub_u32 s30, 0x80000, s73
	s_mov_b32 s31, 0x20000
	s_mov_b32 s46, 0x100
	s_mov_b32 s47, 0x20000
	s_mul_i32 s73, s61, 0x80000
	s_add_u32 s8, s8, s73
	s_addc_u32 s9, s9, 0
	s_sub_u32 s10, 0x400000, s73
	s_mov_b32 s11, 0x20000
	s_mul_i32 s73, s61, 0x80000
	s_add_u32 s12, s12, s73
	s_addc_u32 s13, s13, 0
	s_sub_u32 s14, 0x400000, s73
	s_mov_b32 s15, 0x20000
	s_mul_i32 s73, s61, 0x80000
	s_add_u32 s20, s20, s73
	s_addc_u32 s21, s21, 0
	s_sub_u32 s22, 0x400000, s73
	s_mov_b32 s23, 0x20000
	s_mov_b32 s34, 0x1c0000
	s_mov_b32 s35, 0x20000
	s_mov_b32 s38, 0x1c0000
	s_mov_b32 s39, 0x20000
	s_mov_b32 s42, 0x200000
	s_mov_b32 s43, 0x20000
	s_mov_b32 s52, s48
	s_mov_b32 s53, s49
	s_mov_b32 s54, 0x200000
	s_mov_b32 s55, 0x20000
	s_mov_b64 exec, 0
	s_cmp_eq_u32 s62, 0
	s_cbranch_scc1 L_pg0
	s_cmp_eq_u32 s62, 1
	s_cbranch_scc1 L_pg1
	s_cmp_eq_u32 s62, 2
	s_cbranch_scc1 L_pg2
	s_branch L_pg3
L_touched0:
	s_mov_b64 exec, -1
	s_branch L_go
L_spin1:
	s_mov_b32 s75, 0x80000
L_spin1_loop:
	buffer_load_dword v25, v24, s[44:47], 0 offen sc1
	s_waitcnt vmcnt(0)
	v_cmp_gt_u32 vcc, 8, v25
	s_cbranch_vccz L_back1
	s_sub_u32 s75, s75, 1
	s_cbranch_scc0 L_spin1_loop
	s_branch L_back1
L_spin2:
	s_mov_b32 s75, 0x80000
L_spin2_loop:
	buffer_load_dword v25, v24, s[48:51], 0 offen sc1
	s_waitcnt vmcnt(0)
	v_cmp_ne_u32 vcc, 1, v25
	s_cbranch_vccz L_back2
	s_sub_u32 s75, s75, 1
	s_cbranch_scc0 L_spin2_loop
	s_branch L_back2
L_spin3:
	s_mov_b32 s75, 0x80000
L_spin3_loop:
	buffer_load_dword v25, v24, s[48:51], 0 offen sc1
	s_waitcnt vmcnt(0)
	v_cmp_ne_u32 vcc, 1, v25
	s_cbranch_vccz L_back3
	s_sub_u32 s75, s75, 1
	s_cbranch_scc0 L_spin3_loop
	s_branch L_back3
L_spin4:
	s_mov_b32 s75, 0x80000
L_spin4_loop:
	buffer_load_dword v25, v24, s[44:47], 0 offen sc1
	s_waitcnt vmcnt(0)
	v_cmp_eq_u32 vcc, 0, v25
	s_cbranch_vccz L_back4
	s_sub_u32 s75, s75, 1
	s_cbranch_scc0 L_spin4_loop
	s_branch L_back4
L_spin5:
	s_mov_b32 s75, 0x80000
L_spin5_loop:
	buffer_load_dword v25, v24, s[48:51], 0 offen sc1
	s_waitcnt vmcnt(0)
	v_cmp_ne_u32 vcc, 1, v25
	s_cbranch_vccz L_back5
	s_sub_u32 s75, s75, 1
	s_cbranch_scc0 L_spin5_loop
	s_branch L_back5
L_c0_poll:
	buffer_load_dword v25, v24, s[48:51], 0 offen sc1
	s_sub_u32 s75, s75, 1
	s_cbranch_scc0 L_c0_wait
	s_branch L_c0_end
L_c1_poll:
	buffer_load_dword v25, v24, s[48:51], 0 offen sc1
	s_sub_u32 s75, s75, 1
	s_cbranch_scc0 L_c1_wait
	s_branch L_c1_end
.p2align 12
L_go:
L_pg0:
	s_cbranch_execz L_pg4
	s_waitcnt vmcnt(9)
	v_lshlrev_b32 v41, 16, v64
	s_nop 1
	v_mov_b32_dpp v40, v41 quad_perm:[0,0,0,0] row_mask:0xf bank_mask:0xf
	s_xor_b32 s67, s70, 0x180
	buffer_load_dwordx4 v[88:91], v30, s[4:7], s67 offen
	v_lshlrev_b32_e64 v128, 16, v64
	v_and_b32 v129, 0xffff0000, v64
	v_pk_add_f32 v[128:129], v[128:129], v[40:41] op_sel_hi:[1,0] neg_lo:[0,1] neg_hi:[0,1]
	v_pk_mul_f32 v[34:35], v[128:129], v[128:129]
	v_lshlrev_b32_e64 v130, 16, v65
	v_and_b32 v131, 0xffff0000, v65
	v_pk_add_f32 v[130:131], v[130:131], v[40:41] op_sel_hi:[1,0] neg_lo:[0,1] neg_hi:[0,1]
	v_pk_add_f32 v[32:33], v[128:129], v[130:131]
	v_pk_fma_f32 v[34:35], v[130:131], v[130:131], v[34:35]
	v_lshlrev_b32 v132, 16, v66
	s_add_u32 m0, s64, 0x1000
	s_xor_b32 s66, s97, 0x40000
	buffer_load_dwordx4 v18, s[16:19], s66 offen offset:0 lds
	v_and_b32 v133, 0xffff0000, v66
	v_pk_add_f32 v[132:133], v[132:133], v[40:41] op_sel_hi:[1,0] neg_lo:[0,1] neg_hi:[0,1]
	v_pk_add_f32 v[32:33], v[32:33], v[132:133]
	v_pk_fma_f32 v[34:35], v[132:133], v[132:133], v[34:35]
	v_lshlrev_b32 v134, 16, v67
	v_and_b32 v135, 0xffff0000, v67
	v_pk_add_f32 v[134:135], v[134:135], v[40:41] op_sel_hi:[1,0] neg_lo:[0,1] neg_hi:[0,1]
	v_pk_add_f32 v[32:33], v[32:33], v[134:135]
	v_pk_fma_f32 v[34:35], v[134:135], v[134:135], v[34:35]
	s_waitcnt vmcnt(9)
	v_lshlrev_b32 v136, 16, v68
	s_xor_b32 s67, s70, 0x1c0
	buffer_load_dwordx4 v[92:95], v30, s[4:7], s67 offen
	v_and_b32 v137, 0xffff0000, v68
	v_pk_add_f32 v[136:137], v[136:137], v[40:41] op_sel_hi:[1,0] neg_lo:[0,1] neg_hi:[0,1]
	v_pk_add_f32 v[32:33], v[32:33], v[136:137]
	v_pk_fma_f32 v[34:35], v[136:137], v[136:137], v[34:35]
	v_lshlrev_b32_e64 v138, 16, v69
	v_and_b32 v139, 0xffff0000, v69
	v_pk_add_f32 v[138:139], v[138:139], v[40:41] op_sel_hi:[1,0] neg_lo:[0,1] neg_hi:[0,1]
	v_pk_add_f32 v[32:33], v[32:33], v[138:139]
	v_pk_fma_f32 v[34:35], v[138:139], v[138:139], v[34:35]
	v_lshlrev_b32 v140, 16, v70
	s_xor_b32 s66, s97, 0x5fc00
	buffer_load_dwordx4 v18, s[16:19], s66 offen offset:1024 lds
	v_and_b32 v141, 0xffff0000, v70
	v_pk_add_f32 v[140:141], v[140:141], v[40:41] op_sel_hi:[1,0] neg_lo:[0,1] neg_hi:[0,1]
	v_pk_add_f32 v[32:33], v[32:33], v[140:141]
	v_pk_fma_f32 v[34:35], v[140:141], v[140:141], v[34:35]
	v_lshlrev_b32 v142, 16, v71
	v_and_b32 v143, 0xffff0000, v71
	v_pk_add_f32 v[142:143], v[142:143], v[40:41] op_sel_hi:[1,0] neg_lo:[0,1] neg_hi:[0,1]
	v_pk_add_f32 v[32:33], v[32:33], v[142:143]
	v_pk_fma_f32 v[34:35], v[142:143], v[142:143], v[34:35]
	s_waitcnt vmcnt(9)
	v_lshlrev_b32 v144, 16, v72
	s_xor_b32 s67, s70, 0x200
	buffer_load_dwordx4 v[96:99], v30, s[4:7], s67 offen
	v_and_b32 v145, 0xffff0000, v72
	v_pk_add_f32 v[144:145], v[144:145], v[40:41] op_sel_hi:[1,0] neg_lo:[0,1] neg_hi:[0,1]
	v_pk_add_f32 v[32:33], v[32:33], v[144:145]
	v_pk_fma_f32 v[34:35], v[144:145], v[144:145], v[34:35]
	v_lshlrev_b32_e64 v146, 16, v73
	v_and_b32 v147, 0xffff0000, v73
	v_pk_add_f32 v[146:147], v[146:147], v[40:41] op_sel_hi:[1,0] neg_lo:[0,1] neg_hi:[0,1]
	v_pk_add_f32 v[32:33], v[32:33], v[146:147]
	v_pk_fma_f32 v[34:35], v[146:147], v[146:147], v[34:35]
	v_lshlrev_b32 v148, 16, v74
	s_xor_b32 s66, s97, 0x47800
	buffer_load_dwordx4 v18, s[16:19], s66 offen offset:2048 lds
	v_and_b32 v149, 0xffff0000, v74
	v_pk_add_f32 v[148:149], v[148:149], v[40:41] op_sel_hi:[1,0] neg_lo:[0,1] neg_hi:[0,1]
	v_pk_add_f32 v[32:33], v[32:33], v[148:149]
	v_pk_fma_f32 v[34:35], v[148:149], v[148:149], v[34:35]
	v_lshlrev_b32 v150, 16, v75
	v_and_b32 v151, 0xffff0000, v75
	v_pk_add_f32 v[150:151], v[150:151], v[40:41] op_sel_hi:[1,0] neg_lo:[0,1] neg_hi:[0,1]
	v_pk_add_f32 v[32:33], v[32:33], v[150:151]
	v_pk_fma_f32 v[34:35], v[150:151], v[150:151], v[34:35]
	s_waitcnt vmcnt(9)
	v_lshlrev_b32 v152, 16, v76
	s_xor_b32 s67, s70, 0x240
	buffer_load_dwordx4 v[100:103], v30, s[4:7], s67 offen
	v_and_b32 v153, 0xffff0000, v76
	v_pk_add_f32 v[152:153], v[152:153], v[40:41] op_sel_hi:[1,0] neg_lo:[0,1] neg_hi:[0,1]
	v_pk_add_f32 v[32:33], v[32:33], v[152:153]
	v_pk_fma_f32 v[34:35], v[152:153], v[152:153], v[34:35]
	v_lshlrev_b32_e64 v154, 16, v77
	v_and_b32 v155, 0xffff0000, v77
	v_pk_add_f32 v[154:155], v[154:155], v[40:41] op_sel_hi:[1,0] neg_lo:[0,1] neg_hi:[0,1]
	v_pk_add_f32 v[32:33], v[32:33], v[154:155]
	v_pk_fma_f32 v[34:35], v[154:155], v[154:155], v[34:35]
	v_lshlrev_b32 v156, 16, v78
	s_xor_b32 s66, s97, 0x67400
	buffer_load_dwordx4 v18, s[16:19], s66 offen offset:3072 lds
	v_and_b32 v157, 0xffff0000, v78
	v_pk_add_f32 v[156:157], v[156:157], v[40:41] op_sel_hi:[1,0] neg_lo:[0,1] neg_hi:[0,1]
	v_pk_add_f32 v[32:33], v[32:33], v[156:157]
	v_pk_fma_f32 v[34:35], v[156:157], v[156:157], v[34:35]
	v_lshlrev_b32 v158, 16, v79
	v_and_b32 v159, 0xffff0000, v79
	v_pk_add_f32 v[158:159], v[158:159], v[40:41] op_sel_hi:[1,0] neg_lo:[0,1] neg_hi:[0,1]
	v_pk_add_f32 v[32:33], v[32:33], v[158:159]
	v_pk_fma_f32 v[34:35], v[158:159], v[158:159], v[34:35]
	s_waitcnt vmcnt(9)
	v_lshlrev_b32 v160, 16, v80
	s_xor_b32 s67, s70, 0x280
	buffer_load_dwordx4 v[104:107], v30, s[4:7], s67 offen
	v_and_b32 v161, 0xffff0000, v80
	v_pk_add_f32 v[160:161], v[160:161], v[40:41] op_sel_hi:[1,0] neg_lo:[0,1] neg_hi:[0,1]
	v_pk_add_f32 v[32:33], v[32:33], v[160:161]
	v_pk_fma_f32 v[34:35], v[160:161], v[160:161], v[34:35]
	v_lshlrev_b32_e64 v162, 16, v81
	v_and_b32 v163, 0xffff0000, v81
	v_pk_add_f32 v[162:163], v[162:163], v[40:41] op_sel_hi:[1,0] neg_lo:[0,1] neg_hi:[0,1]
	v_pk_add_f32 v[32:33], v[32:33], v[162:163]
	v_pk_fma_f32 v[34:35], v[162:163], v[162:163], v[34:35]
	v_lshlrev_b32 v164, 16, v82
	s_add_u32 m0, s64, 0x2000
	s_xor_b32 s66, s97, 0x80
	buffer_load_dwordx4 v18, s[16:19], s66 offen offset:0 lds
	v_and_b32 v165, 0xffff0000, v82
	v_pk_add_f32 v[164:165], v[164:165], v[40:41] op_sel_hi:[1,0] neg_lo:[0,1] neg_hi:[0,1]
	v_pk_add_f32 v[32:33], v[32:33], v[164:165]
	v_pk_fma_f32 v[34:35], v[164:165], v[164:165], v[34:35]
	v_lshlrev_b32 v166, 16, v83
	v_and_b32 v167, 0xffff0000, v83
	v_pk_add_f32 v[166:167], v[166:167], v[40:41] op_sel_hi:[1,0] neg_lo:[0,1] neg_hi:[0,1]
	v_pk_add_f32 v[32:33], v[32:33], v[166:167]
	v_pk_fma_f32 v[34:35], v[166:167], v[166:167], v[34:35]
	s_waitcnt vmcnt(10)
	v_lshlrev_b32 v168, 16, v84
	s_xor_b32 s67, s70, 0x2c0
	buffer_load_dwordx4 v[108:111], v30, s[4:7], s67 offen
	v_and_b32 v169, 0xffff0000, v84
	v_pk_add_f32 v[168:169], v[168:169], v[40:41] op_sel_hi:[1,0] neg_lo:[0,1] neg_hi:[0,1]
	v_pk_add_f32 v[32:33], v[32:33], v[168:169]
	v_pk_fma_f32 v[34:35], v[168:169], v[168:169], v[34:35]
	v_lshlrev_b32_e64 v170, 16, v85
	v_and_b32 v171, 0xffff0000, v85
	v_pk_add_f32 v[170:171], v[170:171], v[40:41] op_sel_hi:[1,0] neg_lo:[0,1] neg_hi:[0,1]
	v_pk_add_f32 v[32:33], v[32:33], v[170:171]
	v_pk_fma_f32 v[34:35], v[170:171], v[170:171], v[34:35]
	v_lshlrev_b32 v172, 16, v86
	s_xor_b32 s66, s97, 0x1fc80
	buffer_load_dwordx4 v18, s[16:19], s66 offen offset:1024 lds
	v_and_b32 v173, 0xffff0000, v86
	v_pk_add_f32 v[172:173], v[172:173], v[40:41] op_sel_hi:[1,0] neg_lo:[0,1] neg_hi:[0,1]
	v_pk_add_f32 v[32:33], v[32:33], v[172:173]
	v_pk_fma_f32 v[34:35], v[172:173], v[172:173], v[34:35]
	v_lshlrev_b32 v174, 16, v87
	v_and_b32 v175, 0xffff0000, v87
	v_pk_add_f32 v[174:175], v[174:175], v[40:41] op_sel_hi:[1,0] neg_lo:[0,1] neg_hi:[0,1]
	v_pk_add_f32 v[32:33], v[32:33], v[174:175]
	v_pk_fma_f32 v[34:35], v[174:175], v[174:175], v[34:35]
	s_waitcnt vmcnt(11)
	v_lshlrev_b32 v176, 16, v88
	s_xor_b32 s67, s70, 0x300
	buffer_load_dwordx4 v[112:115], v30, s[4:7], s67 offen
	v_and_b32 v177, 0xffff0000, v88
	v_pk_add_f32 v[176:177], v[176:177], v[40:41] op_sel_hi:[1,0] neg_lo:[0,1] neg_hi:[0,1]
	v_pk_add_f32 v[32:33], v[32:33], v[176:177]
	v_pk_fma_f32 v[34:35], v[176:177], v[176:177], v[34:35]
	v_lshlrev_b32_e64 v178, 16, v89
	v_and_b32 v179, 0xffff0000, v89
	v_pk_add_f32 v[178:179], v[178:179], v[40:41] op_sel_hi:[1,0] neg_lo:[0,1] neg_hi:[0,1]
	v_pk_add_f32 v[32:33], v[32:33], v[178:179]
	v_pk_fma_f32 v[34:35], v[178:179], v[178:179], v[34:35]
	v_lshlrev_b32 v180, 16, v90
	s_xor_b32 s66, s97, 0x7880
	buffer_load_dwordx4 v18, s[16:19], s66 offen offset:2048 lds
	v_and_b32 v181, 0xffff0000, v90
	v_pk_add_f32 v[180:181], v[180:181], v[40:41] op_sel_hi:[1,0] neg_lo:[0,1] neg_hi:[0,1]
	v_pk_add_f32 v[32:33], v[32:33], v[180:181]
	v_pk_fma_f32 v[34:35], v[180:181], v[180:181], v[34:35]
	v_lshlrev_b32 v182, 16, v91
	v_and_b32 v183, 0xffff0000, v91
	v_pk_add_f32 v[182:183], v[182:183], v[40:41] op_sel_hi:[1,0] neg_lo:[0,1] neg_hi:[0,1]
	v_pk_add_f32 v[32:33], v[32:33], v[182:183]
	v_pk_fma_f32 v[34:35], v[182:183], v[182:183], v[34:35]
	s_waitcnt vmcnt(11)
	v_lshlrev_b32 v184, 16, v92
	s_xor_b32 s67, s70, 0x340
	buffer_load_dwordx4 v[116:119], v30, s[4:7], s67 offen
	v_and_b32 v185, 0xffff0000, v92
	v_pk_add_f32 v[184:185], v[184:185], v[40:41] op_sel_hi:[1,0] neg_lo:[0,1] neg_hi:[0,1]
	v_pk_add_f32 v[32:33], v[32:33], v[184:185]
	v_pk_fma_f32 v[34:35], v[184:185], v[184:185], v[34:35]
	v_lshlrev_b32_e64 v186, 16, v93
	v_and_b32 v187, 0xffff0000, v93
	v_pk_add_f32 v[186:187], v[186:187], v[40:41] op_sel_hi:[1,0] neg_lo:[0,1] neg_hi:[0,1]
	v_pk_add_f32 v[32:33], v[32:33], v[186:187]
	v_pk_fma_f32 v[34:35], v[186:187], v[186:187], v[34:35]
	v_lshlrev_b32 v188, 16, v94
	s_xor_b32 s66, s97, 0x27480
	buffer_load_dwordx4 v18, s[16:19], s66 offen offset:3072 lds
	v_and_b32 v189, 0xffff0000, v94
	v_pk_add_f32 v[188:189], v[188:189], v[40:41] op_sel_hi:[1,0] neg_lo:[0,1] neg_hi:[0,1]
	v_pk_add_f32 v[32:33], v[32:33], v[188:189]
	v_pk_fma_f32 v[34:35], v[188:189], v[188:189], v[34:35]
	v_lshlrev_b32 v190, 16, v95
	v_and_b32 v191, 0xffff0000, v95
	v_pk_add_f32 v[190:191], v[190:191], v[40:41] op_sel_hi:[1,0] neg_lo:[0,1] neg_hi:[0,1]
	v_pk_add_f32 v[32:33], v[32:33], v[190:191]
	v_pk_fma_f32 v[34:35], v[190:191], v[190:191], v[34:35]
	s_waitcnt vmcnt(11)
	v_lshlrev_b32 v192, 16, v96
	s_xor_b32 s67, s70, 0x380
	buffer_load_dwordx4 v[120:123], v30, s[4:7], s67 offen
	v_and_b32 v193, 0xffff0000, v96
	v_pk_add_f32 v[192:193], v[192:193], v[40:41] op_sel_hi:[1,0] neg_lo:[0,1] neg_hi:[0,1]
	v_pk_add_f32 v[32:33], v[32:33], v[192:193]
	v_pk_fma_f32 v[34:35], v[192:193], v[192:193], v[34:35]
	v_lshlrev_b32_e64 v194, 16, v97
	v_and_b32 v195, 0xffff0000, v97
	v_pk_add_f32 v[194:195], v[194:195], v[40:41] op_sel_hi:[1,0] neg_lo:[0,1] neg_hi:[0,1]
	v_pk_add_f32 v[32:33], v[32:33], v[194:195]
	v_pk_fma_f32 v[34:35], v[194:195], v[194:195], v[34:35]
	v_lshlrev_b32 v196, 16, v98
	s_add_u32 m0, s64, 0x3000
	s_xor_b32 s66, s97, 0x40080
	buffer_load_dwordx4 v18, s[16:19], s66 offen offset:0 lds
	v_and_b32 v197, 0xffff0000, v98
	v_pk_add_f32 v[196:197], v[196:197], v[40:41] op_sel_hi:[1,0] neg_lo:[0,1] neg_hi:[0,1]
	v_pk_add_f32 v[32:33], v[32:33], v[196:197]
	v_pk_fma_f32 v[34:35], v[196:197], v[196:197], v[34:35]
	v_lshlrev_b32 v198, 16, v99
	v_and_b32 v199, 0xffff0000, v99
	v_pk_add_f32 v[198:199], v[198:199], v[40:41] op_sel_hi:[1,0] neg_lo:[0,1] neg_hi:[0,1]
	v_pk_add_f32 v[32:33], v[32:33], v[198:199]
	v_pk_fma_f32 v[34:35], v[198:199], v[198:199], v[34:35]
	s_waitcnt vmcnt(11)
	v_lshlrev_b32 v200, 16, v100
	s_xor_b32 s67, s70, 0x3c0
	buffer_load_dwordx4 v[124:127], v30, s[4:7], s67 offen
	v_and_b32 v201, 0xffff0000, v100
	v_pk_add_f32 v[200:201], v[200:201], v[40:41] op_sel_hi:[1,0] neg_lo:[0,1] neg_hi:[0,1]
	v_pk_add_f32 v[32:33], v[32:33], v[200:201]
	v_pk_fma_f32 v[34:35], v[200:201], v[200:201], v[34:35]
	v_lshlrev_b32_e64 v202, 16, v101
	v_and_b32 v203, 0xffff0000, v101
	v_pk_add_f32 v[202:203], v[202:203], v[40:41] op_sel_hi:[1,0] neg_lo:[0,1] neg_hi:[0,1]
	v_pk_add_f32 v[32:33], v[32:33], v[202:203]
	v_pk_fma_f32 v[34:35], v[202:203], v[202:203], v[34:35]
	v_lshlrev_b32 v204, 16, v102
	s_xor_b32 s66, s97, 0x5fc80
	buffer_load_dwordx4 v18, s[16:19], s66 offen offset:1024 lds
	v_and_b32 v205, 0xffff0000, v102
	v_pk_add_f32 v[204:205], v[204:205], v[40:41] op_sel_hi:[1,0] neg_lo:[0,1] neg_hi:[0,1]
	v_pk_add_f32 v[32:33], v[32:33], v[204:205]
	v_pk_fma_f32 v[34:35], v[204:205], v[204:205], v[34:35]
	v_lshlrev_b32 v206, 16, v103
	v_and_b32 v207, 0xffff0000, v103
	v_pk_add_f32 v[206:207], v[206:207], v[40:41] op_sel_hi:[1,0] neg_lo:[0,1] neg_hi:[0,1]
	v_pk_add_f32 v[32:33], v[32:33], v[206:207]
	v_pk_fma_f32 v[34:35], v[206:207], v[206:207], v[34:35]
	s_waitcnt vmcnt(11)
	v_lshlrev_b32 v208, 16, v104
	s_xor_b32 s66, s97, 0x47880
	buffer_load_dwordx4 v18, s[16:19], s66 offen offset:2048 lds
	v_and_b32 v209, 0xffff0000, v104
	v_pk_add_f32 v[208:209], v[208:209], v[40:41] op_sel_hi:[1,0] neg_lo:[0,1] neg_hi:[0,1]
	v_pk_add_f32 v[32:33], v[32:33], v[208:209]
	v_pk_fma_f32 v[34:35], v[208:209], v[208:209], v[34:35]
	v_lshlrev_b32_e64 v210, 16, v105
	v_and_b32 v211, 0xffff0000, v105
	v_pk_add_f32 v[210:211], v[210:211], v[40:41] op_sel_hi:[1,0] neg_lo:[0,1] neg_hi:[0,1]
	v_pk_add_f32 v[32:33], v[32:33], v[210:211]
	v_pk_fma_f32 v[34:35], v[210:211], v[210:211], v[34:35]
	v_lshlrev_b32 v212, 16, v106
	s_xor_b32 s66, s97, 0x67480
	buffer_load_dwordx4 v18, s[16:19], s66 offen offset:3072 lds
	v_and_b32 v213, 0xffff0000, v106
	v_pk_add_f32 v[212:213], v[212:213], v[40:41] op_sel_hi:[1,0] neg_lo:[0,1] neg_hi:[0,1]
	v_pk_add_f32 v[32:33], v[32:33], v[212:213]
	v_pk_fma_f32 v[34:35], v[212:213], v[212:213], v[34:35]
	v_lshlrev_b32 v214, 16, v107
	v_and_b32 v215, 0xffff0000, v107
	v_pk_add_f32 v[214:215], v[214:215], v[40:41] op_sel_hi:[1,0] neg_lo:[0,1] neg_hi:[0,1]
	v_pk_add_f32 v[32:33], v[32:33], v[214:215]
	v_pk_fma_f32 v[34:35], v[214:215], v[214:215], v[34:35]
	s_waitcnt vmcnt(11)
	v_lshlrev_b32 v216, 16, v108
	s_add_u32 m0, s64, 0x4000
	s_xor_b32 s66, s97, 0x80000
	buffer_load_dwordx4 v18, s[16:19], s66 offen offset:0 lds
	v_and_b32 v217, 0xffff0000, v108
	v_pk_add_f32 v[216:217], v[216:217], v[40:41] op_sel_hi:[1,0] neg_lo:[0,1] neg_hi:[0,1]
	v_pk_add_f32 v[32:33], v[32:33], v[216:217]
	v_pk_fma_f32 v[34:35], v[216:217], v[216:217], v[34:35]
	v_lshlrev_b32_e64 v218, 16, v109
	v_and_b32 v219, 0xffff0000, v109
	v_pk_add_f32 v[218:219], v[218:219], v[40:41] op_sel_hi:[1,0] neg_lo:[0,1] neg_hi:[0,1]
	v_pk_add_f32 v[32:33], v[32:33], v[218:219]
	v_pk_fma_f32 v[34:35], v[218:219], v[218:219], v[34:35]
	v_lshlrev_b32 v220, 16, v110
	s_xor_b32 s66, s97, 0x9fc00
	buffer_load_dwordx4 v18, s[16:19], s66 offen offset:1024 lds
	v_and_b32 v221, 0xffff0000, v110
	v_pk_add_f32 v[220:221], v[220:221], v[40:41] op_sel_hi:[1,0] neg_lo:[0,1] neg_hi:[0,1]
	v_pk_add_f32 v[32:33], v[32:33], v[220:221]
	v_pk_fma_f32 v[34:35], v[220:221], v[220:221], v[34:35]
	v_lshlrev_b32 v222, 16, v111
	v_and_b32 v223, 0xffff0000, v111
	v_pk_add_f32 v[222:223], v[222:223], v[40:41] op_sel_hi:[1,0] neg_lo:[0,1] neg_hi:[0,1]
	v_pk_add_f32 v[32:33], v[32:33], v[222:223]
	v_pk_fma_f32 v[34:35], v[222:223], v[222:223], v[34:35]
	s_waitcnt vmcnt(11)
	v_lshlrev_b32 v224, 16, v112
	s_xor_b32 s66, s97, 0x87800
	buffer_load_dwordx4 v18, s[16:19], s66 offen offset:2048 lds
	v_and_b32 v225, 0xffff0000, v112
	v_pk_add_f32 v[224:225], v[224:225], v[40:41] op_sel_hi:[1,0] neg_lo:[0,1] neg_hi:[0,1]
	v_pk_add_f32 v[32:33], v[32:33], v[224:225]
	v_pk_fma_f32 v[34:35], v[224:225], v[224:225], v[34:35]
	v_lshlrev_b32_e64 v226, 16, v113
	v_and_b32 v227, 0xffff0000, v113
	v_pk_add_f32 v[226:227], v[226:227], v[40:41] op_sel_hi:[1,0] neg_lo:[0,1] neg_hi:[0,1]
	v_pk_add_f32 v[32:33], v[32:33], v[226:227]
	v_pk_fma_f32 v[34:35], v[226:227], v[226:227], v[34:35]
	v_lshlrev_b32 v228, 16, v114
	s_xor_b32 s66, s97, 0xa7400
	buffer_load_dwordx4 v18, s[16:19], s66 offen offset:3072 lds
	v_and_b32 v229, 0xffff0000, v114
	v_pk_add_f32 v[228:229], v[228:229], v[40:41] op_sel_hi:[1,0] neg_lo:[0,1] neg_hi:[0,1]
	v_pk_add_f32 v[32:33], v[32:33], v[228:229]
	v_pk_fma_f32 v[34:35], v[228:229], v[228:229], v[34:35]
	v_lshlrev_b32 v230, 16, v115
	v_and_b32 v231, 0xffff0000, v115
	v_pk_add_f32 v[230:231], v[230:231], v[40:41] op_sel_hi:[1,0] neg_lo:[0,1] neg_hi:[0,1]
	v_pk_add_f32 v[32:33], v[32:33], v[230:231]
	v_pk_fma_f32 v[34:35], v[230:231], v[230:231], v[34:35]
	s_waitcnt vmcnt(11)
	v_lshlrev_b32 v232, 16, v116
	s_add_u32 m0, s64, 0x5000
	s_xor_b32 s66, s97, 0xc0000
	buffer_load_dwordx4 v18, s[16:19], s66 offen offset:0 lds
	v_and_b32 v233, 0xffff0000, v116
	v_pk_add_f32 v[232:233], v[232:233], v[40:41] op_sel_hi:[1,0] neg_lo:[0,1] neg_hi:[0,1]
	v_pk_add_f32 v[32:33], v[32:33], v[232:233]
	v_pk_fma_f32 v[34:35], v[232:233], v[232:233], v[34:35]
	v_lshlrev_b32_e64 v234, 16, v117
	v_and_b32 v235, 0xffff0000, v117
	v_pk_add_f32 v[234:235], v[234:235], v[40:41] op_sel_hi:[1,0] neg_lo:[0,1] neg_hi:[0,1]
	v_pk_add_f32 v[32:33], v[32:33], v[234:235]
	v_pk_fma_f32 v[34:35], v[234:235], v[234:235], v[34:35]
	v_lshlrev_b32 v236, 16, v118
	s_xor_b32 s66, s97, 0xdfc00
	buffer_load_dwordx4 v18, s[16:19], s66 offen offset:1024 lds
	v_and_b32 v237, 0xffff0000, v118
	v_pk_add_f32 v[236:237], v[236:237], v[40:41] op_sel_hi:[1,0] neg_lo:[0,1] neg_hi:[0,1]
	v_pk_add_f32 v[32:33], v[32:33], v[236:237]
	v_pk_fma_f32 v[34:35], v[236:237], v[236:237], v[34:35]
	v_lshlrev_b32 v238, 16, v119
	v_and_b32 v239, 0xffff0000, v119
	v_pk_add_f32 v[238:239], v[238:239], v[40:41] op_sel_hi:[1,0] neg_lo:[0,1] neg_hi:[0,1]
	v_pk_add_f32 v[32:33], v[32:33], v[238:239]
	v_pk_fma_f32 v[34:35], v[238:239], v[238:239], v[34:35]
	s_waitcnt vmcnt(11)
	v_lshlrev_b32 v240, 16, v120
	s_xor_b32 s66, s97, 0xc7800
	buffer_load_dwordx4 v18, s[16:19], s66 offen offset:2048 lds
	v_and_b32 v241, 0xffff0000, v120
	v_pk_add_f32 v[240:241], v[240:241], v[40:41] op_sel_hi:[1,0] neg_lo:[0,1] neg_hi:[0,1]
	v_pk_add_f32 v[32:33], v[32:33], v[240:241]
	v_pk_fma_f32 v[34:35], v[240:241], v[240:241], v[34:35]
	v_lshlrev_b32_e64 v242, 16, v121
	v_and_b32 v243, 0xffff0000, v121
	v_pk_add_f32 v[242:243], v[242:243], v[40:41] op_sel_hi:[1,0] neg_lo:[0,1] neg_hi:[0,1]
	v_pk_add_f32 v[32:33], v[32:33], v[242:243]
	v_pk_fma_f32 v[34:35], v[242:243], v[242:243], v[34:35]
	v_lshlrev_b32 v244, 16, v122
	s_xor_b32 s66, s97, 0xe7400
	buffer_load_dwordx4 v18, s[16:19], s66 offen offset:3072 lds
	v_and_b32 v245, 0xffff0000, v122
	v_pk_add_f32 v[244:245], v[244:245], v[40:41] op_sel_hi:[1,0] neg_lo:[0,1] neg_hi:[0,1]
	v_pk_add_f32 v[32:33], v[32:33], v[244:245]
	v_pk_fma_f32 v[34:35], v[244:245], v[244:245], v[34:35]
	v_lshlrev_b32 v246, 16, v123
	v_and_b32 v247, 0xffff0000, v123
	v_pk_add_f32 v[246:247], v[246:247], v[40:41] op_sel_hi:[1,0] neg_lo:[0,1] neg_hi:[0,1]
	v_pk_add_f32 v[32:33], v[32:33], v[246:247]
	v_pk_fma_f32 v[34:35], v[246:247], v[246:247], v[34:35]
	s_waitcnt vmcnt(11)
	v_lshlrev_b32 v248, 16, v124
	v_and_b32 v249, 0xffff0000, v124
	v_pk_add_f32 v[248:249], v[248:249], v[40:41] op_sel_hi:[1,0] neg_lo:[0,1] neg_hi:[0,1]
	v_pk_add_f32 v[32:33], v[32:33], v[248:249]
	v_pk_fma_f32 v[34:35], v[248:249], v[248:249], v[34:35]
	v_lshlrev_b32_e64 v250, 16, v125
	v_and_b32 v251, 0xffff0000, v125
	v_pk_add_f32 v[250:251], v[250:251], v[40:41] op_sel_hi:[1,0] neg_lo:[0,1] neg_hi:[0,1]
	v_pk_add_f32 v[32:33], v[32:33], v[250:251]
	v_pk_fma_f32 v[34:35], v[250:251], v[250:251], v[34:35]
	v_lshlrev_b32_e64 v252, 16, v126
	v_and_b32 v253, 0xffff0000, v126
	v_pk_add_f32 v[252:253], v[252:253], v[40:41] op_sel_hi:[1,0] neg_lo:[0,1] neg_hi:[0,1]
	v_pk_add_f32 v[32:33], v[32:33], v[252:253]
	v_pk_fma_f32 v[34:35], v[252:253], v[252:253], v[34:35]
	v_lshlrev_b32_e64 v254, 16, v127
	v_and_b32 v255, 0xffff0000, v127
	v_pk_add_f32 v[254:255], v[254:255], v[40:41] op_sel_hi:[1,0] neg_lo:[0,1] neg_hi:[0,1]
	v_pk_add_f32 v[32:33], v[32:33], v[254:255]
	v_pk_fma_f32 v[34:35], v[254:255], v[254:255], v[34:35]
	buffer_store_dword v51, v50, s[48:51], s71 offen sc1
	v_add_f32 v32, v32, v33
	v_add_f32 v34, v34, v35
	s_nop 0
	v_add_f32_dpp v32, v32, v32 quad_perm:[1,0,3,2] row_mask:0xf bank_mask:0xf
	v_add_f32_dpp v34, v34, v34 quad_perm:[1,0,3,2] row_mask:0xf bank_mask:0xf
	s_nop 0
	v_add_f32_dpp v32, v32, v32 quad_perm:[2,3,0,1] row_mask:0xf bank_mask:0xf
	v_add_f32_dpp v34, v34, v34 quad_perm:[2,3,0,1] row_mask:0xf bank_mask:0xf
	v_mul_f32 v32, 0x3b000000, v32
	v_mul_f32 v34, 0x3b000000, v34
	buffer_load_dwordx4 a[152:155], v48, s[24:27], s79 offen
	v_fma_f32 v34, -v32, v32, v34
	v_max_f32 v34, 0, v34
	v_add_f32 v36, 0x3727c5ac, v34
	v_rsq_f32 v36, v36
	v_and_b32 v39, 0xf0, v13
	v_mul_f32 v38, v36, v36
	v_fmaak_f32 v38, v38, v34, 0x3727c5ac
	v_rsq_f32 v38, v38
	buffer_load_dwordx4 a[152:155], v13, s[8:11], s96 offen offset:0
	v_mul_f32 v36, 0x3e0293ee, v36
	v_mul_f32 v38, 0x40faf233, v38
	v_mul_f32_e64 v32, -v32, v36
	ds_bpermute_b32 v30, v39, v38
	v_pk_fma_f32 v[128:129], v[128:129], v[36:37], v[32:33] op_sel_hi:[1,0,0]
	v_pk_fma_f32 v[130:131], v[130:131], v[36:37], v[32:33] op_sel_hi:[1,0,0]
	v_pk_fma_f32 v[132:133], v[132:133], v[36:37], v[32:33] op_sel_hi:[1,0,0]
	v_pk_fma_f32 v[134:135], v[134:135], v[36:37], v[32:33] op_sel_hi:[1,0,0]
	buffer_load_dwordx4 a[152:155], v13, s[8:11], s96 offen offset:1024
	v_cvt_pk_bf16_f32 v64, v128, v129
	v_cvt_pk_bf16_f32 v65, v130, v131
	v_cvt_pk_bf16_f32 v66, v132, v133
	v_cvt_pk_bf16_f32 v67, v134, v135
	ds_write_b128 v57, v[64:67] offset:0
	v_pk_fma_f32 v[136:137], v[136:137], v[36:37], v[32:33] op_sel_hi:[1,0,0]
	v_pk_fma_f32 v[138:139], v[138:139], v[36:37], v[32:33] op_sel_hi:[1,0,0]
	v_pk_fma_f32 v[140:141], v[140:141], v[36:37], v[32:33] op_sel_hi:[1,0,0]
	buffer_load_dwordx4 a[152:155], v13, s[8:11], s96 offen offset:2048
	v_pk_fma_f32 v[142:143], v[142:143], v[36:37], v[32:33] op_sel_hi:[1,0,0]
	v_cvt_pk_bf16_f32 v68, v136, v137
	v_cvt_pk_bf16_f32 v69, v138, v139
	v_cvt_pk_bf16_f32 v70, v140, v141
	v_cvt_pk_bf16_f32 v71, v142, v143
	ds_write_b128 v57, v[68:71] offset:1024
	v_pk_fma_f32 v[144:145], v[144:145], v[36:37], v[32:33] op_sel_hi:[1,0,0]
	v_pk_fma_f32 v[146:147], v[146:147], v[36:37], v[32:33] op_sel_hi:[1,0,0]
	buffer_load_dwordx4 a[152:155], v13, s[8:11], s96 offen offset:3072
	v_pk_fma_f32 v[148:149], v[148:149], v[36:37], v[32:33] op_sel_hi:[1,0,0]
	v_pk_fma_f32 v[150:151], v[150:151], v[36:37], v[32:33] op_sel_hi:[1,0,0]
	v_cvt_pk_bf16_f32 v72, v144, v145
	v_cvt_pk_bf16_f32 v73, v146, v147
	v_cvt_pk_bf16_f32 v74, v148, v149
	v_cvt_pk_bf16_f32 v75, v150, v151
	ds_write_b128 v57, v[72:75] offset:2048
	v_pk_fma_f32 v[152:153], v[152:153], v[36:37], v[32:33] op_sel_hi:[1,0,0]
	buffer_load_dwordx4 a[152:155], v13, s[12:15], s96 offen offset:0
	v_pk_fma_f32 v[154:155], v[154:155], v[36:37], v[32:33] op_sel_hi:[1,0,0]
	v_pk_fma_f32 v[156:157], v[156:157], v[36:37], v[32:33] op_sel_hi:[1,0,0]
	v_pk_fma_f32 v[158:159], v[158:159], v[36:37], v[32:33] op_sel_hi:[1,0,0]
	v_cvt_pk_bf16_f32 v76, v152, v153
	v_cvt_pk_bf16_f32 v77, v154, v155
	v_cvt_pk_bf16_f32 v78, v156, v157
	v_cvt_pk_bf16_f32 v79, v158, v159
	ds_write_b128 v57, v[76:79] offset:3072
	v_pk_fma_f32 v[160:161], v[160:161], v[36:37], v[32:33] op_sel_hi:[1,0,0]
	v_pk_fma_f32 v[162:163], v[162:163], v[36:37], v[32:33] op_sel_hi:[1,0,0]
	v_pk_fma_f32 v[164:165], v[164:165], v[36:37], v[32:33] op_sel_hi:[1,0,0]
	v_pk_fma_f32 v[166:167], v[166:167], v[36:37], v[32:33] op_sel_hi:[1,0,0]
	v_cvt_pk_bf16_f32 v80, v160, v161
	v_cvt_pk_bf16_f32 v81, v162, v163
	v_cvt_pk_bf16_f32 v82, v164, v165
	v_cvt_pk_bf16_f32 v83, v166, v167
	ds_write_b128 v57, v[80:83] offset:4096
	v_pk_fma_f32 v[168:169], v[168:169], v[36:37], v[32:33] op_sel_hi:[1,0,0]
	v_pk_fma_f32 v[170:171], v[170:171], v[36:37], v[32:33] op_sel_hi:[1,0,0]
	v_pk_fma_f32 v[172:173], v[172:173], v[36:37], v[32:33] op_sel_hi:[1,0,0]
	v_pk_fma_f32 v[174:175], v[174:175], v[36:37], v[32:33] op_sel_hi:[1,0,0]
	v_cvt_pk_bf16_f32 v84, v168, v169
	v_cvt_pk_bf16_f32 v85, v170, v171
	v_cvt_pk_bf16_f32 v86, v172, v173
	v_cvt_pk_bf16_f32 v87, v174, v175
	ds_write_b128 v57, v[84:87] offset:5120
	v_pk_fma_f32 v[176:177], v[176:177], v[36:37], v[32:33] op_sel_hi:[1,0,0]
	v_pk_fma_f32 v[178:179], v[178:179], v[36:37], v[32:33] op_sel_hi:[1,0,0]
	v_pk_fma_f32 v[180:181], v[180:181], v[36:37], v[32:33] op_sel_hi:[1,0,0]
	v_pk_fma_f32 v[182:183], v[182:183], v[36:37], v[32:33] op_sel_hi:[1,0,0]
	v_cvt_pk_bf16_f32 v88, v176, v177
	v_cvt_pk_bf16_f32 v89, v178, v179
	v_cvt_pk_bf16_f32 v90, v180, v181
	v_cvt_pk_bf16_f32 v91, v182, v183
	ds_write_b128 v57, v[88:91] offset:6144
	v_pk_fma_f32 v[184:185], v[184:185], v[36:37], v[32:33] op_sel_hi:[1,0,0]
	v_pk_fma_f32 v[186:187], v[186:187], v[36:37], v[32:33] op_sel_hi:[1,0,0]
	v_pk_fma_f32 v[188:189], v[188:189], v[36:37], v[32:33] op_sel_hi:[1,0,0]
	v_pk_fma_f32 v[190:191], v[190:191], v[36:37], v[32:33] op_sel_hi:[1,0,0]
	v_cvt_pk_bf16_f32 v92, v184, v185
	v_cvt_pk_bf16_f32 v93, v186, v187
	v_cvt_pk_bf16_f32 v94, v188, v189
	v_cvt_pk_bf16_f32 v95, v190, v191
	ds_write_b128 v57, v[92:95] offset:7168
	v_pk_fma_f32 v[192:193], v[192:193], v[36:37], v[32:33] op_sel_hi:[1,0,0]
	v_pk_fma_f32 v[194:195], v[194:195], v[36:37], v[32:33] op_sel_hi:[1,0,0]
	v_pk_fma_f32 v[196:197], v[196:197], v[36:37], v[32:33] op_sel_hi:[1,0,0]
	v_pk_fma_f32 v[198:199], v[198:199], v[36:37], v[32:33] op_sel_hi:[1,0,0]
	v_cvt_pk_bf16_f32 v96, v192, v193
	v_cvt_pk_bf16_f32 v97, v194, v195
	v_cvt_pk_bf16_f32 v98, v196, v197
	v_cvt_pk_bf16_f32 v99, v198, v199
	ds_write_b128 v57, v[96:99] offset:8192
	v_pk_fma_f32 v[200:201], v[200:201], v[36:37], v[32:33] op_sel_hi:[1,0,0]
	v_pk_fma_f32 v[202:203], v[202:203], v[36:37], v[32:33] op_sel_hi:[1,0,0]
	v_pk_fma_f32 v[204:205], v[204:205], v[36:37], v[32:33] op_sel_hi:[1,0,0]
	v_pk_fma_f32 v[206:207], v[206:207], v[36:37], v[32:33] op_sel_hi:[1,0,0]
	v_cvt_pk_bf16_f32 v100, v200, v201
	v_cvt_pk_bf16_f32 v101, v202, v203
	v_cvt_pk_bf16_f32 v102, v204, v205
	v_cvt_pk_bf16_f32 v103, v206, v207
	ds_write_b128 v57, v[100:103] offset:9216
	v_pk_fma_f32 v[208:209], v[208:209], v[36:37], v[32:33] op_sel_hi:[1,0,0]
	v_pk_fma_f32 v[210:211], v[210:211], v[36:37], v[32:33] op_sel_hi:[1,0,0]
	v_pk_fma_f32 v[212:213], v[212:213], v[36:37], v[32:33] op_sel_hi:[1,0,0]
	v_pk_fma_f32 v[214:215], v[214:215], v[36:37], v[32:33] op_sel_hi:[1,0,0]
	v_cvt_pk_bf16_f32 v104, v208, v209
	v_cvt_pk_bf16_f32 v105, v210, v211
	v_cvt_pk_bf16_f32 v106, v212, v213
	v_cvt_pk_bf16_f32 v107, v214, v215
	ds_write_b128 v57, v[104:107] offset:10240
	v_pk_fma_f32 v[216:217], v[216:217], v[36:37], v[32:33] op_sel_hi:[1,0,0]
	v_pk_fma_f32 v[218:219], v[218:219], v[36:37], v[32:33] op_sel_hi:[1,0,0]
	v_pk_fma_f32 v[220:221], v[220:221], v[36:37], v[32:33] op_sel_hi:[1,0,0]
	v_pk_fma_f32 v[222:223], v[222:223], v[36:37], v[32:33] op_sel_hi:[1,0,0]
	v_cvt_pk_bf16_f32 v108, v216, v217
	v_cvt_pk_bf16_f32 v109, v218, v219
	v_cvt_pk_bf16_f32 v110, v220, v221
	v_cvt_pk_bf16_f32 v111, v222, v223
	ds_write_b128 v57, v[108:111] offset:11264
	v_pk_fma_f32 v[224:225], v[224:225], v[36:37], v[32:33] op_sel_hi:[1,0,0]
	v_pk_fma_f32 v[226:227], v[226:227], v[36:37], v[32:33] op_sel_hi:[1,0,0]
	v_pk_fma_f32 v[228:229], v[228:229], v[36:37], v[32:33] op_sel_hi:[1,0,0]
	v_pk_fma_f32 v[230:231], v[230:231], v[36:37], v[32:33] op_sel_hi:[1,0,0]
	v_cvt_pk_bf16_f32 v112, v224, v225
	v_cvt_pk_bf16_f32 v113, v226, v227
	v_cvt_pk_bf16_f32 v114, v228, v229
L_pg1:
	s_cbranch_execz L_pg5
	s_nop 0
	v_cvt_pk_bf16_f32 v115, v230, v231
	ds_write_b128 v57, v[112:115] offset:12288
	v_pk_fma_f32 v[232:233], v[232:233], v[36:37], v[32:33] op_sel_hi:[1,0,0]
	v_pk_fma_f32 v[234:235], v[234:235], v[36:37], v[32:33] op_sel_hi:[1,0,0]
	v_pk_fma_f32 v[236:237], v[236:237], v[36:37], v[32:33] op_sel_hi:[1,0,0]
	v_pk_fma_f32 v[238:239], v[238:239], v[36:37], v[32:33] op_sel_hi:[1,0,0]
	v_cvt_pk_bf16_f32 v116, v232, v233
	v_cvt_pk_bf16_f32 v117, v234, v235
	v_cvt_pk_bf16_f32 v118, v236, v237
	v_cvt_pk_bf16_f32 v119, v238, v239
	ds_write_b128 v57, v[116:119] offset:13312
	v_pk_fma_f32 v[240:241], v[240:241], v[36:37], v[32:33] op_sel_hi:[1,0,0]
	v_pk_fma_f32 v[242:243], v[242:243], v[36:37], v[32:33] op_sel_hi:[1,0,0]
	v_pk_fma_f32 v[244:245], v[244:245], v[36:37], v[32:33] op_sel_hi:[1,0,0]
	v_pk_fma_f32 v[246:247], v[246:247], v[36:37], v[32:33] op_sel_hi:[1,0,0]
	v_cvt_pk_bf16_f32 v120, v240, v241
	v_cvt_pk_bf16_f32 v121, v242, v243
	v_cvt_pk_bf16_f32 v122, v244, v245
	v_cvt_pk_bf16_f32 v123, v246, v247
	ds_write_b128 v57, v[120:123] offset:14336
	v_pk_fma_f32 v[248:249], v[248:249], v[36:37], v[32:33] op_sel_hi:[1,0,0]
	v_pk_fma_f32 v[250:251], v[250:251], v[36:37], v[32:33] op_sel_hi:[1,0,0]
	v_pk_fma_f32 v[252:253], v[252:253], v[36:37], v[32:33] op_sel_hi:[1,0,0]
	v_pk_fma_f32 v[254:255], v[254:255], v[36:37], v[32:33] op_sel_hi:[1,0,0]
	v_cvt_pk_bf16_f32 v124, v248, v249
	v_cvt_pk_bf16_f32 v125, v250, v251
	v_cvt_pk_bf16_f32 v126, v252, v253
	v_cvt_pk_bf16_f32 v127, v254, v255
	ds_write_b128 v57, v[124:127] offset:15360
	ds_read_b64_tr_b16 a[0:1], v1 offset:0
	ds_read_b64_tr_b16 a[2:3], v1 offset:2048
	ds_read_b64_tr_b16 a[4:5], v1 offset:4096
	ds_read_b64_tr_b16 a[6:7], v1 offset:6144
	ds_read_b64_tr_b16 a[8:9], v2 offset:0
	ds_read_b64_tr_b16 a[10:11], v2 offset:2048
	ds_read_b64_tr_b16 a[12:13], v2 offset:4096
	ds_read_b64_tr_b16 a[14:15], v2 offset:6144
	s_waitcnt lgkmcnt(8)
	s_barrier
	ds_read_b128 a[32:35], v56 offset:0
	ds_read_b128 a[48:51], v56 offset:1024
	ds_read_b128 a[52:55], v56 offset:17408
	ds_read_b128 a[36:39], v56 offset:16384
	ds_read_b128 a[40:43], v56 offset:32768
	ds_read_b128 a[56:59], v56 offset:33792
	ds_read_b128 a[60:63], v56 offset:50176
	ds_read_b128 a[44:47], v56 offset:49152
	s_waitcnt lgkmcnt(7)
	v_mfma_f32_16x16x32_bf16 v[128:131], a[0:3], a[32:35], 0
	s_waitcnt lgkmcnt(6)
	ds_read_b128 a[64:67], v56 offset:2048
	v_mfma_f32_16x16x32_bf16 v[128:131], a[4:7], a[48:51], v[128:131]
	s_waitcnt lgkmcnt(6)
	v_lshl_add_u32 v57, s62, 14, v56
	v_mfma_f32_16x16x32_bf16 v[132:135], a[4:7], a[52:55], 0
	s_waitcnt lgkmcnt(5)
	v_mfma_f32_16x16x32_bf16 v[132:135], a[0:3], a[36:39], v[132:135]
	s_waitcnt lgkmcnt(4)
	ds_read_b64_tr_b16 a[16:17], v3 offset:0
	ds_read_b64 a[160:161], v58 offset:0
	v_mfma_f32_16x16x32_bf16 v[136:139], a[0:3], a[40:43], 0
	s_waitcnt lgkmcnt(5)
	ds_read_b64_tr_b16 a[18:19], v3 offset:2048
	v_mfma_f32_16x16x32_bf16 v[136:139], a[4:7], a[56:59], v[136:139]
	s_waitcnt lgkmcnt(5)
	ds_read_b64_tr_b16 a[20:21], v3 offset:4096
	ds_read_b64 a[162:163], v59 offset:512
	v_mfma_f32_16x16x32_bf16 v[140:143], a[4:7], a[60:63], 0
	s_waitcnt lgkmcnt(6)
	ds_read_b64_tr_b16 a[22:23], v3 offset:6144
	ds_read_b128 a[80:83], v56 offset:3072
	v_mfma_f32_16x16x32_bf16 v[140:143], a[0:3], a[44:47], v[140:143]
	ds_read_b64 a[164:165], v52 offset:0
	v_mfma_f32_16x16x32_bf16 v[156:159], a[8:11], a[44:47], 0
	v_mfma_f32_16x16x32_bf16 v[156:159], a[12:15], a[60:63], v[156:159]
	ds_read_b64 a[166:167], v53 offset:512
	v_mfma_f32_16x16x32_bf16 v[152:155], a[12:15], a[56:59], 0
	v_mfma_f32_16x16x32_bf16 v[152:155], a[8:11], a[40:43], v[152:155]
	ds_read_b64_tr_b16 a[24:25], v4 offset:0
	ds_read_b128 v[64:67], v57 offset:0
	v_mfma_f32_16x16x32_bf16 v[148:151], a[8:11], a[36:39], 0
	ds_read_b64_tr_b16 a[26:27], v4 offset:2048
	ds_read_b128 a[68:71], v56 offset:18432
	v_mfma_f32_16x16x32_bf16 v[148:151], a[12:15], a[52:55], v[148:151]
	ds_read_b64_tr_b16 a[28:29], v4 offset:4096
	ds_read_b128 v[68:71], v57 offset:1024
	v_mfma_f32_16x16x32_bf16 v[144:147], a[12:15], a[48:51], 0
	ds_read_b64_tr_b16 a[30:31], v4 offset:6144
	v_mfma_f32_16x16x32_bf16 v[144:147], a[8:11], a[32:35], v[144:147]
	s_waitcnt lgkmcnt(11)
	ds_read_b128 v[72:75], v57 offset:2048
	v_mfma_f32_16x16x32_bf16 v[160:163], a[16:19], a[32:35], 0
	s_waitcnt lgkmcnt(10)
	v_mfma_f32_16x16x32_bf16 v[160:163], a[20:23], a[48:51], v[160:163]
	ds_read_b128 v[76:79], v57 offset:3072
	v_mfma_f32_16x16x32_bf16 v[164:167], a[20:23], a[52:55], 0
	ds_read_b128 a[84:87], v56 offset:19456
	v_mfma_f32_16x16x32_bf16 v[164:167], a[16:19], a[36:39], v[164:167]
	ds_read_b64_tr_b16 a[0:1], v1 offset:8192
	ds_read_b128 v[80:83], v57 offset:4096
	v_mfma_f32_16x16x32_bf16 v[168:171], a[16:19], a[40:43], 0
	ds_read_b64_tr_b16 a[2:3], v1 offset:10240
	v_mfma_f32_16x16x32_bf16 v[168:171], a[20:23], a[56:59], v[168:171]
	s_waitcnt vmcnt(15)
	ds_read_b64_tr_b16 a[4:5], v1 offset:12288
	ds_read_b128 v[84:87], v57 offset:5120
	v_mfma_f32_16x16x32_bf16 v[172:175], a[20:23], a[60:63], 0
	s_add_u32 m0, s64, 0x0
	ds_read_b64_tr_b16 a[6:7], v1 offset:14336
	v_mfma_f32_16x16x32_bf16 v[172:175], a[16:19], a[44:47], v[172:175]
	s_waitcnt lgkmcnt(10)
	ds_read_b128 v[88:91], v57 offset:6144
	v_mfma_f32_16x16x32_bf16 v[188:191], a[24:27], a[44:47], 0
	s_waitcnt lgkmcnt(10)
	s_xor_b32 s66, s97, 0x80080
	ds_read_b128 a[72:75], v56 offset:34816
	v_mfma_f32_16x16x32_bf16 v[188:191], a[28:31], a[60:63], v[188:191]
	buffer_load_dwordx4 v18, s[16:19], s66 offen offset:0 lds
	v_mfma_f32_16x16x32_bf16 v[184:187], a[28:31], a[56:59], 0
	ds_read_b64_tr_b16 a[8:9], v2 offset:8192
	ds_read_b128 v[92:95], v57 offset:7168
	v_mfma_f32_16x16x32_bf16 v[184:187], a[24:27], a[40:43], v[184:187]
	ds_read_b64_tr_b16 a[10:11], v2 offset:10240
	v_mfma_f32_16x16x32_bf16 v[180:183], a[24:27], a[36:39], 0
	s_xor_b32 s66, s97, 0x9fc80
	ds_read_b64_tr_b16 a[12:13], v2 offset:12288
	ds_read_b128 v[96:99], v57 offset:8192
	v_mfma_f32_16x16x32_bf16 v[180:183], a[28:31], a[52:55], v[180:183]
	buffer_load_dwordx4 v18, s[16:19], s66 offen offset:1024 lds
	v_mfma_f32_16x16x32_bf16 v[176:179], a[28:31], a[48:51], 0
	ds_read_b64_tr_b16 a[14:15], v2 offset:14336
	ds_read_b128 a[88:91], v56 offset:35840
	v_mfma_f32_16x16x32_bf16 v[176:179], a[24:27], a[32:35], v[176:179]
	s_waitcnt lgkmcnt(10)
	ds_read_b128 v[100:103], v57 offset:9216
	v_mfma_f32_16x16x32_bf16 v[192:195], a[0:3], a[32:35], 0
	s_waitcnt lgkmcnt(10)
	s_xor_b32 s66, s97, 0x87880
	v_mfma_f32_16x16x32_bf16 v[192:195], a[4:7], a[48:51], v[192:195]
	buffer_load_dwordx4 v18, s[16:19], s66 offen offset:2048 lds
	v_mfma_f32_16x16x32_bf16 v[196:199], a[4:7], a[52:55], 0
	ds_read_b64_tr_b16 a[16:17], v3 offset:8192
	ds_read_b128 v[104:107], v57 offset:10240
	v_mfma_f32_16x16x32_bf16 v[196:199], a[0:3], a[36:39], v[196:199]
	ds_read_b64_tr_b16 a[18:19], v3 offset:10240
	v_mfma_f32_16x16x32_bf16 v[200:203], a[0:3], a[40:43], 0
	s_xor_b32 s66, s97, 0xa7480
	ds_read_b64_tr_b16 a[20:21], v3 offset:12288
	ds_read_b128 a[76:79], v56 offset:51200
	v_mfma_f32_16x16x32_bf16 v[200:203], a[4:7], a[56:59], v[200:203]
	buffer_load_dwordx4 v18, s[16:19], s66 offen offset:3072 lds
	v_mfma_f32_16x16x32_bf16 v[204:207], a[4:7], a[60:63], 0
	s_add_u32 m0, s64, 0x1000
	ds_read_b64_tr_b16 a[22:23], v3 offset:14336
	ds_read_b128 v[108:111], v57 offset:11264
	v_mfma_f32_16x16x32_bf16 v[204:207], a[0:3], a[44:47], v[204:207]
	s_waitcnt lgkmcnt(10)
	v_mfma_f32_16x16x32_bf16 v[220:223], a[8:11], a[44:47], 0
	s_waitcnt lgkmcnt(8)
	s_xor_b32 s66, s97, 0xc0080
	ds_read_b128 v[112:115], v57 offset:12288
	v_mfma_f32_16x16x32_bf16 v[220:223], a[12:15], a[60:63], v[220:223]
	buffer_load_dwordx4 v18, s[16:19], s66 offen offset:0 lds
	v_mfma_f32_16x16x32_bf16 v[216:219], a[12:15], a[56:59], 0
	ds_read_b64_tr_b16 a[24:25], v4 offset:8192
	ds_read_b128 a[92:95], v56 offset:52224
	v_mfma_f32_16x16x32_bf16 v[216:219], a[8:11], a[40:43], v[216:219]
	ds_read_b64_tr_b16 a[26:27], v4 offset:10240
	ds_read_b128 v[116:119], v57 offset:13312
	v_mfma_f32_16x16x32_bf16 v[212:215], a[8:11], a[36:39], 0
	s_xor_b32 s66, s97, 0xdfc80
	ds_read_b64_tr_b16 a[28:29], v4 offset:12288
	v_mfma_f32_16x16x32_bf16 v[212:215], a[12:15], a[52:55], v[212:215]
	buffer_load_dwordx4 v18, s[16:19], s66 offen offset:1024 lds
	v_mfma_f32_16x16x32_bf16 v[208:211], a[12:15], a[48:51], 0
	ds_read_b64_tr_b16 a[30:31], v4 offset:14336
	ds_read_b128 v[120:123], v57 offset:14336
	v_mfma_f32_16x16x32_bf16 v[208:211], a[8:11], a[32:35], v[208:211]
	s_waitcnt lgkmcnt(10)
	v_mfma_f32_16x16x32_bf16 v[224:227], a[16:19], a[32:35], 0
	s_waitcnt lgkmcnt(8)
	s_xor_b32 s66, s97, 0xc7880
	ds_read_b128 v[124:127], v57 offset:15360
	v_mfma_f32_16x16x32_bf16 v[224:227], a[20:23], a[48:51], v[224:227]
	buffer_load_dwordx4 v18, s[16:19], s66 offen offset:2048 lds
	v_mfma_f32_16x16x32_bf16 v[228:231], a[20:23], a[52:55], 0
	s_waitcnt vmcnt(18)
	ds_read_b64_tr_b16 a[0:1], v1 offset:16384
	v_lshrrev_b32 v60, 2, v0
	v_mfma_f32_16x16x32_bf16 v[228:231], a[16:19], a[36:39], v[228:231]
	ds_read_b64_tr_b16 a[2:3], v1 offset:18432
	v_bfe_u32 v26, v0, 3, 2
	v_mfma_f32_16x16x32_bf16 v[232:235], a[16:19], a[40:43], 0
	s_waitcnt vmcnt(14)
	s_xor_b32 s66, s97, 0xe7480
	ds_read_b64_tr_b16 a[4:5], v1 offset:20480
	v_lshlrev_b32 v26, 5, v26
	v_mfma_f32_16x16x32_bf16 v[232:235], a[20:23], a[56:59], v[232:235]
	buffer_load_dwordx4 v18, s[16:19], s66 offen offset:3072 lds
	v_mfma_f32_16x16x32_bf16 v[236:239], a[20:23], a[60:63], 0
	s_add_u32 m0, s64, 0x2000
	ds_read_b64_tr_b16 a[6:7], v1 offset:22528
	v_lshl_or_b32 v60, v60, 7, v26
	v_mfma_f32_16x16x32_bf16 v[236:239], a[16:19], a[44:47], v[236:239]
	s_waitcnt lgkmcnt(7)
	v_and_b32 v26, 3, v0
	v_lshl_or_b32 v60, v26, 3, v60
	v_mfma_f32_16x16x32_bf16 v[252:255], a[24:27], a[44:47], 0
	s_waitcnt lgkmcnt(5)
	s_xor_b32 s66, s97, 0x100000
	v_add_u32 v60, 0x12000, v60
	v_xor_b32 v61, 0x20, v60
	v_mfma_f32_16x16x32_bf16 v[252:255], a[28:31], a[60:63], v[252:255]
	buffer_load_dwordx4 v18, s[16:19], s66 offen offset:0 lds
	v_mfma_f32_16x16x32_bf16 v[248:251], a[28:31], a[56:59], 0
	ds_read_b64_tr_b16 a[8:9], v2 offset:16384
	v_xor_b32 v62, 0x40, v60
	v_mfma_f32_16x16x32_bf16 v[248:251], a[24:27], a[40:43], v[248:251]
	ds_read_b64_tr_b16 a[10:11], v2 offset:18432
	v_xor_b32 v63, 0x60, v60
	v_mfma_f32_16x16x32_bf16 v[244:247], a[24:27], a[36:39], 0
	s_xor_b32 s66, s97, 0x11fc00
	ds_read_b64_tr_b16 a[12:13], v2 offset:20480
	v_mov_b32 v58, 0xc0135761
	v_mfma_f32_16x16x32_bf16 v[244:247], a[28:31], a[52:55], v[244:247]
	buffer_load_dwordx4 v18, s[16:19], s66 offen offset:1024 lds
	v_mfma_f32_16x16x32_bf16 v[240:243], a[28:31], a[48:51], 0
	ds_read_b64_tr_b16 a[14:15], v2 offset:22528
	v_mfma_f32_16x16x32_bf16 v[240:243], a[24:27], a[32:35], v[240:243]
	s_waitcnt lgkmcnt(5)
	v_mfma_f32_16x16x32_bf16 v[128:131], a[0:3], a[64:67], v[128:131]
	s_waitcnt lgkmcnt(4)
	s_xor_b32 s66, s97, 0x107800
	ds_read_b128 a[32:35], v56 offset:4096
	v_mfma_f32_16x16x32_bf16 v[128:131], a[4:7], a[80:83], v[128:131]
	buffer_load_dwordx4 v18, s[16:19], s66 offen offset:2048 lds
	v_mfma_f32_16x16x32_bf16 v[132:135], a[4:7], a[84:87], v[132:135]
	ds_read_b64_tr_b16 a[16:17], v3 offset:16384
	v_mfma_f32_16x16x32_bf16 v[132:135], a[0:3], a[68:71], v[132:135]
	ds_read_b64_tr_b16 a[18:19], v3 offset:18432
	v_mfma_f32_16x16x32_bf16 v[136:139], a[0:3], a[72:75], v[136:139]
	s_xor_b32 s66, s97, 0x127400
	ds_read_b64_tr_b16 a[20:21], v3 offset:20480
	v_mfma_f32_16x16x32_bf16 v[136:139], a[4:7], a[88:91], v[136:139]
	buffer_load_dwordx4 v18, s[16:19], s66 offen offset:3072 lds
	v_mfma_f32_16x16x32_bf16 v[140:143], a[4:7], a[92:95], v[140:143]
	s_add_u32 m0, s64, 0x3000
	ds_read_b64_tr_b16 a[22:23], v3 offset:22528
	ds_read_b128 a[48:51], v56 offset:5120
	v_mfma_f32_16x16x32_bf16 v[140:143], a[0:3], a[76:79], v[140:143]
	s_waitcnt lgkmcnt(7)
	v_mfma_f32_16x16x32_bf16 v[156:159], a[8:11], a[76:79], v[156:159]
	s_waitcnt lgkmcnt(6)
	s_xor_b32 s66, s97, 0x140000
	v_mfma_f32_16x16x32_bf16 v[156:159], a[12:15], a[92:95], v[156:159]
	buffer_load_dwordx4 v18, s[16:19], s66 offen offset:0 lds
	v_mfma_f32_16x16x32_bf16 v[152:155], a[12:15], a[88:91], v[152:155]
	ds_read_b64_tr_b16 a[24:25], v4 offset:16384
	v_mfma_f32_16x16x32_bf16 v[152:155], a[8:11], a[72:75], v[152:155]
	ds_read_b64_tr_b16 a[26:27], v4 offset:18432
	v_mfma_f32_16x16x32_bf16 v[148:151], a[8:11], a[68:71], v[148:151]
	s_xor_b32 s66, s97, 0x15fc00
	ds_read_b64_tr_b16 a[28:29], v4 offset:20480
	ds_read_b128 a[36:39], v56 offset:20480
	v_mfma_f32_16x16x32_bf16 v[148:151], a[12:15], a[84:87], v[148:151]
	buffer_load_dwordx4 v18, s[16:19], s66 offen offset:1024 lds
	v_mfma_f32_16x16x32_bf16 v[144:147], a[12:15], a[80:83], v[144:147]
	ds_read_b64_tr_b16 a[30:31], v4 offset:22528
	v_mfma_f32_16x16x32_bf16 v[144:147], a[8:11], a[64:67], v[144:147]
	s_waitcnt lgkmcnt(7)
	v_mfma_f32_16x16x32_bf16 v[160:163], a[16:19], a[64:67], v[160:163]
	s_waitcnt lgkmcnt(5)
	s_xor_b32 s66, s97, 0x147800
	v_mfma_f32_16x16x32_bf16 v[160:163], a[20:23], a[80:83], v[160:163]
	buffer_load_dwordx4 v18, s[16:19], s66 offen offset:2048 lds
	v_mfma_f32_16x16x32_bf16 v[164:167], a[20:23], a[84:87], v[164:167]
	s_waitcnt vmcnt(11)
	ds_read_b64_tr_b16 a[0:1], v1 offset:0
	ds_read_b128 a[52:55], v56 offset:21504
	v_mfma_f32_16x16x32_bf16 v[164:167], a[16:19], a[68:71], v[164:167]
	ds_read_b64_tr_b16 a[2:3], v1 offset:2048
	v_mfma_f32_16x16x32_bf16 v[168:171], a[16:19], a[72:75], v[168:171]
	s_waitcnt vmcnt(7)
	s_xor_b32 s66, s97, 0x167400
	ds_read_b64_tr_b16 a[4:5], v1 offset:4096
	v_mfma_f32_16x16x32_bf16 v[168:171], a[20:23], a[88:91], v[168:171]
	buffer_load_dwordx4 v18, s[16:19], s66 offen offset:3072 lds
	v_mfma_f32_16x16x32_bf16 v[172:175], a[20:23], a[92:95], v[172:175]
	s_add_u32 m0, s64, 0x4000
	ds_read_b64_tr_b16 a[6:7], v1 offset:6144
	v_mfma_f32_16x16x32_bf16 v[172:175], a[16:19], a[76:79], v[172:175]
	s_waitcnt lgkmcnt(6)
	v_mfma_f32_16x16x32_bf16 v[188:191], a[24:27], a[76:79], v[188:191]
	s_waitcnt lgkmcnt(5)
	s_xor_b32 s66, s97, 0x100080
	ds_read_b128 a[40:43], v56 offset:36864
	v_mfma_f32_16x16x32_bf16 v[188:191], a[28:31], a[92:95], v[188:191]
	buffer_load_dwordx4 v18, s[16:19], s66 offen offset:0 lds
	v_mfma_f32_16x16x32_bf16 v[184:187], a[28:31], a[88:91], v[184:187]
	ds_read_b64_tr_b16 a[8:9], v2 offset:0
	v_mfma_f32_16x16x32_bf16 v[184:187], a[24:27], a[72:75], v[184:187]
	ds_read_b64_tr_b16 a[10:11], v2 offset:2048
	v_mfma_f32_16x16x32_bf16 v[180:183], a[24:27], a[68:71], v[180:183]
	s_xor_b32 s66, s97, 0x11fc80
	ds_read_b64_tr_b16 a[12:13], v2 offset:4096
	v_mfma_f32_16x16x32_bf16 v[180:183], a[28:31], a[84:87], v[180:183]
	buffer_load_dwordx4 v18, s[16:19], s66 offen offset:1024 lds
	v_mfma_f32_16x16x32_bf16 v[176:179], a[28:31], a[80:83], v[176:179]
	ds_read_b64_tr_b16 a[14:15], v2 offset:6144
	ds_read_b128 a[56:59], v56 offset:37888
	v_mfma_f32_16x16x32_bf16 v[176:179], a[24:27], a[64:67], v[176:179]
	s_waitcnt lgkmcnt(7)
	v_mfma_f32_16x16x32_bf16 v[192:195], a[0:3], a[64:67], v[192:195]
	s_waitcnt lgkmcnt(6)
	s_xor_b32 s66, s97, 0x107880
	v_mfma_f32_16x16x32_bf16 v[192:195], a[4:7], a[80:83], v[192:195]
	buffer_load_dwordx4 v18, s[16:19], s66 offen offset:2048 lds
	v_mfma_f32_16x16x32_bf16 v[196:199], a[4:7], a[84:87], v[196:199]
	ds_read_b64_tr_b16 a[16:17], v3 offset:0
	v_mfma_f32_16x16x32_bf16 v[196:199], a[0:3], a[68:71], v[196:199]
	ds_read_b64_tr_b16 a[18:19], v3 offset:2048
	v_mfma_f32_16x16x32_bf16 v[200:203], a[0:3], a[72:75], v[200:203]
	s_xor_b32 s66, s97, 0x127480
	ds_read_b64_tr_b16 a[20:21], v3 offset:4096
	ds_read_b128 a[44:47], v56 offset:53248
	v_mfma_f32_16x16x32_bf16 v[200:203], a[4:7], a[88:91], v[200:203]
	buffer_load_dwordx4 v18, s[16:19], s66 offen offset:3072 lds
	v_mfma_f32_16x16x32_bf16 v[204:207], a[4:7], a[92:95], v[204:207]
	s_add_u32 m0, s64, 0x5000
	ds_read_b64_tr_b16 a[22:23], v3 offset:6144
	v_mfma_f32_16x16x32_bf16 v[204:207], a[0:3], a[76:79], v[204:207]
	s_waitcnt lgkmcnt(7)
	v_mfma_f32_16x16x32_bf16 v[220:223], a[8:11], a[76:79], v[220:223]
	s_waitcnt lgkmcnt(5)
	s_xor_b32 s66, s97, 0x140080
	v_mfma_f32_16x16x32_bf16 v[220:223], a[12:15], a[92:95], v[220:223]
	buffer_load_dwordx4 v18, s[16:19], s66 offen offset:0 lds
	v_mfma_f32_16x16x32_bf16 v[216:219], a[12:15], a[88:91], v[216:219]
	ds_read_b64_tr_b16 a[24:25], v4 offset:0
	ds_read_b128 a[60:63], v56 offset:54272
	v_mfma_f32_16x16x32_bf16 v[216:219], a[8:11], a[72:75], v[216:219]
	ds_read_b64_tr_b16 a[26:27], v4 offset:2048
	v_mfma_f32_16x16x32_bf16 v[212:215], a[8:11], a[68:71], v[212:215]
	s_xor_b32 s66, s97, 0x15fc80
	ds_read_b64_tr_b16 a[28:29], v4 offset:4096
	v_mfma_f32_16x16x32_bf16 v[212:215], a[12:15], a[84:87], v[212:215]
	buffer_load_dwordx4 v18, s[16:19], s66 offen offset:1024 lds
	v_mfma_f32_16x16x32_bf16 v[208:211], a[12:15], a[80:83], v[208:211]
	ds_read_b64_tr_b16 a[30:31], v4 offset:6144
	v_mfma_f32_16x16x32_bf16 v[208:211], a[8:11], a[64:67], v[208:211]
	s_waitcnt lgkmcnt(6)
	v_mfma_f32_16x16x32_bf16 v[224:227], a[16:19], a[64:67], v[224:227]
	s_waitcnt lgkmcnt(5)
	s_xor_b32 s66, s97, 0x147880
	v_mfma_f32_16x16x32_bf16 v[224:227], a[20:23], a[80:83], v[224:227]
	buffer_load_dwordx4 v18, s[16:19], s66 offen offset:2048 lds
	v_mfma_f32_16x16x32_bf16 v[228:231], a[20:23], a[84:87], v[228:231]
	s_waitcnt vmcnt(11)
	ds_read_b64_tr_b16 a[0:1], v1 offset:8192
	v_mfma_f32_16x16x32_bf16 v[228:231], a[16:19], a[68:71], v[228:231]
	ds_read_b64_tr_b16 a[2:3], v1 offset:10240
	v_mfma_f32_16x16x32_bf16 v[232:235], a[16:19], a[72:75], v[232:235]
	s_waitcnt vmcnt(7)
	s_xor_b32 s66, s97, 0x167480
	ds_read_b64_tr_b16 a[4:5], v1 offset:12288
	v_mfma_f32_16x16x32_bf16 v[232:235], a[20:23], a[88:91], v[232:235]
	buffer_load_dwordx4 v18, s[16:19], s66 offen offset:3072 lds
	v_mfma_f32_16x16x32_bf16 v[236:239], a[20:23], a[92:95], v[236:239]
	s_add_u32 m0, s64, 0x0
	ds_read_b64_tr_b16 a[6:7], v1 offset:14336
	v_mfma_f32_16x16x32_bf16 v[236:239], a[16:19], a[76:79], v[236:239]
	s_waitcnt lgkmcnt(5)
	v_mfma_f32_16x16x32_bf16 v[252:255], a[24:27], a[76:79], v[252:255]
	s_waitcnt lgkmcnt(4)
	s_xor_b32 s66, s97, 0x180000
	v_mfma_f32_16x16x32_bf16 v[252:255], a[28:31], a[92:95], v[252:255]
	buffer_load_dwordx4 v18, s[16:19], s66 offen offset:0 lds
	v_mfma_f32_16x16x32_bf16 v[248:251], a[28:31], a[88:91], v[248:251]
	ds_read_b64_tr_b16 a[8:9], v2 offset:8192
	v_mfma_f32_16x16x32_bf16 v[248:251], a[24:27], a[72:75], v[248:251]
	ds_read_b64_tr_b16 a[10:11], v2 offset:10240
	v_mfma_f32_16x16x32_bf16 v[244:247], a[24:27], a[68:71], v[244:247]
	s_xor_b32 s66, s97, 0x19fc00
	ds_read_b64_tr_b16 a[12:13], v2 offset:12288
	v_mfma_f32_16x16x32_bf16 v[244:247], a[28:31], a[84:87], v[244:247]
	buffer_load_dwordx4 v18, s[16:19], s66 offen offset:1024 lds
	v_mfma_f32_16x16x32_bf16 v[240:243], a[28:31], a[80:83], v[240:243]
	ds_read_b64_tr_b16 a[14:15], v2 offset:14336
	v_mfma_f32_16x16x32_bf16 v[240:243], a[24:27], a[64:67], v[240:243]
	s_waitcnt lgkmcnt(5)
	v_mfma_f32_16x16x32_bf16 v[128:131], a[0:3], a[32:35], v[128:131]
	s_waitcnt lgkmcnt(4)
	s_xor_b32 s66, s97, 0x187800
	ds_read_b128 a[64:67], v56 offset:6144
	v_mfma_f32_16x16x32_bf16 v[128:131], a[4:7], a[48:51], v[128:131]
	buffer_load_dwordx4 v18, s[16:19], s66 offen offset:2048 lds
	v_mfma_f32_16x16x32_bf16 v[132:135], a[4:7], a[52:55], v[132:135]
	ds_read_b64_tr_b16 a[16:17], v3 offset:8192
	v_mfma_f32_16x16x32_bf16 v[132:135], a[0:3], a[36:39], v[132:135]
	ds_read_b64_tr_b16 a[18:19], v3 offset:10240
	v_mfma_f32_16x16x32_bf16 v[136:139], a[0:3], a[40:43], v[136:139]
	s_xor_b32 s66, s97, 0x1a7400
	ds_read_b64_tr_b16 a[20:21], v3 offset:12288
	v_mfma_f32_16x16x32_bf16 v[136:139], a[4:7], a[56:59], v[136:139]
	buffer_load_dwordx4 v18, s[16:19], s66 offen offset:3072 lds
	v_mfma_f32_16x16x32_bf16 v[140:143], a[4:7], a[60:63], v[140:143]
	s_add_u32 m0, s64, 0x1000
	ds_read_b64_tr_b16 a[22:23], v3 offset:14336
	ds_read_b128 a[80:83], v56 offset:7168
	v_mfma_f32_16x16x32_bf16 v[140:143], a[0:3], a[44:47], v[140:143]
	s_waitcnt lgkmcnt(7)
	v_mfma_f32_16x16x32_bf16 v[156:159], a[8:11], a[44:47], v[156:159]
	s_waitcnt lgkmcnt(6)
	s_xor_b32 s66, s97, 0x1c0000
	v_mfma_f32_16x16x32_bf16 v[156:159], a[12:15], a[60:63], v[156:159]
	buffer_load_dwordx4 v18, s[16:19], s66 offen offset:0 lds
	v_mfma_f32_16x16x32_bf16 v[152:155], a[12:15], a[56:59], v[152:155]
	ds_read_b64_tr_b16 a[24:25], v4 offset:8192
	v_mfma_f32_16x16x32_bf16 v[152:155], a[8:11], a[40:43], v[152:155]
	ds_read_b64_tr_b16 a[26:27], v4 offset:10240
	v_mfma_f32_16x16x32_bf16 v[148:151], a[8:11], a[36:39], v[148:151]
	s_xor_b32 s66, s97, 0x1dfc00
	ds_read_b64_tr_b16 a[28:29], v4 offset:12288
	ds_read_b128 a[68:71], v56 offset:22528
	v_mfma_f32_16x16x32_bf16 v[148:151], a[12:15], a[52:55], v[148:151]
	buffer_load_dwordx4 v18, s[16:19], s66 offen offset:1024 lds
	v_mfma_f32_16x16x32_bf16 v[144:147], a[12:15], a[48:51], v[144:147]
	ds_read_b64_tr_b16 a[30:31], v4 offset:14336
	v_mfma_f32_16x16x32_bf16 v[144:147], a[8:11], a[32:35], v[144:147]
	s_waitcnt lgkmcnt(7)
	v_mfma_f32_16x16x32_bf16 v[160:163], a[16:19], a[32:35], v[160:163]
	s_waitcnt lgkmcnt(5)
	s_xor_b32 s66, s97, 0x1c7800
	v_mfma_f32_16x16x32_bf16 v[160:163], a[20:23], a[48:51], v[160:163]
	buffer_load_dwordx4 v18, s[16:19], s66 offen offset:2048 lds
	v_mfma_f32_16x16x32_bf16 v[164:167], a[20:23], a[52:55], v[164:167]
	s_waitcnt vmcnt(11)
	ds_read_b64_tr_b16 a[0:1], v1 offset:16384
	ds_read_b128 a[84:87], v56 offset:23552
	v_mfma_f32_16x16x32_bf16 v[164:167], a[16:19], a[36:39], v[164:167]
	ds_read_b64_tr_b16 a[2:3], v1 offset:18432
	v_mfma_f32_16x16x32_bf16 v[168:171], a[16:19], a[40:43], v[168:171]
	s_waitcnt vmcnt(7)
	s_xor_b32 s66, s97, 0x1e7400
	ds_read_b64_tr_b16 a[4:5], v1 offset:20480
	v_mfma_f32_16x16x32_bf16 v[168:171], a[20:23], a[56:59], v[168:171]
	buffer_load_dwordx4 v18, s[16:19], s66 offen offset:3072 lds
	v_mfma_f32_16x16x32_bf16 v[172:175], a[20:23], a[60:63], v[172:175]
	s_add_u32 m0, s64, 0x2000
	ds_read_b64_tr_b16 a[6:7], v1 offset:22528
	v_mfma_f32_16x16x32_bf16 v[172:175], a[16:19], a[44:47], v[172:175]
	s_waitcnt lgkmcnt(6)
	v_mfma_f32_16x16x32_bf16 v[188:191], a[24:27], a[44:47], v[188:191]
	s_waitcnt lgkmcnt(5)
	s_xor_b32 s66, s97, 0x180080
	ds_read_b128 a[72:75], v56 offset:38912
	v_mfma_f32_16x16x32_bf16 v[188:191], a[28:31], a[60:63], v[188:191]
	buffer_load_dwordx4 v18, s[16:19], s66 offen offset:0 lds
	v_mfma_f32_16x16x32_bf16 v[184:187], a[28:31], a[56:59], v[184:187]
	ds_read_b64_tr_b16 a[8:9], v2 offset:16384
	v_mfma_f32_16x16x32_bf16 v[184:187], a[24:27], a[40:43], v[184:187]
	ds_read_b64_tr_b16 a[10:11], v2 offset:18432
	v_mfma_f32_16x16x32_bf16 v[180:183], a[24:27], a[36:39], v[180:183]
	s_xor_b32 s66, s97, 0x19fc80
	ds_read_b64_tr_b16 a[12:13], v2 offset:20480
	v_mfma_f32_16x16x32_bf16 v[180:183], a[28:31], a[52:55], v[180:183]
	buffer_load_dwordx4 v18, s[16:19], s66 offen offset:1024 lds
	v_mfma_f32_16x16x32_bf16 v[176:179], a[28:31], a[48:51], v[176:179]
	ds_read_b64_tr_b16 a[14:15], v2 offset:22528
	ds_read_b128 a[88:91], v56 offset:39936
	v_mfma_f32_16x16x32_bf16 v[176:179], a[24:27], a[32:35], v[176:179]
	s_waitcnt lgkmcnt(7)
	v_mfma_f32_16x16x32_bf16 v[192:195], a[0:3], a[32:35], v[192:195]
	s_waitcnt lgkmcnt(6)
	s_xor_b32 s66, s97, 0x187880
	v_mfma_f32_16x16x32_bf16 v[192:195], a[4:7], a[48:51], v[192:195]
	buffer_load_dwordx4 v18, s[16:19], s66 offen offset:2048 lds
	v_mfma_f32_16x16x32_bf16 v[196:199], a[4:7], a[52:55], v[196:199]
	ds_read_b64_tr_b16 a[16:17], v3 offset:16384
	v_mfma_f32_16x16x32_bf16 v[196:199], a[0:3], a[36:39], v[196:199]
	ds_read_b64_tr_b16 a[18:19], v3 offset:18432
	v_mfma_f32_16x16x32_bf16 v[200:203], a[0:3], a[40:43], v[200:203]
	s_xor_b32 s66, s97, 0x1a7480
	ds_read_b64_tr_b16 a[20:21], v3 offset:20480
	ds_read_b128 a[76:79], v56 offset:55296
	v_mfma_f32_16x16x32_bf16 v[200:203], a[4:7], a[56:59], v[200:203]
	buffer_load_dwordx4 v18, s[16:19], s66 offen offset:3072 lds
	v_mfma_f32_16x16x32_bf16 v[204:207], a[4:7], a[60:63], v[204:207]
	s_add_u32 m0, s64, 0x3000
	ds_read_b64_tr_b16 a[22:23], v3 offset:22528
	v_mfma_f32_16x16x32_bf16 v[204:207], a[0:3], a[44:47], v[204:207]
	s_waitcnt lgkmcnt(7)
	v_mfma_f32_16x16x32_bf16 v[220:223], a[8:11], a[44:47], v[220:223]
	s_waitcnt lgkmcnt(5)
	s_xor_b32 s66, s97, 0x1c0080
	v_mfma_f32_16x16x32_bf16 v[220:223], a[12:15], a[60:63], v[220:223]
	buffer_load_dwordx4 v18, s[16:19], s66 offen offset:0 lds
	v_mfma_f32_16x16x32_bf16 v[216:219], a[12:15], a[56:59], v[216:219]
	ds_read_b64_tr_b16 a[24:25], v4 offset:16384
	ds_read_b128 a[92:95], v56 offset:56320
	v_mfma_f32_16x16x32_bf16 v[216:219], a[8:11], a[40:43], v[216:219]
	ds_read_b64_tr_b16 a[26:27], v4 offset:18432
	v_mfma_f32_16x16x32_bf16 v[212:215], a[8:11], a[36:39], v[212:215]
	s_xor_b32 s66, s97, 0x1dfc80
	ds_read_b64_tr_b16 a[28:29], v4 offset:20480
	v_mfma_f32_16x16x32_bf16 v[212:215], a[12:15], a[52:55], v[212:215]
	buffer_load_dwordx4 v18, s[16:19], s66 offen offset:1024 lds
	v_mfma_f32_16x16x32_bf16 v[208:211], a[12:15], a[48:51], v[208:211]
	ds_read_b64_tr_b16 a[30:31], v4 offset:22528
	v_mfma_f32_16x16x32_bf16 v[208:211], a[8:11], a[32:35], v[208:211]
	s_waitcnt lgkmcnt(6)
	v_mfma_f32_16x16x32_bf16 v[224:227], a[16:19], a[32:35], v[224:227]
	s_waitcnt lgkmcnt(5)
	s_xor_b32 s66, s97, 0x1c7880
	v_mfma_f32_16x16x32_bf16 v[224:227], a[20:23], a[48:51], v[224:227]
	buffer_load_dwordx4 v18, s[16:19], s66 offen offset:2048 lds
	v_mfma_f32_16x16x32_bf16 v[228:231], a[20:23], a[52:55], v[228:231]
	s_waitcnt vmcnt(11)
	ds_read_b64_tr_b16 a[0:1], v1 offset:0
	v_mfma_f32_16x16x32_bf16 v[228:231], a[16:19], a[36:39], v[228:231]
	ds_read_b64_tr_b16 a[2:3], v1 offset:2048
	v_mfma_f32_16x16x32_bf16 v[232:235], a[16:19], a[40:43], v[232:235]
	s_waitcnt vmcnt(7)
	s_xor_b32 s66, s97, 0x1e7480
	ds_read_b64_tr_b16 a[4:5], v1 offset:4096
	v_mfma_f32_16x16x32_bf16 v[232:235], a[20:23], a[56:59], v[232:235]
	buffer_load_dwordx4 v18, s[16:19], s66 offen offset:3072 lds
	v_mfma_f32_16x16x32_bf16 v[236:239], a[20:23], a[60:63], v[236:239]
	s_add_u32 m0, s64, 0x4000
	ds_read_b64_tr_b16 a[6:7], v1 offset:6144
	v_mfma_f32_16x16x32_bf16 v[236:239], a[16:19], a[44:47], v[236:239]
	s_waitcnt lgkmcnt(5)
	v_mfma_f32_16x16x32_bf16 v[252:255], a[24:27], a[44:47], v[252:255]
	s_waitcnt lgkmcnt(4)
	s_xor_b32 s66, s97, 0x200000
	v_mfma_f32_16x16x32_bf16 v[252:255], a[28:31], a[60:63], v[252:255]
	buffer_load_dwordx4 v18, s[16:19], s66 offen offset:0 lds
	v_mfma_f32_16x16x32_bf16 v[248:251], a[28:31], a[56:59], v[248:251]
	ds_read_b64_tr_b16 a[8:9], v2 offset:0
	v_mfma_f32_16x16x32_bf16 v[248:251], a[24:27], a[40:43], v[248:251]
	ds_read_b64_tr_b16 a[10:11], v2 offset:2048
	v_mfma_f32_16x16x32_bf16 v[244:247], a[24:27], a[36:39], v[244:247]
	s_xor_b32 s66, s97, 0x21fc00
	ds_read_b64_tr_b16 a[12:13], v2 offset:4096
	v_mfma_f32_16x16x32_bf16 v[244:247], a[28:31], a[52:55], v[244:247]
	buffer_load_dwordx4 v18, s[16:19], s66 offen offset:1024 lds
	v_mfma_f32_16x16x32_bf16 v[240:243], a[28:31], a[48:51], v[240:243]
L_pg2:
	s_cbranch_execz L_pg6
	ds_read_b64_tr_b16 a[14:15], v2 offset:6144
	v_mfma_f32_16x16x32_bf16 v[240:243], a[24:27], a[32:35], v[240:243]
	s_waitcnt lgkmcnt(5)
	v_mfma_f32_16x16x32_bf16 v[128:131], a[0:3], a[64:67], v[128:131]
	s_waitcnt lgkmcnt(4)
	s_xor_b32 s66, s97, 0x207800
	ds_read_b128 a[32:35], v56 offset:8192
	v_mfma_f32_16x16x32_bf16 v[128:131], a[4:7], a[80:83], v[128:131]
	buffer_load_dwordx4 v18, s[16:19], s66 offen offset:2048 lds
	v_mfma_f32_16x16x32_bf16 v[132:135], a[4:7], a[84:87], v[132:135]
	ds_read_b64_tr_b16 a[16:17], v3 offset:0
	v_mfma_f32_16x16x32_bf16 v[132:135], a[0:3], a[68:71], v[132:135]
	ds_read_b64_tr_b16 a[18:19], v3 offset:2048
	v_mfma_f32_16x16x32_bf16 v[136:139], a[0:3], a[72:75], v[136:139]
	s_xor_b32 s66, s97, 0x227400
	ds_read_b64_tr_b16 a[20:21], v3 offset:4096
	v_mfma_f32_16x16x32_bf16 v[136:139], a[4:7], a[88:91], v[136:139]
	buffer_load_dwordx4 v18, s[16:19], s66 offen offset:3072 lds
	v_mfma_f32_16x16x32_bf16 v[140:143], a[4:7], a[92:95], v[140:143]
	s_add_u32 m0, s64, 0x5000
	ds_read_b64_tr_b16 a[22:23], v3 offset:6144
	ds_read_b128 a[48:51], v56 offset:9216
	v_mfma_f32_16x16x32_bf16 v[140:143], a[0:3], a[76:79], v[140:143]
	s_waitcnt lgkmcnt(7)
	v_mfma_f32_16x16x32_bf16 v[156:159], a[8:11], a[76:79], v[156:159]
	s_waitcnt lgkmcnt(6)
	s_xor_b32 s66, s97, 0x240000
	v_mfma_f32_16x16x32_bf16 v[156:159], a[12:15], a[92:95], v[156:159]
	buffer_load_dwordx4 v18, s[16:19], s66 offen offset:0 lds
	v_mfma_f32_16x16x32_bf16 v[152:155], a[12:15], a[88:91], v[152:155]
	ds_read_b64_tr_b16 a[24:25], v4 offset:0
	v_mfma_f32_16x16x32_bf16 v[152:155], a[8:11], a[72:75], v[152:155]
	ds_read_b64_tr_b16 a[26:27], v4 offset:2048
	v_mfma_f32_16x16x32_bf16 v[148:151], a[8:11], a[68:71], v[148:151]
	s_xor_b32 s66, s97, 0x25fc00
	ds_read_b64_tr_b16 a[28:29], v4 offset:4096
	ds_read_b128 a[36:39], v56 offset:24576
	v_mfma_f32_16x16x32_bf16 v[148:151], a[12:15], a[84:87], v[148:151]
	buffer_load_dwordx4 v18, s[16:19], s66 offen offset:1024 lds
	v_mfma_f32_16x16x32_bf16 v[144:147], a[12:15], a[80:83], v[144:147]
	ds_read_b64_tr_b16 a[30:31], v4 offset:6144
	v_mfma_f32_16x16x32_bf16 v[144:147], a[8:11], a[64:67], v[144:147]
	s_waitcnt lgkmcnt(7)
	v_mfma_f32_16x16x32_bf16 v[160:163], a[16:19], a[64:67], v[160:163]
	s_waitcnt lgkmcnt(5)
	s_xor_b32 s66, s97, 0x247800
	v_mfma_f32_16x16x32_bf16 v[160:163], a[20:23], a[80:83], v[160:163]
	buffer_load_dwordx4 v18, s[16:19], s66 offen offset:2048 lds
	v_mfma_f32_16x16x32_bf16 v[164:167], a[20:23], a[84:87], v[164:167]
	s_waitcnt vmcnt(11)
	ds_read_b64_tr_b16 a[0:1], v1 offset:8192
	ds_read_b128 a[52:55], v56 offset:25600
	v_mfma_f32_16x16x32_bf16 v[164:167], a[16:19], a[68:71], v[164:167]
	ds_read_b64_tr_b16 a[2:3], v1 offset:10240
	v_mfma_f32_16x16x32_bf16 v[168:171], a[16:19], a[72:75], v[168:171]
	s_waitcnt vmcnt(7)
	s_xor_b32 s66, s97, 0x267400
	ds_read_b64_tr_b16 a[4:5], v1 offset:12288
	v_mfma_f32_16x16x32_bf16 v[168:171], a[20:23], a[88:91], v[168:171]
	buffer_load_dwordx4 v18, s[16:19], s66 offen offset:3072 lds
	v_mfma_f32_16x16x32_bf16 v[172:175], a[20:23], a[92:95], v[172:175]
	s_add_u32 m0, s64, 0x0
	ds_read_b64_tr_b16 a[6:7], v1 offset:14336
	v_mfma_f32_16x16x32_bf16 v[172:175], a[16:19], a[76:79], v[172:175]
	s_waitcnt lgkmcnt(6)
	v_mfma_f32_16x16x32_bf16 v[188:191], a[24:27], a[76:79], v[188:191]
	s_waitcnt lgkmcnt(5)
	s_xor_b32 s66, s97, 0x200080
	ds_read_b128 a[40:43], v56 offset:40960
	v_mfma_f32_16x16x32_bf16 v[188:191], a[28:31], a[92:95], v[188:191]
	buffer_load_dwordx4 v18, s[16:19], s66 offen offset:0 lds
	v_mfma_f32_16x16x32_bf16 v[184:187], a[28:31], a[88:91], v[184:187]
	ds_read_b64_tr_b16 a[8:9], v2 offset:8192
	v_mfma_f32_16x16x32_bf16 v[184:187], a[24:27], a[72:75], v[184:187]
	ds_read_b64_tr_b16 a[10:11], v2 offset:10240
	v_mfma_f32_16x16x32_bf16 v[180:183], a[24:27], a[68:71], v[180:183]
	s_xor_b32 s66, s97, 0x21fc80
	ds_read_b64_tr_b16 a[12:13], v2 offset:12288
	v_mfma_f32_16x16x32_bf16 v[180:183], a[28:31], a[84:87], v[180:183]
	buffer_load_dwordx4 v18, s[16:19], s66 offen offset:1024 lds
	v_mfma_f32_16x16x32_bf16 v[176:179], a[28:31], a[80:83], v[176:179]
	ds_read_b64_tr_b16 a[14:15], v2 offset:14336
	ds_read_b128 a[56:59], v56 offset:41984
	v_mfma_f32_16x16x32_bf16 v[176:179], a[24:27], a[64:67], v[176:179]
	s_waitcnt lgkmcnt(7)
	v_mfma_f32_16x16x32_bf16 v[192:195], a[0:3], a[64:67], v[192:195]
	s_waitcnt lgkmcnt(6)
	s_xor_b32 s66, s97, 0x207880
	v_mfma_f32_16x16x32_bf16 v[192:195], a[4:7], a[80:83], v[192:195]
	buffer_load_dwordx4 v18, s[16:19], s66 offen offset:2048 lds
	v_mfma_f32_16x16x32_bf16 v[196:199], a[4:7], a[84:87], v[196:199]
	ds_read_b64_tr_b16 a[16:17], v3 offset:8192
	v_mfma_f32_16x16x32_bf16 v[196:199], a[0:3], a[68:71], v[196:199]
	ds_read_b64_tr_b16 a[18:19], v3 offset:10240
	v_mfma_f32_16x16x32_bf16 v[200:203], a[0:3], a[72:75], v[200:203]
	s_xor_b32 s66, s97, 0x227480
	ds_read_b64_tr_b16 a[20:21], v3 offset:12288
	ds_read_b128 a[44:47], v56 offset:57344
	v_mfma_f32_16x16x32_bf16 v[200:203], a[4:7], a[88:91], v[200:203]
	buffer_load_dwordx4 v18, s[16:19], s66 offen offset:3072 lds
	v_mfma_f32_16x16x32_bf16 v[204:207], a[4:7], a[92:95], v[204:207]
	s_add_u32 m0, s64, 0x1000
	ds_read_b64_tr_b16 a[22:23], v3 offset:14336
	v_mfma_f32_16x16x32_bf16 v[204:207], a[0:3], a[76:79], v[204:207]
	s_waitcnt lgkmcnt(7)
	v_mfma_f32_16x16x32_bf16 v[220:223], a[8:11], a[76:79], v[220:223]
	s_waitcnt lgkmcnt(5)
	s_xor_b32 s66, s97, 0x240080
	v_mfma_f32_16x16x32_bf16 v[220:223], a[12:15], a[92:95], v[220:223]
	buffer_load_dwordx4 v18, s[16:19], s66 offen offset:0 lds
	v_mfma_f32_16x16x32_bf16 v[216:219], a[12:15], a[88:91], v[216:219]
	ds_read_b64_tr_b16 a[24:25], v4 offset:8192
	ds_read_b128 a[60:63], v56 offset:58368
	v_mfma_f32_16x16x32_bf16 v[216:219], a[8:11], a[72:75], v[216:219]
	ds_read_b64_tr_b16 a[26:27], v4 offset:10240
	v_mfma_f32_16x16x32_bf16 v[212:215], a[8:11], a[68:71], v[212:215]
	s_xor_b32 s66, s97, 0x25fc80
	ds_read_b64_tr_b16 a[28:29], v4 offset:12288
	v_mfma_f32_16x16x32_bf16 v[212:215], a[12:15], a[84:87], v[212:215]
	buffer_load_dwordx4 v18, s[16:19], s66 offen offset:1024 lds
	v_mfma_f32_16x16x32_bf16 v[208:211], a[12:15], a[80:83], v[208:211]
	ds_read_b64_tr_b16 a[30:31], v4 offset:14336
	v_mfma_f32_16x16x32_bf16 v[208:211], a[8:11], a[64:67], v[208:211]
	s_waitcnt lgkmcnt(6)
	v_mfma_f32_16x16x32_bf16 v[224:227], a[16:19], a[64:67], v[224:227]
	s_waitcnt lgkmcnt(5)
	s_xor_b32 s66, s97, 0x247880
	v_mfma_f32_16x16x32_bf16 v[224:227], a[20:23], a[80:83], v[224:227]
	buffer_load_dwordx4 v18, s[16:19], s66 offen offset:2048 lds
	v_mfma_f32_16x16x32_bf16 v[228:231], a[20:23], a[84:87], v[228:231]
	s_waitcnt vmcnt(11)
	ds_read_b64_tr_b16 a[0:1], v1 offset:16384
	v_mfma_f32_16x16x32_bf16 v[228:231], a[16:19], a[68:71], v[228:231]
	ds_read_b64_tr_b16 a[2:3], v1 offset:18432
	v_mfma_f32_16x16x32_bf16 v[232:235], a[16:19], a[72:75], v[232:235]
	s_waitcnt vmcnt(7)
	s_xor_b32 s66, s97, 0x267480
	ds_read_b64_tr_b16 a[4:5], v1 offset:20480
	v_mfma_f32_16x16x32_bf16 v[232:235], a[20:23], a[88:91], v[232:235]
	buffer_load_dwordx4 v18, s[16:19], s66 offen offset:3072 lds
	v_mfma_f32_16x16x32_bf16 v[236:239], a[20:23], a[92:95], v[236:239]
	s_add_u32 m0, s64, 0x2000
	ds_read_b64_tr_b16 a[6:7], v1 offset:22528
	v_mfma_f32_16x16x32_bf16 v[236:239], a[16:19], a[76:79], v[236:239]
	s_waitcnt lgkmcnt(5)
	v_mfma_f32_16x16x32_bf16 v[252:255], a[24:27], a[76:79], v[252:255]
	s_waitcnt lgkmcnt(4)
	s_xor_b32 s66, s97, 0x280000
	v_mfma_f32_16x16x32_bf16 v[252:255], a[28:31], a[92:95], v[252:255]
	buffer_load_dwordx4 v18, s[16:19], s66 offen offset:0 lds
	v_mfma_f32_16x16x32_bf16 v[248:251], a[28:31], a[88:91], v[248:251]
	ds_read_b64_tr_b16 a[8:9], v2 offset:16384
	v_mfma_f32_16x16x32_bf16 v[248:251], a[24:27], a[72:75], v[248:251]
	ds_read_b64_tr_b16 a[10:11], v2 offset:18432
	v_mfma_f32_16x16x32_bf16 v[244:247], a[24:27], a[68:71], v[244:247]
	s_xor_b32 s66, s97, 0x29fc00
	ds_read_b64_tr_b16 a[12:13], v2 offset:20480
	v_mfma_f32_16x16x32_bf16 v[244:247], a[28:31], a[84:87], v[244:247]
	buffer_load_dwordx4 v18, s[16:19], s66 offen offset:1024 lds
	v_mfma_f32_16x16x32_bf16 v[240:243], a[28:31], a[80:83], v[240:243]
	ds_read_b64_tr_b16 a[14:15], v2 offset:22528
	v_mfma_f32_16x16x32_bf16 v[240:243], a[24:27], a[64:67], v[240:243]
	s_waitcnt lgkmcnt(5)
	v_mfma_f32_16x16x32_bf16 v[128:131], a[0:3], a[32:35], v[128:131]
	s_waitcnt lgkmcnt(4)
	s_xor_b32 s66, s97, 0x287800
	ds_read_b128 a[64:67], v56 offset:10240
	v_mfma_f32_16x16x32_bf16 v[128:131], a[4:7], a[48:51], v[128:131]
	buffer_load_dwordx4 v18, s[16:19], s66 offen offset:2048 lds
	v_mfma_f32_16x16x32_bf16 v[132:135], a[4:7], a[52:55], v[132:135]
	ds_read_b64_tr_b16 a[16:17], v3 offset:16384
	v_mfma_f32_16x16x32_bf16 v[132:135], a[0:3], a[36:39], v[132:135]
	ds_read_b64_tr_b16 a[18:19], v3 offset:18432
	v_mfma_f32_16x16x32_bf16 v[136:139], a[0:3], a[40:43], v[136:139]
	s_xor_b32 s66, s97, 0x2a7400
	ds_read_b64_tr_b16 a[20:21], v3 offset:20480
	v_mfma_f32_16x16x32_bf16 v[136:139], a[4:7], a[56:59], v[136:139]
	buffer_load_dwordx4 v18, s[16:19], s66 offen offset:3072 lds
	v_mfma_f32_16x16x32_bf16 v[140:143], a[4:7], a[60:63], v[140:143]
	s_add_u32 m0, s64, 0x3000
	ds_read_b64_tr_b16 a[22:23], v3 offset:22528
	ds_read_b128 a[80:83], v56 offset:11264
	v_mfma_f32_16x16x32_bf16 v[140:143], a[0:3], a[44:47], v[140:143]
	s_waitcnt lgkmcnt(7)
	v_mfma_f32_16x16x32_bf16 v[156:159], a[8:11], a[44:47], v[156:159]
	s_waitcnt lgkmcnt(6)
	s_xor_b32 s66, s97, 0x2c0000
	v_mfma_f32_16x16x32_bf16 v[156:159], a[12:15], a[60:63], v[156:159]
	buffer_load_dwordx4 v18, s[16:19], s66 offen offset:0 lds
	v_mfma_f32_16x16x32_bf16 v[152:155], a[12:15], a[56:59], v[152:155]
	ds_read_b64_tr_b16 a[24:25], v4 offset:16384
	v_mfma_f32_16x16x32_bf16 v[152:155], a[8:11], a[40:43], v[152:155]
	ds_read_b64_tr_b16 a[26:27], v4 offset:18432
	v_mfma_f32_16x16x32_bf16 v[148:151], a[8:11], a[36:39], v[148:151]
	s_xor_b32 s66, s97, 0x2dfc00
	ds_read_b64_tr_b16 a[28:29], v4 offset:20480
	ds_read_b128 a[68:71], v56 offset:26624
	v_mfma_f32_16x16x32_bf16 v[148:151], a[12:15], a[52:55], v[148:151]
	buffer_load_dwordx4 v18, s[16:19], s66 offen offset:1024 lds
	v_mfma_f32_16x16x32_bf16 v[144:147], a[12:15], a[48:51], v[144:147]
	ds_read_b64_tr_b16 a[30:31], v4 offset:22528
	v_mfma_f32_16x16x32_bf16 v[144:147], a[8:11], a[32:35], v[144:147]
	s_waitcnt lgkmcnt(7)
	v_mfma_f32_16x16x32_bf16 v[160:163], a[16:19], a[32:35], v[160:163]
	s_waitcnt lgkmcnt(5)
	s_xor_b32 s66, s97, 0x2c7800
	v_mfma_f32_16x16x32_bf16 v[160:163], a[20:23], a[48:51], v[160:163]
	buffer_load_dwordx4 v18, s[16:19], s66 offen offset:2048 lds
	v_mfma_f32_16x16x32_bf16 v[164:167], a[20:23], a[52:55], v[164:167]
	s_waitcnt vmcnt(11)
	ds_read_b64_tr_b16 a[0:1], v1 offset:0
	ds_read_b128 a[84:87], v56 offset:27648
	v_mfma_f32_16x16x32_bf16 v[164:167], a[16:19], a[36:39], v[164:167]
	ds_read_b64_tr_b16 a[2:3], v1 offset:2048
	v_mfma_f32_16x16x32_bf16 v[168:171], a[16:19], a[40:43], v[168:171]
	s_waitcnt vmcnt(7)
	s_xor_b32 s66, s97, 0x2e7400
	ds_read_b64_tr_b16 a[4:5], v1 offset:4096
	v_mfma_f32_16x16x32_bf16 v[168:171], a[20:23], a[56:59], v[168:171]
	buffer_load_dwordx4 v18, s[16:19], s66 offen offset:3072 lds
	v_mfma_f32_16x16x32_bf16 v[172:175], a[20:23], a[60:63], v[172:175]
	s_add_u32 m0, s64, 0x4000
	ds_read_b64_tr_b16 a[6:7], v1 offset:6144
	v_mfma_f32_16x16x32_bf16 v[172:175], a[16:19], a[44:47], v[172:175]
	s_waitcnt lgkmcnt(6)
	v_mfma_f32_16x16x32_bf16 v[188:191], a[24:27], a[44:47], v[188:191]
	s_waitcnt lgkmcnt(5)
	s_xor_b32 s66, s97, 0x300000
	ds_read_b128 a[72:75], v56 offset:43008
	v_mfma_f32_16x16x32_bf16 v[188:191], a[28:31], a[60:63], v[188:191]
	buffer_load_dwordx4 v18, s[16:19], s66 offen offset:0 lds
	v_mfma_f32_16x16x32_bf16 v[184:187], a[28:31], a[56:59], v[184:187]
	ds_read_b64_tr_b16 a[8:9], v2 offset:0
	v_mfma_f32_16x16x32_bf16 v[184:187], a[24:27], a[40:43], v[184:187]
	ds_read_b64_tr_b16 a[10:11], v2 offset:2048
	v_mfma_f32_16x16x32_bf16 v[180:183], a[24:27], a[36:39], v[180:183]
	s_xor_b32 s66, s97, 0x31fc00
	ds_read_b64_tr_b16 a[12:13], v2 offset:4096
	v_mfma_f32_16x16x32_bf16 v[180:183], a[28:31], a[52:55], v[180:183]
	buffer_load_dwordx4 v18, s[16:19], s66 offen offset:1024 lds
	v_mfma_f32_16x16x32_bf16 v[176:179], a[28:31], a[48:51], v[176:179]
	ds_read_b64_tr_b16 a[14:15], v2 offset:6144
	ds_read_b128 a[88:91], v56 offset:44032
	v_mfma_f32_16x16x32_bf16 v[176:179], a[24:27], a[32:35], v[176:179]
	s_waitcnt lgkmcnt(7)
	v_mfma_f32_16x16x32_bf16 v[192:195], a[0:3], a[32:35], v[192:195]
	s_waitcnt lgkmcnt(6)
	s_xor_b32 s66, s97, 0x307800
	v_mfma_f32_16x16x32_bf16 v[192:195], a[4:7], a[48:51], v[192:195]
	buffer_load_dwordx4 v18, s[16:19], s66 offen offset:2048 lds
	v_mfma_f32_16x16x32_bf16 v[196:199], a[4:7], a[52:55], v[196:199]
	ds_read_b64_tr_b16 a[16:17], v3 offset:0
	v_mfma_f32_16x16x32_bf16 v[196:199], a[0:3], a[36:39], v[196:199]
	ds_read_b64_tr_b16 a[18:19], v3 offset:2048
	v_mfma_f32_16x16x32_bf16 v[200:203], a[0:3], a[40:43], v[200:203]
	s_xor_b32 s66, s97, 0x327400
	ds_read_b64_tr_b16 a[20:21], v3 offset:4096
	ds_read_b128 a[76:79], v56 offset:59392
	v_mfma_f32_16x16x32_bf16 v[200:203], a[4:7], a[56:59], v[200:203]
	buffer_load_dwordx4 v18, s[16:19], s66 offen offset:3072 lds
	v_mfma_f32_16x16x32_bf16 v[204:207], a[4:7], a[60:63], v[204:207]
	s_add_u32 m0, s64, 0x5000
	ds_read_b64_tr_b16 a[22:23], v3 offset:6144
	v_mfma_f32_16x16x32_bf16 v[204:207], a[0:3], a[44:47], v[204:207]
	s_waitcnt lgkmcnt(7)
	v_mfma_f32_16x16x32_bf16 v[220:223], a[8:11], a[44:47], v[220:223]
	s_waitcnt lgkmcnt(5)
	s_xor_b32 s66, s97, 0x340000
	v_mfma_f32_16x16x32_bf16 v[220:223], a[12:15], a[60:63], v[220:223]
	buffer_load_dwordx4 v18, s[16:19], s66 offen offset:0 lds
	v_mfma_f32_16x16x32_bf16 v[216:219], a[12:15], a[56:59], v[216:219]
	ds_read_b64_tr_b16 a[24:25], v4 offset:0
	ds_read_b128 a[92:95], v56 offset:60416
	v_mfma_f32_16x16x32_bf16 v[216:219], a[8:11], a[40:43], v[216:219]
	ds_read_b64_tr_b16 a[26:27], v4 offset:2048
	v_mfma_f32_16x16x32_bf16 v[212:215], a[8:11], a[36:39], v[212:215]
	s_xor_b32 s66, s97, 0x35fc00
	ds_read_b64_tr_b16 a[28:29], v4 offset:4096
	v_mfma_f32_16x16x32_bf16 v[212:215], a[12:15], a[52:55], v[212:215]
	buffer_load_dwordx4 v18, s[16:19], s66 offen offset:1024 lds
	v_mfma_f32_16x16x32_bf16 v[208:211], a[12:15], a[48:51], v[208:211]
	ds_read_b64_tr_b16 a[30:31], v4 offset:6144
	v_mfma_f32_16x16x32_bf16 v[208:211], a[8:11], a[32:35], v[208:211]
	s_waitcnt lgkmcnt(6)
	v_mfma_f32_16x16x32_bf16 v[224:227], a[16:19], a[32:35], v[224:227]
	s_waitcnt lgkmcnt(5)
	s_xor_b32 s66, s97, 0x347800
	v_mfma_f32_16x16x32_bf16 v[224:227], a[20:23], a[48:51], v[224:227]
	buffer_load_dwordx4 v18, s[16:19], s66 offen offset:2048 lds
	v_mfma_f32_16x16x32_bf16 v[228:231], a[20:23], a[52:55], v[228:231]
	s_waitcnt vmcnt(11)
	ds_read_b64_tr_b16 a[0:1], v1 offset:8192
	v_mfma_f32_16x16x32_bf16 v[228:231], a[16:19], a[36:39], v[228:231]
	ds_read_b64_tr_b16 a[2:3], v1 offset:10240
	v_mfma_f32_16x16x32_bf16 v[232:235], a[16:19], a[40:43], v[232:235]
	s_waitcnt vmcnt(7)
	s_xor_b32 s66, s97, 0x367400
	ds_read_b64_tr_b16 a[4:5], v1 offset:12288
	v_mfma_f32_16x16x32_bf16 v[232:235], a[20:23], a[56:59], v[232:235]
	buffer_load_dwordx4 v18, s[16:19], s66 offen offset:3072 lds
	v_mfma_f32_16x16x32_bf16 v[236:239], a[20:23], a[60:63], v[236:239]
	s_add_u32 m0, s64, 0x0
	ds_read_b64_tr_b16 a[6:7], v1 offset:14336
	v_mfma_f32_16x16x32_bf16 v[236:239], a[16:19], a[44:47], v[236:239]
	s_waitcnt lgkmcnt(5)
	v_mfma_f32_16x16x32_bf16 v[252:255], a[24:27], a[44:47], v[252:255]
	s_waitcnt lgkmcnt(4)
	s_xor_b32 s66, s97, 0x380000
	v_mfma_f32_16x16x32_bf16 v[252:255], a[28:31], a[60:63], v[252:255]
	buffer_load_dwordx4 v18, s[16:19], s66 offen offset:0 lds
	v_mfma_f32_16x16x32_bf16 v[248:251], a[28:31], a[56:59], v[248:251]
	ds_read_b64_tr_b16 a[8:9], v2 offset:8192
	v_mfma_f32_16x16x32_bf16 v[248:251], a[24:27], a[40:43], v[248:251]
	ds_read_b64_tr_b16 a[10:11], v2 offset:10240
	v_mfma_f32_16x16x32_bf16 v[244:247], a[24:27], a[36:39], v[244:247]
	s_xor_b32 s66, s97, 0x39fc00
	ds_read_b64_tr_b16 a[12:13], v2 offset:12288
	v_mfma_f32_16x16x32_bf16 v[244:247], a[28:31], a[52:55], v[244:247]
	buffer_load_dwordx4 v18, s[16:19], s66 offen offset:1024 lds
	v_mfma_f32_16x16x32_bf16 v[240:243], a[28:31], a[48:51], v[240:243]
	ds_read_b64_tr_b16 a[14:15], v2 offset:14336
	v_mfma_f32_16x16x32_bf16 v[240:243], a[24:27], a[32:35], v[240:243]
	s_waitcnt lgkmcnt(5)
	v_mfma_f32_16x16x32_bf16 v[128:131], a[0:3], a[64:67], v[128:131]
	s_waitcnt lgkmcnt(4)
	s_xor_b32 s66, s97, 0x387800
	ds_read_b128 a[32:35], v56 offset:12288
	v_mfma_f32_16x16x32_bf16 v[128:131], a[4:7], a[80:83], v[128:131]
	buffer_load_dwordx4 v18, s[16:19], s66 offen offset:2048 lds
	v_mfma_f32_16x16x32_bf16 v[132:135], a[4:7], a[84:87], v[132:135]
	ds_read_b64_tr_b16 a[16:17], v3 offset:8192
	ds_read_b128 a[48:51], v56 offset:13312
	v_mfma_f32_16x16x32_bf16 v[132:135], a[0:3], a[68:71], v[132:135]
	ds_read_b64_tr_b16 a[18:19], v3 offset:10240
	v_mfma_f32_16x16x32_bf16 v[136:139], a[0:3], a[72:75], v[136:139]
	s_xor_b32 s66, s97, 0x3a7400
	ds_read_b64_tr_b16 a[20:21], v3 offset:12288
	ds_read_b128 a[36:39], v56 offset:28672
	v_mfma_f32_16x16x32_bf16 v[136:139], a[4:7], a[88:91], v[136:139]
	buffer_load_dwordx4 v18, s[16:19], s66 offen offset:3072 lds
	v_mfma_f32_16x16x32_bf16 v[140:143], a[4:7], a[92:95], v[140:143]
	s_add_u32 m0, s64, 0x1000
	ds_read_b64_tr_b16 a[22:23], v3 offset:14336
	ds_read_b128 a[52:55], v56 offset:29696
	v_mfma_f32_16x16x32_bf16 v[140:143], a[0:3], a[76:79], v[140:143]
	s_waitcnt lgkmcnt(9)
	v_mfma_f32_16x16x32_bf16 v[156:159], a[8:11], a[76:79], v[156:159]
	s_waitcnt lgkmcnt(8)
	s_xor_b32 s66, s97, 0x3c0000
	ds_read_b128 a[40:43], v56 offset:45056
	v_mfma_f32_16x16x32_bf16 v[156:159], a[12:15], a[92:95], v[156:159]
	buffer_load_dwordx4 v18, s[16:19], s66 offen offset:0 lds
	v_mfma_f32_16x16x32_bf16 v[152:155], a[12:15], a[88:91], v[152:155]
	ds_read_b64_tr_b16 a[24:25], v4 offset:8192
	ds_read_b128 a[56:59], v56 offset:46080
	v_mfma_f32_16x16x32_bf16 v[152:155], a[8:11], a[72:75], v[152:155]
	ds_read_b64_tr_b16 a[26:27], v4 offset:10240
	v_mfma_f32_16x16x32_bf16 v[148:151], a[8:11], a[68:71], v[148:151]
	s_xor_b32 s66, s97, 0x3dfc00
	ds_read_b64_tr_b16 a[28:29], v4 offset:12288
	ds_read_b128 a[44:47], v56 offset:61440
	v_mfma_f32_16x16x32_bf16 v[148:151], a[12:15], a[84:87], v[148:151]
	buffer_load_dwordx4 v18, s[16:19], s66 offen offset:1024 lds
	v_mfma_f32_16x16x32_bf16 v[144:147], a[12:15], a[80:83], v[144:147]
	ds_read_b64_tr_b16 a[30:31], v4 offset:14336
	ds_read_b128 a[60:63], v56 offset:62464
	v_mfma_f32_16x16x32_bf16 v[144:147], a[8:11], a[64:67], v[144:147]
	s_waitcnt lgkmcnt(10)
	v_mfma_f32_16x16x32_bf16 v[160:163], a[16:19], a[64:67], v[160:163]
	s_waitcnt lgkmcnt(8)
	s_xor_b32 s66, s97, 0x3c7800
	v_mfma_f32_16x16x32_bf16 v[160:163], a[20:23], a[80:83], v[160:163]
	buffer_load_dwordx4 v18, s[16:19], s66 offen offset:2048 lds
	v_mfma_f32_16x16x32_bf16 v[164:167], a[20:23], a[84:87], v[164:167]
	s_waitcnt vmcnt(11)
	ds_read_b64_tr_b16 a[0:1], v1 offset:16384
	v_mfma_f32_16x16x32_bf16 v[164:167], a[16:19], a[68:71], v[164:167]
	ds_read_b64_tr_b16 a[2:3], v1 offset:18432
	v_mfma_f32_16x16x32_bf16 v[168:171], a[16:19], a[72:75], v[168:171]
	s_waitcnt vmcnt(7)
	s_xor_b32 s66, s97, 0x3e7400
	ds_read_b64_tr_b16 a[4:5], v1 offset:20480
	v_mfma_f32_16x16x32_bf16 v[168:171], a[20:23], a[88:91], v[168:171]
	buffer_load_dwordx4 v18, s[16:19], s66 offen offset:3072 lds
	v_mfma_f32_16x16x32_bf16 v[172:175], a[20:23], a[92:95], v[172:175]
	s_add_u32 m0, s64, 0x2000
	ds_read_b64_tr_b16 a[6:7], v1 offset:22528
	v_mfma_f32_16x16x32_bf16 v[172:175], a[16:19], a[76:79], v[172:175]
	s_waitcnt lgkmcnt(6)
	v_mfma_f32_16x16x32_bf16 v[188:191], a[24:27], a[76:79], v[188:191]
	s_waitcnt lgkmcnt(4)
	s_xor_b32 s66, s97, 0x280080
	v_mfma_f32_16x16x32_bf16 v[188:191], a[28:31], a[92:95], v[188:191]
	buffer_load_dwordx4 v18, s[16:19], s66 offen offset:0 lds
	v_mfma_f32_16x16x32_bf16 v[184:187], a[28:31], a[88:91], v[184:187]
	ds_read_b64_tr_b16 a[8:9], v2 offset:16384
	v_mfma_f32_16x16x32_bf16 v[184:187], a[24:27], a[72:75], v[184:187]
	ds_read_b64_tr_b16 a[10:11], v2 offset:18432
	v_mfma_f32_16x16x32_bf16 v[180:183], a[24:27], a[68:71], v[180:183]
	s_xor_b32 s66, s97, 0x29fc80
	ds_read_b64_tr_b16 a[12:13], v2 offset:20480
	v_mfma_f32_16x16x32_bf16 v[180:183], a[28:31], a[84:87], v[180:183]
	buffer_load_dwordx4 v18, s[16:19], s66 offen offset:1024 lds
	v_mfma_f32_16x16x32_bf16 v[176:179], a[28:31], a[80:83], v[176:179]
	ds_read_b64_tr_b16 a[14:15], v2 offset:22528
	v_mfma_f32_16x16x32_bf16 v[176:179], a[24:27], a[64:67], v[176:179]
	s_waitcnt lgkmcnt(5)
	v_mfma_f32_16x16x32_bf16 v[128:131], a[0:3], a[32:35], v[128:131]
	s_waitcnt lgkmcnt(4)
	s_xor_b32 s66, s97, 0x287880
	ds_read_b128 a[64:67], v56 offset:14336
	v_mfma_f32_16x16x32_bf16 v[128:131], a[4:7], a[48:51], v[128:131]
	buffer_load_dwordx4 v18, s[16:19], s66 offen offset:2048 lds
	v_mfma_f32_16x16x32_bf16 v[132:135], a[4:7], a[52:55], v[132:135]
	ds_read_b64_tr_b16 a[16:17], v3 offset:16384
	ds_read_b128 a[80:83], v56 offset:15360
	v_mfma_f32_16x16x32_bf16 v[132:135], a[0:3], a[36:39], v[132:135]
	ds_read_b64_tr_b16 a[18:19], v3 offset:18432
	v_mfma_f32_16x16x32_bf16 v[136:139], a[0:3], a[40:43], v[136:139]
	s_xor_b32 s66, s97, 0x2a7480
	ds_read_b64_tr_b16 a[20:21], v3 offset:20480
	ds_read_b128 a[68:71], v56 offset:30720
	v_mfma_f32_16x16x32_bf16 v[136:139], a[4:7], a[56:59], v[136:139]
	buffer_load_dwordx4 v18, s[16:19], s66 offen offset:3072 lds
	v_mfma_f32_16x16x32_bf16 v[140:143], a[4:7], a[60:63], v[140:143]
	s_add_u32 m0, s64, 0x3000
	ds_read_b64_tr_b16 a[22:23], v3 offset:22528
	ds_read_b128 a[84:87], v56 offset:31744
	v_mfma_f32_16x16x32_bf16 v[140:143], a[0:3], a[44:47], v[140:143]
	s_waitcnt lgkmcnt(9)
	v_mfma_f32_16x16x32_bf16 v[156:159], a[8:11], a[44:47], v[156:159]
	s_waitcnt lgkmcnt(8)
	s_xor_b32 s66, s97, 0x2c0080
	ds_read_b128 a[72:75], v56 offset:47104
	v_mfma_f32_16x16x32_bf16 v[156:159], a[12:15], a[60:63], v[156:159]
	buffer_load_dwordx4 v18, s[16:19], s66 offen offset:0 lds
	v_mfma_f32_16x16x32_bf16 v[152:155], a[12:15], a[56:59], v[152:155]
	ds_read_b64_tr_b16 a[24:25], v4 offset:16384
	ds_read_b128 a[88:91], v56 offset:48128
	v_mfma_f32_16x16x32_bf16 v[152:155], a[8:11], a[40:43], v[152:155]
	ds_read_b64_tr_b16 a[26:27], v4 offset:18432
	v_mfma_f32_16x16x32_bf16 v[148:151], a[8:11], a[36:39], v[148:151]
	s_xor_b32 s66, s97, 0x2dfc80
	ds_read_b64_tr_b16 a[28:29], v4 offset:20480
	ds_read_b128 a[76:79], v56 offset:63488
	v_mfma_f32_16x16x32_bf16 v[148:151], a[12:15], a[52:55], v[148:151]
	buffer_load_dwordx4 v18, s[16:19], s66 offen offset:1024 lds
	v_mfma_f32_16x16x32_bf16 v[144:147], a[12:15], a[48:51], v[144:147]
	ds_read_b64_tr_b16 a[30:31], v4 offset:22528
	ds_read_b128 a[92:95], v56 offset:64512
	v_mfma_f32_16x16x32_bf16 v[144:147], a[8:11], a[32:35], v[144:147]
	s_waitcnt lgkmcnt(10)
	v_mfma_f32_16x16x32_bf16 v[160:163], a[16:19], a[32:35], v[160:163]
	s_waitcnt lgkmcnt(8)
	s_xor_b32 s66, s97, 0x2c7880
	v_mfma_f32_16x16x32_bf16 v[160:163], a[20:23], a[48:51], v[160:163]
	buffer_load_dwordx4 v18, s[16:19], s66 offen offset:2048 lds
	v_mfma_f32_16x16x32_bf16 v[164:167], a[20:23], a[52:55], v[164:167]
	s_waitcnt vmcnt(11)
	ds_read_b64_tr_b16 a[0:1], v1 offset:0
	v_mfma_f32_16x16x32_bf16 v[164:167], a[16:19], a[36:39], v[164:167]
	ds_read_b64_tr_b16 a[2:3], v1 offset:2048
	v_mfma_f32_16x16x32_bf16 v[168:171], a[16:19], a[40:43], v[168:171]
	s_waitcnt vmcnt(7)
	s_xor_b32 s66, s97, 0x2e7480
	ds_read_b64_tr_b16 a[4:5], v1 offset:4096
	v_mfma_f32_16x16x32_bf16 v[168:171], a[20:23], a[56:59], v[168:171]
	buffer_load_dwordx4 v18, s[16:19], s66 offen offset:3072 lds
	v_mfma_f32_16x16x32_bf16 v[172:175], a[20:23], a[60:63], v[172:175]
	s_add_u32 m0, s64, 0x4000
	ds_read_b64_tr_b16 a[6:7], v1 offset:6144
	v_mfma_f32_16x16x32_bf16 v[172:175], a[16:19], a[44:47], v[172:175]
	s_waitcnt lgkmcnt(6)
	v_mfma_f32_16x16x32_bf16 v[188:191], a[24:27], a[44:47], v[188:191]
	s_waitcnt lgkmcnt(4)
	s_xor_b32 s66, s97, 0x300080
	v_mfma_f32_16x16x32_bf16 v[188:191], a[28:31], a[60:63], v[188:191]
	buffer_load_dwordx4 v18, s[16:19], s66 offen offset:0 lds
	v_mfma_f32_16x16x32_bf16 v[184:187], a[28:31], a[56:59], v[184:187]
	ds_read_b64_tr_b16 a[8:9], v2 offset:0
	v_mfma_f32_16x16x32_bf16 v[184:187], a[24:27], a[40:43], v[184:187]
	ds_read_b64_tr_b16 a[10:11], v2 offset:2048
	v_mfma_f32_16x16x32_bf16 v[180:183], a[24:27], a[36:39], v[180:183]
	s_xor_b32 s66, s97, 0x31fc80
	ds_read_b64_tr_b16 a[12:13], v2 offset:4096
	v_mfma_f32_16x16x32_bf16 v[180:183], a[28:31], a[52:55], v[180:183]
	buffer_load_dwordx4 v18, s[16:19], s66 offen offset:1024 lds
	v_mfma_f32_16x16x32_bf16 v[176:179], a[28:31], a[48:51], v[176:179]
	ds_read_b64_tr_b16 a[14:15], v2 offset:6144
	v_mfma_f32_16x16x32_bf16 v[176:179], a[24:27], a[32:35], v[176:179]
	s_waitcnt lgkmcnt(5)
	v_mfma_f32_16x16x32_bf16 v[128:131], a[0:3], a[64:67], v[128:131]
	s_waitcnt lgkmcnt(4)
	s_xor_b32 s66, s97, 0x307880
	ds_read_b128 a[32:35], v56 offset:10240
	v_mfma_f32_16x16x32_bf16 v[128:131], a[4:7], a[80:83], v[128:131]
	buffer_load_dwordx4 v18, s[16:19], s66 offen offset:2048 lds
	v_mfma_f32_16x16x32_bf16 v[132:135], a[4:7], a[84:87], v[132:135]
	ds_read_b64_tr_b16 a[16:17], v3 offset:0
	ds_read_b128 a[48:51], v56 offset:11264
	v_mfma_f32_16x16x32_bf16 v[132:135], a[0:3], a[68:71], v[132:135]
	ds_read_b64_tr_b16 a[18:19], v3 offset:2048
	v_mfma_f32_16x16x32_bf16 v[136:139], a[0:3], a[72:75], v[136:139]
	s_xor_b32 s66, s97, 0x327480
	ds_read_b64_tr_b16 a[20:21], v3 offset:4096
	ds_read_b128 a[36:39], v56 offset:26624
	v_mfma_f32_16x16x32_bf16 v[136:139], a[4:7], a[88:91], v[136:139]
	buffer_load_dwordx4 v18, s[16:19], s66 offen offset:3072 lds
	v_mfma_f32_16x16x32_bf16 v[140:143], a[4:7], a[92:95], v[140:143]
	s_add_u32 m0, s64, 0x5000
	ds_read_b64_tr_b16 a[22:23], v3 offset:6144
	ds_read_b128 a[52:55], v56 offset:27648
	v_mfma_f32_16x16x32_bf16 v[140:143], a[0:3], a[76:79], v[140:143]
	s_waitcnt lgkmcnt(9)
	v_mfma_f32_16x16x32_bf16 v[156:159], a[8:11], a[76:79], v[156:159]
	s_waitcnt lgkmcnt(8)
	s_xor_b32 s66, s97, 0x340080
	ds_read_b128 a[40:43], v56 offset:43008
	v_mfma_f32_16x16x32_bf16 v[156:159], a[12:15], a[92:95], v[156:159]
	buffer_load_dwordx4 v18, s[16:19], s66 offen offset:0 lds
	v_mfma_f32_16x16x32_bf16 v[152:155], a[12:15], a[88:91], v[152:155]
	ds_read_b64_tr_b16 a[24:25], v4 offset:0
	ds_read_b128 a[56:59], v56 offset:44032
	v_mfma_f32_16x16x32_bf16 v[152:155], a[8:11], a[72:75], v[152:155]
	ds_read_b64_tr_b16 a[26:27], v4 offset:2048
	v_mfma_f32_16x16x32_bf16 v[148:151], a[8:11], a[68:71], v[148:151]
	s_xor_b32 s66, s97, 0x35fc80
	ds_read_b64_tr_b16 a[28:29], v4 offset:4096
	ds_read_b128 a[44:47], v56 offset:59392
	v_mfma_f32_16x16x32_bf16 v[148:151], a[12:15], a[84:87], v[148:151]
	buffer_load_dwordx4 v18, s[16:19], s66 offen offset:1024 lds
	v_mfma_f32_16x16x32_bf16 v[144:147], a[12:15], a[80:83], v[144:147]
	ds_read_b64_tr_b16 a[30:31], v4 offset:6144
	ds_read_b128 a[60:63], v56 offset:60416
	v_mfma_f32_16x16x32_bf16 v[144:147], a[8:11], a[64:67], v[144:147]
	s_waitcnt lgkmcnt(10)
	v_mfma_f32_16x16x32_bf16 v[160:163], a[16:19], a[64:67], v[160:163]
	s_waitcnt lgkmcnt(8)
	s_xor_b32 s66, s97, 0x347880
	v_mfma_f32_16x16x32_bf16 v[160:163], a[20:23], a[80:83], v[160:163]
	buffer_load_dwordx4 v18, s[16:19], s66 offen offset:2048 lds
	v_mfma_f32_16x16x32_bf16 v[164:167], a[20:23], a[84:87], v[164:167]
	s_waitcnt vmcnt(11)
	ds_read_b64_tr_b16 a[0:1], v1 offset:8192
	v_mfma_f32_16x16x32_bf16 v[164:167], a[16:19], a[68:71], v[164:167]
	ds_read_b64_tr_b16 a[2:3], v1 offset:10240
	v_mfma_f32_16x16x32_bf16 v[168:171], a[16:19], a[72:75], v[168:171]
L_pg3:
	s_cbranch_execz L_pg7
	s_waitcnt vmcnt(7)
	s_xor_b32 s66, s97, 0x367480
	ds_read_b64_tr_b16 a[4:5], v1 offset:12288
	v_mfma_f32_16x16x32_bf16 v[168:171], a[20:23], a[88:91], v[168:171]
	buffer_load_dwordx4 v18, s[16:19], s66 offen offset:3072 lds
	v_mfma_f32_16x16x32_bf16 v[172:175], a[20:23], a[92:95], v[172:175]
	s_add_u32 m0, s64, 0x0
	ds_read_b64_tr_b16 a[6:7], v1 offset:14336
	v_mfma_f32_16x16x32_bf16 v[172:175], a[16:19], a[76:79], v[172:175]
	s_waitcnt lgkmcnt(6)
	v_mfma_f32_16x16x32_bf16 v[188:191], a[24:27], a[76:79], v[188:191]
	s_waitcnt lgkmcnt(4)
	s_xor_b32 s66, s97, 0x380080
	v_mfma_f32_16x16x32_bf16 v[188:191], a[28:31], a[92:95], v[188:191]
	buffer_load_dwordx4 v18, s[16:19], s66 offen offset:0 lds
	v_mfma_f32_16x16x32_bf16 v[184:187], a[28:31], a[88:91], v[184:187]
	ds_read_b64_tr_b16 a[8:9], v2 offset:8192
	v_mfma_f32_16x16x32_bf16 v[184:187], a[24:27], a[72:75], v[184:187]
	ds_read_b64_tr_b16 a[10:11], v2 offset:10240
	v_mfma_f32_16x16x32_bf16 v[180:183], a[24:27], a[68:71], v[180:183]
	s_xor_b32 s66, s97, 0x39fc80
	ds_read_b64_tr_b16 a[12:13], v2 offset:12288
	v_mfma_f32_16x16x32_bf16 v[180:183], a[28:31], a[84:87], v[180:183]
	buffer_load_dwordx4 v18, s[16:19], s66 offen offset:1024 lds
	v_mfma_f32_16x16x32_bf16 v[176:179], a[28:31], a[80:83], v[176:179]
	ds_read_b64_tr_b16 a[14:15], v2 offset:14336
	v_mfma_f32_16x16x32_bf16 v[176:179], a[24:27], a[64:67], v[176:179]
	s_waitcnt lgkmcnt(5)
	v_mfma_f32_16x16x32_bf16 v[192:195], a[0:3], a[32:35], v[192:195]
	s_waitcnt lgkmcnt(4)
	s_xor_b32 s66, s97, 0x387880
	ds_read_b128 a[64:67], v56 offset:12288
	v_mfma_f32_16x16x32_bf16 v[192:195], a[4:7], a[48:51], v[192:195]
	buffer_load_dwordx4 v18, s[16:19], s66 offen offset:2048 lds
	v_mfma_f32_16x16x32_bf16 v[196:199], a[4:7], a[52:55], v[196:199]
	ds_read_b64_tr_b16 a[16:17], v3 offset:8192
	ds_read_b128 a[80:83], v56 offset:13312
	v_mfma_f32_16x16x32_bf16 v[196:199], a[0:3], a[36:39], v[196:199]
	ds_read_b64_tr_b16 a[18:19], v3 offset:10240
	v_cvt_pk_bf16_f32 v159, v158, v159
	v_mfma_f32_16x16x32_bf16 v[200:203], a[0:3], a[40:43], v[200:203]
	s_xor_b32 s66, s97, 0x3a7480
	ds_read_b64_tr_b16 a[20:21], v3 offset:12288
	ds_read_b128 a[68:71], v56 offset:28672
	v_mfma_f32_16x16x32_bf16 v[200:203], a[4:7], a[56:59], v[200:203]
	buffer_load_dwordx4 v18, s[16:19], s66 offen offset:3072 lds
	v_mfma_f32_16x16x32_bf16 v[204:207], a[4:7], a[60:63], v[204:207]
	s_add_u32 m0, s64, 0x1000
	ds_read_b64_tr_b16 a[22:23], v3 offset:14336
	ds_read_b128 a[84:87], v56 offset:29696
	v_mfma_f32_16x16x32_bf16 v[204:207], a[0:3], a[44:47], v[204:207]
	s_waitcnt lgkmcnt(9)
	v_cvt_pk_bf16_f32 v158, v156, v157
	v_cvt_pk_bf16_f32 v156, v140, v141
	v_mfma_f32_16x16x32_bf16 v[220:223], a[8:11], a[44:47], v[220:223]
	s_waitcnt lgkmcnt(8)
	s_xor_b32 s66, s97, 0x3c0080
	ds_read_b128 a[72:75], v56 offset:45056
	v_cvt_pk_bf16_f32 v157, v142, v143
	v_mfma_f32_16x16x32_bf16 v[220:223], a[12:15], a[60:63], v[220:223]
	buffer_load_dwordx4 v18, s[16:19], s66 offen offset:0 lds
	v_mfma_f32_16x16x32_bf16 v[216:219], a[12:15], a[56:59], v[216:219]
	ds_read_b64_tr_b16 a[24:25], v4 offset:8192
	ds_read_b128 a[88:91], v56 offset:46080
	v_mfma_f32_16x16x32_bf16 v[216:219], a[8:11], a[40:43], v[216:219]
	ds_read_b64_tr_b16 a[26:27], v4 offset:10240
	v_cvt_pk_bf16_f32 v155, v154, v155
	v_mfma_f32_16x16x32_bf16 v[212:215], a[8:11], a[36:39], v[212:215]
	s_xor_b32 s66, s97, 0x3dfc80
	ds_read_b64_tr_b16 a[28:29], v4 offset:12288
	ds_read_b128 a[76:79], v56 offset:61440
	v_mfma_f32_16x16x32_bf16 v[212:215], a[12:15], a[52:55], v[212:215]
	buffer_load_dwordx4 v18, s[16:19], s66 offen offset:1024 lds
	v_mfma_f32_16x16x32_bf16 v[208:211], a[12:15], a[48:51], v[208:211]
	ds_read_b64_tr_b16 a[30:31], v4 offset:14336
	ds_read_b128 a[92:95], v56 offset:62464
	v_mfma_f32_16x16x32_bf16 v[208:211], a[8:11], a[32:35], v[208:211]
	s_waitcnt lgkmcnt(10)
	v_cvt_pk_bf16_f32 v154, v152, v153
	v_cvt_pk_bf16_f32 v152, v136, v137
	v_mfma_f32_16x16x32_bf16 v[224:227], a[16:19], a[32:35], v[224:227]
	s_waitcnt lgkmcnt(8)
	s_xor_b32 s66, s97, 0x3c7880
	v_cvt_pk_bf16_f32 v153, v138, v139
	v_cvt_pk_bf16_f32 v151, v150, v151
	v_mfma_f32_16x16x32_bf16 v[224:227], a[20:23], a[48:51], v[224:227]
	buffer_load_dwordx4 v18, s[16:19], s66 offen offset:2048 lds
	v_mfma_f32_16x16x32_bf16 v[228:231], a[20:23], a[52:55], v[228:231]
	s_waitcnt vmcnt(11)
	ds_read_b64_tr_b16 a[0:1], v1 offset:16384
	v_cvt_pk_bf16_f32 v150, v148, v149
	v_mfma_f32_16x16x32_bf16 v[228:231], a[16:19], a[36:39], v[228:231]
	ds_read_b64_tr_b16 a[2:3], v1 offset:18432
	v_cvt_pk_bf16_f32 v148, v132, v133
	v_mfma_f32_16x16x32_bf16 v[232:235], a[16:19], a[40:43], v[232:235]
	s_waitcnt vmcnt(7)
	s_xor_b32 s66, s97, 0x3e7480
	ds_read_b64_tr_b16 a[4:5], v1 offset:20480
	v_cvt_pk_bf16_f32 v149, v134, v135
	v_mfma_f32_16x16x32_bf16 v[232:235], a[20:23], a[56:59], v[232:235]
	buffer_load_dwordx4 v18, s[16:19], s66 offen offset:3072 lds
	v_mfma_f32_16x16x32_bf16 v[236:239], a[20:23], a[60:63], v[236:239]
	s_add_u32 m0, s64, 0x2000
	ds_read_b64_tr_b16 a[6:7], v1 offset:22528
	v_cvt_pk_bf16_f32 v147, v146, v147
	v_mfma_f32_16x16x32_bf16 v[236:239], a[16:19], a[44:47], v[236:239]
	s_waitcnt lgkmcnt(6)
	v_cvt_pk_bf16_f32 v146, v144, v145
	v_cvt_pk_bf16_f32 v144, v128, v129
	v_mfma_f32_16x16x32_bf16 v[252:255], a[24:27], a[44:47], v[252:255]
	s_waitcnt lgkmcnt(4)
	s_xor_b32 s66, s95, 0x0
	v_cvt_pk_bf16_f32 v145, v130, v131
	v_cvt_pk_bf16_f32 v191, v190, v191
	v_mfma_f32_16x16x32_bf16 v[252:255], a[28:31], a[60:63], v[252:255]
	buffer_load_dwordx4 v17, s[24:27], s66 offen offset:0 lds
	v_mfma_f32_16x16x32_bf16 v[248:251], a[28:31], a[56:59], v[248:251]
	ds_read_b64_tr_b16 a[8:9], v2 offset:16384
	v_cvt_pk_bf16_f32 v190, v188, v189
	v_mfma_f32_16x16x32_bf16 v[248:251], a[24:27], a[40:43], v[248:251]
	ds_read_b64_tr_b16 a[10:11], v2 offset:18432
	v_cvt_pk_bf16_f32 v188, v172, v173
	v_mfma_f32_16x16x32_bf16 v[244:247], a[24:27], a[36:39], v[244:247]
	s_xor_b32 s66, s95, 0x3c00
	ds_read_b64_tr_b16 a[12:13], v2 offset:20480
	v_cvt_pk_bf16_f32 v189, v174, v175
	v_mfma_f32_16x16x32_bf16 v[244:247], a[28:31], a[52:55], v[244:247]
	buffer_load_dwordx4 v17, s[24:27], s66 offen offset:1024 lds
	v_mfma_f32_16x16x32_bf16 v[240:243], a[28:31], a[48:51], v[240:243]
	ds_read_b64_tr_b16 a[14:15], v2 offset:22528
	v_cvt_pk_bf16_f32 v187, v186, v187
	v_mfma_f32_16x16x32_bf16 v[240:243], a[24:27], a[32:35], v[240:243]
	s_waitcnt lgkmcnt(5)
	v_cvt_pk_bf16_f32 v186, v184, v185
	v_cvt_pk_bf16_f32 v184, v168, v169
	v_mfma_f32_16x16x32_bf16 v[192:195], a[0:3], a[64:67], v[192:195]
	s_waitcnt lgkmcnt(4)
	s_xor_b32 s66, s95, 0x800
	ds_read_b128 a[32:35], v56 offset:14336
	v_lshrrev_b32 v26, 4, v0
	v_mfma_f32_16x16x32_bf16 v[192:195], a[4:7], a[80:83], v[192:195]
	buffer_load_dwordx4 v17, s[24:27], s66 offen offset:2048 lds
	v_mfma_f32_16x16x32_bf16 v[196:199], a[4:7], a[84:87], v[196:199]
	ds_read_b64_tr_b16 a[16:17], v3 offset:16384
	ds_read_b128 a[48:51], v56 offset:15360
	v_mfma_f32_16x16x32_bf16 v[196:199], a[0:3], a[68:71], v[196:199]
	ds_read_b64_tr_b16 a[18:19], v3 offset:18432
	v_and_b32 v27, 15, v0
	v_mfma_f32_16x16x32_bf16 v[200:203], a[0:3], a[72:75], v[200:203]
	s_xor_b32 s66, s95, 0x4400
	ds_read_b64_tr_b16 a[20:21], v3 offset:20480
	ds_read_b128 a[36:39], v56 offset:30720
	v_mfma_f32_16x16x32_bf16 v[200:203], a[4:7], a[88:91], v[200:203]
	buffer_load_dwordx4 v17, s[24:27], s66 offen offset:3072 lds
	v_mfma_f32_16x16x32_bf16 v[204:207], a[4:7], a[92:95], v[204:207]
	s_add_u32 m0, s64, 0x3000
	ds_read_b64_tr_b16 a[22:23], v3 offset:22528
	ds_read_b128 a[52:55], v56 offset:31744
	v_mfma_f32_16x16x32_bf16 v[204:207], a[0:3], a[76:79], v[204:207]
	s_waitcnt lgkmcnt(9)
	v_lshl_add_u32 v28, v26, 8, s65
	v_bfe_u32 v29, v28, 8, 4
	v_mfma_f32_16x16x32_bf16 v[220:223], a[8:11], a[76:79], v[220:223]
	s_waitcnt lgkmcnt(8)
	s_xor_b32 s66, s95, 0x8000
	ds_read_b128 a[40:43], v56 offset:47104
	v_xor_b32 v29, v29, v27
	v_mfma_f32_16x16x32_bf16 v[220:223], a[12:15], a[92:95], v[220:223]
	buffer_load_dwordx4 v17, s[24:27], s66 offen offset:0 lds
	v_mfma_f32_16x16x32_bf16 v[216:219], a[12:15], a[88:91], v[216:219]
	ds_read_b64_tr_b16 a[24:25], v4 offset:16384
	ds_read_b128 a[56:59], v56 offset:48128
	v_mfma_f32_16x16x32_bf16 v[216:219], a[8:11], a[72:75], v[216:219]
	ds_read_b64_tr_b16 a[26:27], v4 offset:18432
	v_lshl_add_u32 v18, v29, 4, v28
	v_mfma_f32_16x16x32_bf16 v[212:215], a[8:11], a[68:71], v[212:215]
	s_xor_b32 s66, s95, 0xbc00
	ds_read_b64_tr_b16 a[28:29], v4 offset:20480
	ds_read_b128 a[44:47], v56 offset:63488
	v_mfma_f32_16x16x32_bf16 v[212:215], a[12:15], a[84:87], v[212:215]
	buffer_load_dwordx4 v17, s[24:27], s66 offen offset:1024 lds
	v_mfma_f32_16x16x32_bf16 v[208:211], a[12:15], a[80:83], v[208:211]
	ds_read_b64_tr_b16 a[30:31], v4 offset:22528
	ds_read_b128 a[60:63], v56 offset:64512
	v_mfma_f32_16x16x32_bf16 v[208:211], a[8:11], a[64:67], v[208:211]
	s_waitcnt lgkmcnt(10)
	v_xor_b32 v19, 64, v18
	v_lshlrev_b32 v29, 1, v26
	v_mfma_f32_16x16x32_bf16 v[224:227], a[16:19], a[64:67], v[224:227]
	s_waitcnt lgkmcnt(8)
	s_xor_b32 s66, s95, 0x8800
	v_xor_b32 v29, v29, v27
	v_lshl_add_u32 v20, v29, 4, v28
	v_mfma_f32_16x16x32_bf16 v[224:227], a[20:23], a[80:83], v[224:227]
	buffer_load_dwordx4 v17, s[24:27], s66 offen offset:2048 lds
	v_mfma_f32_16x16x32_bf16 v[228:231], a[20:23], a[84:87], v[228:231]
	s_waitcnt vmcnt(11)
	ds_read_b64_tr_b16 a[0:1], v1 offset:0
	v_xor_b32 v21, 0x80, v20
	v_mfma_f32_16x16x32_bf16 v[228:231], a[16:19], a[68:71], v[228:231]
	ds_read_b64_tr_b16 a[2:3], v1 offset:2048
	v_cvt_pk_bf16_f32 v185, v170, v171
	v_mfma_f32_16x16x32_bf16 v[232:235], a[16:19], a[72:75], v[232:235]
	s_waitcnt vmcnt(7)
	s_xor_b32 s66, s95, 0xc400
	ds_read_b64_tr_b16 a[4:5], v1 offset:4096
	v_cvt_pk_bf16_f32 v183, v182, v183
	v_mfma_f32_16x16x32_bf16 v[232:235], a[20:23], a[88:91], v[232:235]
	buffer_load_dwordx4 v17, s[24:27], s66 offen offset:3072 lds
	v_mfma_f32_16x16x32_bf16 v[236:239], a[20:23], a[92:95], v[236:239]
	s_add_u32 m0, s64, 0x4000
	ds_read_b64_tr_b16 a[6:7], v1 offset:6144
	v_cvt_pk_bf16_f32 v182, v180, v181
	v_mfma_f32_16x16x32_bf16 v[236:239], a[16:19], a[76:79], v[236:239]
	s_waitcnt lgkmcnt(6)
	v_cvt_pk_bf16_f32 v180, v164, v165
	v_cvt_pk_bf16_f32 v181, v166, v167
	v_mfma_f32_16x16x32_bf16 v[252:255], a[24:27], a[76:79], v[252:255]
	s_waitcnt lgkmcnt(4)
	s_xor_b32 s66, s95, 0x10000
	v_cvt_pk_bf16_f32 v179, v178, v179
	v_cvt_pk_bf16_f32 v178, v176, v177
	v_mfma_f32_16x16x32_bf16 v[252:255], a[28:31], a[92:95], v[252:255]
	buffer_load_dwordx4 v17, s[24:27], s66 offen offset:0 lds
	v_mfma_f32_16x16x32_bf16 v[248:251], a[28:31], a[88:91], v[248:251]
	ds_read_b64_tr_b16 a[8:9], v2 offset:0
	v_cvt_pk_bf16_f32 v176, v160, v161
	v_mfma_f32_16x16x32_bf16 v[248:251], a[24:27], a[72:75], v[248:251]
	ds_read_b64_tr_b16 a[10:11], v2 offset:2048
	v_cvt_pk_bf16_f32 v177, v162, v163
	v_mfma_f32_16x16x32_bf16 v[244:247], a[24:27], a[68:71], v[244:247]
	s_xor_b32 s66, s95, 0x13c00
	ds_read_b64_tr_b16 a[12:13], v2 offset:4096
	v_mfma_f32_16x16x32_bf16 v[244:247], a[28:31], a[84:87], v[244:247]
	buffer_load_dwordx4 v17, s[24:27], s66 offen offset:1024 lds
	v_mfma_f32_16x16x32_bf16 v[240:243], a[28:31], a[80:83], v[240:243]
	ds_read_b64_tr_b16 a[14:15], v2 offset:6144
	v_mfma_f32_16x16x32_bf16 v[240:243], a[24:27], a[64:67], v[240:243]
	s_waitcnt lgkmcnt(5)
	v_permlane32_swap_b32 v156, v158
	v_mfma_f32_16x16x32_bf16 v[192:195], a[0:3], a[32:35], v[192:195]
	s_waitcnt lgkmcnt(4)
	s_xor_b32 s66, s95, 0x10800
	v_permlane32_swap_b32 v157, v159
	v_mfma_f32_16x16x32_bf16 v[192:195], a[4:7], a[48:51], v[192:195]
	buffer_load_dwordx4 v17, s[24:27], s66 offen offset:2048 lds
	v_mfma_f32_16x16x32_bf16 v[196:199], a[4:7], a[52:55], v[196:199]
	ds_read_b64_tr_b16 a[16:17], v3 offset:0
	v_mfma_f32_16x16x32_bf16 v[196:199], a[0:3], a[36:39], v[196:199]
	ds_read_b64_tr_b16 a[18:19], v3 offset:2048
	v_mfma_f32_16x16x32_bf16 v[200:203], a[0:3], a[40:43], v[200:203]
	s_xor_b32 s66, s95, 0x14400
	ds_read_b64_tr_b16 a[20:21], v3 offset:4096
	v_mfma_f32_16x16x32_bf16 v[200:203], a[4:7], a[56:59], v[200:203]
	buffer_load_dwordx4 v17, s[24:27], s66 offen offset:3072 lds
	v_mfma_f32_16x16x32_bf16 v[204:207], a[4:7], a[60:63], v[204:207]
	s_add_u32 m0, s64, 0x5000
	ds_read_b64_tr_b16 a[22:23], v3 offset:6144
	v_mfma_f32_16x16x32_bf16 v[204:207], a[0:3], a[44:47], v[204:207]
	s_waitcnt lgkmcnt(5)
	v_permlane32_swap_b32 v152, v154
	v_mfma_f32_16x16x32_bf16 v[220:223], a[8:11], a[44:47], v[220:223]
	s_waitcnt lgkmcnt(4)
	s_xor_b32 s66, s95, 0x18000
	v_permlane32_swap_b32 v153, v155
	v_mfma_f32_16x16x32_bf16 v[220:223], a[12:15], a[60:63], v[220:223]
	buffer_load_dwordx4 v17, s[24:27], s66 offen offset:0 lds
	v_mfma_f32_16x16x32_bf16 v[216:219], a[12:15], a[56:59], v[216:219]
	ds_read_b64_tr_b16 a[24:25], v4 offset:0
	v_mfma_f32_16x16x32_bf16 v[216:219], a[8:11], a[40:43], v[216:219]
	ds_read_b64_tr_b16 a[26:27], v4 offset:2048
	v_mfma_f32_16x16x32_bf16 v[212:215], a[8:11], a[36:39], v[212:215]
	s_xor_b32 s66, s95, 0x1bc00
	ds_read_b64_tr_b16 a[28:29], v4 offset:4096
	v_mfma_f32_16x16x32_bf16 v[212:215], a[12:15], a[52:55], v[212:215]
	buffer_load_dwordx4 v17, s[24:27], s66 offen offset:1024 lds
	v_mfma_f32_16x16x32_bf16 v[208:211], a[12:15], a[48:51], v[208:211]
	ds_read_b64_tr_b16 a[30:31], v4 offset:6144
	v_mfma_f32_16x16x32_bf16 v[208:211], a[8:11], a[32:35], v[208:211]
	s_waitcnt lgkmcnt(5)
	v_permlane16_swap_b32 v156, v158
	v_mfma_f32_16x16x32_bf16 v[224:227], a[16:19], a[32:35], v[224:227]
	s_waitcnt lgkmcnt(4)
	s_xor_b32 s66, s95, 0x18800
	v_permlane16_swap_b32 v157, v159
	v_mfma_f32_16x16x32_bf16 v[224:227], a[20:23], a[48:51], v[224:227]
	buffer_load_dwordx4 v17, s[24:27], s66 offen offset:2048 lds
	v_mfma_f32_16x16x32_bf16 v[228:231], a[20:23], a[52:55], v[228:231]
	v_xor_b32 v1, 0x80, v5
	v_xor_b32 v2, 0x80, v6
	v_mfma_f32_16x16x32_bf16 v[228:231], a[16:19], a[36:39], v[228:231]
	v_xor_b32 v3, 0x80, v7
	v_xor_b32 v4, 0x80, v8
	v_mfma_f32_16x16x32_bf16 v[232:235], a[16:19], a[40:43], v[232:235]
	s_xor_b32 s66, s95, 0x1c400
	v_permlane16_swap_b32 v152, v154
	v_mfma_f32_16x16x32_bf16 v[232:235], a[20:23], a[56:59], v[232:235]
	buffer_load_dwordx4 v17, s[24:27], s66 offen offset:3072 lds
	v_mfma_f32_16x16x32_bf16 v[236:239], a[20:23], a[60:63], v[236:239]
	s_lshl_b32 s72, s60, 3
	v_permlane16_swap_b32 v153, v155
	v_mfma_f32_16x16x32_bf16 v[236:239], a[16:19], a[44:47], v[236:239]
	s_waitcnt lgkmcnt(1)
	s_mov_b32 s69, s68
	v_permlane32_swap_b32 v148, v150
	v_mfma_f32_16x16x32_bf16 v[252:255], a[24:27], a[44:47], v[252:255]
	s_waitcnt lgkmcnt(0)
	v_permlane32_swap_b32 v149, v151
	v_mfma_f32_16x16x32_bf16 v[252:255], a[28:31], a[60:63], v[252:255]
	v_permlane32_swap_b32 v144, v146
	v_mfma_f32_16x16x32_bf16 v[248:251], a[28:31], a[56:59], v[248:251]
	v_permlane32_swap_b32 v145, v147
	v_mfma_f32_16x16x32_bf16 v[248:251], a[24:27], a[40:43], v[248:251]
	v_permlane16_swap_b32 v148, v150
	v_mfma_f32_16x16x32_bf16 v[244:247], a[24:27], a[36:39], v[244:247]
	v_permlane16_swap_b32 v149, v151
	v_mfma_f32_16x16x32_bf16 v[244:247], a[28:31], a[52:55], v[244:247]
	v_permlane16_swap_b32 v144, v146
	v_mfma_f32_16x16x32_bf16 v[240:243], a[28:31], a[48:51], v[240:243]
	v_permlane16_swap_b32 v145, v147
	v_mfma_f32_16x16x32_bf16 v[240:243], a[24:27], a[32:35], v[240:243]
	v_permlane32_swap_b32 v188, v190
	s_barrier
	s_add_u32 m0, s65, 0x0
	s_nop 0
	buffer_load_dwordx4 v18, s[8:11], s68 offen lds
	v_permlane32_swap_b32 v189, v191
	v_permlane32_swap_b32 v184, v186
	v_permlane32_swap_b32 v185, v187
	v_permlane16_swap_b32 v188, v190
	buffer_load_dwordx4 v19, s[8:11], s68 offen offset:1024 lds
	s_add_u32 s68, s68, 0x2000
	s_and_b32 s68, s68, 0x7ffff
	v_permlane16_swap_b32 v189, v191
	v_permlane16_swap_b32 v184, v186
	v_permlane16_swap_b32 v185, v187
	v_permlane32_swap_b32 v180, v182
	s_add_u32 m0, s65, 0x2000
	s_nop 0
	buffer_load_dwordx4 v18, s[8:11], s68 offen lds
	v_permlane32_swap_b32 v181, v183
	v_permlane32_swap_b32 v176, v178
	v_permlane32_swap_b32 v177, v179
	v_permlane16_swap_b32 v180, v182
	buffer_load_dwordx4 v19, s[8:11], s68 offen offset:1024 lds
	s_add_u32 s68, s68, 0x2000
	s_and_b32 s68, s68, 0x7ffff
	v_permlane16_swap_b32 v181, v183
	v_permlane16_swap_b32 v176, v178
	v_permlane16_swap_b32 v177, v179
	v_cvt_pk_bf16_f32 v223, v222, v223
	s_add_u32 m0, s65, 0x8000
	s_nop 0
	buffer_load_dwordx4 v20, s[12:15], s69 offen lds
	s_nop 0
	v_cvt_pk_bf16_f32 v222, v220, v221
	v_cvt_pk_bf16_f32 v220, v204, v205
	v_cvt_pk_bf16_f32 v221, v206, v207
	v_cvt_pk_bf16_f32 v219, v218, v219
	buffer_load_dwordx4 v21, s[12:15], s69 offen offset:1024 lds
	s_add_u32 s69, s69, 0x2000
	s_and_b32 s69, s69, 0x7ffff
	v_cvt_pk_bf16_f32 v218, v216, v217
	v_cvt_pk_bf16_f32 v216, v200, v201
	v_cvt_pk_bf16_f32 v217, v202, v203
	v_permlane32_swap_b32 v220, v222
	s_add_u32 m0, s65, 0xa000
	s_nop 0
	buffer_load_dwordx4 v20, s[12:15], s69 offen lds
	v_permlane32_swap_b32 v221, v223
	v_permlane32_swap_b32 v216, v218
	v_permlane32_swap_b32 v217, v219
	v_permlane16_swap_b32 v220, v222
	buffer_load_dwordx4 v21, s[12:15], s69 offen offset:1024 lds
	s_add_u32 s69, s69, 0x2000
	s_and_b32 s69, s69, 0x7ffff
	v_permlane16_swap_b32 v221, v223
	v_permlane16_swap_b32 v216, v218
	v_permlane16_swap_b32 v217, v219
	s_nop 0
	v_cvt_pk_bf16_f32 v215, v214, v215
	buffer_atomic_add v23, v24, s[44:47], s72 offen sc1
	v_cvt_pk_bf16_f32 v214, v212, v213
	v_cvt_pk_bf16_f32 v212, v196, v197
	v_cvt_pk_bf16_f32 v213, v198, v199
	v_cvt_pk_bf16_f32 v211, v210, v211
	v_cvt_pk_bf16_f32 v210, v208, v209
	v_cvt_pk_bf16_f32 v208, v192, v193
	v_cvt_pk_bf16_f32 v209, v194, v195
	v_permlane32_swap_b32 v212, v214
	v_permlane32_swap_b32 v213, v215
	v_permlane32_swap_b32 v208, v210
	v_permlane32_swap_b32 v209, v211
	v_permlane16_swap_b32 v212, v214
	v_permlane16_swap_b32 v213, v215
	v_permlane16_swap_b32 v208, v210
	v_permlane16_swap_b32 v209, v211
	v_cvt_pk_bf16_f32 v255, v254, v255
	v_cvt_pk_bf16_f32 v254, v252, v253
	v_cvt_pk_bf16_f32 v252, v236, v237
	v_cvt_pk_bf16_f32 v253, v238, v239
	v_cvt_pk_bf16_f32 v251, v250, v251
	v_cvt_pk_bf16_f32 v250, v248, v249
	v_cvt_pk_bf16_f32 v248, v232, v233
	v_cvt_pk_bf16_f32 v249, v234, v235
	v_permlane32_swap_b32 v252, v254
	v_permlane32_swap_b32 v253, v255
	v_permlane32_swap_b32 v248, v250
	v_permlane32_swap_b32 v249, v251
	v_permlane16_swap_b32 v252, v254
	v_permlane16_swap_b32 v253, v255
	v_permlane16_swap_b32 v248, v250
	v_permlane16_swap_b32 v249, v251
	v_cvt_pk_bf16_f32 v247, v246, v247
	v_cvt_pk_bf16_f32 v246, v244, v245
	v_cvt_pk_bf16_f32 v244, v228, v229
	v_cvt_pk_bf16_f32 v245, v230, v231
	v_cvt_pk_bf16_f32 v243, v242, v243
	v_cvt_pk_bf16_f32 v242, v240, v241
	v_cvt_pk_bf16_f32 v240, v224, v225
	v_cvt_pk_bf16_f32 v241, v226, v227
	v_permlane32_swap_b32 v244, v246
	v_permlane32_swap_b32 v245, v247
	v_permlane32_swap_b32 v240, v242
	v_permlane32_swap_b32 v241, v243
	v_permlane16_swap_b32 v244, v246
	v_permlane16_swap_b32 v245, v247
	v_permlane16_swap_b32 v240, v242
	v_permlane16_swap_b32 v241, v243
	s_waitcnt vmcnt(9)
	s_barrier
	ds_read_b64_tr_b16 a[0:1], v60 offset:0
	ds_read_b64_tr_b16 a[2:3], v60 offset:2048
	ds_read_b64_tr_b16 a[4:5], v60 offset:4096
	ds_read_b64_tr_b16 a[6:7], v60 offset:6144
	ds_read_b64_tr_b16 a[8:9], v60 offset:8192
	ds_read_b64_tr_b16 a[10:11], v60 offset:10240
	ds_read_b64_tr_b16 a[12:13], v60 offset:12288
	ds_read_b64_tr_b16 a[14:15], v60 offset:14336
	ds_read_b64_tr_b16 a[16:17], v60 offset:24576
	ds_read_b64_tr_b16 a[18:19], v60 offset:26624
	ds_read_b64_tr_b16 a[20:21], v60 offset:28672
	ds_read_b64_tr_b16 a[22:23], v60 offset:30720
	s_waitcnt lgkmcnt(10)
	v_mfma_f32_16x16x32_bf16 v[32:35], a[0:3], v[64:67], 0
	s_waitcnt lgkmcnt(8)
	ds_read_b64_tr_b16 a[24:25], v60 offset:32768
	ds_read_b64_tr_b16 a[26:27], v60 offset:34816
	v_accvgpr_write_b32 a240, v156
	v_mfma_f32_16x16x32_bf16 v[32:35], a[4:7], v[68:71], v[32:35]
	ds_read_b64_tr_b16 a[28:29], v60 offset:36864
	ds_read_b64_tr_b16 a[30:31], v60 offset:38912
	v_add_u32 v60, 0xc000, v60
	v_accvgpr_write_b32 a241, v157
	s_waitcnt lgkmcnt(10)
	v_mfma_f32_16x16x32_bf16 v[32:35], a[8:11], v[72:75], v[32:35]
	s_waitcnt lgkmcnt(8)
	ds_read_b64_tr_b16 a[0:1], v60 offset:0
	ds_read_b64_tr_b16 a[2:3], v60 offset:2048
	v_accvgpr_write_b32 a242, v158
	v_mfma_f32_16x16x32_bf16 v[32:35], a[12:15], v[76:79], v[32:35]
	s_waitcnt lgkmcnt(8)
	ds_read_b64_tr_b16 a[4:5], v60 offset:4096
	ds_read_b64_tr_b16 a[6:7], v60 offset:6144
	v_accvgpr_write_b32 a243, v159
	v_mfma_f32_16x16x32_bf16 v[32:35], a[16:19], v[80:83], v[32:35]
	s_waitcnt lgkmcnt(8)
	ds_read_b64_tr_b16 a[8:9], v60 offset:8192
	ds_read_b64_tr_b16 a[10:11], v60 offset:10240
	v_accvgpr_write_b32 a224, v152
	v_mfma_f32_16x16x32_bf16 v[32:35], a[20:23], v[84:87], v[32:35]
	s_waitcnt lgkmcnt(8)
	ds_read_b64_tr_b16 a[12:13], v60 offset:12288
	ds_read_b64_tr_b16 a[14:15], v60 offset:14336
	v_accvgpr_write_b32 a225, v153
	v_mfma_f32_16x16x32_bf16 v[32:35], a[24:27], v[88:91], v[32:35]
	s_waitcnt lgkmcnt(8)
	ds_read_b64_tr_b16 a[16:17], v60 offset:24576
	ds_read_b64_tr_b16 a[18:19], v60 offset:26624
	v_accvgpr_write_b32 a226, v154
	v_mfma_f32_16x16x32_bf16 v[32:35], a[28:31], v[92:95], v[32:35]
	s_waitcnt lgkmcnt(8)
	ds_read_b64_tr_b16 a[20:21], v60 offset:28672
	ds_read_b64_tr_b16 a[22:23], v60 offset:30720
	v_accvgpr_write_b32 a227, v155
	v_mfma_f32_16x16x32_bf16 v[32:35], a[0:3], v[96:99], v[32:35]
	s_waitcnt lgkmcnt(8)
	ds_read_b64_tr_b16 a[24:25], v60 offset:32768
	ds_read_b64_tr_b16 a[26:27], v60 offset:34816
	v_accvgpr_write_b32 a208, v148
	v_mfma_f32_16x16x32_bf16 v[32:35], a[4:7], v[100:103], v[32:35]
	s_waitcnt lgkmcnt(8)
	ds_read_b64_tr_b16 a[28:29], v60 offset:36864
	ds_read_b64_tr_b16 a[30:31], v60 offset:38912
	v_accvgpr_write_b32 a209, v149
	v_mfma_f32_16x16x32_bf16 v[32:35], a[8:11], v[104:107], v[32:35]
	s_waitcnt lgkmcnt(8)
	ds_read_b64_tr_b16 a[0:1], v61 offset:0
	ds_read_b64_tr_b16 a[2:3], v61 offset:2048
	v_accvgpr_write_b32 a210, v150
	v_mfma_f32_16x16x32_bf16 v[32:35], a[12:15], v[108:111], v[32:35]
	s_waitcnt lgkmcnt(8)
	ds_read_b64_tr_b16 a[4:5], v61 offset:4096
	ds_read_b64_tr_b16 a[6:7], v61 offset:6144
	v_accvgpr_write_b32 a211, v151
	v_mfma_f32_16x16x32_bf16 v[32:35], a[16:19], v[112:115], v[32:35]
	s_waitcnt lgkmcnt(8)
	ds_read_b64_tr_b16 a[8:9], v61 offset:8192
	ds_read_b64_tr_b16 a[10:11], v61 offset:10240
	v_accvgpr_write_b32 a192, v144
	v_mfma_f32_16x16x32_bf16 v[32:35], a[20:23], v[116:119], v[32:35]
	s_waitcnt lgkmcnt(8)
	ds_read_b64_tr_b16 a[12:13], v61 offset:12288
	ds_read_b64_tr_b16 a[14:15], v61 offset:14336
	v_accvgpr_write_b32 a193, v145
	v_mfma_f32_16x16x32_bf16 v[32:35], a[24:27], v[120:123], v[32:35]
	s_waitcnt lgkmcnt(8)
	ds_read_b64_tr_b16 a[16:17], v61 offset:24576
	ds_read_b64_tr_b16 a[18:19], v61 offset:26624
	v_accvgpr_write_b32 a194, v146
	v_mfma_f32_16x16x32_bf16 v[32:35], a[28:31], v[124:127], v[32:35]
	s_waitcnt lgkmcnt(8)
	ds_read_b64_tr_b16 a[20:21], v61 offset:28672
	ds_read_b64_tr_b16 a[22:23], v61 offset:30720
	v_accvgpr_write_b32 a195, v147
	v_mfma_f32_16x16x32_bf16 v[36:39], a[0:3], v[64:67], 0
	s_waitcnt lgkmcnt(8)
	ds_read_b64_tr_b16 a[24:25], v61 offset:32768
	ds_read_b64_tr_b16 a[26:27], v61 offset:34816
	v_accvgpr_write_b32 a244, v188
	v_mfma_f32_16x16x32_bf16 v[36:39], a[4:7], v[68:71], v[36:39]
	ds_read_b64_tr_b16 a[28:29], v61 offset:36864
	ds_read_b64_tr_b16 a[30:31], v61 offset:38912
	v_add_u32 v61, 0xc000, v61
	v_accvgpr_write_b32 a245, v189
	s_waitcnt lgkmcnt(10)
	v_mfma_f32_16x16x32_bf16 v[36:39], a[8:11], v[72:75], v[36:39]
	s_waitcnt lgkmcnt(8)
	ds_read_b64_tr_b16 a[0:1], v61 offset:0
	ds_read_b64_tr_b16 a[2:3], v61 offset:2048
	v_accvgpr_write_b32 a246, v190
	v_mfma_f32_16x16x32_bf16 v[36:39], a[12:15], v[76:79], v[36:39]
	s_waitcnt lgkmcnt(8)
	ds_read_b64_tr_b16 a[4:5], v61 offset:4096
	ds_read_b64_tr_b16 a[6:7], v61 offset:6144
	v_accvgpr_write_b32 a247, v191
	v_mfma_f32_16x16x32_bf16 v[36:39], a[16:19], v[80:83], v[36:39]
	s_waitcnt lgkmcnt(8)
	ds_read_b64_tr_b16 a[8:9], v61 offset:8192
	ds_read_b64_tr_b16 a[10:11], v61 offset:10240
	v_accvgpr_write_b32 a228, v184
	v_mfma_f32_16x16x32_bf16 v[36:39], a[20:23], v[84:87], v[36:39]
	s_waitcnt lgkmcnt(8)
	ds_read_b64_tr_b16 a[12:13], v61 offset:12288
	ds_read_b64_tr_b16 a[14:15], v61 offset:14336
	v_accvgpr_write_b32 a229, v185
	v_mfma_f32_16x16x32_bf16 v[36:39], a[24:27], v[88:91], v[36:39]
	s_waitcnt lgkmcnt(8)
	ds_read_b64_tr_b16 a[16:17], v61 offset:24576
	ds_read_b64_tr_b16 a[18:19], v61 offset:26624
	v_accvgpr_write_b32 a230, v186
	v_mfma_f32_16x16x32_bf16 v[36:39], a[28:31], v[92:95], v[36:39]
	s_waitcnt lgkmcnt(8)
	ds_read_b64_tr_b16 a[20:21], v61 offset:28672
	ds_read_b64_tr_b16 a[22:23], v61 offset:30720
	v_accvgpr_write_b32 a231, v187
	v_mfma_f32_16x16x32_bf16 v[36:39], a[0:3], v[96:99], v[36:39]
	s_waitcnt lgkmcnt(8)
	ds_read_b64_tr_b16 a[24:25], v61 offset:32768
	ds_read_b64_tr_b16 a[26:27], v61 offset:34816
	v_accvgpr_write_b32 a212, v180
	v_mfma_f32_16x16x32_bf16 v[36:39], a[4:7], v[100:103], v[36:39]
	s_waitcnt lgkmcnt(8)
	ds_read_b64_tr_b16 a[28:29], v61 offset:36864
	ds_read_b64_tr_b16 a[30:31], v61 offset:38912
	v_accvgpr_write_b32 a213, v181
	v_mfma_f32_16x16x32_bf16 v[36:39], a[8:11], v[104:107], v[36:39]
	s_waitcnt lgkmcnt(8)
	ds_read_b64_tr_b16 a[0:1], v62 offset:0
	ds_read_b64_tr_b16 a[2:3], v62 offset:2048
	v_accvgpr_write_b32 a214, v182
	v_mfma_f32_16x16x32_bf16 v[36:39], a[12:15], v[108:111], v[36:39]
L_pg4:
	s_cbranch_execz L_pg8
	s_waitcnt lgkmcnt(8)
	ds_read_b64_tr_b16 a[4:5], v62 offset:4096
	ds_read_b64_tr_b16 a[6:7], v62 offset:6144
	v_accvgpr_write_b32 a215, v183
	v_mfma_f32_16x16x32_bf16 v[36:39], a[16:19], v[112:115], v[36:39]
	s_waitcnt lgkmcnt(8)
	ds_read_b64_tr_b16 a[8:9], v62 offset:8192
	ds_read_b64_tr_b16 a[10:11], v62 offset:10240
	v_accvgpr_write_b32 a196, v176
	v_mfma_f32_16x16x32_bf16 v[36:39], a[20:23], v[116:119], v[36:39]
	s_waitcnt lgkmcnt(8)
	ds_read_b64_tr_b16 a[12:13], v62 offset:12288
	ds_read_b64_tr_b16 a[14:15], v62 offset:14336
	v_accvgpr_write_b32 a197, v177
	v_mfma_f32_16x16x32_bf16 v[36:39], a[24:27], v[120:123], v[36:39]
	s_waitcnt lgkmcnt(8)
	ds_read_b64_tr_b16 a[16:17], v62 offset:24576
	ds_read_b64_tr_b16 a[18:19], v62 offset:26624
	v_accvgpr_write_b32 a198, v178
	v_mfma_f32_16x16x32_bf16 v[36:39], a[28:31], v[124:127], v[36:39]
	s_waitcnt lgkmcnt(8)
	ds_read_b64_tr_b16 a[20:21], v62 offset:28672
	ds_read_b64_tr_b16 a[22:23], v62 offset:30720
	v_accvgpr_write_b32 a199, v179
	v_mfma_f32_16x16x32_bf16 v[40:43], a[0:3], v[64:67], 0
	s_waitcnt lgkmcnt(8)
	ds_read_b64_tr_b16 a[24:25], v62 offset:32768
	ds_read_b64_tr_b16 a[26:27], v62 offset:34816
	v_accvgpr_write_b32 a248, v220
	v_mfma_f32_16x16x32_bf16 v[40:43], a[4:7], v[68:71], v[40:43]
	ds_read_b64_tr_b16 a[28:29], v62 offset:36864
	ds_read_b64_tr_b16 a[30:31], v62 offset:38912
	v_add_u32 v62, 0xc000, v62
	v_accvgpr_write_b32 a249, v221
	s_waitcnt lgkmcnt(10)
	v_mfma_f32_16x16x32_bf16 v[40:43], a[8:11], v[72:75], v[40:43]
	s_waitcnt lgkmcnt(8)
	ds_read_b64_tr_b16 a[0:1], v62 offset:0
	ds_read_b64_tr_b16 a[2:3], v62 offset:2048
	v_accvgpr_write_b32 a250, v222
	v_mfma_f32_16x16x32_bf16 v[40:43], a[12:15], v[76:79], v[40:43]
	s_waitcnt lgkmcnt(8)
	ds_read_b64_tr_b16 a[4:5], v62 offset:4096
	ds_read_b64_tr_b16 a[6:7], v62 offset:6144
	v_accvgpr_write_b32 a251, v223
	v_mfma_f32_16x16x32_bf16 v[40:43], a[16:19], v[80:83], v[40:43]
	s_waitcnt lgkmcnt(8)
	ds_read_b64_tr_b16 a[8:9], v62 offset:8192
	ds_read_b64_tr_b16 a[10:11], v62 offset:10240
	v_accvgpr_write_b32 a232, v216
	v_mfma_f32_16x16x32_bf16 v[40:43], a[20:23], v[84:87], v[40:43]
	s_waitcnt lgkmcnt(8)
	ds_read_b64_tr_b16 a[12:13], v62 offset:12288
	ds_read_b64_tr_b16 a[14:15], v62 offset:14336
	v_accvgpr_write_b32 a233, v217
	v_mfma_f32_16x16x32_bf16 v[40:43], a[24:27], v[88:91], v[40:43]
	s_waitcnt lgkmcnt(8)
	ds_read_b64_tr_b16 a[16:17], v62 offset:24576
	ds_read_b64_tr_b16 a[18:19], v62 offset:26624
	v_accvgpr_write_b32 a234, v218
	v_mfma_f32_16x16x32_bf16 v[40:43], a[28:31], v[92:95], v[40:43]
	s_waitcnt lgkmcnt(8)
	ds_read_b64_tr_b16 a[20:21], v62 offset:28672
	ds_read_b64_tr_b16 a[22:23], v62 offset:30720
	v_accvgpr_write_b32 a235, v219
	v_mfma_f32_16x16x32_bf16 v[40:43], a[0:3], v[96:99], v[40:43]
	s_waitcnt lgkmcnt(8)
	ds_read_b64_tr_b16 a[24:25], v62 offset:32768
	ds_read_b64_tr_b16 a[26:27], v62 offset:34816
	v_accvgpr_write_b32 a216, v212
	v_mfma_f32_16x16x32_bf16 v[40:43], a[4:7], v[100:103], v[40:43]
	s_waitcnt lgkmcnt(8)
	ds_read_b64_tr_b16 a[28:29], v62 offset:36864
	ds_read_b64_tr_b16 a[30:31], v62 offset:38912
	v_accvgpr_write_b32 a217, v213
	v_mfma_f32_16x16x32_bf16 v[40:43], a[8:11], v[104:107], v[40:43]
	s_waitcnt lgkmcnt(8)
	ds_read_b64_tr_b16 a[0:1], v63 offset:0
	ds_read_b64_tr_b16 a[2:3], v63 offset:2048
	v_accvgpr_write_b32 a218, v214
	v_mfma_f32_16x16x32_bf16 v[40:43], a[12:15], v[108:111], v[40:43]
	s_waitcnt lgkmcnt(8)
	ds_read_b64_tr_b16 a[4:5], v63 offset:4096
	ds_read_b64_tr_b16 a[6:7], v63 offset:6144
	v_accvgpr_write_b32 a219, v215
	v_mfma_f32_16x16x32_bf16 v[40:43], a[16:19], v[112:115], v[40:43]
	s_waitcnt lgkmcnt(8)
	ds_read_b64_tr_b16 a[8:9], v63 offset:8192
	ds_read_b64_tr_b16 a[10:11], v63 offset:10240
	v_accvgpr_write_b32 a200, v208
	v_mfma_f32_16x16x32_bf16 v[40:43], a[20:23], v[116:119], v[40:43]
	s_waitcnt lgkmcnt(8)
	ds_read_b64_tr_b16 a[12:13], v63 offset:12288
	ds_read_b64_tr_b16 a[14:15], v63 offset:14336
	v_accvgpr_write_b32 a201, v209
	v_mfma_f32_16x16x32_bf16 v[40:43], a[24:27], v[120:123], v[40:43]
	s_waitcnt lgkmcnt(8)
	ds_read_b64_tr_b16 a[16:17], v63 offset:24576
	ds_read_b64_tr_b16 a[18:19], v63 offset:26624
	v_accvgpr_write_b32 a202, v210
	v_mfma_f32_16x16x32_bf16 v[40:43], a[28:31], v[124:127], v[40:43]
	s_waitcnt lgkmcnt(8)
	ds_read_b64_tr_b16 a[20:21], v63 offset:28672
	ds_read_b64_tr_b16 a[22:23], v63 offset:30720
	v_accvgpr_write_b32 a203, v211
	v_mfma_f32_16x16x32_bf16 v[44:47], a[0:3], v[64:67], 0
	s_waitcnt lgkmcnt(8)
	ds_read_b64_tr_b16 a[24:25], v63 offset:32768
	ds_read_b64_tr_b16 a[26:27], v63 offset:34816
	v_accvgpr_write_b32 a252, v252
	v_mfma_f32_16x16x32_bf16 v[44:47], a[4:7], v[68:71], v[44:47]
	ds_read_b64_tr_b16 a[28:29], v63 offset:36864
	ds_read_b64_tr_b16 a[30:31], v63 offset:38912
	v_add_u32 v63, 0xc000, v63
	v_accvgpr_write_b32 a253, v253
	s_waitcnt lgkmcnt(10)
	v_mfma_f32_16x16x32_bf16 v[44:47], a[8:11], v[72:75], v[44:47]
	s_waitcnt lgkmcnt(8)
	ds_read_b64_tr_b16 a[0:1], v63 offset:0
	ds_read_b64_tr_b16 a[2:3], v63 offset:2048
	v_accvgpr_write_b32 a254, v254
	v_mfma_f32_16x16x32_bf16 v[44:47], a[12:15], v[76:79], v[44:47]
	s_waitcnt lgkmcnt(8)
	ds_read_b64_tr_b16 a[4:5], v63 offset:4096
	ds_read_b64_tr_b16 a[6:7], v63 offset:6144
	v_accvgpr_write_b32 a255, v255
	v_mfma_f32_16x16x32_bf16 v[44:47], a[16:19], v[80:83], v[44:47]
	s_waitcnt lgkmcnt(8)
	ds_read_b64_tr_b16 a[8:9], v63 offset:8192
	ds_read_b64_tr_b16 a[10:11], v63 offset:10240
	v_accvgpr_write_b32 a236, v248
	v_mfma_f32_16x16x32_bf16 v[44:47], a[20:23], v[84:87], v[44:47]
	s_waitcnt lgkmcnt(8)
	ds_read_b64_tr_b16 a[12:13], v63 offset:12288
	ds_read_b64_tr_b16 a[14:15], v63 offset:14336
	v_accvgpr_write_b32 a237, v249
	v_mfma_f32_16x16x32_bf16 v[44:47], a[24:27], v[88:91], v[44:47]
	s_waitcnt lgkmcnt(8)
	ds_read_b64_tr_b16 a[16:17], v63 offset:24576
	ds_read_b64_tr_b16 a[18:19], v63 offset:26624
	v_accvgpr_write_b32 a238, v250
	v_mfma_f32_16x16x32_bf16 v[44:47], a[28:31], v[92:95], v[44:47]
	s_waitcnt lgkmcnt(8)
	ds_read_b64_tr_b16 a[20:21], v63 offset:28672
	ds_read_b64_tr_b16 a[22:23], v63 offset:30720
	v_accvgpr_write_b32 a239, v251
	v_mfma_f32_16x16x32_bf16 v[44:47], a[0:3], v[96:99], v[44:47]
	s_waitcnt lgkmcnt(8)
	ds_read_b64_tr_b16 a[24:25], v63 offset:32768
	ds_read_b64_tr_b16 a[26:27], v63 offset:34816
	v_accvgpr_write_b32 a220, v244
	v_mfma_f32_16x16x32_bf16 v[44:47], a[4:7], v[100:103], v[44:47]
	s_waitcnt lgkmcnt(8)
	ds_read_b64_tr_b16 a[28:29], v63 offset:36864
	ds_read_b64_tr_b16 a[30:31], v63 offset:38912
	v_accvgpr_write_b32 a221, v245
	v_mfma_f32_16x16x32_bf16 v[44:47], a[8:11], v[104:107], v[44:47]
	s_waitcnt lgkmcnt(8)
	v_accvgpr_write_b32 a222, v246
	v_mfma_f32_16x16x32_bf16 v[44:47], a[12:15], v[108:111], v[44:47]
	s_waitcnt lgkmcnt(6)
	v_accvgpr_write_b32 a223, v247
	v_mfma_f32_16x16x32_bf16 v[44:47], a[16:19], v[112:115], v[44:47]
	s_waitcnt lgkmcnt(4)
	v_accvgpr_write_b32 a204, v240
	v_mfma_f32_16x16x32_bf16 v[44:47], a[20:23], v[116:119], v[44:47]
	s_waitcnt lgkmcnt(2)
	v_accvgpr_write_b32 a205, v241
	v_mfma_f32_16x16x32_bf16 v[44:47], a[24:27], v[120:123], v[44:47]
	s_waitcnt lgkmcnt(0)
	v_accvgpr_write_b32 a206, v242
	v_mfma_f32_16x16x32_bf16 v[44:47], a[28:31], v[124:127], v[44:47]
	s_nop 0
	v_accvgpr_write_b32 a207, v243
	v_pk_mul_f32 v[32:33], v[32:33], v[30:31] op_sel_hi:[1,0]
	v_pk_mul_f32 v[34:35], v[34:35], v[30:31] op_sel_hi:[1,0]
	v_pk_mul_f32 v[48:49], v[32:33], v[32:33]
	v_pk_mul_f32 v[50:51], v[34:35], v[34:35]
	v_pk_fma_f32 v[48:49], v[48:49], s[76:77], v[58:59] op_sel_hi:[1,1,0]
	v_pk_fma_f32 v[50:51], v[50:51], s[76:77], v[58:59] op_sel_hi:[1,1,0]
	v_pk_mul_f32 v[48:49], v[48:49], v[32:33]
	v_pk_mul_f32 v[50:51], v[50:51], v[34:35]
	v_exp_f32 v48, v48
	v_exp_f32 v49, v49
	v_exp_f32 v50, v50
	v_exp_f32 v51, v51
	v_pk_add_f32 v[48:49], v[48:49], 1.0 op_sel_hi:[1,0]
	v_pk_add_f32 v[50:51], v[50:51], 1.0 op_sel_hi:[1,0]
	v_rcp_f32 v48, v48
	v_rcp_f32 v49, v49
	v_rcp_f32 v50, v50
	v_rcp_f32 v51, v51
	v_pk_mul_f32 v[48:49], v[48:49], v[32:33]
	v_pk_mul_f32 v[50:51], v[50:51], v[34:35]
	v_cvt_pk_bf16_f32 v64, v48, v49
	v_cvt_pk_bf16_f32 v65, v50, v51
	v_pk_mul_f32 v[36:37], v[36:37], v[30:31] op_sel_hi:[1,0]
	v_pk_mul_f32 v[38:39], v[38:39], v[30:31] op_sel_hi:[1,0]
	v_pk_mul_f32 v[52:53], v[36:37], v[36:37]
	v_pk_mul_f32 v[54:55], v[38:39], v[38:39]
	v_pk_fma_f32 v[52:53], v[52:53], s[76:77], v[58:59] op_sel_hi:[1,1,0]
	v_pk_fma_f32 v[54:55], v[54:55], s[76:77], v[58:59] op_sel_hi:[1,1,0]
	v_pk_mul_f32 v[52:53], v[52:53], v[36:37]
	v_pk_mul_f32 v[54:55], v[54:55], v[38:39]
	v_exp_f32 v52, v52
	v_exp_f32 v53, v53
	v_exp_f32 v54, v54
	v_exp_f32 v55, v55
	v_pk_add_f32 v[52:53], v[52:53], 1.0 op_sel_hi:[1,0]
	v_pk_add_f32 v[54:55], v[54:55], 1.0 op_sel_hi:[1,0]
	v_rcp_f32 v52, v52
	v_rcp_f32 v53, v53
	v_rcp_f32 v54, v54
	v_rcp_f32 v55, v55
	v_pk_mul_f32 v[52:53], v[52:53], v[36:37]
	v_pk_mul_f32 v[54:55], v[54:55], v[38:39]
	v_cvt_pk_bf16_f32 v66, v52, v53
	v_cvt_pk_bf16_f32 v67, v54, v55
	v_pk_mul_f32 v[40:41], v[40:41], v[30:31] op_sel_hi:[1,0]
	v_pk_mul_f32 v[42:43], v[42:43], v[30:31] op_sel_hi:[1,0]
	v_pk_mul_f32 v[48:49], v[40:41], v[40:41]
	v_pk_mul_f32 v[50:51], v[42:43], v[42:43]
	v_pk_fma_f32 v[48:49], v[48:49], s[76:77], v[58:59] op_sel_hi:[1,1,0]
	v_pk_fma_f32 v[50:51], v[50:51], s[76:77], v[58:59] op_sel_hi:[1,1,0]
	v_pk_mul_f32 v[48:49], v[48:49], v[40:41]
	v_pk_mul_f32 v[50:51], v[50:51], v[42:43]
	v_exp_f32 v48, v48
	v_exp_f32 v49, v49
	v_exp_f32 v50, v50
	v_exp_f32 v51, v51
	v_pk_add_f32 v[48:49], v[48:49], 1.0 op_sel_hi:[1,0]
	v_pk_add_f32 v[50:51], v[50:51], 1.0 op_sel_hi:[1,0]
	v_rcp_f32 v48, v48
	v_rcp_f32 v49, v49
	v_rcp_f32 v50, v50
	v_rcp_f32 v51, v51
	v_pk_mul_f32 v[48:49], v[48:49], v[40:41]
	v_pk_mul_f32 v[50:51], v[50:51], v[42:43]
	v_cvt_pk_bf16_f32 v68, v48, v49
	v_cvt_pk_bf16_f32 v69, v50, v51
	v_pk_mul_f32 v[44:45], v[44:45], v[30:31] op_sel_hi:[1,0]
	v_pk_mul_f32 v[46:47], v[46:47], v[30:31] op_sel_hi:[1,0]
	v_pk_mul_f32 v[52:53], v[44:45], v[44:45]
	v_pk_mul_f32 v[54:55], v[46:47], v[46:47]
	v_pk_fma_f32 v[52:53], v[52:53], s[76:77], v[58:59] op_sel_hi:[1,1,0]
	v_pk_fma_f32 v[54:55], v[54:55], s[76:77], v[58:59] op_sel_hi:[1,1,0]
	v_pk_mul_f32 v[52:53], v[52:53], v[44:45]
	v_pk_mul_f32 v[54:55], v[54:55], v[46:47]
	v_exp_f32 v52, v52
	v_exp_f32 v53, v53
	v_exp_f32 v54, v54
	v_exp_f32 v55, v55
	v_pk_add_f32 v[52:53], v[52:53], 1.0 op_sel_hi:[1,0]
	v_pk_add_f32 v[54:55], v[54:55], 1.0 op_sel_hi:[1,0]
	v_rcp_f32 v52, v52
	v_rcp_f32 v53, v53
	v_rcp_f32 v54, v54
	v_rcp_f32 v55, v55
	v_pk_mul_f32 v[52:53], v[52:53], v[44:45]
	v_pk_mul_f32 v[54:55], v[54:55], v[46:47]
	v_cvt_pk_bf16_f32 v70, v52, v53
	v_cvt_pk_bf16_f32 v71, v54, v55
	buffer_store_dwordx4 v[64:67], v13, s[52:55], s84 offen offset:0 sc1
	buffer_store_dwordx4 v[68:71], v13, s[52:55], s84 offen offset:1024 sc1
	v_and_b32 v112, 3, v0
	v_min_u32 v112, 2, v112
	v_add3_u32 v112, v112, s60, -1
	v_med3_i32 v112, v112, 0, 31
	v_lshlrev_b32 v24, 3, v112
	s_mov_b32 s70, 4
	s_waitcnt vmcnt(7)
	s_barrier
	ds_read_b128 a[0:3], v9 offset:0
	ds_read_b128 a[4:7], v10 offset:0
	ds_read_b128 a[8:11], v11 offset:0
	ds_read_b128 a[12:15], v12 offset:0
	ds_read_b128 a[28:31], v12 offset:4096
	ds_read_b128 a[24:27], v11 offset:4096
	ds_read_b128 a[20:23], v10 offset:4096
	ds_read_b128 a[16:19], v9 offset:4096
	s_waitcnt lgkmcnt(7)
	v_mfma_f32_16x16x32_bf16 v[32:35], a[0:3], a[192:195], -4.0
	s_waitcnt lgkmcnt(6)
	s_add_u32 m0, s65, 0x4000
	s_nop 0
	buffer_load_dwordx4 v18, s[8:11], s68 offen lds
	v_mfma_f32_16x16x32_bf16 v[32:35], a[4:7], a[196:199], v[32:35]
	s_waitcnt lgkmcnt(5)
	ds_read_b128 a[32:35], v9 offset:8192
	ds_read_b128 a[36:39], v10 offset:8192
	v_mfma_f32_16x16x32_bf16 v[32:35], a[8:11], a[200:203], v[32:35]
	s_waitcnt lgkmcnt(6)
	buffer_load_dwordx4 v19, s[8:11], s68 offen offset:1024 lds
	v_mfma_f32_16x16x32_bf16 v[32:35], a[12:15], a[204:207], v[32:35]
	s_add_u32 s68, s68, 0x2000
	s_and_b32 s68, s68, 0x7ffff
	s_add_u32 m0, s65, 0x6000
	ds_read_b128 a[40:43], v11 offset:8192
	ds_read_b128 a[44:47], v12 offset:8192
	s_waitcnt lgkmcnt(7)
	v_mfma_f32_16x16x32_bf16 v[36:39], a[28:31], a[204:207], -4.0
	s_waitcnt lgkmcnt(6)
	buffer_load_dwordx4 v18, s[8:11], s68 offen lds
	v_mfma_f32_16x16x32_bf16 v[36:39], a[24:27], a[200:203], v[36:39]
	s_waitcnt lgkmcnt(5)
	ds_read_b128 a[60:63], v12 offset:12288
	ds_read_b128 a[56:59], v11 offset:12288
	v_mfma_f32_16x16x32_bf16 v[36:39], a[20:23], a[196:199], v[36:39]
	s_waitcnt lgkmcnt(6)
	buffer_load_dwordx4 v19, s[8:11], s68 offen offset:1024 lds
	v_mfma_f32_16x16x32_bf16 v[36:39], a[16:19], a[192:195], v[36:39]
	s_add_u32 s68, s68, 0x2000
	s_and_b32 s68, s68, 0x7ffff
	ds_read_b128 a[52:55], v10 offset:12288
	ds_read_b128 a[48:51], v9 offset:12288
	s_waitcnt lgkmcnt(7)
	v_mfma_f32_16x16x32_bf16 v[40:43], a[32:35], a[192:195], -4.0
	s_waitcnt lgkmcnt(6)
	s_add_u32 m0, s65, 0xc000
	s_nop 0
	buffer_load_dwordx4 v20, s[12:15], s69 offen lds
	v_mfma_f32_16x16x32_bf16 v[40:43], a[36:39], a[196:199], v[40:43]
	s_waitcnt lgkmcnt(5)
	v_mfma_f32_16x16x32_bf16 v[40:43], a[40:43], a[200:203], v[40:43]
	s_waitcnt lgkmcnt(4)
	buffer_load_dwordx4 v21, s[12:15], s69 offen offset:1024 lds
	v_exp_f32 v32, v32
	v_mfma_f32_16x16x32_bf16 v[40:43], a[44:47], a[204:207], v[40:43]
	s_add_u32 s69, s69, 0x2000
	s_and_b32 s69, s69, 0x7ffff
	s_add_u32 m0, s65, 0xe000
	v_exp_f32 v33, v33
	s_waitcnt lgkmcnt(3)
	v_mfma_f32_16x16x32_bf16 v[44:47], a[60:63], a[204:207], -4.0
	s_waitcnt lgkmcnt(2)
	buffer_load_dwordx4 v20, s[12:15], s69 offen lds
	v_cvt_pk_bf16_f32 v48, v32, v33
	v_exp_f32 v34, v34
	v_mfma_f32_16x16x32_bf16 v[44:47], a[56:59], a[200:203], v[44:47]
	s_waitcnt lgkmcnt(1)
	v_exp_f32 v35, v35
	v_mfma_f32_16x16x32_bf16 v[44:47], a[52:55], a[196:199], v[44:47]
	s_waitcnt lgkmcnt(0)
	buffer_load_dwordx4 v21, s[12:15], s69 offen offset:1024 lds
	v_cvt_pk_bf16_f32 v49, v34, v35
	v_exp_f32 v36, v36
	v_mfma_f32_16x16x32_bf16 v[44:47], a[48:51], a[192:195], v[44:47]
	s_add_u32 s69, s69, 0x2000
	s_and_b32 s69, s69, 0x7ffff
	v_exp_f32 v37, v37
	s_nop 0
	v_cvt_pk_bf16_f32 v50, v36, v37
	v_exp_f32 v38, v38
	v_exp_f32 v39, v39
	s_nop 0
	v_cvt_pk_bf16_f32 v51, v38, v39
	v_mfma_f32_16x16x32_bf16 v[32:35], a[0:3], a[208:211], -4.0
	s_waitcnt vmcnt(11)
	s_barrier
	ds_read_b64_tr_b16 a[64:65], v1 offset:0
	ds_read_b64_tr_b16 a[66:67], v1 offset:4096
	v_mfma_f32_16x16x32_bf16 v[32:35], a[4:7], a[212:215], v[32:35]
	ds_read_b64_tr_b16 a[96:97], v1 offset:8192
	ds_read_b64_tr_b16 a[98:99], v1 offset:12288
	v_mfma_f32_16x16x32_bf16 v[32:35], a[8:11], a[216:219], v[32:35]
	ds_read_b64_tr_b16 a[100:101], v2 offset:8192
	ds_read_b64_tr_b16 a[102:103], v2 offset:12288
	v_exp_f32 v40, v40
	v_mfma_f32_16x16x32_bf16 v[32:35], a[12:15], a[220:223], v[32:35]
	ds_read_b64_tr_b16 a[68:69], v2 offset:0
	ds_read_b64_tr_b16 a[70:71], v2 offset:4096
	v_exp_f32 v41, v41
	v_mfma_f32_16x16x32_bf16 v[36:39], a[28:31], a[220:223], -4.0
	ds_read_b64_tr_b16 a[72:73], v3 offset:0
	ds_read_b64_tr_b16 a[74:75], v3 offset:4096
	v_cvt_pk_bf16_f32 v52, v40, v41
	v_exp_f32 v42, v42
	v_mfma_f32_16x16x32_bf16 v[36:39], a[24:27], a[216:219], v[36:39]
	ds_read_b64_tr_b16 a[104:105], v3 offset:8192
	ds_read_b64_tr_b16 a[106:107], v3 offset:12288
	v_exp_f32 v43, v43
	v_mfma_f32_16x16x32_bf16 v[36:39], a[20:23], a[212:215], v[36:39]
	ds_read_b64_tr_b16 a[108:109], v4 offset:8192
	ds_read_b64_tr_b16 a[110:111], v4 offset:12288
	v_cvt_pk_bf16_f32 v53, v42, v43
	v_exp_f32 v44, v44
	v_mfma_f32_16x16x32_bf16 v[36:39], a[16:19], a[208:211], v[36:39]
	ds_read_b64_tr_b16 a[76:77], v4 offset:0
	ds_read_b64_tr_b16 a[78:79], v4 offset:4096
	v_exp_f32 v45, v45
	s_nop 0
	v_cvt_pk_bf16_f32 v54, v44, v45
	v_exp_f32 v46, v46
	v_exp_f32 v47, v47
	s_nop 0
	v_cvt_pk_bf16_f32 v55, v46, v47
	v_mfma_f32_16x16x32_bf16 v[40:43], a[32:35], a[208:211], -4.0
	v_exp_f32 v32, v32
	v_mfma_f32_16x16x32_bf16 v[40:43], a[36:39], a[212:215], v[40:43]
	ds_read_b64_tr_b16 a[80:81], v5 offset:0
	ds_read_b64_tr_b16 a[82:83], v5 offset:4096
	v_mfma_f32_16x16x32_bf16 v[40:43], a[40:43], a[216:219], v[40:43]
	v_exp_f32 v33, v33
	v_mfma_f32_16x16x32_bf16 v[40:43], a[44:47], a[220:223], v[40:43]
	ds_read_b64_tr_b16 a[112:113], v5 offset:8192
	v_cvt_pk_bf16_f32 v56, v32, v33
	v_mfma_f32_16x16x32_bf16 v[44:47], a[60:63], a[220:223], -4.0
	v_exp_f32 v34, v34
	v_mfma_f32_16x16x32_bf16 v[44:47], a[56:59], a[216:219], v[44:47]
	ds_read_b64_tr_b16 a[114:115], v5 offset:12288
	ds_read_b64_tr_b16 a[116:117], v6 offset:8192
	v_mfma_f32_16x16x32_bf16 v[44:47], a[52:55], a[212:215], v[44:47]
	v_exp_f32 v35, v35
	v_mfma_f32_16x16x32_bf16 v[44:47], a[48:51], a[208:211], v[44:47]
	ds_read_b64_tr_b16 a[118:119], v6 offset:12288
	v_cvt_pk_bf16_f32 v57, v34, v35
	v_smfmac_f32_16x16x64_bf16 a[132:135], a[128:131], v[48:55], v31
	s_waitcnt lgkmcnt(8)
	v_mfma_f32_16x16x32_bf16 v[128:131], a[64:67], v[48:51], 0
	v_exp_f32 v36, v36
	v_mfma_f32_16x16x32_bf16 v[128:131], a[96:99], v[52:55], v[128:131]
	ds_read_b64_tr_b16 a[84:85], v6 offset:0
	ds_read_b64_tr_b16 a[86:87], v6 offset:4096
	v_mfma_f32_16x16x32_bf16 v[144:147], a[100:103], v[52:55], 0
	v_exp_f32 v37, v37
	v_mfma_f32_16x16x32_bf16 v[144:147], a[68:71], v[48:51], v[144:147]
	ds_read_b64_tr_b16 a[88:89], v7 offset:0
	v_cvt_pk_bf16_f32 v58, v36, v37
	v_mfma_f32_16x16x32_bf16 v[160:163], a[72:75], v[48:51], 0
	v_exp_f32 v38, v38
	v_mfma_f32_16x16x32_bf16 v[160:163], a[104:107], v[52:55], v[160:163]
	ds_read_b64_tr_b16 a[90:91], v7 offset:4096
	ds_read_b64_tr_b16 a[120:121], v7 offset:8192
	v_mfma_f32_16x16x32_bf16 v[176:179], a[108:111], v[52:55], 0
	s_waitcnt lgkmcnt(6)
	v_exp_f32 v39, v39
	v_mfma_f32_16x16x32_bf16 v[176:179], a[76:79], v[48:51], v[176:179]
	ds_read_b64_tr_b16 a[122:123], v7 offset:12288
	v_cvt_pk_bf16_f32 v59, v38, v39
	v_mfma_f32_16x16x32_bf16 v[32:35], a[0:3], a[224:227], -4.0
	v_exp_f32 v40, v40
	v_mfma_f32_16x16x32_bf16 v[32:35], a[4:7], a[228:231], v[32:35]
	ds_read_b64_tr_b16 a[124:125], v8 offset:8192
	ds_read_b64_tr_b16 a[126:127], v8 offset:12288
	v_mfma_f32_16x16x32_bf16 v[32:35], a[8:11], a[232:235], v[32:35]
	v_exp_f32 v41, v41
	v_mfma_f32_16x16x32_bf16 v[32:35], a[12:15], a[236:239], v[32:35]
	ds_read_b64_tr_b16 a[92:93], v8 offset:0
	v_cvt_pk_bf16_f32 v60, v40, v41
	v_mfma_f32_16x16x32_bf16 v[36:39], a[28:31], a[236:239], -4.0
	v_exp_f32 v42, v42
	v_mfma_f32_16x16x32_bf16 v[36:39], a[24:27], a[232:235], v[36:39]
	ds_read_b64_tr_b16 a[94:95], v8 offset:4096
	v_bfe_u32 v112, v0, 1, 1
	v_mfma_f32_16x16x32_bf16 v[36:39], a[20:23], a[228:231], v[36:39]
	v_exp_f32 v43, v43
	v_mfma_f32_16x16x32_bf16 v[36:39], a[16:19], a[224:227], v[36:39]
	v_cvt_pk_bf16_f32 v61, v42, v43
	v_lshl_add_u32 v112, v112, 1, -1
	v_mfma_f32_16x16x32_bf16 v[192:195], a[80:83], v[48:51], 0
	s_mov_b32 s74, 0x400000
	v_exp_f32 v44, v44
	v_mfma_f32_16x16x32_bf16 v[192:195], a[112:115], v[52:55], v[192:195]
	s_waitcnt vmcnt(8) lgkmcnt(4)
	buffer_store_dword v23, v22, s[48:51], s74 offen sc1
	v_mfma_f32_16x16x32_bf16 v[208:211], a[116:119], v[52:55], 0
	v_exp_f32 v45, v45
	v_mfma_f32_16x16x32_bf16 v[208:211], a[84:87], v[48:51], v[208:211]
	s_lshr_b32 s73, s60, 1
	v_cvt_pk_bf16_f32 v62, v44, v45
	v_bfe_u32 v113, v0, 3, 1
	v_mfma_f32_16x16x32_bf16 v[224:227], a[88:91], v[48:51], 0
	s_lshl_b32 s73, s73, 13
	v_exp_f32 v46, v46
	v_mfma_f32_16x16x32_bf16 v[224:227], a[120:123], v[52:55], v[224:227]
	s_waitcnt lgkmcnt(1)
	buffer_load_dwordx4 a[152:155], v16, s[28:31], s73 offen offset:0
	v_mfma_f32_16x16x32_bf16 v[240:243], a[124:127], v[52:55], 0
	s_waitcnt vmcnt(6) lgkmcnt(0)
	v_exp_f32 v47, v47
	v_mfma_f32_16x16x32_bf16 v[240:243], a[92:95], v[48:51], v[240:243]
	s_barrier
	v_cvt_pk_bf16_f32 v63, v46, v47
	v_mul_i32_i24 v112, v112, v113
	v_mfma_f32_16x16x32_bf16 v[40:43], a[32:35], a[224:227], -4.0
	s_add_u32 m0, s65, 0x0
	v_exp_f32 v32, v32
	v_mfma_f32_16x16x32_bf16 v[40:43], a[36:39], a[228:231], v[40:43]
	buffer_load_dwordx4 v18, s[8:11], s68 offen lds
	v_mfma_f32_16x16x32_bf16 v[40:43], a[40:43], a[232:235], v[40:43]
	v_exp_f32 v33, v33
	v_mfma_f32_16x16x32_bf16 v[40:43], a[44:47], a[236:239], v[40:43]
	v_cvt_pk_bf16_f32 v48, v32, v33
	v_add_u32 v112, s63, v112
	v_mfma_f32_16x16x32_bf16 v[44:47], a[60:63], a[236:239], -4.0
	v_exp_f32 v34, v34
	v_mfma_f32_16x16x32_bf16 v[44:47], a[56:59], a[232:235], v[44:47]
	buffer_load_dwordx4 v19, s[8:11], s68 offen offset:1024 lds
	v_mfma_f32_16x16x32_bf16 v[44:47], a[52:55], a[228:231], v[44:47]
	s_add_u32 s68, s68, 0x2000
	v_exp_f32 v35, v35
	v_mfma_f32_16x16x32_bf16 v[44:47], a[48:51], a[224:227], v[44:47]
	s_and_b32 s68, s68, 0x7ffff
	v_cvt_pk_bf16_f32 v49, v34, v35
	v_max_i32 v112, 0, v112
	v_smfmac_f32_16x16x64_bf16 a[132:135], a[168:171], v[56:63], v31
	v_mfma_f32_16x16x32_bf16 v[132:135], a[64:67], v[56:59], 0
	s_add_u32 m0, s65, 0x2000
	v_exp_f32 v36, v36
	v_mfma_f32_16x16x32_bf16 v[132:135], a[96:99], v[60:63], v[132:135]
	buffer_load_dwordx4 v18, s[8:11], s68 offen lds
	v_mfma_f32_16x16x32_bf16 v[148:151], a[100:103], v[60:63], 0
	v_exp_f32 v37, v37
	v_mfma_f32_16x16x32_bf16 v[148:151], a[68:71], v[56:59], v[148:151]
	v_cvt_pk_bf16_f32 v50, v36, v37
	v_min_i32 v112, 0x7f, v112
	v_mfma_f32_16x16x32_bf16 v[164:167], a[72:75], v[56:59], 0
	v_exp_f32 v38, v38
	v_mfma_f32_16x16x32_bf16 v[164:167], a[104:107], v[60:63], v[164:167]
	buffer_load_dwordx4 v19, s[8:11], s68 offen offset:1024 lds
	v_mfma_f32_16x16x32_bf16 v[180:183], a[108:111], v[60:63], 0
	s_add_u32 s68, s68, 0x2000
	v_exp_f32 v39, v39
	v_mfma_f32_16x16x32_bf16 v[180:183], a[76:79], v[56:59], v[180:183]
	s_and_b32 s68, s68, 0x7ffff
	v_cvt_pk_bf16_f32 v51, v38, v39
	v_and_b32 v113, 7, v0
	v_mfma_f32_16x16x32_bf16 v[32:35], a[0:3], a[240:243], -4.0
	s_add_u32 m0, s65, 0x8000
	v_exp_f32 v40, v40
	v_mfma_f32_16x16x32_bf16 v[32:35], a[4:7], a[244:247], v[32:35]
	buffer_load_dwordx4 v20, s[12:15], s69 offen lds
	v_mfma_f32_16x16x32_bf16 v[32:35], a[8:11], a[248:251], v[32:35]
	v_exp_f32 v41, v41
	v_mfma_f32_16x16x32_bf16 v[32:35], a[12:15], a[252:255], v[32:35]
	ds_read_b128 a[0:3], v9 offset:16384
	v_cvt_pk_bf16_f32 v52, v40, v41
	v_mfma_f32_16x16x32_bf16 v[36:39], a[28:31], a[252:255], -4.0
	v_exp_f32 v42, v42
	v_mfma_f32_16x16x32_bf16 v[36:39], a[24:27], a[248:251], v[36:39]
	buffer_load_dwordx4 v21, s[12:15], s69 offen offset:1024 lds
	v_mfma_f32_16x16x32_bf16 v[36:39], a[20:23], a[244:247], v[36:39]
	v_exp_f32 v43, v43
	v_mfma_f32_16x16x32_bf16 v[36:39], a[16:19], a[240:243], v[36:39]
	ds_read_b128 a[4:7], v10 offset:16384
	v_cvt_pk_bf16_f32 v53, v42, v43
	v_mfma_f32_16x16x32_bf16 v[196:199], a[80:83], v[56:59], 0
	v_exp_f32 v44, v44
	v_mfma_f32_16x16x32_bf16 v[196:199], a[112:115], v[60:63], v[196:199]
	ds_read_b128 a[8:11], v11 offset:16384
	ds_read_b128 a[12:15], v12 offset:16384
	v_mfma_f32_16x16x32_bf16 v[212:215], a[116:119], v[60:63], 0
	s_add_u32 s69, s69, 0x2000
	v_exp_f32 v45, v45
	v_mfma_f32_16x16x32_bf16 v[212:215], a[84:87], v[56:59], v[212:215]
	s_and_b32 s69, s69, 0x7ffff
	ds_read_b128 a[28:31], v12 offset:20480
	v_cvt_pk_bf16_f32 v54, v44, v45
	v_mfma_f32_16x16x32_bf16 v[228:231], a[88:91], v[56:59], 0
	s_add_u32 m0, s65, 0xa000
	v_exp_f32 v46, v46
	v_mfma_f32_16x16x32_bf16 v[228:231], a[120:123], v[60:63], v[228:231]
	buffer_load_dwordx4 v20, s[12:15], s69 offen lds
	v_mfma_f32_16x16x32_bf16 v[244:247], a[124:127], v[60:63], 0
	v_exp_f32 v47, v47
	v_mfma_f32_16x16x32_bf16 v[244:247], a[92:95], v[56:59], v[244:247]
	ds_read_b128 a[24:27], v11 offset:20480
	v_cvt_pk_bf16_f32 v55, v46, v47
	v_mfma_f32_16x16x32_bf16 v[40:43], a[32:35], a[240:243], -4.0
	s_add_u32 m0, s65, 0xa000
	v_exp_f32 v32, v32
	v_mfma_f32_16x16x32_bf16 v[40:43], a[36:39], a[244:247], v[40:43]
	buffer_load_dwordx4 v21, s[12:15], s69 offen offset:1024 lds
	v_mfma_f32_16x16x32_bf16 v[40:43], a[40:43], a[248:251], v[40:43]
	v_exp_f32 v33, v33
	v_mfma_f32_16x16x32_bf16 v[40:43], a[44:47], a[252:255], v[40:43]
	s_add_u32 s69, s69, 0x2000
	ds_read_b128 a[20:23], v10 offset:20480
	v_cvt_pk_bf16_f32 v56, v32, v33
	v_mfma_f32_16x16x32_bf16 v[44:47], a[60:63], a[252:255], -4.0
	s_and_b32 s69, s69, 0x7ffff
	v_exp_f32 v34, v34
	v_mfma_f32_16x16x32_bf16 v[44:47], a[56:59], a[248:251], v[44:47]
	buffer_load_dword v25, v24, s[44:47], 0 offen sc1
	v_mfma_f32_16x16x32_bf16 v[44:47], a[52:55], a[244:247], v[44:47]
	v_exp_f32 v35, v35
	v_mfma_f32_16x16x32_bf16 v[44:47], a[48:51], a[240:243], v[44:47]
	ds_read_b128 a[16:19], v9 offset:20480
	v_cvt_pk_bf16_f32 v57, v34, v35
	v_smfmac_f32_16x16x64_bf16 a[136:139], a[128:131], v[48:55], v31
	v_mfma_f32_16x16x32_bf16 v[136:139], a[64:67], v[48:51], 0
	v_exp_f32 v36, v36
	v_mfma_f32_16x16x32_bf16 v[136:139], a[96:99], v[52:55], v[136:139]
	ds_read_b128 a[32:35], v9 offset:24576
	ds_read_b128 a[36:39], v10 offset:24576
	v_mfma_f32_16x16x32_bf16 v[152:155], a[100:103], v[52:55], 0
L_pg5:
	s_cbranch_execz L_pg9
	v_exp_f32 v37, v37
	v_mfma_f32_16x16x32_bf16 v[152:155], a[68:71], v[48:51], v[152:155]
	ds_read_b128 a[40:43], v11 offset:24576
	v_cvt_pk_bf16_f32 v58, v36, v37
	v_mfma_f32_16x16x32_bf16 v[168:171], a[72:75], v[48:51], 0
	v_exp_f32 v38, v38
	v_mfma_f32_16x16x32_bf16 v[168:171], a[104:107], v[52:55], v[168:171]
	ds_read_b128 a[44:47], v12 offset:24576
	ds_read_b128 a[60:63], v12 offset:28672
	v_mfma_f32_16x16x32_bf16 v[184:187], a[108:111], v[52:55], 0
	v_exp_f32 v39, v39
	v_mfma_f32_16x16x32_bf16 v[184:187], a[76:79], v[48:51], v[184:187]
	s_waitcnt lgkmcnt(6)
	ds_read_b128 a[56:59], v11 offset:28672
	v_cvt_pk_bf16_f32 v59, v38, v39
	v_mfma_f32_16x16x32_bf16 v[32:35], a[0:3], a[192:195], -4.0
	v_exp_f32 v40, v40
	v_mfma_f32_16x16x32_bf16 v[32:35], a[4:7], a[196:199], v[32:35]
	ds_read_b128 a[52:55], v10 offset:28672
	ds_read_b128 a[48:51], v9 offset:28672
	v_mfma_f32_16x16x32_bf16 v[32:35], a[8:11], a[200:203], v[32:35]
	v_exp_f32 v41, v41
	v_mfma_f32_16x16x32_bf16 v[32:35], a[12:15], a[204:207], v[32:35]
	v_cvt_pk_bf16_f32 v60, v40, v41
	v_lshl_or_b32 v112, v112, 3, v113
	v_mfma_f32_16x16x32_bf16 v[36:39], a[28:31], a[204:207], -4.0
	v_exp_f32 v42, v42
	v_mfma_f32_16x16x32_bf16 v[36:39], a[24:27], a[200:203], v[36:39]
	v_lshlrev_b32 v112, 7, v112
	v_add_u32 v30, 0x400000, v112
	v_mfma_f32_16x16x32_bf16 v[36:39], a[20:23], a[196:199], v[36:39]
	s_waitcnt lgkmcnt(5)
	v_exp_f32 v43, v43
	v_mfma_f32_16x16x32_bf16 v[36:39], a[16:19], a[192:195], v[36:39]
	v_cvt_pk_bf16_f32 v61, v42, v43
	v_mfma_f32_16x16x32_bf16 v[200:203], a[80:83], v[48:51], 0
	v_exp_f32 v44, v44
	v_mfma_f32_16x16x32_bf16 v[200:203], a[112:115], v[52:55], v[200:203]
	v_mfma_f32_16x16x32_bf16 v[216:219], a[116:119], v[52:55], 0
	v_exp_f32 v45, v45
	v_mfma_f32_16x16x32_bf16 v[216:219], a[84:87], v[48:51], v[216:219]
	v_cvt_pk_bf16_f32 v62, v44, v45
	v_mfma_f32_16x16x32_bf16 v[232:235], a[88:91], v[48:51], 0
	v_exp_f32 v46, v46
	v_mfma_f32_16x16x32_bf16 v[232:235], a[120:123], v[52:55], v[232:235]
	v_mfma_f32_16x16x32_bf16 v[248:251], a[124:127], v[52:55], 0
	v_exp_f32 v47, v47
	v_mfma_f32_16x16x32_bf16 v[248:251], a[92:95], v[48:51], v[248:251]
	v_cvt_pk_bf16_f32 v63, v46, v47
	v_mfma_f32_16x16x32_bf16 v[40:43], a[32:35], a[192:195], -4.0
	s_waitcnt vmcnt(11)
	s_barrier
	v_exp_f32 v32, v32
	v_mfma_f32_16x16x32_bf16 v[40:43], a[36:39], a[196:199], v[40:43]
	v_mfma_f32_16x16x32_bf16 v[40:43], a[40:43], a[200:203], v[40:43]
	s_waitcnt lgkmcnt(0)
	v_exp_f32 v33, v33
	v_mfma_f32_16x16x32_bf16 v[40:43], a[44:47], a[204:207], v[40:43]
	v_cvt_pk_bf16_f32 v48, v32, v33
	v_mfma_f32_16x16x32_bf16 v[44:47], a[60:63], a[204:207], -4.0
	v_exp_f32 v34, v34
	v_mfma_f32_16x16x32_bf16 v[44:47], a[56:59], a[200:203], v[44:47]
	v_mfma_f32_16x16x32_bf16 v[44:47], a[52:55], a[196:199], v[44:47]
	v_exp_f32 v35, v35
	v_mfma_f32_16x16x32_bf16 v[44:47], a[48:51], a[192:195], v[44:47]
	v_cvt_pk_bf16_f32 v49, v34, v35
	v_smfmac_f32_16x16x64_bf16 a[136:139], a[168:171], v[56:63], v31
	v_mfma_f32_16x16x32_bf16 v[140:143], a[64:67], v[56:59], 0
	v_exp_f32 v36, v36
	v_mfma_f32_16x16x32_bf16 v[140:143], a[96:99], v[60:63], v[140:143]
	ds_read_b64_tr_b16 a[64:65], v1 offset:16384
	ds_read_b64_tr_b16 a[66:67], v1 offset:20480
	v_mfma_f32_16x16x32_bf16 v[156:159], a[100:103], v[60:63], 0
	v_exp_f32 v37, v37
	v_mfma_f32_16x16x32_bf16 v[156:159], a[68:71], v[56:59], v[156:159]
	ds_read_b64_tr_b16 a[96:97], v1 offset:24576
	v_cvt_pk_bf16_f32 v50, v36, v37
	v_mfma_f32_16x16x32_bf16 v[172:175], a[72:75], v[56:59], 0
	v_exp_f32 v38, v38
	v_mfma_f32_16x16x32_bf16 v[172:175], a[104:107], v[60:63], v[172:175]
	ds_read_b64_tr_b16 a[98:99], v1 offset:28672
	ds_read_b64_tr_b16 a[100:101], v2 offset:24576
	v_mfma_f32_16x16x32_bf16 v[188:191], a[108:111], v[60:63], 0
	v_exp_f32 v39, v39
	v_mfma_f32_16x16x32_bf16 v[188:191], a[76:79], v[56:59], v[188:191]
	ds_read_b64_tr_b16 a[102:103], v2 offset:28672
	v_cvt_pk_bf16_f32 v51, v38, v39
	v_mfma_f32_16x16x32_bf16 v[32:35], a[0:3], a[208:211], -4.0
	v_exp_f32 v40, v40
	v_mfma_f32_16x16x32_bf16 v[32:35], a[4:7], a[212:215], v[32:35]
	ds_read_b64_tr_b16 a[68:69], v2 offset:16384
	ds_read_b64_tr_b16 a[70:71], v2 offset:20480
	v_mfma_f32_16x16x32_bf16 v[32:35], a[8:11], a[216:219], v[32:35]
	v_exp_f32 v41, v41
	v_mfma_f32_16x16x32_bf16 v[32:35], a[12:15], a[220:223], v[32:35]
	ds_read_b64_tr_b16 a[72:73], v3 offset:16384
	v_cvt_pk_bf16_f32 v52, v40, v41
	v_mfma_f32_16x16x32_bf16 v[36:39], a[28:31], a[220:223], -4.0
	v_exp_f32 v42, v42
	v_mfma_f32_16x16x32_bf16 v[36:39], a[24:27], a[216:219], v[36:39]
	ds_read_b64_tr_b16 a[74:75], v3 offset:20480
	ds_read_b64_tr_b16 a[104:105], v3 offset:24576
	v_mfma_f32_16x16x32_bf16 v[36:39], a[20:23], a[212:215], v[36:39]
	v_exp_f32 v43, v43
	v_mfma_f32_16x16x32_bf16 v[36:39], a[16:19], a[208:211], v[36:39]
	ds_read_b64_tr_b16 a[106:107], v3 offset:28672
	v_cvt_pk_bf16_f32 v53, v42, v43
	v_mfma_f32_16x16x32_bf16 v[204:207], a[80:83], v[56:59], 0
	v_exp_f32 v44, v44
	v_mfma_f32_16x16x32_bf16 v[204:207], a[112:115], v[60:63], v[204:207]
	ds_read_b64_tr_b16 a[108:109], v4 offset:24576
	ds_read_b64_tr_b16 a[110:111], v4 offset:28672
	v_mfma_f32_16x16x32_bf16 v[220:223], a[116:119], v[60:63], 0
	v_exp_f32 v45, v45
	v_mfma_f32_16x16x32_bf16 v[220:223], a[84:87], v[56:59], v[220:223]
	ds_read_b64_tr_b16 a[76:77], v4 offset:16384
	v_cvt_pk_bf16_f32 v54, v44, v45
	v_mfma_f32_16x16x32_bf16 v[236:239], a[88:91], v[56:59], 0
	v_exp_f32 v46, v46
	v_mfma_f32_16x16x32_bf16 v[236:239], a[120:123], v[60:63], v[236:239]
	ds_read_b64_tr_b16 a[78:79], v4 offset:20480
	ds_read_b64_tr_b16 a[80:81], v5 offset:16384
	v_mfma_f32_16x16x32_bf16 v[252:255], a[124:127], v[60:63], 0
	v_exp_f32 v47, v47
	v_mfma_f32_16x16x32_bf16 v[252:255], a[92:95], v[56:59], v[252:255]
	ds_read_b64_tr_b16 a[82:83], v5 offset:20480
	v_cvt_pk_bf16_f32 v55, v46, v47
	v_mfma_f32_16x16x32_bf16 v[40:43], a[32:35], a[208:211], -4.0
	v_exp_f32 v32, v32
	v_mfma_f32_16x16x32_bf16 v[40:43], a[36:39], a[212:215], v[40:43]
	ds_read_b64_tr_b16 a[112:113], v5 offset:24576
	ds_read_b64_tr_b16 a[114:115], v5 offset:28672
	v_mfma_f32_16x16x32_bf16 v[40:43], a[40:43], a[216:219], v[40:43]
	v_exp_f32 v33, v33
	v_mfma_f32_16x16x32_bf16 v[40:43], a[44:47], a[220:223], v[40:43]
	ds_read_b64_tr_b16 a[116:117], v6 offset:24576
	v_cvt_pk_bf16_f32 v56, v32, v33
	v_mfma_f32_16x16x32_bf16 v[44:47], a[60:63], a[220:223], -4.0
	v_exp_f32 v34, v34
	v_mfma_f32_16x16x32_bf16 v[44:47], a[56:59], a[216:219], v[44:47]
	ds_read_b64_tr_b16 a[118:119], v6 offset:28672
	ds_read_b64_tr_b16 a[84:85], v6 offset:16384
	v_mfma_f32_16x16x32_bf16 v[44:47], a[52:55], a[212:215], v[44:47]
	v_exp_f32 v35, v35
	v_mfma_f32_16x16x32_bf16 v[44:47], a[48:51], a[208:211], v[44:47]
	ds_read_b64_tr_b16 a[86:87], v6 offset:20480
	v_cvt_pk_bf16_f32 v57, v34, v35
	v_smfmac_f32_16x16x64_bf16 a[132:135], a[128:131], v[48:55], v31
	s_waitcnt lgkmcnt(7)
	v_mfma_f32_16x16x32_bf16 v[128:131], a[64:67], v[48:51], v[128:131]
	v_exp_f32 v36, v36
	v_mfma_f32_16x16x32_bf16 v[128:131], a[96:99], v[52:55], v[128:131]
	ds_read_b64_tr_b16 a[88:89], v7 offset:16384
	ds_read_b64_tr_b16 a[90:91], v7 offset:20480
	v_mfma_f32_16x16x32_bf16 v[144:147], a[100:103], v[52:55], v[144:147]
	v_exp_f32 v37, v37
	v_mfma_f32_16x16x32_bf16 v[144:147], a[68:71], v[48:51], v[144:147]
	ds_read_b64_tr_b16 a[120:121], v7 offset:24576
	v_cvt_pk_bf16_f32 v58, v36, v37
	v_mfma_f32_16x16x32_bf16 v[160:163], a[72:75], v[48:51], v[160:163]
	v_exp_f32 v38, v38
	v_mfma_f32_16x16x32_bf16 v[160:163], a[104:107], v[52:55], v[160:163]
	ds_read_b64_tr_b16 a[122:123], v7 offset:28672
	ds_read_b64_tr_b16 a[124:125], v8 offset:24576
	v_mfma_f32_16x16x32_bf16 v[176:179], a[108:111], v[52:55], v[176:179]
	v_exp_f32 v39, v39
	v_mfma_f32_16x16x32_bf16 v[176:179], a[76:79], v[48:51], v[176:179]
	ds_read_b64_tr_b16 a[126:127], v8 offset:28672
	v_cvt_pk_bf16_f32 v59, v38, v39
	v_mfma_f32_16x16x32_bf16 v[32:35], a[0:3], a[224:227], -4.0
	v_exp_f32 v40, v40
	v_mfma_f32_16x16x32_bf16 v[32:35], a[4:7], a[228:231], v[32:35]
	ds_read_b64_tr_b16 a[92:93], v8 offset:16384
	ds_read_b64_tr_b16 a[94:95], v8 offset:20480
	v_mfma_f32_16x16x32_bf16 v[32:35], a[8:11], a[232:235], v[32:35]
	v_exp_f32 v41, v41
	v_mfma_f32_16x16x32_bf16 v[32:35], a[12:15], a[236:239], v[32:35]
	v_cvt_pk_bf16_f32 v60, v40, v41
	v_and_b32 v112, 15, v0
	v_mfma_f32_16x16x32_bf16 v[36:39], a[28:31], a[236:239], -4.0
	v_exp_f32 v42, v42
	v_mfma_f32_16x16x32_bf16 v[36:39], a[24:27], a[232:235], v[36:39]
	v_lshl_add_u32 v112, s63, 4, v112
	v_and_b32 v113, 48, v0
	v_mfma_f32_16x16x32_bf16 v[36:39], a[20:23], a[228:231], v[36:39]
	v_exp_f32 v43, v43
	v_mfma_f32_16x16x32_bf16 v[36:39], a[16:19], a[224:227], v[36:39]
	s_waitcnt lgkmcnt(3)
	s_add_u32 m0, s64, 0x2000
	v_cvt_pk_bf16_f32 v61, v42, v43
	v_add_u32 v114, -1, v112
	v_mfma_f32_16x16x32_bf16 v[192:195], a[80:83], v[48:51], v[192:195]
	s_mov_b32 s66, 0x0
	v_exp_f32 v44, v44
	v_mfma_f32_16x16x32_bf16 v[192:195], a[112:115], v[52:55], v[192:195]
	buffer_load_dwordx4 v16, s[28:31], s66 offen offset:0 lds
	v_mfma_f32_16x16x32_bf16 v[208:211], a[116:119], v[52:55], v[208:211]
	v_exp_f32 v45, v45
	v_mfma_f32_16x16x32_bf16 v[208:211], a[84:87], v[48:51], v[208:211]
	v_cvt_pk_bf16_f32 v62, v44, v45
	v_and_or_b32 v115, v114, 15, v113
	v_mfma_f32_16x16x32_bf16 v[224:227], a[88:91], v[48:51], v[224:227]
	v_exp_f32 v46, v46
	v_mfma_f32_16x16x32_bf16 v[224:227], a[120:123], v[52:55], v[224:227]
	s_waitcnt vmcnt(1)
	v_cmp_gt_u32 vcc, 8, v25
	s_cbranch_vccnz L_spin1
L_back1:
	v_mov_b32 v24, v30
	s_waitcnt lgkmcnt(0)
	v_mfma_f32_16x16x32_bf16 v[240:243], a[124:127], v[52:55], v[240:243]
	v_exp_f32 v47, v47
	v_mfma_f32_16x16x32_bf16 v[240:243], a[92:95], v[48:51], v[240:243]
	s_barrier
	v_cvt_pk_bf16_f32 v63, v46, v47
	v_bfe_u32 v114, v114, 4, 8
	v_mfma_f32_16x16x32_bf16 v[40:43], a[32:35], a[224:227], -4.0
	s_add_u32 m0, s65, 0x4000
	v_exp_f32 v32, v32
	v_mfma_f32_16x16x32_bf16 v[40:43], a[36:39], a[228:231], v[40:43]
	buffer_load_dwordx4 v18, s[8:11], s68 offen lds
	v_mfma_f32_16x16x32_bf16 v[40:43], a[40:43], a[232:235], v[40:43]
	v_exp_f32 v33, v33
	v_mfma_f32_16x16x32_bf16 v[40:43], a[44:47], a[236:239], v[40:43]
	v_cvt_pk_bf16_f32 v48, v32, v33
	v_lshl_or_b32 v115, v114, 10, v115
	v_mfma_f32_16x16x32_bf16 v[44:47], a[60:63], a[236:239], -4.0
	v_exp_f32 v34, v34
	v_mfma_f32_16x16x32_bf16 v[44:47], a[56:59], a[232:235], v[44:47]
	buffer_load_dwordx4 v19, s[8:11], s68 offen offset:1024 lds
	v_mfma_f32_16x16x32_bf16 v[44:47], a[52:55], a[228:231], v[44:47]
	s_add_u32 s68, s68, 0x2000
	v_exp_f32 v35, v35
	v_mfma_f32_16x16x32_bf16 v[44:47], a[48:51], a[224:227], v[44:47]
	s_and_b32 s68, s68, 0x7ffff
	v_cvt_pk_bf16_f32 v49, v34, v35
	v_lshlrev_b32 v115, 4, v115
	v_smfmac_f32_16x16x64_bf16 a[132:135], a[168:171], v[56:63], v31
	v_mfma_f32_16x16x32_bf16 v[132:135], a[64:67], v[56:59], v[132:135]
	s_add_u32 m0, s65, 0x6000
	v_exp_f32 v36, v36
	v_mfma_f32_16x16x32_bf16 v[132:135], a[96:99], v[60:63], v[132:135]
	buffer_load_dwordx4 v18, s[8:11], s68 offen lds
	v_mfma_f32_16x16x32_bf16 v[148:151], a[100:103], v[60:63], v[148:151]
	v_exp_f32 v37, v37
	v_mfma_f32_16x16x32_bf16 v[148:151], a[68:71], v[56:59], v[148:151]
	v_cvt_pk_bf16_f32 v50, v36, v37
	v_add_u32 v26, 0x0, v115
	v_mfma_f32_16x16x32_bf16 v[164:167], a[72:75], v[56:59], v[164:167]
	v_exp_f32 v38, v38
	v_mfma_f32_16x16x32_bf16 v[164:167], a[104:107], v[60:63], v[164:167]
	buffer_load_dwordx4 v19, s[8:11], s68 offen offset:1024 lds
	v_mfma_f32_16x16x32_bf16 v[180:183], a[108:111], v[60:63], v[180:183]
	s_add_u32 s68, s68, 0x2000
	v_exp_f32 v39, v39
	v_mfma_f32_16x16x32_bf16 v[180:183], a[76:79], v[56:59], v[180:183]
	s_and_b32 s68, s68, 0x7ffff
	v_cvt_pk_bf16_f32 v51, v38, v39
	v_add_u32 v114, 1, v112
	v_mfma_f32_16x16x32_bf16 v[32:35], a[0:3], a[240:243], -4.0
	s_add_u32 m0, s65, 0xc000
	v_exp_f32 v40, v40
	v_mfma_f32_16x16x32_bf16 v[32:35], a[4:7], a[244:247], v[32:35]
	buffer_load_dwordx4 v20, s[12:15], s69 offen lds
	v_mfma_f32_16x16x32_bf16 v[32:35], a[8:11], a[248:251], v[32:35]
	v_exp_f32 v41, v41
	v_mfma_f32_16x16x32_bf16 v[32:35], a[12:15], a[252:255], v[32:35]
	ds_read_b128 a[0:3], v9 offset:0
	v_cvt_pk_bf16_f32 v52, v40, v41
	v_mfma_f32_16x16x32_bf16 v[36:39], a[28:31], a[252:255], -4.0
	v_exp_f32 v42, v42
	v_mfma_f32_16x16x32_bf16 v[36:39], a[24:27], a[248:251], v[36:39]
	buffer_load_dwordx4 v21, s[12:15], s69 offen offset:1024 lds
	v_mfma_f32_16x16x32_bf16 v[36:39], a[20:23], a[244:247], v[36:39]
	v_exp_f32 v43, v43
	v_mfma_f32_16x16x32_bf16 v[36:39], a[16:19], a[240:243], v[36:39]
	ds_read_b128 a[4:7], v10 offset:0
	v_cvt_pk_bf16_f32 v53, v42, v43
	v_mfma_f32_16x16x32_bf16 v[196:199], a[80:83], v[56:59], v[196:199]
	v_exp_f32 v44, v44
	v_mfma_f32_16x16x32_bf16 v[196:199], a[112:115], v[60:63], v[196:199]
	ds_read_b128 a[8:11], v11 offset:0
	ds_read_b128 a[12:15], v12 offset:0
	v_mfma_f32_16x16x32_bf16 v[212:215], a[116:119], v[60:63], v[212:215]
	s_add_u32 s69, s69, 0x2000
	v_exp_f32 v45, v45
	v_mfma_f32_16x16x32_bf16 v[212:215], a[84:87], v[56:59], v[212:215]
	s_and_b32 s69, s69, 0x7ffff
	ds_read_b128 a[28:31], v12 offset:4096
	v_cvt_pk_bf16_f32 v54, v44, v45
	v_mfma_f32_16x16x32_bf16 v[228:231], a[88:91], v[56:59], v[228:231]
	s_add_u32 m0, s65, 0xe000
	v_exp_f32 v46, v46
	v_mfma_f32_16x16x32_bf16 v[228:231], a[120:123], v[60:63], v[228:231]
	buffer_load_dwordx4 v20, s[12:15], s69 offen lds
	v_mfma_f32_16x16x32_bf16 v[244:247], a[124:127], v[60:63], v[244:247]
	v_exp_f32 v47, v47
	v_mfma_f32_16x16x32_bf16 v[244:247], a[92:95], v[56:59], v[244:247]
	ds_read_b128 a[24:27], v11 offset:4096
	v_cvt_pk_bf16_f32 v55, v46, v47
	v_mfma_f32_16x16x32_bf16 v[40:43], a[32:35], a[240:243], -4.0
	s_add_u32 m0, s65, 0xe000
	v_exp_f32 v32, v32
	v_mfma_f32_16x16x32_bf16 v[40:43], a[36:39], a[244:247], v[40:43]
	buffer_load_dwordx4 v21, s[12:15], s69 offen offset:1024 lds
	v_mfma_f32_16x16x32_bf16 v[40:43], a[40:43], a[248:251], v[40:43]
	v_exp_f32 v33, v33
	v_mfma_f32_16x16x32_bf16 v[40:43], a[44:47], a[252:255], v[40:43]
	s_add_u32 s69, s69, 0x2000
	ds_read_b128 a[20:23], v10 offset:4096
	v_cvt_pk_bf16_f32 v56, v32, v33
	v_mfma_f32_16x16x32_bf16 v[44:47], a[60:63], a[252:255], -4.0
	s_and_b32 s69, s69, 0x7ffff
	v_exp_f32 v34, v34
	v_mfma_f32_16x16x32_bf16 v[44:47], a[56:59], a[248:251], v[44:47]
	buffer_load_dword v25, v24, s[48:51], 0 offen sc1
	v_mfma_f32_16x16x32_bf16 v[44:47], a[52:55], a[244:247], v[44:47]
	v_exp_f32 v35, v35
	v_mfma_f32_16x16x32_bf16 v[44:47], a[48:51], a[240:243], v[44:47]
	ds_read_b128 a[16:19], v9 offset:4096
	v_cvt_pk_bf16_f32 v57, v34, v35
	v_smfmac_f32_16x16x64_bf16 a[136:139], a[128:131], v[48:55], v31
	v_mfma_f32_16x16x32_bf16 v[136:139], a[64:67], v[48:51], v[136:139]
	v_exp_f32 v36, v36
	v_mfma_f32_16x16x32_bf16 v[136:139], a[96:99], v[52:55], v[136:139]
	ds_read_b128 a[32:35], v9 offset:8192
	ds_read_b128 a[36:39], v10 offset:8192
	v_mfma_f32_16x16x32_bf16 v[152:155], a[100:103], v[52:55], v[152:155]
	v_exp_f32 v37, v37
	v_mfma_f32_16x16x32_bf16 v[152:155], a[68:71], v[48:51], v[152:155]
	s_add_u32 m0, s64, 0x2000
	ds_read_b128 a[40:43], v11 offset:8192
	v_cvt_pk_bf16_f32 v58, v36, v37
	v_mfma_f32_16x16x32_bf16 v[168:171], a[72:75], v[48:51], v[168:171]
	s_mov_b32 s66, 0x1c00
	v_exp_f32 v38, v38
	v_mfma_f32_16x16x32_bf16 v[168:171], a[104:107], v[52:55], v[168:171]
	buffer_load_dwordx4 v16, s[28:31], s66 offen offset:1024 lds
	v_mfma_f32_16x16x32_bf16 v[184:187], a[108:111], v[52:55], v[184:187]
	v_exp_f32 v39, v39
	v_mfma_f32_16x16x32_bf16 v[184:187], a[76:79], v[48:51], v[184:187]
	s_waitcnt lgkmcnt(4)
	ds_read_b128 a[44:47], v12 offset:8192
	v_cvt_pk_bf16_f32 v59, v38, v39
	v_mfma_f32_16x16x32_bf16 v[32:35], a[0:3], a[192:195], -4.0
	s_add_u32 m0, s64, 0x2000
	s_mov_b32 s66, 0x3800
	v_exp_f32 v40, v40
	v_mfma_f32_16x16x32_bf16 v[32:35], a[4:7], a[196:199], v[32:35]
	buffer_load_dwordx4 v16, s[28:31], s66 offen offset:2048 lds
	v_mfma_f32_16x16x32_bf16 v[32:35], a[8:11], a[200:203], v[32:35]
	v_exp_f32 v41, v41
	v_mfma_f32_16x16x32_bf16 v[32:35], a[12:15], a[204:207], v[32:35]
	ds_read_b128 a[60:63], v12 offset:12288
	v_cvt_pk_bf16_f32 v60, v40, v41
	v_mfma_f32_16x16x32_bf16 v[36:39], a[28:31], a[204:207], -4.0
	s_mov_b32 s66, 0x5400
	v_exp_f32 v42, v42
	v_mfma_f32_16x16x32_bf16 v[36:39], a[24:27], a[200:203], v[36:39]
	buffer_load_dwordx4 v16, s[28:31], s66 offen offset:3072 lds
	v_mfma_f32_16x16x32_bf16 v[36:39], a[20:23], a[196:199], v[36:39]
	s_waitcnt lgkmcnt(2)
	v_exp_f32 v43, v43
	v_mfma_f32_16x16x32_bf16 v[36:39], a[16:19], a[192:195], v[36:39]
	s_add_u32 m0, s64, 0x3000
	ds_read_b128 a[56:59], v11 offset:12288
	v_cvt_pk_bf16_f32 v61, v42, v43
	v_mfma_f32_16x16x32_bf16 v[200:203], a[80:83], v[48:51], v[200:203]
	s_mov_b32 s66, 0x8000
	v_exp_f32 v44, v44
	v_mfma_f32_16x16x32_bf16 v[200:203], a[112:115], v[52:55], v[200:203]
	buffer_load_dwordx4 v16, s[28:31], s66 offen offset:0 lds
	v_mfma_f32_16x16x32_bf16 v[216:219], a[116:119], v[52:55], v[216:219]
	v_exp_f32 v45, v45
	v_mfma_f32_16x16x32_bf16 v[216:219], a[84:87], v[48:51], v[216:219]
	ds_read_b128 a[52:55], v10 offset:12288
	v_cvt_pk_bf16_f32 v62, v44, v45
	v_mfma_f32_16x16x32_bf16 v[232:235], a[88:91], v[48:51], v[232:235]
	s_mov_b32 s66, 0x9c00
	v_exp_f32 v46, v46
	v_mfma_f32_16x16x32_bf16 v[232:235], a[120:123], v[52:55], v[232:235]
	buffer_load_dwordx4 v16, s[28:31], s66 offen offset:1024 lds
	v_mfma_f32_16x16x32_bf16 v[248:251], a[124:127], v[52:55], v[248:251]
	v_exp_f32 v47, v47
	v_mfma_f32_16x16x32_bf16 v[248:251], a[92:95], v[48:51], v[248:251]
	ds_read_b128 a[48:51], v9 offset:12288
	v_cvt_pk_bf16_f32 v63, v46, v47
	v_mfma_f32_16x16x32_bf16 v[40:43], a[32:35], a[192:195], -4.0
	s_add_u32 m0, s64, 0x3000
	s_mov_b32 s66, 0xb800
	v_exp_f32 v32, v32
	v_mfma_f32_16x16x32_bf16 v[40:43], a[36:39], a[196:199], v[40:43]
	buffer_load_dwordx4 v16, s[28:31], s66 offen offset:2048 lds
	v_mfma_f32_16x16x32_bf16 v[40:43], a[40:43], a[200:203], v[40:43]
	s_waitcnt lgkmcnt(2)
	v_exp_f32 v33, v33
	v_mfma_f32_16x16x32_bf16 v[40:43], a[44:47], a[204:207], v[40:43]
	v_cvt_pk_bf16_f32 v48, v32, v33
	v_and_or_b32 v115, v114, 15, v113
	v_mfma_f32_16x16x32_bf16 v[44:47], a[60:63], a[204:207], -4.0
	s_mov_b32 s66, 0xd400
	v_exp_f32 v34, v34
	v_mfma_f32_16x16x32_bf16 v[44:47], a[56:59], a[200:203], v[44:47]
	s_waitcnt lgkmcnt(1)
	buffer_load_dwordx4 v16, s[28:31], s66 offen offset:3072 lds
	v_mfma_f32_16x16x32_bf16 v[44:47], a[52:55], a[196:199], v[44:47]
	s_waitcnt lgkmcnt(0)
	v_exp_f32 v35, v35
	v_mfma_f32_16x16x32_bf16 v[44:47], a[48:51], a[192:195], v[44:47]
	v_cvt_pk_bf16_f32 v49, v34, v35
	v_bfe_u32 v114, v114, 4, 8
	v_smfmac_f32_16x16x64_bf16 a[136:139], a[168:171], v[56:63], v31
	v_mfma_f32_16x16x32_bf16 v[140:143], a[64:67], v[56:59], v[140:143]
	v_exp_f32 v36, v36
	v_mfma_f32_16x16x32_bf16 v[140:143], a[96:99], v[60:63], v[140:143]
	ds_read_b64_tr_b16 a[64:65], v1 offset:0
	ds_read_b64_tr_b16 a[66:67], v1 offset:4096
	v_mfma_f32_16x16x32_bf16 v[156:159], a[100:103], v[60:63], v[156:159]
	v_exp_f32 v37, v37
	v_mfma_f32_16x16x32_bf16 v[156:159], a[68:71], v[56:59], v[156:159]
	ds_read_b64_tr_b16 a[96:97], v1 offset:8192
	v_cvt_pk_bf16_f32 v50, v36, v37
	v_mfma_f32_16x16x32_bf16 v[172:175], a[72:75], v[56:59], v[172:175]
	v_exp_f32 v38, v38
	v_mfma_f32_16x16x32_bf16 v[172:175], a[104:107], v[60:63], v[172:175]
	ds_read_b64_tr_b16 a[98:99], v1 offset:12288
	ds_read_b64_tr_b16 a[100:101], v2 offset:8192
	v_mfma_f32_16x16x32_bf16 v[188:191], a[108:111], v[60:63], v[188:191]
	v_exp_f32 v39, v39
	v_mfma_f32_16x16x32_bf16 v[188:191], a[76:79], v[56:59], v[188:191]
	ds_read_b64_tr_b16 a[102:103], v2 offset:12288
	v_cvt_pk_bf16_f32 v51, v38, v39
	v_mfma_f32_16x16x32_bf16 v[32:35], a[0:3], a[208:211], -4.0
	v_exp_f32 v40, v40
	v_mfma_f32_16x16x32_bf16 v[32:35], a[4:7], a[212:215], v[32:35]
	ds_read_b64_tr_b16 a[68:69], v2 offset:0
	ds_read_b64_tr_b16 a[70:71], v2 offset:4096
	v_mfma_f32_16x16x32_bf16 v[32:35], a[8:11], a[216:219], v[32:35]
	v_exp_f32 v41, v41
	v_mfma_f32_16x16x32_bf16 v[32:35], a[12:15], a[220:223], v[32:35]
	ds_read_b64_tr_b16 a[72:73], v3 offset:0
	v_cvt_pk_bf16_f32 v52, v40, v41
	v_mfma_f32_16x16x32_bf16 v[36:39], a[28:31], a[220:223], -4.0
	v_exp_f32 v42, v42
	v_mfma_f32_16x16x32_bf16 v[36:39], a[24:27], a[216:219], v[36:39]
	ds_read_b64_tr_b16 a[74:75], v3 offset:4096
	ds_read_b64_tr_b16 a[104:105], v3 offset:8192
	v_mfma_f32_16x16x32_bf16 v[36:39], a[20:23], a[212:215], v[36:39]
	v_exp_f32 v43, v43
	v_mfma_f32_16x16x32_bf16 v[36:39], a[16:19], a[208:211], v[36:39]
	ds_read_b64_tr_b16 a[106:107], v3 offset:12288
	v_cvt_pk_bf16_f32 v53, v42, v43
	v_mfma_f32_16x16x32_bf16 v[204:207], a[80:83], v[56:59], v[204:207]
	v_exp_f32 v44, v44
	v_mfma_f32_16x16x32_bf16 v[204:207], a[112:115], v[60:63], v[204:207]
	ds_read_b64_tr_b16 a[108:109], v4 offset:8192
	ds_read_b64_tr_b16 a[110:111], v4 offset:12288
	v_mfma_f32_16x16x32_bf16 v[220:223], a[116:119], v[60:63], v[220:223]
	v_exp_f32 v45, v45
	v_mfma_f32_16x16x32_bf16 v[220:223], a[84:87], v[56:59], v[220:223]
	ds_read_b64_tr_b16 a[76:77], v4 offset:0
	v_cvt_pk_bf16_f32 v54, v44, v45
	v_mfma_f32_16x16x32_bf16 v[236:239], a[88:91], v[56:59], v[236:239]
	v_exp_f32 v46, v46
	v_mfma_f32_16x16x32_bf16 v[236:239], a[120:123], v[60:63], v[236:239]
	ds_read_b64_tr_b16 a[78:79], v4 offset:4096
	ds_read_b64_tr_b16 a[80:81], v5 offset:0
	v_mfma_f32_16x16x32_bf16 v[252:255], a[124:127], v[60:63], v[252:255]
	v_exp_f32 v47, v47
	v_mfma_f32_16x16x32_bf16 v[252:255], a[92:95], v[56:59], v[252:255]
	ds_read_b64_tr_b16 a[82:83], v5 offset:4096
	v_cvt_pk_bf16_f32 v55, v46, v47
	v_mfma_f32_16x16x32_bf16 v[40:43], a[32:35], a[208:211], -4.0
	v_exp_f32 v32, v32
	v_mfma_f32_16x16x32_bf16 v[40:43], a[36:39], a[212:215], v[40:43]
	ds_read_b64_tr_b16 a[112:113], v5 offset:8192
	ds_read_b64_tr_b16 a[114:115], v5 offset:12288
	v_mfma_f32_16x16x32_bf16 v[40:43], a[40:43], a[216:219], v[40:43]
	v_exp_f32 v33, v33
	v_mfma_f32_16x16x32_bf16 v[40:43], a[44:47], a[220:223], v[40:43]
	ds_read_b64_tr_b16 a[116:117], v6 offset:8192
	v_cvt_pk_bf16_f32 v56, v32, v33
	v_mfma_f32_16x16x32_bf16 v[44:47], a[60:63], a[220:223], -4.0
	v_exp_f32 v34, v34
	v_mfma_f32_16x16x32_bf16 v[44:47], a[56:59], a[216:219], v[44:47]
	ds_read_b64_tr_b16 a[118:119], v6 offset:12288
	ds_read_b64_tr_b16 a[84:85], v6 offset:0
	v_mfma_f32_16x16x32_bf16 v[44:47], a[52:55], a[212:215], v[44:47]
	v_exp_f32 v35, v35
	v_mfma_f32_16x16x32_bf16 v[44:47], a[48:51], a[208:211], v[44:47]
	ds_read_b64_tr_b16 a[86:87], v6 offset:4096
	v_cvt_pk_bf16_f32 v57, v34, v35
	v_smfmac_f32_16x16x64_bf16 a[132:135], a[128:131], v[48:55], v31
	s_waitcnt lgkmcnt(7)
	v_mfma_f32_16x16x32_bf16 v[128:131], a[64:67], v[48:51], v[128:131]
	v_exp_f32 v36, v36
	v_mfma_f32_16x16x32_bf16 v[128:131], a[96:99], v[52:55], v[128:131]
	ds_read_b64_tr_b16 a[88:89], v7 offset:0
	ds_read_b64_tr_b16 a[90:91], v7 offset:4096
	v_mfma_f32_16x16x32_bf16 v[144:147], a[100:103], v[52:55], v[144:147]
	v_exp_f32 v37, v37
	v_mfma_f32_16x16x32_bf16 v[144:147], a[68:71], v[48:51], v[144:147]
	ds_read_b64_tr_b16 a[120:121], v7 offset:8192
	v_cvt_pk_bf16_f32 v58, v36, v37
	v_mfma_f32_16x16x32_bf16 v[160:163], a[72:75], v[48:51], v[160:163]
	v_exp_f32 v38, v38
	v_mfma_f32_16x16x32_bf16 v[160:163], a[104:107], v[52:55], v[160:163]
	ds_read_b64_tr_b16 a[122:123], v7 offset:12288
	ds_read_b64_tr_b16 a[124:125], v8 offset:8192
	v_mfma_f32_16x16x32_bf16 v[176:179], a[108:111], v[52:55], v[176:179]
	v_exp_f32 v39, v39
	v_mfma_f32_16x16x32_bf16 v[176:179], a[76:79], v[48:51], v[176:179]
	ds_read_b64_tr_b16 a[126:127], v8 offset:12288
	v_cvt_pk_bf16_f32 v59, v38, v39
	v_mfma_f32_16x16x32_bf16 v[32:35], a[0:3], a[224:227], -4.0
	v_exp_f32 v40, v40
	v_mfma_f32_16x16x32_bf16 v[32:35], a[4:7], a[228:231], v[32:35]
	ds_read_b64_tr_b16 a[92:93], v8 offset:0
	ds_read_b64_tr_b16 a[94:95], v8 offset:4096
	v_mfma_f32_16x16x32_bf16 v[32:35], a[8:11], a[232:235], v[32:35]
	v_exp_f32 v41, v41
	v_mfma_f32_16x16x32_bf16 v[32:35], a[12:15], a[236:239], v[32:35]
	v_cvt_pk_bf16_f32 v60, v40, v41
	v_lshl_or_b32 v115, v114, 10, v115
	v_mfma_f32_16x16x32_bf16 v[36:39], a[28:31], a[236:239], -4.0
	v_exp_f32 v42, v42
	v_mfma_f32_16x16x32_bf16 v[36:39], a[24:27], a[232:235], v[36:39]
	v_lshlrev_b32 v115, 4, v115
	v_add_u32 v27, 0x1000, v115
	v_mfma_f32_16x16x32_bf16 v[36:39], a[20:23], a[228:231], v[36:39]
	v_exp_f32 v43, v43
	v_mfma_f32_16x16x32_bf16 v[36:39], a[16:19], a[224:227], v[36:39]
	s_waitcnt lgkmcnt(3)
	s_add_u32 m0, s64, 0x4000
	v_cvt_pk_bf16_f32 v61, v42, v43
	v_add_u32 v114, -2, v112
	v_mfma_f32_16x16x32_bf16 v[192:195], a[80:83], v[48:51], v[192:195]
	s_mov_b32 s66, 0x10000
	v_exp_f32 v44, v44
	v_mfma_f32_16x16x32_bf16 v[192:195], a[112:115], v[52:55], v[192:195]
	buffer_load_dwordx4 v16, s[28:31], s66 offen offset:0 lds
	v_mfma_f32_16x16x32_bf16 v[208:211], a[116:119], v[52:55], v[208:211]
	v_exp_f32 v45, v45
	v_mfma_f32_16x16x32_bf16 v[208:211], a[84:87], v[48:51], v[208:211]
	v_cvt_pk_bf16_f32 v62, v44, v45
	v_and_or_b32 v115, v114, 15, v113
	v_mfma_f32_16x16x32_bf16 v[224:227], a[88:91], v[48:51], v[224:227]
	v_exp_f32 v46, v46
	v_mfma_f32_16x16x32_bf16 v[224:227], a[120:123], v[52:55], v[224:227]
	s_waitcnt vmcnt(8)
	v_cmp_ne_u32 vcc, 1, v25
	s_cbranch_vccnz L_spin2
L_back2:
	s_waitcnt lgkmcnt(0)
	v_mfma_f32_16x16x32_bf16 v[240:243], a[124:127], v[52:55], v[240:243]
	v_exp_f32 v47, v47
	v_mfma_f32_16x16x32_bf16 v[240:243], a[92:95], v[48:51], v[240:243]
	s_barrier
	v_cvt_pk_bf16_f32 v63, v46, v47
	v_bfe_u32 v114, v114, 4, 8
	v_lshl_or_b32 v115, v114, 10, v115
	v_lshlrev_b32 v115, 4, v115
	v_add_u32 v28, 0x2000, v115
	v_add_u32_e64 v114, 2, v112
	v_and_or_b32 v115, v114, 15, v113
	v_bfe_u32 v114, v114, 4, 8
	v_lshl_or_b32 v115, v114, 10, v115
	v_lshlrev_b32 v115, 4, v115
	v_add_u32 v29, 0x3000, v115
	v_mfma_f32_16x16x32_bf16 v[40:43], a[32:35], a[224:227], -4.0
	s_add_u32 m0, s65, 0x0
	v_exp_f32 v32, v32
	v_mfma_f32_16x16x32_bf16 v[40:43], a[36:39], a[228:231], v[40:43]
	buffer_load_dwordx4 v18, s[8:11], s68 offen lds
	v_mfma_f32_16x16x32_bf16 v[40:43], a[40:43], a[232:235], v[40:43]
	v_exp_f32 v33, v33
	v_mfma_f32_16x16x32_bf16 v[40:43], a[44:47], a[236:239], v[40:43]
	v_cvt_pk_bf16_f32 v48, v32, v33
	v_mfma_f32_16x16x32_bf16 v[44:47], a[60:63], a[236:239], -4.0
	v_exp_f32 v34, v34
	v_mfma_f32_16x16x32_bf16 v[44:47], a[56:59], a[232:235], v[44:47]
	buffer_load_dwordx4 v19, s[8:11], s68 offen offset:1024 lds
	v_mfma_f32_16x16x32_bf16 v[44:47], a[52:55], a[228:231], v[44:47]
	s_add_u32 s68, s68, 0x2000
	v_exp_f32 v35, v35
	v_mfma_f32_16x16x32_bf16 v[44:47], a[48:51], a[224:227], v[44:47]
L_pg6:
	s_cbranch_execz L_pg10
	s_and_b32 s68, s68, 0x7ffff
	v_cvt_pk_bf16_f32 v49, v34, v35
	v_smfmac_f32_16x16x64_bf16 a[132:135], a[168:171], v[56:63], v31
	v_mfma_f32_16x16x32_bf16 v[132:135], a[64:67], v[56:59], v[132:135]
	s_add_u32 m0, s65, 0x2000
	v_exp_f32 v36, v36
	v_mfma_f32_16x16x32_bf16 v[132:135], a[96:99], v[60:63], v[132:135]
	buffer_load_dwordx4 v18, s[8:11], s68 offen lds
	v_mfma_f32_16x16x32_bf16 v[148:151], a[100:103], v[60:63], v[148:151]
	v_exp_f32 v37, v37
	v_mfma_f32_16x16x32_bf16 v[148:151], a[68:71], v[56:59], v[148:151]
	v_cvt_pk_bf16_f32 v50, v36, v37
	v_mfma_f32_16x16x32_bf16 v[164:167], a[72:75], v[56:59], v[164:167]
	v_exp_f32 v38, v38
	v_mfma_f32_16x16x32_bf16 v[164:167], a[104:107], v[60:63], v[164:167]
	buffer_load_dwordx4 v19, s[8:11], s68 offen offset:1024 lds
	v_mfma_f32_16x16x32_bf16 v[180:183], a[108:111], v[60:63], v[180:183]
	s_add_u32 s68, s68, 0x2000
	v_exp_f32 v39, v39
	v_mfma_f32_16x16x32_bf16 v[180:183], a[76:79], v[56:59], v[180:183]
	s_and_b32 s68, s68, 0x7ffff
	v_cvt_pk_bf16_f32 v51, v38, v39
	v_mfma_f32_16x16x32_bf16 v[32:35], a[0:3], a[240:243], -4.0
	s_add_u32 m0, s65, 0x8000
	v_exp_f32 v40, v40
	v_mfma_f32_16x16x32_bf16 v[32:35], a[4:7], a[244:247], v[32:35]
	buffer_load_dwordx4 v20, s[12:15], s69 offen lds
	v_mfma_f32_16x16x32_bf16 v[32:35], a[8:11], a[248:251], v[32:35]
	v_exp_f32 v41, v41
	v_mfma_f32_16x16x32_bf16 v[32:35], a[12:15], a[252:255], v[32:35]
	ds_read_b128 a[0:3], v9 offset:16384
	v_cvt_pk_bf16_f32 v52, v40, v41
	v_mfma_f32_16x16x32_bf16 v[36:39], a[28:31], a[252:255], -4.0
	v_exp_f32 v42, v42
	v_mfma_f32_16x16x32_bf16 v[36:39], a[24:27], a[248:251], v[36:39]
	buffer_load_dwordx4 v21, s[12:15], s69 offen offset:1024 lds
	v_mfma_f32_16x16x32_bf16 v[36:39], a[20:23], a[244:247], v[36:39]
	v_exp_f32 v43, v43
	v_mfma_f32_16x16x32_bf16 v[36:39], a[16:19], a[240:243], v[36:39]
	ds_read_b128 a[4:7], v10 offset:16384
	v_cvt_pk_bf16_f32 v53, v42, v43
	v_mfma_f32_16x16x32_bf16 v[196:199], a[80:83], v[56:59], v[196:199]
	v_exp_f32 v44, v44
	v_mfma_f32_16x16x32_bf16 v[196:199], a[112:115], v[60:63], v[196:199]
	ds_read_b128 a[8:11], v11 offset:16384
	ds_read_b128 a[12:15], v12 offset:16384
	v_mfma_f32_16x16x32_bf16 v[212:215], a[116:119], v[60:63], v[212:215]
	s_add_u32 s69, s69, 0x2000
	v_exp_f32 v45, v45
	v_mfma_f32_16x16x32_bf16 v[212:215], a[84:87], v[56:59], v[212:215]
	s_and_b32 s69, s69, 0x7ffff
	ds_read_b128 a[28:31], v12 offset:20480
	v_cvt_pk_bf16_f32 v54, v44, v45
	v_mfma_f32_16x16x32_bf16 v[228:231], a[88:91], v[56:59], v[228:231]
	s_add_u32 m0, s65, 0xa000
	v_exp_f32 v46, v46
	v_mfma_f32_16x16x32_bf16 v[228:231], a[120:123], v[60:63], v[228:231]
	buffer_load_dwordx4 v20, s[12:15], s69 offen lds
	v_mfma_f32_16x16x32_bf16 v[244:247], a[124:127], v[60:63], v[244:247]
	v_exp_f32 v47, v47
	v_mfma_f32_16x16x32_bf16 v[244:247], a[92:95], v[56:59], v[244:247]
	ds_read_b128 a[24:27], v11 offset:20480
	v_cvt_pk_bf16_f32 v55, v46, v47
	v_mfma_f32_16x16x32_bf16 v[40:43], a[32:35], a[240:243], -4.0
	s_add_u32 m0, s65, 0xa000
	v_exp_f32 v32, v32
	v_mfma_f32_16x16x32_bf16 v[40:43], a[36:39], a[244:247], v[40:43]
	buffer_load_dwordx4 v21, s[12:15], s69 offen offset:1024 lds
	v_mfma_f32_16x16x32_bf16 v[40:43], a[40:43], a[248:251], v[40:43]
	v_exp_f32 v33, v33
	v_mfma_f32_16x16x32_bf16 v[40:43], a[44:47], a[252:255], v[40:43]
	s_add_u32 s69, s69, 0x2000
	ds_read_b128 a[20:23], v10 offset:20480
	v_cvt_pk_bf16_f32 v56, v32, v33
	v_mfma_f32_16x16x32_bf16 v[44:47], a[60:63], a[252:255], -4.0
	s_and_b32 s69, s69, 0x7ffff
	v_exp_f32 v34, v34
	v_mfma_f32_16x16x32_bf16 v[44:47], a[56:59], a[248:251], v[44:47]
	buffer_load_dwordx4 v[64:67], v26, s[52:55], 0 offen offset:0 sc1
	v_mfma_f32_16x16x32_bf16 v[44:47], a[52:55], a[244:247], v[44:47]
	v_exp_f32 v35, v35
	v_mfma_f32_16x16x32_bf16 v[44:47], a[48:51], a[240:243], v[44:47]
	ds_read_b128 a[16:19], v9 offset:20480
	v_cvt_pk_bf16_f32 v57, v34, v35
	v_smfmac_f32_16x16x64_bf16 a[136:139], a[128:131], v[48:55], v31
	v_mfma_f32_16x16x32_bf16 v[136:139], a[64:67], v[48:51], v[136:139]
	v_exp_f32 v36, v36
	v_mfma_f32_16x16x32_bf16 v[136:139], a[96:99], v[52:55], v[136:139]
	ds_read_b128 a[32:35], v9 offset:24576
	ds_read_b128 a[36:39], v10 offset:24576
	v_mfma_f32_16x16x32_bf16 v[152:155], a[100:103], v[52:55], v[152:155]
	v_exp_f32 v37, v37
	v_mfma_f32_16x16x32_bf16 v[152:155], a[68:71], v[48:51], v[152:155]
	s_add_u32 m0, s64, 0x4000
	ds_read_b128 a[40:43], v11 offset:24576
	v_cvt_pk_bf16_f32 v58, v36, v37
	v_mfma_f32_16x16x32_bf16 v[168:171], a[72:75], v[48:51], v[168:171]
	s_mov_b32 s66, 0x11c00
	v_exp_f32 v38, v38
	v_mfma_f32_16x16x32_bf16 v[168:171], a[104:107], v[52:55], v[168:171]
	buffer_load_dwordx4 v16, s[28:31], s66 offen offset:1024 lds
	v_mfma_f32_16x16x32_bf16 v[184:187], a[108:111], v[52:55], v[184:187]
	v_exp_f32 v39, v39
	v_mfma_f32_16x16x32_bf16 v[184:187], a[76:79], v[48:51], v[184:187]
	s_waitcnt lgkmcnt(4)
	ds_read_b128 a[44:47], v12 offset:24576
	v_cvt_pk_bf16_f32 v59, v38, v39
	v_mfma_f32_16x16x32_bf16 v[32:35], a[0:3], a[192:195], -4.0
	v_exp_f32 v40, v40
	v_mfma_f32_16x16x32_bf16 v[32:35], a[4:7], a[196:199], v[32:35]
	buffer_load_dwordx4 v[68:71], v26, s[52:55], 0 offen offset:1024 sc1
	v_mfma_f32_16x16x32_bf16 v[32:35], a[8:11], a[200:203], v[32:35]
	v_exp_f32 v41, v41
	v_mfma_f32_16x16x32_bf16 v[32:35], a[12:15], a[204:207], v[32:35]
	ds_read_b128 a[60:63], v12 offset:28672
	v_cvt_pk_bf16_f32 v60, v40, v41
	v_mfma_f32_16x16x32_bf16 v[36:39], a[28:31], a[204:207], -4.0
	v_exp_f32 v42, v42
	v_mfma_f32_16x16x32_bf16 v[36:39], a[24:27], a[200:203], v[36:39]
	buffer_load_dwordx4 v[72:75], v26, s[52:55], 0 offen offset:2048 sc1
	v_mfma_f32_16x16x32_bf16 v[36:39], a[20:23], a[196:199], v[36:39]
	s_waitcnt lgkmcnt(2)
	v_exp_f32 v43, v43
	v_mfma_f32_16x16x32_bf16 v[36:39], a[16:19], a[192:195], v[36:39]
	s_add_u32 m0, s64, 0x4000
	ds_read_b128 a[56:59], v11 offset:28672
	v_cvt_pk_bf16_f32 v61, v42, v43
	v_mfma_f32_16x16x32_bf16 v[200:203], a[80:83], v[48:51], v[200:203]
	s_mov_b32 s66, 0x13800
	v_exp_f32 v44, v44
	v_mfma_f32_16x16x32_bf16 v[200:203], a[112:115], v[52:55], v[200:203]
	buffer_load_dwordx4 v16, s[28:31], s66 offen offset:2048 lds
	v_mfma_f32_16x16x32_bf16 v[216:219], a[116:119], v[52:55], v[216:219]
	v_exp_f32 v45, v45
	v_mfma_f32_16x16x32_bf16 v[216:219], a[84:87], v[48:51], v[216:219]
	ds_read_b128 a[52:55], v10 offset:28672
	v_cvt_pk_bf16_f32 v62, v44, v45
	v_mfma_f32_16x16x32_bf16 v[232:235], a[88:91], v[48:51], v[232:235]
	s_mov_b32 s66, 0x15400
	v_exp_f32 v46, v46
	v_mfma_f32_16x16x32_bf16 v[232:235], a[120:123], v[52:55], v[232:235]
	buffer_load_dwordx4 v16, s[28:31], s66 offen offset:3072 lds
	v_mfma_f32_16x16x32_bf16 v[248:251], a[124:127], v[52:55], v[248:251]
	v_exp_f32 v47, v47
	v_mfma_f32_16x16x32_bf16 v[248:251], a[92:95], v[48:51], v[248:251]
	ds_read_b128 a[48:51], v9 offset:28672
	v_cvt_pk_bf16_f32 v63, v46, v47
	v_mfma_f32_16x16x32_bf16 v[40:43], a[32:35], a[192:195], -4.0
	v_exp_f32 v32, v32
	v_mfma_f32_16x16x32_bf16 v[40:43], a[36:39], a[196:199], v[40:43]
	buffer_load_dwordx4 v[76:79], v26, s[52:55], 0 offen offset:3072 sc1
	v_mfma_f32_16x16x32_bf16 v[40:43], a[40:43], a[200:203], v[40:43]
	s_waitcnt lgkmcnt(2)
	v_exp_f32 v33, v33
	v_mfma_f32_16x16x32_bf16 v[40:43], a[44:47], a[204:207], v[40:43]
	s_add_u32 m0, s64, 0x5000
	v_cvt_pk_bf16_f32 v48, v32, v33
	v_mfma_f32_16x16x32_bf16 v[44:47], a[60:63], a[204:207], -4.0
	s_mov_b32 s66, 0x18000
	v_exp_f32 v34, v34
	v_mfma_f32_16x16x32_bf16 v[44:47], a[56:59], a[200:203], v[44:47]
	s_waitcnt lgkmcnt(1)
	buffer_load_dwordx4 v16, s[28:31], s66 offen offset:0 lds
	v_mfma_f32_16x16x32_bf16 v[44:47], a[52:55], a[196:199], v[44:47]
	s_waitcnt lgkmcnt(0)
	v_exp_f32 v35, v35
	v_mfma_f32_16x16x32_bf16 v[44:47], a[48:51], a[192:195], v[44:47]
	v_cvt_pk_bf16_f32 v49, v34, v35
	v_smfmac_f32_16x16x64_bf16 a[136:139], a[168:171], v[56:63], v31
	v_mfma_f32_16x16x32_bf16 v[140:143], a[64:67], v[56:59], v[140:143]
	v_exp_f32 v36, v36
	v_mfma_f32_16x16x32_bf16 v[140:143], a[96:99], v[60:63], v[140:143]
	ds_read_b64_tr_b16 a[64:65], v1 offset:16384
	ds_read_b64_tr_b16 a[66:67], v1 offset:20480
	v_mfma_f32_16x16x32_bf16 v[156:159], a[100:103], v[60:63], v[156:159]
	v_exp_f32 v37, v37
	v_mfma_f32_16x16x32_bf16 v[156:159], a[68:71], v[56:59], v[156:159]
	ds_read_b64_tr_b16 a[96:97], v1 offset:24576
	v_cvt_pk_bf16_f32 v50, v36, v37
	v_mfma_f32_16x16x32_bf16 v[172:175], a[72:75], v[56:59], v[172:175]
	v_exp_f32 v38, v38
	v_mfma_f32_16x16x32_bf16 v[172:175], a[104:107], v[60:63], v[172:175]
	ds_read_b64_tr_b16 a[98:99], v1 offset:28672
	ds_read_b64_tr_b16 a[100:101], v2 offset:24576
	v_mfma_f32_16x16x32_bf16 v[188:191], a[108:111], v[60:63], v[188:191]
	v_exp_f32 v39, v39
	v_mfma_f32_16x16x32_bf16 v[188:191], a[76:79], v[56:59], v[188:191]
	ds_read_b64_tr_b16 a[102:103], v2 offset:28672
	v_cvt_pk_bf16_f32 v51, v38, v39
	v_mfma_f32_16x16x32_bf16 v[32:35], a[0:3], a[208:211], -4.0
	v_exp_f32 v40, v40
	v_mfma_f32_16x16x32_bf16 v[32:35], a[4:7], a[212:215], v[32:35]
	ds_read_b64_tr_b16 a[68:69], v2 offset:16384
	ds_read_b64_tr_b16 a[70:71], v2 offset:20480
	v_mfma_f32_16x16x32_bf16 v[32:35], a[8:11], a[216:219], v[32:35]
	v_exp_f32 v41, v41
	v_mfma_f32_16x16x32_bf16 v[32:35], a[12:15], a[220:223], v[32:35]
	ds_read_b64_tr_b16 a[72:73], v3 offset:16384
	v_cvt_pk_bf16_f32 v52, v40, v41
	v_mfma_f32_16x16x32_bf16 v[36:39], a[28:31], a[220:223], -4.0
	v_exp_f32 v42, v42
	v_mfma_f32_16x16x32_bf16 v[36:39], a[24:27], a[216:219], v[36:39]
	ds_read_b64_tr_b16 a[74:75], v3 offset:20480
	ds_read_b64_tr_b16 a[104:105], v3 offset:24576
	v_mfma_f32_16x16x32_bf16 v[36:39], a[20:23], a[212:215], v[36:39]
	v_exp_f32 v43, v43
	v_mfma_f32_16x16x32_bf16 v[36:39], a[16:19], a[208:211], v[36:39]
	ds_read_b64_tr_b16 a[106:107], v3 offset:28672
	v_cvt_pk_bf16_f32 v53, v42, v43
	v_mfma_f32_16x16x32_bf16 v[204:207], a[80:83], v[56:59], v[204:207]
	v_exp_f32 v44, v44
	v_mfma_f32_16x16x32_bf16 v[204:207], a[112:115], v[60:63], v[204:207]
	ds_read_b64_tr_b16 a[108:109], v4 offset:24576
	ds_read_b64_tr_b16 a[110:111], v4 offset:28672
	v_mfma_f32_16x16x32_bf16 v[220:223], a[116:119], v[60:63], v[220:223]
	v_exp_f32 v45, v45
	v_mfma_f32_16x16x32_bf16 v[220:223], a[84:87], v[56:59], v[220:223]
	ds_read_b64_tr_b16 a[76:77], v4 offset:16384
	v_cvt_pk_bf16_f32 v54, v44, v45
	v_mfma_f32_16x16x32_bf16 v[236:239], a[88:91], v[56:59], v[236:239]
	v_exp_f32 v46, v46
	v_mfma_f32_16x16x32_bf16 v[236:239], a[120:123], v[60:63], v[236:239]
	ds_read_b64_tr_b16 a[78:79], v4 offset:20480
	ds_read_b64_tr_b16 a[80:81], v5 offset:16384
	v_mfma_f32_16x16x32_bf16 v[252:255], a[124:127], v[60:63], v[252:255]
	v_exp_f32 v47, v47
	v_mfma_f32_16x16x32_bf16 v[252:255], a[92:95], v[56:59], v[252:255]
	ds_read_b64_tr_b16 a[82:83], v5 offset:20480
	v_cvt_pk_bf16_f32 v55, v46, v47
	v_mfma_f32_16x16x32_bf16 v[40:43], a[32:35], a[208:211], -4.0
	v_exp_f32 v32, v32
	v_mfma_f32_16x16x32_bf16 v[40:43], a[36:39], a[212:215], v[40:43]
	ds_read_b64_tr_b16 a[112:113], v5 offset:24576
	ds_read_b64_tr_b16 a[114:115], v5 offset:28672
	v_mfma_f32_16x16x32_bf16 v[40:43], a[40:43], a[216:219], v[40:43]
	v_exp_f32 v33, v33
	v_mfma_f32_16x16x32_bf16 v[40:43], a[44:47], a[220:223], v[40:43]
	ds_read_b64_tr_b16 a[116:117], v6 offset:24576
	v_cvt_pk_bf16_f32 v56, v32, v33
	v_mfma_f32_16x16x32_bf16 v[44:47], a[60:63], a[220:223], -4.0
	v_exp_f32 v34, v34
	v_mfma_f32_16x16x32_bf16 v[44:47], a[56:59], a[216:219], v[44:47]
	ds_read_b64_tr_b16 a[118:119], v6 offset:28672
	ds_read_b64_tr_b16 a[84:85], v6 offset:16384
	v_mfma_f32_16x16x32_bf16 v[44:47], a[52:55], a[212:215], v[44:47]
	v_exp_f32 v35, v35
	v_mfma_f32_16x16x32_bf16 v[44:47], a[48:51], a[208:211], v[44:47]
	ds_read_b64_tr_b16 a[86:87], v6 offset:20480
	v_cvt_pk_bf16_f32 v57, v34, v35
	v_smfmac_f32_16x16x64_bf16 a[132:135], a[128:131], v[48:55], v31
	s_waitcnt lgkmcnt(7)
	v_mfma_f32_16x16x32_bf16 v[128:131], a[64:67], v[48:51], v[128:131]
	v_exp_f32 v36, v36
	v_mfma_f32_16x16x32_bf16 v[128:131], a[96:99], v[52:55], v[128:131]
	ds_read_b64_tr_b16 a[88:89], v7 offset:16384
	ds_read_b64_tr_b16 a[90:91], v7 offset:20480
	v_mfma_f32_16x16x32_bf16 v[144:147], a[100:103], v[52:55], v[144:147]
	v_exp_f32 v37, v37
	v_mfma_f32_16x16x32_bf16 v[144:147], a[68:71], v[48:51], v[144:147]
	ds_read_b64_tr_b16 a[120:121], v7 offset:24576
	v_cvt_pk_bf16_f32 v58, v36, v37
	v_mfma_f32_16x16x32_bf16 v[160:163], a[72:75], v[48:51], v[160:163]
	v_exp_f32 v38, v38
	v_mfma_f32_16x16x32_bf16 v[160:163], a[104:107], v[52:55], v[160:163]
	ds_read_b64_tr_b16 a[122:123], v7 offset:28672
	ds_read_b64_tr_b16 a[124:125], v8 offset:24576
	v_mfma_f32_16x16x32_bf16 v[176:179], a[108:111], v[52:55], v[176:179]
	v_exp_f32 v39, v39
	v_mfma_f32_16x16x32_bf16 v[176:179], a[76:79], v[48:51], v[176:179]
	ds_read_b64_tr_b16 a[126:127], v8 offset:28672
	v_cvt_pk_bf16_f32 v59, v38, v39
	v_mfma_f32_16x16x32_bf16 v[32:35], a[0:3], a[224:227], -4.0
	v_exp_f32 v40, v40
	v_mfma_f32_16x16x32_bf16 v[32:35], a[4:7], a[228:231], v[32:35]
	ds_read_b64_tr_b16 a[92:93], v8 offset:16384
	ds_read_b64_tr_b16 a[94:95], v8 offset:20480
	v_mfma_f32_16x16x32_bf16 v[32:35], a[8:11], a[232:235], v[32:35]
	v_exp_f32 v41, v41
	v_mfma_f32_16x16x32_bf16 v[32:35], a[12:15], a[236:239], v[32:35]
	v_cvt_pk_bf16_f32 v60, v40, v41
	v_mfma_f32_16x16x32_bf16 v[36:39], a[28:31], a[236:239], -4.0
	v_exp_f32 v42, v42
	v_mfma_f32_16x16x32_bf16 v[36:39], a[24:27], a[232:235], v[36:39]
	v_mfma_f32_16x16x32_bf16 v[36:39], a[20:23], a[228:231], v[36:39]
	v_exp_f32 v43, v43
	v_mfma_f32_16x16x32_bf16 v[36:39], a[16:19], a[224:227], v[36:39]
	s_waitcnt lgkmcnt(3)
	v_cvt_pk_bf16_f32 v61, v42, v43
	v_mfma_f32_16x16x32_bf16 v[192:195], a[80:83], v[48:51], v[192:195]
	v_exp_f32 v44, v44
	v_mfma_f32_16x16x32_bf16 v[192:195], a[112:115], v[52:55], v[192:195]
	buffer_load_dwordx4 v[80:83], v27, s[52:55], 0 offen offset:0 sc1
	v_mfma_f32_16x16x32_bf16 v[208:211], a[116:119], v[52:55], v[208:211]
	v_exp_f32 v45, v45
	v_mfma_f32_16x16x32_bf16 v[208:211], a[84:87], v[48:51], v[208:211]
	v_cvt_pk_bf16_f32 v62, v44, v45
	v_mfma_f32_16x16x32_bf16 v[224:227], a[88:91], v[48:51], v[224:227]
	v_exp_f32 v46, v46
	v_mfma_f32_16x16x32_bf16 v[224:227], a[120:123], v[52:55], v[224:227]
	s_waitcnt lgkmcnt(0)
	buffer_load_dwordx4 v[84:87], v27, s[52:55], 0 offen offset:1024 sc1
	v_mfma_f32_16x16x32_bf16 v[240:243], a[124:127], v[52:55], v[240:243]
	s_waitcnt vmcnt(10)
	v_exp_f32 v47, v47
	v_mfma_f32_16x16x32_bf16 v[240:243], a[92:95], v[48:51], v[240:243]
	s_barrier
	v_cvt_pk_bf16_f32 v63, v46, v47
	v_mfma_f32_16x16x32_bf16 v[40:43], a[32:35], a[224:227], -4.0
	s_add_u32 m0, s65, 0x4000
	v_exp_f32 v32, v32
	v_mfma_f32_16x16x32_bf16 v[40:43], a[36:39], a[228:231], v[40:43]
	buffer_load_dwordx4 v18, s[8:11], s68 offen lds
	v_mfma_f32_16x16x32_bf16 v[40:43], a[40:43], a[232:235], v[40:43]
	v_exp_f32 v33, v33
	v_mfma_f32_16x16x32_bf16 v[40:43], a[44:47], a[236:239], v[40:43]
	v_cvt_pk_bf16_f32 v48, v32, v33
	v_mfma_f32_16x16x32_bf16 v[44:47], a[60:63], a[236:239], -4.0
	v_exp_f32 v34, v34
	v_mfma_f32_16x16x32_bf16 v[44:47], a[56:59], a[232:235], v[44:47]
	buffer_load_dwordx4 v19, s[8:11], s68 offen offset:1024 lds
	v_mfma_f32_16x16x32_bf16 v[44:47], a[52:55], a[228:231], v[44:47]
	s_add_u32 s68, s68, 0x2000
	v_exp_f32 v35, v35
	v_mfma_f32_16x16x32_bf16 v[44:47], a[48:51], a[224:227], v[44:47]
	s_and_b32 s68, s68, 0x7ffff
	v_cvt_pk_bf16_f32 v49, v34, v35
	v_smfmac_f32_16x16x64_bf16 a[132:135], a[168:171], v[56:63], v31
	v_mfma_f32_16x16x32_bf16 v[132:135], a[64:67], v[56:59], v[132:135]
	s_add_u32 m0, s65, 0x6000
	v_exp_f32 v36, v36
	v_mfma_f32_16x16x32_bf16 v[132:135], a[96:99], v[60:63], v[132:135]
	buffer_load_dwordx4 v18, s[8:11], s68 offen lds
	v_mfma_f32_16x16x32_bf16 v[148:151], a[100:103], v[60:63], v[148:151]
	v_exp_f32 v37, v37
	v_mfma_f32_16x16x32_bf16 v[148:151], a[68:71], v[56:59], v[148:151]
	v_cvt_pk_bf16_f32 v50, v36, v37
	v_mfma_f32_16x16x32_bf16 v[164:167], a[72:75], v[56:59], v[164:167]
	v_exp_f32 v38, v38
	v_mfma_f32_16x16x32_bf16 v[164:167], a[104:107], v[60:63], v[164:167]
	buffer_load_dwordx4 v19, s[8:11], s68 offen offset:1024 lds
	v_mfma_f32_16x16x32_bf16 v[180:183], a[108:111], v[60:63], v[180:183]
	s_add_u32 s68, s68, 0x2000
	v_exp_f32 v39, v39
	v_mfma_f32_16x16x32_bf16 v[180:183], a[76:79], v[56:59], v[180:183]
	s_and_b32 s68, s68, 0x7ffff
	v_cvt_pk_bf16_f32 v51, v38, v39
	v_mfma_f32_16x16x32_bf16 v[32:35], a[0:3], a[240:243], -4.0
	s_add_u32 m0, s65, 0xc000
	v_exp_f32 v40, v40
	v_mfma_f32_16x16x32_bf16 v[32:35], a[4:7], a[244:247], v[32:35]
	buffer_load_dwordx4 v20, s[12:15], s69 offen lds
	v_mfma_f32_16x16x32_bf16 v[32:35], a[8:11], a[248:251], v[32:35]
	v_exp_f32 v41, v41
	v_mfma_f32_16x16x32_bf16 v[32:35], a[12:15], a[252:255], v[32:35]
	ds_read_b128 a[0:3], v9 offset:0
	v_cvt_pk_bf16_f32 v52, v40, v41
	v_mfma_f32_16x16x32_bf16 v[36:39], a[28:31], a[252:255], -4.0
	v_exp_f32 v42, v42
	v_mfma_f32_16x16x32_bf16 v[36:39], a[24:27], a[248:251], v[36:39]
	buffer_load_dwordx4 v21, s[12:15], s69 offen offset:1024 lds
	v_mfma_f32_16x16x32_bf16 v[36:39], a[20:23], a[244:247], v[36:39]
	v_exp_f32 v43, v43
	v_mfma_f32_16x16x32_bf16 v[36:39], a[16:19], a[240:243], v[36:39]
	ds_read_b128 a[4:7], v10 offset:0
	v_cvt_pk_bf16_f32 v53, v42, v43
	v_mfma_f32_16x16x32_bf16 v[196:199], a[80:83], v[56:59], v[196:199]
	v_exp_f32 v44, v44
	v_mfma_f32_16x16x32_bf16 v[196:199], a[112:115], v[60:63], v[196:199]
	ds_read_b128 a[8:11], v11 offset:0
	ds_read_b128 a[12:15], v12 offset:0
	v_mfma_f32_16x16x32_bf16 v[212:215], a[116:119], v[60:63], v[212:215]
	s_add_u32 s69, s69, 0x2000
	v_exp_f32 v45, v45
	v_mfma_f32_16x16x32_bf16 v[212:215], a[84:87], v[56:59], v[212:215]
	s_and_b32 s69, s69, 0x7ffff
	ds_read_b128 a[28:31], v12 offset:4096
	v_cvt_pk_bf16_f32 v54, v44, v45
	v_mfma_f32_16x16x32_bf16 v[228:231], a[88:91], v[56:59], v[228:231]
	s_add_u32 m0, s65, 0xe000
	v_exp_f32 v46, v46
	v_mfma_f32_16x16x32_bf16 v[228:231], a[120:123], v[60:63], v[228:231]
	buffer_load_dwordx4 v20, s[12:15], s69 offen lds
	v_mfma_f32_16x16x32_bf16 v[244:247], a[124:127], v[60:63], v[244:247]
	v_exp_f32 v47, v47
	v_mfma_f32_16x16x32_bf16 v[244:247], a[92:95], v[56:59], v[244:247]
	ds_read_b128 a[24:27], v11 offset:4096
	v_cvt_pk_bf16_f32 v55, v46, v47
	v_mfma_f32_16x16x32_bf16 v[40:43], a[32:35], a[240:243], -4.0
	s_add_u32 m0, s65, 0xe000
	v_exp_f32 v32, v32
	v_mfma_f32_16x16x32_bf16 v[40:43], a[36:39], a[244:247], v[40:43]
	buffer_load_dwordx4 v21, s[12:15], s69 offen offset:1024 lds
	v_mfma_f32_16x16x32_bf16 v[40:43], a[40:43], a[248:251], v[40:43]
	v_exp_f32 v33, v33
	v_mfma_f32_16x16x32_bf16 v[40:43], a[44:47], a[252:255], v[40:43]
	s_add_u32 s69, s69, 0x2000
	ds_read_b128 a[20:23], v10 offset:4096
	v_cvt_pk_bf16_f32 v56, v32, v33
	v_mfma_f32_16x16x32_bf16 v[44:47], a[60:63], a[252:255], -4.0
	s_and_b32 s69, s69, 0x7ffff
	v_exp_f32 v34, v34
	v_mfma_f32_16x16x32_bf16 v[44:47], a[56:59], a[248:251], v[44:47]
	buffer_load_dwordx4 v[88:91], v27, s[52:55], 0 offen offset:2048 sc1
	v_mfma_f32_16x16x32_bf16 v[44:47], a[52:55], a[244:247], v[44:47]
	v_exp_f32 v35, v35
	v_mfma_f32_16x16x32_bf16 v[44:47], a[48:51], a[240:243], v[44:47]
	ds_read_b128 a[16:19], v9 offset:4096
	v_cvt_pk_bf16_f32 v57, v34, v35
	v_smfmac_f32_16x16x64_bf16 a[136:139], a[128:131], v[48:55], v31
	v_mfma_f32_16x16x32_bf16 v[136:139], a[64:67], v[48:51], v[136:139]
	v_exp_f32 v36, v36
	v_mfma_f32_16x16x32_bf16 v[136:139], a[96:99], v[52:55], v[136:139]
	ds_read_b128 a[32:35], v9 offset:8192
	ds_read_b128 a[36:39], v10 offset:8192
	v_mfma_f32_16x16x32_bf16 v[152:155], a[100:103], v[52:55], v[152:155]
	v_exp_f32 v37, v37
	v_mfma_f32_16x16x32_bf16 v[152:155], a[68:71], v[48:51], v[152:155]
	s_add_u32 m0, s64, 0x5000
	ds_read_b128 a[40:43], v11 offset:8192
	v_cvt_pk_bf16_f32 v58, v36, v37
	v_mfma_f32_16x16x32_bf16 v[168:171], a[72:75], v[48:51], v[168:171]
	s_mov_b32 s66, 0x19c00
	v_exp_f32 v38, v38
	v_mfma_f32_16x16x32_bf16 v[168:171], a[104:107], v[52:55], v[168:171]
	buffer_load_dwordx4 v16, s[28:31], s66 offen offset:1024 lds
	v_mfma_f32_16x16x32_bf16 v[184:187], a[108:111], v[52:55], v[184:187]
	v_exp_f32 v39, v39
	v_mfma_f32_16x16x32_bf16 v[184:187], a[76:79], v[48:51], v[184:187]
	s_waitcnt lgkmcnt(4)
	ds_read_b128 a[44:47], v12 offset:8192
	v_cvt_pk_bf16_f32 v59, v38, v39
	v_mfma_f32_16x16x32_bf16 v[32:35], a[0:3], a[192:195], -4.0
	v_exp_f32 v40, v40
	v_mfma_f32_16x16x32_bf16 v[32:35], a[4:7], a[196:199], v[32:35]
	buffer_load_dwordx4 v[92:95], v27, s[52:55], 0 offen offset:3072 sc1
	v_mfma_f32_16x16x32_bf16 v[32:35], a[8:11], a[200:203], v[32:35]
	v_exp_f32 v41, v41
	v_mfma_f32_16x16x32_bf16 v[32:35], a[12:15], a[204:207], v[32:35]
	ds_read_b128 a[60:63], v12 offset:12288
	v_cvt_pk_bf16_f32 v60, v40, v41
	v_mfma_f32_16x16x32_bf16 v[36:39], a[28:31], a[204:207], -4.0
	v_exp_f32 v42, v42
	v_mfma_f32_16x16x32_bf16 v[36:39], a[24:27], a[200:203], v[36:39]
	buffer_load_dwordx4 v[96:99], v28, s[52:55], 0 offen offset:0 sc1
	v_mfma_f32_16x16x32_bf16 v[36:39], a[20:23], a[196:199], v[36:39]
	s_waitcnt lgkmcnt(2)
	v_exp_f32 v43, v43
	v_mfma_f32_16x16x32_bf16 v[36:39], a[16:19], a[192:195], v[36:39]
	s_add_u32 m0, s64, 0x5000
	ds_read_b128 a[56:59], v11 offset:12288
	v_cvt_pk_bf16_f32 v61, v42, v43
	v_mfma_f32_16x16x32_bf16 v[200:203], a[80:83], v[48:51], v[200:203]
	s_mov_b32 s66, 0x1b800
	v_exp_f32 v44, v44
	v_mfma_f32_16x16x32_bf16 v[200:203], a[112:115], v[52:55], v[200:203]
	buffer_load_dwordx4 v16, s[28:31], s66 offen offset:2048 lds
	v_mfma_f32_16x16x32_bf16 v[216:219], a[116:119], v[52:55], v[216:219]
	v_exp_f32 v45, v45
	v_mfma_f32_16x16x32_bf16 v[216:219], a[84:87], v[48:51], v[216:219]
	ds_read_b128 a[52:55], v10 offset:12288
	v_cvt_pk_bf16_f32 v62, v44, v45
	v_mfma_f32_16x16x32_bf16 v[232:235], a[88:91], v[48:51], v[232:235]
	s_mov_b32 s66, 0x1d400
	v_exp_f32 v46, v46
	v_mfma_f32_16x16x32_bf16 v[232:235], a[120:123], v[52:55], v[232:235]
	buffer_load_dwordx4 v16, s[28:31], s66 offen offset:3072 lds
	v_mfma_f32_16x16x32_bf16 v[248:251], a[124:127], v[52:55], v[248:251]
	v_exp_f32 v47, v47
	v_mfma_f32_16x16x32_bf16 v[248:251], a[92:95], v[48:51], v[248:251]
	ds_read_b128 a[48:51], v9 offset:12288
	v_cvt_pk_bf16_f32 v63, v46, v47
	v_mfma_f32_16x16x32_bf16 v[40:43], a[32:35], a[192:195], -4.0
	v_exp_f32 v32, v32
	v_mfma_f32_16x16x32_bf16 v[40:43], a[36:39], a[196:199], v[40:43]
	buffer_load_dwordx4 v[100:103], v28, s[52:55], 0 offen offset:1024 sc1
	v_mfma_f32_16x16x32_bf16 v[40:43], a[40:43], a[200:203], v[40:43]
	s_waitcnt lgkmcnt(2)
	v_exp_f32 v33, v33
	v_mfma_f32_16x16x32_bf16 v[40:43], a[44:47], a[204:207], v[40:43]
	v_cvt_pk_bf16_f32 v48, v32, v33
	v_mfma_f32_16x16x32_bf16 v[44:47], a[60:63], a[204:207], -4.0
	v_exp_f32 v34, v34
	v_mfma_f32_16x16x32_bf16 v[44:47], a[56:59], a[200:203], v[44:47]
	s_waitcnt lgkmcnt(1)
	v_mfma_f32_16x16x32_bf16 v[44:47], a[52:55], a[196:199], v[44:47]
	s_waitcnt lgkmcnt(0)
	v_exp_f32 v35, v35
	v_mfma_f32_16x16x32_bf16 v[44:47], a[48:51], a[192:195], v[44:47]
	v_cvt_pk_bf16_f32 v49, v34, v35
	v_smfmac_f32_16x16x64_bf16 a[136:139], a[168:171], v[56:63], v31
	v_mfma_f32_16x16x32_bf16 v[140:143], a[64:67], v[56:59], v[140:143]
	v_exp_f32 v36, v36
	v_mfma_f32_16x16x32_bf16 v[140:143], a[96:99], v[60:63], v[140:143]
	ds_read_b64_tr_b16 a[64:65], v1 offset:0
	ds_read_b64_tr_b16 a[66:67], v1 offset:4096
	v_mfma_f32_16x16x32_bf16 v[156:159], a[100:103], v[60:63], v[156:159]
	v_exp_f32 v37, v37
	v_mfma_f32_16x16x32_bf16 v[156:159], a[68:71], v[56:59], v[156:159]
	ds_read_b64_tr_b16 a[96:97], v1 offset:8192
	v_cvt_pk_bf16_f32 v50, v36, v37
	v_mfma_f32_16x16x32_bf16 v[172:175], a[72:75], v[56:59], v[172:175]
	v_exp_f32 v38, v38
	v_mfma_f32_16x16x32_bf16 v[172:175], a[104:107], v[60:63], v[172:175]
	ds_read_b64_tr_b16 a[98:99], v1 offset:12288
	ds_read_b64_tr_b16 a[100:101], v2 offset:8192
	v_mfma_f32_16x16x32_bf16 v[188:191], a[108:111], v[60:63], v[188:191]
	v_exp_f32 v39, v39
	v_mfma_f32_16x16x32_bf16 v[188:191], a[76:79], v[56:59], v[188:191]
	ds_read_b64_tr_b16 a[102:103], v2 offset:12288
	v_cvt_pk_bf16_f32 v51, v38, v39
	v_mfma_f32_16x16x32_bf16 v[32:35], a[0:3], a[208:211], -4.0
	v_exp_f32 v40, v40
	v_mfma_f32_16x16x32_bf16 v[32:35], a[4:7], a[212:215], v[32:35]
	ds_read_b64_tr_b16 a[68:69], v2 offset:0
	ds_read_b64_tr_b16 a[70:71], v2 offset:4096
	v_mfma_f32_16x16x32_bf16 v[32:35], a[8:11], a[216:219], v[32:35]
	v_exp_f32 v41, v41
	v_mfma_f32_16x16x32_bf16 v[32:35], a[12:15], a[220:223], v[32:35]
	ds_read_b64_tr_b16 a[72:73], v3 offset:0
	v_cvt_pk_bf16_f32 v52, v40, v41
	v_mfma_f32_16x16x32_bf16 v[36:39], a[28:31], a[220:223], -4.0
	v_exp_f32 v42, v42
	v_mfma_f32_16x16x32_bf16 v[36:39], a[24:27], a[216:219], v[36:39]
	ds_read_b64_tr_b16 a[74:75], v3 offset:4096
	ds_read_b64_tr_b16 a[104:105], v3 offset:8192
	v_mfma_f32_16x16x32_bf16 v[36:39], a[20:23], a[212:215], v[36:39]
	v_exp_f32 v43, v43
	v_mfma_f32_16x16x32_bf16 v[36:39], a[16:19], a[208:211], v[36:39]
	ds_read_b64_tr_b16 a[106:107], v3 offset:12288
	v_cvt_pk_bf16_f32 v53, v42, v43
	v_mfma_f32_16x16x32_bf16 v[204:207], a[80:83], v[56:59], v[204:207]
	v_exp_f32 v44, v44
	v_mfma_f32_16x16x32_bf16 v[204:207], a[112:115], v[60:63], v[204:207]
	ds_read_b64_tr_b16 a[108:109], v4 offset:8192
	ds_read_b64_tr_b16 a[110:111], v4 offset:12288
	v_mfma_f32_16x16x32_bf16 v[220:223], a[116:119], v[60:63], v[220:223]
	v_exp_f32 v45, v45
	v_mfma_f32_16x16x32_bf16 v[220:223], a[84:87], v[56:59], v[220:223]
	ds_read_b64_tr_b16 a[76:77], v4 offset:0
	v_cvt_pk_bf16_f32 v54, v44, v45
	v_mfma_f32_16x16x32_bf16 v[236:239], a[88:91], v[56:59], v[236:239]
	v_exp_f32 v46, v46
	v_mfma_f32_16x16x32_bf16 v[236:239], a[120:123], v[60:63], v[236:239]
	ds_read_b64_tr_b16 a[78:79], v4 offset:4096
	ds_read_b64_tr_b16 a[80:81], v5 offset:0
	v_mfma_f32_16x16x32_bf16 v[252:255], a[124:127], v[60:63], v[252:255]
	v_exp_f32 v47, v47
	v_mfma_f32_16x16x32_bf16 v[252:255], a[92:95], v[56:59], v[252:255]
	ds_read_b64_tr_b16 a[82:83], v5 offset:4096
	v_cvt_pk_bf16_f32 v55, v46, v47
	v_mfma_f32_16x16x32_bf16 v[40:43], a[32:35], a[208:211], -4.0
	v_exp_f32 v32, v32
	v_mfma_f32_16x16x32_bf16 v[40:43], a[36:39], a[212:215], v[40:43]
	ds_read_b64_tr_b16 a[112:113], v5 offset:8192
	ds_read_b64_tr_b16 a[114:115], v5 offset:12288
	v_mfma_f32_16x16x32_bf16 v[40:43], a[40:43], a[216:219], v[40:43]
	v_exp_f32 v33, v33
	v_mfma_f32_16x16x32_bf16 v[40:43], a[44:47], a[220:223], v[40:43]
	ds_read_b64_tr_b16 a[116:117], v6 offset:8192
	v_cvt_pk_bf16_f32 v56, v32, v33
	v_mfma_f32_16x16x32_bf16 v[44:47], a[60:63], a[220:223], -4.0
	v_exp_f32 v34, v34
	v_mfma_f32_16x16x32_bf16 v[44:47], a[56:59], a[216:219], v[44:47]
	ds_read_b64_tr_b16 a[118:119], v6 offset:12288
	ds_read_b64_tr_b16 a[84:85], v6 offset:0
	v_mfma_f32_16x16x32_bf16 v[44:47], a[52:55], a[212:215], v[44:47]
	v_exp_f32 v35, v35
	v_mfma_f32_16x16x32_bf16 v[44:47], a[48:51], a[208:211], v[44:47]
	ds_read_b64_tr_b16 a[86:87], v6 offset:4096
	v_cvt_pk_bf16_f32 v57, v34, v35
	v_smfmac_f32_16x16x64_bf16 a[132:135], a[128:131], v[48:55], v31
	s_waitcnt lgkmcnt(7)
	v_mfma_f32_16x16x32_bf16 v[128:131], a[64:67], v[48:51], v[128:131]
	v_exp_f32 v36, v36
	v_mfma_f32_16x16x32_bf16 v[128:131], a[96:99], v[52:55], v[128:131]
	ds_read_b64_tr_b16 a[88:89], v7 offset:0
	ds_read_b64_tr_b16 a[90:91], v7 offset:4096
	v_mfma_f32_16x16x32_bf16 v[144:147], a[100:103], v[52:55], v[144:147]
L_pg7:
	s_cbranch_execz L_pg11
	v_exp_f32 v37, v37
	v_mfma_f32_16x16x32_bf16 v[144:147], a[68:71], v[48:51], v[144:147]
	ds_read_b64_tr_b16 a[120:121], v7 offset:8192
	v_cvt_pk_bf16_f32 v58, v36, v37
	v_mfma_f32_16x16x32_bf16 v[160:163], a[72:75], v[48:51], v[160:163]
	v_exp_f32 v38, v38
	v_mfma_f32_16x16x32_bf16 v[160:163], a[104:107], v[52:55], v[160:163]
	ds_read_b64_tr_b16 a[122:123], v7 offset:12288
	ds_read_b64_tr_b16 a[124:125], v8 offset:8192
	v_mfma_f32_16x16x32_bf16 v[176:179], a[108:111], v[52:55], v[176:179]
	v_exp_f32 v39, v39
	v_mfma_f32_16x16x32_bf16 v[176:179], a[76:79], v[48:51], v[176:179]
	ds_read_b64_tr_b16 a[126:127], v8 offset:12288
	v_cvt_pk_bf16_f32 v59, v38, v39
	v_mfma_f32_16x16x32_bf16 v[32:35], a[0:3], a[224:227], -4.0
	v_exp_f32 v40, v40
	v_mfma_f32_16x16x32_bf16 v[32:35], a[4:7], a[228:231], v[32:35]
	ds_read_b64_tr_b16 a[92:93], v8 offset:0
	ds_read_b64_tr_b16 a[94:95], v8 offset:4096
	v_mfma_f32_16x16x32_bf16 v[32:35], a[8:11], a[232:235], v[32:35]
	v_exp_f32 v41, v41
	v_mfma_f32_16x16x32_bf16 v[32:35], a[12:15], a[236:239], v[32:35]
	v_cvt_pk_bf16_f32 v60, v40, v41
	v_mfma_f32_16x16x32_bf16 v[36:39], a[28:31], a[236:239], -4.0
	v_exp_f32 v42, v42
	v_mfma_f32_16x16x32_bf16 v[36:39], a[24:27], a[232:235], v[36:39]
	v_mfma_f32_16x16x32_bf16 v[36:39], a[20:23], a[228:231], v[36:39]
	v_exp_f32 v43, v43
	v_mfma_f32_16x16x32_bf16 v[36:39], a[16:19], a[224:227], v[36:39]
	s_waitcnt lgkmcnt(3)
	v_cvt_pk_bf16_f32 v61, v42, v43
	v_mfma_f32_16x16x32_bf16 v[192:195], a[80:83], v[48:51], v[192:195]
	v_exp_f32 v44, v44
	v_mfma_f32_16x16x32_bf16 v[192:195], a[112:115], v[52:55], v[192:195]
	buffer_load_dwordx4 v[104:107], v28, s[52:55], 0 offen offset:2048 sc1
	v_mfma_f32_16x16x32_bf16 v[208:211], a[116:119], v[52:55], v[208:211]
	v_exp_f32 v45, v45
	v_mfma_f32_16x16x32_bf16 v[208:211], a[84:87], v[48:51], v[208:211]
	v_cvt_pk_bf16_f32 v62, v44, v45
	v_mfma_f32_16x16x32_bf16 v[224:227], a[88:91], v[48:51], v[224:227]
	v_exp_f32 v46, v46
	v_mfma_f32_16x16x32_bf16 v[224:227], a[120:123], v[52:55], v[224:227]
	s_waitcnt lgkmcnt(0)
	buffer_load_dwordx4 v[108:111], v28, s[52:55], 0 offen offset:3072 sc1
	v_mfma_f32_16x16x32_bf16 v[240:243], a[124:127], v[52:55], v[240:243]
	s_waitcnt vmcnt(9)
	v_exp_f32 v47, v47
	v_mfma_f32_16x16x32_bf16 v[240:243], a[92:95], v[48:51], v[240:243]
	s_barrier
	v_cvt_pk_bf16_f32 v63, v46, v47
	v_mfma_f32_16x16x32_bf16 v[40:43], a[32:35], a[224:227], -4.0
	s_add_u32 m0, s65, 0x0
	v_exp_f32 v32, v32
	v_mfma_f32_16x16x32_bf16 v[40:43], a[36:39], a[228:231], v[40:43]
	buffer_load_dwordx4 v18, s[8:11], s68 offen lds
	v_mfma_f32_16x16x32_bf16 v[40:43], a[40:43], a[232:235], v[40:43]
	v_exp_f32 v33, v33
	v_mfma_f32_16x16x32_bf16 v[40:43], a[44:47], a[236:239], v[40:43]
	v_cvt_pk_bf16_f32 v48, v32, v33
	v_mfma_f32_16x16x32_bf16 v[44:47], a[60:63], a[236:239], -4.0
	v_exp_f32 v34, v34
	v_mfma_f32_16x16x32_bf16 v[44:47], a[56:59], a[232:235], v[44:47]
	buffer_load_dwordx4 v19, s[8:11], s68 offen offset:1024 lds
	v_mfma_f32_16x16x32_bf16 v[44:47], a[52:55], a[228:231], v[44:47]
	s_add_u32 s68, s68, 0x2000
	v_exp_f32 v35, v35
	v_mfma_f32_16x16x32_bf16 v[44:47], a[48:51], a[224:227], v[44:47]
	s_and_b32 s68, s68, 0x7ffff
	v_cvt_pk_bf16_f32 v49, v34, v35
	v_smfmac_f32_16x16x64_bf16 a[132:135], a[168:171], v[56:63], v31
	v_mfma_f32_16x16x32_bf16 v[132:135], a[64:67], v[56:59], v[132:135]
	s_add_u32 m0, s65, 0x2000
	v_exp_f32 v36, v36
	v_mfma_f32_16x16x32_bf16 v[132:135], a[96:99], v[60:63], v[132:135]
	buffer_load_dwordx4 v18, s[8:11], s68 offen lds
	v_mfma_f32_16x16x32_bf16 v[148:151], a[100:103], v[60:63], v[148:151]
	v_exp_f32 v37, v37
	v_mfma_f32_16x16x32_bf16 v[148:151], a[68:71], v[56:59], v[148:151]
	v_cvt_pk_bf16_f32 v50, v36, v37
	v_mfma_f32_16x16x32_bf16 v[164:167], a[72:75], v[56:59], v[164:167]
	v_exp_f32 v38, v38
	v_mfma_f32_16x16x32_bf16 v[164:167], a[104:107], v[60:63], v[164:167]
	buffer_load_dwordx4 v19, s[8:11], s68 offen offset:1024 lds
	v_mfma_f32_16x16x32_bf16 v[180:183], a[108:111], v[60:63], v[180:183]
	s_add_u32 s68, s68, 0x2000
	v_exp_f32 v39, v39
	v_mfma_f32_16x16x32_bf16 v[180:183], a[76:79], v[56:59], v[180:183]
	s_and_b32 s68, s68, 0x7ffff
	v_cvt_pk_bf16_f32 v51, v38, v39
	v_mfma_f32_16x16x32_bf16 v[32:35], a[0:3], a[240:243], -4.0
	s_add_u32 m0, s65, 0x8000
	v_exp_f32 v40, v40
	v_mfma_f32_16x16x32_bf16 v[32:35], a[4:7], a[244:247], v[32:35]
	buffer_load_dwordx4 v20, s[12:15], s69 offen lds
	v_mfma_f32_16x16x32_bf16 v[32:35], a[8:11], a[248:251], v[32:35]
	v_exp_f32 v41, v41
	v_mfma_f32_16x16x32_bf16 v[32:35], a[12:15], a[252:255], v[32:35]
	ds_read_b128 a[0:3], v9 offset:16384
	v_cvt_pk_bf16_f32 v52, v40, v41
	v_mfma_f32_16x16x32_bf16 v[36:39], a[28:31], a[252:255], -4.0
	v_exp_f32 v42, v42
	v_mfma_f32_16x16x32_bf16 v[36:39], a[24:27], a[248:251], v[36:39]
	buffer_load_dwordx4 v21, s[12:15], s69 offen offset:1024 lds
	v_mfma_f32_16x16x32_bf16 v[36:39], a[20:23], a[244:247], v[36:39]
	v_exp_f32 v43, v43
	v_mfma_f32_16x16x32_bf16 v[36:39], a[16:19], a[240:243], v[36:39]
	ds_read_b128 a[4:7], v10 offset:16384
	v_cvt_pk_bf16_f32 v53, v42, v43
	v_mfma_f32_16x16x32_bf16 v[196:199], a[80:83], v[56:59], v[196:199]
	v_exp_f32 v44, v44
	v_mfma_f32_16x16x32_bf16 v[196:199], a[112:115], v[60:63], v[196:199]
	ds_read_b128 a[8:11], v11 offset:16384
	ds_read_b128 a[12:15], v12 offset:16384
	v_mfma_f32_16x16x32_bf16 v[212:215], a[116:119], v[60:63], v[212:215]
	s_add_u32 s69, s69, 0x2000
	v_exp_f32 v45, v45
	v_mfma_f32_16x16x32_bf16 v[212:215], a[84:87], v[56:59], v[212:215]
	s_and_b32 s69, s69, 0x7ffff
	ds_read_b128 a[28:31], v12 offset:20480
	v_cvt_pk_bf16_f32 v54, v44, v45
	v_mfma_f32_16x16x32_bf16 v[228:231], a[88:91], v[56:59], v[228:231]
	s_add_u32 m0, s65, 0xa000
	v_exp_f32 v46, v46
	v_mfma_f32_16x16x32_bf16 v[228:231], a[120:123], v[60:63], v[228:231]
	buffer_load_dwordx4 v20, s[12:15], s69 offen lds
	v_mfma_f32_16x16x32_bf16 v[244:247], a[124:127], v[60:63], v[244:247]
	v_exp_f32 v47, v47
	v_mfma_f32_16x16x32_bf16 v[244:247], a[92:95], v[56:59], v[244:247]
	ds_read_b128 a[24:27], v11 offset:20480
	v_cvt_pk_bf16_f32 v55, v46, v47
	v_mfma_f32_16x16x32_bf16 v[40:43], a[32:35], a[240:243], -4.0
	s_add_u32 m0, s65, 0xa000
	v_exp_f32 v32, v32
	v_mfma_f32_16x16x32_bf16 v[40:43], a[36:39], a[244:247], v[40:43]
	buffer_load_dwordx4 v21, s[12:15], s69 offen offset:1024 lds
	v_mfma_f32_16x16x32_bf16 v[40:43], a[40:43], a[248:251], v[40:43]
	v_exp_f32 v33, v33
	v_mfma_f32_16x16x32_bf16 v[40:43], a[44:47], a[252:255], v[40:43]
	s_add_u32 s69, s69, 0x2000
	ds_read_b128 a[20:23], v10 offset:20480
	v_cvt_pk_bf16_f32 v56, v32, v33
	v_mfma_f32_16x16x32_bf16 v[44:47], a[60:63], a[252:255], -4.0
	s_and_b32 s69, s69, 0x7ffff
	v_exp_f32 v34, v34
	v_mfma_f32_16x16x32_bf16 v[44:47], a[56:59], a[248:251], v[44:47]
	buffer_load_dwordx4 v[112:115], v29, s[52:55], 0 offen offset:0 sc1
	v_mfma_f32_16x16x32_bf16 v[44:47], a[52:55], a[244:247], v[44:47]
	v_exp_f32 v35, v35
	v_mfma_f32_16x16x32_bf16 v[44:47], a[48:51], a[240:243], v[44:47]
	ds_read_b128 a[16:19], v9 offset:20480
	v_cvt_pk_bf16_f32 v57, v34, v35
	v_smfmac_f32_16x16x64_bf16 a[136:139], a[128:131], v[48:55], v31
	v_mfma_f32_16x16x32_bf16 v[136:139], a[64:67], v[48:51], v[136:139]
	v_exp_f32 v36, v36
	v_mfma_f32_16x16x32_bf16 v[136:139], a[96:99], v[52:55], v[136:139]
	ds_read_b128 a[32:35], v9 offset:24576
	ds_read_b128 a[36:39], v10 offset:24576
	v_mfma_f32_16x16x32_bf16 v[152:155], a[100:103], v[52:55], v[152:155]
	v_exp_f32 v37, v37
	v_mfma_f32_16x16x32_bf16 v[152:155], a[68:71], v[48:51], v[152:155]
	ds_read_b128 a[40:43], v11 offset:24576
	v_cvt_pk_bf16_f32 v58, v36, v37
	v_mfma_f32_16x16x32_bf16 v[168:171], a[72:75], v[48:51], v[168:171]
	v_exp_f32 v38, v38
	v_mfma_f32_16x16x32_bf16 v[168:171], a[104:107], v[52:55], v[168:171]
	ds_read_b128 a[44:47], v12 offset:24576
	ds_read_b128 a[60:63], v12 offset:28672
	v_mfma_f32_16x16x32_bf16 v[184:187], a[108:111], v[52:55], v[184:187]
	v_exp_f32 v39, v39
	v_mfma_f32_16x16x32_bf16 v[184:187], a[76:79], v[48:51], v[184:187]
	s_waitcnt lgkmcnt(6)
	ds_read_b128 a[56:59], v11 offset:28672
	v_cvt_pk_bf16_f32 v59, v38, v39
	v_mfma_f32_16x16x32_bf16 v[32:35], a[0:3], a[192:195], -4.0
	v_exp_f32 v40, v40
	v_mfma_f32_16x16x32_bf16 v[32:35], a[4:7], a[196:199], v[32:35]
	buffer_load_dwordx4 v[116:119], v29, s[52:55], 0 offen offset:1024 sc1
	v_mfma_f32_16x16x32_bf16 v[32:35], a[8:11], a[200:203], v[32:35]
	v_exp_f32 v41, v41
	v_mfma_f32_16x16x32_bf16 v[32:35], a[12:15], a[204:207], v[32:35]
	ds_read_b128 a[52:55], v10 offset:28672
	v_cvt_pk_bf16_f32 v60, v40, v41
	v_mfma_f32_16x16x32_bf16 v[36:39], a[28:31], a[204:207], -4.0
	v_exp_f32 v42, v42
	v_mfma_f32_16x16x32_bf16 v[36:39], a[24:27], a[200:203], v[36:39]
	buffer_load_dwordx4 v[120:123], v29, s[52:55], 0 offen offset:2048 sc1
	v_mfma_f32_16x16x32_bf16 v[36:39], a[20:23], a[196:199], v[36:39]
	s_waitcnt lgkmcnt(4)
	v_exp_f32 v43, v43
	v_mfma_f32_16x16x32_bf16 v[36:39], a[16:19], a[192:195], v[36:39]
	ds_read_b128 a[48:51], v9 offset:28672
	v_cvt_pk_bf16_f32 v61, v42, v43
	v_mfma_f32_16x16x32_bf16 v[200:203], a[80:83], v[48:51], v[200:203]
	v_exp_f32 v44, v44
	v_mfma_f32_16x16x32_bf16 v[200:203], a[112:115], v[52:55], v[200:203]
	v_mfma_f32_16x16x32_bf16 v[216:219], a[116:119], v[52:55], v[216:219]
	v_exp_f32 v45, v45
	v_mfma_f32_16x16x32_bf16 v[216:219], a[84:87], v[48:51], v[216:219]
	v_cvt_pk_bf16_f32 v62, v44, v45
	v_mfma_f32_16x16x32_bf16 v[232:235], a[88:91], v[48:51], v[232:235]
	v_exp_f32 v46, v46
	v_mfma_f32_16x16x32_bf16 v[232:235], a[120:123], v[52:55], v[232:235]
	v_mfma_f32_16x16x32_bf16 v[248:251], a[124:127], v[52:55], v[248:251]
	v_exp_f32 v47, v47
	v_mfma_f32_16x16x32_bf16 v[248:251], a[92:95], v[48:51], v[248:251]
	v_cvt_pk_bf16_f32 v63, v46, v47
	v_mfma_f32_16x16x32_bf16 v[40:43], a[32:35], a[192:195], -4.0
	v_exp_f32 v32, v32
	v_mfma_f32_16x16x32_bf16 v[40:43], a[36:39], a[196:199], v[40:43]
	buffer_load_dwordx4 v[124:127], v29, s[52:55], 0 offen offset:3072 sc1
	v_mfma_f32_16x16x32_bf16 v[40:43], a[40:43], a[200:203], v[40:43]
	s_waitcnt lgkmcnt(0)
	v_exp_f32 v33, v33
	v_mfma_f32_16x16x32_bf16 v[40:43], a[44:47], a[204:207], v[40:43]
	v_cvt_pk_bf16_f32 v48, v32, v33
	v_mfma_f32_16x16x32_bf16 v[44:47], a[60:63], a[204:207], -4.0
	v_exp_f32 v34, v34
	v_mfma_f32_16x16x32_bf16 v[44:47], a[56:59], a[200:203], v[44:47]
	v_mfma_f32_16x16x32_bf16 v[44:47], a[52:55], a[196:199], v[44:47]
	v_exp_f32 v35, v35
	v_mfma_f32_16x16x32_bf16 v[44:47], a[48:51], a[192:195], v[44:47]
	v_cvt_pk_bf16_f32 v49, v34, v35
	v_smfmac_f32_16x16x64_bf16 a[136:139], a[168:171], v[56:63], v31
	v_mfma_f32_16x16x32_bf16 v[140:143], a[64:67], v[56:59], v[140:143]
	v_exp_f32 v36, v36
	v_mfma_f32_16x16x32_bf16 v[140:143], a[96:99], v[60:63], v[140:143]
	ds_read_b64_tr_b16 a[64:65], v1 offset:16384
	ds_read_b64_tr_b16 a[66:67], v1 offset:20480
	v_mfma_f32_16x16x32_bf16 v[156:159], a[100:103], v[60:63], v[156:159]
	v_exp_f32 v37, v37
	v_mfma_f32_16x16x32_bf16 v[156:159], a[68:71], v[56:59], v[156:159]
	ds_read_b64_tr_b16 a[96:97], v1 offset:24576
	v_cvt_pk_bf16_f32 v50, v36, v37
	v_mfma_f32_16x16x32_bf16 v[172:175], a[72:75], v[56:59], v[172:175]
	v_exp_f32 v38, v38
	v_mfma_f32_16x16x32_bf16 v[172:175], a[104:107], v[60:63], v[172:175]
	ds_read_b64_tr_b16 a[98:99], v1 offset:28672
	ds_read_b64_tr_b16 a[100:101], v2 offset:24576
	v_mfma_f32_16x16x32_bf16 v[188:191], a[108:111], v[60:63], v[188:191]
	v_exp_f32 v39, v39
	v_mfma_f32_16x16x32_bf16 v[188:191], a[76:79], v[56:59], v[188:191]
	ds_read_b64_tr_b16 a[102:103], v2 offset:28672
	v_cvt_pk_bf16_f32 v51, v38, v39
	v_mfma_f32_16x16x32_bf16 v[32:35], a[0:3], a[208:211], -4.0
	v_exp_f32 v40, v40
	v_mfma_f32_16x16x32_bf16 v[32:35], a[4:7], a[212:215], v[32:35]
	ds_read_b64_tr_b16 a[68:69], v2 offset:16384
	ds_read_b64_tr_b16 a[70:71], v2 offset:20480
	v_mfma_f32_16x16x32_bf16 v[32:35], a[8:11], a[216:219], v[32:35]
	v_exp_f32 v41, v41
	v_mfma_f32_16x16x32_bf16 v[32:35], a[12:15], a[220:223], v[32:35]
	ds_read_b64_tr_b16 a[72:73], v3 offset:16384
	v_cvt_pk_bf16_f32 v52, v40, v41
	v_mfma_f32_16x16x32_bf16 v[36:39], a[28:31], a[220:223], -4.0
	v_exp_f32 v42, v42
	v_mfma_f32_16x16x32_bf16 v[36:39], a[24:27], a[216:219], v[36:39]
	ds_read_b64_tr_b16 a[74:75], v3 offset:20480
	ds_read_b64_tr_b16 a[104:105], v3 offset:24576
	v_mfma_f32_16x16x32_bf16 v[36:39], a[20:23], a[212:215], v[36:39]
	v_exp_f32 v43, v43
	v_mfma_f32_16x16x32_bf16 v[36:39], a[16:19], a[208:211], v[36:39]
	ds_read_b64_tr_b16 a[106:107], v3 offset:28672
	v_cvt_pk_bf16_f32 v53, v42, v43
	v_mfma_f32_16x16x32_bf16 v[204:207], a[80:83], v[56:59], v[204:207]
	v_exp_f32 v44, v44
	v_mfma_f32_16x16x32_bf16 v[204:207], a[112:115], v[60:63], v[204:207]
	ds_read_b64_tr_b16 a[108:109], v4 offset:24576
	ds_read_b64_tr_b16 a[110:111], v4 offset:28672
	v_mfma_f32_16x16x32_bf16 v[220:223], a[116:119], v[60:63], v[220:223]
	v_exp_f32 v45, v45
	v_mfma_f32_16x16x32_bf16 v[220:223], a[84:87], v[56:59], v[220:223]
	ds_read_b64_tr_b16 a[76:77], v4 offset:16384
	v_cvt_pk_bf16_f32 v54, v44, v45
	v_mfma_f32_16x16x32_bf16 v[236:239], a[88:91], v[56:59], v[236:239]
	v_exp_f32 v46, v46
	v_mfma_f32_16x16x32_bf16 v[236:239], a[120:123], v[60:63], v[236:239]
	ds_read_b64_tr_b16 a[78:79], v4 offset:20480
	ds_read_b64_tr_b16 a[80:81], v5 offset:16384
	v_mfma_f32_16x16x32_bf16 v[252:255], a[124:127], v[60:63], v[252:255]
	v_exp_f32 v47, v47
	v_mfma_f32_16x16x32_bf16 v[252:255], a[92:95], v[56:59], v[252:255]
	ds_read_b64_tr_b16 a[82:83], v5 offset:20480
	v_cvt_pk_bf16_f32 v55, v46, v47
	v_mfma_f32_16x16x32_bf16 v[40:43], a[32:35], a[208:211], -4.0
	v_exp_f32 v32, v32
	v_mfma_f32_16x16x32_bf16 v[40:43], a[36:39], a[212:215], v[40:43]
	ds_read_b64_tr_b16 a[112:113], v5 offset:24576
	ds_read_b64_tr_b16 a[114:115], v5 offset:28672
	v_mfma_f32_16x16x32_bf16 v[40:43], a[40:43], a[216:219], v[40:43]
	v_exp_f32 v33, v33
	v_mfma_f32_16x16x32_bf16 v[40:43], a[44:47], a[220:223], v[40:43]
	ds_read_b64_tr_b16 a[116:117], v6 offset:24576
	v_cvt_pk_bf16_f32 v56, v32, v33
	v_mfma_f32_16x16x32_bf16 v[44:47], a[60:63], a[220:223], -4.0
	v_exp_f32 v34, v34
	v_mfma_f32_16x16x32_bf16 v[44:47], a[56:59], a[216:219], v[44:47]
	ds_read_b64_tr_b16 a[118:119], v6 offset:28672
	ds_read_b64_tr_b16 a[84:85], v6 offset:16384
	v_mfma_f32_16x16x32_bf16 v[44:47], a[52:55], a[212:215], v[44:47]
	v_exp_f32 v35, v35
	v_mfma_f32_16x16x32_bf16 v[44:47], a[48:51], a[208:211], v[44:47]
	ds_read_b64_tr_b16 a[86:87], v6 offset:20480
	v_cvt_pk_bf16_f32 v57, v34, v35
	v_smfmac_f32_16x16x64_bf16 a[132:135], a[128:131], v[48:55], v31
	s_waitcnt lgkmcnt(7)
	v_mfma_f32_16x16x32_bf16 v[128:131], a[64:67], v[48:51], v[128:131]
	v_exp_f32 v36, v36
	v_mfma_f32_16x16x32_bf16 v[128:131], a[96:99], v[52:55], v[128:131]
	ds_read_b64_tr_b16 a[88:89], v7 offset:16384
	ds_read_b64_tr_b16 a[90:91], v7 offset:20480
	v_mfma_f32_16x16x32_bf16 v[144:147], a[100:103], v[52:55], v[144:147]
	v_exp_f32 v37, v37
	v_mfma_f32_16x16x32_bf16 v[144:147], a[68:71], v[48:51], v[144:147]
	ds_read_b64_tr_b16 a[120:121], v7 offset:24576
	v_cvt_pk_bf16_f32 v58, v36, v37
	v_mfma_f32_16x16x32_bf16 v[160:163], a[72:75], v[48:51], v[160:163]
	v_exp_f32 v38, v38
	v_mfma_f32_16x16x32_bf16 v[160:163], a[104:107], v[52:55], v[160:163]
	ds_read_b64_tr_b16 a[122:123], v7 offset:28672
	ds_read_b64_tr_b16 a[124:125], v8 offset:24576
	v_mfma_f32_16x16x32_bf16 v[176:179], a[108:111], v[52:55], v[176:179]
	v_exp_f32 v39, v39
	v_mfma_f32_16x16x32_bf16 v[176:179], a[76:79], v[48:51], v[176:179]
	ds_read_b64_tr_b16 a[126:127], v8 offset:28672
	v_cvt_pk_bf16_f32 v59, v38, v39
	v_mfma_f32_16x16x32_bf16 v[32:35], a[0:3], a[224:227], -4.0
	v_exp_f32 v40, v40
	v_mfma_f32_16x16x32_bf16 v[32:35], a[4:7], a[228:231], v[32:35]
	ds_read_b64_tr_b16 a[92:93], v8 offset:16384
	ds_read_b64_tr_b16 a[94:95], v8 offset:20480
	v_mfma_f32_16x16x32_bf16 v[32:35], a[8:11], a[232:235], v[32:35]
	v_exp_f32 v41, v41
	v_mfma_f32_16x16x32_bf16 v[32:35], a[12:15], a[236:239], v[32:35]
	v_cvt_pk_bf16_f32 v60, v40, v41
	v_mfma_f32_16x16x32_bf16 v[36:39], a[28:31], a[236:239], -4.0
	v_exp_f32 v42, v42
	v_mfma_f32_16x16x32_bf16 v[36:39], a[24:27], a[232:235], v[36:39]
	v_mfma_f32_16x16x32_bf16 v[36:39], a[20:23], a[228:231], v[36:39]
	v_exp_f32 v43, v43
	v_mfma_f32_16x16x32_bf16 v[36:39], a[16:19], a[224:227], v[36:39]
	s_waitcnt lgkmcnt(3)
	v_cvt_pk_bf16_f32 v61, v42, v43
	v_mfma_f32_16x16x32_bf16 v[192:195], a[80:83], v[48:51], v[192:195]
	v_exp_f32 v44, v44
	v_mfma_f32_16x16x32_bf16 v[192:195], a[112:115], v[52:55], v[192:195]
	v_mfma_f32_16x16x32_bf16 v[208:211], a[116:119], v[52:55], v[208:211]
	v_exp_f32 v45, v45
	v_mfma_f32_16x16x32_bf16 v[208:211], a[84:87], v[48:51], v[208:211]
	v_cvt_pk_bf16_f32 v62, v44, v45
	v_mfma_f32_16x16x32_bf16 v[224:227], a[88:91], v[48:51], v[224:227]
	v_exp_f32 v46, v46
	v_mfma_f32_16x16x32_bf16 v[224:227], a[120:123], v[52:55], v[224:227]
	s_waitcnt lgkmcnt(0)
	v_mfma_f32_16x16x32_bf16 v[240:243], a[124:127], v[52:55], v[240:243]
	s_waitcnt vmcnt(4)
	v_exp_f32 v47, v47
	v_mfma_f32_16x16x32_bf16 v[240:243], a[92:95], v[48:51], v[240:243]
	s_barrier
	v_cvt_pk_bf16_f32 v63, v46, v47
	v_mfma_f32_16x16x32_bf16 v[40:43], a[32:35], a[224:227], -4.0
	s_add_u32 m0, s65, 0x4000
	v_exp_f32 v32, v32
	v_mfma_f32_16x16x32_bf16 v[40:43], a[36:39], a[228:231], v[40:43]
	buffer_load_dwordx4 v18, s[8:11], s68 offen lds
	v_mfma_f32_16x16x32_bf16 v[40:43], a[40:43], a[232:235], v[40:43]
	v_exp_f32 v33, v33
	v_mfma_f32_16x16x32_bf16 v[40:43], a[44:47], a[236:239], v[40:43]
	v_cvt_pk_bf16_f32 v48, v32, v33
	v_mfma_f32_16x16x32_bf16 v[44:47], a[60:63], a[236:239], -4.0
	v_exp_f32 v34, v34
	v_mfma_f32_16x16x32_bf16 v[44:47], a[56:59], a[232:235], v[44:47]
	buffer_load_dwordx4 v19, s[8:11], s68 offen offset:1024 lds
	v_mfma_f32_16x16x32_bf16 v[44:47], a[52:55], a[228:231], v[44:47]
	s_add_u32 s68, s68, 0x2000
	v_exp_f32 v35, v35
	v_mfma_f32_16x16x32_bf16 v[44:47], a[48:51], a[224:227], v[44:47]
	s_and_b32 s68, s68, 0x7ffff
	v_cvt_pk_bf16_f32 v49, v34, v35
	v_smfmac_f32_16x16x64_bf16 a[132:135], a[168:171], v[56:63], v31
	v_mfma_f32_16x16x32_bf16 v[132:135], a[64:67], v[56:59], v[132:135]
	s_add_u32 m0, s65, 0x6000
	v_exp_f32 v36, v36
	v_mfma_f32_16x16x32_bf16 v[132:135], a[96:99], v[60:63], v[132:135]
	buffer_load_dwordx4 v18, s[8:11], s68 offen lds
	v_mfma_f32_16x16x32_bf16 v[148:151], a[100:103], v[60:63], v[148:151]
	v_exp_f32 v37, v37
	v_mfma_f32_16x16x32_bf16 v[148:151], a[68:71], v[56:59], v[148:151]
	v_cvt_pk_bf16_f32 v50, v36, v37
	v_mfma_f32_16x16x32_bf16 v[164:167], a[72:75], v[56:59], v[164:167]
	v_exp_f32 v38, v38
	v_mfma_f32_16x16x32_bf16 v[164:167], a[104:107], v[60:63], v[164:167]
	buffer_load_dwordx4 v19, s[8:11], s68 offen offset:1024 lds
	v_mfma_f32_16x16x32_bf16 v[180:183], a[108:111], v[60:63], v[180:183]
	s_add_u32 s68, s68, 0x2000
	v_exp_f32 v39, v39
	v_mfma_f32_16x16x32_bf16 v[180:183], a[76:79], v[56:59], v[180:183]
	s_and_b32 s68, s68, 0x7ffff
	v_cvt_pk_bf16_f32 v51, v38, v39
	v_mfma_f32_16x16x32_bf16 v[32:35], a[0:3], a[240:243], -4.0
	s_add_u32 m0, s65, 0xc000
	v_exp_f32 v40, v40
	v_mfma_f32_16x16x32_bf16 v[32:35], a[4:7], a[244:247], v[32:35]
	buffer_load_dwordx4 v20, s[12:15], s69 offen lds
	v_mfma_f32_16x16x32_bf16 v[32:35], a[8:11], a[248:251], v[32:35]
	v_exp_f32 v41, v41
	v_mfma_f32_16x16x32_bf16 v[32:35], a[12:15], a[252:255], v[32:35]
	v_cvt_pk_bf16_f32 v52, v40, v41
	v_mfma_f32_16x16x32_bf16 v[36:39], a[28:31], a[252:255], -4.0
	v_exp_f32 v42, v42
	v_mfma_f32_16x16x32_bf16 v[36:39], a[24:27], a[248:251], v[36:39]
	buffer_load_dwordx4 v21, s[12:15], s69 offen offset:1024 lds
	v_mfma_f32_16x16x32_bf16 v[36:39], a[20:23], a[244:247], v[36:39]
	v_exp_f32 v43, v43
	v_mfma_f32_16x16x32_bf16 v[36:39], a[16:19], a[240:243], v[36:39]
	v_cvt_pk_bf16_f32 v53, v42, v43
	v_mfma_f32_16x16x32_bf16 v[196:199], a[80:83], v[56:59], v[196:199]
	v_exp_f32 v44, v44
	v_mfma_f32_16x16x32_bf16 v[196:199], a[112:115], v[60:63], v[196:199]
	v_mfma_f32_16x16x32_bf16 v[212:215], a[116:119], v[60:63], v[212:215]
	s_add_u32 s69, s69, 0x2000
	v_exp_f32 v45, v45
	v_mfma_f32_16x16x32_bf16 v[212:215], a[84:87], v[56:59], v[212:215]
	s_and_b32 s69, s69, 0x7ffff
	v_cvt_pk_bf16_f32 v54, v44, v45
	v_mfma_f32_16x16x32_bf16 v[228:231], a[88:91], v[56:59], v[228:231]
	s_add_u32 m0, s65, 0xe000
	v_exp_f32 v46, v46
	v_mfma_f32_16x16x32_bf16 v[228:231], a[120:123], v[60:63], v[228:231]
	buffer_load_dwordx4 v20, s[12:15], s69 offen lds
	v_mfma_f32_16x16x32_bf16 v[244:247], a[124:127], v[60:63], v[244:247]
	v_exp_f32 v47, v47
	v_mfma_f32_16x16x32_bf16 v[244:247], a[92:95], v[56:59], v[244:247]
	v_cvt_pk_bf16_f32 v55, v46, v47
	v_mfma_f32_16x16x32_bf16 v[40:43], a[32:35], a[240:243], -4.0
	s_add_u32 m0, s65, 0xe000
	v_exp_f32 v32, v32
	v_mfma_f32_16x16x32_bf16 v[40:43], a[36:39], a[244:247], v[40:43]
	buffer_load_dwordx4 v21, s[12:15], s69 offen offset:1024 lds
	v_mfma_f32_16x16x32_bf16 v[40:43], a[40:43], a[248:251], v[40:43]
	s_add_u32 s69, s69, 0x2000
	v_exp_f32 v33, v33
	v_mfma_f32_16x16x32_bf16 v[40:43], a[44:47], a[252:255], v[40:43]
	s_and_b32 s69, s69, 0x7ffff
	v_cvt_pk_bf16_f32 v56, v32, v33
	v_mfma_f32_16x16x32_bf16 v[44:47], a[60:63], a[252:255], -4.0
	v_exp_f32 v34, v34
	v_mfma_f32_16x16x32_bf16 v[44:47], a[56:59], a[248:251], v[44:47]
	v_mfma_f32_16x16x32_bf16 v[44:47], a[52:55], a[244:247], v[44:47]
	v_exp_f32 v35, v35
	v_mfma_f32_16x16x32_bf16 v[44:47], a[48:51], a[240:243], v[44:47]
	v_cvt_pk_bf16_f32 v57, v34, v35
	v_smfmac_f32_16x16x64_bf16 a[136:139], a[128:131], v[48:55], v31
	v_mfma_f32_16x16x32_bf16 v[136:139], a[64:67], v[48:51], v[136:139]
	v_exp_f32 v36, v36
	v_mfma_f32_16x16x32_bf16 v[136:139], a[96:99], v[52:55], v[136:139]
	v_mfma_f32_16x16x32_bf16 v[152:155], a[100:103], v[52:55], v[152:155]
	v_exp_f32 v37, v37
	v_mfma_f32_16x16x32_bf16 v[152:155], a[68:71], v[48:51], v[152:155]
	v_cvt_pk_bf16_f32 v58, v36, v37
	v_mfma_f32_16x16x32_bf16 v[168:171], a[72:75], v[48:51], v[168:171]
	v_exp_f32 v38, v38
	v_mfma_f32_16x16x32_bf16 v[168:171], a[104:107], v[52:55], v[168:171]
	v_mfma_f32_16x16x32_bf16 v[184:187], a[108:111], v[52:55], v[184:187]
	v_exp_f32 v39, v39
	v_mfma_f32_16x16x32_bf16 v[184:187], a[76:79], v[48:51], v[184:187]
	v_cvt_pk_bf16_f32 v59, v38, v39
	v_lshrrev_b32 v26, 2, v0
	v_bfe_u32 v30, v0, 3, 2
	v_lshlrev_b32 v30, 5, v30
	v_lshl_or_b32 v26, v26, 7, v30
	v_and_b32 v30, 3, v0
	v_lshl_or_b32 v26, v30, 3, v26
	v_add_u32 v26, 0x12000, v26
	v_xor_b32 v27, 0x20, v26
	v_xor_b32 v28, 0x40, v26
	v_xor_b32 v29, 0x60, v26
	ds_read_b64_tr_b16 a[32:33], v26 offset:0
	ds_read_b64_tr_b16 a[34:35], v26 offset:2048
	ds_read_b64_tr_b16 a[36:37], v26 offset:4096
	ds_read_b64_tr_b16 a[38:39], v26 offset:6144
	ds_read_b64_tr_b16 a[40:41], v26 offset:8192
	ds_read_b64_tr_b16 a[42:43], v26 offset:10240
	ds_read_b64_tr_b16 a[44:45], v26 offset:12288
	ds_read_b64_tr_b16 a[46:47], v26 offset:14336
	ds_read_b64_tr_b16 a[48:49], v26 offset:24576
	ds_read_b64_tr_b16 a[50:51], v26 offset:26624
	ds_read_b64_tr_b16 a[52:53], v26 offset:28672
	ds_read_b64_tr_b16 a[54:55], v26 offset:30720
	s_waitcnt lgkmcnt(10)
	v_mfma_f32_16x16x32_bf16 a[0:3], a[32:35], v[64:67], 0
	s_waitcnt lgkmcnt(8)
	ds_read_b64_tr_b16 a[56:57], v26 offset:32768
	ds_read_b64_tr_b16 a[58:59], v26 offset:34816
	v_mfma_f32_16x16x32_bf16 a[0:3], a[36:39], v[68:71], a[0:3]
	s_waitcnt lgkmcnt(8)
	ds_read_b64_tr_b16 a[60:61], v26 offset:36864
	ds_read_b64_tr_b16 a[62:63], v26 offset:38912
	v_add_u32 v26, 0xc000, v26
	v_mfma_f32_16x16x32_bf16 a[0:3], a[40:43], v[72:75], a[0:3]
	s_waitcnt lgkmcnt(8)
	ds_read_b64_tr_b16 a[32:33], v26 offset:0
	ds_read_b64_tr_b16 a[34:35], v26 offset:2048
	v_mfma_f32_16x16x32_bf16 a[0:3], a[44:47], v[76:79], a[0:3]
	s_waitcnt lgkmcnt(8)
	ds_read_b64_tr_b16 a[36:37], v26 offset:4096
	ds_read_b64_tr_b16 a[38:39], v26 offset:6144
	v_mfma_f32_16x16x32_bf16 a[0:3], a[48:51], v[80:83], a[0:3]
	s_waitcnt lgkmcnt(8)
	ds_read_b64_tr_b16 a[40:41], v26 offset:8192
	ds_read_b64_tr_b16 a[42:43], v26 offset:10240
	v_mfma_f32_16x16x32_bf16 a[0:3], a[52:55], v[84:87], a[0:3]
	s_waitcnt lgkmcnt(8)
	ds_read_b64_tr_b16 a[44:45], v26 offset:12288
	ds_read_b64_tr_b16 a[46:47], v26 offset:14336
	v_mfma_f32_16x16x32_bf16 a[0:3], a[56:59], v[88:91], a[0:3]
	s_waitcnt lgkmcnt(8)
	ds_read_b64_tr_b16 a[48:49], v26 offset:24576
	ds_read_b64_tr_b16 a[50:51], v26 offset:26624
	v_mfma_f32_16x16x32_bf16 a[0:3], a[60:63], v[92:95], a[0:3]
	s_waitcnt lgkmcnt(8)
	ds_read_b64_tr_b16 a[52:53], v26 offset:28672
	ds_read_b64_tr_b16 a[54:55], v26 offset:30720
	v_mfma_f32_16x16x32_bf16 a[0:3], a[32:35], v[96:99], a[0:3]
	s_waitcnt lgkmcnt(8)
	ds_read_b64_tr_b16 a[56:57], v26 offset:32768
	ds_read_b64_tr_b16 a[58:59], v26 offset:34816
	v_mfma_f32_16x16x32_bf16 a[0:3], a[36:39], v[100:103], a[0:3]
	s_waitcnt lgkmcnt(8)
	ds_read_b64_tr_b16 a[60:61], v26 offset:36864
	ds_read_b64_tr_b16 a[62:63], v26 offset:38912
	v_mfma_f32_16x16x32_bf16 a[0:3], a[40:43], v[104:107], a[0:3]
	s_waitcnt lgkmcnt(8)
	ds_read_b64_tr_b16 a[32:33], v27 offset:0
	ds_read_b64_tr_b16 a[34:35], v27 offset:2048
	v_mfma_f32_16x16x32_bf16 a[0:3], a[44:47], v[108:111], a[0:3]
	s_waitcnt vmcnt(11) lgkmcnt(8)
	ds_read_b64_tr_b16 a[36:37], v27 offset:4096
	ds_read_b64_tr_b16 a[38:39], v27 offset:6144
	v_mfma_f32_16x16x32_bf16 a[0:3], a[48:51], v[112:115], a[0:3]
	s_waitcnt vmcnt(10) lgkmcnt(8)
	ds_read_b64_tr_b16 a[40:41], v27 offset:8192
	ds_read_b64_tr_b16 a[42:43], v27 offset:10240
	v_mfma_f32_16x16x32_bf16 a[0:3], a[52:55], v[116:119], a[0:3]
	s_waitcnt vmcnt(9) lgkmcnt(8)
	ds_read_b64_tr_b16 a[44:45], v27 offset:12288
	ds_read_b64_tr_b16 a[46:47], v27 offset:14336
	v_mfma_f32_16x16x32_bf16 a[0:3], a[56:59], v[120:123], a[0:3]
	s_waitcnt vmcnt(8) lgkmcnt(8)
	ds_read_b64_tr_b16 a[48:49], v27 offset:24576
	ds_read_b64_tr_b16 a[50:51], v27 offset:26624
	v_mfma_f32_16x16x32_bf16 a[0:3], a[60:63], v[124:127], a[0:3]
	s_waitcnt lgkmcnt(8)
	ds_read_b64_tr_b16 a[52:53], v27 offset:28672
	ds_read_b64_tr_b16 a[54:55], v27 offset:30720
	v_mfma_f32_16x16x32_bf16 a[4:7], a[32:35], v[64:67], 0
	s_waitcnt lgkmcnt(8)
	ds_read_b64_tr_b16 a[56:57], v27 offset:32768
	ds_read_b64_tr_b16 a[58:59], v27 offset:34816
	v_mfma_f32_16x16x32_bf16 a[4:7], a[36:39], v[68:71], a[4:7]
	s_waitcnt lgkmcnt(8)
	ds_read_b64_tr_b16 a[60:61], v27 offset:36864
	ds_read_b64_tr_b16 a[62:63], v27 offset:38912
	v_add_u32 v27, 0xc000, v27
	v_mfma_f32_16x16x32_bf16 a[4:7], a[40:43], v[72:75], a[4:7]
	s_waitcnt lgkmcnt(8)
	ds_read_b64_tr_b16 a[32:33], v27 offset:0
	ds_read_b64_tr_b16 a[34:35], v27 offset:2048
	v_mfma_f32_16x16x32_bf16 a[4:7], a[44:47], v[76:79], a[4:7]
	s_waitcnt lgkmcnt(8)
	ds_read_b64_tr_b16 a[36:37], v27 offset:4096
	ds_read_b64_tr_b16 a[38:39], v27 offset:6144
	v_mfma_f32_16x16x32_bf16 a[4:7], a[48:51], v[80:83], a[4:7]
	s_waitcnt lgkmcnt(8)
	ds_read_b64_tr_b16 a[40:41], v27 offset:8192
	ds_read_b64_tr_b16 a[42:43], v27 offset:10240
	v_mfma_f32_16x16x32_bf16 a[4:7], a[52:55], v[84:87], a[4:7]
	s_waitcnt lgkmcnt(8)
	ds_read_b64_tr_b16 a[44:45], v27 offset:12288
	ds_read_b64_tr_b16 a[46:47], v27 offset:14336
	v_mfma_f32_16x16x32_bf16 a[4:7], a[56:59], v[88:91], a[4:7]
L_pg8:
	s_cbranch_execz L_pg12
	s_waitcnt lgkmcnt(8)
	ds_read_b64_tr_b16 a[48:49], v27 offset:24576
	ds_read_b64_tr_b16 a[50:51], v27 offset:26624
	v_mfma_f32_16x16x32_bf16 a[4:7], a[60:63], v[92:95], a[4:7]
	s_waitcnt lgkmcnt(8)
	ds_read_b64_tr_b16 a[52:53], v27 offset:28672
	ds_read_b64_tr_b16 a[54:55], v27 offset:30720
	v_mfma_f32_16x16x32_bf16 a[4:7], a[32:35], v[96:99], a[4:7]
	s_waitcnt lgkmcnt(8)
	ds_read_b64_tr_b16 a[56:57], v27 offset:32768
	ds_read_b64_tr_b16 a[58:59], v27 offset:34816
	v_mfma_f32_16x16x32_bf16 a[4:7], a[36:39], v[100:103], a[4:7]
	s_waitcnt lgkmcnt(8)
	ds_read_b64_tr_b16 a[60:61], v27 offset:36864
	ds_read_b64_tr_b16 a[62:63], v27 offset:38912
	v_mfma_f32_16x16x32_bf16 a[4:7], a[40:43], v[104:107], a[4:7]
	s_waitcnt lgkmcnt(8)
	ds_read_b64_tr_b16 a[32:33], v28 offset:0
	ds_read_b64_tr_b16 a[34:35], v28 offset:2048
	v_mfma_f32_16x16x32_bf16 a[4:7], a[44:47], v[108:111], a[4:7]
	s_waitcnt lgkmcnt(8)
	ds_read_b64_tr_b16 a[36:37], v28 offset:4096
	ds_read_b64_tr_b16 a[38:39], v28 offset:6144
	v_mfma_f32_16x16x32_bf16 a[4:7], a[48:51], v[112:115], a[4:7]
	s_waitcnt lgkmcnt(8)
	ds_read_b64_tr_b16 a[40:41], v28 offset:8192
	ds_read_b64_tr_b16 a[42:43], v28 offset:10240
	v_mfma_f32_16x16x32_bf16 a[4:7], a[52:55], v[116:119], a[4:7]
	s_waitcnt lgkmcnt(8)
	ds_read_b64_tr_b16 a[44:45], v28 offset:12288
	ds_read_b64_tr_b16 a[46:47], v28 offset:14336
	v_mfma_f32_16x16x32_bf16 a[4:7], a[56:59], v[120:123], a[4:7]
	s_waitcnt lgkmcnt(8)
	ds_read_b64_tr_b16 a[48:49], v28 offset:24576
	ds_read_b64_tr_b16 a[50:51], v28 offset:26624
	v_mfma_f32_16x16x32_bf16 a[4:7], a[60:63], v[124:127], a[4:7]
	s_waitcnt lgkmcnt(8)
	ds_read_b64_tr_b16 a[52:53], v28 offset:28672
	ds_read_b64_tr_b16 a[54:55], v28 offset:30720
	v_mfma_f32_16x16x32_bf16 a[8:11], a[32:35], v[64:67], 0
	s_waitcnt lgkmcnt(8)
	ds_read_b64_tr_b16 a[56:57], v28 offset:32768
	ds_read_b64_tr_b16 a[58:59], v28 offset:34816
	v_mfma_f32_16x16x32_bf16 a[8:11], a[36:39], v[68:71], a[8:11]
	s_waitcnt lgkmcnt(8)
	ds_read_b64_tr_b16 a[60:61], v28 offset:36864
	ds_read_b64_tr_b16 a[62:63], v28 offset:38912
	v_add_u32 v28, 0xc000, v28
	v_mfma_f32_16x16x32_bf16 a[8:11], a[40:43], v[72:75], a[8:11]
	s_waitcnt lgkmcnt(8)
	ds_read_b64_tr_b16 a[32:33], v28 offset:0
	ds_read_b64_tr_b16 a[34:35], v28 offset:2048
	v_mfma_f32_16x16x32_bf16 a[8:11], a[44:47], v[76:79], a[8:11]
	s_waitcnt lgkmcnt(8)
	ds_read_b64_tr_b16 a[36:37], v28 offset:4096
	ds_read_b64_tr_b16 a[38:39], v28 offset:6144
	v_mfma_f32_16x16x32_bf16 a[8:11], a[48:51], v[80:83], a[8:11]
	s_waitcnt lgkmcnt(8)
	ds_read_b64_tr_b16 a[40:41], v28 offset:8192
	ds_read_b64_tr_b16 a[42:43], v28 offset:10240
	v_mfma_f32_16x16x32_bf16 a[8:11], a[52:55], v[84:87], a[8:11]
	s_waitcnt lgkmcnt(8)
	ds_read_b64_tr_b16 a[44:45], v28 offset:12288
	ds_read_b64_tr_b16 a[46:47], v28 offset:14336
	v_mfma_f32_16x16x32_bf16 a[8:11], a[56:59], v[88:91], a[8:11]
	s_waitcnt lgkmcnt(8)
	ds_read_b64_tr_b16 a[48:49], v28 offset:24576
	ds_read_b64_tr_b16 a[50:51], v28 offset:26624
	v_mfma_f32_16x16x32_bf16 a[8:11], a[60:63], v[92:95], a[8:11]
	s_waitcnt lgkmcnt(8)
	ds_read_b64_tr_b16 a[52:53], v28 offset:28672
	ds_read_b64_tr_b16 a[54:55], v28 offset:30720
	v_mfma_f32_16x16x32_bf16 a[8:11], a[32:35], v[96:99], a[8:11]
	s_waitcnt lgkmcnt(8)
	ds_read_b64_tr_b16 a[56:57], v28 offset:32768
	ds_read_b64_tr_b16 a[58:59], v28 offset:34816
	v_mfma_f32_16x16x32_bf16 a[8:11], a[36:39], v[100:103], a[8:11]
	s_waitcnt lgkmcnt(8)
	ds_read_b64_tr_b16 a[60:61], v28 offset:36864
	ds_read_b64_tr_b16 a[62:63], v28 offset:38912
	v_mfma_f32_16x16x32_bf16 a[8:11], a[40:43], v[104:107], a[8:11]
	s_waitcnt lgkmcnt(8)
	ds_read_b64_tr_b16 a[32:33], v29 offset:0
	ds_read_b64_tr_b16 a[34:35], v29 offset:2048
	v_mfma_f32_16x16x32_bf16 a[8:11], a[44:47], v[108:111], a[8:11]
	s_waitcnt lgkmcnt(8)
	ds_read_b64_tr_b16 a[36:37], v29 offset:4096
	ds_read_b64_tr_b16 a[38:39], v29 offset:6144
	v_mfma_f32_16x16x32_bf16 a[8:11], a[48:51], v[112:115], a[8:11]
	s_waitcnt lgkmcnt(8)
	ds_read_b64_tr_b16 a[40:41], v29 offset:8192
	ds_read_b64_tr_b16 a[42:43], v29 offset:10240
	v_mfma_f32_16x16x32_bf16 a[8:11], a[52:55], v[116:119], a[8:11]
	s_waitcnt lgkmcnt(8)
	ds_read_b64_tr_b16 a[44:45], v29 offset:12288
	ds_read_b64_tr_b16 a[46:47], v29 offset:14336
	v_mfma_f32_16x16x32_bf16 a[8:11], a[56:59], v[120:123], a[8:11]
	s_waitcnt lgkmcnt(8)
	ds_read_b64_tr_b16 a[48:49], v29 offset:24576
	ds_read_b64_tr_b16 a[50:51], v29 offset:26624
	v_mfma_f32_16x16x32_bf16 a[8:11], a[60:63], v[124:127], a[8:11]
	s_waitcnt lgkmcnt(8)
	ds_read_b64_tr_b16 a[52:53], v29 offset:28672
	ds_read_b64_tr_b16 a[54:55], v29 offset:30720
	v_mfma_f32_16x16x32_bf16 a[12:15], a[32:35], v[64:67], 0
	s_waitcnt lgkmcnt(8)
	ds_read_b64_tr_b16 a[56:57], v29 offset:32768
	ds_read_b64_tr_b16 a[58:59], v29 offset:34816
	v_mfma_f32_16x16x32_bf16 a[12:15], a[36:39], v[68:71], a[12:15]
	s_waitcnt lgkmcnt(8)
	ds_read_b64_tr_b16 a[60:61], v29 offset:36864
	ds_read_b64_tr_b16 a[62:63], v29 offset:38912
	v_add_u32 v29, 0xc000, v29
	v_mfma_f32_16x16x32_bf16 a[12:15], a[40:43], v[72:75], a[12:15]
	s_waitcnt lgkmcnt(8)
	ds_read_b64_tr_b16 a[32:33], v29 offset:0
	ds_read_b64_tr_b16 a[34:35], v29 offset:2048
	v_mfma_f32_16x16x32_bf16 a[12:15], a[44:47], v[76:79], a[12:15]
	s_waitcnt lgkmcnt(8)
	ds_read_b64_tr_b16 a[36:37], v29 offset:4096
	ds_read_b64_tr_b16 a[38:39], v29 offset:6144
	v_mfma_f32_16x16x32_bf16 a[12:15], a[48:51], v[80:83], a[12:15]
	s_waitcnt lgkmcnt(8)
	ds_read_b64_tr_b16 a[40:41], v29 offset:8192
	ds_read_b64_tr_b16 a[42:43], v29 offset:10240
	v_mfma_f32_16x16x32_bf16 a[12:15], a[52:55], v[84:87], a[12:15]
	s_waitcnt lgkmcnt(8)
	ds_read_b64_tr_b16 a[44:45], v29 offset:12288
	ds_read_b64_tr_b16 a[46:47], v29 offset:14336
	v_mfma_f32_16x16x32_bf16 a[12:15], a[56:59], v[88:91], a[12:15]
	s_waitcnt lgkmcnt(8)
	ds_read_b64_tr_b16 a[48:49], v29 offset:24576
	ds_read_b64_tr_b16 a[50:51], v29 offset:26624
	v_mfma_f32_16x16x32_bf16 a[12:15], a[60:63], v[92:95], a[12:15]
	s_waitcnt lgkmcnt(8)
	ds_read_b64_tr_b16 a[52:53], v29 offset:28672
	ds_read_b64_tr_b16 a[54:55], v29 offset:30720
	v_mfma_f32_16x16x32_bf16 a[12:15], a[32:35], v[96:99], a[12:15]
	s_waitcnt lgkmcnt(8)
	ds_read_b64_tr_b16 a[56:57], v29 offset:32768
	ds_read_b64_tr_b16 a[58:59], v29 offset:34816
	v_mfma_f32_16x16x32_bf16 a[12:15], a[36:39], v[100:103], a[12:15]
	s_waitcnt lgkmcnt(8)
	ds_read_b64_tr_b16 a[60:61], v29 offset:36864
	ds_read_b64_tr_b16 a[62:63], v29 offset:38912
	v_mfma_f32_16x16x32_bf16 a[12:15], a[40:43], v[104:107], a[12:15]
	s_waitcnt lgkmcnt(8)
	v_mfma_f32_16x16x32_bf16 a[12:15], a[44:47], v[108:111], a[12:15]
	s_waitcnt lgkmcnt(6)
	v_mfma_f32_16x16x32_bf16 a[12:15], a[48:51], v[112:115], a[12:15]
	s_waitcnt lgkmcnt(4)
	v_mfma_f32_16x16x32_bf16 a[12:15], a[52:55], v[116:119], a[12:15]
	s_waitcnt lgkmcnt(2)
	v_mfma_f32_16x16x32_bf16 a[12:15], a[56:59], v[120:123], a[12:15]
	s_waitcnt lgkmcnt(0)
	v_mfma_f32_16x16x32_bf16 a[12:15], a[60:63], v[124:127], a[12:15]
	s_nop 0
	v_accvgpr_read_b32 v96, a160
	v_accvgpr_read_b32 v97, a161
	v_accvgpr_read_b32 v98, a162
	v_accvgpr_read_b32 v99, a163
	v_accvgpr_read_b32 v100, a164
	v_accvgpr_read_b32 v101, a165
	v_accvgpr_read_b32 v102, a166
	v_accvgpr_read_b32 v103, a167
	v_lshlrev_b32 v80, 16, v96
	v_and_b32 v81, 0xffff0000, v96
	v_lshlrev_b32 v82, 16, v97
	v_and_b32 v83, 0xffff0000, v97
	v_lshlrev_b32 v84, 16, v98
	v_and_b32 v85, 0xffff0000, v98
	v_lshlrev_b32 v86, 16, v99
	v_and_b32 v87, 0xffff0000, v99
	v_lshlrev_b32 v88, 16, v100
	v_and_b32 v89, 0xffff0000, v100
	v_lshlrev_b32 v90, 16, v101
	v_and_b32 v91, 0xffff0000, v101
	v_lshlrev_b32 v92, 16, v102
	v_and_b32 v93, 0xffff0000, v102
	v_lshlrev_b32 v94, 16, v103
	v_and_b32 v95, 0xffff0000, v103
	v_mov_b32 v104, 0x40faf233
	v_accvgpr_read_b32 v64, a0
	v_accvgpr_read_b32 v65, a1
	v_accvgpr_read_b32 v66, a2
	v_accvgpr_read_b32 v67, a3
	v_accvgpr_read_b32 v68, a4
	v_accvgpr_read_b32 v69, a5
	v_accvgpr_read_b32 v70, a6
	v_accvgpr_read_b32 v71, a7
	v_accvgpr_read_b32 v72, a8
	v_accvgpr_read_b32 v73, a9
	v_accvgpr_read_b32 v74, a10
	v_accvgpr_read_b32 v75, a11
	v_accvgpr_read_b32 v76, a12
	v_accvgpr_read_b32 v77, a13
	v_accvgpr_read_b32 v78, a14
	v_accvgpr_read_b32 v79, a15
	ds_read_b128 a[0:3], v9 offset:0
	ds_read_b128 a[4:7], v10 offset:0
	ds_read_b128 a[8:11], v11 offset:0
	ds_read_b128 a[12:15], v12 offset:0
	v_pk_fma_f32 v[64:65], v[80:81], v[104:105], v[64:65] op_sel_hi:[1,0,1]
	v_pk_fma_f32 v[66:67], v[82:83], v[104:105], v[66:67] op_sel_hi:[1,0,1]
	v_pk_fma_f32 v[68:69], v[84:85], v[104:105], v[68:69] op_sel_hi:[1,0,1]
	v_pk_fma_f32 v[70:71], v[86:87], v[104:105], v[70:71] op_sel_hi:[1,0,1]
	v_pk_fma_f32 v[72:73], v[88:89], v[104:105], v[72:73] op_sel_hi:[1,0,1]
	v_pk_fma_f32 v[74:75], v[90:91], v[104:105], v[74:75] op_sel_hi:[1,0,1]
	v_pk_fma_f32 v[76:77], v[92:93], v[104:105], v[76:77] op_sel_hi:[1,0,1]
	v_pk_fma_f32 v[78:79], v[94:95], v[104:105], v[78:79] op_sel_hi:[1,0,1]
	v_cvt_pk_bf16_f32 v96, v64, v65
	v_cvt_pk_bf16_f32 v97, v66, v67
	v_cvt_pk_bf16_f32 v98, v68, v69
	v_cvt_pk_bf16_f32 v99, v70, v71
	v_cvt_pk_bf16_f32 v100, v72, v73
	v_cvt_pk_bf16_f32 v101, v74, v75
	v_cvt_pk_bf16_f32 v102, v76, v77
	v_cvt_pk_bf16_f32 v103, v78, v79
	ds_read_b128 a[28:31], v12 offset:4096
	ds_read_b128 a[24:27], v11 offset:4096
	ds_read_b128 a[20:23], v10 offset:4096
	ds_read_b128 a[16:19], v9 offset:4096
	s_add_u32 s73, s85, 0x2000
	buffer_store_dwordx4 v[96:99], v13, s[48:51], s85 offen sc1
	buffer_store_dwordx4 v[100:103], v13, s[48:51], s73 offen sc1
	v_lshlrev_b32 v64, 16, v96
	v_and_b32 v65, 0xffff0000, v96
	v_accvgpr_write_b32 a140, v96
	v_lshlrev_b32 v66, 16, v97
	v_and_b32 v67, 0xffff0000, v97
	v_accvgpr_write_b32 a141, v97
	v_lshlrev_b32 v68, 16, v98
	v_and_b32 v69, 0xffff0000, v98
	v_accvgpr_write_b32 a142, v98
	v_lshlrev_b32 v70, 16, v99
	v_and_b32 v71, 0xffff0000, v99
	v_accvgpr_write_b32 a143, v99
	v_lshlrev_b32 v72, 16, v100
	ds_read_b128 a[32:35], v9 offset:8192
	ds_read_b128 a[36:39], v10 offset:8192
	ds_read_b128 a[40:43], v11 offset:8192
	ds_read_b128 a[44:47], v12 offset:8192
	v_and_b32 v73, 0xffff0000, v100
	v_accvgpr_write_b32 a144, v100
	v_lshlrev_b32 v74, 16, v101
	v_and_b32 v75, 0xffff0000, v101
	v_accvgpr_write_b32 a145, v101
	v_lshlrev_b32 v76, 16, v102
	v_and_b32 v77, 0xffff0000, v102
	v_accvgpr_write_b32 a146, v102
	v_lshlrev_b32 v78, 16, v103
	v_and_b32 v79, 0xffff0000, v103
	v_accvgpr_write_b32 a147, v103
	v_pk_add_f32 v[80:81], v[64:65], v[72:73]
	v_pk_add_f32 v[82:83], v[66:67], v[74:75]
	v_pk_add_f32 v[84:85], v[68:69], v[76:77]
	v_pk_add_f32 v[86:87], v[70:71], v[78:79]
	v_pk_add_f32 v[80:81], v[80:81], v[82:83]
	ds_read_b128 a[60:63], v12 offset:12288
	ds_read_b128 a[56:59], v11 offset:12288
	ds_read_b128 a[52:55], v10 offset:12288
	ds_read_b128 a[48:51], v9 offset:12288
	v_pk_add_f32 v[84:85], v[84:85], v[86:87]
	v_pk_add_f32 v[80:81], v[80:81], v[84:85]
	v_add_f32 v88, v80, v81
	v_mov_b32 v90, v88
	s_nop 1
	v_permlane32_swap_b32 v90, v88
	v_add_f32 v88, v88, v90
	v_mov_b32 v90, v88
	s_nop 1
	v_permlane16_swap_b32 v90, v88
	v_add_f32_e64 v88, v88, v90
	v_mul_f32 v88, 0x3c800000, v88
	v_pk_add_f32 v[64:65], v[64:65], v[88:89] op_sel_hi:[1,0] neg_lo:[0,1] neg_hi:[0,1]
	v_pk_add_f32 v[66:67], v[66:67], v[88:89] op_sel_hi:[1,0] neg_lo:[0,1] neg_hi:[0,1]
	v_pk_add_f32 v[68:69], v[68:69], v[88:89] op_sel_hi:[1,0] neg_lo:[0,1] neg_hi:[0,1]
	v_pk_add_f32 v[70:71], v[70:71], v[88:89] op_sel_hi:[1,0] neg_lo:[0,1] neg_hi:[0,1]
	v_pk_add_f32 v[72:73], v[72:73], v[88:89] op_sel_hi:[1,0] neg_lo:[0,1] neg_hi:[0,1]
	v_pk_add_f32 v[74:75], v[74:75], v[88:89] op_sel_hi:[1,0] neg_lo:[0,1] neg_hi:[0,1]
	v_pk_add_f32 v[76:77], v[76:77], v[88:89] op_sel_hi:[1,0] neg_lo:[0,1] neg_hi:[0,1]
	v_pk_add_f32 v[78:79], v[78:79], v[88:89] op_sel_hi:[1,0] neg_lo:[0,1] neg_hi:[0,1]
	v_pk_mul_f32 v[80:81], v[64:65], v[64:65]
	v_pk_fma_f32 v[80:81], v[66:67], v[66:67], v[80:81]
	v_pk_fma_f32 v[80:81], v[68:69], v[68:69], v[80:81]
	v_pk_fma_f32 v[80:81], v[70:71], v[70:71], v[80:81]
	v_pk_fma_f32 v[80:81], v[72:73], v[72:73], v[80:81]
	v_pk_fma_f32 v[80:81], v[74:75], v[74:75], v[80:81]
	v_pk_fma_f32 v[80:81], v[76:77], v[76:77], v[80:81]
	v_pk_fma_f32 v[80:81], v[78:79], v[78:79], v[80:81]
	v_add_f32 v89, v80, v81
	v_lshlrev_b32 v80, 3, v0
	v_mov_b32 v81, 0x40000000
	v_cmp_gt_u32 vcc, 16, v0
	v_mov_b32 v90, v89
	s_nop 1
	v_permlane32_swap_b32 v90, v89
	v_add_f32 v89, v89, v90
	v_mov_b32 v90, v89
	s_nop 1
	v_permlane16_swap_b32 v90, v89
	v_add_f32 v89, v89, v90
	v_cndmask_b32 v80, v81, v80, vcc
	buffer_store_dwordx2 v[88:89], v80, s[48:51], s87 offen sc1
	s_waitcnt lgkmcnt(14)
	v_mfma_f32_16x16x32_bf16 v[32:35], a[0:3], a[192:195], -4.0
	v_exp_f32 v40, v40
	v_mfma_f32_16x16x32_bf16 v[32:35], a[4:7], a[196:199], v[32:35]
	s_waitcnt lgkmcnt(13)
	v_lshrrev_b32 v26, 4, v0
	v_and_b32 v27, 15, v0
	v_mfma_f32_16x16x32_bf16 v[32:35], a[8:11], a[200:203], v[32:35]
	s_waitcnt lgkmcnt(12)
	v_exp_f32 v41, v41
	v_mfma_f32_16x16x32_bf16 v[32:35], a[12:15], a[204:207], v[32:35]
	s_waitcnt lgkmcnt(11)
	v_cvt_pk_bf16_f32 v60, v40, v41
	v_mul_u32_u24 v28, 3584, v26
	v_mfma_f32_16x16x32_bf16 v[36:39], a[28:31], a[204:207], -4.0
	s_waitcnt lgkmcnt(10)
	v_exp_f32 v42, v42
	v_mfma_f32_16x16x32_bf16 v[36:39], a[24:27], a[200:203], v[36:39]
	s_waitcnt lgkmcnt(9)
	v_lshl_add_u32 v29, v27, 4, v28
	v_lshlrev_b32 v26, 8, v26
	v_mfma_f32_16x16x32_bf16 v[36:39], a[20:23], a[196:199], v[36:39]
	s_waitcnt lgkmcnt(8)
	v_exp_f32 v43, v43
	v_mfma_f32_16x16x32_bf16 v[36:39], a[16:19], a[192:195], v[36:39]
	v_cvt_pk_bf16_f32 v61, v42, v43
	v_lshl_or_b32 v26, v27, 3, v26
	v_mfma_f32_16x16x32_bf16 v[200:203], a[80:83], v[48:51], v[200:203]
	v_exp_f32 v44, v44
	v_mfma_f32_16x16x32_bf16 v[200:203], a[112:115], v[52:55], v[200:203]
	v_lshl_add_u32 v26, s63, 10, v26
	v_add_u32 v30, 0x600000, v26
	v_mfma_f32_16x16x32_bf16 v[216:219], a[116:119], v[52:55], v[216:219]
	v_exp_f32 v45, v45
	v_mfma_f32_16x16x32_bf16 v[216:219], a[84:87], v[48:51], v[216:219]
	v_cvt_pk_bf16_f32 v62, v44, v45
	v_and_b32 v26, 7, v0
	v_mfma_f32_16x16x32_bf16 v[232:235], a[88:91], v[48:51], v[232:235]
	v_exp_f32 v46, v46
	v_mfma_f32_16x16x32_bf16 v[232:235], a[120:123], v[52:55], v[232:235]
	v_lshl_or_b32 v26, s63, 3, v26
	v_lshlrev_b32 v26, 7, v26
	v_mfma_f32_16x16x32_bf16 v[248:251], a[124:127], v[52:55], v[248:251]
	v_exp_f32 v47, v47
	v_mfma_f32_16x16x32_bf16 v[248:251], a[92:95], v[48:51], v[248:251]
	s_waitcnt lgkmcnt(0)
	v_cvt_pk_bf16_f32 v63, v46, v47
	v_add_u32 v24, 0x420000, v26
	v_mfma_f32_16x16x32_bf16 v[40:43], a[32:35], a[192:195], -4.0
	v_exp_f32 v32, v32
	v_mfma_f32_16x16x32_bf16 v[40:43], a[36:39], a[196:199], v[40:43]
	v_or_b32 v27, s62, v0
	v_cmp_eq_u32 vcc, 0, v27
	v_mfma_f32_16x16x32_bf16 v[40:43], a[40:43], a[200:203], v[40:43]
	v_exp_f32 v33, v33
	v_mfma_f32_16x16x32_bf16 v[40:43], a[44:47], a[204:207], v[40:43]
	v_cvt_pk_bf16_f32 v48, v32, v33
	v_mov_b32 v28, 0x40000000
	v_mfma_f32_16x16x32_bf16 v[44:47], a[60:63], a[204:207], -4.0
	v_exp_f32 v34, v34
	v_mfma_f32_16x16x32_bf16 v[44:47], a[56:59], a[200:203], v[44:47]
	v_mov_b32 v26, 1
	v_cndmask_b32 v27, v28, 0, vcc
	v_mfma_f32_16x16x32_bf16 v[44:47], a[52:55], a[196:199], v[44:47]
	v_exp_f32 v35, v35
	v_mfma_f32_16x16x32_bf16 v[44:47], a[48:51], a[192:195], v[44:47]
	v_cvt_pk_bf16_f32 v49, v34, v35
	v_smfmac_f32_16x16x64_bf16 a[136:139], a[168:171], v[56:63], v31
	v_mfma_f32_16x16x32_bf16 v[140:143], a[64:67], v[56:59], v[140:143]
	v_exp_f32 v36, v36
	v_mfma_f32_16x16x32_bf16 v[140:143], a[96:99], v[60:63], v[140:143]
	ds_read_b64_tr_b16 a[64:65], v1 offset:0
	ds_read_b64_tr_b16 a[66:67], v1 offset:4096
	v_mfma_f32_16x16x32_bf16 v[156:159], a[100:103], v[60:63], v[156:159]
	v_exp_f32 v37, v37
	v_mfma_f32_16x16x32_bf16 v[156:159], a[68:71], v[56:59], v[156:159]
	ds_read_b64_tr_b16 a[96:97], v1 offset:8192
	v_cvt_pk_bf16_f32 v50, v36, v37
	v_mfma_f32_16x16x32_bf16 v[172:175], a[72:75], v[56:59], v[172:175]
	v_exp_f32 v38, v38
	v_mfma_f32_16x16x32_bf16 v[172:175], a[104:107], v[60:63], v[172:175]
	ds_read_b64_tr_b16 a[98:99], v1 offset:12288
	ds_read_b64_tr_b16 a[100:101], v2 offset:8192
	v_mfma_f32_16x16x32_bf16 v[188:191], a[108:111], v[60:63], v[188:191]
	v_exp_f32 v39, v39
	v_mfma_f32_16x16x32_bf16 v[188:191], a[76:79], v[56:59], v[188:191]
	ds_read_b64_tr_b16 a[102:103], v2 offset:12288
	v_cvt_pk_bf16_f32 v51, v38, v39
	v_mfma_f32_16x16x32_bf16 v[32:35], a[0:3], a[208:211], -4.0
	v_exp_f32 v40, v40
	v_mfma_f32_16x16x32_bf16 v[32:35], a[4:7], a[212:215], v[32:35]
	ds_read_b64_tr_b16 a[68:69], v2 offset:0
	ds_read_b64_tr_b16 a[70:71], v2 offset:4096
	v_mfma_f32_16x16x32_bf16 v[32:35], a[8:11], a[216:219], v[32:35]
	v_exp_f32 v41, v41
	v_mfma_f32_16x16x32_bf16 v[32:35], a[12:15], a[220:223], v[32:35]
	ds_read_b64_tr_b16 a[72:73], v3 offset:0
	v_cvt_pk_bf16_f32 v52, v40, v41
	v_mfma_f32_16x16x32_bf16 v[36:39], a[28:31], a[220:223], -4.0
	v_exp_f32 v42, v42
	v_mfma_f32_16x16x32_bf16 v[36:39], a[24:27], a[216:219], v[36:39]
	ds_read_b64_tr_b16 a[74:75], v3 offset:4096
	ds_read_b64_tr_b16 a[104:105], v3 offset:8192
	v_mfma_f32_16x16x32_bf16 v[36:39], a[20:23], a[212:215], v[36:39]
	v_exp_f32 v43, v43
	v_mfma_f32_16x16x32_bf16 v[36:39], a[16:19], a[208:211], v[36:39]
	ds_read_b64_tr_b16 a[106:107], v3 offset:12288
	v_cvt_pk_bf16_f32 v53, v42, v43
	v_mfma_f32_16x16x32_bf16 v[204:207], a[80:83], v[56:59], v[204:207]
	v_exp_f32 v44, v44
	v_mfma_f32_16x16x32_bf16 v[204:207], a[112:115], v[60:63], v[204:207]
	ds_read_b64_tr_b16 a[108:109], v4 offset:8192
	ds_read_b64_tr_b16 a[110:111], v4 offset:12288
	v_mfma_f32_16x16x32_bf16 v[220:223], a[116:119], v[60:63], v[220:223]
	v_exp_f32 v45, v45
	v_mfma_f32_16x16x32_bf16 v[220:223], a[84:87], v[56:59], v[220:223]
	ds_read_b64_tr_b16 a[76:77], v4 offset:0
	v_cvt_pk_bf16_f32 v54, v44, v45
	v_mfma_f32_16x16x32_bf16 v[236:239], a[88:91], v[56:59], v[236:239]
	v_exp_f32 v46, v46
	v_mfma_f32_16x16x32_bf16 v[236:239], a[120:123], v[60:63], v[236:239]
	ds_read_b64_tr_b16 a[78:79], v4 offset:4096
	ds_read_b64_tr_b16 a[80:81], v5 offset:0
	v_mfma_f32_16x16x32_bf16 v[252:255], a[124:127], v[60:63], v[252:255]
	v_exp_f32 v47, v47
	v_mfma_f32_16x16x32_bf16 v[252:255], a[92:95], v[56:59], v[252:255]
	ds_read_b64_tr_b16 a[82:83], v5 offset:4096
	v_cvt_pk_bf16_f32 v55, v46, v47
	v_mfma_f32_16x16x32_bf16 v[40:43], a[32:35], a[208:211], -4.0
	v_exp_f32 v32, v32
	v_mfma_f32_16x16x32_bf16 v[40:43], a[36:39], a[212:215], v[40:43]
	ds_read_b64_tr_b16 a[112:113], v5 offset:8192
	ds_read_b64_tr_b16 a[114:115], v5 offset:12288
	v_mfma_f32_16x16x32_bf16 v[40:43], a[40:43], a[216:219], v[40:43]
	v_exp_f32 v33, v33
	v_mfma_f32_16x16x32_bf16 v[40:43], a[44:47], a[220:223], v[40:43]
	ds_read_b64_tr_b16 a[116:117], v6 offset:8192
	v_cvt_pk_bf16_f32 v56, v32, v33
	v_mfma_f32_16x16x32_bf16 v[44:47], a[60:63], a[220:223], -4.0
	v_exp_f32 v34, v34
	v_mfma_f32_16x16x32_bf16 v[44:47], a[56:59], a[216:219], v[44:47]
	ds_read_b64_tr_b16 a[118:119], v6 offset:12288
	ds_read_b64_tr_b16 a[84:85], v6 offset:0
	v_mfma_f32_16x16x32_bf16 v[44:47], a[52:55], a[212:215], v[44:47]
	v_exp_f32 v35, v35
	v_mfma_f32_16x16x32_bf16 v[44:47], a[48:51], a[208:211], v[44:47]
	ds_read_b64_tr_b16 a[86:87], v6 offset:4096
	v_cvt_pk_bf16_f32 v57, v34, v35
	v_smfmac_f32_16x16x64_bf16 a[132:135], a[128:131], v[48:55], v31
	s_waitcnt lgkmcnt(7)
	v_mfma_f32_16x16x32_bf16 v[128:131], a[64:67], v[48:51], v[128:131]
	v_exp_f32 v36, v36
	v_mfma_f32_16x16x32_bf16 v[128:131], a[96:99], v[52:55], v[128:131]
	ds_read_b64_tr_b16 a[88:89], v7 offset:0
	ds_read_b64_tr_b16 a[90:91], v7 offset:4096
	v_mfma_f32_16x16x32_bf16 v[144:147], a[100:103], v[52:55], v[144:147]
	v_exp_f32 v37, v37
	v_mfma_f32_16x16x32_bf16 v[144:147], a[68:71], v[48:51], v[144:147]
	ds_read_b64_tr_b16 a[120:121], v7 offset:8192
	v_cvt_pk_bf16_f32 v58, v36, v37
	v_mfma_f32_16x16x32_bf16 v[160:163], a[72:75], v[48:51], v[160:163]
	v_exp_f32 v38, v38
	v_mfma_f32_16x16x32_bf16 v[160:163], a[104:107], v[52:55], v[160:163]
	ds_read_b64_tr_b16 a[122:123], v7 offset:12288
	ds_read_b64_tr_b16 a[124:125], v8 offset:8192
	v_mfma_f32_16x16x32_bf16 v[176:179], a[108:111], v[52:55], v[176:179]
	v_exp_f32 v39, v39
	v_mfma_f32_16x16x32_bf16 v[176:179], a[76:79], v[48:51], v[176:179]
	ds_read_b64_tr_b16 a[126:127], v8 offset:12288
	v_cvt_pk_bf16_f32 v59, v38, v39
	v_mfma_f32_16x16x32_bf16 v[32:35], a[0:3], a[224:227], -4.0
	v_exp_f32 v40, v40
	v_mfma_f32_16x16x32_bf16 v[32:35], a[4:7], a[228:231], v[32:35]
	ds_read_b64_tr_b16 a[92:93], v8 offset:0
	ds_read_b64_tr_b16 a[94:95], v8 offset:4096
	v_mfma_f32_16x16x32_bf16 v[32:35], a[8:11], a[232:235], v[32:35]
	v_exp_f32 v41, v41
	v_mfma_f32_16x16x32_bf16 v[32:35], a[12:15], a[236:239], v[32:35]
	v_cvt_pk_bf16_f32 v60, v40, v41
	v_mfma_f32_16x16x32_bf16 v[36:39], a[28:31], a[236:239], -4.0
	v_exp_f32 v42, v42
	v_mfma_f32_16x16x32_bf16 v[36:39], a[24:27], a[232:235], v[36:39]
	v_mfma_f32_16x16x32_bf16 v[36:39], a[20:23], a[228:231], v[36:39]
	v_exp_f32 v43, v43
	v_mfma_f32_16x16x32_bf16 v[36:39], a[16:19], a[224:227], v[36:39]
	s_waitcnt lgkmcnt(3)
	v_cvt_pk_bf16_f32 v61, v42, v43
	v_mfma_f32_16x16x32_bf16 v[192:195], a[80:83], v[48:51], v[192:195]
	s_mov_b32 s74, 0x420000
	v_exp_f32 v44, v44
	v_mfma_f32_16x16x32_bf16 v[192:195], a[112:115], v[52:55], v[192:195]
	s_waitcnt vmcnt(0)
	buffer_store_dword v23, v22, s[48:51], s74 offen sc1
	v_mfma_f32_16x16x32_bf16 v[208:211], a[116:119], v[52:55], v[208:211]
	v_exp_f32 v45, v45
	v_mfma_f32_16x16x32_bf16 v[208:211], a[84:87], v[48:51], v[208:211]
	v_cvt_pk_bf16_f32 v62, v44, v45
	v_mfma_f32_16x16x32_bf16 v[224:227], a[88:91], v[48:51], v[224:227]
	v_exp_f32 v46, v46
	v_mfma_f32_16x16x32_bf16 v[224:227], a[120:123], v[52:55], v[224:227]
	s_waitcnt lgkmcnt(0)
	v_mfma_f32_16x16x32_bf16 v[240:243], a[124:127], v[52:55], v[240:243]
	v_exp_f32 v47, v47
	v_mfma_f32_16x16x32_bf16 v[240:243], a[92:95], v[48:51], v[240:243]
	s_barrier
	v_cvt_pk_bf16_f32 v63, v46, v47
	v_mfma_f32_16x16x32_bf16 v[40:43], a[32:35], a[224:227], -4.0
	s_add_u32 m0, s65, 0x0
	v_exp_f32 v32, v32
	v_mfma_f32_16x16x32_bf16 v[40:43], a[36:39], a[228:231], v[40:43]
	buffer_load_dwordx4 v18, s[8:11], s68 offen lds
	v_mfma_f32_16x16x32_bf16 v[40:43], a[40:43], a[232:235], v[40:43]
	v_exp_f32 v33, v33
	v_mfma_f32_16x16x32_bf16 v[40:43], a[44:47], a[236:239], v[40:43]
	v_cvt_pk_bf16_f32 v48, v32, v33
	v_mfma_f32_16x16x32_bf16 v[44:47], a[60:63], a[236:239], -4.0
	v_exp_f32 v34, v34
	v_mfma_f32_16x16x32_bf16 v[44:47], a[56:59], a[232:235], v[44:47]
	buffer_load_dwordx4 v19, s[8:11], s68 offen offset:1024 lds
	v_mfma_f32_16x16x32_bf16 v[44:47], a[52:55], a[228:231], v[44:47]
	s_add_u32 s68, s68, 0x2000
	v_exp_f32 v35, v35
	v_mfma_f32_16x16x32_bf16 v[44:47], a[48:51], a[224:227], v[44:47]
	s_and_b32 s68, s68, 0x7ffff
	v_cvt_pk_bf16_f32 v49, v34, v35
	v_smfmac_f32_16x16x64_bf16 a[132:135], a[168:171], v[56:63], v31
	v_mfma_f32_16x16x32_bf16 v[132:135], a[64:67], v[56:59], v[132:135]
	s_add_u32 m0, s65, 0x2000
	v_exp_f32 v36, v36
	v_mfma_f32_16x16x32_bf16 v[132:135], a[96:99], v[60:63], v[132:135]
	buffer_load_dwordx4 v18, s[8:11], s68 offen lds
	v_mfma_f32_16x16x32_bf16 v[148:151], a[100:103], v[60:63], v[148:151]
	v_exp_f32 v37, v37
	v_mfma_f32_16x16x32_bf16 v[148:151], a[68:71], v[56:59], v[148:151]
	v_cvt_pk_bf16_f32 v50, v36, v37
	v_mfma_f32_16x16x32_bf16 v[164:167], a[72:75], v[56:59], v[164:167]
	v_exp_f32 v38, v38
	v_mfma_f32_16x16x32_bf16 v[164:167], a[104:107], v[60:63], v[164:167]
	buffer_load_dwordx4 v19, s[8:11], s68 offen offset:1024 lds
	v_mfma_f32_16x16x32_bf16 v[180:183], a[108:111], v[60:63], v[180:183]
	s_add_u32 s68, s68, 0x2000
	v_exp_f32 v39, v39
	v_mfma_f32_16x16x32_bf16 v[180:183], a[76:79], v[56:59], v[180:183]
	s_and_b32 s68, s68, 0x7ffff
	v_cvt_pk_bf16_f32 v51, v38, v39
	v_mfma_f32_16x16x32_bf16 v[32:35], a[0:3], a[240:243], -4.0
	s_add_u32 m0, s65, 0x8000
	v_exp_f32 v40, v40
	v_mfma_f32_16x16x32_bf16 v[32:35], a[4:7], a[244:247], v[32:35]
	buffer_load_dwordx4 v20, s[12:15], s69 offen lds
	v_mfma_f32_16x16x32_bf16 v[32:35], a[8:11], a[248:251], v[32:35]
	v_exp_f32 v41, v41
	v_mfma_f32_16x16x32_bf16 v[32:35], a[12:15], a[252:255], v[32:35]
	ds_read_b128 a[0:3], v9 offset:16384
	v_cvt_pk_bf16_f32 v52, v40, v41
	v_mfma_f32_16x16x32_bf16 v[36:39], a[28:31], a[252:255], -4.0
	v_exp_f32 v42, v42
	v_mfma_f32_16x16x32_bf16 v[36:39], a[24:27], a[248:251], v[36:39]
	buffer_load_dwordx4 v21, s[12:15], s69 offen offset:1024 lds
	v_mfma_f32_16x16x32_bf16 v[36:39], a[20:23], a[244:247], v[36:39]
	v_exp_f32 v43, v43
	v_mfma_f32_16x16x32_bf16 v[36:39], a[16:19], a[240:243], v[36:39]
	ds_read_b128 a[4:7], v10 offset:16384
	v_cvt_pk_bf16_f32 v53, v42, v43
	v_mfma_f32_16x16x32_bf16 v[196:199], a[80:83], v[56:59], v[196:199]
	v_exp_f32 v44, v44
	v_mfma_f32_16x16x32_bf16 v[196:199], a[112:115], v[60:63], v[196:199]
	ds_read_b128 a[8:11], v11 offset:16384
	ds_read_b128 a[12:15], v12 offset:16384
	v_mfma_f32_16x16x32_bf16 v[212:215], a[116:119], v[60:63], v[212:215]
	s_add_u32 s69, s69, 0x2000
	v_exp_f32 v45, v45
	v_mfma_f32_16x16x32_bf16 v[212:215], a[84:87], v[56:59], v[212:215]
	s_and_b32 s69, s69, 0x7ffff
	ds_read_b128 a[28:31], v12 offset:20480
	v_cvt_pk_bf16_f32 v54, v44, v45
	v_mfma_f32_16x16x32_bf16 v[228:231], a[88:91], v[56:59], v[228:231]
	s_add_u32 m0, s65, 0xa000
	v_exp_f32 v46, v46
	v_mfma_f32_16x16x32_bf16 v[228:231], a[120:123], v[60:63], v[228:231]
	buffer_load_dwordx4 v20, s[12:15], s69 offen lds
	v_mfma_f32_16x16x32_bf16 v[244:247], a[124:127], v[60:63], v[244:247]
	v_exp_f32 v47, v47
	v_mfma_f32_16x16x32_bf16 v[244:247], a[92:95], v[56:59], v[244:247]
	ds_read_b128 a[24:27], v11 offset:20480
	v_cvt_pk_bf16_f32 v55, v46, v47
	v_mfma_f32_16x16x32_bf16 v[40:43], a[32:35], a[240:243], -4.0
L_pg9:
	s_cbranch_execz L_pg13
	s_add_u32 m0, s65, 0xa000
	v_exp_f32 v32, v32
	v_mfma_f32_16x16x32_bf16 v[40:43], a[36:39], a[244:247], v[40:43]
	buffer_load_dwordx4 v21, s[12:15], s69 offen offset:1024 lds
	v_mfma_f32_16x16x32_bf16 v[40:43], a[40:43], a[248:251], v[40:43]
	s_add_u32 s69, s69, 0x2000
	v_exp_f32 v33, v33
	v_mfma_f32_16x16x32_bf16 v[40:43], a[44:47], a[252:255], v[40:43]
	s_and_b32 s69, s69, 0x7ffff
	ds_read_b128 a[20:23], v10 offset:20480
	v_cvt_pk_bf16_f32 v56, v32, v33
	v_mfma_f32_16x16x32_bf16 v[44:47], a[60:63], a[252:255], -4.0
	v_exp_f32 v34, v34
	v_mfma_f32_16x16x32_bf16 v[44:47], a[56:59], a[248:251], v[44:47]
	ds_read_b128 a[16:19], v9 offset:20480
	ds_read_b128 a[32:35], v9 offset:24576
	v_mfma_f32_16x16x32_bf16 v[44:47], a[52:55], a[244:247], v[44:47]
	v_exp_f32 v35, v35
	v_mfma_f32_16x16x32_bf16 v[44:47], a[48:51], a[240:243], v[44:47]
	ds_read_b128 a[36:39], v10 offset:24576
	v_cvt_pk_bf16_f32 v57, v34, v35
	v_smfmac_f32_16x16x64_bf16 a[136:139], a[128:131], v[48:55], v31
	v_mfma_f32_16x16x32_bf16 v[136:139], a[64:67], v[48:51], v[136:139]
	v_exp_f32 v36, v36
	v_mfma_f32_16x16x32_bf16 v[136:139], a[96:99], v[52:55], v[136:139]
	ds_read_b128 a[40:43], v11 offset:24576
	ds_read_b128 a[44:47], v12 offset:24576
	v_mfma_f32_16x16x32_bf16 v[152:155], a[100:103], v[52:55], v[152:155]
	v_exp_f32 v37, v37
	v_mfma_f32_16x16x32_bf16 v[152:155], a[68:71], v[48:51], v[152:155]
	ds_read_b128 a[60:63], v12 offset:28672
	v_cvt_pk_bf16_f32 v58, v36, v37
	v_mfma_f32_16x16x32_bf16 v[168:171], a[72:75], v[48:51], v[168:171]
	v_exp_f32 v38, v38
	v_mfma_f32_16x16x32_bf16 v[168:171], a[104:107], v[52:55], v[168:171]
	ds_read_b128 a[56:59], v11 offset:28672
	ds_read_b128 a[52:55], v10 offset:28672
	v_mfma_f32_16x16x32_bf16 v[184:187], a[108:111], v[52:55], v[184:187]
	v_exp_f32 v39, v39
	v_mfma_f32_16x16x32_bf16 v[184:187], a[76:79], v[48:51], v[184:187]
	ds_read_b128 a[48:51], v9 offset:28672
	v_cvt_pk_bf16_f32 v59, v38, v39
.p2align 3
L_attn0:
	s_waitcnt lgkmcnt(7)
	v_mfma_f32_16x16x32_bf16 v[32:35], a[0:3], a[192:195], -4.0
	v_exp_f32 v40, v40
	v_mfma_f32_16x16x32_bf16 v[32:35], a[4:7], a[196:199], v[32:35]
	v_mfma_f32_16x16x32_bf16 v[32:35], a[8:11], a[200:203], v[32:35]
	v_exp_f32 v41, v41
	v_mfma_f32_16x16x32_bf16 v[32:35], a[12:15], a[204:207], v[32:35]
	v_cvt_pk_bf16_f32 v60, v40, v41
	v_mfma_f32_16x16x32_bf16 v[36:39], a[28:31], a[204:207], -4.0
	v_exp_f32 v42, v42
	v_mfma_f32_16x16x32_bf16 v[36:39], a[24:27], a[200:203], v[36:39]
	v_mfma_f32_16x16x32_bf16 v[36:39], a[20:23], a[196:199], v[36:39]
	v_exp_f32 v43, v43
	v_mfma_f32_16x16x32_bf16 v[36:39], a[16:19], a[192:195], v[36:39]
	v_cvt_pk_bf16_f32 v61, v42, v43
	v_mfma_f32_16x16x32_bf16 v[200:203], a[80:83], v[48:51], v[200:203]
	v_exp_f32 v44, v44
	v_mfma_f32_16x16x32_bf16 v[200:203], a[112:115], v[52:55], v[200:203]
	v_mfma_f32_16x16x32_bf16 v[216:219], a[116:119], v[52:55], v[216:219]
	v_exp_f32 v45, v45
	v_mfma_f32_16x16x32_bf16 v[216:219], a[84:87], v[48:51], v[216:219]
	v_cvt_pk_bf16_f32 v62, v44, v45
	v_mfma_f32_16x16x32_bf16 v[232:235], a[88:91], v[48:51], v[232:235]
	v_exp_f32 v46, v46
	v_mfma_f32_16x16x32_bf16 v[232:235], a[120:123], v[52:55], v[232:235]
	v_mfma_f32_16x16x32_bf16 v[248:251], a[124:127], v[52:55], v[248:251]
	v_exp_f32 v47, v47
	v_mfma_f32_16x16x32_bf16 v[248:251], a[92:95], v[48:51], v[248:251]
	v_cvt_pk_bf16_f32 v63, v46, v47
	v_mfma_f32_16x16x32_bf16 v[40:43], a[32:35], a[192:195], -4.0
	s_waitcnt lgkmcnt(0)
	v_exp_f32 v32, v32
	v_mfma_f32_16x16x32_bf16 v[40:43], a[36:39], a[196:199], v[40:43]
	v_mfma_f32_16x16x32_bf16 v[40:43], a[40:43], a[200:203], v[40:43]
	v_exp_f32 v33, v33
	v_mfma_f32_16x16x32_bf16 v[40:43], a[44:47], a[204:207], v[40:43]
	v_cvt_pk_bf16_f32 v48, v32, v33
	v_mfma_f32_16x16x32_bf16 v[44:47], a[60:63], a[204:207], -4.0
	v_exp_f32 v34, v34
	v_mfma_f32_16x16x32_bf16 v[44:47], a[56:59], a[200:203], v[44:47]
	v_mfma_f32_16x16x32_bf16 v[44:47], a[52:55], a[196:199], v[44:47]
	v_exp_f32 v35, v35
	v_mfma_f32_16x16x32_bf16 v[44:47], a[48:51], a[192:195], v[44:47]
	v_cvt_pk_bf16_f32 v49, v34, v35
	v_smfmac_f32_16x16x64_bf16 a[136:139], a[168:171], v[56:63], v31
	v_mfma_f32_16x16x32_bf16 v[140:143], a[64:67], v[56:59], v[140:143]
	v_exp_f32 v36, v36
	v_mfma_f32_16x16x32_bf16 v[140:143], a[96:99], v[60:63], v[140:143]
	ds_read_b64_tr_b16 a[64:65], v1 offset:16384
	ds_read_b64_tr_b16 a[66:67], v1 offset:20480
	v_mfma_f32_16x16x32_bf16 v[156:159], a[100:103], v[60:63], v[156:159]
	v_exp_f32 v37, v37
	v_mfma_f32_16x16x32_bf16 v[156:159], a[68:71], v[56:59], v[156:159]
	ds_read_b64_tr_b16 a[96:97], v1 offset:24576
	v_cvt_pk_bf16_f32 v50, v36, v37
	v_mfma_f32_16x16x32_bf16 v[172:175], a[72:75], v[56:59], v[172:175]
	v_exp_f32 v38, v38
	v_mfma_f32_16x16x32_bf16 v[172:175], a[104:107], v[60:63], v[172:175]
	ds_read_b64_tr_b16 a[98:99], v1 offset:28672
	ds_read_b64_tr_b16 a[100:101], v2 offset:24576
	v_mfma_f32_16x16x32_bf16 v[188:191], a[108:111], v[60:63], v[188:191]
	v_exp_f32 v39, v39
	v_mfma_f32_16x16x32_bf16 v[188:191], a[76:79], v[56:59], v[188:191]
	ds_read_b64_tr_b16 a[102:103], v2 offset:28672
	v_cvt_pk_bf16_f32 v51, v38, v39
	v_mfma_f32_16x16x32_bf16 v[32:35], a[0:3], a[208:211], -4.0
	v_exp_f32 v40, v40
	v_mfma_f32_16x16x32_bf16 v[32:35], a[4:7], a[212:215], v[32:35]
	ds_read_b64_tr_b16 a[68:69], v2 offset:16384
	ds_read_b64_tr_b16 a[70:71], v2 offset:20480
	v_mfma_f32_16x16x32_bf16 v[32:35], a[8:11], a[216:219], v[32:35]
	v_exp_f32 v41, v41
	v_mfma_f32_16x16x32_bf16 v[32:35], a[12:15], a[220:223], v[32:35]
	ds_read_b64_tr_b16 a[72:73], v3 offset:16384
	v_cvt_pk_bf16_f32 v52, v40, v41
	v_mfma_f32_16x16x32_bf16 v[36:39], a[28:31], a[220:223], -4.0
	v_exp_f32 v42, v42
	v_mfma_f32_16x16x32_bf16 v[36:39], a[24:27], a[216:219], v[36:39]
	ds_read_b64_tr_b16 a[74:75], v3 offset:20480
	ds_read_b64_tr_b16 a[104:105], v3 offset:24576
	v_mfma_f32_16x16x32_bf16 v[36:39], a[20:23], a[212:215], v[36:39]
	v_exp_f32 v43, v43
	v_mfma_f32_16x16x32_bf16 v[36:39], a[16:19], a[208:211], v[36:39]
	ds_read_b64_tr_b16 a[106:107], v3 offset:28672
	v_cvt_pk_bf16_f32 v53, v42, v43
	v_mfma_f32_16x16x32_bf16 v[204:207], a[80:83], v[56:59], v[204:207]
	v_exp_f32 v44, v44
	v_mfma_f32_16x16x32_bf16 v[204:207], a[112:115], v[60:63], v[204:207]
	ds_read_b64_tr_b16 a[108:109], v4 offset:24576
	ds_read_b64_tr_b16 a[110:111], v4 offset:28672
	v_mfma_f32_16x16x32_bf16 v[220:223], a[116:119], v[60:63], v[220:223]
	v_exp_f32 v45, v45
	v_mfma_f32_16x16x32_bf16 v[220:223], a[84:87], v[56:59], v[220:223]
	ds_read_b64_tr_b16 a[76:77], v4 offset:16384
	v_cvt_pk_bf16_f32 v54, v44, v45
	v_mfma_f32_16x16x32_bf16 v[236:239], a[88:91], v[56:59], v[236:239]
	v_exp_f32 v46, v46
	v_mfma_f32_16x16x32_bf16 v[236:239], a[120:123], v[60:63], v[236:239]
	ds_read_b64_tr_b16 a[78:79], v4 offset:20480
	ds_read_b64_tr_b16 a[80:81], v5 offset:16384
	v_mfma_f32_16x16x32_bf16 v[252:255], a[124:127], v[60:63], v[252:255]
	v_exp_f32 v47, v47
	v_mfma_f32_16x16x32_bf16 v[252:255], a[92:95], v[56:59], v[252:255]
	ds_read_b64_tr_b16 a[82:83], v5 offset:20480
	v_cvt_pk_bf16_f32 v55, v46, v47
	v_mfma_f32_16x16x32_bf16 v[40:43], a[32:35], a[208:211], -4.0
	v_exp_f32 v32, v32
	v_mfma_f32_16x16x32_bf16 v[40:43], a[36:39], a[212:215], v[40:43]
	ds_read_b64_tr_b16 a[112:113], v5 offset:24576
	ds_read_b64_tr_b16 a[114:115], v5 offset:28672
	v_mfma_f32_16x16x32_bf16 v[40:43], a[40:43], a[216:219], v[40:43]
	v_exp_f32 v33, v33
	v_mfma_f32_16x16x32_bf16 v[40:43], a[44:47], a[220:223], v[40:43]
	ds_read_b64_tr_b16 a[116:117], v6 offset:24576
	v_cvt_pk_bf16_f32 v56, v32, v33
	v_mfma_f32_16x16x32_bf16 v[44:47], a[60:63], a[220:223], -4.0
	v_exp_f32 v34, v34
	v_mfma_f32_16x16x32_bf16 v[44:47], a[56:59], a[216:219], v[44:47]
	ds_read_b64_tr_b16 a[118:119], v6 offset:28672
	ds_read_b64_tr_b16 a[84:85], v6 offset:16384
	v_mfma_f32_16x16x32_bf16 v[44:47], a[52:55], a[212:215], v[44:47]
	v_exp_f32 v35, v35
	v_mfma_f32_16x16x32_bf16 v[44:47], a[48:51], a[208:211], v[44:47]
	ds_read_b64_tr_b16 a[86:87], v6 offset:20480
	v_cvt_pk_bf16_f32 v57, v34, v35
	v_smfmac_f32_16x16x64_bf16 a[132:135], a[128:131], v[48:55], v31
	s_waitcnt lgkmcnt(7)
	v_mfma_f32_16x16x32_bf16 v[128:131], a[64:67], v[48:51], v[128:131]
	v_exp_f32 v36, v36
	v_mfma_f32_16x16x32_bf16 v[128:131], a[96:99], v[52:55], v[128:131]
	ds_read_b64_tr_b16 a[88:89], v7 offset:16384
	ds_read_b64_tr_b16 a[90:91], v7 offset:20480
	v_mfma_f32_16x16x32_bf16 v[144:147], a[100:103], v[52:55], v[144:147]
	v_exp_f32 v37, v37
	v_mfma_f32_16x16x32_bf16 v[144:147], a[68:71], v[48:51], v[144:147]
	ds_read_b64_tr_b16 a[120:121], v7 offset:24576
	v_cvt_pk_bf16_f32 v58, v36, v37
	v_mfma_f32_16x16x32_bf16 v[160:163], a[72:75], v[48:51], v[160:163]
	v_exp_f32 v38, v38
	v_mfma_f32_16x16x32_bf16 v[160:163], a[104:107], v[52:55], v[160:163]
	ds_read_b64_tr_b16 a[122:123], v7 offset:28672
	ds_read_b64_tr_b16 a[124:125], v8 offset:24576
	v_mfma_f32_16x16x32_bf16 v[176:179], a[108:111], v[52:55], v[176:179]
	v_exp_f32 v39, v39
	v_mfma_f32_16x16x32_bf16 v[176:179], a[76:79], v[48:51], v[176:179]
	ds_read_b64_tr_b16 a[126:127], v8 offset:28672
	v_cvt_pk_bf16_f32 v59, v38, v39
	v_mfma_f32_16x16x32_bf16 v[32:35], a[0:3], a[224:227], -4.0
	v_exp_f32 v40, v40
	v_mfma_f32_16x16x32_bf16 v[32:35], a[4:7], a[228:231], v[32:35]
	ds_read_b64_tr_b16 a[92:93], v8 offset:16384
	ds_read_b64_tr_b16 a[94:95], v8 offset:20480
	v_mfma_f32_16x16x32_bf16 v[32:35], a[8:11], a[232:235], v[32:35]
	v_exp_f32 v41, v41
	v_mfma_f32_16x16x32_bf16 v[32:35], a[12:15], a[236:239], v[32:35]
	v_cvt_pk_bf16_f32 v60, v40, v41
	v_mfma_f32_16x16x32_bf16 v[36:39], a[28:31], a[236:239], -4.0
	v_exp_f32 v42, v42
	v_mfma_f32_16x16x32_bf16 v[36:39], a[24:27], a[232:235], v[36:39]
	v_mfma_f32_16x16x32_bf16 v[36:39], a[20:23], a[228:231], v[36:39]
	v_exp_f32 v43, v43
	v_mfma_f32_16x16x32_bf16 v[36:39], a[16:19], a[224:227], v[36:39]
	s_waitcnt lgkmcnt(3)
	v_cvt_pk_bf16_f32 v61, v42, v43
	v_mfma_f32_16x16x32_bf16 v[192:195], a[80:83], v[48:51], v[192:195]
	v_exp_f32 v44, v44
	v_mfma_f32_16x16x32_bf16 v[192:195], a[112:115], v[52:55], v[192:195]
	v_mfma_f32_16x16x32_bf16 v[208:211], a[116:119], v[52:55], v[208:211]
	v_exp_f32 v45, v45
	v_mfma_f32_16x16x32_bf16 v[208:211], a[84:87], v[48:51], v[208:211]
	v_cvt_pk_bf16_f32 v62, v44, v45
	v_mfma_f32_16x16x32_bf16 v[224:227], a[88:91], v[48:51], v[224:227]
	v_exp_f32 v46, v46
	v_mfma_f32_16x16x32_bf16 v[224:227], a[120:123], v[52:55], v[224:227]
	s_waitcnt lgkmcnt(0)
	v_mfma_f32_16x16x32_bf16 v[240:243], a[124:127], v[52:55], v[240:243]
	s_waitcnt vmcnt(0)
	v_exp_f32 v47, v47
	v_mfma_f32_16x16x32_bf16 v[240:243], a[92:95], v[48:51], v[240:243]
	s_barrier
	v_cvt_pk_bf16_f32 v63, v46, v47
	v_mfma_f32_16x16x32_bf16 v[40:43], a[32:35], a[224:227], -4.0
	s_add_u32 m0, s65, 0x4000
	v_exp_f32 v32, v32
	v_mfma_f32_16x16x32_bf16 v[40:43], a[36:39], a[228:231], v[40:43]
	buffer_load_dwordx4 v18, s[8:11], s68 offen lds
	v_mfma_f32_16x16x32_bf16 v[40:43], a[40:43], a[232:235], v[40:43]
	v_exp_f32 v33, v33
	v_mfma_f32_16x16x32_bf16 v[40:43], a[44:47], a[236:239], v[40:43]
	v_cvt_pk_bf16_f32 v48, v32, v33
	v_mfma_f32_16x16x32_bf16 v[44:47], a[60:63], a[236:239], -4.0
	v_exp_f32 v34, v34
	v_mfma_f32_16x16x32_bf16 v[44:47], a[56:59], a[232:235], v[44:47]
	buffer_load_dwordx4 v19, s[8:11], s68 offen offset:1024 lds
	v_mfma_f32_16x16x32_bf16 v[44:47], a[52:55], a[228:231], v[44:47]
	s_add_u32 s68, s68, 0x2000
	v_exp_f32 v35, v35
	v_mfma_f32_16x16x32_bf16 v[44:47], a[48:51], a[224:227], v[44:47]
	s_and_b32 s68, s68, 0x7ffff
	v_cvt_pk_bf16_f32 v49, v34, v35
	v_smfmac_f32_16x16x64_bf16 a[132:135], a[168:171], v[56:63], v31
	v_mfma_f32_16x16x32_bf16 v[132:135], a[64:67], v[56:59], v[132:135]
	s_add_u32 m0, s65, 0x6000
	v_exp_f32 v36, v36
	v_mfma_f32_16x16x32_bf16 v[132:135], a[96:99], v[60:63], v[132:135]
	buffer_load_dwordx4 v18, s[8:11], s68 offen lds
	v_mfma_f32_16x16x32_bf16 v[148:151], a[100:103], v[60:63], v[148:151]
	v_exp_f32 v37, v37
	v_mfma_f32_16x16x32_bf16 v[148:151], a[68:71], v[56:59], v[148:151]
	v_cvt_pk_bf16_f32 v50, v36, v37
	v_mfma_f32_16x16x32_bf16 v[164:167], a[72:75], v[56:59], v[164:167]
	v_exp_f32 v38, v38
	v_mfma_f32_16x16x32_bf16 v[164:167], a[104:107], v[60:63], v[164:167]
	buffer_load_dwordx4 v19, s[8:11], s68 offen offset:1024 lds
	v_mfma_f32_16x16x32_bf16 v[180:183], a[108:111], v[60:63], v[180:183]
	s_add_u32 s68, s68, 0x2000
	v_exp_f32 v39, v39
	v_mfma_f32_16x16x32_bf16 v[180:183], a[76:79], v[56:59], v[180:183]
	s_and_b32 s68, s68, 0x7ffff
	v_cvt_pk_bf16_f32 v51, v38, v39
	v_mfma_f32_16x16x32_bf16 v[32:35], a[0:3], a[240:243], -4.0
	s_add_u32 m0, s65, 0xc000
	v_exp_f32 v40, v40
	v_mfma_f32_16x16x32_bf16 v[32:35], a[4:7], a[244:247], v[32:35]
	buffer_load_dwordx4 v20, s[12:15], s69 offen lds
	v_mfma_f32_16x16x32_bf16 v[32:35], a[8:11], a[248:251], v[32:35]
	v_exp_f32 v41, v41
	v_mfma_f32_16x16x32_bf16 v[32:35], a[12:15], a[252:255], v[32:35]
	ds_read_b128 a[0:3], v9 offset:0
	v_cvt_pk_bf16_f32 v52, v40, v41
	v_mfma_f32_16x16x32_bf16 v[36:39], a[28:31], a[252:255], -4.0
	v_exp_f32 v42, v42
	v_mfma_f32_16x16x32_bf16 v[36:39], a[24:27], a[248:251], v[36:39]
	buffer_load_dwordx4 v21, s[12:15], s69 offen offset:1024 lds
	v_mfma_f32_16x16x32_bf16 v[36:39], a[20:23], a[244:247], v[36:39]
	v_exp_f32 v43, v43
	v_mfma_f32_16x16x32_bf16 v[36:39], a[16:19], a[240:243], v[36:39]
	ds_read_b128 a[4:7], v10 offset:0
	v_cvt_pk_bf16_f32 v53, v42, v43
	v_mfma_f32_16x16x32_bf16 v[196:199], a[80:83], v[56:59], v[196:199]
	v_exp_f32 v44, v44
	v_mfma_f32_16x16x32_bf16 v[196:199], a[112:115], v[60:63], v[196:199]
	ds_read_b128 a[8:11], v11 offset:0
	ds_read_b128 a[12:15], v12 offset:0
	v_mfma_f32_16x16x32_bf16 v[212:215], a[116:119], v[60:63], v[212:215]
	s_add_u32 s69, s69, 0x2000
	v_exp_f32 v45, v45
	v_mfma_f32_16x16x32_bf16 v[212:215], a[84:87], v[56:59], v[212:215]
	s_and_b32 s69, s69, 0x7ffff
	ds_read_b128 a[28:31], v12 offset:4096
	v_cvt_pk_bf16_f32 v54, v44, v45
	v_mfma_f32_16x16x32_bf16 v[228:231], a[88:91], v[56:59], v[228:231]
	s_add_u32 m0, s65, 0xe000
	v_exp_f32 v46, v46
	v_mfma_f32_16x16x32_bf16 v[228:231], a[120:123], v[60:63], v[228:231]
	buffer_load_dwordx4 v20, s[12:15], s69 offen lds
	v_mfma_f32_16x16x32_bf16 v[244:247], a[124:127], v[60:63], v[244:247]
	v_exp_f32 v47, v47
	v_mfma_f32_16x16x32_bf16 v[244:247], a[92:95], v[56:59], v[244:247]
	ds_read_b128 a[24:27], v11 offset:4096
	v_cvt_pk_bf16_f32 v55, v46, v47
	v_mfma_f32_16x16x32_bf16 v[40:43], a[32:35], a[240:243], -4.0
	s_add_u32 m0, s65, 0xe000
	v_exp_f32 v32, v32
	v_mfma_f32_16x16x32_bf16 v[40:43], a[36:39], a[244:247], v[40:43]
	buffer_load_dwordx4 v21, s[12:15], s69 offen offset:1024 lds
	v_mfma_f32_16x16x32_bf16 v[40:43], a[40:43], a[248:251], v[40:43]
	s_add_u32 s69, s69, 0x2000
	v_exp_f32 v33, v33
	v_mfma_f32_16x16x32_bf16 v[40:43], a[44:47], a[252:255], v[40:43]
	s_and_b32 s69, s69, 0x7ffff
	ds_read_b128 a[20:23], v10 offset:4096
	v_cvt_pk_bf16_f32 v56, v32, v33
	v_mfma_f32_16x16x32_bf16 v[44:47], a[60:63], a[252:255], -4.0
	v_exp_f32 v34, v34
	v_mfma_f32_16x16x32_bf16 v[44:47], a[56:59], a[248:251], v[44:47]
	ds_read_b128 a[16:19], v9 offset:4096
	ds_read_b128 a[32:35], v9 offset:8192
	v_mfma_f32_16x16x32_bf16 v[44:47], a[52:55], a[244:247], v[44:47]
	v_exp_f32 v35, v35
	v_mfma_f32_16x16x32_bf16 v[44:47], a[48:51], a[240:243], v[44:47]
	ds_read_b128 a[36:39], v10 offset:8192
	v_cvt_pk_bf16_f32 v57, v34, v35
	v_smfmac_f32_16x16x64_bf16 a[136:139], a[128:131], v[48:55], v31
	v_mfma_f32_16x16x32_bf16 v[136:139], a[64:67], v[48:51], v[136:139]
	v_exp_f32 v36, v36
	v_mfma_f32_16x16x32_bf16 v[136:139], a[96:99], v[52:55], v[136:139]
	ds_read_b128 a[40:43], v11 offset:8192
	ds_read_b128 a[44:47], v12 offset:8192
	v_mfma_f32_16x16x32_bf16 v[152:155], a[100:103], v[52:55], v[152:155]
	v_exp_f32 v37, v37
	v_mfma_f32_16x16x32_bf16 v[152:155], a[68:71], v[48:51], v[152:155]
	ds_read_b128 a[60:63], v12 offset:12288
	v_cvt_pk_bf16_f32 v58, v36, v37
	v_mfma_f32_16x16x32_bf16 v[168:171], a[72:75], v[48:51], v[168:171]
	v_exp_f32 v38, v38
	v_mfma_f32_16x16x32_bf16 v[168:171], a[104:107], v[52:55], v[168:171]
	ds_read_b128 a[56:59], v11 offset:12288
	ds_read_b128 a[52:55], v10 offset:12288
	v_mfma_f32_16x16x32_bf16 v[184:187], a[108:111], v[52:55], v[184:187]
	v_exp_f32 v39, v39
	v_mfma_f32_16x16x32_bf16 v[184:187], a[76:79], v[48:51], v[184:187]
	s_waitcnt lgkmcnt(6)
	ds_read_b128 a[48:51], v9 offset:12288
	v_cvt_pk_bf16_f32 v59, v38, v39
	v_mfma_f32_16x16x32_bf16 v[32:35], a[0:3], a[192:195], -4.0
	v_exp_f32 v40, v40
	v_mfma_f32_16x16x32_bf16 v[32:35], a[4:7], a[196:199], v[32:35]
	v_mfma_f32_16x16x32_bf16 v[32:35], a[8:11], a[200:203], v[32:35]
	v_exp_f32 v41, v41
	v_mfma_f32_16x16x32_bf16 v[32:35], a[12:15], a[204:207], v[32:35]
	v_cvt_pk_bf16_f32 v60, v40, v41
	v_mfma_f32_16x16x32_bf16 v[36:39], a[28:31], a[204:207], -4.0
	v_exp_f32 v42, v42
	v_mfma_f32_16x16x32_bf16 v[36:39], a[24:27], a[200:203], v[36:39]
	v_mfma_f32_16x16x32_bf16 v[36:39], a[20:23], a[196:199], v[36:39]
	v_exp_f32 v43, v43
	v_mfma_f32_16x16x32_bf16 v[36:39], a[16:19], a[192:195], v[36:39]
	v_cvt_pk_bf16_f32 v61, v42, v43
	v_mfma_f32_16x16x32_bf16 v[200:203], a[80:83], v[48:51], v[200:203]
	v_exp_f32 v44, v44
	v_mfma_f32_16x16x32_bf16 v[200:203], a[112:115], v[52:55], v[200:203]
	v_mfma_f32_16x16x32_bf16 v[216:219], a[116:119], v[52:55], v[216:219]
	v_exp_f32 v45, v45
	v_mfma_f32_16x16x32_bf16 v[216:219], a[84:87], v[48:51], v[216:219]
	v_cvt_pk_bf16_f32 v62, v44, v45
	v_mfma_f32_16x16x32_bf16 v[232:235], a[88:91], v[48:51], v[232:235]
	v_exp_f32 v46, v46
	v_mfma_f32_16x16x32_bf16 v[232:235], a[120:123], v[52:55], v[232:235]
	v_mfma_f32_16x16x32_bf16 v[248:251], a[124:127], v[52:55], v[248:251]
	v_exp_f32 v47, v47
	v_mfma_f32_16x16x32_bf16 v[248:251], a[92:95], v[48:51], v[248:251]
	v_cvt_pk_bf16_f32 v63, v46, v47
	v_mfma_f32_16x16x32_bf16 v[40:43], a[32:35], a[192:195], -4.0
	s_waitcnt lgkmcnt(0)
	v_exp_f32 v32, v32
	v_mfma_f32_16x16x32_bf16 v[40:43], a[36:39], a[196:199], v[40:43]
	v_mfma_f32_16x16x32_bf16 v[40:43], a[40:43], a[200:203], v[40:43]
	v_exp_f32 v33, v33
	v_mfma_f32_16x16x32_bf16 v[40:43], a[44:47], a[204:207], v[40:43]
	v_cvt_pk_bf16_f32 v48, v32, v33
	v_mfma_f32_16x16x32_bf16 v[44:47], a[60:63], a[204:207], -4.0
	v_exp_f32 v34, v34
	v_mfma_f32_16x16x32_bf16 v[44:47], a[56:59], a[200:203], v[44:47]
	v_mfma_f32_16x16x32_bf16 v[44:47], a[52:55], a[196:199], v[44:47]
	v_exp_f32 v35, v35
	v_mfma_f32_16x16x32_bf16 v[44:47], a[48:51], a[192:195], v[44:47]
	v_cvt_pk_bf16_f32 v49, v34, v35
	v_smfmac_f32_16x16x64_bf16 a[136:139], a[168:171], v[56:63], v31
	v_mfma_f32_16x16x32_bf16 v[140:143], a[64:67], v[56:59], v[140:143]
	v_exp_f32 v36, v36
	v_mfma_f32_16x16x32_bf16 v[140:143], a[96:99], v[60:63], v[140:143]
	ds_read_b64_tr_b16 a[64:65], v1 offset:0
	ds_read_b64_tr_b16 a[66:67], v1 offset:4096
	v_mfma_f32_16x16x32_bf16 v[156:159], a[100:103], v[60:63], v[156:159]
	v_exp_f32 v37, v37
	v_mfma_f32_16x16x32_bf16 v[156:159], a[68:71], v[56:59], v[156:159]
	ds_read_b64_tr_b16 a[96:97], v1 offset:8192
	v_cvt_pk_bf16_f32 v50, v36, v37
	v_mfma_f32_16x16x32_bf16 v[172:175], a[72:75], v[56:59], v[172:175]
	v_exp_f32 v38, v38
	v_mfma_f32_16x16x32_bf16 v[172:175], a[104:107], v[60:63], v[172:175]
	ds_read_b64_tr_b16 a[98:99], v1 offset:12288
	ds_read_b64_tr_b16 a[100:101], v2 offset:8192
	v_mfma_f32_16x16x32_bf16 v[188:191], a[108:111], v[60:63], v[188:191]
	v_exp_f32 v39, v39
	v_mfma_f32_16x16x32_bf16 v[188:191], a[76:79], v[56:59], v[188:191]
	ds_read_b64_tr_b16 a[102:103], v2 offset:12288
	v_cvt_pk_bf16_f32 v51, v38, v39
	v_mfma_f32_16x16x32_bf16 v[32:35], a[0:3], a[208:211], -4.0
	v_exp_f32 v40, v40
	v_mfma_f32_16x16x32_bf16 v[32:35], a[4:7], a[212:215], v[32:35]
	ds_read_b64_tr_b16 a[68:69], v2 offset:0
	ds_read_b64_tr_b16 a[70:71], v2 offset:4096
	v_mfma_f32_16x16x32_bf16 v[32:35], a[8:11], a[216:219], v[32:35]
	v_exp_f32 v41, v41
	v_mfma_f32_16x16x32_bf16 v[32:35], a[12:15], a[220:223], v[32:35]
	ds_read_b64_tr_b16 a[72:73], v3 offset:0
	v_cvt_pk_bf16_f32 v52, v40, v41
	v_mfma_f32_16x16x32_bf16 v[36:39], a[28:31], a[220:223], -4.0
	v_exp_f32 v42, v42
	v_mfma_f32_16x16x32_bf16 v[36:39], a[24:27], a[216:219], v[36:39]
	ds_read_b64_tr_b16 a[74:75], v3 offset:4096
	ds_read_b64_tr_b16 a[104:105], v3 offset:8192
	v_mfma_f32_16x16x32_bf16 v[36:39], a[20:23], a[212:215], v[36:39]
	v_exp_f32 v43, v43
	v_mfma_f32_16x16x32_bf16 v[36:39], a[16:19], a[208:211], v[36:39]
	ds_read_b64_tr_b16 a[106:107], v3 offset:12288
	v_cvt_pk_bf16_f32 v53, v42, v43
	v_mfma_f32_16x16x32_bf16 v[204:207], a[80:83], v[56:59], v[204:207]
	v_exp_f32 v44, v44
	v_mfma_f32_16x16x32_bf16 v[204:207], a[112:115], v[60:63], v[204:207]
	ds_read_b64_tr_b16 a[108:109], v4 offset:8192
	ds_read_b64_tr_b16 a[110:111], v4 offset:12288
	v_mfma_f32_16x16x32_bf16 v[220:223], a[116:119], v[60:63], v[220:223]
	v_exp_f32 v45, v45
	v_mfma_f32_16x16x32_bf16 v[220:223], a[84:87], v[56:59], v[220:223]
	ds_read_b64_tr_b16 a[76:77], v4 offset:0
	v_cvt_pk_bf16_f32 v54, v44, v45
	v_mfma_f32_16x16x32_bf16 v[236:239], a[88:91], v[56:59], v[236:239]
	v_exp_f32 v46, v46
	v_mfma_f32_16x16x32_bf16 v[236:239], a[120:123], v[60:63], v[236:239]
	ds_read_b64_tr_b16 a[78:79], v4 offset:4096
	ds_read_b64_tr_b16 a[80:81], v5 offset:0
	v_mfma_f32_16x16x32_bf16 v[252:255], a[124:127], v[60:63], v[252:255]
	v_exp_f32 v47, v47
	v_mfma_f32_16x16x32_bf16 v[252:255], a[92:95], v[56:59], v[252:255]
	ds_read_b64_tr_b16 a[82:83], v5 offset:4096
	v_cvt_pk_bf16_f32 v55, v46, v47
	v_mfma_f32_16x16x32_bf16 v[40:43], a[32:35], a[208:211], -4.0
	v_exp_f32 v32, v32
	v_mfma_f32_16x16x32_bf16 v[40:43], a[36:39], a[212:215], v[40:43]
	ds_read_b64_tr_b16 a[112:113], v5 offset:8192
	ds_read_b64_tr_b16 a[114:115], v5 offset:12288
	v_mfma_f32_16x16x32_bf16 v[40:43], a[40:43], a[216:219], v[40:43]
	v_exp_f32 v33, v33
	v_mfma_f32_16x16x32_bf16 v[40:43], a[44:47], a[220:223], v[40:43]
	ds_read_b64_tr_b16 a[116:117], v6 offset:8192
	v_cvt_pk_bf16_f32 v56, v32, v33
	v_mfma_f32_16x16x32_bf16 v[44:47], a[60:63], a[220:223], -4.0
	v_exp_f32 v34, v34
	v_mfma_f32_16x16x32_bf16 v[44:47], a[56:59], a[216:219], v[44:47]
	ds_read_b64_tr_b16 a[118:119], v6 offset:12288
	ds_read_b64_tr_b16 a[84:85], v6 offset:0
	v_mfma_f32_16x16x32_bf16 v[44:47], a[52:55], a[212:215], v[44:47]
	v_exp_f32 v35, v35
	v_mfma_f32_16x16x32_bf16 v[44:47], a[48:51], a[208:211], v[44:47]
	ds_read_b64_tr_b16 a[86:87], v6 offset:4096
	v_cvt_pk_bf16_f32 v57, v34, v35
	v_smfmac_f32_16x16x64_bf16 a[132:135], a[128:131], v[48:55], v31
	s_waitcnt lgkmcnt(7)
	v_mfma_f32_16x16x32_bf16 v[128:131], a[64:67], v[48:51], v[128:131]
	v_exp_f32 v36, v36
	v_mfma_f32_16x16x32_bf16 v[128:131], a[96:99], v[52:55], v[128:131]
	ds_read_b64_tr_b16 a[88:89], v7 offset:0
	ds_read_b64_tr_b16 a[90:91], v7 offset:4096
	v_mfma_f32_16x16x32_bf16 v[144:147], a[100:103], v[52:55], v[144:147]
	v_exp_f32 v37, v37
	v_mfma_f32_16x16x32_bf16 v[144:147], a[68:71], v[48:51], v[144:147]
	ds_read_b64_tr_b16 a[120:121], v7 offset:8192
	v_cvt_pk_bf16_f32 v58, v36, v37
	v_mfma_f32_16x16x32_bf16 v[160:163], a[72:75], v[48:51], v[160:163]
	v_exp_f32 v38, v38
	v_mfma_f32_16x16x32_bf16 v[160:163], a[104:107], v[52:55], v[160:163]
	ds_read_b64_tr_b16 a[122:123], v7 offset:12288
	ds_read_b64_tr_b16 a[124:125], v8 offset:8192
	v_mfma_f32_16x16x32_bf16 v[176:179], a[108:111], v[52:55], v[176:179]
	v_exp_f32 v39, v39
	v_mfma_f32_16x16x32_bf16 v[176:179], a[76:79], v[48:51], v[176:179]
	ds_read_b64_tr_b16 a[126:127], v8 offset:12288
	v_cvt_pk_bf16_f32 v59, v38, v39
	v_mfma_f32_16x16x32_bf16 v[32:35], a[0:3], a[224:227], -4.0
	v_exp_f32 v40, v40
	v_mfma_f32_16x16x32_bf16 v[32:35], a[4:7], a[228:231], v[32:35]
	ds_read_b64_tr_b16 a[92:93], v8 offset:0
	ds_read_b64_tr_b16 a[94:95], v8 offset:4096
	v_mfma_f32_16x16x32_bf16 v[32:35], a[8:11], a[232:235], v[32:35]
	v_exp_f32 v41, v41
	v_mfma_f32_16x16x32_bf16 v[32:35], a[12:15], a[236:239], v[32:35]
	v_cvt_pk_bf16_f32 v60, v40, v41
	v_mfma_f32_16x16x32_bf16 v[36:39], a[28:31], a[236:239], -4.0
	v_exp_f32 v42, v42
	v_mfma_f32_16x16x32_bf16 v[36:39], a[24:27], a[232:235], v[36:39]
	v_mfma_f32_16x16x32_bf16 v[36:39], a[20:23], a[228:231], v[36:39]
	v_exp_f32 v43, v43
	v_mfma_f32_16x16x32_bf16 v[36:39], a[16:19], a[224:227], v[36:39]
	s_waitcnt lgkmcnt(3)
	v_cvt_pk_bf16_f32 v61, v42, v43
	v_mfma_f32_16x16x32_bf16 v[192:195], a[80:83], v[48:51], v[192:195]
	v_exp_f32 v44, v44
	v_mfma_f32_16x16x32_bf16 v[192:195], a[112:115], v[52:55], v[192:195]
	v_mfma_f32_16x16x32_bf16 v[208:211], a[116:119], v[52:55], v[208:211]
	v_exp_f32 v45, v45
	v_mfma_f32_16x16x32_bf16 v[208:211], a[84:87], v[48:51], v[208:211]
	v_cvt_pk_bf16_f32 v62, v44, v45
	v_mfma_f32_16x16x32_bf16 v[224:227], a[88:91], v[48:51], v[224:227]
	v_exp_f32 v46, v46
	v_mfma_f32_16x16x32_bf16 v[224:227], a[120:123], v[52:55], v[224:227]
	s_waitcnt lgkmcnt(0)
	v_mfma_f32_16x16x32_bf16 v[240:243], a[124:127], v[52:55], v[240:243]
	s_waitcnt vmcnt(0)
	v_exp_f32 v47, v47
	v_mfma_f32_16x16x32_bf16 v[240:243], a[92:95], v[48:51], v[240:243]
	s_barrier
	v_cvt_pk_bf16_f32 v63, v46, v47
	v_mfma_f32_16x16x32_bf16 v[40:43], a[32:35], a[224:227], -4.0
	s_add_u32 m0, s65, 0x0
	v_exp_f32 v32, v32
	v_mfma_f32_16x16x32_bf16 v[40:43], a[36:39], a[228:231], v[40:43]
	buffer_load_dwordx4 v18, s[8:11], s68 offen lds
	v_mfma_f32_16x16x32_bf16 v[40:43], a[40:43], a[232:235], v[40:43]
	v_exp_f32 v33, v33
	v_mfma_f32_16x16x32_bf16 v[40:43], a[44:47], a[236:239], v[40:43]
	v_cvt_pk_bf16_f32 v48, v32, v33
	v_mfma_f32_16x16x32_bf16 v[44:47], a[60:63], a[236:239], -4.0
	v_exp_f32 v34, v34
	v_mfma_f32_16x16x32_bf16 v[44:47], a[56:59], a[232:235], v[44:47]
	buffer_load_dwordx4 v19, s[8:11], s68 offen offset:1024 lds
	v_mfma_f32_16x16x32_bf16 v[44:47], a[52:55], a[228:231], v[44:47]
	s_add_u32 s68, s68, 0x2000
	v_exp_f32 v35, v35
	v_mfma_f32_16x16x32_bf16 v[44:47], a[48:51], a[224:227], v[44:47]
	s_and_b32 s68, s68, 0x7ffff
	v_cvt_pk_bf16_f32 v49, v34, v35
	v_smfmac_f32_16x16x64_bf16 a[132:135], a[168:171], v[56:63], v31
	v_mfma_f32_16x16x32_bf16 v[132:135], a[64:67], v[56:59], v[132:135]
	s_add_u32 m0, s65, 0x2000
	v_exp_f32 v36, v36
	v_mfma_f32_16x16x32_bf16 v[132:135], a[96:99], v[60:63], v[132:135]
	buffer_load_dwordx4 v18, s[8:11], s68 offen lds
	v_mfma_f32_16x16x32_bf16 v[148:151], a[100:103], v[60:63], v[148:151]
	v_exp_f32 v37, v37
	v_mfma_f32_16x16x32_bf16 v[148:151], a[68:71], v[56:59], v[148:151]
	v_cvt_pk_bf16_f32 v50, v36, v37
	v_mfma_f32_16x16x32_bf16 v[164:167], a[72:75], v[56:59], v[164:167]
	v_exp_f32 v38, v38
	v_mfma_f32_16x16x32_bf16 v[164:167], a[104:107], v[60:63], v[164:167]
	buffer_load_dwordx4 v19, s[8:11], s68 offen offset:1024 lds
	v_mfma_f32_16x16x32_bf16 v[180:183], a[108:111], v[60:63], v[180:183]
	s_add_u32 s68, s68, 0x2000
	v_exp_f32 v39, v39
	v_mfma_f32_16x16x32_bf16 v[180:183], a[76:79], v[56:59], v[180:183]
	s_and_b32 s68, s68, 0x7ffff
	v_cvt_pk_bf16_f32 v51, v38, v39
	v_mfma_f32_16x16x32_bf16 v[32:35], a[0:3], a[240:243], -4.0
	s_add_u32 m0, s65, 0x8000
	v_exp_f32 v40, v40
	v_mfma_f32_16x16x32_bf16 v[32:35], a[4:7], a[244:247], v[32:35]
	buffer_load_dwordx4 v20, s[12:15], s69 offen lds
	v_mfma_f32_16x16x32_bf16 v[32:35], a[8:11], a[248:251], v[32:35]
	v_exp_f32 v41, v41
	v_mfma_f32_16x16x32_bf16 v[32:35], a[12:15], a[252:255], v[32:35]
	ds_read_b128 a[0:3], v9 offset:16384
	v_cvt_pk_bf16_f32 v52, v40, v41
	v_mfma_f32_16x16x32_bf16 v[36:39], a[28:31], a[252:255], -4.0
	v_exp_f32 v42, v42
	v_mfma_f32_16x16x32_bf16 v[36:39], a[24:27], a[248:251], v[36:39]
L_pg10:
	s_cbranch_execz L_pg14
	buffer_load_dwordx4 v21, s[12:15], s69 offen offset:1024 lds
	v_mfma_f32_16x16x32_bf16 v[36:39], a[20:23], a[244:247], v[36:39]
	v_exp_f32 v43, v43
	v_mfma_f32_16x16x32_bf16 v[36:39], a[16:19], a[240:243], v[36:39]
	ds_read_b128 a[4:7], v10 offset:16384
	v_cvt_pk_bf16_f32 v53, v42, v43
	v_mfma_f32_16x16x32_bf16 v[196:199], a[80:83], v[56:59], v[196:199]
	v_exp_f32 v44, v44
	v_mfma_f32_16x16x32_bf16 v[196:199], a[112:115], v[60:63], v[196:199]
	ds_read_b128 a[8:11], v11 offset:16384
	ds_read_b128 a[12:15], v12 offset:16384
	v_mfma_f32_16x16x32_bf16 v[212:215], a[116:119], v[60:63], v[212:215]
	s_add_u32 s69, s69, 0x2000
	v_exp_f32 v45, v45
	v_mfma_f32_16x16x32_bf16 v[212:215], a[84:87], v[56:59], v[212:215]
	s_and_b32 s69, s69, 0x7ffff
	ds_read_b128 a[28:31], v12 offset:20480
	v_cvt_pk_bf16_f32 v54, v44, v45
	v_mfma_f32_16x16x32_bf16 v[228:231], a[88:91], v[56:59], v[228:231]
	s_add_u32 m0, s65, 0xa000
	v_exp_f32 v46, v46
	v_mfma_f32_16x16x32_bf16 v[228:231], a[120:123], v[60:63], v[228:231]
	buffer_load_dwordx4 v20, s[12:15], s69 offen lds
	v_mfma_f32_16x16x32_bf16 v[244:247], a[124:127], v[60:63], v[244:247]
	v_exp_f32 v47, v47
	v_mfma_f32_16x16x32_bf16 v[244:247], a[92:95], v[56:59], v[244:247]
	ds_read_b128 a[24:27], v11 offset:20480
	v_cvt_pk_bf16_f32 v55, v46, v47
	v_mfma_f32_16x16x32_bf16 v[40:43], a[32:35], a[240:243], -4.0
	s_add_u32 m0, s65, 0xa000
	v_exp_f32 v32, v32
	v_mfma_f32_16x16x32_bf16 v[40:43], a[36:39], a[244:247], v[40:43]
	buffer_load_dwordx4 v21, s[12:15], s69 offen offset:1024 lds
	v_mfma_f32_16x16x32_bf16 v[40:43], a[40:43], a[248:251], v[40:43]
	s_add_u32 s69, s69, 0x2000
	v_exp_f32 v33, v33
	v_mfma_f32_16x16x32_bf16 v[40:43], a[44:47], a[252:255], v[40:43]
	s_and_b32 s69, s69, 0x7ffff
	ds_read_b128 a[20:23], v10 offset:20480
	v_cvt_pk_bf16_f32 v56, v32, v33
	v_mfma_f32_16x16x32_bf16 v[44:47], a[60:63], a[252:255], -4.0
	v_exp_f32 v34, v34
	v_mfma_f32_16x16x32_bf16 v[44:47], a[56:59], a[248:251], v[44:47]
	ds_read_b128 a[16:19], v9 offset:20480
	ds_read_b128 a[32:35], v9 offset:24576
	v_mfma_f32_16x16x32_bf16 v[44:47], a[52:55], a[244:247], v[44:47]
	v_exp_f32 v35, v35
	v_mfma_f32_16x16x32_bf16 v[44:47], a[48:51], a[240:243], v[44:47]
	ds_read_b128 a[36:39], v10 offset:24576
	v_cvt_pk_bf16_f32 v57, v34, v35
	v_smfmac_f32_16x16x64_bf16 a[136:139], a[128:131], v[48:55], v31
	v_mfma_f32_16x16x32_bf16 v[136:139], a[64:67], v[48:51], v[136:139]
	v_exp_f32 v36, v36
	v_mfma_f32_16x16x32_bf16 v[136:139], a[96:99], v[52:55], v[136:139]
	ds_read_b128 a[40:43], v11 offset:24576
	ds_read_b128 a[44:47], v12 offset:24576
	v_mfma_f32_16x16x32_bf16 v[152:155], a[100:103], v[52:55], v[152:155]
	s_sub_u32 s70, s70, 1
	v_exp_f32 v37, v37
	v_mfma_f32_16x16x32_bf16 v[152:155], a[68:71], v[48:51], v[152:155]
	ds_read_b128 a[60:63], v12 offset:28672
	v_cvt_pk_bf16_f32 v58, v36, v37
	v_mfma_f32_16x16x32_bf16 v[168:171], a[72:75], v[48:51], v[168:171]
	s_cmp_lg_u32 s70, 0
	v_exp_f32 v38, v38
	v_mfma_f32_16x16x32_bf16 v[168:171], a[104:107], v[52:55], v[168:171]
	ds_read_b128 a[56:59], v11 offset:28672
	ds_read_b128 a[52:55], v10 offset:28672
	v_mfma_f32_16x16x32_bf16 v[184:187], a[108:111], v[52:55], v[184:187]
	v_exp_f32 v39, v39
	v_mfma_f32_16x16x32_bf16 v[184:187], a[76:79], v[48:51], v[184:187]
	ds_read_b128 a[48:51], v9 offset:28672
	v_cvt_pk_bf16_f32 v59, v38, v39
	s_cbranch_scc1 L_attn0
	s_waitcnt lgkmcnt(7)
	v_mfma_f32_16x16x32_bf16 v[32:35], a[0:3], a[192:195], -4.0
	v_exp_f32 v40, v40
	v_mfma_f32_16x16x32_bf16 v[32:35], a[4:7], a[196:199], v[32:35]
	buffer_load_dword v25, v24, s[48:51], 0 offen sc1
	v_mfma_f32_16x16x32_bf16 v[32:35], a[8:11], a[200:203], v[32:35]
	v_exp_f32 v41, v41
	v_mfma_f32_16x16x32_bf16 v[32:35], a[12:15], a[204:207], v[32:35]
	v_cvt_pk_bf16_f32 v60, v40, v41
	v_mfma_f32_16x16x32_bf16 v[36:39], a[28:31], a[204:207], -4.0
	v_exp_f32 v42, v42
	v_mfma_f32_16x16x32_bf16 v[36:39], a[24:27], a[200:203], v[36:39]
	v_mfma_f32_16x16x32_bf16 v[36:39], a[20:23], a[196:199], v[36:39]
	v_exp_f32 v43, v43
	v_mfma_f32_16x16x32_bf16 v[36:39], a[16:19], a[192:195], v[36:39]
	v_cvt_pk_bf16_f32 v61, v42, v43
	v_mfma_f32_16x16x32_bf16 v[200:203], a[80:83], v[48:51], v[200:203]
	v_exp_f32 v44, v44
	v_mfma_f32_16x16x32_bf16 v[200:203], a[112:115], v[52:55], v[200:203]
	v_mfma_f32_16x16x32_bf16 v[216:219], a[116:119], v[52:55], v[216:219]
	v_exp_f32 v45, v45
	v_mfma_f32_16x16x32_bf16 v[216:219], a[84:87], v[48:51], v[216:219]
	v_cvt_pk_bf16_f32 v62, v44, v45
	v_mfma_f32_16x16x32_bf16 v[232:235], a[88:91], v[48:51], v[232:235]
	v_exp_f32 v46, v46
	v_mfma_f32_16x16x32_bf16 v[232:235], a[120:123], v[52:55], v[232:235]
	v_mfma_f32_16x16x32_bf16 v[248:251], a[124:127], v[52:55], v[248:251]
	v_exp_f32 v47, v47
	v_mfma_f32_16x16x32_bf16 v[248:251], a[92:95], v[48:51], v[248:251]
	v_cvt_pk_bf16_f32 v63, v46, v47
	v_mfma_f32_16x16x32_bf16 v[40:43], a[32:35], a[192:195], -4.0
	s_waitcnt lgkmcnt(0)
	v_exp_f32 v32, v32
	v_mfma_f32_16x16x32_bf16 v[40:43], a[36:39], a[196:199], v[40:43]
	v_mfma_f32_16x16x32_bf16 v[40:43], a[40:43], a[200:203], v[40:43]
	v_exp_f32 v33, v33
	v_mfma_f32_16x16x32_bf16 v[40:43], a[44:47], a[204:207], v[40:43]
	v_cvt_pk_bf16_f32 v48, v32, v33
	v_mfma_f32_16x16x32_bf16 v[44:47], a[60:63], a[204:207], -4.0
	v_exp_f32 v34, v34
	v_mfma_f32_16x16x32_bf16 v[44:47], a[56:59], a[200:203], v[44:47]
	v_mfma_f32_16x16x32_bf16 v[44:47], a[52:55], a[196:199], v[44:47]
	v_exp_f32 v35, v35
	v_mfma_f32_16x16x32_bf16 v[44:47], a[48:51], a[192:195], v[44:47]
	v_cvt_pk_bf16_f32 v49, v34, v35
	v_smfmac_f32_16x16x64_bf16 a[136:139], a[168:171], v[56:63], v31
	v_mfma_f32_16x16x32_bf16 v[140:143], a[64:67], v[56:59], v[140:143]
	v_exp_f32 v36, v36
	v_mfma_f32_16x16x32_bf16 v[140:143], a[96:99], v[60:63], v[140:143]
	ds_read_b64_tr_b16 a[64:65], v1 offset:16384
	ds_read_b64_tr_b16 a[66:67], v1 offset:20480
	v_mfma_f32_16x16x32_bf16 v[156:159], a[100:103], v[60:63], v[156:159]
	v_exp_f32 v37, v37
	v_mfma_f32_16x16x32_bf16 v[156:159], a[68:71], v[56:59], v[156:159]
	ds_read_b64_tr_b16 a[96:97], v1 offset:24576
	v_cvt_pk_bf16_f32 v50, v36, v37
	v_mfma_f32_16x16x32_bf16 v[172:175], a[72:75], v[56:59], v[172:175]
	v_exp_f32 v38, v38
	v_mfma_f32_16x16x32_bf16 v[172:175], a[104:107], v[60:63], v[172:175]
	ds_read_b64_tr_b16 a[98:99], v1 offset:28672
	ds_read_b64_tr_b16 a[100:101], v2 offset:24576
	v_mfma_f32_16x16x32_bf16 v[188:191], a[108:111], v[60:63], v[188:191]
	v_exp_f32 v39, v39
	v_mfma_f32_16x16x32_bf16 v[188:191], a[76:79], v[56:59], v[188:191]
	ds_read_b64_tr_b16 a[102:103], v2 offset:28672
	v_cvt_pk_bf16_f32 v51, v38, v39
	v_mfma_f32_16x16x32_bf16 v[32:35], a[0:3], a[208:211], -4.0
	v_exp_f32 v40, v40
	v_mfma_f32_16x16x32_bf16 v[32:35], a[4:7], a[212:215], v[32:35]
	ds_read_b64_tr_b16 a[68:69], v2 offset:16384
	ds_read_b64_tr_b16 a[70:71], v2 offset:20480
	v_mfma_f32_16x16x32_bf16 v[32:35], a[8:11], a[216:219], v[32:35]
	v_exp_f32 v41, v41
	v_mfma_f32_16x16x32_bf16 v[32:35], a[12:15], a[220:223], v[32:35]
	ds_read_b64_tr_b16 a[72:73], v3 offset:16384
	v_cvt_pk_bf16_f32 v52, v40, v41
	v_mfma_f32_16x16x32_bf16 v[36:39], a[28:31], a[220:223], -4.0
	v_exp_f32 v42, v42
	v_mfma_f32_16x16x32_bf16 v[36:39], a[24:27], a[216:219], v[36:39]
	ds_read_b64_tr_b16 a[74:75], v3 offset:20480
	ds_read_b64_tr_b16 a[104:105], v3 offset:24576
	v_mfma_f32_16x16x32_bf16 v[36:39], a[20:23], a[212:215], v[36:39]
	v_exp_f32 v43, v43
	v_mfma_f32_16x16x32_bf16 v[36:39], a[16:19], a[208:211], v[36:39]
	ds_read_b64_tr_b16 a[106:107], v3 offset:28672
	v_cvt_pk_bf16_f32 v53, v42, v43
	v_mfma_f32_16x16x32_bf16 v[204:207], a[80:83], v[56:59], v[204:207]
	v_exp_f32 v44, v44
	v_mfma_f32_16x16x32_bf16 v[204:207], a[112:115], v[60:63], v[204:207]
	ds_read_b64_tr_b16 a[108:109], v4 offset:24576
	ds_read_b64_tr_b16 a[110:111], v4 offset:28672
	v_mfma_f32_16x16x32_bf16 v[220:223], a[116:119], v[60:63], v[220:223]
	v_exp_f32 v45, v45
	v_mfma_f32_16x16x32_bf16 v[220:223], a[84:87], v[56:59], v[220:223]
	ds_read_b64_tr_b16 a[76:77], v4 offset:16384
	v_cvt_pk_bf16_f32 v54, v44, v45
	v_mfma_f32_16x16x32_bf16 v[236:239], a[88:91], v[56:59], v[236:239]
	v_exp_f32 v46, v46
	v_mfma_f32_16x16x32_bf16 v[236:239], a[120:123], v[60:63], v[236:239]
	ds_read_b64_tr_b16 a[78:79], v4 offset:20480
	ds_read_b64_tr_b16 a[80:81], v5 offset:16384
	v_mfma_f32_16x16x32_bf16 v[252:255], a[124:127], v[60:63], v[252:255]
	v_exp_f32 v47, v47
	v_mfma_f32_16x16x32_bf16 v[252:255], a[92:95], v[56:59], v[252:255]
	ds_read_b64_tr_b16 a[82:83], v5 offset:20480
	v_cvt_pk_bf16_f32 v55, v46, v47
	v_mfma_f32_16x16x32_bf16 v[40:43], a[32:35], a[208:211], -4.0
	v_exp_f32 v32, v32
	v_mfma_f32_16x16x32_bf16 v[40:43], a[36:39], a[212:215], v[40:43]
	ds_read_b64_tr_b16 a[112:113], v5 offset:24576
	ds_read_b64_tr_b16 a[114:115], v5 offset:28672
	v_mfma_f32_16x16x32_bf16 v[40:43], a[40:43], a[216:219], v[40:43]
	v_exp_f32 v33, v33
	v_mfma_f32_16x16x32_bf16 v[40:43], a[44:47], a[220:223], v[40:43]
	ds_read_b64_tr_b16 a[116:117], v6 offset:24576
	v_cvt_pk_bf16_f32 v56, v32, v33
	v_mfma_f32_16x16x32_bf16 v[44:47], a[60:63], a[220:223], -4.0
	v_exp_f32 v34, v34
	v_mfma_f32_16x16x32_bf16 v[44:47], a[56:59], a[216:219], v[44:47]
	ds_read_b64_tr_b16 a[118:119], v6 offset:28672
	ds_read_b64_tr_b16 a[84:85], v6 offset:16384
	v_mfma_f32_16x16x32_bf16 v[44:47], a[52:55], a[212:215], v[44:47]
	v_exp_f32 v35, v35
	v_mfma_f32_16x16x32_bf16 v[44:47], a[48:51], a[208:211], v[44:47]
	ds_read_b64_tr_b16 a[86:87], v6 offset:20480
	v_cvt_pk_bf16_f32 v57, v34, v35
	v_smfmac_f32_16x16x64_bf16 a[132:135], a[128:131], v[48:55], v31
	s_waitcnt lgkmcnt(7)
	v_mfma_f32_16x16x32_bf16 v[128:131], a[64:67], v[48:51], v[128:131]
	v_exp_f32 v36, v36
	v_mfma_f32_16x16x32_bf16 v[128:131], a[96:99], v[52:55], v[128:131]
	ds_read_b64_tr_b16 a[88:89], v7 offset:16384
	ds_read_b64_tr_b16 a[90:91], v7 offset:20480
	v_mfma_f32_16x16x32_bf16 v[144:147], a[100:103], v[52:55], v[144:147]
	v_exp_f32 v37, v37
	v_mfma_f32_16x16x32_bf16 v[144:147], a[68:71], v[48:51], v[144:147]
	ds_read_b64_tr_b16 a[120:121], v7 offset:24576
	v_cvt_pk_bf16_f32 v58, v36, v37
	v_mfma_f32_16x16x32_bf16 v[160:163], a[72:75], v[48:51], v[160:163]
	v_exp_f32 v38, v38
	v_mfma_f32_16x16x32_bf16 v[160:163], a[104:107], v[52:55], v[160:163]
	ds_read_b64_tr_b16 a[122:123], v7 offset:28672
	ds_read_b64_tr_b16 a[124:125], v8 offset:24576
	v_mfma_f32_16x16x32_bf16 v[176:179], a[108:111], v[52:55], v[176:179]
	v_exp_f32 v39, v39
	v_mfma_f32_16x16x32_bf16 v[176:179], a[76:79], v[48:51], v[176:179]
	ds_read_b64_tr_b16 a[126:127], v8 offset:28672
	v_cvt_pk_bf16_f32 v59, v38, v39
	v_mfma_f32_16x16x32_bf16 v[32:35], a[0:3], a[224:227], -4.0
	v_exp_f32 v40, v40
	v_mfma_f32_16x16x32_bf16 v[32:35], a[4:7], a[228:231], v[32:35]
	ds_read_b64_tr_b16 a[92:93], v8 offset:16384
	ds_read_b64_tr_b16 a[94:95], v8 offset:20480
	v_mfma_f32_16x16x32_bf16 v[32:35], a[8:11], a[232:235], v[32:35]
	v_exp_f32 v41, v41
	v_mfma_f32_16x16x32_bf16 v[32:35], a[12:15], a[236:239], v[32:35]
	v_cvt_pk_bf16_f32 v60, v40, v41
	v_mfma_f32_16x16x32_bf16 v[36:39], a[28:31], a[236:239], -4.0
	v_exp_f32 v42, v42
	v_mfma_f32_16x16x32_bf16 v[36:39], a[24:27], a[232:235], v[36:39]
	v_mfma_f32_16x16x32_bf16 v[36:39], a[20:23], a[228:231], v[36:39]
	v_exp_f32 v43, v43
	v_mfma_f32_16x16x32_bf16 v[36:39], a[16:19], a[224:227], v[36:39]
	s_waitcnt lgkmcnt(3)
	v_cvt_pk_bf16_f32 v61, v42, v43
	v_mfma_f32_16x16x32_bf16 v[192:195], a[80:83], v[48:51], v[192:195]
	v_exp_f32 v44, v44
	v_mfma_f32_16x16x32_bf16 v[192:195], a[112:115], v[52:55], v[192:195]
	v_mfma_f32_16x16x32_bf16 v[208:211], a[116:119], v[52:55], v[208:211]
	v_exp_f32 v45, v45
	v_mfma_f32_16x16x32_bf16 v[208:211], a[84:87], v[48:51], v[208:211]
	v_cvt_pk_bf16_f32 v62, v44, v45
	v_mfma_f32_16x16x32_bf16 v[224:227], a[88:91], v[48:51], v[224:227]
	v_exp_f32 v46, v46
	v_mfma_f32_16x16x32_bf16 v[224:227], a[120:123], v[52:55], v[224:227]
	s_waitcnt vmcnt(0)
	v_cmp_ne_u32 vcc, 1, v25
	s_cbranch_vccnz L_spin3
L_back3:
	v_mov_b32 v24, 132
	v_lshl_add_u32 v24, s61, 3, v24
	s_waitcnt lgkmcnt(0)
	v_mfma_f32_16x16x32_bf16 v[240:243], a[124:127], v[52:55], v[240:243]
	v_exp_f32 v47, v47
	v_mfma_f32_16x16x32_bf16 v[240:243], a[92:95], v[48:51], v[240:243]
	s_barrier
	v_cvt_pk_bf16_f32 v63, v46, v47
	v_mfma_f32_16x16x32_bf16 v[40:43], a[32:35], a[224:227], -4.0
	s_add_u32 m0, s65, 0x4000
	v_exp_f32 v32, v32
	v_mfma_f32_16x16x32_bf16 v[40:43], a[36:39], a[228:231], v[40:43]
	buffer_load_dwordx4 v18, s[8:11], s68 offen lds
	v_mfma_f32_16x16x32_bf16 v[40:43], a[40:43], a[232:235], v[40:43]
	v_exp_f32 v33, v33
	v_mfma_f32_16x16x32_bf16 v[40:43], a[44:47], a[236:239], v[40:43]
	v_cvt_pk_bf16_f32 v48, v32, v33
	v_mfma_f32_16x16x32_bf16 v[44:47], a[60:63], a[236:239], -4.0
	v_exp_f32 v34, v34
	v_mfma_f32_16x16x32_bf16 v[44:47], a[56:59], a[232:235], v[44:47]
	buffer_load_dwordx4 v19, s[8:11], s68 offen offset:1024 lds
	v_mfma_f32_16x16x32_bf16 v[44:47], a[52:55], a[228:231], v[44:47]
	s_add_u32 s68, s68, 0x2000
	v_exp_f32 v35, v35
	v_mfma_f32_16x16x32_bf16 v[44:47], a[48:51], a[224:227], v[44:47]
	s_and_b32 s68, s68, 0x7ffff
	v_cvt_pk_bf16_f32 v49, v34, v35
	v_smfmac_f32_16x16x64_bf16 a[132:135], a[168:171], v[56:63], v31
	v_mfma_f32_16x16x32_bf16 v[132:135], a[64:67], v[56:59], v[132:135]
	s_add_u32 m0, s65, 0x6000
	v_exp_f32 v36, v36
	v_mfma_f32_16x16x32_bf16 v[132:135], a[96:99], v[60:63], v[132:135]
	buffer_load_dwordx4 v18, s[8:11], s68 offen lds
	v_mfma_f32_16x16x32_bf16 v[148:151], a[100:103], v[60:63], v[148:151]
	v_exp_f32 v37, v37
	v_mfma_f32_16x16x32_bf16 v[148:151], a[68:71], v[56:59], v[148:151]
	v_cvt_pk_bf16_f32 v50, v36, v37
	v_mfma_f32_16x16x32_bf16 v[164:167], a[72:75], v[56:59], v[164:167]
	v_exp_f32 v38, v38
	v_mfma_f32_16x16x32_bf16 v[164:167], a[104:107], v[60:63], v[164:167]
	buffer_load_dwordx4 v19, s[8:11], s68 offen offset:1024 lds
	v_mfma_f32_16x16x32_bf16 v[180:183], a[108:111], v[60:63], v[180:183]
	s_add_u32 s68, s68, 0x2000
	v_exp_f32 v39, v39
	v_mfma_f32_16x16x32_bf16 v[180:183], a[76:79], v[56:59], v[180:183]
	s_and_b32 s68, s68, 0x7ffff
	v_cvt_pk_bf16_f32 v51, v38, v39
	v_mfma_f32_16x16x32_bf16 v[32:35], a[0:3], a[240:243], -4.0
	s_add_u32 m0, s65, 0xc000
	v_exp_f32 v40, v40
	v_mfma_f32_16x16x32_bf16 v[32:35], a[4:7], a[244:247], v[32:35]
	buffer_load_dwordx4 v20, s[12:15], s69 offen lds
	v_mfma_f32_16x16x32_bf16 v[32:35], a[8:11], a[248:251], v[32:35]
	v_exp_f32 v41, v41
	v_mfma_f32_16x16x32_bf16 v[32:35], a[12:15], a[252:255], v[32:35]
	ds_read_b128 a[0:3], v9 offset:0
	v_cvt_pk_bf16_f32 v52, v40, v41
	v_mfma_f32_16x16x32_bf16 v[36:39], a[28:31], a[252:255], -4.0
	v_exp_f32 v42, v42
	v_mfma_f32_16x16x32_bf16 v[36:39], a[24:27], a[248:251], v[36:39]
	buffer_load_dwordx4 v21, s[12:15], s69 offen offset:1024 lds
	v_mfma_f32_16x16x32_bf16 v[36:39], a[20:23], a[244:247], v[36:39]
	v_exp_f32 v43, v43
	v_mfma_f32_16x16x32_bf16 v[36:39], a[16:19], a[240:243], v[36:39]
	ds_read_b128 a[4:7], v10 offset:0
	v_cvt_pk_bf16_f32 v53, v42, v43
	v_mfma_f32_16x16x32_bf16 v[196:199], a[80:83], v[56:59], v[196:199]
	v_exp_f32 v44, v44
	v_mfma_f32_16x16x32_bf16 v[196:199], a[112:115], v[60:63], v[196:199]
	ds_read_b128 a[8:11], v11 offset:0
	ds_read_b128 a[12:15], v12 offset:0
	v_mfma_f32_16x16x32_bf16 v[212:215], a[116:119], v[60:63], v[212:215]
	s_add_u32 s69, s69, 0x2000
	v_exp_f32 v45, v45
	v_mfma_f32_16x16x32_bf16 v[212:215], a[84:87], v[56:59], v[212:215]
	s_and_b32 s69, s69, 0x7ffff
	ds_read_b128 a[28:31], v12 offset:4096
	v_cvt_pk_bf16_f32 v54, v44, v45
	v_mfma_f32_16x16x32_bf16 v[228:231], a[88:91], v[56:59], v[228:231]
	s_add_u32 m0, s65, 0xe000
	v_exp_f32 v46, v46
	v_mfma_f32_16x16x32_bf16 v[228:231], a[120:123], v[60:63], v[228:231]
	buffer_load_dwordx4 v20, s[12:15], s69 offen lds
	v_mfma_f32_16x16x32_bf16 v[244:247], a[124:127], v[60:63], v[244:247]
	v_exp_f32 v47, v47
	v_mfma_f32_16x16x32_bf16 v[244:247], a[92:95], v[56:59], v[244:247]
	ds_read_b128 a[24:27], v11 offset:4096
	v_cvt_pk_bf16_f32 v55, v46, v47
	v_mfma_f32_16x16x32_bf16 v[40:43], a[32:35], a[240:243], -4.0
	s_add_u32 m0, s65, 0xe000
	v_exp_f32 v32, v32
	v_mfma_f32_16x16x32_bf16 v[40:43], a[36:39], a[244:247], v[40:43]
	buffer_load_dwordx4 v21, s[12:15], s69 offen offset:1024 lds
	v_mfma_f32_16x16x32_bf16 v[40:43], a[40:43], a[248:251], v[40:43]
	v_exp_f32 v33, v33
	v_mfma_f32_16x16x32_bf16 v[40:43], a[44:47], a[252:255], v[40:43]
	s_add_u32 s69, s69, 0x2000
	ds_read_b128 a[20:23], v10 offset:4096
	v_cvt_pk_bf16_f32 v56, v32, v33
	v_mfma_f32_16x16x32_bf16 v[44:47], a[60:63], a[252:255], -4.0
	s_and_b32 s69, s69, 0x7ffff
	v_exp_f32 v34, v34
	v_mfma_f32_16x16x32_bf16 v[44:47], a[56:59], a[248:251], v[44:47]
	buffer_load_dwordx2 a[156:157], v30, s[48:51], 0 offen offset:0 sc1
	v_mfma_f32_16x16x32_bf16 v[44:47], a[52:55], a[244:247], v[44:47]
	v_exp_f32 v35, v35
	v_mfma_f32_16x16x32_bf16 v[44:47], a[48:51], a[240:243], v[44:47]
	ds_read_b128 a[16:19], v9 offset:4096
	v_cvt_pk_bf16_f32 v57, v34, v35
	v_smfmac_f32_16x16x64_bf16 a[136:139], a[128:131], v[48:55], v31
	v_mfma_f32_16x16x32_bf16 v[136:139], a[64:67], v[48:51], v[136:139]
	v_exp_f32 v36, v36
	v_mfma_f32_16x16x32_bf16 v[136:139], a[96:99], v[52:55], v[136:139]
	ds_read_b128 a[32:35], v9 offset:8192
	ds_read_b128 a[36:39], v10 offset:8192
	v_mfma_f32_16x16x32_bf16 v[152:155], a[100:103], v[52:55], v[152:155]
	v_exp_f32 v37, v37
	v_mfma_f32_16x16x32_bf16 v[152:155], a[68:71], v[48:51], v[152:155]
	ds_read_b128 a[40:43], v11 offset:8192
	v_cvt_pk_bf16_f32 v58, v36, v37
	v_mfma_f32_16x16x32_bf16 v[168:171], a[72:75], v[48:51], v[168:171]
	v_exp_f32 v38, v38
	v_mfma_f32_16x16x32_bf16 v[168:171], a[104:107], v[52:55], v[168:171]
	buffer_load_dwordx2 a[158:159], v30, s[48:51], 0 offen offset:128 sc1
	v_mfma_f32_16x16x32_bf16 v[184:187], a[108:111], v[52:55], v[184:187]
	v_exp_f32 v39, v39
	v_mfma_f32_16x16x32_bf16 v[184:187], a[76:79], v[48:51], v[184:187]
	s_waitcnt lgkmcnt(4)
	ds_read_b128 a[44:47], v12 offset:8192
	v_cvt_pk_bf16_f32 v59, v38, v39
	v_mfma_f32_16x16x32_bf16 v[32:35], a[0:3], a[192:195], -4.0
	s_lshl_b32 s74, s61, 3
	v_exp_f32 v40, v40
	v_mfma_f32_16x16x32_bf16 v[32:35], a[4:7], a[196:199], v[32:35]
	buffer_atomic_add v26, v27, s[44:47], s74 offen offset:4 sc0 sc1
	v_mfma_f32_16x16x32_bf16 v[32:35], a[8:11], a[200:203], v[32:35]
	v_exp_f32 v41, v41
	v_mfma_f32_16x16x32_bf16 v[32:35], a[12:15], a[204:207], v[32:35]
	ds_read_b128 a[60:63], v12 offset:12288
	v_cvt_pk_bf16_f32 v60, v40, v41
	v_mfma_f32_16x16x32_bf16 v[36:39], a[28:31], a[204:207], -4.0
	s_add_u32 s71, s86, 0x0
	v_exp_f32 v42, v42
	v_mfma_f32_16x16x32_bf16 v[36:39], a[24:27], a[200:203], v[36:39]
	buffer_load_dwordx4 v[64:67], v13, s[48:51], s71 offen offset:0 sc1
	v_mfma_f32_16x16x32_bf16 v[36:39], a[20:23], a[196:199], v[36:39]
	s_waitcnt lgkmcnt(2)
	v_exp_f32 v43, v43
	v_mfma_f32_16x16x32_bf16 v[36:39], a[16:19], a[192:195], v[36:39]
	ds_read_b128 a[56:59], v11 offset:12288
	v_cvt_pk_bf16_f32 v61, v42, v43
	v_mfma_f32_16x16x32_bf16 v[200:203], a[80:83], v[48:51], v[200:203]
	v_exp_f32 v44, v44
	v_mfma_f32_16x16x32_bf16 v[200:203], a[112:115], v[52:55], v[200:203]
	buffer_load_dwordx4 v[68:71], v13, s[48:51], s71 offen offset:1024 sc1
	v_mfma_f32_16x16x32_bf16 v[216:219], a[116:119], v[52:55], v[216:219]
	v_exp_f32 v45, v45
	v_mfma_f32_16x16x32_bf16 v[216:219], a[84:87], v[48:51], v[216:219]
	ds_read_b128 a[52:55], v10 offset:12288
	v_cvt_pk_bf16_f32 v62, v44, v45
	v_mfma_f32_16x16x32_bf16 v[232:235], a[88:91], v[48:51], v[232:235]
	v_exp_f32 v46, v46
	v_mfma_f32_16x16x32_bf16 v[232:235], a[120:123], v[52:55], v[232:235]
	ds_read_b128 a[48:51], v9 offset:12288
	v_mfma_f32_16x16x32_bf16 v[248:251], a[124:127], v[52:55], v[248:251]
	v_exp_f32 v47, v47
	v_mfma_f32_16x16x32_bf16 v[248:251], a[92:95], v[48:51], v[248:251]
	v_cvt_pk_bf16_f32 v63, v46, v47
	v_mfma_f32_16x16x32_bf16 v[40:43], a[32:35], a[192:195], -4.0
	v_exp_f32 v32, v32
	v_mfma_f32_16x16x32_bf16 v[40:43], a[36:39], a[196:199], v[40:43]
	buffer_load_dwordx4 v[72:75], v13, s[48:51], s71 offen offset:2048 sc1
	v_mfma_f32_16x16x32_bf16 v[40:43], a[40:43], a[200:203], v[40:43]
	s_waitcnt lgkmcnt(2)
	v_exp_f32 v33, v33
	v_mfma_f32_16x16x32_bf16 v[40:43], a[44:47], a[204:207], v[40:43]
	v_cvt_pk_bf16_f32 v48, v32, v33
	v_mfma_f32_16x16x32_bf16 v[44:47], a[60:63], a[204:207], -4.0
	v_exp_f32 v34, v34
	v_mfma_f32_16x16x32_bf16 v[44:47], a[56:59], a[200:203], v[44:47]
	s_waitcnt lgkmcnt(1)
	v_mfma_f32_16x16x32_bf16 v[44:47], a[52:55], a[196:199], v[44:47]
	s_waitcnt lgkmcnt(0)
	v_exp_f32 v35, v35
	v_mfma_f32_16x16x32_bf16 v[44:47], a[48:51], a[192:195], v[44:47]
	v_cvt_pk_bf16_f32 v49, v34, v35
	v_smfmac_f32_16x16x64_bf16 a[136:139], a[168:171], v[56:63], v31
	v_mfma_f32_16x16x32_bf16 v[140:143], a[64:67], v[56:59], v[140:143]
	v_exp_f32 v36, v36
	v_mfma_f32_16x16x32_bf16 v[140:143], a[96:99], v[60:63], v[140:143]
	ds_read_b64_tr_b16 a[64:65], v1 offset:0
	ds_read_b64_tr_b16 a[66:67], v1 offset:4096
	v_mfma_f32_16x16x32_bf16 v[156:159], a[100:103], v[60:63], v[156:159]
	v_exp_f32 v37, v37
	v_mfma_f32_16x16x32_bf16 v[156:159], a[68:71], v[56:59], v[156:159]
	ds_read_b64_tr_b16 a[96:97], v1 offset:8192
	v_cvt_pk_bf16_f32 v50, v36, v37
	v_mfma_f32_16x16x32_bf16 v[172:175], a[72:75], v[56:59], v[172:175]
	v_exp_f32 v38, v38
	v_mfma_f32_16x16x32_bf16 v[172:175], a[104:107], v[60:63], v[172:175]
	ds_read_b64_tr_b16 a[98:99], v1 offset:12288
	ds_read_b64_tr_b16 a[100:101], v2 offset:8192
	v_mfma_f32_16x16x32_bf16 v[188:191], a[108:111], v[60:63], v[188:191]
	v_exp_f32 v39, v39
	v_mfma_f32_16x16x32_bf16 v[188:191], a[76:79], v[56:59], v[188:191]
	ds_read_b64_tr_b16 a[102:103], v2 offset:12288
	v_cvt_pk_bf16_f32 v51, v38, v39
	v_mfma_f32_16x16x32_bf16 v[32:35], a[0:3], a[208:211], -4.0
	v_exp_f32 v40, v40
	v_mfma_f32_16x16x32_bf16 v[32:35], a[4:7], a[212:215], v[32:35]
	ds_read_b64_tr_b16 a[68:69], v2 offset:0
	ds_read_b64_tr_b16 a[70:71], v2 offset:4096
	v_mfma_f32_16x16x32_bf16 v[32:35], a[8:11], a[216:219], v[32:35]
	v_exp_f32 v41, v41
	v_mfma_f32_16x16x32_bf16 v[32:35], a[12:15], a[220:223], v[32:35]
	ds_read_b64_tr_b16 a[72:73], v3 offset:0
	v_cvt_pk_bf16_f32 v52, v40, v41
	v_mfma_f32_16x16x32_bf16 v[36:39], a[28:31], a[220:223], -4.0
	v_exp_f32 v42, v42
	v_mfma_f32_16x16x32_bf16 v[36:39], a[24:27], a[216:219], v[36:39]
	ds_read_b64_tr_b16 a[74:75], v3 offset:4096
	ds_read_b64_tr_b16 a[104:105], v3 offset:8192
	v_mfma_f32_16x16x32_bf16 v[36:39], a[20:23], a[212:215], v[36:39]
	v_exp_f32 v43, v43
	v_mfma_f32_16x16x32_bf16 v[36:39], a[16:19], a[208:211], v[36:39]
	ds_read_b64_tr_b16 a[106:107], v3 offset:12288
	v_cvt_pk_bf16_f32 v53, v42, v43
	v_mfma_f32_16x16x32_bf16 v[204:207], a[80:83], v[56:59], v[204:207]
	v_exp_f32 v44, v44
	v_mfma_f32_16x16x32_bf16 v[204:207], a[112:115], v[60:63], v[204:207]
	ds_read_b64_tr_b16 a[108:109], v4 offset:8192
	ds_read_b64_tr_b16 a[110:111], v4 offset:12288
	v_mfma_f32_16x16x32_bf16 v[220:223], a[116:119], v[60:63], v[220:223]
	v_exp_f32 v45, v45
	v_mfma_f32_16x16x32_bf16 v[220:223], a[84:87], v[56:59], v[220:223]
	ds_read_b64_tr_b16 a[76:77], v4 offset:0
	v_cvt_pk_bf16_f32 v54, v44, v45
	v_mfma_f32_16x16x32_bf16 v[236:239], a[88:91], v[56:59], v[236:239]
	v_exp_f32 v46, v46
	v_mfma_f32_16x16x32_bf16 v[236:239], a[120:123], v[60:63], v[236:239]
	ds_read_b64_tr_b16 a[78:79], v4 offset:4096
	ds_read_b64_tr_b16 a[80:81], v5 offset:0
	v_mfma_f32_16x16x32_bf16 v[252:255], a[124:127], v[60:63], v[252:255]
	v_exp_f32 v47, v47
	v_mfma_f32_16x16x32_bf16 v[252:255], a[92:95], v[56:59], v[252:255]
	ds_read_b64_tr_b16 a[82:83], v5 offset:4096
	v_cvt_pk_bf16_f32 v55, v46, v47
	v_mfma_f32_16x16x32_bf16 v[40:43], a[32:35], a[208:211], -4.0
	v_exp_f32 v32, v32
	v_mfma_f32_16x16x32_bf16 v[40:43], a[36:39], a[212:215], v[40:43]
	ds_read_b64_tr_b16 a[112:113], v5 offset:8192
	ds_read_b64_tr_b16 a[114:115], v5 offset:12288
	v_mfma_f32_16x16x32_bf16 v[40:43], a[40:43], a[216:219], v[40:43]
	v_exp_f32 v33, v33
	v_mfma_f32_16x16x32_bf16 v[40:43], a[44:47], a[220:223], v[40:43]
	ds_read_b64_tr_b16 a[116:117], v6 offset:8192
	v_cvt_pk_bf16_f32 v56, v32, v33
	v_mfma_f32_16x16x32_bf16 v[44:47], a[60:63], a[220:223], -4.0
	v_exp_f32 v34, v34
	v_mfma_f32_16x16x32_bf16 v[44:47], a[56:59], a[216:219], v[44:47]
	ds_read_b64_tr_b16 a[118:119], v6 offset:12288
	ds_read_b64_tr_b16 a[84:85], v6 offset:0
	v_mfma_f32_16x16x32_bf16 v[44:47], a[52:55], a[212:215], v[44:47]
	v_exp_f32 v35, v35
	v_mfma_f32_16x16x32_bf16 v[44:47], a[48:51], a[208:211], v[44:47]
	ds_read_b64_tr_b16 a[86:87], v6 offset:4096
	v_cvt_pk_bf16_f32 v57, v34, v35
	v_smfmac_f32_16x16x64_bf16 a[132:135], a[128:131], v[48:55], v31
	s_waitcnt lgkmcnt(7)
	v_mfma_f32_16x16x32_bf16 v[128:131], a[64:67], v[48:51], v[128:131]
	v_exp_f32 v36, v36
	v_mfma_f32_16x16x32_bf16 v[128:131], a[96:99], v[52:55], v[128:131]
	ds_read_b64_tr_b16 a[88:89], v7 offset:0
	ds_read_b64_tr_b16 a[90:91], v7 offset:4096
	v_mfma_f32_16x16x32_bf16 v[144:147], a[100:103], v[52:55], v[144:147]
	v_exp_f32 v37, v37
	v_mfma_f32_16x16x32_bf16 v[144:147], a[68:71], v[48:51], v[144:147]
	ds_read_b64_tr_b16 a[120:121], v7 offset:8192
	v_cvt_pk_bf16_f32 v58, v36, v37
	v_mfma_f32_16x16x32_bf16 v[160:163], a[72:75], v[48:51], v[160:163]
	v_exp_f32 v38, v38
	v_mfma_f32_16x16x32_bf16 v[160:163], a[104:107], v[52:55], v[160:163]
	ds_read_b64_tr_b16 a[122:123], v7 offset:12288
	ds_read_b64_tr_b16 a[124:125], v8 offset:8192
	v_mfma_f32_16x16x32_bf16 v[176:179], a[108:111], v[52:55], v[176:179]
	v_exp_f32 v39, v39
	v_mfma_f32_16x16x32_bf16 v[176:179], a[76:79], v[48:51], v[176:179]
	ds_read_b64_tr_b16 a[126:127], v8 offset:12288
	v_cvt_pk_bf16_f32 v59, v38, v39
	v_mfma_f32_16x16x32_bf16 v[32:35], a[0:3], a[224:227], -4.0
	v_exp_f32 v40, v40
	v_mfma_f32_16x16x32_bf16 v[32:35], a[4:7], a[228:231], v[32:35]
	ds_read_b64_tr_b16 a[92:93], v8 offset:0
	ds_read_b64_tr_b16 a[94:95], v8 offset:4096
	v_mfma_f32_16x16x32_bf16 v[32:35], a[8:11], a[232:235], v[32:35]
	v_exp_f32 v41, v41
	v_mfma_f32_16x16x32_bf16 v[32:35], a[12:15], a[236:239], v[32:35]
	s_waitcnt vmcnt(5)
	v_cvt_pk_bf16_f32 v60, v40, v41
	v_accvgpr_read_b32 v120, a156
	v_mfma_f32_16x16x32_bf16 v[36:39], a[28:31], a[236:239], -4.0
	v_exp_f32 v42, v42
	v_mfma_f32_16x16x32_bf16 v[36:39], a[24:27], a[232:235], v[36:39]
	s_waitcnt vmcnt(4)
	v_accvgpr_read_b32 v121, a157
	v_accvgpr_read_b32 v122, a158
	v_mfma_f32_16x16x32_bf16 v[36:39], a[20:23], a[228:231], v[36:39]
	v_exp_f32 v43, v43
	v_mfma_f32_16x16x32_bf16 v[36:39], a[16:19], a[224:227], v[36:39]
	s_waitcnt lgkmcnt(3)
	v_cvt_pk_bf16_f32 v61, v42, v43
	v_accvgpr_read_b32 v123, a159
	v_mfma_f32_16x16x32_bf16 v[192:195], a[80:83], v[48:51], v[192:195]
	v_exp_f32 v44, v44
	v_mfma_f32_16x16x32_bf16 v[192:195], a[112:115], v[52:55], v[192:195]
	buffer_load_dwordx4 v[76:79], v13, s[48:51], s71 offen offset:3072 sc1
	v_mfma_f32_16x16x32_bf16 v[208:211], a[116:119], v[52:55], v[208:211]
	v_exp_f32 v45, v45
	v_mfma_f32_16x16x32_bf16 v[208:211], a[84:87], v[48:51], v[208:211]
	v_cvt_pk_bf16_f32 v62, v44, v45
	v_add_f32 v124, v120, v122
	v_mfma_f32_16x16x32_bf16 v[224:227], a[88:91], v[48:51], v[224:227]
	s_add_u32 s71, s86, 0x1000
	v_exp_f32 v46, v46
	v_mfma_f32_16x16x32_bf16 v[224:227], a[120:123], v[52:55], v[224:227]
	s_waitcnt lgkmcnt(0)
	buffer_load_dwordx4 v[80:83], v13, s[48:51], s71 offen offset:0 sc1
	v_mfma_f32_16x16x32_bf16 v[240:243], a[124:127], v[52:55], v[240:243]
	v_exp_f32 v47, v47
	v_mfma_f32_16x16x32_bf16 v[240:243], a[92:95], v[48:51], v[240:243]
	s_barrier
	v_cvt_pk_bf16_f32 v63, v46, v47
	v_mov_b32 v125, v124
	v_mfma_f32_16x16x32_bf16 v[40:43], a[32:35], a[224:227], -4.0
L_pg11:
	s_cbranch_execz L_touched0
	s_add_u32 m0, s65, 0x0
	v_exp_f32 v32, v32
	v_mfma_f32_16x16x32_bf16 v[40:43], a[36:39], a[228:231], v[40:43]
	buffer_load_dwordx4 v18, s[8:11], s68 offen lds
	v_mfma_f32_16x16x32_bf16 v[40:43], a[40:43], a[232:235], v[40:43]
	v_exp_f32 v33, v33
	v_mfma_f32_16x16x32_bf16 v[40:43], a[44:47], a[236:239], v[40:43]
	v_cvt_pk_bf16_f32 v48, v32, v33
	v_mfma_f32_16x16x32_bf16 v[44:47], a[60:63], a[236:239], -4.0
	v_exp_f32 v34, v34
	v_mfma_f32_16x16x32_bf16 v[44:47], a[56:59], a[232:235], v[44:47]
	buffer_load_dwordx4 v19, s[8:11], s68 offen offset:1024 lds
	v_mfma_f32_16x16x32_bf16 v[44:47], a[52:55], a[228:231], v[44:47]
	s_add_u32 s68, s68, 0x2000
	v_exp_f32 v35, v35
	v_mfma_f32_16x16x32_bf16 v[44:47], a[48:51], a[224:227], v[44:47]
	s_and_b32 s68, s68, 0x7ffff
	v_cvt_pk_bf16_f32 v49, v34, v35
	v_smfmac_f32_16x16x64_bf16 a[132:135], a[168:171], v[56:63], v31
	v_mfma_f32_16x16x32_bf16 v[132:135], a[64:67], v[56:59], v[132:135]
	s_add_u32 m0, s65, 0x2000
	v_exp_f32 v36, v36
	v_mfma_f32_16x16x32_bf16 v[132:135], a[96:99], v[60:63], v[132:135]
	buffer_load_dwordx4 v18, s[8:11], s68 offen lds
	v_mfma_f32_16x16x32_bf16 v[148:151], a[100:103], v[60:63], v[148:151]
	v_exp_f32 v37, v37
	v_mfma_f32_16x16x32_bf16 v[148:151], a[68:71], v[56:59], v[148:151]
	v_cvt_pk_bf16_f32 v50, v36, v37
	v_mfma_f32_16x16x32_bf16 v[164:167], a[72:75], v[56:59], v[164:167]
	v_exp_f32 v38, v38
	v_mfma_f32_16x16x32_bf16 v[164:167], a[104:107], v[60:63], v[164:167]
	buffer_load_dwordx4 v19, s[8:11], s68 offen offset:1024 lds
	v_mfma_f32_16x16x32_bf16 v[180:183], a[108:111], v[60:63], v[180:183]
	s_add_u32 s68, s68, 0x2000
	v_exp_f32 v39, v39
	v_mfma_f32_16x16x32_bf16 v[180:183], a[76:79], v[56:59], v[180:183]
	s_and_b32 s68, s68, 0x7ffff
	v_cvt_pk_bf16_f32 v51, v38, v39
	v_mfma_f32_16x16x32_bf16 v[32:35], a[0:3], a[240:243], -4.0
	s_add_u32 m0, s65, 0x8000
	v_exp_f32 v40, v40
	v_mfma_f32_16x16x32_bf16 v[32:35], a[4:7], a[244:247], v[32:35]
	buffer_load_dwordx4 v20, s[12:15], s69 offen lds
	v_mfma_f32_16x16x32_bf16 v[32:35], a[8:11], a[248:251], v[32:35]
	v_exp_f32 v41, v41
	v_mfma_f32_16x16x32_bf16 v[32:35], a[12:15], a[252:255], v[32:35]
	ds_read_b128 a[0:3], v9 offset:16384
	v_cvt_pk_bf16_f32 v52, v40, v41
	v_mfma_f32_16x16x32_bf16 v[36:39], a[28:31], a[252:255], -4.0
	v_exp_f32 v42, v42
	v_mfma_f32_16x16x32_bf16 v[36:39], a[24:27], a[248:251], v[36:39]
	buffer_load_dwordx4 v21, s[12:15], s69 offen offset:1024 lds
	v_mfma_f32_16x16x32_bf16 v[36:39], a[20:23], a[244:247], v[36:39]
	v_exp_f32 v43, v43
	v_mfma_f32_16x16x32_bf16 v[36:39], a[16:19], a[240:243], v[36:39]
	ds_read_b128 a[4:7], v10 offset:16384
	v_cvt_pk_bf16_f32 v53, v42, v43
	v_mfma_f32_16x16x32_bf16 v[196:199], a[80:83], v[56:59], v[196:199]
	v_exp_f32 v44, v44
	v_mfma_f32_16x16x32_bf16 v[196:199], a[112:115], v[60:63], v[196:199]
	ds_read_b128 a[8:11], v11 offset:16384
	ds_read_b128 a[12:15], v12 offset:16384
	v_mfma_f32_16x16x32_bf16 v[212:215], a[116:119], v[60:63], v[212:215]
	s_add_u32 s69, s69, 0x2000
	v_exp_f32 v45, v45
	v_mfma_f32_16x16x32_bf16 v[212:215], a[84:87], v[56:59], v[212:215]
	s_and_b32 s69, s69, 0x7ffff
	ds_read_b128 a[28:31], v12 offset:20480
	v_cvt_pk_bf16_f32 v54, v44, v45
	v_mfma_f32_16x16x32_bf16 v[228:231], a[88:91], v[56:59], v[228:231]
	s_add_u32 m0, s65, 0xa000
	v_exp_f32 v46, v46
	v_mfma_f32_16x16x32_bf16 v[228:231], a[120:123], v[60:63], v[228:231]
	buffer_load_dwordx4 v20, s[12:15], s69 offen lds
	v_mfma_f32_16x16x32_bf16 v[244:247], a[124:127], v[60:63], v[244:247]
	v_exp_f32 v47, v47
	v_mfma_f32_16x16x32_bf16 v[244:247], a[92:95], v[56:59], v[244:247]
	ds_read_b128 a[24:27], v11 offset:20480
	v_cvt_pk_bf16_f32 v55, v46, v47
	v_mfma_f32_16x16x32_bf16 v[40:43], a[32:35], a[240:243], -4.0
	s_add_u32 m0, s65, 0xa000
	v_exp_f32 v32, v32
	v_mfma_f32_16x16x32_bf16 v[40:43], a[36:39], a[244:247], v[40:43]
	buffer_load_dwordx4 v21, s[12:15], s69 offen offset:1024 lds
	v_mfma_f32_16x16x32_bf16 v[40:43], a[40:43], a[248:251], v[40:43]
	v_exp_f32 v33, v33
	v_mfma_f32_16x16x32_bf16 v[40:43], a[44:47], a[252:255], v[40:43]
	s_add_u32 s69, s69, 0x2000
	ds_read_b128 a[20:23], v10 offset:20480
	v_cvt_pk_bf16_f32 v56, v32, v33
	v_mfma_f32_16x16x32_bf16 v[44:47], a[60:63], a[252:255], -4.0
	s_and_b32 s69, s69, 0x7ffff
	v_exp_f32 v34, v34
	v_mfma_f32_16x16x32_bf16 v[44:47], a[56:59], a[248:251], v[44:47]
	buffer_load_dwordx4 v[84:87], v13, s[48:51], s71 offen offset:1024 sc1
	v_mfma_f32_16x16x32_bf16 v[44:47], a[52:55], a[244:247], v[44:47]
	v_exp_f32 v35, v35
	v_mfma_f32_16x16x32_bf16 v[44:47], a[48:51], a[240:243], v[44:47]
	ds_read_b128 a[16:19], v9 offset:20480
	v_cvt_pk_bf16_f32 v57, v34, v35
	v_smfmac_f32_16x16x64_bf16 a[136:139], a[128:131], v[48:55], v31
	v_mfma_f32_16x16x32_bf16 v[136:139], a[64:67], v[48:51], v[136:139]
	v_exp_f32 v36, v36
	v_mfma_f32_16x16x32_bf16 v[136:139], a[96:99], v[52:55], v[136:139]
	ds_read_b128 a[32:35], v9 offset:24576
	ds_read_b128 a[36:39], v10 offset:24576
	v_mfma_f32_16x16x32_bf16 v[152:155], a[100:103], v[52:55], v[152:155]
	v_exp_f32 v37, v37
	v_mfma_f32_16x16x32_bf16 v[152:155], a[68:71], v[48:51], v[152:155]
	ds_read_b128 a[40:43], v11 offset:24576
	v_cvt_pk_bf16_f32 v58, v36, v37
	v_mfma_f32_16x16x32_bf16 v[168:171], a[72:75], v[48:51], v[168:171]
	v_exp_f32 v38, v38
	v_mfma_f32_16x16x32_bf16 v[168:171], a[104:107], v[52:55], v[168:171]
	s_waitcnt vmcnt(14)
	v_cmp_eq_u32 vcc, 15, v26
	v_mov_b32 v26, 1
	s_nop 0
	v_cndmask_b32 v27, v28, v27, vcc
	v_mfma_f32_16x16x32_bf16 v[184:187], a[108:111], v[52:55], v[184:187]
	v_exp_f32 v39, v39
	v_mfma_f32_16x16x32_bf16 v[184:187], a[76:79], v[48:51], v[184:187]
	s_waitcnt lgkmcnt(4)
	ds_read_b128 a[44:47], v12 offset:24576
	v_cvt_pk_bf16_f32 v59, v38, v39
	v_mfma_f32_16x16x32_bf16 v[32:35], a[0:3], a[192:195], -4.0
	s_mov_b32 s74, 0
	v_exp_f32 v40, v40
	v_mfma_f32_16x16x32_bf16 v[32:35], a[4:7], a[196:199], v[32:35]
	buffer_atomic_add v26, v27, s[44:47], s74 offen offset:68 sc0 sc1
	v_mfma_f32_16x16x32_bf16 v[32:35], a[8:11], a[200:203], v[32:35]
	v_exp_f32 v41, v41
	v_mfma_f32_16x16x32_bf16 v[32:35], a[12:15], a[204:207], v[32:35]
	ds_read_b128 a[60:63], v12 offset:28672
	v_cvt_pk_bf16_f32 v60, v40, v41
	v_mfma_f32_16x16x32_bf16 v[36:39], a[28:31], a[204:207], -4.0
	v_exp_f32 v42, v42
	v_mfma_f32_16x16x32_bf16 v[36:39], a[24:27], a[200:203], v[36:39]
	buffer_load_dwordx4 v[88:91], v13, s[48:51], s71 offen offset:2048 sc1
	v_mfma_f32_16x16x32_bf16 v[36:39], a[20:23], a[196:199], v[36:39]
	s_waitcnt lgkmcnt(2)
	v_exp_f32 v43, v43
	v_mfma_f32_16x16x32_bf16 v[36:39], a[16:19], a[192:195], v[36:39]
	ds_read_b128 a[56:59], v11 offset:28672
	v_cvt_pk_bf16_f32 v61, v42, v43
	v_mfma_f32_16x16x32_bf16 v[200:203], a[80:83], v[48:51], v[200:203]
	v_exp_f32 v44, v44
	v_mfma_f32_16x16x32_bf16 v[200:203], a[112:115], v[52:55], v[200:203]
	buffer_load_dwordx4 v[92:95], v13, s[48:51], s71 offen offset:3072 sc1
	v_mfma_f32_16x16x32_bf16 v[216:219], a[116:119], v[52:55], v[216:219]
	v_exp_f32 v45, v45
	v_mfma_f32_16x16x32_bf16 v[216:219], a[84:87], v[48:51], v[216:219]
	ds_read_b128 a[52:55], v10 offset:28672
	v_cvt_pk_bf16_f32 v62, v44, v45
	v_mfma_f32_16x16x32_bf16 v[232:235], a[88:91], v[48:51], v[232:235]
	v_exp_f32 v46, v46
	v_mfma_f32_16x16x32_bf16 v[232:235], a[120:123], v[52:55], v[232:235]
	ds_read_b128 a[48:51], v9 offset:28672
	v_mfma_f32_16x16x32_bf16 v[248:251], a[124:127], v[52:55], v[248:251]
	v_exp_f32 v47, v47
	v_mfma_f32_16x16x32_bf16 v[248:251], a[92:95], v[48:51], v[248:251]
	v_cvt_pk_bf16_f32 v63, v46, v47
	v_mfma_f32_16x16x32_bf16 v[40:43], a[32:35], a[192:195], -4.0
	s_add_u32 s71, s86, 0x2000
	v_exp_f32 v32, v32
	v_mfma_f32_16x16x32_bf16 v[40:43], a[36:39], a[196:199], v[40:43]
	buffer_load_dwordx4 v[96:99], v13, s[48:51], s71 offen offset:0 sc1
	v_mfma_f32_16x16x32_bf16 v[40:43], a[40:43], a[200:203], v[40:43]
	s_waitcnt lgkmcnt(2)
	v_exp_f32 v33, v33
	v_mfma_f32_16x16x32_bf16 v[40:43], a[44:47], a[204:207], v[40:43]
	v_cvt_pk_bf16_f32 v48, v32, v33
	v_mfma_f32_16x16x32_bf16 v[44:47], a[60:63], a[204:207], -4.0
	v_exp_f32 v34, v34
	v_mfma_f32_16x16x32_bf16 v[44:47], a[56:59], a[200:203], v[44:47]
	s_waitcnt lgkmcnt(1)
	v_permlane32_swap_b32 v125, v124
	v_mfma_f32_16x16x32_bf16 v[44:47], a[52:55], a[196:199], v[44:47]
	s_waitcnt lgkmcnt(0)
	v_exp_f32 v35, v35
	v_mfma_f32_16x16x32_bf16 v[44:47], a[48:51], a[192:195], v[44:47]
	v_cvt_pk_bf16_f32 v49, v34, v35
	v_add_f32 v124, v124, v125
	v_smfmac_f32_16x16x64_bf16 a[136:139], a[168:171], v[56:63], v31
	v_mfma_f32_16x16x32_bf16 v[140:143], a[64:67], v[56:59], v[140:143]
	v_exp_f32 v36, v36
	v_mfma_f32_16x16x32_bf16 v[140:143], a[96:99], v[60:63], v[140:143]
	ds_read_b64_tr_b16 a[64:65], v1 offset:16384
	ds_read_b64_tr_b16 a[66:67], v1 offset:20480
	v_mfma_f32_16x16x32_bf16 v[156:159], a[100:103], v[60:63], v[156:159]
	v_exp_f32 v37, v37
	v_mfma_f32_16x16x32_bf16 v[156:159], a[68:71], v[56:59], v[156:159]
	ds_read_b64_tr_b16 a[96:97], v1 offset:24576
	v_cvt_pk_bf16_f32 v50, v36, v37
	v_mfma_f32_16x16x32_bf16 v[172:175], a[72:75], v[56:59], v[172:175]
	v_exp_f32 v38, v38
	v_mfma_f32_16x16x32_bf16 v[172:175], a[104:107], v[60:63], v[172:175]
	ds_read_b64_tr_b16 a[98:99], v1 offset:28672
	ds_read_b64_tr_b16 a[100:101], v2 offset:24576
	v_mfma_f32_16x16x32_bf16 v[188:191], a[108:111], v[60:63], v[188:191]
	v_exp_f32 v39, v39
	v_mfma_f32_16x16x32_bf16 v[188:191], a[76:79], v[56:59], v[188:191]
	ds_read_b64_tr_b16 a[102:103], v2 offset:28672
	v_cvt_pk_bf16_f32 v51, v38, v39
	v_mfma_f32_16x16x32_bf16 v[32:35], a[0:3], a[208:211], -4.0
	v_exp_f32 v40, v40
	v_mfma_f32_16x16x32_bf16 v[32:35], a[4:7], a[212:215], v[32:35]
	ds_read_b64_tr_b16 a[68:69], v2 offset:16384
	ds_read_b64_tr_b16 a[70:71], v2 offset:20480
	v_mfma_f32_16x16x32_bf16 v[32:35], a[8:11], a[216:219], v[32:35]
	v_exp_f32 v41, v41
	v_mfma_f32_16x16x32_bf16 v[32:35], a[12:15], a[220:223], v[32:35]
	ds_read_b64_tr_b16 a[72:73], v3 offset:16384
	v_cvt_pk_bf16_f32 v52, v40, v41
	v_mfma_f32_16x16x32_bf16 v[36:39], a[28:31], a[220:223], -4.0
	v_exp_f32 v42, v42
	v_mfma_f32_16x16x32_bf16 v[36:39], a[24:27], a[216:219], v[36:39]
	ds_read_b64_tr_b16 a[74:75], v3 offset:20480
	ds_read_b64_tr_b16 a[104:105], v3 offset:24576
	v_mfma_f32_16x16x32_bf16 v[36:39], a[20:23], a[212:215], v[36:39]
	v_exp_f32 v43, v43
	v_mfma_f32_16x16x32_bf16 v[36:39], a[16:19], a[208:211], v[36:39]
	ds_read_b64_tr_b16 a[106:107], v3 offset:28672
	v_cvt_pk_bf16_f32 v53, v42, v43
	v_mfma_f32_16x16x32_bf16 v[204:207], a[80:83], v[56:59], v[204:207]
	v_exp_f32 v44, v44
	v_mfma_f32_16x16x32_bf16 v[204:207], a[112:115], v[60:63], v[204:207]
	ds_read_b64_tr_b16 a[108:109], v4 offset:24576
	ds_read_b64_tr_b16 a[110:111], v4 offset:28672
	v_mfma_f32_16x16x32_bf16 v[220:223], a[116:119], v[60:63], v[220:223]
	v_exp_f32 v45, v45
	v_mfma_f32_16x16x32_bf16 v[220:223], a[84:87], v[56:59], v[220:223]
	ds_read_b64_tr_b16 a[76:77], v4 offset:16384
	v_cvt_pk_bf16_f32 v54, v44, v45
	v_mfma_f32_16x16x32_bf16 v[236:239], a[88:91], v[56:59], v[236:239]
	v_exp_f32 v46, v46
	v_mfma_f32_16x16x32_bf16 v[236:239], a[120:123], v[60:63], v[236:239]
	ds_read_b64_tr_b16 a[78:79], v4 offset:20480
	ds_read_b64_tr_b16 a[80:81], v5 offset:16384
	v_mfma_f32_16x16x32_bf16 v[252:255], a[124:127], v[60:63], v[252:255]
	v_exp_f32 v47, v47
	v_mfma_f32_16x16x32_bf16 v[252:255], a[92:95], v[56:59], v[252:255]
	ds_read_b64_tr_b16 a[82:83], v5 offset:20480
	v_cvt_pk_bf16_f32 v55, v46, v47
	v_mfma_f32_16x16x32_bf16 v[40:43], a[32:35], a[208:211], -4.0
	v_exp_f32 v32, v32
	v_mfma_f32_16x16x32_bf16 v[40:43], a[36:39], a[212:215], v[40:43]
	ds_read_b64_tr_b16 a[112:113], v5 offset:24576
	ds_read_b64_tr_b16 a[114:115], v5 offset:28672
	v_mfma_f32_16x16x32_bf16 v[40:43], a[40:43], a[216:219], v[40:43]
	v_exp_f32 v33, v33
	v_mfma_f32_16x16x32_bf16 v[40:43], a[44:47], a[220:223], v[40:43]
	ds_read_b64_tr_b16 a[116:117], v6 offset:24576
	v_cvt_pk_bf16_f32 v56, v32, v33
	v_mfma_f32_16x16x32_bf16 v[44:47], a[60:63], a[220:223], -4.0
	v_exp_f32 v34, v34
	v_mfma_f32_16x16x32_bf16 v[44:47], a[56:59], a[216:219], v[44:47]
	ds_read_b64_tr_b16 a[118:119], v6 offset:28672
	ds_read_b64_tr_b16 a[84:85], v6 offset:16384
	v_mfma_f32_16x16x32_bf16 v[44:47], a[52:55], a[212:215], v[44:47]
	v_exp_f32 v35, v35
	v_mfma_f32_16x16x32_bf16 v[44:47], a[48:51], a[208:211], v[44:47]
	ds_read_b64_tr_b16 a[86:87], v6 offset:20480
	v_cvt_pk_bf16_f32 v57, v34, v35
	v_smfmac_f32_16x16x64_bf16 a[132:135], a[128:131], v[48:55], v31
	s_waitcnt lgkmcnt(7)
	v_mfma_f32_16x16x32_bf16 v[128:131], a[64:67], v[48:51], v[128:131]
	v_exp_f32 v36, v36
	v_mfma_f32_16x16x32_bf16 v[128:131], a[96:99], v[52:55], v[128:131]
	ds_read_b64_tr_b16 a[88:89], v7 offset:16384
	ds_read_b64_tr_b16 a[90:91], v7 offset:20480
	v_mfma_f32_16x16x32_bf16 v[144:147], a[100:103], v[52:55], v[144:147]
	v_exp_f32 v37, v37
	v_mfma_f32_16x16x32_bf16 v[144:147], a[68:71], v[48:51], v[144:147]
	ds_read_b64_tr_b16 a[120:121], v7 offset:24576
	v_cvt_pk_bf16_f32 v58, v36, v37
	v_mfma_f32_16x16x32_bf16 v[160:163], a[72:75], v[48:51], v[160:163]
	v_exp_f32 v38, v38
	v_mfma_f32_16x16x32_bf16 v[160:163], a[104:107], v[52:55], v[160:163]
	ds_read_b64_tr_b16 a[122:123], v7 offset:28672
	ds_read_b64_tr_b16 a[124:125], v8 offset:24576
	v_mfma_f32_16x16x32_bf16 v[176:179], a[108:111], v[52:55], v[176:179]
	v_exp_f32 v39, v39
	v_mfma_f32_16x16x32_bf16 v[176:179], a[76:79], v[48:51], v[176:179]
	ds_read_b64_tr_b16 a[126:127], v8 offset:28672
	v_cvt_pk_bf16_f32 v59, v38, v39
	v_mfma_f32_16x16x32_bf16 v[32:35], a[0:3], a[224:227], -4.0
	v_exp_f32 v40, v40
	v_mfma_f32_16x16x32_bf16 v[32:35], a[4:7], a[228:231], v[32:35]
	ds_read_b64_tr_b16 a[92:93], v8 offset:16384
	ds_read_b64_tr_b16 a[94:95], v8 offset:20480
	v_mfma_f32_16x16x32_bf16 v[32:35], a[8:11], a[232:235], v[32:35]
	v_exp_f32 v41, v41
	v_mfma_f32_16x16x32_bf16 v[32:35], a[12:15], a[236:239], v[32:35]
	v_cvt_pk_bf16_f32 v60, v40, v41
	v_mov_b32 v125, v124
	v_mfma_f32_16x16x32_bf16 v[36:39], a[28:31], a[236:239], -4.0
	v_exp_f32 v42, v42
	v_mfma_f32_16x16x32_bf16 v[36:39], a[24:27], a[232:235], v[36:39]
	v_permlane16_swap_b32 v125, v124
	v_mfma_f32_16x16x32_bf16 v[36:39], a[20:23], a[228:231], v[36:39]
	v_exp_f32 v43, v43
	v_mfma_f32_16x16x32_bf16 v[36:39], a[16:19], a[224:227], v[36:39]
	s_waitcnt lgkmcnt(3)
	v_cvt_pk_bf16_f32 v61, v42, v43
	v_add_f32 v124, v124, v125
	v_mfma_f32_16x16x32_bf16 v[192:195], a[80:83], v[48:51], v[192:195]
	v_exp_f32 v44, v44
	v_mfma_f32_16x16x32_bf16 v[192:195], a[112:115], v[52:55], v[192:195]
	buffer_load_dwordx4 v[100:103], v13, s[48:51], s71 offen offset:1024 sc1
	v_mfma_f32_16x16x32_bf16 v[208:211], a[116:119], v[52:55], v[208:211]
	v_exp_f32 v45, v45
	v_mfma_f32_16x16x32_bf16 v[208:211], a[84:87], v[48:51], v[208:211]
	v_cvt_pk_bf16_f32 v62, v44, v45
	v_mul_f32 v124, 0x3e000000, v124
	v_mfma_f32_16x16x32_bf16 v[224:227], a[88:91], v[48:51], v[224:227]
	v_exp_f32 v46, v46
	v_mfma_f32_16x16x32_bf16 v[224:227], a[120:123], v[52:55], v[224:227]
	s_waitcnt lgkmcnt(0)
	buffer_load_dwordx4 v[104:107], v13, s[48:51], s71 offen offset:2048 sc1
	v_mfma_f32_16x16x32_bf16 v[240:243], a[124:127], v[52:55], v[240:243]
	s_waitcnt vmcnt(7)
	v_exp_f32 v47, v47
	v_mfma_f32_16x16x32_bf16 v[240:243], a[92:95], v[48:51], v[240:243]
	s_barrier
	v_cvt_pk_bf16_f32 v63, v46, v47
	v_sub_f32 v120, v120, v124
	v_mfma_f32_16x16x32_bf16 v[40:43], a[32:35], a[224:227], -4.0
	s_add_u32 m0, s65, 0x4000
	v_exp_f32 v32, v32
	v_mfma_f32_16x16x32_bf16 v[40:43], a[36:39], a[228:231], v[40:43]
	buffer_load_dwordx4 v18, s[8:11], s68 offen lds
	v_mfma_f32_16x16x32_bf16 v[40:43], a[40:43], a[232:235], v[40:43]
	v_exp_f32 v33, v33
	v_mfma_f32_16x16x32_bf16 v[40:43], a[44:47], a[236:239], v[40:43]
	v_cvt_pk_bf16_f32 v48, v32, v33
	v_sub_f32 v122, v122, v124
	v_mfma_f32_16x16x32_bf16 v[44:47], a[60:63], a[236:239], -4.0
	v_exp_f32 v34, v34
	v_mfma_f32_16x16x32_bf16 v[44:47], a[56:59], a[232:235], v[44:47]
	buffer_load_dwordx4 v19, s[8:11], s68 offen offset:1024 lds
	v_mfma_f32_16x16x32_bf16 v[44:47], a[52:55], a[228:231], v[44:47]
	s_add_u32 s68, s68, 0x2000
	v_exp_f32 v35, v35
	v_mfma_f32_16x16x32_bf16 v[44:47], a[48:51], a[224:227], v[44:47]
	s_and_b32 s68, s68, 0x7ffff
	v_cvt_pk_bf16_f32 v49, v34, v35
	v_mul_f32 v120, v120, v120
	v_smfmac_f32_16x16x64_bf16 a[132:135], a[168:171], v[56:63], v31
	v_mfma_f32_16x16x32_bf16 v[132:135], a[64:67], v[56:59], v[132:135]
	s_add_u32 m0, s65, 0x6000
	v_exp_f32 v36, v36
	v_mfma_f32_16x16x32_bf16 v[132:135], a[96:99], v[60:63], v[132:135]
	buffer_load_dwordx4 v18, s[8:11], s68 offen lds
	v_mfma_f32_16x16x32_bf16 v[148:151], a[100:103], v[60:63], v[148:151]
	v_exp_f32 v37, v37
	v_mfma_f32_16x16x32_bf16 v[148:151], a[68:71], v[56:59], v[148:151]
	v_cvt_pk_bf16_f32 v50, v36, v37
	v_fmac_f32 v120, v122, v122
	v_mfma_f32_16x16x32_bf16 v[164:167], a[72:75], v[56:59], v[164:167]
	v_exp_f32 v38, v38
	v_mfma_f32_16x16x32_bf16 v[164:167], a[104:107], v[60:63], v[164:167]
	buffer_load_dwordx4 v19, s[8:11], s68 offen offset:1024 lds
	v_mfma_f32_16x16x32_bf16 v[180:183], a[108:111], v[60:63], v[180:183]
	s_add_u32 s68, s68, 0x2000
	v_exp_f32 v39, v39
	v_mfma_f32_16x16x32_bf16 v[180:183], a[76:79], v[56:59], v[180:183]
	s_and_b32 s68, s68, 0x7ffff
	v_cvt_pk_bf16_f32 v51, v38, v39
	v_add_f32 v121, v121, v123
	v_mfma_f32_16x16x32_bf16 v[32:35], a[0:3], a[240:243], -4.0
	s_add_u32 m0, s65, 0xc000
	v_exp_f32 v40, v40
	v_mfma_f32_16x16x32_bf16 v[32:35], a[4:7], a[244:247], v[32:35]
	buffer_load_dwordx4 v20, s[12:15], s69 offen lds
	v_mfma_f32_16x16x32_bf16 v[32:35], a[8:11], a[248:251], v[32:35]
	v_exp_f32 v41, v41
	v_mfma_f32_16x16x32_bf16 v[32:35], a[12:15], a[252:255], v[32:35]
	ds_read_b128 a[0:3], v9 offset:0
	v_cvt_pk_bf16_f32 v52, v40, v41
	v_mfma_f32_16x16x32_bf16 v[36:39], a[28:31], a[252:255], -4.0
	v_exp_f32 v42, v42
	v_mfma_f32_16x16x32_bf16 v[36:39], a[24:27], a[248:251], v[36:39]
	buffer_load_dwordx4 v21, s[12:15], s69 offen offset:1024 lds
	v_mfma_f32_16x16x32_bf16 v[36:39], a[20:23], a[244:247], v[36:39]
	v_exp_f32 v43, v43
	v_mfma_f32_16x16x32_bf16 v[36:39], a[16:19], a[240:243], v[36:39]
	ds_read_b128 a[4:7], v10 offset:0
	v_cvt_pk_bf16_f32 v53, v42, v43
	v_mfma_f32_16x16x32_bf16 v[196:199], a[80:83], v[56:59], v[196:199]
	v_exp_f32 v44, v44
	v_mfma_f32_16x16x32_bf16 v[196:199], a[112:115], v[60:63], v[196:199]
	ds_read_b128 a[8:11], v11 offset:0
	ds_read_b128 a[12:15], v12 offset:0
	v_mfma_f32_16x16x32_bf16 v[212:215], a[116:119], v[60:63], v[212:215]
	s_add_u32 s69, s69, 0x2000
	v_exp_f32 v45, v45
	v_mfma_f32_16x16x32_bf16 v[212:215], a[84:87], v[56:59], v[212:215]
	s_and_b32 s69, s69, 0x7ffff
	ds_read_b128 a[28:31], v12 offset:4096
	v_cvt_pk_bf16_f32 v54, v44, v45
	v_mfma_f32_16x16x32_bf16 v[228:231], a[88:91], v[56:59], v[228:231]
	s_add_u32 m0, s65, 0xe000
	v_exp_f32 v46, v46
	v_mfma_f32_16x16x32_bf16 v[228:231], a[120:123], v[60:63], v[228:231]
	buffer_load_dwordx4 v20, s[12:15], s69 offen lds
	v_mfma_f32_16x16x32_bf16 v[244:247], a[124:127], v[60:63], v[244:247]
	v_exp_f32 v47, v47
	v_mfma_f32_16x16x32_bf16 v[244:247], a[92:95], v[56:59], v[244:247]
	ds_read_b128 a[24:27], v11 offset:4096
	v_cvt_pk_bf16_f32 v55, v46, v47
	v_mfma_f32_16x16x32_bf16 v[40:43], a[32:35], a[240:243], -4.0
	s_add_u32 m0, s65, 0xe000
	v_exp_f32 v32, v32
	v_mfma_f32_16x16x32_bf16 v[40:43], a[36:39], a[244:247], v[40:43]
	buffer_load_dwordx4 v21, s[12:15], s69 offen offset:1024 lds
	v_mfma_f32_16x16x32_bf16 v[40:43], a[40:43], a[248:251], v[40:43]
	v_exp_f32 v33, v33
	v_mfma_f32_16x16x32_bf16 v[40:43], a[44:47], a[252:255], v[40:43]
	s_add_u32 s69, s69, 0x2000
	ds_read_b128 a[20:23], v10 offset:4096
	v_cvt_pk_bf16_f32 v56, v32, v33
	v_mfma_f32_16x16x32_bf16 v[44:47], a[60:63], a[252:255], -4.0
	s_and_b32 s69, s69, 0x7ffff
	v_exp_f32 v34, v34
	v_mfma_f32_16x16x32_bf16 v[44:47], a[56:59], a[248:251], v[44:47]
	buffer_load_dwordx4 v[108:111], v13, s[48:51], s71 offen offset:3072 sc1
	v_mfma_f32_16x16x32_bf16 v[44:47], a[52:55], a[244:247], v[44:47]
	v_exp_f32 v35, v35
	v_mfma_f32_16x16x32_bf16 v[44:47], a[48:51], a[240:243], v[44:47]
	ds_read_b128 a[16:19], v9 offset:4096
	v_cvt_pk_bf16_f32 v57, v34, v35
	v_smfmac_f32_16x16x64_bf16 a[136:139], a[128:131], v[48:55], v31
	v_mfma_f32_16x16x32_bf16 v[136:139], a[64:67], v[48:51], v[136:139]
	v_exp_f32 v36, v36
	v_mfma_f32_16x16x32_bf16 v[136:139], a[96:99], v[52:55], v[136:139]
	ds_read_b128 a[32:35], v9 offset:8192
	ds_read_b128 a[36:39], v10 offset:8192
	v_mfma_f32_16x16x32_bf16 v[152:155], a[100:103], v[52:55], v[152:155]
	v_exp_f32 v37, v37
	v_mfma_f32_16x16x32_bf16 v[152:155], a[68:71], v[48:51], v[152:155]
	ds_read_b128 a[40:43], v11 offset:8192
	v_cvt_pk_bf16_f32 v58, v36, v37
	v_mfma_f32_16x16x32_bf16 v[168:171], a[72:75], v[48:51], v[168:171]
	v_exp_f32 v38, v38
	v_mfma_f32_16x16x32_bf16 v[168:171], a[104:107], v[52:55], v[168:171]
	s_waitcnt vmcnt(14)
	v_add_u32 v26, 1, v26
	v_mfma_f32_16x16x32_bf16 v[184:187], a[108:111], v[52:55], v[184:187]
	v_exp_f32 v39, v39
	v_mfma_f32_16x16x32_bf16 v[184:187], a[76:79], v[48:51], v[184:187]
	ds_read_b128 a[44:47], v12 offset:8192
	v_cvt_pk_bf16_f32 v59, v38, v39
	v_fmac_f32 v121, 0x42800000, v120
	v_mov_b32 v125, v121
	s_nop 1
	v_permlane32_swap_b32 v125, v121
	v_add_f32 v121, v121, v125
	v_mov_b32 v125, v121
	s_nop 1
	v_permlane16_swap_b32 v125, v121
	v_add_f32 v121, v121, v125
	v_mov_b32 v17, 0x3727c5ac
	v_fmac_f32 v17, 0x3b000000, v121
	v_rsq_f32 v17, v17
	v_sub_f32 v124, 0, v124
	v_mul_f32 v22, v124, v17
	s_waitcnt lgkmcnt(5)
	v_mfma_f32_16x16x32_bf16 v[32:35], a[0:3], a[192:195], -4.0
	s_lshl_b32 s74, s61, 3
	v_exp_f32 v40, v40
	v_mfma_f32_16x16x32_bf16 v[32:35], a[4:7], a[196:199], v[32:35]
	buffer_store_dword v26, v27, s[44:47], s74 offen offset:132 sc1
	v_mfma_f32_16x16x32_bf16 v[32:35], a[8:11], a[200:203], v[32:35]
	v_exp_f32 v41, v41
	v_mfma_f32_16x16x32_bf16 v[32:35], a[12:15], a[204:207], v[32:35]
	ds_read_b128 a[60:63], v12 offset:12288
	v_cvt_pk_bf16_f32 v60, v40, v41
	v_mfma_f32_16x16x32_bf16 v[36:39], a[28:31], a[204:207], -4.0
	s_add_u32 s71, s86, 0x3000
	v_exp_f32 v42, v42
	v_mfma_f32_16x16x32_bf16 v[36:39], a[24:27], a[200:203], v[36:39]
	buffer_load_dwordx4 v[112:115], v13, s[48:51], s71 offen offset:0 sc1
	v_mfma_f32_16x16x32_bf16 v[36:39], a[20:23], a[196:199], v[36:39]
	s_waitcnt lgkmcnt(2)
	v_exp_f32 v43, v43
	v_mfma_f32_16x16x32_bf16 v[36:39], a[16:19], a[192:195], v[36:39]
	ds_read_b128 a[56:59], v11 offset:12288
	v_cvt_pk_bf16_f32 v61, v42, v43
	v_mfma_f32_16x16x32_bf16 v[200:203], a[80:83], v[48:51], v[200:203]
	v_exp_f32 v44, v44
	v_mfma_f32_16x16x32_bf16 v[200:203], a[112:115], v[52:55], v[200:203]
	buffer_load_dwordx4 v[116:119], v13, s[48:51], s71 offen offset:1024 sc1
	v_mfma_f32_16x16x32_bf16 v[216:219], a[116:119], v[52:55], v[216:219]
	v_exp_f32 v45, v45
	v_mfma_f32_16x16x32_bf16 v[216:219], a[84:87], v[48:51], v[216:219]
	ds_read_b128 a[52:55], v10 offset:12288
	v_cvt_pk_bf16_f32 v62, v44, v45
	v_mfma_f32_16x16x32_bf16 v[232:235], a[88:91], v[48:51], v[232:235]
	v_exp_f32 v46, v46
	v_mfma_f32_16x16x32_bf16 v[232:235], a[120:123], v[52:55], v[232:235]
	ds_read_b128 a[48:51], v9 offset:12288
	v_lshlrev_b32 v30, 16, v64
	v_mfma_f32_16x16x32_bf16 v[248:251], a[124:127], v[52:55], v[248:251]
	v_exp_f32 v47, v47
	v_mfma_f32_16x16x32_bf16 v[248:251], a[92:95], v[48:51], v[248:251]
	v_cvt_pk_bf16_f32 v63, v46, v47
	v_and_b32 v64, 0xffff0000, v64
	v_mfma_f32_16x16x32_bf16 v[40:43], a[32:35], a[192:195], -4.0
	v_exp_f32 v32, v32
	v_mfma_f32_16x16x32_bf16 v[40:43], a[36:39], a[196:199], v[40:43]
	buffer_load_dwordx4 v[120:123], v13, s[48:51], s71 offen offset:2048 sc1
	v_mfma_f32_16x16x32_bf16 v[40:43], a[40:43], a[200:203], v[40:43]
	s_waitcnt lgkmcnt(2)
	v_exp_f32 v33, v33
	v_mfma_f32_16x16x32_bf16 v[40:43], a[44:47], a[204:207], v[40:43]
	v_cvt_pk_bf16_f32 v48, v32, v33
	v_fma_f32 v30, v30, v17, v22
	v_mfma_f32_16x16x32_bf16 v[44:47], a[60:63], a[204:207], -4.0
	v_exp_f32 v34, v34
	v_mfma_f32_16x16x32_bf16 v[44:47], a[56:59], a[200:203], v[44:47]
	s_waitcnt lgkmcnt(1)
	v_fma_f32 v64, v64, v17, v22
	v_cvt_pk_bf16_f32 v64, v30, v64
	v_mfma_f32_16x16x32_bf16 v[44:47], a[52:55], a[196:199], v[44:47]
	s_waitcnt lgkmcnt(0)
	v_exp_f32 v35, v35
	v_mfma_f32_16x16x32_bf16 v[44:47], a[48:51], a[192:195], v[44:47]
	v_cvt_pk_bf16_f32 v49, v34, v35
	v_lshlrev_b32 v30, 16, v65
	v_smfmac_f32_16x16x64_bf16 a[136:139], a[168:171], v[56:63], v31
	v_mfma_f32_16x16x32_bf16 v[140:143], a[64:67], v[56:59], v[140:143]
	v_exp_f32 v36, v36
	v_mfma_f32_16x16x32_bf16 v[140:143], a[96:99], v[60:63], v[140:143]
	ds_read_b64_tr_b16 a[64:65], v1 offset:0
	ds_read_b64_tr_b16 a[66:67], v1 offset:4096
	v_mfma_f32_16x16x32_bf16 v[156:159], a[100:103], v[60:63], v[156:159]
	v_exp_f32 v37, v37
	v_mfma_f32_16x16x32_bf16 v[156:159], a[68:71], v[56:59], v[156:159]
	ds_read_b64_tr_b16 a[96:97], v1 offset:8192
	v_cvt_pk_bf16_f32 v50, v36, v37
	v_mfma_f32_16x16x32_bf16 v[172:175], a[72:75], v[56:59], v[172:175]
	v_exp_f32 v38, v38
	v_mfma_f32_16x16x32_bf16 v[172:175], a[104:107], v[60:63], v[172:175]
	ds_read_b64_tr_b16 a[98:99], v1 offset:12288
	ds_read_b64_tr_b16 a[100:101], v2 offset:8192
	v_mfma_f32_16x16x32_bf16 v[188:191], a[108:111], v[60:63], v[188:191]
	v_exp_f32 v39, v39
	v_mfma_f32_16x16x32_bf16 v[188:191], a[76:79], v[56:59], v[188:191]
	ds_read_b64_tr_b16 a[102:103], v2 offset:12288
	v_cvt_pk_bf16_f32 v51, v38, v39
	v_mfma_f32_16x16x32_bf16 v[32:35], a[0:3], a[208:211], -4.0
	v_exp_f32 v40, v40
	v_mfma_f32_16x16x32_bf16 v[32:35], a[4:7], a[212:215], v[32:35]
	ds_read_b64_tr_b16 a[68:69], v2 offset:0
	ds_read_b64_tr_b16 a[70:71], v2 offset:4096
	v_mfma_f32_16x16x32_bf16 v[32:35], a[8:11], a[216:219], v[32:35]
	v_exp_f32 v41, v41
	v_mfma_f32_16x16x32_bf16 v[32:35], a[12:15], a[220:223], v[32:35]
	ds_read_b64_tr_b16 a[72:73], v3 offset:0
	v_cvt_pk_bf16_f32 v52, v40, v41
	v_mfma_f32_16x16x32_bf16 v[36:39], a[28:31], a[220:223], -4.0
	v_exp_f32 v42, v42
	v_mfma_f32_16x16x32_bf16 v[36:39], a[24:27], a[216:219], v[36:39]
	ds_read_b64_tr_b16 a[74:75], v3 offset:4096
	ds_read_b64_tr_b16 a[104:105], v3 offset:8192
	v_mfma_f32_16x16x32_bf16 v[36:39], a[20:23], a[212:215], v[36:39]
	v_exp_f32 v43, v43
	v_mfma_f32_16x16x32_bf16 v[36:39], a[16:19], a[208:211], v[36:39]
	ds_read_b64_tr_b16 a[106:107], v3 offset:12288
	v_cvt_pk_bf16_f32 v53, v42, v43
	v_mfma_f32_16x16x32_bf16 v[204:207], a[80:83], v[56:59], v[204:207]
	v_exp_f32 v44, v44
	v_mfma_f32_16x16x32_bf16 v[204:207], a[112:115], v[60:63], v[204:207]
	ds_read_b64_tr_b16 a[108:109], v4 offset:8192
	ds_read_b64_tr_b16 a[110:111], v4 offset:12288
	v_mfma_f32_16x16x32_bf16 v[220:223], a[116:119], v[60:63], v[220:223]
	v_exp_f32 v45, v45
	v_mfma_f32_16x16x32_bf16 v[220:223], a[84:87], v[56:59], v[220:223]
	ds_read_b64_tr_b16 a[76:77], v4 offset:0
	v_cvt_pk_bf16_f32 v54, v44, v45
	v_mfma_f32_16x16x32_bf16 v[236:239], a[88:91], v[56:59], v[236:239]
	v_exp_f32 v46, v46
	v_mfma_f32_16x16x32_bf16 v[236:239], a[120:123], v[60:63], v[236:239]
	ds_read_b64_tr_b16 a[78:79], v4 offset:4096
	ds_read_b64_tr_b16 a[80:81], v5 offset:0
	v_mfma_f32_16x16x32_bf16 v[252:255], a[124:127], v[60:63], v[252:255]
	v_exp_f32 v47, v47
	v_mfma_f32_16x16x32_bf16 v[252:255], a[92:95], v[56:59], v[252:255]
L_pg12:
	s_cbranch_execz L_touched0
	ds_read_b64_tr_b16 a[82:83], v5 offset:4096
	v_cvt_pk_bf16_f32 v55, v46, v47
	v_mfma_f32_16x16x32_bf16 v[40:43], a[32:35], a[208:211], -4.0
	v_exp_f32 v32, v32
	v_mfma_f32_16x16x32_bf16 v[40:43], a[36:39], a[212:215], v[40:43]
	ds_read_b64_tr_b16 a[112:113], v5 offset:8192
	ds_read_b64_tr_b16 a[114:115], v5 offset:12288
	v_mfma_f32_16x16x32_bf16 v[40:43], a[40:43], a[216:219], v[40:43]
	v_exp_f32 v33, v33
	v_mfma_f32_16x16x32_bf16 v[40:43], a[44:47], a[220:223], v[40:43]
	ds_read_b64_tr_b16 a[116:117], v6 offset:8192
	v_cvt_pk_bf16_f32 v56, v32, v33
	v_mfma_f32_16x16x32_bf16 v[44:47], a[60:63], a[220:223], -4.0
	v_exp_f32 v34, v34
	v_mfma_f32_16x16x32_bf16 v[44:47], a[56:59], a[216:219], v[44:47]
	ds_read_b64_tr_b16 a[118:119], v6 offset:12288
	ds_read_b64_tr_b16 a[84:85], v6 offset:0
	v_mfma_f32_16x16x32_bf16 v[44:47], a[52:55], a[212:215], v[44:47]
	v_exp_f32 v35, v35
	v_mfma_f32_16x16x32_bf16 v[44:47], a[48:51], a[208:211], v[44:47]
	ds_read_b64_tr_b16 a[86:87], v6 offset:4096
	v_cvt_pk_bf16_f32 v57, v34, v35
	v_smfmac_f32_16x16x64_bf16 a[132:135], a[128:131], v[48:55], v31
	s_waitcnt lgkmcnt(7)
	v_mfma_f32_16x16x32_bf16 v[128:131], a[64:67], v[48:51], v[128:131]
	v_exp_f32 v36, v36
	v_mfma_f32_16x16x32_bf16 v[128:131], a[96:99], v[52:55], v[128:131]
	ds_read_b64_tr_b16 a[88:89], v7 offset:0
	ds_read_b64_tr_b16 a[90:91], v7 offset:4096
	v_mfma_f32_16x16x32_bf16 v[144:147], a[100:103], v[52:55], v[144:147]
	v_exp_f32 v37, v37
	v_mfma_f32_16x16x32_bf16 v[144:147], a[68:71], v[48:51], v[144:147]
	ds_read_b64_tr_b16 a[120:121], v7 offset:8192
	v_cvt_pk_bf16_f32 v58, v36, v37
	v_mfma_f32_16x16x32_bf16 v[160:163], a[72:75], v[48:51], v[160:163]
	v_exp_f32 v38, v38
	v_mfma_f32_16x16x32_bf16 v[160:163], a[104:107], v[52:55], v[160:163]
	ds_read_b64_tr_b16 a[122:123], v7 offset:12288
	ds_read_b64_tr_b16 a[124:125], v8 offset:8192
	v_mfma_f32_16x16x32_bf16 v[176:179], a[108:111], v[52:55], v[176:179]
	v_exp_f32 v39, v39
	v_mfma_f32_16x16x32_bf16 v[176:179], a[76:79], v[48:51], v[176:179]
	ds_read_b64_tr_b16 a[126:127], v8 offset:12288
	v_cvt_pk_bf16_f32 v59, v38, v39
	v_mfma_f32_16x16x32_bf16 v[32:35], a[0:3], a[224:227], -4.0
	v_exp_f32 v40, v40
	v_mfma_f32_16x16x32_bf16 v[32:35], a[4:7], a[228:231], v[32:35]
	ds_read_b64_tr_b16 a[92:93], v8 offset:0
	ds_read_b64_tr_b16 a[94:95], v8 offset:4096
	v_mfma_f32_16x16x32_bf16 v[32:35], a[8:11], a[232:235], v[32:35]
	v_exp_f32 v41, v41
	v_mfma_f32_16x16x32_bf16 v[32:35], a[12:15], a[236:239], v[32:35]
	v_cvt_pk_bf16_f32 v60, v40, v41
	v_and_b32 v65, 0xffff0000, v65
	v_mfma_f32_16x16x32_bf16 v[36:39], a[28:31], a[236:239], -4.0
	v_exp_f32 v42, v42
	v_mfma_f32_16x16x32_bf16 v[36:39], a[24:27], a[232:235], v[36:39]
	v_fma_f32 v30, v30, v17, v22
	v_fma_f32 v65, v65, v17, v22
	v_mfma_f32_16x16x32_bf16 v[36:39], a[20:23], a[228:231], v[36:39]
	v_exp_f32 v43, v43
	v_mfma_f32_16x16x32_bf16 v[36:39], a[16:19], a[224:227], v[36:39]
	s_waitcnt lgkmcnt(3)
	v_cvt_pk_bf16_f32 v61, v42, v43
	v_cvt_pk_bf16_f32 v65, v30, v65
	v_mfma_f32_16x16x32_bf16 v[192:195], a[80:83], v[48:51], v[192:195]
	v_exp_f32 v44, v44
	v_mfma_f32_16x16x32_bf16 v[192:195], a[112:115], v[52:55], v[192:195]
	buffer_load_dwordx4 v[124:127], v13, s[48:51], s71 offen offset:3072 sc1
	v_mfma_f32_16x16x32_bf16 v[208:211], a[116:119], v[52:55], v[208:211]
	v_exp_f32 v45, v45
	v_mfma_f32_16x16x32_bf16 v[208:211], a[84:87], v[48:51], v[208:211]
	v_cvt_pk_bf16_f32 v62, v44, v45
	v_lshlrev_b32 v30, 16, v66
	v_mfma_f32_16x16x32_bf16 v[224:227], a[88:91], v[48:51], v[224:227]
	v_exp_f32 v46, v46
	v_mfma_f32_16x16x32_bf16 v[224:227], a[120:123], v[52:55], v[224:227]
	s_waitcnt lgkmcnt(0)
	v_and_b32 v66, 0xffff0000, v66
	v_fma_f32 v30, v30, v17, v22
	v_mfma_f32_16x16x32_bf16 v[240:243], a[124:127], v[52:55], v[240:243]
	s_waitcnt vmcnt(6)
	v_exp_f32 v47, v47
	v_mfma_f32_16x16x32_bf16 v[240:243], a[92:95], v[48:51], v[240:243]
	s_barrier
	v_cvt_pk_bf16_f32 v63, v46, v47
	v_fma_f32 v66, v66, v17, v22
	v_mfma_f32_16x16x32_bf16 v[40:43], a[32:35], a[224:227], -4.0
	s_add_u32 m0, s65, 0x0
	v_exp_f32 v32, v32
	v_mfma_f32_16x16x32_bf16 v[40:43], a[36:39], a[228:231], v[40:43]
	buffer_load_dwordx4 v18, s[8:11], s68 offen lds
	v_mfma_f32_16x16x32_bf16 v[40:43], a[40:43], a[232:235], v[40:43]
	v_exp_f32 v33, v33
	v_mfma_f32_16x16x32_bf16 v[40:43], a[44:47], a[236:239], v[40:43]
	v_cvt_pk_bf16_f32 v48, v32, v33
	v_cvt_pk_bf16_f32 v66, v30, v66
	v_mfma_f32_16x16x32_bf16 v[44:47], a[60:63], a[236:239], -4.0
	v_exp_f32 v34, v34
	v_mfma_f32_16x16x32_bf16 v[44:47], a[56:59], a[232:235], v[44:47]
	buffer_load_dwordx4 v19, s[8:11], s68 offen offset:1024 lds
	v_mfma_f32_16x16x32_bf16 v[44:47], a[52:55], a[228:231], v[44:47]
	s_add_u32 s68, s68, 0x2000
	v_exp_f32 v35, v35
	v_mfma_f32_16x16x32_bf16 v[44:47], a[48:51], a[224:227], v[44:47]
	s_and_b32 s68, s68, 0x7ffff
	v_cvt_pk_bf16_f32 v49, v34, v35
	v_lshlrev_b32 v30, 16, v67
	v_smfmac_f32_16x16x64_bf16 a[132:135], a[168:171], v[56:63], v31
	v_mfma_f32_16x16x32_bf16 v[132:135], a[64:67], v[56:59], v[132:135]
	s_add_u32 m0, s65, 0x2000
	v_exp_f32 v36, v36
	v_mfma_f32_16x16x32_bf16 v[132:135], a[96:99], v[60:63], v[132:135]
	buffer_load_dwordx4 v18, s[8:11], s68 offen lds
	v_mfma_f32_16x16x32_bf16 v[148:151], a[100:103], v[60:63], v[148:151]
	v_exp_f32 v37, v37
	v_mfma_f32_16x16x32_bf16 v[148:151], a[68:71], v[56:59], v[148:151]
	v_cvt_pk_bf16_f32 v50, v36, v37
	v_and_b32 v67, 0xffff0000, v67
	v_mfma_f32_16x16x32_bf16 v[164:167], a[72:75], v[56:59], v[164:167]
	v_exp_f32 v38, v38
	v_mfma_f32_16x16x32_bf16 v[164:167], a[104:107], v[60:63], v[164:167]
	buffer_load_dwordx4 v19, s[8:11], s68 offen offset:1024 lds
	v_mfma_f32_16x16x32_bf16 v[180:183], a[108:111], v[60:63], v[180:183]
	s_add_u32 s68, s68, 0x2000
	v_exp_f32 v39, v39
	v_mfma_f32_16x16x32_bf16 v[180:183], a[76:79], v[56:59], v[180:183]
	s_and_b32 s68, s68, 0x7ffff
	v_cvt_pk_bf16_f32 v51, v38, v39
	v_fma_f32 v30, v30, v17, v22
	v_mfma_f32_16x16x32_bf16 v[32:35], a[0:3], a[240:243], -4.0
	s_add_u32 m0, s65, 0x8000
	v_exp_f32 v40, v40
	v_mfma_f32_16x16x32_bf16 v[32:35], a[4:7], a[244:247], v[32:35]
	buffer_load_dwordx4 v20, s[12:15], s69 offen lds
	v_mfma_f32_16x16x32_bf16 v[32:35], a[8:11], a[248:251], v[32:35]
	v_exp_f32 v41, v41
	v_mfma_f32_16x16x32_bf16 v[32:35], a[12:15], a[252:255], v[32:35]
	ds_read_b128 a[0:3], v9 offset:16384
	v_cvt_pk_bf16_f32 v52, v40, v41
	v_mfma_f32_16x16x32_bf16 v[36:39], a[28:31], a[252:255], -4.0
	v_exp_f32 v42, v42
	v_mfma_f32_16x16x32_bf16 v[36:39], a[24:27], a[248:251], v[36:39]
	buffer_load_dwordx4 v21, s[12:15], s69 offen offset:1024 lds
	v_mfma_f32_16x16x32_bf16 v[36:39], a[20:23], a[244:247], v[36:39]
	v_exp_f32 v43, v43
	v_mfma_f32_16x16x32_bf16 v[36:39], a[16:19], a[240:243], v[36:39]
	ds_read_b128 a[4:7], v10 offset:16384
	v_cvt_pk_bf16_f32 v53, v42, v43
	v_mfma_f32_16x16x32_bf16 v[196:199], a[80:83], v[56:59], v[196:199]
	v_exp_f32 v44, v44
	v_mfma_f32_16x16x32_bf16 v[196:199], a[112:115], v[60:63], v[196:199]
	ds_read_b128 a[8:11], v11 offset:16384
	ds_read_b128 a[12:15], v12 offset:16384
	v_mfma_f32_16x16x32_bf16 v[212:215], a[116:119], v[60:63], v[212:215]
	s_add_u32 s69, s69, 0x2000
	v_exp_f32 v45, v45
	v_mfma_f32_16x16x32_bf16 v[212:215], a[84:87], v[56:59], v[212:215]
	s_and_b32 s69, s69, 0x7ffff
	ds_read_b128 a[28:31], v12 offset:20480
	v_cvt_pk_bf16_f32 v54, v44, v45
	v_mfma_f32_16x16x32_bf16 v[228:231], a[88:91], v[56:59], v[228:231]
	s_add_u32 m0, s65, 0xa000
	v_exp_f32 v46, v46
	v_mfma_f32_16x16x32_bf16 v[228:231], a[120:123], v[60:63], v[228:231]
	buffer_load_dwordx4 v20, s[12:15], s69 offen lds
	v_mfma_f32_16x16x32_bf16 v[244:247], a[124:127], v[60:63], v[244:247]
	v_exp_f32 v47, v47
	v_mfma_f32_16x16x32_bf16 v[244:247], a[92:95], v[56:59], v[244:247]
	ds_read_b128 a[24:27], v11 offset:20480
	v_cvt_pk_bf16_f32 v55, v46, v47
	v_mfma_f32_16x16x32_bf16 v[40:43], a[32:35], a[240:243], -4.0
	s_add_u32 m0, s65, 0xa000
	v_exp_f32 v32, v32
	v_mfma_f32_16x16x32_bf16 v[40:43], a[36:39], a[244:247], v[40:43]
	buffer_load_dwordx4 v21, s[12:15], s69 offen offset:1024 lds
	v_mfma_f32_16x16x32_bf16 v[40:43], a[40:43], a[248:251], v[40:43]
	v_exp_f32 v33, v33
	v_mfma_f32_16x16x32_bf16 v[40:43], a[44:47], a[252:255], v[40:43]
	s_add_u32 s69, s69, 0x2000
	ds_read_b128 a[20:23], v10 offset:20480
	v_cvt_pk_bf16_f32 v56, v32, v33
	v_mfma_f32_16x16x32_bf16 v[44:47], a[60:63], a[252:255], -4.0
	s_and_b32 s69, s69, 0x7ffff
	v_exp_f32 v34, v34
	v_mfma_f32_16x16x32_bf16 v[44:47], a[56:59], a[248:251], v[44:47]
	buffer_load_dword v25, v24, s[44:47], 0 offen sc1
	v_mfma_f32_16x16x32_bf16 v[44:47], a[52:55], a[244:247], v[44:47]
	v_exp_f32 v35, v35
	v_mfma_f32_16x16x32_bf16 v[44:47], a[48:51], a[240:243], v[44:47]
	ds_read_b128 a[16:19], v9 offset:20480
	v_cvt_pk_bf16_f32 v57, v34, v35
	v_smfmac_f32_16x16x64_bf16 a[136:139], a[128:131], v[48:55], v31
	v_mfma_f32_16x16x32_bf16 v[136:139], a[64:67], v[48:51], v[136:139]
	v_exp_f32 v36, v36
	v_mfma_f32_16x16x32_bf16 v[136:139], a[96:99], v[52:55], v[136:139]
	ds_read_b128 a[32:35], v9 offset:24576
	ds_read_b128 a[36:39], v10 offset:24576
	v_mfma_f32_16x16x32_bf16 v[152:155], a[100:103], v[52:55], v[152:155]
	v_exp_f32 v37, v37
	v_mfma_f32_16x16x32_bf16 v[152:155], a[68:71], v[48:51], v[152:155]
	ds_read_b128 a[40:43], v11 offset:24576
	v_cvt_pk_bf16_f32 v58, v36, v37
	v_mfma_f32_16x16x32_bf16 v[168:171], a[72:75], v[48:51], v[168:171]
	v_exp_f32 v38, v38
	v_mfma_f32_16x16x32_bf16 v[168:171], a[104:107], v[52:55], v[168:171]
	ds_read_b128 a[44:47], v12 offset:24576
	ds_read_b128 a[60:63], v12 offset:28672
	v_mfma_f32_16x16x32_bf16 v[184:187], a[108:111], v[52:55], v[184:187]
	v_exp_f32 v39, v39
	v_mfma_f32_16x16x32_bf16 v[184:187], a[76:79], v[48:51], v[184:187]
	s_waitcnt lgkmcnt(6)
	ds_read_b128 a[56:59], v11 offset:28672
	v_cvt_pk_bf16_f32 v59, v38, v39
	v_mfma_f32_16x16x32_bf16 v[32:35], a[0:3], a[192:195], -4.0
	v_exp_f32 v40, v40
	v_mfma_f32_16x16x32_bf16 v[32:35], a[4:7], a[196:199], v[32:35]
	ds_read_b128 a[52:55], v10 offset:28672
	ds_read_b128 a[48:51], v9 offset:28672
	v_mfma_f32_16x16x32_bf16 v[32:35], a[8:11], a[200:203], v[32:35]
	v_exp_f32 v41, v41
	v_mfma_f32_16x16x32_bf16 v[32:35], a[12:15], a[204:207], v[32:35]
	v_cvt_pk_bf16_f32 v60, v40, v41
	v_fma_f32 v67, v67, v17, v22
	v_mfma_f32_16x16x32_bf16 v[36:39], a[28:31], a[204:207], -4.0
	v_exp_f32 v42, v42
	v_mfma_f32_16x16x32_bf16 v[36:39], a[24:27], a[200:203], v[36:39]
	v_cvt_pk_bf16_f32 v67, v30, v67
	v_lshlrev_b32 v30, 16, v68
	v_mfma_f32_16x16x32_bf16 v[36:39], a[20:23], a[196:199], v[36:39]
	s_waitcnt lgkmcnt(5)
	v_exp_f32 v43, v43
	v_mfma_f32_16x16x32_bf16 v[36:39], a[16:19], a[192:195], v[36:39]
	v_cvt_pk_bf16_f32 v61, v42, v43
	v_and_b32 v68, 0xffff0000, v68
	v_mfma_f32_16x16x32_bf16 v[200:203], a[80:83], v[48:51], v[200:203]
	v_exp_f32 v44, v44
	v_mfma_f32_16x16x32_bf16 v[200:203], a[112:115], v[52:55], v[200:203]
	v_fma_f32 v30, v30, v17, v22
	v_fma_f32 v68, v68, v17, v22
	v_mfma_f32_16x16x32_bf16 v[216:219], a[116:119], v[52:55], v[216:219]
	v_exp_f32 v45, v45
	v_mfma_f32_16x16x32_bf16 v[216:219], a[84:87], v[48:51], v[216:219]
	v_cvt_pk_bf16_f32 v62, v44, v45
	v_cvt_pk_bf16_f32 v68, v30, v68
	v_mfma_f32_16x16x32_bf16 v[232:235], a[88:91], v[48:51], v[232:235]
	v_exp_f32 v46, v46
	v_mfma_f32_16x16x32_bf16 v[232:235], a[120:123], v[52:55], v[232:235]
	v_lshlrev_b32 v30, 16, v69
	v_and_b32 v69, 0xffff0000, v69
	v_mfma_f32_16x16x32_bf16 v[248:251], a[124:127], v[52:55], v[248:251]
	v_exp_f32 v47, v47
	v_mfma_f32_16x16x32_bf16 v[248:251], a[92:95], v[48:51], v[248:251]
	v_cvt_pk_bf16_f32 v63, v46, v47
	v_fma_f32 v30, v30, v17, v22
	v_mfma_f32_16x16x32_bf16 v[40:43], a[32:35], a[192:195], -4.0
	v_exp_f32 v32, v32
	v_mfma_f32_16x16x32_bf16 v[40:43], a[36:39], a[196:199], v[40:43]
	v_fma_f32 v69, v69, v17, v22
	v_cvt_pk_bf16_f32 v69, v30, v69
	v_mfma_f32_16x16x32_bf16 v[40:43], a[40:43], a[200:203], v[40:43]
	s_waitcnt lgkmcnt(0)
	v_exp_f32 v33, v33
	v_mfma_f32_16x16x32_bf16 v[40:43], a[44:47], a[204:207], v[40:43]
	v_cvt_pk_bf16_f32 v48, v32, v33
	v_lshlrev_b32 v30, 16, v70
	v_mfma_f32_16x16x32_bf16 v[44:47], a[60:63], a[204:207], -4.0
	v_exp_f32 v34, v34
	v_mfma_f32_16x16x32_bf16 v[44:47], a[56:59], a[200:203], v[44:47]
	v_and_b32 v70, 0xffff0000, v70
	v_fma_f32 v30, v30, v17, v22
	v_mfma_f32_16x16x32_bf16 v[44:47], a[52:55], a[196:199], v[44:47]
	v_exp_f32 v35, v35
	v_mfma_f32_16x16x32_bf16 v[44:47], a[48:51], a[192:195], v[44:47]
	v_cvt_pk_bf16_f32 v49, v34, v35
	v_fma_f32 v70, v70, v17, v22
	v_smfmac_f32_16x16x64_bf16 a[136:139], a[168:171], v[56:63], v31
	v_mfma_f32_16x16x32_bf16 v[140:143], a[64:67], v[56:59], v[140:143]
	v_exp_f32 v36, v36
	v_mfma_f32_16x16x32_bf16 v[140:143], a[96:99], v[60:63], v[140:143]
	ds_read_b64_tr_b16 a[64:65], v1 offset:16384
	ds_read_b64_tr_b16 a[66:67], v1 offset:20480
	v_mfma_f32_16x16x32_bf16 v[156:159], a[100:103], v[60:63], v[156:159]
	v_exp_f32 v37, v37
	v_mfma_f32_16x16x32_bf16 v[156:159], a[68:71], v[56:59], v[156:159]
	ds_read_b64_tr_b16 a[96:97], v1 offset:24576
	v_cvt_pk_bf16_f32 v50, v36, v37
	v_mfma_f32_16x16x32_bf16 v[172:175], a[72:75], v[56:59], v[172:175]
	v_exp_f32 v38, v38
	v_mfma_f32_16x16x32_bf16 v[172:175], a[104:107], v[60:63], v[172:175]
	ds_read_b64_tr_b16 a[98:99], v1 offset:28672
	ds_read_b64_tr_b16 a[100:101], v2 offset:24576
	v_mfma_f32_16x16x32_bf16 v[188:191], a[108:111], v[60:63], v[188:191]
	v_exp_f32 v39, v39
	v_mfma_f32_16x16x32_bf16 v[188:191], a[76:79], v[56:59], v[188:191]
	ds_read_b64_tr_b16 a[102:103], v2 offset:28672
	v_cvt_pk_bf16_f32 v51, v38, v39
	v_mfma_f32_16x16x32_bf16 v[32:35], a[0:3], a[208:211], -4.0
	v_exp_f32 v40, v40
	v_mfma_f32_16x16x32_bf16 v[32:35], a[4:7], a[212:215], v[32:35]
	ds_read_b64_tr_b16 a[68:69], v2 offset:16384
	ds_read_b64_tr_b16 a[70:71], v2 offset:20480
	v_mfma_f32_16x16x32_bf16 v[32:35], a[8:11], a[216:219], v[32:35]
	v_exp_f32 v41, v41
	v_mfma_f32_16x16x32_bf16 v[32:35], a[12:15], a[220:223], v[32:35]
	ds_read_b64_tr_b16 a[72:73], v3 offset:16384
	v_cvt_pk_bf16_f32 v52, v40, v41
	v_mfma_f32_16x16x32_bf16 v[36:39], a[28:31], a[220:223], -4.0
	v_exp_f32 v42, v42
	v_mfma_f32_16x16x32_bf16 v[36:39], a[24:27], a[216:219], v[36:39]
	ds_read_b64_tr_b16 a[74:75], v3 offset:20480
	ds_read_b64_tr_b16 a[104:105], v3 offset:24576
	v_mfma_f32_16x16x32_bf16 v[36:39], a[20:23], a[212:215], v[36:39]
	v_exp_f32 v43, v43
	v_mfma_f32_16x16x32_bf16 v[36:39], a[16:19], a[208:211], v[36:39]
	ds_read_b64_tr_b16 a[106:107], v3 offset:28672
	v_cvt_pk_bf16_f32 v53, v42, v43
	v_mfma_f32_16x16x32_bf16 v[204:207], a[80:83], v[56:59], v[204:207]
	v_exp_f32 v44, v44
	v_mfma_f32_16x16x32_bf16 v[204:207], a[112:115], v[60:63], v[204:207]
	ds_read_b64_tr_b16 a[108:109], v4 offset:24576
	ds_read_b64_tr_b16 a[110:111], v4 offset:28672
	v_mfma_f32_16x16x32_bf16 v[220:223], a[116:119], v[60:63], v[220:223]
	v_exp_f32 v45, v45
	v_mfma_f32_16x16x32_bf16 v[220:223], a[84:87], v[56:59], v[220:223]
	ds_read_b64_tr_b16 a[76:77], v4 offset:16384
	v_cvt_pk_bf16_f32 v54, v44, v45
	v_mfma_f32_16x16x32_bf16 v[236:239], a[88:91], v[56:59], v[236:239]
	v_exp_f32 v46, v46
	v_mfma_f32_16x16x32_bf16 v[236:239], a[120:123], v[60:63], v[236:239]
	ds_read_b64_tr_b16 a[78:79], v4 offset:20480
	ds_read_b64_tr_b16 a[80:81], v5 offset:16384
	v_mfma_f32_16x16x32_bf16 v[252:255], a[124:127], v[60:63], v[252:255]
	v_exp_f32 v47, v47
	v_mfma_f32_16x16x32_bf16 v[252:255], a[92:95], v[56:59], v[252:255]
	ds_read_b64_tr_b16 a[82:83], v5 offset:20480
	v_cvt_pk_bf16_f32 v55, v46, v47
	v_mfma_f32_16x16x32_bf16 v[40:43], a[32:35], a[208:211], -4.0
	v_exp_f32 v32, v32
	v_mfma_f32_16x16x32_bf16 v[40:43], a[36:39], a[212:215], v[40:43]
	ds_read_b64_tr_b16 a[112:113], v5 offset:24576
	ds_read_b64_tr_b16 a[114:115], v5 offset:28672
	v_mfma_f32_16x16x32_bf16 v[40:43], a[40:43], a[216:219], v[40:43]
	v_exp_f32 v33, v33
	v_mfma_f32_16x16x32_bf16 v[40:43], a[44:47], a[220:223], v[40:43]
	ds_read_b64_tr_b16 a[116:117], v6 offset:24576
	v_cvt_pk_bf16_f32 v56, v32, v33
	v_mfma_f32_16x16x32_bf16 v[44:47], a[60:63], a[220:223], -4.0
	v_exp_f32 v34, v34
	v_mfma_f32_16x16x32_bf16 v[44:47], a[56:59], a[216:219], v[44:47]
	ds_read_b64_tr_b16 a[118:119], v6 offset:28672
	ds_read_b64_tr_b16 a[84:85], v6 offset:16384
	v_mfma_f32_16x16x32_bf16 v[44:47], a[52:55], a[212:215], v[44:47]
	v_exp_f32 v35, v35
	v_mfma_f32_16x16x32_bf16 v[44:47], a[48:51], a[208:211], v[44:47]
	ds_read_b64_tr_b16 a[86:87], v6 offset:20480
	v_cvt_pk_bf16_f32 v57, v34, v35
	v_smfmac_f32_16x16x64_bf16 a[132:135], a[128:131], v[48:55], v31
	s_waitcnt lgkmcnt(7)
	v_mfma_f32_16x16x32_bf16 v[128:131], a[64:67], v[48:51], v[128:131]
	v_exp_f32 v36, v36
	v_mfma_f32_16x16x32_bf16 v[128:131], a[96:99], v[52:55], v[128:131]
	ds_read_b64_tr_b16 a[88:89], v7 offset:16384
	ds_read_b64_tr_b16 a[90:91], v7 offset:20480
	v_mfma_f32_16x16x32_bf16 v[144:147], a[100:103], v[52:55], v[144:147]
	v_exp_f32 v37, v37
	v_mfma_f32_16x16x32_bf16 v[144:147], a[68:71], v[48:51], v[144:147]
	ds_read_b64_tr_b16 a[120:121], v7 offset:24576
	v_cvt_pk_bf16_f32 v58, v36, v37
	v_mfma_f32_16x16x32_bf16 v[160:163], a[72:75], v[48:51], v[160:163]
	v_exp_f32 v38, v38
	v_mfma_f32_16x16x32_bf16 v[160:163], a[104:107], v[52:55], v[160:163]
	ds_read_b64_tr_b16 a[122:123], v7 offset:28672
	ds_read_b64_tr_b16 a[124:125], v8 offset:24576
	v_mfma_f32_16x16x32_bf16 v[176:179], a[108:111], v[52:55], v[176:179]
	v_exp_f32 v39, v39
	v_mfma_f32_16x16x32_bf16 v[176:179], a[76:79], v[48:51], v[176:179]
	ds_read_b64_tr_b16 a[126:127], v8 offset:28672
	v_cvt_pk_bf16_f32 v59, v38, v39
	v_mfma_f32_16x16x32_bf16 v[32:35], a[0:3], a[224:227], -4.0
	v_exp_f32 v40, v40
	v_mfma_f32_16x16x32_bf16 v[32:35], a[4:7], a[228:231], v[32:35]
	ds_read_b64_tr_b16 a[92:93], v8 offset:16384
	ds_read_b64_tr_b16 a[94:95], v8 offset:20480
	v_mfma_f32_16x16x32_bf16 v[32:35], a[8:11], a[232:235], v[32:35]
	v_exp_f32 v41, v41
	v_mfma_f32_16x16x32_bf16 v[32:35], a[12:15], a[236:239], v[32:35]
	v_cvt_pk_bf16_f32 v60, v40, v41
	v_cvt_pk_bf16_f32 v70, v30, v70
	v_mfma_f32_16x16x32_bf16 v[36:39], a[28:31], a[236:239], -4.0
	v_exp_f32 v42, v42
	v_mfma_f32_16x16x32_bf16 v[36:39], a[24:27], a[232:235], v[36:39]
	v_lshlrev_b32 v30, 16, v71
	v_and_b32 v71, 0xffff0000, v71
	v_mfma_f32_16x16x32_bf16 v[36:39], a[20:23], a[228:231], v[36:39]
	v_exp_f32 v43, v43
	v_mfma_f32_16x16x32_bf16 v[36:39], a[16:19], a[224:227], v[36:39]
	s_waitcnt lgkmcnt(3)
	v_cvt_pk_bf16_f32 v61, v42, v43
	v_fma_f32 v30, v30, v17, v22
	v_mfma_f32_16x16x32_bf16 v[192:195], a[80:83], v[48:51], v[192:195]
	v_exp_f32 v44, v44
	v_mfma_f32_16x16x32_bf16 v[192:195], a[112:115], v[52:55], v[192:195]
	v_fma_f32 v71, v71, v17, v22
	v_cvt_pk_bf16_f32 v71, v30, v71
	v_mfma_f32_16x16x32_bf16 v[208:211], a[116:119], v[52:55], v[208:211]
	v_exp_f32 v45, v45
	v_mfma_f32_16x16x32_bf16 v[208:211], a[84:87], v[48:51], v[208:211]
	v_cvt_pk_bf16_f32 v62, v44, v45
	v_lshlrev_b32 v30, 16, v72
	v_mfma_f32_16x16x32_bf16 v[224:227], a[88:91], v[48:51], v[224:227]
	v_exp_f32 v46, v46
	v_mfma_f32_16x16x32_bf16 v[224:227], a[120:123], v[52:55], v[224:227]
	s_waitcnt vmcnt(0)
	v_cmp_eq_u32 vcc, 0, v25
	s_cbranch_vccnz L_spin4
L_back4:
	v_readfirstlane_b32 s84, v25
	v_and_b32 v28, 64, v14
	s_sub_u32 s84, s84, 1
	s_and_b32 s84, s84, 7
	s_lshl_b32 s72, s84, 9
	s_mul_i32 s73, s84, 384
	s_add_u32 s73, s73, 640
	s_min_u32 s72, s72, s73
	s_add_u32 s94, s94, s72
	s_lshl_b32 s74, s72, 9
	v_add_u32 v16, s74, v14
	s_lshr_b32 s75, s62, 1
	s_sub_u32 s75, s75, s62
	s_add_u32 s75, s75, 3
	s_lshl_b32 s73, s62, 6
	s_cmp_ge_u32 s84, 7
	s_cselect_b32 s75, 1791, s75
	s_cselect_b32 s95, 2, 3
	s_cselect_b32 s97, 2, 1
	s_cmp_ge_u32 s84, 5
	s_cselect_b32 s75, s75, 0
	s_cselect_b32 s95, s95, 4
	s_cselect_b32 s73, s73, 0
	v_mad_u32_u24 v15, s75, v28, v15
	s_mul_i32 s95, s95, s63
	s_lshl_b32 s95, s95, 9
	s_add_u32 s95, s95, s74
	s_mul_i32 s97, s97, 0x1c000
	s_sub_u32 s72, s72, s73
	v_add_u32 v15, s72, v15
	s_sub_u32 s74, s84, s61
	s_lshl_b32 s74, s74, 11
	s_add_u32 s85, s88, s74
	v_add_u32 v26, s93, v13
	v_min_u32 v26, s58, v26
	v_mov_b32 v27, 0
	v_lshl_add_u64 v[26:27], v[26:27], 0, s[56:57]
	s_waitcnt lgkmcnt(2)
	v_mfma_f32_16x16x32_bf16 v[240:243], a[124:127], v[52:55], v[240:243]
	s_waitcnt lgkmcnt(0)
	v_exp_f32 v47, v47
	v_mfma_f32_16x16x32_bf16 v[240:243], a[92:95], v[48:51], v[240:243]
	s_barrier
	v_cvt_pk_bf16_f32 v63, v46, v47
	v_and_b32 v72, 0xffff0000, v72
	v_mfma_f32_16x16x32_bf16 v[40:43], a[32:35], a[224:227], -4.0
	s_add_u32 m0, s65, 0x4000
	v_exp_f32 v32, v32
	v_mfma_f32_16x16x32_bf16 v[40:43], a[36:39], a[228:231], v[40:43]
	buffer_load_dwordx4 v18, s[8:11], s68 offen lds
	v_mfma_f32_16x16x32_bf16 v[40:43], a[40:43], a[232:235], v[40:43]
	v_exp_f32 v33, v33
	v_mfma_f32_16x16x32_bf16 v[40:43], a[44:47], a[236:239], v[40:43]
	v_cvt_pk_bf16_f32 v48, v32, v33
	v_fma_f32 v30, v30, v17, v22
	v_mfma_f32_16x16x32_bf16 v[44:47], a[60:63], a[236:239], -4.0
	v_exp_f32 v34, v34
	v_mfma_f32_16x16x32_bf16 v[44:47], a[56:59], a[232:235], v[44:47]
	buffer_load_dwordx4 v19, s[8:11], s68 offen offset:1024 lds
	v_mfma_f32_16x16x32_bf16 v[44:47], a[52:55], a[228:231], v[44:47]
	s_add_u32 s68, s68, 0x2000
	v_exp_f32 v35, v35
	v_mfma_f32_16x16x32_bf16 v[44:47], a[48:51], a[224:227], v[44:47]
	s_and_b32 s68, s68, 0x7ffff
	v_cvt_pk_bf16_f32 v49, v34, v35
	v_fma_f32 v72, v72, v17, v22
	v_smfmac_f32_16x16x64_bf16 a[132:135], a[168:171], v[56:63], v31
	v_mfma_f32_16x16x32_bf16 v[132:135], a[64:67], v[56:59], v[132:135]
	s_add_u32 m0, s65, 0x6000
	v_exp_f32 v36, v36
	v_mfma_f32_16x16x32_bf16 v[132:135], a[96:99], v[60:63], v[132:135]
	buffer_load_dwordx4 v18, s[8:11], s68 offen lds
	v_mfma_f32_16x16x32_bf16 v[148:151], a[100:103], v[60:63], v[148:151]
	v_exp_f32 v37, v37
	v_mfma_f32_16x16x32_bf16 v[148:151], a[68:71], v[56:59], v[148:151]
	v_cvt_pk_bf16_f32 v50, v36, v37
	v_cvt_pk_bf16_f32 v72, v30, v72
	v_mfma_f32_16x16x32_bf16 v[164:167], a[72:75], v[56:59], v[164:167]
	v_exp_f32 v38, v38
	v_mfma_f32_16x16x32_bf16 v[164:167], a[104:107], v[60:63], v[164:167]
	buffer_load_dwordx4 v19, s[8:11], s68 offen offset:1024 lds
	v_mfma_f32_16x16x32_bf16 v[180:183], a[108:111], v[60:63], v[180:183]
	s_add_u32 s68, s68, 0x2000
	v_exp_f32 v39, v39
	v_mfma_f32_16x16x32_bf16 v[180:183], a[76:79], v[56:59], v[180:183]
	s_and_b32 s68, s68, 0x7ffff
	v_cvt_pk_bf16_f32 v51, v38, v39
	v_lshlrev_b32 v30, 16, v73
	v_mfma_f32_16x16x32_bf16 v[32:35], a[0:3], a[240:243], -4.0
	s_add_u32 m0, s65, 0xc000
	v_exp_f32 v40, v40
	v_mfma_f32_16x16x32_bf16 v[32:35], a[4:7], a[244:247], v[32:35]
	buffer_load_dwordx4 v20, s[12:15], s69 offen lds
	v_mfma_f32_16x16x32_bf16 v[32:35], a[8:11], a[248:251], v[32:35]
	v_exp_f32 v41, v41
	v_mfma_f32_16x16x32_bf16 v[32:35], a[12:15], a[252:255], v[32:35]
	ds_read_b128 a[0:3], v9 offset:0
	v_cvt_pk_bf16_f32 v52, v40, v41
	v_mfma_f32_16x16x32_bf16 v[36:39], a[28:31], a[252:255], -4.0
	v_exp_f32 v42, v42
	v_mfma_f32_16x16x32_bf16 v[36:39], a[24:27], a[248:251], v[36:39]
	buffer_load_dwordx4 v21, s[12:15], s69 offen offset:1024 lds
	v_mfma_f32_16x16x32_bf16 v[36:39], a[20:23], a[244:247], v[36:39]
	v_exp_f32 v43, v43
	v_mfma_f32_16x16x32_bf16 v[36:39], a[16:19], a[240:243], v[36:39]
	ds_read_b128 a[4:7], v10 offset:0
	v_cvt_pk_bf16_f32 v53, v42, v43
	v_mfma_f32_16x16x32_bf16 v[196:199], a[80:83], v[56:59], v[196:199]
	v_exp_f32 v44, v44
	v_mfma_f32_16x16x32_bf16 v[196:199], a[112:115], v[60:63], v[196:199]
	ds_read_b128 a[8:11], v11 offset:0
	ds_read_b128 a[12:15], v12 offset:0
	v_mfma_f32_16x16x32_bf16 v[212:215], a[116:119], v[60:63], v[212:215]
	s_add_u32 s69, s69, 0x2000
	v_exp_f32 v45, v45
	v_mfma_f32_16x16x32_bf16 v[212:215], a[84:87], v[56:59], v[212:215]
	s_and_b32 s69, s69, 0x7ffff
	ds_read_b128 a[28:31], v12 offset:4096
	v_cvt_pk_bf16_f32 v54, v44, v45
	v_mfma_f32_16x16x32_bf16 v[228:231], a[88:91], v[56:59], v[228:231]
	s_add_u32 m0, s65, 0xe000
	v_exp_f32 v46, v46
	v_mfma_f32_16x16x32_bf16 v[228:231], a[120:123], v[60:63], v[228:231]
	buffer_load_dwordx4 v20, s[12:15], s69 offen lds
	v_mfma_f32_16x16x32_bf16 v[244:247], a[124:127], v[60:63], v[244:247]
	v_exp_f32 v47, v47
	v_mfma_f32_16x16x32_bf16 v[244:247], a[92:95], v[56:59], v[244:247]
	ds_read_b128 a[24:27], v11 offset:4096
	v_cvt_pk_bf16_f32 v55, v46, v47
	v_mfma_f32_16x16x32_bf16 v[40:43], a[32:35], a[240:243], -4.0
	s_add_u32 m0, s65, 0xe000
	v_exp_f32 v32, v32
	v_mfma_f32_16x16x32_bf16 v[40:43], a[36:39], a[244:247], v[40:43]
	buffer_load_dwordx4 v21, s[12:15], s69 offen offset:1024 lds
	v_mfma_f32_16x16x32_bf16 v[40:43], a[40:43], a[248:251], v[40:43]
	v_exp_f32 v33, v33
	v_mfma_f32_16x16x32_bf16 v[40:43], a[44:47], a[252:255], v[40:43]
	s_add_u32 s69, s69, 0x2000
	ds_read_b128 a[20:23], v10 offset:4096
	v_cvt_pk_bf16_f32 v56, v32, v33
	v_mfma_f32_16x16x32_bf16 v[44:47], a[60:63], a[252:255], -4.0
	s_and_b32 s69, s69, 0x7ffff
	v_exp_f32 v34, v34
	v_mfma_f32_16x16x32_bf16 v[44:47], a[56:59], a[248:251], v[44:47]
	buffer_load_dwordx4 a[152:155], v29, s[32:35], s94 offen offset:0
	v_mfma_f32_16x16x32_bf16 v[44:47], a[52:55], a[244:247], v[44:47]
	v_exp_f32 v35, v35
	v_mfma_f32_16x16x32_bf16 v[44:47], a[48:51], a[240:243], v[44:47]
	ds_read_b128 a[16:19], v9 offset:4096
	v_cvt_pk_bf16_f32 v57, v34, v35
	v_smfmac_f32_16x16x64_bf16 a[136:139], a[128:131], v[48:55], v31
	v_mfma_f32_16x16x32_bf16 v[136:139], a[64:67], v[48:51], v[136:139]
	v_exp_f32 v36, v36
	v_mfma_f32_16x16x32_bf16 v[136:139], a[96:99], v[52:55], v[136:139]
	ds_read_b128 a[32:35], v9 offset:8192
	ds_read_b128 a[36:39], v10 offset:8192
	v_mfma_f32_16x16x32_bf16 v[152:155], a[100:103], v[52:55], v[152:155]
	v_exp_f32 v37, v37
	v_mfma_f32_16x16x32_bf16 v[152:155], a[68:71], v[48:51], v[152:155]
	ds_read_b128 a[40:43], v11 offset:8192
	v_cvt_pk_bf16_f32 v58, v36, v37
	v_mfma_f32_16x16x32_bf16 v[168:171], a[72:75], v[48:51], v[168:171]
	v_exp_f32 v38, v38
	v_mfma_f32_16x16x32_bf16 v[168:171], a[104:107], v[52:55], v[168:171]
	buffer_load_dwordx4 a[152:155], v29, s[32:35], s94 offen offset:256
	v_mfma_f32_16x16x32_bf16 v[184:187], a[108:111], v[52:55], v[184:187]
	v_exp_f32 v39, v39
	v_mfma_f32_16x16x32_bf16 v[184:187], a[76:79], v[48:51], v[184:187]
	s_waitcnt lgkmcnt(4)
	ds_read_b128 a[44:47], v12 offset:8192
	v_cvt_pk_bf16_f32 v59, v38, v39
	v_mfma_f32_16x16x32_bf16 v[32:35], a[0:3], a[192:195], -4.0
	v_exp_f32 v40, v40
	v_mfma_f32_16x16x32_bf16 v[32:35], a[4:7], a[196:199], v[32:35]
	buffer_load_dwordx4 a[152:155], v13, s[36:39], s95 offen offset:0
	v_mfma_f32_16x16x32_bf16 v[32:35], a[8:11], a[200:203], v[32:35]
	v_exp_f32 v41, v41
	v_mfma_f32_16x16x32_bf16 v[32:35], a[12:15], a[204:207], v[32:35]
L_pg13:
	s_cbranch_execz L_touched0
	ds_read_b128 a[60:63], v12 offset:12288
	v_cvt_pk_bf16_f32 v60, v40, v41
	v_mfma_f32_16x16x32_bf16 v[36:39], a[28:31], a[204:207], -4.0
	v_exp_f32 v42, v42
	v_mfma_f32_16x16x32_bf16 v[36:39], a[24:27], a[200:203], v[36:39]
	buffer_load_dwordx4 a[152:155], v13, s[36:39], s95 offen offset:1024
	v_mfma_f32_16x16x32_bf16 v[36:39], a[20:23], a[196:199], v[36:39]
	s_waitcnt lgkmcnt(2)
	v_exp_f32 v43, v43
	v_mfma_f32_16x16x32_bf16 v[36:39], a[16:19], a[192:195], v[36:39]
	ds_read_b128 a[56:59], v11 offset:12288
	v_cvt_pk_bf16_f32 v61, v42, v43
	v_mfma_f32_16x16x32_bf16 v[200:203], a[80:83], v[48:51], v[200:203]
	v_exp_f32 v44, v44
	v_mfma_f32_16x16x32_bf16 v[200:203], a[112:115], v[52:55], v[200:203]
	global_load_dwordx4 a[152:155], v[26:27], off
	v_mfma_f32_16x16x32_bf16 v[216:219], a[116:119], v[52:55], v[216:219]
	v_exp_f32 v45, v45
	v_mfma_f32_16x16x32_bf16 v[216:219], a[84:87], v[48:51], v[216:219]
	ds_read_b128 a[52:55], v10 offset:12288
	v_cvt_pk_bf16_f32 v62, v44, v45
	v_mfma_f32_16x16x32_bf16 v[232:235], a[88:91], v[48:51], v[232:235]
	v_exp_f32 v46, v46
	v_mfma_f32_16x16x32_bf16 v[232:235], a[120:123], v[52:55], v[232:235]
	ds_read_b128 a[48:51], v9 offset:12288
	v_and_b32 v73, 0xffff0000, v73
	v_mfma_f32_16x16x32_bf16 v[248:251], a[124:127], v[52:55], v[248:251]
	v_exp_f32 v47, v47
	v_mfma_f32_16x16x32_bf16 v[248:251], a[92:95], v[48:51], v[248:251]
	v_cvt_pk_bf16_f32 v63, v46, v47
	v_fma_f32 v30, v30, v17, v22
	v_mfma_f32_16x16x32_bf16 v[40:43], a[32:35], a[192:195], -4.0
	v_exp_f32 v32, v32
	v_mfma_f32_16x16x32_bf16 v[40:43], a[36:39], a[196:199], v[40:43]
	v_fma_f32 v73, v73, v17, v22
	v_cvt_pk_bf16_f32 v73, v30, v73
	v_mfma_f32_16x16x32_bf16 v[40:43], a[40:43], a[200:203], v[40:43]
	s_waitcnt lgkmcnt(2)
	v_exp_f32 v33, v33
	v_mfma_f32_16x16x32_bf16 v[40:43], a[44:47], a[204:207], v[40:43]
	v_cvt_pk_bf16_f32 v48, v32, v33
	v_lshlrev_b32 v30, 16, v74
	v_mfma_f32_16x16x32_bf16 v[44:47], a[60:63], a[204:207], -4.0
	v_exp_f32 v34, v34
	v_mfma_f32_16x16x32_bf16 v[44:47], a[56:59], a[200:203], v[44:47]
	s_waitcnt lgkmcnt(1)
	v_and_b32 v74, 0xffff0000, v74
	v_fma_f32 v30, v30, v17, v22
	v_mfma_f32_16x16x32_bf16 v[44:47], a[52:55], a[196:199], v[44:47]
	s_waitcnt lgkmcnt(0)
	v_exp_f32 v35, v35
	v_mfma_f32_16x16x32_bf16 v[44:47], a[48:51], a[192:195], v[44:47]
	v_cvt_pk_bf16_f32 v49, v34, v35
	v_fma_f32 v74, v74, v17, v22
	v_smfmac_f32_16x16x64_bf16 a[136:139], a[168:171], v[56:63], v31
	v_mfma_f32_16x16x32_bf16 v[140:143], a[64:67], v[56:59], v[140:143]
	v_exp_f32 v36, v36
	v_mfma_f32_16x16x32_bf16 v[140:143], a[96:99], v[60:63], v[140:143]
	ds_read_b64_tr_b16 a[64:65], v1 offset:0
	ds_read_b64_tr_b16 a[66:67], v1 offset:4096
	v_mfma_f32_16x16x32_bf16 v[156:159], a[100:103], v[60:63], v[156:159]
	v_exp_f32 v37, v37
	v_mfma_f32_16x16x32_bf16 v[156:159], a[68:71], v[56:59], v[156:159]
	ds_read_b64_tr_b16 a[96:97], v1 offset:8192
	v_cvt_pk_bf16_f32 v50, v36, v37
	v_mfma_f32_16x16x32_bf16 v[172:175], a[72:75], v[56:59], v[172:175]
	v_exp_f32 v38, v38
	v_mfma_f32_16x16x32_bf16 v[172:175], a[104:107], v[60:63], v[172:175]
	ds_read_b64_tr_b16 a[98:99], v1 offset:12288
	ds_read_b64_tr_b16 a[100:101], v2 offset:8192
	v_mfma_f32_16x16x32_bf16 v[188:191], a[108:111], v[60:63], v[188:191]
	v_exp_f32 v39, v39
	v_mfma_f32_16x16x32_bf16 v[188:191], a[76:79], v[56:59], v[188:191]
	ds_read_b64_tr_b16 a[102:103], v2 offset:12288
	v_cvt_pk_bf16_f32 v51, v38, v39
	v_mfma_f32_16x16x32_bf16 v[32:35], a[0:3], a[208:211], -4.0
	v_exp_f32 v40, v40
	v_mfma_f32_16x16x32_bf16 v[32:35], a[4:7], a[212:215], v[32:35]
	ds_read_b64_tr_b16 a[68:69], v2 offset:0
	ds_read_b64_tr_b16 a[70:71], v2 offset:4096
	v_mfma_f32_16x16x32_bf16 v[32:35], a[8:11], a[216:219], v[32:35]
	v_exp_f32 v41, v41
	v_mfma_f32_16x16x32_bf16 v[32:35], a[12:15], a[220:223], v[32:35]
	ds_read_b64_tr_b16 a[72:73], v3 offset:0
	v_cvt_pk_bf16_f32 v52, v40, v41
	v_mfma_f32_16x16x32_bf16 v[36:39], a[28:31], a[220:223], -4.0
	v_exp_f32 v42, v42
	v_mfma_f32_16x16x32_bf16 v[36:39], a[24:27], a[216:219], v[36:39]
	ds_read_b64_tr_b16 a[74:75], v3 offset:4096
	ds_read_b64_tr_b16 a[104:105], v3 offset:8192
	v_mfma_f32_16x16x32_bf16 v[36:39], a[20:23], a[212:215], v[36:39]
	v_exp_f32 v43, v43
	v_mfma_f32_16x16x32_bf16 v[36:39], a[16:19], a[208:211], v[36:39]
	ds_read_b64_tr_b16 a[106:107], v3 offset:12288
	v_cvt_pk_bf16_f32 v53, v42, v43
	v_mfma_f32_16x16x32_bf16 v[204:207], a[80:83], v[56:59], v[204:207]
	v_exp_f32 v44, v44
	v_mfma_f32_16x16x32_bf16 v[204:207], a[112:115], v[60:63], v[204:207]
	ds_read_b64_tr_b16 a[108:109], v4 offset:8192
	ds_read_b64_tr_b16 a[110:111], v4 offset:12288
	v_mfma_f32_16x16x32_bf16 v[220:223], a[116:119], v[60:63], v[220:223]
	v_exp_f32 v45, v45
	v_mfma_f32_16x16x32_bf16 v[220:223], a[84:87], v[56:59], v[220:223]
	ds_read_b64_tr_b16 a[76:77], v4 offset:0
	v_cvt_pk_bf16_f32 v54, v44, v45
	v_mfma_f32_16x16x32_bf16 v[236:239], a[88:91], v[56:59], v[236:239]
	v_exp_f32 v46, v46
	v_mfma_f32_16x16x32_bf16 v[236:239], a[120:123], v[60:63], v[236:239]
	ds_read_b64_tr_b16 a[78:79], v4 offset:4096
	ds_read_b64_tr_b16 a[80:81], v5 offset:0
	v_mfma_f32_16x16x32_bf16 v[252:255], a[124:127], v[60:63], v[252:255]
	v_exp_f32 v47, v47
	v_mfma_f32_16x16x32_bf16 v[252:255], a[92:95], v[56:59], v[252:255]
	ds_read_b64_tr_b16 a[82:83], v5 offset:4096
	v_cvt_pk_bf16_f32 v55, v46, v47
	v_mfma_f32_16x16x32_bf16 v[40:43], a[32:35], a[208:211], -4.0
	v_exp_f32 v32, v32
	v_mfma_f32_16x16x32_bf16 v[40:43], a[36:39], a[212:215], v[40:43]
	ds_read_b64_tr_b16 a[112:113], v5 offset:8192
	ds_read_b64_tr_b16 a[114:115], v5 offset:12288
	v_mfma_f32_16x16x32_bf16 v[40:43], a[40:43], a[216:219], v[40:43]
	v_exp_f32 v33, v33
	v_mfma_f32_16x16x32_bf16 v[40:43], a[44:47], a[220:223], v[40:43]
	ds_read_b64_tr_b16 a[116:117], v6 offset:8192
	v_cvt_pk_bf16_f32 v56, v32, v33
	v_mfma_f32_16x16x32_bf16 v[44:47], a[60:63], a[220:223], -4.0
	v_exp_f32 v34, v34
	v_mfma_f32_16x16x32_bf16 v[44:47], a[56:59], a[216:219], v[44:47]
	ds_read_b64_tr_b16 a[118:119], v6 offset:12288
	ds_read_b64_tr_b16 a[84:85], v6 offset:0
	v_mfma_f32_16x16x32_bf16 v[44:47], a[52:55], a[212:215], v[44:47]
	v_exp_f32 v35, v35
	v_mfma_f32_16x16x32_bf16 v[44:47], a[48:51], a[208:211], v[44:47]
	ds_read_b64_tr_b16 a[86:87], v6 offset:4096
	v_cvt_pk_bf16_f32 v57, v34, v35
	v_smfmac_f32_16x16x64_bf16 a[132:135], a[128:131], v[48:55], v31
	s_waitcnt lgkmcnt(7)
	v_mfma_f32_16x16x32_bf16 v[128:131], a[64:67], v[48:51], v[128:131]
	v_exp_f32 v36, v36
	v_mfma_f32_16x16x32_bf16 v[128:131], a[96:99], v[52:55], v[128:131]
	ds_read_b64_tr_b16 a[88:89], v7 offset:0
	ds_read_b64_tr_b16 a[90:91], v7 offset:4096
	v_mfma_f32_16x16x32_bf16 v[144:147], a[100:103], v[52:55], v[144:147]
	v_exp_f32 v37, v37
	v_mfma_f32_16x16x32_bf16 v[144:147], a[68:71], v[48:51], v[144:147]
	ds_read_b64_tr_b16 a[120:121], v7 offset:8192
	v_cvt_pk_bf16_f32 v58, v36, v37
	v_mfma_f32_16x16x32_bf16 v[160:163], a[72:75], v[48:51], v[160:163]
	v_exp_f32 v38, v38
	v_mfma_f32_16x16x32_bf16 v[160:163], a[104:107], v[52:55], v[160:163]
	ds_read_b64_tr_b16 a[122:123], v7 offset:12288
	ds_read_b64_tr_b16 a[124:125], v8 offset:8192
	v_mfma_f32_16x16x32_bf16 v[176:179], a[108:111], v[52:55], v[176:179]
	v_exp_f32 v39, v39
	v_mfma_f32_16x16x32_bf16 v[176:179], a[76:79], v[48:51], v[176:179]
	ds_read_b64_tr_b16 a[126:127], v8 offset:12288
	v_cvt_pk_bf16_f32 v59, v38, v39
	v_mfma_f32_16x16x32_bf16 v[32:35], a[0:3], a[224:227], -4.0
	v_exp_f32 v40, v40
	v_mfma_f32_16x16x32_bf16 v[32:35], a[4:7], a[228:231], v[32:35]
	ds_read_b64_tr_b16 a[92:93], v8 offset:0
	ds_read_b64_tr_b16 a[94:95], v8 offset:4096
	v_mfma_f32_16x16x32_bf16 v[32:35], a[8:11], a[232:235], v[32:35]
	v_exp_f32 v41, v41
	v_mfma_f32_16x16x32_bf16 v[32:35], a[12:15], a[236:239], v[32:35]
	v_cvt_pk_bf16_f32 v60, v40, v41
	v_cvt_pk_bf16_f32 v74, v30, v74
	v_mfma_f32_16x16x32_bf16 v[36:39], a[28:31], a[236:239], -4.0
	v_exp_f32 v42, v42
	v_mfma_f32_16x16x32_bf16 v[36:39], a[24:27], a[232:235], v[36:39]
	v_lshlrev_b32 v30, 16, v75
	v_and_b32 v75, 0xffff0000, v75
	v_mfma_f32_16x16x32_bf16 v[36:39], a[20:23], a[228:231], v[36:39]
	v_exp_f32 v43, v43
	v_mfma_f32_16x16x32_bf16 v[36:39], a[16:19], a[224:227], v[36:39]
	s_waitcnt lgkmcnt(3)
	v_cvt_pk_bf16_f32 v61, v42, v43
	v_fma_f32 v30, v30, v17, v22
	v_mfma_f32_16x16x32_bf16 v[192:195], a[80:83], v[48:51], v[192:195]
	v_exp_f32 v44, v44
	v_mfma_f32_16x16x32_bf16 v[192:195], a[112:115], v[52:55], v[192:195]
	v_fma_f32 v75, v75, v17, v22
	v_cvt_pk_bf16_f32 v75, v30, v75
	v_mfma_f32_16x16x32_bf16 v[208:211], a[116:119], v[52:55], v[208:211]
	v_exp_f32 v45, v45
	v_mfma_f32_16x16x32_bf16 v[208:211], a[84:87], v[48:51], v[208:211]
	v_cvt_pk_bf16_f32 v62, v44, v45
	v_lshlrev_b32 v30, 16, v76
	v_mfma_f32_16x16x32_bf16 v[224:227], a[88:91], v[48:51], v[224:227]
	v_exp_f32 v46, v46
	v_mfma_f32_16x16x32_bf16 v[224:227], a[120:123], v[52:55], v[224:227]
	s_waitcnt lgkmcnt(0)
	v_and_b32 v76, 0xffff0000, v76
	v_fma_f32 v30, v30, v17, v22
	v_mfma_f32_16x16x32_bf16 v[240:243], a[124:127], v[52:55], v[240:243]
	s_waitcnt vmcnt(5)
	v_exp_f32 v47, v47
	v_mfma_f32_16x16x32_bf16 v[240:243], a[92:95], v[48:51], v[240:243]
	s_barrier
	v_cvt_pk_bf16_f32 v63, v46, v47
	v_fma_f32 v76, v76, v17, v22
	v_mfma_f32_16x16x32_bf16 v[40:43], a[32:35], a[224:227], -4.0
	v_exp_f32 v32, v32
	v_mfma_f32_16x16x32_bf16 v[40:43], a[36:39], a[228:231], v[40:43]
	v_cvt_pk_bf16_f32 v76, v30, v76
	v_lshlrev_b32 v30, 16, v77
	v_mfma_f32_16x16x32_bf16 v[40:43], a[40:43], a[232:235], v[40:43]
	v_exp_f32 v33, v33
	v_mfma_f32_16x16x32_bf16 v[40:43], a[44:47], a[236:239], v[40:43]
	v_cvt_pk_bf16_f32 v48, v32, v33
	v_and_b32 v77, 0xffff0000, v77
	v_mfma_f32_16x16x32_bf16 v[44:47], a[60:63], a[236:239], -4.0
	v_exp_f32 v34, v34
	v_mfma_f32_16x16x32_bf16 v[44:47], a[56:59], a[232:235], v[44:47]
	v_fma_f32 v30, v30, v17, v22
	v_fma_f32 v77, v77, v17, v22
	v_mfma_f32_16x16x32_bf16 v[44:47], a[52:55], a[228:231], v[44:47]
	v_exp_f32 v35, v35
	v_mfma_f32_16x16x32_bf16 v[44:47], a[48:51], a[224:227], v[44:47]
	v_cvt_pk_bf16_f32 v49, v34, v35
	v_cvt_pk_bf16_f32 v77, v30, v77
	v_smfmac_f32_16x16x64_bf16 a[132:135], a[168:171], v[56:63], v31
	v_mfma_f32_16x16x32_bf16 v[132:135], a[64:67], v[56:59], v[132:135]
	v_exp_f32 v36, v36
	v_mfma_f32_16x16x32_bf16 v[132:135], a[96:99], v[60:63], v[132:135]
	v_lshlrev_b32 v30, 16, v78
	v_and_b32 v78, 0xffff0000, v78
	v_mfma_f32_16x16x32_bf16 v[148:151], a[100:103], v[60:63], v[148:151]
	v_exp_f32 v37, v37
	v_mfma_f32_16x16x32_bf16 v[148:151], a[68:71], v[56:59], v[148:151]
	v_cvt_pk_bf16_f32 v50, v36, v37
	v_fma_f32 v30, v30, v17, v22
	v_mfma_f32_16x16x32_bf16 v[164:167], a[72:75], v[56:59], v[164:167]
	v_exp_f32 v38, v38
	v_mfma_f32_16x16x32_bf16 v[164:167], a[104:107], v[60:63], v[164:167]
	v_fma_f32 v78, v78, v17, v22
	v_cvt_pk_bf16_f32 v78, v30, v78
	v_mfma_f32_16x16x32_bf16 v[180:183], a[108:111], v[60:63], v[180:183]
	v_exp_f32 v39, v39
	v_mfma_f32_16x16x32_bf16 v[180:183], a[76:79], v[56:59], v[180:183]
	v_cvt_pk_bf16_f32 v51, v38, v39
	v_lshlrev_b32 v30, 16, v79
	v_mfma_f32_16x16x32_bf16 v[32:35], a[0:3], a[240:243], -4.0
	v_exp_f32 v40, v40
	v_mfma_f32_16x16x32_bf16 v[32:35], a[4:7], a[244:247], v[32:35]
	ds_read_b128 a[0:3], v9 offset:16384
	ds_read_b128 a[4:7], v10 offset:16384
	v_mfma_f32_16x16x32_bf16 v[32:35], a[8:11], a[248:251], v[32:35]
	v_exp_f32 v41, v41
	v_mfma_f32_16x16x32_bf16 v[32:35], a[12:15], a[252:255], v[32:35]
	ds_read_b128 a[8:11], v11 offset:16384
	v_cvt_pk_bf16_f32 v52, v40, v41
	v_mfma_f32_16x16x32_bf16 v[36:39], a[28:31], a[252:255], -4.0
	v_exp_f32 v42, v42
	v_mfma_f32_16x16x32_bf16 v[36:39], a[24:27], a[248:251], v[36:39]
	ds_read_b128 a[12:15], v12 offset:16384
	ds_read_b128 a[28:31], v12 offset:20480
	v_mfma_f32_16x16x32_bf16 v[36:39], a[20:23], a[244:247], v[36:39]
	v_exp_f32 v43, v43
	v_mfma_f32_16x16x32_bf16 v[36:39], a[16:19], a[240:243], v[36:39]
	ds_read_b128 a[24:27], v11 offset:20480
	v_cvt_pk_bf16_f32 v53, v42, v43
	v_mfma_f32_16x16x32_bf16 v[196:199], a[80:83], v[56:59], v[196:199]
	v_exp_f32 v44, v44
	v_mfma_f32_16x16x32_bf16 v[196:199], a[112:115], v[60:63], v[196:199]
	ds_read_b128 a[20:23], v10 offset:20480
	ds_read_b128 a[16:19], v9 offset:20480
	v_mfma_f32_16x16x32_bf16 v[212:215], a[116:119], v[60:63], v[212:215]
	v_exp_f32 v45, v45
	v_mfma_f32_16x16x32_bf16 v[212:215], a[84:87], v[56:59], v[212:215]
	v_cvt_pk_bf16_f32 v54, v44, v45
	v_and_b32 v79, 0xffff0000, v79
	v_mfma_f32_16x16x32_bf16 v[228:231], a[88:91], v[56:59], v[228:231]
	v_exp_f32 v46, v46
	v_mfma_f32_16x16x32_bf16 v[228:231], a[120:123], v[60:63], v[228:231]
	v_fma_f32 v30, v30, v17, v22
	v_fma_f32 v79, v79, v17, v22
	v_mfma_f32_16x16x32_bf16 v[244:247], a[124:127], v[60:63], v[244:247]
	v_exp_f32 v47, v47
	v_mfma_f32_16x16x32_bf16 v[244:247], a[92:95], v[56:59], v[244:247]
	v_cvt_pk_bf16_f32 v55, v46, v47
	v_cvt_pk_bf16_f32 v79, v30, v79
	v_mfma_f32_16x16x32_bf16 v[40:43], a[32:35], a[240:243], -4.0
	s_add_u32 m0, s64, 0x0
	s_mul_i32 s66, s97, 0
	v_exp_f32 v32, v32
	v_mfma_f32_16x16x32_bf16 v[40:43], a[36:39], a[244:247], v[40:43]
	buffer_load_dwordx4 v15, s[32:35], s66 offen offset:0 lds
	v_mfma_f32_16x16x32_bf16 v[40:43], a[40:43], a[248:251], v[40:43]
	v_exp_f32 v33, v33
	v_mfma_f32_16x16x32_bf16 v[40:43], a[44:47], a[252:255], v[40:43]
	ds_read_b128 a[32:35], v9 offset:24576
	v_cvt_pk_bf16_f32 v56, v32, v33
	v_mfma_f32_16x16x32_bf16 v[44:47], a[60:63], a[252:255], -4.0
	s_add_u32 s66, s66, 0x6c00
	v_exp_f32 v34, v34
	v_mfma_f32_16x16x32_bf16 v[44:47], a[56:59], a[248:251], v[44:47]
	buffer_load_dwordx4 v15, s[32:35], s66 offen offset:1024 lds
	v_mfma_f32_16x16x32_bf16 v[44:47], a[52:55], a[244:247], v[44:47]
	v_exp_f32 v35, v35
	v_mfma_f32_16x16x32_bf16 v[44:47], a[48:51], a[240:243], v[44:47]
	ds_read_b128 a[36:39], v10 offset:24576
	v_cvt_pk_bf16_f32 v57, v34, v35
	v_smfmac_f32_16x16x64_bf16 a[136:139], a[128:131], v[48:55], v31
	v_mfma_f32_16x16x32_bf16 v[136:139], a[64:67], v[48:51], v[136:139]
	v_exp_f32 v36, v36
	v_mfma_f32_16x16x32_bf16 v[136:139], a[96:99], v[52:55], v[136:139]
	ds_read_b128 a[40:43], v11 offset:24576
	ds_read_b128 a[44:47], v12 offset:24576
	v_mfma_f32_16x16x32_bf16 v[152:155], a[100:103], v[52:55], v[152:155]
	v_exp_f32 v37, v37
	v_mfma_f32_16x16x32_bf16 v[152:155], a[68:71], v[48:51], v[152:155]
	ds_read_b128 a[60:63], v12 offset:28672
	v_cvt_pk_bf16_f32 v58, v36, v37
	v_mfma_f32_16x16x32_bf16 v[168:171], a[72:75], v[48:51], v[168:171]
	s_add_u32 s66, s66, 0x6c00
	v_exp_f32 v38, v38
	v_mfma_f32_16x16x32_bf16 v[168:171], a[104:107], v[52:55], v[168:171]
	buffer_load_dwordx4 v15, s[32:35], s66 offen offset:2048 lds
	v_mfma_f32_16x16x32_bf16 v[184:187], a[108:111], v[52:55], v[184:187]
	v_exp_f32 v39, v39
	v_mfma_f32_16x16x32_bf16 v[184:187], a[76:79], v[48:51], v[184:187]
	s_waitcnt lgkmcnt(4)
	ds_read_b128 a[56:59], v11 offset:28672
	v_cvt_pk_bf16_f32 v59, v38, v39
	v_mfma_f32_16x16x32_bf16 v[32:35], a[0:3], a[192:195], -4.0
	s_add_u32 m0, s64, 0x0
	s_add_u32 s66, s66, 0x6c00
	v_exp_f32 v40, v40
	v_mfma_f32_16x16x32_bf16 v[32:35], a[4:7], a[196:199], v[32:35]
	buffer_load_dwordx4 v15, s[32:35], s66 offen offset:3072 lds
	v_mfma_f32_16x16x32_bf16 v[32:35], a[8:11], a[200:203], v[32:35]
	v_exp_f32 v41, v41
	v_mfma_f32_16x16x32_bf16 v[32:35], a[12:15], a[204:207], v[32:35]
	s_add_u32 m0, s64, 0x1000
	ds_read_b128 a[52:55], v10 offset:28672
	v_cvt_pk_bf16_f32 v60, v40, v41
	v_mfma_f32_16x16x32_bf16 v[36:39], a[28:31], a[204:207], -4.0
	s_mul_i32 s66, s97, 1
	v_exp_f32 v42, v42
	v_mfma_f32_16x16x32_bf16 v[36:39], a[24:27], a[200:203], v[36:39]
	buffer_load_dwordx4 v15, s[32:35], s66 offen offset:0 lds
	v_mfma_f32_16x16x32_bf16 v[36:39], a[20:23], a[196:199], v[36:39]
	v_exp_f32 v43, v43
	v_mfma_f32_16x16x32_bf16 v[36:39], a[16:19], a[192:195], v[36:39]
	ds_read_b128 a[48:51], v9 offset:28672
	v_cvt_pk_bf16_f32 v61, v42, v43
	v_mfma_f32_16x16x32_bf16 v[200:203], a[80:83], v[48:51], v[200:203]
	s_add_u32 s66, s66, 0x6c00
	v_exp_f32 v44, v44
	v_mfma_f32_16x16x32_bf16 v[200:203], a[112:115], v[52:55], v[200:203]
	buffer_load_dwordx4 v15, s[32:35], s66 offen offset:1024 lds
	v_mfma_f32_16x16x32_bf16 v[216:219], a[116:119], v[52:55], v[216:219]
	v_exp_f32 v45, v45
	v_mfma_f32_16x16x32_bf16 v[216:219], a[84:87], v[48:51], v[216:219]
	v_cvt_pk_bf16_f32 v62, v44, v45
	v_lshlrev_b32 v30, 16, v80
	v_mfma_f32_16x16x32_bf16 v[232:235], a[88:91], v[48:51], v[232:235]
	s_add_u32 s66, s66, 0x6c00
	v_exp_f32 v46, v46
	v_mfma_f32_16x16x32_bf16 v[232:235], a[120:123], v[52:55], v[232:235]
	buffer_load_dwordx4 v15, s[32:35], s66 offen offset:2048 lds
	v_mfma_f32_16x16x32_bf16 v[248:251], a[124:127], v[52:55], v[248:251]
	v_exp_f32 v47, v47
	v_mfma_f32_16x16x32_bf16 v[248:251], a[92:95], v[48:51], v[248:251]
	v_cvt_pk_bf16_f32 v63, v46, v47
	v_and_b32 v80, 0xffff0000, v80
	v_mfma_f32_16x16x32_bf16 v[40:43], a[32:35], a[192:195], -4.0
	s_waitcnt lgkmcnt(1)
	s_add_u32 m0, s64, 0x1000
	s_add_u32 s66, s66, 0x6c00
	v_exp_f32 v32, v32
	v_mfma_f32_16x16x32_bf16 v[40:43], a[36:39], a[196:199], v[40:43]
	buffer_load_dwordx4 v15, s[32:35], s66 offen offset:3072 lds
	v_mfma_f32_16x16x32_bf16 v[40:43], a[40:43], a[200:203], v[40:43]
	v_exp_f32 v33, v33
	v_mfma_f32_16x16x32_bf16 v[40:43], a[44:47], a[204:207], v[40:43]
	s_add_u32 m0, s64, 0x2000
	v_cvt_pk_bf16_f32 v48, v32, v33
	v_fma_f32 v30, v30, v17, v22
	v_mfma_f32_16x16x32_bf16 v[44:47], a[60:63], a[204:207], -4.0
	s_mul_i32 s66, s97, 2
	v_exp_f32 v34, v34
	v_mfma_f32_16x16x32_bf16 v[44:47], a[56:59], a[200:203], v[44:47]
	buffer_load_dwordx4 v15, s[32:35], s66 offen offset:0 lds
	v_mfma_f32_16x16x32_bf16 v[44:47], a[52:55], a[196:199], v[44:47]
	s_waitcnt lgkmcnt(0)
	v_exp_f32 v35, v35
	v_mfma_f32_16x16x32_bf16 v[44:47], a[48:51], a[192:195], v[44:47]
	v_cvt_pk_bf16_f32 v49, v34, v35
	v_fma_f32 v80, v80, v17, v22
	v_smfmac_f32_16x16x64_bf16 a[136:139], a[168:171], v[56:63], v31
	v_mfma_f32_16x16x32_bf16 v[140:143], a[64:67], v[56:59], v[140:143]
	v_exp_f32 v36, v36
	v_mfma_f32_16x16x32_bf16 v[140:143], a[96:99], v[60:63], v[140:143]
	ds_read_b64_tr_b16 a[64:65], v1 offset:16384
	ds_read_b64_tr_b16 a[66:67], v1 offset:20480
	v_mfma_f32_16x16x32_bf16 v[156:159], a[100:103], v[60:63], v[156:159]
	v_exp_f32 v37, v37
	v_mfma_f32_16x16x32_bf16 v[156:159], a[68:71], v[56:59], v[156:159]
	ds_read_b64_tr_b16 a[96:97], v1 offset:24576
	v_cvt_pk_bf16_f32 v50, v36, v37
	v_mfma_f32_16x16x32_bf16 v[172:175], a[72:75], v[56:59], v[172:175]
	v_exp_f32 v38, v38
	v_mfma_f32_16x16x32_bf16 v[172:175], a[104:107], v[60:63], v[172:175]
	ds_read_b64_tr_b16 a[98:99], v1 offset:28672
	ds_read_b64_tr_b16 a[100:101], v2 offset:24576
	v_mfma_f32_16x16x32_bf16 v[188:191], a[108:111], v[60:63], v[188:191]
	v_exp_f32 v39, v39
	v_mfma_f32_16x16x32_bf16 v[188:191], a[76:79], v[56:59], v[188:191]
	ds_read_b64_tr_b16 a[102:103], v2 offset:28672
	v_cvt_pk_bf16_f32 v51, v38, v39
	v_mfma_f32_16x16x32_bf16 v[32:35], a[0:3], a[208:211], -4.0
	v_exp_f32 v40, v40
	v_mfma_f32_16x16x32_bf16 v[32:35], a[4:7], a[212:215], v[32:35]
	ds_read_b64_tr_b16 a[68:69], v2 offset:16384
	ds_read_b64_tr_b16 a[70:71], v2 offset:20480
	v_mfma_f32_16x16x32_bf16 v[32:35], a[8:11], a[216:219], v[32:35]
	v_exp_f32 v41, v41
	v_mfma_f32_16x16x32_bf16 v[32:35], a[12:15], a[220:223], v[32:35]
	ds_read_b64_tr_b16 a[72:73], v3 offset:16384
	v_cvt_pk_bf16_f32 v52, v40, v41
	v_mfma_f32_16x16x32_bf16 v[36:39], a[28:31], a[220:223], -4.0
	v_exp_f32 v42, v42
	v_mfma_f32_16x16x32_bf16 v[36:39], a[24:27], a[216:219], v[36:39]
	ds_read_b64_tr_b16 a[74:75], v3 offset:20480
	ds_read_b64_tr_b16 a[104:105], v3 offset:24576
	v_mfma_f32_16x16x32_bf16 v[36:39], a[20:23], a[212:215], v[36:39]
	v_exp_f32 v43, v43
	v_mfma_f32_16x16x32_bf16 v[36:39], a[16:19], a[208:211], v[36:39]
	ds_read_b64_tr_b16 a[106:107], v3 offset:28672
	v_cvt_pk_bf16_f32 v53, v42, v43
	v_mfma_f32_16x16x32_bf16 v[204:207], a[80:83], v[56:59], v[204:207]
	v_exp_f32 v44, v44
	v_mfma_f32_16x16x32_bf16 v[204:207], a[112:115], v[60:63], v[204:207]
	ds_read_b64_tr_b16 a[108:109], v4 offset:24576
	ds_read_b64_tr_b16 a[110:111], v4 offset:28672
	v_mfma_f32_16x16x32_bf16 v[220:223], a[116:119], v[60:63], v[220:223]
	v_exp_f32 v45, v45
	v_mfma_f32_16x16x32_bf16 v[220:223], a[84:87], v[56:59], v[220:223]
	ds_read_b64_tr_b16 a[76:77], v4 offset:16384
	v_cvt_pk_bf16_f32 v54, v44, v45
	v_mfma_f32_16x16x32_bf16 v[236:239], a[88:91], v[56:59], v[236:239]
	v_exp_f32 v46, v46
	v_mfma_f32_16x16x32_bf16 v[236:239], a[120:123], v[60:63], v[236:239]
	ds_read_b64_tr_b16 a[78:79], v4 offset:20480
	ds_read_b64_tr_b16 a[80:81], v5 offset:16384
	v_mfma_f32_16x16x32_bf16 v[252:255], a[124:127], v[60:63], v[252:255]
	v_exp_f32 v47, v47
	v_mfma_f32_16x16x32_bf16 v[252:255], a[92:95], v[56:59], v[252:255]
	ds_read_b64_tr_b16 a[82:83], v5 offset:20480
	v_cvt_pk_bf16_f32 v55, v46, v47
	v_mfma_f32_16x16x32_bf16 v[40:43], a[32:35], a[208:211], -4.0
	v_exp_f32 v32, v32
	v_mfma_f32_16x16x32_bf16 v[40:43], a[36:39], a[212:215], v[40:43]
	ds_read_b64_tr_b16 a[112:113], v5 offset:24576
	ds_read_b64_tr_b16 a[114:115], v5 offset:28672
	v_mfma_f32_16x16x32_bf16 v[40:43], a[40:43], a[216:219], v[40:43]
	v_exp_f32 v33, v33
	v_mfma_f32_16x16x32_bf16 v[40:43], a[44:47], a[220:223], v[40:43]
	ds_read_b64_tr_b16 a[116:117], v6 offset:24576
	v_cvt_pk_bf16_f32 v56, v32, v33
	v_mfma_f32_16x16x32_bf16 v[44:47], a[60:63], a[220:223], -4.0
	v_exp_f32 v34, v34
	v_mfma_f32_16x16x32_bf16 v[44:47], a[56:59], a[216:219], v[44:47]
	ds_read_b64_tr_b16 a[118:119], v6 offset:28672
	ds_read_b64_tr_b16 a[84:85], v6 offset:16384
	v_mfma_f32_16x16x32_bf16 v[44:47], a[52:55], a[212:215], v[44:47]
	v_exp_f32 v35, v35
	v_mfma_f32_16x16x32_bf16 v[44:47], a[48:51], a[208:211], v[44:47]
	ds_read_b64_tr_b16 a[86:87], v6 offset:20480
	v_cvt_pk_bf16_f32 v57, v34, v35
	v_smfmac_f32_16x16x64_bf16 a[132:135], a[128:131], v[48:55], v31
	s_waitcnt lgkmcnt(7)
	v_mfma_f32_16x16x32_bf16 v[128:131], a[64:67], v[48:51], v[128:131]
	v_exp_f32 v36, v36
	v_mfma_f32_16x16x32_bf16 v[128:131], a[96:99], v[52:55], v[128:131]
	ds_read_b64_tr_b16 a[88:89], v7 offset:16384
	ds_read_b64_tr_b16 a[90:91], v7 offset:20480
	v_mfma_f32_16x16x32_bf16 v[144:147], a[100:103], v[52:55], v[144:147]
	v_exp_f32 v37, v37
	v_mfma_f32_16x16x32_bf16 v[144:147], a[68:71], v[48:51], v[144:147]
	ds_read_b64_tr_b16 a[120:121], v7 offset:24576
	v_cvt_pk_bf16_f32 v58, v36, v37
	v_mfma_f32_16x16x32_bf16 v[160:163], a[72:75], v[48:51], v[160:163]
	v_exp_f32 v38, v38
	v_mfma_f32_16x16x32_bf16 v[160:163], a[104:107], v[52:55], v[160:163]
	ds_read_b64_tr_b16 a[122:123], v7 offset:28672
	ds_read_b64_tr_b16 a[124:125], v8 offset:24576
	v_mfma_f32_16x16x32_bf16 v[176:179], a[108:111], v[52:55], v[176:179]
	v_exp_f32 v39, v39
	v_mfma_f32_16x16x32_bf16 v[176:179], a[76:79], v[48:51], v[176:179]
	ds_read_b64_tr_b16 a[126:127], v8 offset:28672
	v_cvt_pk_bf16_f32 v59, v38, v39
	v_mfma_f32_16x16x32_bf16 v[32:35], a[0:3], a[224:227], -4.0
	v_exp_f32 v40, v40
	v_mfma_f32_16x16x32_bf16 v[32:35], a[4:7], a[228:231], v[32:35]
	ds_read_b64_tr_b16 a[92:93], v8 offset:16384
	ds_read_b64_tr_b16 a[94:95], v8 offset:20480
	v_mfma_f32_16x16x32_bf16 v[32:35], a[8:11], a[232:235], v[32:35]
	v_exp_f32 v41, v41
	v_mfma_f32_16x16x32_bf16 v[32:35], a[12:15], a[236:239], v[32:35]
	s_add_u32 m0, s64, 0x2000
	v_cvt_pk_bf16_f32 v60, v40, v41
	v_cvt_pk_bf16_f32 v80, v30, v80
	v_mfma_f32_16x16x32_bf16 v[36:39], a[28:31], a[236:239], -4.0
	s_add_u32 s66, s66, 0x6c00
	v_exp_f32 v42, v42
	v_mfma_f32_16x16x32_bf16 v[36:39], a[24:27], a[232:235], v[36:39]
	buffer_load_dwordx4 v15, s[32:35], s66 offen offset:1024 lds
	v_mfma_f32_16x16x32_bf16 v[36:39], a[20:23], a[228:231], v[36:39]
	v_exp_f32 v43, v43
	v_mfma_f32_16x16x32_bf16 v[36:39], a[16:19], a[224:227], v[36:39]
	s_waitcnt lgkmcnt(3)
	v_cvt_pk_bf16_f32 v61, v42, v43
	v_lshlrev_b32 v30, 16, v81
	v_mfma_f32_16x16x32_bf16 v[192:195], a[80:83], v[48:51], v[192:195]
	s_add_u32 s66, s66, 0x6c00
	v_exp_f32 v44, v44
	v_mfma_f32_16x16x32_bf16 v[192:195], a[112:115], v[52:55], v[192:195]
	buffer_load_dwordx4 v15, s[32:35], s66 offen offset:2048 lds
	v_mfma_f32_16x16x32_bf16 v[208:211], a[116:119], v[52:55], v[208:211]
	v_exp_f32 v45, v45
	v_mfma_f32_16x16x32_bf16 v[208:211], a[84:87], v[48:51], v[208:211]
	v_cvt_pk_bf16_f32 v62, v44, v45
	v_and_b32 v81, 0xffff0000, v81
	v_mfma_f32_16x16x32_bf16 v[224:227], a[88:91], v[48:51], v[224:227]
	s_add_u32 s66, s66, 0x6c00
	v_exp_f32 v46, v46
	v_mfma_f32_16x16x32_bf16 v[224:227], a[120:123], v[52:55], v[224:227]
	s_waitcnt lgkmcnt(0)
	buffer_load_dwordx4 v15, s[32:35], s66 offen offset:3072 lds
	v_mfma_f32_16x16x32_bf16 v[240:243], a[124:127], v[52:55], v[240:243]
	v_exp_f32 v47, v47
	v_mfma_f32_16x16x32_bf16 v[240:243], a[92:95], v[48:51], v[240:243]
	s_barrier
	v_cvt_pk_bf16_f32 v63, v46, v47
	v_fma_f32 v30, v30, v17, v22
	v_mfma_f32_16x16x32_bf16 v[40:43], a[32:35], a[224:227], -4.0
	s_add_u32 m0, s64, 0x3000
	s_mul_i32 s66, s97, 3
	v_exp_f32 v32, v32
	v_mfma_f32_16x16x32_bf16 v[40:43], a[36:39], a[228:231], v[40:43]
	buffer_load_dwordx4 v15, s[32:35], s66 offen offset:0 lds
	v_mfma_f32_16x16x32_bf16 v[40:43], a[40:43], a[232:235], v[40:43]
	v_exp_f32 v33, v33
	v_mfma_f32_16x16x32_bf16 v[40:43], a[44:47], a[236:239], v[40:43]
	v_cvt_pk_bf16_f32 v48, v32, v33
	v_fma_f32 v81, v81, v17, v22
	v_mfma_f32_16x16x32_bf16 v[44:47], a[60:63], a[236:239], -4.0
	s_add_u32 s66, s66, 0x6c00
	v_exp_f32 v34, v34
	v_mfma_f32_16x16x32_bf16 v[44:47], a[56:59], a[232:235], v[44:47]
	buffer_load_dwordx4 v15, s[32:35], s66 offen offset:1024 lds
	v_mfma_f32_16x16x32_bf16 v[44:47], a[52:55], a[228:231], v[44:47]
	v_exp_f32 v35, v35
	v_mfma_f32_16x16x32_bf16 v[44:47], a[48:51], a[224:227], v[44:47]
	v_cvt_pk_bf16_f32 v49, v34, v35
	v_cvt_pk_bf16_f32 v81, v30, v81
	v_smfmac_f32_16x16x64_bf16 a[132:135], a[168:171], v[56:63], v31
	v_mfma_f32_16x16x32_bf16 v[132:135], a[64:67], v[56:59], v[132:135]
	s_add_u32 s66, s66, 0x6c00
	v_exp_f32 v36, v36
	v_mfma_f32_16x16x32_bf16 v[132:135], a[96:99], v[60:63], v[132:135]
	buffer_load_dwordx4 v15, s[32:35], s66 offen offset:2048 lds
	v_mfma_f32_16x16x32_bf16 v[148:151], a[100:103], v[60:63], v[148:151]
	v_exp_f32 v37, v37
	v_mfma_f32_16x16x32_bf16 v[148:151], a[68:71], v[56:59], v[148:151]
	v_cvt_pk_bf16_f32 v50, v36, v37
	v_lshlrev_b32 v30, 16, v82
	v_mfma_f32_16x16x32_bf16 v[164:167], a[72:75], v[56:59], v[164:167]
	s_add_u32 s66, s66, 0x6c00
	v_exp_f32 v38, v38
	v_mfma_f32_16x16x32_bf16 v[164:167], a[104:107], v[60:63], v[164:167]
	buffer_load_dwordx4 v15, s[32:35], s66 offen offset:3072 lds
	v_mfma_f32_16x16x32_bf16 v[180:183], a[108:111], v[60:63], v[180:183]
	v_exp_f32 v39, v39
	v_mfma_f32_16x16x32_bf16 v[180:183], a[76:79], v[56:59], v[180:183]
	v_cvt_pk_bf16_f32 v51, v38, v39
	v_and_b32 v82, 0xffff0000, v82
	v_mfma_f32_16x16x32_bf16 v[32:35], a[0:3], a[240:243], -4.0
L_pg14:
	s_cbranch_execz L_touched0
	s_add_u32 m0, s64, 0x4000
	s_mul_i32 s66, s97, 4
	v_exp_f32 v40, v40
	v_mfma_f32_16x16x32_bf16 v[32:35], a[4:7], a[244:247], v[32:35]
	buffer_load_dwordx4 v15, s[32:35], s66 offen offset:0 lds
	v_mfma_f32_16x16x32_bf16 v[32:35], a[8:11], a[248:251], v[32:35]
	v_exp_f32 v41, v41
	v_mfma_f32_16x16x32_bf16 v[32:35], a[12:15], a[252:255], v[32:35]
	v_cvt_pk_bf16_f32 v52, v40, v41
	v_fma_f32 v30, v30, v17, v22
	v_mfma_f32_16x16x32_bf16 v[36:39], a[28:31], a[252:255], -4.0
	s_add_u32 s66, s66, 0x6c00
	v_exp_f32 v42, v42
	v_mfma_f32_16x16x32_bf16 v[36:39], a[24:27], a[248:251], v[36:39]
	buffer_load_dwordx4 v15, s[32:35], s66 offen offset:1024 lds
	v_mfma_f32_16x16x32_bf16 v[36:39], a[20:23], a[244:247], v[36:39]
	v_exp_f32 v43, v43
	v_mfma_f32_16x16x32_bf16 v[36:39], a[16:19], a[240:243], v[36:39]
	v_cvt_pk_bf16_f32 v53, v42, v43
	v_fma_f32 v82, v82, v17, v22
	v_mfma_f32_16x16x32_bf16 v[196:199], a[80:83], v[56:59], v[196:199]
	s_add_u32 s66, s66, 0x6c00
	v_exp_f32 v44, v44
	v_mfma_f32_16x16x32_bf16 v[196:199], a[112:115], v[60:63], v[196:199]
	buffer_load_dwordx4 v15, s[32:35], s66 offen offset:2048 lds
	v_mfma_f32_16x16x32_bf16 v[212:215], a[116:119], v[60:63], v[212:215]
	v_exp_f32 v45, v45
	v_mfma_f32_16x16x32_bf16 v[212:215], a[84:87], v[56:59], v[212:215]
	v_cvt_pk_bf16_f32 v54, v44, v45
	v_cvt_pk_bf16_f32 v82, v30, v82
	v_mfma_f32_16x16x32_bf16 v[228:231], a[88:91], v[56:59], v[228:231]
	s_add_u32 s66, s66, 0x6c00
	v_exp_f32 v46, v46
	v_mfma_f32_16x16x32_bf16 v[228:231], a[120:123], v[60:63], v[228:231]
	buffer_load_dwordx4 v15, s[32:35], s66 offen offset:3072 lds
	v_mfma_f32_16x16x32_bf16 v[244:247], a[124:127], v[60:63], v[244:247]
	v_exp_f32 v47, v47
	v_mfma_f32_16x16x32_bf16 v[244:247], a[92:95], v[56:59], v[244:247]
	v_cvt_pk_bf16_f32 v55, v46, v47
	v_lshlrev_b32 v30, 16, v83
	v_mfma_f32_16x16x32_bf16 v[40:43], a[32:35], a[240:243], -4.0
	s_add_u32 m0, s64, 0x5000
	s_mul_i32 s66, s97, 5
	v_exp_f32 v32, v32
	v_mfma_f32_16x16x32_bf16 v[40:43], a[36:39], a[244:247], v[40:43]
	buffer_load_dwordx4 v15, s[32:35], s66 offen offset:0 lds
	v_mfma_f32_16x16x32_bf16 v[40:43], a[40:43], a[248:251], v[40:43]
	v_exp_f32 v33, v33
	v_mfma_f32_16x16x32_bf16 v[40:43], a[44:47], a[252:255], v[40:43]
	v_cvt_pk_bf16_f32 v56, v32, v33
	v_and_b32 v83, 0xffff0000, v83
	v_mfma_f32_16x16x32_bf16 v[44:47], a[60:63], a[252:255], -4.0
	s_add_u32 s66, s66, 0x6c00
	v_exp_f32 v34, v34
	v_mfma_f32_16x16x32_bf16 v[44:47], a[56:59], a[248:251], v[44:47]
	buffer_load_dwordx4 v15, s[32:35], s66 offen offset:1024 lds
	v_mfma_f32_16x16x32_bf16 v[44:47], a[52:55], a[244:247], v[44:47]
	v_exp_f32 v35, v35
	v_mfma_f32_16x16x32_bf16 v[44:47], a[48:51], a[240:243], v[44:47]
	v_cvt_pk_bf16_f32 v57, v34, v35
	v_fma_f32 v30, v30, v17, v22
	v_smfmac_f32_16x16x64_bf16 a[136:139], a[128:131], v[48:55], v31
	v_mfma_f32_16x16x32_bf16 v[136:139], a[64:67], v[48:51], v[136:139]
	s_add_u32 s66, s66, 0x6c00
	v_exp_f32 v36, v36
	v_mfma_f32_16x16x32_bf16 v[136:139], a[96:99], v[52:55], v[136:139]
	buffer_load_dwordx4 v15, s[32:35], s66 offen offset:2048 lds
	v_mfma_f32_16x16x32_bf16 v[152:155], a[100:103], v[52:55], v[152:155]
	v_exp_f32 v37, v37
	v_mfma_f32_16x16x32_bf16 v[152:155], a[68:71], v[48:51], v[152:155]
	v_cvt_pk_bf16_f32 v58, v36, v37
	v_fma_f32 v83, v83, v17, v22
	v_mfma_f32_16x16x32_bf16 v[168:171], a[72:75], v[48:51], v[168:171]
	s_add_u32 s66, s66, 0x6c00
	v_exp_f32 v38, v38
	v_mfma_f32_16x16x32_bf16 v[168:171], a[104:107], v[52:55], v[168:171]
	buffer_load_dwordx4 v15, s[32:35], s66 offen offset:3072 lds
	v_mfma_f32_16x16x32_bf16 v[184:187], a[108:111], v[52:55], v[184:187]
	v_exp_f32 v39, v39
	v_mfma_f32_16x16x32_bf16 v[184:187], a[76:79], v[48:51], v[184:187]
	v_cvt_pk_bf16_f32 v59, v38, v39
	v_cvt_pk_bf16_f32 v83, v30, v83
	v_mfma_f32_16x16x32_bf16 v[200:203], a[80:83], v[48:51], v[200:203]
	v_exp_f32 v40, v40
	v_mfma_f32_16x16x32_bf16 v[200:203], a[112:115], v[52:55], v[200:203]
	v_exp_f32 v41, v41
	v_mfma_f32_16x16x32_bf16 v[216:219], a[116:119], v[52:55], v[216:219]
	v_cvt_pk_bf16_f32 v60, v40, v41
	v_exp_f32 v42, v42
	v_mfma_f32_16x16x32_bf16 v[216:219], a[84:87], v[48:51], v[216:219]
	v_exp_f32 v43, v43
	v_mfma_f32_16x16x32_bf16 v[232:235], a[88:91], v[48:51], v[232:235]
	v_cvt_pk_bf16_f32 v61, v42, v43
	v_exp_f32 v44, v44
	v_mfma_f32_16x16x32_bf16 v[232:235], a[120:123], v[52:55], v[232:235]
	v_exp_f32 v45, v45
	v_mfma_f32_16x16x32_bf16 v[248:251], a[124:127], v[52:55], v[248:251]
	v_cvt_pk_bf16_f32 v62, v44, v45
	v_exp_f32 v46, v46
	v_mfma_f32_16x16x32_bf16 v[248:251], a[92:95], v[48:51], v[248:251]
	v_exp_f32 v47, v47
	s_nop 0
	v_cvt_pk_bf16_f32 v63, v46, v47
	v_mfma_f32_16x16x32_bf16 v[140:143], a[64:67], v[56:59], v[140:143]
	v_lshlrev_b32 v30, 16, v84
	v_and_b32 v84, 0xffff0000, v84
	v_mfma_f32_16x16x32_bf16 v[140:143], a[96:99], v[60:63], v[140:143]
	v_fma_f32 v30, v30, v17, v22
	v_fma_f32 v84, v84, v17, v22
	v_mfma_f32_16x16x32_bf16 v[156:159], a[100:103], v[60:63], v[156:159]
	v_cvt_pk_bf16_f32 v84, v30, v84
	v_lshlrev_b32 v30, 16, v85
	v_mfma_f32_16x16x32_bf16 v[156:159], a[68:71], v[56:59], v[156:159]
	v_and_b32 v85, 0xffff0000, v85
	v_fma_f32 v30, v30, v17, v22
	v_smfmac_f32_16x16x64_bf16 a[136:139], a[168:171], v[56:63], v31
	v_mfma_f32_16x16x32_bf16 v[172:175], a[72:75], v[56:59], v[172:175]
	v_fma_f32 v85, v85, v17, v22
	v_cvt_pk_bf16_f32 v85, v30, v85
	v_mfma_f32_16x16x32_bf16 v[172:175], a[104:107], v[60:63], v[172:175]
	v_lshlrev_b32 v30, 16, v86
	v_and_b32 v86, 0xffff0000, v86
	v_mfma_f32_16x16x32_bf16 v[188:191], a[108:111], v[60:63], v[188:191]
	v_fma_f32 v30, v30, v17, v22
	v_fma_f32 v86, v86, v17, v22
	v_mfma_f32_16x16x32_bf16 v[188:191], a[76:79], v[56:59], v[188:191]
	v_cvt_pk_bf16_f32 v86, v30, v86
	v_lshlrev_b32_e64 v30, 16, v87
	v_and_b32 v87, 0xffff0000, v87
	v_fma_f32 v30, v30, v17, v22
	v_fma_f32 v87, v87, v17, v22
	v_cvt_pk_bf16_f32 v87, v30, v87
	v_mfma_f32_16x16x32_bf16 v[204:207], a[80:83], v[56:59], v[204:207]
	v_lshl_add_u32 v29, s62, 14, v13
	v_lshrrev_b32 v1, 2, v0
	v_mfma_f32_16x16x32_bf16 v[204:207], a[112:115], v[60:63], v[204:207]
	v_bfe_u32 v26, v0, 3, 2
	v_lshlrev_b32 v26, 5, v26
	v_mfma_f32_16x16x32_bf16 v[220:223], a[116:119], v[60:63], v[220:223]
	v_lshl_or_b32 v1, v1, 7, v26
	v_and_b32 v26, 3, v0
	v_mfma_f32_16x16x32_bf16 v[220:223], a[84:87], v[56:59], v[220:223]
	v_lshl_or_b32 v1, v26, 3, v1
	v_add_u32 v1, s64, v1
	v_mfma_f32_16x16x32_bf16 v[236:239], a[88:91], v[56:59], v[236:239]
	v_xor_b32 v2, 0x20, v1
	v_xor_b32 v3, 0x40, v1
	v_mfma_f32_16x16x32_bf16 v[236:239], a[120:123], v[60:63], v[236:239]
	v_xor_b32 v4, 0x60, v1
	v_mov_b32 v38, v17
	v_mfma_f32_16x16x32_bf16 v[252:255], a[124:127], v[60:63], v[252:255]
	v_mov_b32 v36, v22
	v_mfma_f32_16x16x32_bf16 v[252:255], a[92:95], v[56:59], v[252:255]
	s_and_b32 s87, s60, 0
	s_lshl_b32 s87, s87, 17
	v_lshlrev_b32 v48, 16, v88
	v_and_b32 v49, 0xffff0000, v88
	v_lshlrev_b32 v50, 16, v89
	v_and_b32 v51, 0xffff0000, v89
	v_lshlrev_b32 v52, 16, v90
	v_and_b32 v53, 0xffff0000, v90
	v_lshlrev_b32 v54, 16, v91
	v_and_b32 v55, 0xffff0000, v91
	ds_write_b128 v29, v[64:67] offset:0
	v_pk_fma_f32 v[48:49], v[48:49], v[38:39], v[36:37] op_sel_hi:[1,0,0]
	v_pk_fma_f32 v[50:51], v[50:51], v[38:39], v[36:37] op_sel_hi:[1,0,0]
	v_pk_fma_f32 v[52:53], v[52:53], v[38:39], v[36:37] op_sel_hi:[1,0,0]
	v_pk_fma_f32 v[54:55], v[54:55], v[38:39], v[36:37] op_sel_hi:[1,0,0]
	v_cvt_pk_bf16_f32 v88, v48, v49
	v_cvt_pk_bf16_f32 v89, v50, v51
	v_cvt_pk_bf16_f32 v90, v52, v53
	v_cvt_pk_bf16_f32 v91, v54, v55
	ds_write_b128 v29, v[88:91] offset:6144
	v_lshlrev_b32 v56, 16, v92
	v_and_b32 v57, 0xffff0000, v92
	v_lshlrev_b32 v58, 16, v93
	v_and_b32 v59, 0xffff0000, v93
	v_lshlrev_b32 v60, 16, v94
	v_and_b32 v61, 0xffff0000, v94
	v_lshlrev_b32 v62, 16, v95
	v_and_b32 v63, 0xffff0000, v95
	ds_write_b128 v29, v[68:71] offset:1024
	v_pk_fma_f32 v[56:57], v[56:57], v[38:39], v[36:37] op_sel_hi:[1,0,0]
	v_pk_fma_f32 v[58:59], v[58:59], v[38:39], v[36:37] op_sel_hi:[1,0,0]
	v_pk_fma_f32 v[60:61], v[60:61], v[38:39], v[36:37] op_sel_hi:[1,0,0]
	v_pk_fma_f32 v[62:63], v[62:63], v[38:39], v[36:37] op_sel_hi:[1,0,0]
	v_cvt_pk_bf16_f32 v92, v56, v57
	v_cvt_pk_bf16_f32 v93, v58, v59
	v_cvt_pk_bf16_f32 v94, v60, v61
	v_cvt_pk_bf16_f32 v95, v62, v63
	ds_write_b128 v29, v[92:95] offset:7168
	v_lshlrev_b32 v48, 16, v96
	v_and_b32 v49, 0xffff0000, v96
	v_lshlrev_b32 v50, 16, v97
	v_and_b32 v51, 0xffff0000, v97
	v_lshlrev_b32 v52, 16, v98
	v_and_b32 v53, 0xffff0000, v98
	v_lshlrev_b32 v54, 16, v99
	v_and_b32 v55, 0xffff0000, v99
	ds_write_b128 v29, v[72:75] offset:2048
	v_pk_fma_f32 v[48:49], v[48:49], v[38:39], v[36:37] op_sel_hi:[1,0,0]
	v_pk_fma_f32 v[50:51], v[50:51], v[38:39], v[36:37] op_sel_hi:[1,0,0]
	v_pk_fma_f32 v[52:53], v[52:53], v[38:39], v[36:37] op_sel_hi:[1,0,0]
	v_pk_fma_f32 v[54:55], v[54:55], v[38:39], v[36:37] op_sel_hi:[1,0,0]
	v_cvt_pk_bf16_f32 v96, v48, v49
	v_cvt_pk_bf16_f32 v97, v50, v51
	v_cvt_pk_bf16_f32 v98, v52, v53
	v_cvt_pk_bf16_f32 v99, v54, v55
	ds_write_b128 v29, v[96:99] offset:8192
	v_lshlrev_b32 v56, 16, v100
	v_and_b32 v57, 0xffff0000, v100
	v_lshlrev_b32 v58, 16, v101
	v_and_b32 v59, 0xffff0000, v101
	v_lshlrev_b32 v60, 16, v102
	v_and_b32 v61, 0xffff0000, v102
	v_lshlrev_b32 v62, 16, v103
	v_and_b32 v63, 0xffff0000, v103
	ds_write_b128 v29, v[76:79] offset:3072
	v_pk_fma_f32 v[56:57], v[56:57], v[38:39], v[36:37] op_sel_hi:[1,0,0]
	v_pk_fma_f32 v[58:59], v[58:59], v[38:39], v[36:37] op_sel_hi:[1,0,0]
	v_pk_fma_f32 v[60:61], v[60:61], v[38:39], v[36:37] op_sel_hi:[1,0,0]
	v_pk_fma_f32 v[62:63], v[62:63], v[38:39], v[36:37] op_sel_hi:[1,0,0]
	v_cvt_pk_bf16_f32 v100, v56, v57
	v_cvt_pk_bf16_f32 v101, v58, v59
	v_cvt_pk_bf16_f32 v102, v60, v61
	v_cvt_pk_bf16_f32 v103, v62, v63
	ds_write_b128 v29, v[100:103] offset:9216
	v_lshlrev_b32 v48, 16, v104
	v_and_b32 v49, 0xffff0000, v104
	v_lshlrev_b32 v50, 16, v105
	v_and_b32 v51, 0xffff0000, v105
	v_lshlrev_b32 v52, 16, v106
	v_and_b32 v53, 0xffff0000, v106
	v_lshlrev_b32 v54, 16, v107
	v_and_b32 v55, 0xffff0000, v107
	ds_write_b128 v29, v[80:83] offset:4096
	v_pk_fma_f32 v[48:49], v[48:49], v[38:39], v[36:37] op_sel_hi:[1,0,0]
	v_pk_fma_f32 v[50:51], v[50:51], v[38:39], v[36:37] op_sel_hi:[1,0,0]
	v_pk_fma_f32 v[52:53], v[52:53], v[38:39], v[36:37] op_sel_hi:[1,0,0]
	v_pk_fma_f32 v[54:55], v[54:55], v[38:39], v[36:37] op_sel_hi:[1,0,0]
	v_cvt_pk_bf16_f32 v104, v48, v49
	v_cvt_pk_bf16_f32 v105, v50, v51
	v_cvt_pk_bf16_f32 v106, v52, v53
	v_cvt_pk_bf16_f32 v107, v54, v55
	ds_write_b128 v29, v[104:107] offset:10240
	v_lshlrev_b32 v56, 16, v108
	v_and_b32 v57, 0xffff0000, v108
	v_lshlrev_b32 v58, 16, v109
	v_and_b32 v59, 0xffff0000, v109
	v_lshlrev_b32 v60, 16, v110
	v_and_b32 v61, 0xffff0000, v110
	v_lshlrev_b32 v62, 16, v111
	v_and_b32 v63, 0xffff0000, v111
	ds_write_b128 v29, v[84:87] offset:5120
	v_pk_fma_f32 v[56:57], v[56:57], v[38:39], v[36:37] op_sel_hi:[1,0,0]
	v_pk_fma_f32 v[58:59], v[58:59], v[38:39], v[36:37] op_sel_hi:[1,0,0]
	v_pk_fma_f32 v[60:61], v[60:61], v[38:39], v[36:37] op_sel_hi:[1,0,0]
	v_pk_fma_f32 v[62:63], v[62:63], v[38:39], v[36:37] op_sel_hi:[1,0,0]
	v_cvt_pk_bf16_f32 v108, v56, v57
	v_cvt_pk_bf16_f32 v109, v58, v59
	v_cvt_pk_bf16_f32 v110, v60, v61
	v_cvt_pk_bf16_f32 v111, v62, v63
	ds_write_b128 v29, v[108:111] offset:11264
	v_lshlrev_b32 v48, 16, v112
	v_and_b32 v49, 0xffff0000, v112
	v_lshlrev_b32 v50, 16, v113
	v_and_b32 v51, 0xffff0000, v113
	v_lshlrev_b32 v52, 16, v114
	v_and_b32 v53, 0xffff0000, v114
	v_lshlrev_b32 v54, 16, v115
	v_and_b32 v55, 0xffff0000, v115
	v_pk_fma_f32 v[48:49], v[48:49], v[38:39], v[36:37] op_sel_hi:[1,0,0]
	v_pk_fma_f32 v[50:51], v[50:51], v[38:39], v[36:37] op_sel_hi:[1,0,0]
	v_pk_fma_f32 v[52:53], v[52:53], v[38:39], v[36:37] op_sel_hi:[1,0,0]
	v_pk_fma_f32 v[54:55], v[54:55], v[38:39], v[36:37] op_sel_hi:[1,0,0]
	v_cvt_pk_bf16_f32 v112, v48, v49
	v_cvt_pk_bf16_f32 v113, v50, v51
	v_cvt_pk_bf16_f32 v114, v52, v53
	v_cvt_pk_bf16_f32 v115, v54, v55
	ds_write_b128 v29, v[112:115] offset:12288
	v_lshlrev_b32 v56, 16, v116
	v_and_b32 v57, 0xffff0000, v116
	v_lshlrev_b32 v58, 16, v117
	v_and_b32 v59, 0xffff0000, v117
	v_lshlrev_b32 v60, 16, v118
	v_and_b32 v61, 0xffff0000, v118
	v_lshlrev_b32 v62, 16, v119
	v_and_b32 v63, 0xffff0000, v119
	v_pk_fma_f32 v[56:57], v[56:57], v[38:39], v[36:37] op_sel_hi:[1,0,0]
	v_pk_fma_f32 v[58:59], v[58:59], v[38:39], v[36:37] op_sel_hi:[1,0,0]
	v_pk_fma_f32 v[60:61], v[60:61], v[38:39], v[36:37] op_sel_hi:[1,0,0]
	v_pk_fma_f32 v[62:63], v[62:63], v[38:39], v[36:37] op_sel_hi:[1,0,0]
	v_cvt_pk_bf16_f32 v116, v56, v57
	v_cvt_pk_bf16_f32 v117, v58, v59
	v_cvt_pk_bf16_f32 v118, v60, v61
	v_cvt_pk_bf16_f32 v119, v62, v63
	ds_write_b128 v29, v[116:119] offset:13312
	v_lshlrev_b32 v48, 16, v120
	v_and_b32 v49, 0xffff0000, v120
	v_lshlrev_b32 v50, 16, v121
	v_and_b32 v51, 0xffff0000, v121
	v_lshlrev_b32 v52, 16, v122
	v_and_b32 v53, 0xffff0000, v122
	v_lshlrev_b32 v54, 16, v123
	v_and_b32 v55, 0xffff0000, v123
	v_pk_fma_f32 v[48:49], v[48:49], v[38:39], v[36:37] op_sel_hi:[1,0,0]
	v_pk_fma_f32 v[50:51], v[50:51], v[38:39], v[36:37] op_sel_hi:[1,0,0]
	v_pk_fma_f32 v[52:53], v[52:53], v[38:39], v[36:37] op_sel_hi:[1,0,0]
	v_pk_fma_f32 v[54:55], v[54:55], v[38:39], v[36:37] op_sel_hi:[1,0,0]
	v_cvt_pk_bf16_f32 v120, v48, v49
	v_cvt_pk_bf16_f32 v121, v50, v51
	v_cvt_pk_bf16_f32 v122, v52, v53
	v_cvt_pk_bf16_f32 v123, v54, v55
	ds_write_b128 v29, v[120:123] offset:14336
	v_lshlrev_b32 v56, 16, v124
	v_and_b32 v57, 0xffff0000, v124
	v_lshlrev_b32 v58, 16, v125
	v_and_b32 v59, 0xffff0000, v125
	v_lshlrev_b32 v60, 16, v126
	v_and_b32 v61, 0xffff0000, v126
	v_lshlrev_b32 v62, 16, v127
	v_and_b32 v63, 0xffff0000, v127
	v_pk_fma_f32 v[56:57], v[56:57], v[38:39], v[36:37] op_sel_hi:[1,0,0]
	v_pk_fma_f32 v[58:59], v[58:59], v[38:39], v[36:37] op_sel_hi:[1,0,0]
	v_pk_fma_f32 v[60:61], v[60:61], v[38:39], v[36:37] op_sel_hi:[1,0,0]
	v_pk_fma_f32 v[62:63], v[62:63], v[38:39], v[36:37] op_sel_hi:[1,0,0]
	v_cvt_pk_bf16_f32 v124, v56, v57
	v_cvt_pk_bf16_f32 v125, v58, v59
	v_cvt_pk_bf16_f32 v126, v60, v61
	v_cvt_pk_bf16_f32 v127, v62, v63
	ds_write_b128 v29, v[124:127] offset:15360
	s_mov_b64 exec, 0
	s_cmp_ge_u32 s84, 7
	s_cbranch_scc1 L_enter4
	s_cmp_ge_u32 s84, 5
	s_cbranch_scc1 L_enter6
	s_cmp_eq_u32 s62, 0
	s_cbranch_scc1 L_pg15
	s_cmp_eq_u32 s62, 1
	s_cbranch_scc1 L_pg16
	s_cmp_eq_u32 s62, 2
	s_cbranch_scc1 L_pg17
	s_branch L_pg18
L_enter4:
	s_cmp_eq_u32 s62, 0
	s_cbranch_scc1 L_pg30
	s_cmp_eq_u32 s62, 1
	s_cbranch_scc1 L_pg20
	s_cmp_eq_u32 s62, 2
	s_cbranch_scc1 L_pg19
	s_branch L_pg18
L_enter6:
	s_cmp_eq_u32 s62, 0
	s_cbranch_scc1 L_pg27
	s_cmp_eq_u32 s62, 1
	s_cbranch_scc1 L_pg28
	s_cmp_eq_u32 s62, 2
	s_cbranch_scc1 L_pg29
	s_branch L_pg18
L_touched1:
	s_mov_b64 exec, -1
	s_cmp_ge_u32 s84, 7
	s_cbranch_scc1 L_mlp4
	s_cmp_ge_u32 s84, 5
	s_cbranch_scc1 L_mlp6
	s_waitcnt vmcnt(20)
	ds_read_b64_tr_b16 a[0:1], v1 offset:0
	ds_read_b64_tr_b16 a[2:3], v1 offset:2048
	s_waitcnt vmcnt(16)
	ds_read_b64_tr_b16 a[4:5], v1 offset:4096
	ds_read_b64_tr_b16 a[6:7], v1 offset:6144
	ds_read_b64_tr_b16 a[8:9], v2 offset:0
	ds_read_b64_tr_b16 a[10:11], v2 offset:2048
	ds_read_b64_tr_b16 a[12:13], v2 offset:4096
	ds_read_b64_tr_b16 a[14:15], v2 offset:6144
	s_waitcnt lgkmcnt(8)
	s_barrier
	ds_read_b128 a[32:35], v13 offset:0
	ds_read_b128 a[48:51], v13 offset:1024
	ds_read_b128 a[52:55], v13 offset:17408
	ds_read_b128 a[36:39], v13 offset:16384
	ds_read_b128 a[40:43], v13 offset:32768
	ds_read_b128 a[56:59], v13 offset:33792
	ds_read_b128 a[60:63], v13 offset:50176
	ds_read_b128 a[44:47], v13 offset:49152
	s_waitcnt lgkmcnt(7)
	v_mfma_f32_16x16x32_bf16 v[64:67], a[0:3], a[32:35], 0
	s_waitcnt lgkmcnt(6)
	ds_read_b128 a[64:67], v13 offset:2048
	v_lshl_add_u32 v26, s62, 11, v13
	v_mfma_f32_16x16x32_bf16 v[64:67], a[4:7], a[48:51], v[64:67]
	s_waitcnt lgkmcnt(6)
	v_mov_b32 v28, 0xc0135761
	v_lshlrev_b32 v32, 7, v0
	v_mfma_f32_16x16x32_bf16 v[68:71], a[4:7], a[52:55], 0
	s_waitcnt lgkmcnt(5)
	ds_read_b128 a[80:83], v13 offset:3072
	v_mov_b32 v33, 0x40000000
	v_mfma_f32_16x16x32_bf16 v[68:71], a[0:3], a[36:39], v[68:71]
	s_waitcnt lgkmcnt(5)
	ds_read_b64_tr_b16 a[16:17], v3 offset:0
	v_cmp_gt_u32 vcc, 2, v0
	v_mfma_f32_16x16x32_bf16 v[72:75], a[0:3], a[40:43], 0
	s_waitcnt lgkmcnt(5)
	ds_read_b64_tr_b16 a[18:19], v3 offset:2048
	ds_read_b128 a[68:71], v13 offset:18432
	v_mfma_f32_16x16x32_bf16 v[72:75], a[4:7], a[56:59], v[72:75]
	s_waitcnt lgkmcnt(6)
	ds_read_b64_tr_b16 a[20:21], v3 offset:4096
	v_and_b32 v34, 7, v0
	v_mfma_f32_16x16x32_bf16 v[76:79], a[4:7], a[60:63], 0
	s_waitcnt lgkmcnt(6)
	ds_read_b64_tr_b16 a[22:23], v3 offset:6144
	ds_read_b128 a[84:87], v13 offset:19456
	v_mfma_f32_16x16x32_bf16 v[76:79], a[0:3], a[44:47], v[76:79]
	v_lshl_add_u32 v24, v34, 2, s90
	v_cndmask_b32 v22, v33, v32, vcc
	v_mfma_f32_16x16x32_bf16 v[92:95], a[8:11], a[44:47], 0
	ds_read_b128 a[72:75], v13 offset:34816
	v_and_b32 v32, 15, v0
	v_mfma_f32_16x16x32_bf16 v[92:95], a[12:15], a[60:63], v[92:95]
	v_lshlrev_b32 v32, 10, v32
	v_lshrrev_b32 v33, 4, v0
	v_mfma_f32_16x16x32_bf16 v[88:91], a[12:15], a[56:59], 0
	ds_read_b128 a[88:91], v13 offset:35840
	v_lshl_or_b32 v17, v33, 3, v32
	v_mfma_f32_16x16x32_bf16 v[88:91], a[8:11], a[40:43], v[88:91]
	ds_read_b64_tr_b16 a[24:25], v4 offset:0
	v_mfma_f32_16x16x32_bf16 v[84:87], a[8:11], a[36:39], 0
	ds_read_b64_tr_b16 a[26:27], v4 offset:2048
	ds_read_b128 a[76:79], v13 offset:51200
	v_mfma_f32_16x16x32_bf16 v[84:87], a[12:15], a[52:55], v[84:87]
	ds_read_b64_tr_b16 a[28:29], v4 offset:4096
	v_mfma_f32_16x16x32_bf16 v[80:83], a[12:15], a[48:51], 0
	ds_read_b64_tr_b16 a[30:31], v4 offset:6144
	ds_read_b128 a[92:95], v13 offset:52224
	v_mfma_f32_16x16x32_bf16 v[80:83], a[8:11], a[32:35], v[80:83]
	s_waitcnt lgkmcnt(10)
	v_mfma_f32_16x16x32_bf16 v[96:99], a[16:19], a[32:35], 0
	s_waitcnt lgkmcnt(8)
	v_mfma_f32_16x16x32_bf16 v[96:99], a[20:23], a[48:51], v[96:99]
	v_mfma_f32_16x16x32_bf16 v[100:103], a[20:23], a[52:55], 0
	v_mfma_f32_16x16x32_bf16 v[100:103], a[16:19], a[36:39], v[100:103]
	s_waitcnt vmcnt(12)
	ds_read_b64_tr_b16 a[0:1], v1 offset:8192
	v_mfma_f32_16x16x32_bf16 v[104:107], a[16:19], a[40:43], 0
	ds_read_b64_tr_b16 a[2:3], v1 offset:10240
	v_mfma_f32_16x16x32_bf16 v[104:107], a[20:23], a[56:59], v[104:107]
	s_waitcnt vmcnt(8)
	ds_read_b64_tr_b16 a[4:5], v1 offset:12288
	v_mfma_f32_16x16x32_bf16 v[108:111], a[20:23], a[60:63], 0
	s_add_u32 m0, s64, 0x0
	ds_read_b64_tr_b16 a[6:7], v1 offset:14336
	v_mfma_f32_16x16x32_bf16 v[108:111], a[16:19], a[44:47], v[108:111]
	s_waitcnt lgkmcnt(6)
	v_mfma_f32_16x16x32_bf16 v[124:127], a[24:27], a[44:47], 0
	s_waitcnt lgkmcnt(4)
	s_mov_b32 s66, 0xa8000
	v_mfma_f32_16x16x32_bf16 v[124:127], a[28:31], a[60:63], v[124:127]
	buffer_load_dwordx4 v15, s[32:35], s66 offen offset:0 lds
	v_mfma_f32_16x16x32_bf16 v[120:123], a[28:31], a[56:59], 0
	ds_read_b64_tr_b16 a[8:9], v2 offset:8192
	v_mfma_f32_16x16x32_bf16 v[120:123], a[24:27], a[40:43], v[120:123]
	ds_read_b64_tr_b16 a[10:11], v2 offset:10240
	v_mfma_f32_16x16x32_bf16 v[116:119], a[24:27], a[36:39], 0
	s_mov_b32 s66, 0xaec00
	ds_read_b64_tr_b16 a[12:13], v2 offset:12288
	v_mfma_f32_16x16x32_bf16 v[116:119], a[28:31], a[52:55], v[116:119]
	buffer_load_dwordx4 v15, s[32:35], s66 offen offset:1024 lds
	v_mfma_f32_16x16x32_bf16 v[112:115], a[28:31], a[48:51], 0
	ds_read_b64_tr_b16 a[14:15], v2 offset:14336
	v_mfma_f32_16x16x32_bf16 v[112:115], a[24:27], a[32:35], v[112:115]
	s_waitcnt lgkmcnt(5)
	v_mfma_f32_16x16x32_bf16 v[64:67], a[0:3], a[64:67], v[64:67]
	s_waitcnt lgkmcnt(4)
	s_mov_b32 s66, 0xb5800
	ds_read_b128 a[32:35], v13 offset:4096
	v_mfma_f32_16x16x32_bf16 v[64:67], a[4:7], a[80:83], v[64:67]
	buffer_load_dwordx4 v15, s[32:35], s66 offen offset:2048 lds
	v_mfma_f32_16x16x32_bf16 v[68:71], a[4:7], a[84:87], v[68:71]
	ds_read_b64_tr_b16 a[16:17], v3 offset:8192
	ds_read_b128 a[48:51], v13 offset:5120
	v_mfma_f32_16x16x32_bf16 v[68:71], a[0:3], a[68:71], v[68:71]
	ds_read_b64_tr_b16 a[18:19], v3 offset:10240
	v_mfma_f32_16x16x32_bf16 v[72:75], a[0:3], a[72:75], v[72:75]
	s_mov_b32 s66, 0xbc400
	ds_read_b64_tr_b16 a[20:21], v3 offset:12288
	ds_read_b128 a[36:39], v13 offset:20480
	v_mfma_f32_16x16x32_bf16 v[72:75], a[4:7], a[88:91], v[72:75]
	buffer_load_dwordx4 v15, s[32:35], s66 offen offset:3072 lds
	v_mfma_f32_16x16x32_bf16 v[76:79], a[4:7], a[92:95], v[76:79]
	s_add_u32 m0, s64, 0x1000
	ds_read_b64_tr_b16 a[22:23], v3 offset:14336
	ds_read_b128 a[52:55], v13 offset:21504
	v_mfma_f32_16x16x32_bf16 v[76:79], a[0:3], a[76:79], v[76:79]
	s_waitcnt lgkmcnt(9)
	v_mfma_f32_16x16x32_bf16 v[92:95], a[8:11], a[76:79], v[92:95]
	s_waitcnt lgkmcnt(8)
	s_mov_b32 s66, 0xc4000
	ds_read_b128 a[40:43], v13 offset:36864
	v_mfma_f32_16x16x32_bf16 v[92:95], a[12:15], a[92:95], v[92:95]
	buffer_load_dwordx4 v15, s[32:35], s66 offen offset:0 lds
	v_mfma_f32_16x16x32_bf16 v[88:91], a[12:15], a[88:91], v[88:91]
	ds_read_b64_tr_b16 a[24:25], v4 offset:8192
	ds_read_b128 a[56:59], v13 offset:37888
	v_mfma_f32_16x16x32_bf16 v[88:91], a[8:11], a[72:75], v[88:91]
	ds_read_b64_tr_b16 a[26:27], v4 offset:10240
	v_mfma_f32_16x16x32_bf16 v[84:87], a[8:11], a[68:71], v[84:87]
	s_mov_b32 s66, 0xcac00
	ds_read_b64_tr_b16 a[28:29], v4 offset:12288
	ds_read_b128 a[44:47], v13 offset:53248
	v_mfma_f32_16x16x32_bf16 v[84:87], a[12:15], a[84:87], v[84:87]
	buffer_load_dwordx4 v15, s[32:35], s66 offen offset:1024 lds
	v_mfma_f32_16x16x32_bf16 v[80:83], a[12:15], a[80:83], v[80:83]
	ds_read_b64_tr_b16 a[30:31], v4 offset:14336
	ds_read_b128 a[60:63], v13 offset:54272
	v_mfma_f32_16x16x32_bf16 v[80:83], a[8:11], a[64:67], v[80:83]
	s_waitcnt lgkmcnt(10)
	v_mfma_f32_16x16x32_bf16 v[96:99], a[16:19], a[64:67], v[96:99]
	s_waitcnt lgkmcnt(8)
	s_mov_b32 s66, 0xd1800
	v_mfma_f32_16x16x32_bf16 v[96:99], a[20:23], a[80:83], v[96:99]
	buffer_load_dwordx4 v15, s[32:35], s66 offen offset:2048 lds
	v_mfma_f32_16x16x32_bf16 v[100:103], a[20:23], a[84:87], v[100:103]
	s_waitcnt vmcnt(11)
	ds_read_b64_tr_b16 a[0:1], v1 offset:16384
	v_mfma_f32_16x16x32_bf16 v[100:103], a[16:19], a[68:71], v[100:103]
	ds_read_b64_tr_b16 a[2:3], v1 offset:18432
	v_mfma_f32_16x16x32_bf16 v[104:107], a[16:19], a[72:75], v[104:107]
	s_waitcnt vmcnt(7)
	s_mov_b32 s66, 0xd8400
	ds_read_b64_tr_b16 a[4:5], v1 offset:20480
	v_mfma_f32_16x16x32_bf16 v[104:107], a[20:23], a[88:91], v[104:107]
	buffer_load_dwordx4 v15, s[32:35], s66 offen offset:3072 lds
	v_mfma_f32_16x16x32_bf16 v[108:111], a[20:23], a[92:95], v[108:111]
	s_add_u32 m0, s64, 0x2000
	ds_read_b64_tr_b16 a[6:7], v1 offset:22528
	v_mfma_f32_16x16x32_bf16 v[108:111], a[16:19], a[76:79], v[108:111]
	s_waitcnt lgkmcnt(6)
	v_mfma_f32_16x16x32_bf16 v[124:127], a[24:27], a[76:79], v[124:127]
	s_waitcnt lgkmcnt(4)
	s_mov_b32 s66, 0xe0000
	v_mfma_f32_16x16x32_bf16 v[124:127], a[28:31], a[92:95], v[124:127]
	buffer_load_dwordx4 v15, s[32:35], s66 offen offset:0 lds
	v_mfma_f32_16x16x32_bf16 v[120:123], a[28:31], a[88:91], v[120:123]
	ds_read_b64_tr_b16 a[8:9], v2 offset:16384
	v_mfma_f32_16x16x32_bf16 v[120:123], a[24:27], a[72:75], v[120:123]
	ds_read_b64_tr_b16 a[10:11], v2 offset:18432
	v_mfma_f32_16x16x32_bf16 v[116:119], a[24:27], a[68:71], v[116:119]
	s_mov_b32 s66, 0xe6c00
	ds_read_b64_tr_b16 a[12:13], v2 offset:20480
	v_mfma_f32_16x16x32_bf16 v[116:119], a[28:31], a[84:87], v[116:119]
	buffer_load_dwordx4 v15, s[32:35], s66 offen offset:1024 lds
	v_mfma_f32_16x16x32_bf16 v[112:115], a[28:31], a[80:83], v[112:115]
	ds_read_b64_tr_b16 a[14:15], v2 offset:22528
	v_mfma_f32_16x16x32_bf16 v[112:115], a[24:27], a[64:67], v[112:115]
	s_waitcnt lgkmcnt(5)
	v_mfma_f32_16x16x32_bf16 v[64:67], a[0:3], a[32:35], v[64:67]
	s_waitcnt lgkmcnt(4)
	s_mov_b32 s66, 0xed800
	ds_read_b128 a[64:67], v13 offset:6144
	v_mfma_f32_16x16x32_bf16 v[64:67], a[4:7], a[48:51], v[64:67]
	buffer_load_dwordx4 v15, s[32:35], s66 offen offset:2048 lds
	v_mfma_f32_16x16x32_bf16 v[68:71], a[4:7], a[52:55], v[68:71]
	ds_read_b64_tr_b16 a[16:17], v3 offset:16384
	ds_read_b128 a[80:83], v13 offset:7168
	v_mfma_f32_16x16x32_bf16 v[68:71], a[0:3], a[36:39], v[68:71]
	ds_read_b64_tr_b16 a[18:19], v3 offset:18432
	v_mfma_f32_16x16x32_bf16 v[72:75], a[0:3], a[40:43], v[72:75]
	s_mov_b32 s66, 0xf4400
	ds_read_b64_tr_b16 a[20:21], v3 offset:20480
	ds_read_b128 a[68:71], v13 offset:22528
	v_mfma_f32_16x16x32_bf16 v[72:75], a[4:7], a[56:59], v[72:75]
	buffer_load_dwordx4 v15, s[32:35], s66 offen offset:3072 lds
	v_mfma_f32_16x16x32_bf16 v[76:79], a[4:7], a[60:63], v[76:79]
	s_add_u32 m0, s64, 0x3000
	ds_read_b64_tr_b16 a[22:23], v3 offset:22528
	ds_read_b128 a[84:87], v13 offset:23552
	v_mfma_f32_16x16x32_bf16 v[76:79], a[0:3], a[44:47], v[76:79]
	s_waitcnt lgkmcnt(9)
	v_mfma_f32_16x16x32_bf16 v[92:95], a[8:11], a[44:47], v[92:95]
	s_waitcnt lgkmcnt(8)
	s_mov_b32 s66, 0xfc000
	ds_read_b128 a[72:75], v13 offset:38912
	v_mfma_f32_16x16x32_bf16 v[92:95], a[12:15], a[60:63], v[92:95]
	buffer_load_dwordx4 v15, s[32:35], s66 offen offset:0 lds
	v_mfma_f32_16x16x32_bf16 v[88:91], a[12:15], a[56:59], v[88:91]
	ds_read_b64_tr_b16 a[24:25], v4 offset:16384
	ds_read_b128 a[88:91], v13 offset:39936
	v_mfma_f32_16x16x32_bf16 v[88:91], a[8:11], a[40:43], v[88:91]
	ds_read_b64_tr_b16 a[26:27], v4 offset:18432
	v_mfma_f32_16x16x32_bf16 v[84:87], a[8:11], a[36:39], v[84:87]
L_pg15:
	s_cbranch_execz L_pg21
	s_mov_b32 s66, 0x102c00
	ds_read_b64_tr_b16 a[28:29], v4 offset:20480
	ds_read_b128 a[76:79], v13 offset:55296
	v_mfma_f32_16x16x32_bf16 v[84:87], a[12:15], a[52:55], v[84:87]
	buffer_load_dwordx4 v15, s[32:35], s66 offen offset:1024 lds
	v_mfma_f32_16x16x32_bf16 v[80:83], a[12:15], a[48:51], v[80:83]
	ds_read_b64_tr_b16 a[30:31], v4 offset:22528
	ds_read_b128 a[92:95], v13 offset:56320
	v_mfma_f32_16x16x32_bf16 v[80:83], a[8:11], a[32:35], v[80:83]
	s_waitcnt lgkmcnt(10)
	v_mfma_f32_16x16x32_bf16 v[96:99], a[16:19], a[32:35], v[96:99]
	s_waitcnt lgkmcnt(8)
	s_mov_b32 s66, 0x109800
	v_mfma_f32_16x16x32_bf16 v[96:99], a[20:23], a[48:51], v[96:99]
	buffer_load_dwordx4 v15, s[32:35], s66 offen offset:2048 lds
	v_mfma_f32_16x16x32_bf16 v[100:103], a[20:23], a[52:55], v[100:103]
	s_waitcnt vmcnt(11)
	ds_read_b64_tr_b16 a[0:1], v1 offset:0
	v_mfma_f32_16x16x32_bf16 v[100:103], a[16:19], a[36:39], v[100:103]
	ds_read_b64_tr_b16 a[2:3], v1 offset:2048
	v_mfma_f32_16x16x32_bf16 v[104:107], a[16:19], a[40:43], v[104:107]
	s_waitcnt vmcnt(7)
	s_mov_b32 s66, 0x110400
	ds_read_b64_tr_b16 a[4:5], v1 offset:4096
	v_mfma_f32_16x16x32_bf16 v[104:107], a[20:23], a[56:59], v[104:107]
	buffer_load_dwordx4 v15, s[32:35], s66 offen offset:3072 lds
	v_mfma_f32_16x16x32_bf16 v[108:111], a[20:23], a[60:63], v[108:111]
	s_add_u32 m0, s64, 0x4000
	ds_read_b64_tr_b16 a[6:7], v1 offset:6144
	v_mfma_f32_16x16x32_bf16 v[108:111], a[16:19], a[44:47], v[108:111]
	s_waitcnt lgkmcnt(6)
	v_mfma_f32_16x16x32_bf16 v[124:127], a[24:27], a[44:47], v[124:127]
	s_waitcnt lgkmcnt(4)
	s_mov_b32 s66, 0x118000
	v_mfma_f32_16x16x32_bf16 v[124:127], a[28:31], a[60:63], v[124:127]
	buffer_load_dwordx4 v15, s[32:35], s66 offen offset:0 lds
	v_mfma_f32_16x16x32_bf16 v[120:123], a[28:31], a[56:59], v[120:123]
	ds_read_b64_tr_b16 a[8:9], v2 offset:0
	v_mfma_f32_16x16x32_bf16 v[120:123], a[24:27], a[40:43], v[120:123]
	ds_read_b64_tr_b16 a[10:11], v2 offset:2048
	v_mfma_f32_16x16x32_bf16 v[116:119], a[24:27], a[36:39], v[116:119]
	s_mov_b32 s66, 0x11ec00
	ds_read_b64_tr_b16 a[12:13], v2 offset:4096
	v_mfma_f32_16x16x32_bf16 v[116:119], a[28:31], a[52:55], v[116:119]
	buffer_load_dwordx4 v15, s[32:35], s66 offen offset:1024 lds
	v_mfma_f32_16x16x32_bf16 v[112:115], a[28:31], a[48:51], v[112:115]
	ds_read_b64_tr_b16 a[14:15], v2 offset:6144
	v_mfma_f32_16x16x32_bf16 v[112:115], a[24:27], a[32:35], v[112:115]
	s_waitcnt lgkmcnt(5)
	v_mfma_f32_16x16x32_bf16 v[64:67], a[0:3], a[64:67], v[64:67]
	s_waitcnt lgkmcnt(4)
	s_mov_b32 s66, 0x125800
	ds_read_b128 a[32:35], v13 offset:8192
	v_mfma_f32_16x16x32_bf16 v[64:67], a[4:7], a[80:83], v[64:67]
	buffer_load_dwordx4 v15, s[32:35], s66 offen offset:2048 lds
	v_mfma_f32_16x16x32_bf16 v[68:71], a[4:7], a[84:87], v[68:71]
	ds_read_b64_tr_b16 a[16:17], v3 offset:0
	ds_read_b128 a[48:51], v13 offset:9216
	v_mfma_f32_16x16x32_bf16 v[68:71], a[0:3], a[68:71], v[68:71]
	ds_read_b64_tr_b16 a[18:19], v3 offset:2048
	v_mfma_f32_16x16x32_bf16 v[72:75], a[0:3], a[72:75], v[72:75]
	s_mov_b32 s66, 0x12c400
	ds_read_b64_tr_b16 a[20:21], v3 offset:4096
	ds_read_b128 a[36:39], v13 offset:24576
	v_mfma_f32_16x16x32_bf16 v[72:75], a[4:7], a[88:91], v[72:75]
	buffer_load_dwordx4 v15, s[32:35], s66 offen offset:3072 lds
	v_mfma_f32_16x16x32_bf16 v[76:79], a[4:7], a[92:95], v[76:79]
	s_add_u32 m0, s64, 0x5000
	ds_read_b64_tr_b16 a[22:23], v3 offset:6144
	ds_read_b128 a[52:55], v13 offset:25600
	v_mfma_f32_16x16x32_bf16 v[76:79], a[0:3], a[76:79], v[76:79]
	s_waitcnt lgkmcnt(9)
	v_mfma_f32_16x16x32_bf16 v[92:95], a[8:11], a[76:79], v[92:95]
	s_waitcnt lgkmcnt(8)
	s_mov_b32 s66, 0x134000
	ds_read_b128 a[40:43], v13 offset:40960
	v_mfma_f32_16x16x32_bf16 v[92:95], a[12:15], a[92:95], v[92:95]
	buffer_load_dwordx4 v15, s[32:35], s66 offen offset:0 lds
	v_mfma_f32_16x16x32_bf16 v[88:91], a[12:15], a[88:91], v[88:91]
	ds_read_b64_tr_b16 a[24:25], v4 offset:0
	ds_read_b128 a[56:59], v13 offset:41984
	v_mfma_f32_16x16x32_bf16 v[88:91], a[8:11], a[72:75], v[88:91]
	ds_read_b64_tr_b16 a[26:27], v4 offset:2048
	v_mfma_f32_16x16x32_bf16 v[84:87], a[8:11], a[68:71], v[84:87]
	s_mov_b32 s66, 0x13ac00
	ds_read_b64_tr_b16 a[28:29], v4 offset:4096
	ds_read_b128 a[44:47], v13 offset:57344
	v_mfma_f32_16x16x32_bf16 v[84:87], a[12:15], a[84:87], v[84:87]
	buffer_load_dwordx4 v15, s[32:35], s66 offen offset:1024 lds
	v_mfma_f32_16x16x32_bf16 v[80:83], a[12:15], a[80:83], v[80:83]
	ds_read_b64_tr_b16 a[30:31], v4 offset:6144
	ds_read_b128 a[60:63], v13 offset:58368
	v_mfma_f32_16x16x32_bf16 v[80:83], a[8:11], a[64:67], v[80:83]
	s_waitcnt lgkmcnt(10)
	v_mfma_f32_16x16x32_bf16 v[96:99], a[16:19], a[64:67], v[96:99]
	s_waitcnt lgkmcnt(8)
	s_mov_b32 s66, 0x141800
	v_mfma_f32_16x16x32_bf16 v[96:99], a[20:23], a[80:83], v[96:99]
	buffer_load_dwordx4 v15, s[32:35], s66 offen offset:2048 lds
	v_mfma_f32_16x16x32_bf16 v[100:103], a[20:23], a[84:87], v[100:103]
	s_waitcnt vmcnt(11)
	ds_read_b64_tr_b16 a[0:1], v1 offset:8192
	v_mfma_f32_16x16x32_bf16 v[100:103], a[16:19], a[68:71], v[100:103]
	ds_read_b64_tr_b16 a[2:3], v1 offset:10240
	v_mfma_f32_16x16x32_bf16 v[104:107], a[16:19], a[72:75], v[104:107]
	s_waitcnt vmcnt(7)
	s_mov_b32 s66, 0x148400
	ds_read_b64_tr_b16 a[4:5], v1 offset:12288
	v_mfma_f32_16x16x32_bf16 v[104:107], a[20:23], a[88:91], v[104:107]
	buffer_load_dwordx4 v15, s[32:35], s66 offen offset:3072 lds
	v_mfma_f32_16x16x32_bf16 v[108:111], a[20:23], a[92:95], v[108:111]
	s_add_u32 m0, s64, 0x0
	ds_read_b64_tr_b16 a[6:7], v1 offset:14336
	v_mfma_f32_16x16x32_bf16 v[108:111], a[16:19], a[76:79], v[108:111]
	s_waitcnt lgkmcnt(6)
	v_mfma_f32_16x16x32_bf16 v[124:127], a[24:27], a[76:79], v[124:127]
	s_waitcnt lgkmcnt(4)
	s_mov_b32 s66, 0x150000
	v_mfma_f32_16x16x32_bf16 v[124:127], a[28:31], a[92:95], v[124:127]
	buffer_load_dwordx4 v15, s[32:35], s66 offen offset:0 lds
	v_mfma_f32_16x16x32_bf16 v[120:123], a[28:31], a[88:91], v[120:123]
	ds_read_b64_tr_b16 a[8:9], v2 offset:8192
	v_mfma_f32_16x16x32_bf16 v[120:123], a[24:27], a[72:75], v[120:123]
	ds_read_b64_tr_b16 a[10:11], v2 offset:10240
	v_mfma_f32_16x16x32_bf16 v[116:119], a[24:27], a[68:71], v[116:119]
	s_mov_b32 s66, 0x156c00
	ds_read_b64_tr_b16 a[12:13], v2 offset:12288
	v_mfma_f32_16x16x32_bf16 v[116:119], a[28:31], a[84:87], v[116:119]
	buffer_load_dwordx4 v15, s[32:35], s66 offen offset:1024 lds
	v_mfma_f32_16x16x32_bf16 v[112:115], a[28:31], a[80:83], v[112:115]
	ds_read_b64_tr_b16 a[14:15], v2 offset:14336
	v_mfma_f32_16x16x32_bf16 v[112:115], a[24:27], a[64:67], v[112:115]
	s_waitcnt lgkmcnt(5)
	v_mfma_f32_16x16x32_bf16 v[64:67], a[0:3], a[32:35], v[64:67]
	s_waitcnt lgkmcnt(4)
	s_mov_b32 s66, 0x15d800
	ds_read_b128 a[64:67], v13 offset:10240
	v_mfma_f32_16x16x32_bf16 v[64:67], a[4:7], a[48:51], v[64:67]
	buffer_load_dwordx4 v15, s[32:35], s66 offen offset:2048 lds
	v_mfma_f32_16x16x32_bf16 v[68:71], a[4:7], a[52:55], v[68:71]
	ds_read_b64_tr_b16 a[16:17], v3 offset:8192
	ds_read_b128 a[80:83], v13 offset:11264
	v_mfma_f32_16x16x32_bf16 v[68:71], a[0:3], a[36:39], v[68:71]
	ds_read_b64_tr_b16 a[18:19], v3 offset:10240
	v_mfma_f32_16x16x32_bf16 v[72:75], a[0:3], a[40:43], v[72:75]
	s_mov_b32 s66, 0x164400
	ds_read_b64_tr_b16 a[20:21], v3 offset:12288
	ds_read_b128 a[68:71], v13 offset:26624
	v_mfma_f32_16x16x32_bf16 v[72:75], a[4:7], a[56:59], v[72:75]
	buffer_load_dwordx4 v15, s[32:35], s66 offen offset:3072 lds
	v_mfma_f32_16x16x32_bf16 v[76:79], a[4:7], a[60:63], v[76:79]
	s_add_u32 m0, s64, 0x1000
	ds_read_b64_tr_b16 a[22:23], v3 offset:14336
	ds_read_b128 a[84:87], v13 offset:27648
	v_mfma_f32_16x16x32_bf16 v[76:79], a[0:3], a[44:47], v[76:79]
	s_waitcnt lgkmcnt(9)
	v_mfma_f32_16x16x32_bf16 v[92:95], a[8:11], a[44:47], v[92:95]
	s_waitcnt lgkmcnt(8)
	s_mov_b32 s66, 0x16c000
	ds_read_b128 a[72:75], v13 offset:43008
	v_mfma_f32_16x16x32_bf16 v[92:95], a[12:15], a[60:63], v[92:95]
	buffer_load_dwordx4 v15, s[32:35], s66 offen offset:0 lds
	v_mfma_f32_16x16x32_bf16 v[88:91], a[12:15], a[56:59], v[88:91]
	ds_read_b64_tr_b16 a[24:25], v4 offset:8192
	ds_read_b128 a[88:91], v13 offset:44032
	v_mfma_f32_16x16x32_bf16 v[88:91], a[8:11], a[40:43], v[88:91]
	ds_read_b64_tr_b16 a[26:27], v4 offset:10240
	v_mfma_f32_16x16x32_bf16 v[84:87], a[8:11], a[36:39], v[84:87]
	s_mov_b32 s66, 0x172c00
	ds_read_b64_tr_b16 a[28:29], v4 offset:12288
	ds_read_b128 a[76:79], v13 offset:59392
	v_mfma_f32_16x16x32_bf16 v[84:87], a[12:15], a[52:55], v[84:87]
	buffer_load_dwordx4 v15, s[32:35], s66 offen offset:1024 lds
	v_mfma_f32_16x16x32_bf16 v[80:83], a[12:15], a[48:51], v[80:83]
	ds_read_b64_tr_b16 a[30:31], v4 offset:14336
	ds_read_b128 a[92:95], v13 offset:60416
	v_mfma_f32_16x16x32_bf16 v[80:83], a[8:11], a[32:35], v[80:83]
	s_waitcnt lgkmcnt(10)
	v_mfma_f32_16x16x32_bf16 v[96:99], a[16:19], a[32:35], v[96:99]
	s_waitcnt lgkmcnt(8)
	s_mov_b32 s66, 0x179800
	v_mfma_f32_16x16x32_bf16 v[96:99], a[20:23], a[48:51], v[96:99]
	buffer_load_dwordx4 v15, s[32:35], s66 offen offset:2048 lds
	v_mfma_f32_16x16x32_bf16 v[100:103], a[20:23], a[52:55], v[100:103]
	s_waitcnt vmcnt(11)
	ds_read_b64_tr_b16 a[0:1], v1 offset:16384
	v_mfma_f32_16x16x32_bf16 v[100:103], a[16:19], a[36:39], v[100:103]
	ds_read_b64_tr_b16 a[2:3], v1 offset:18432
	v_mfma_f32_16x16x32_bf16 v[104:107], a[16:19], a[40:43], v[104:107]
	s_waitcnt vmcnt(7)
	s_mov_b32 s66, 0x180400
	ds_read_b64_tr_b16 a[4:5], v1 offset:20480
	v_mfma_f32_16x16x32_bf16 v[104:107], a[20:23], a[56:59], v[104:107]
	buffer_load_dwordx4 v15, s[32:35], s66 offen offset:3072 lds
	v_mfma_f32_16x16x32_bf16 v[108:111], a[20:23], a[60:63], v[108:111]
	s_add_u32 m0, s64, 0x2000
	ds_read_b64_tr_b16 a[6:7], v1 offset:22528
	v_mfma_f32_16x16x32_bf16 v[108:111], a[16:19], a[44:47], v[108:111]
	s_waitcnt lgkmcnt(6)
	v_mfma_f32_16x16x32_bf16 v[124:127], a[24:27], a[44:47], v[124:127]
	s_waitcnt lgkmcnt(4)
	s_mov_b32 s66, 0x188000
	v_mfma_f32_16x16x32_bf16 v[124:127], a[28:31], a[60:63], v[124:127]
	buffer_load_dwordx4 v15, s[32:35], s66 offen offset:0 lds
	v_mfma_f32_16x16x32_bf16 v[120:123], a[28:31], a[56:59], v[120:123]
	ds_read_b64_tr_b16 a[8:9], v2 offset:16384
	v_mfma_f32_16x16x32_bf16 v[120:123], a[24:27], a[40:43], v[120:123]
	ds_read_b64_tr_b16 a[10:11], v2 offset:18432
	v_mfma_f32_16x16x32_bf16 v[116:119], a[24:27], a[36:39], v[116:119]
	s_mov_b32 s66, 0x18ec00
	ds_read_b64_tr_b16 a[12:13], v2 offset:20480
	v_mfma_f32_16x16x32_bf16 v[116:119], a[28:31], a[52:55], v[116:119]
	buffer_load_dwordx4 v15, s[32:35], s66 offen offset:1024 lds
	v_mfma_f32_16x16x32_bf16 v[112:115], a[28:31], a[48:51], v[112:115]
	ds_read_b64_tr_b16 a[14:15], v2 offset:22528
	v_mfma_f32_16x16x32_bf16 v[112:115], a[24:27], a[32:35], v[112:115]
	s_waitcnt lgkmcnt(5)
	v_mfma_f32_16x16x32_bf16 v[64:67], a[0:3], a[64:67], v[64:67]
	s_waitcnt lgkmcnt(4)
	s_mov_b32 s66, 0x195800
	ds_read_b128 a[32:35], v13 offset:12288
	v_mfma_f32_16x16x32_bf16 v[64:67], a[4:7], a[80:83], v[64:67]
	buffer_load_dwordx4 v15, s[32:35], s66 offen offset:2048 lds
	v_mfma_f32_16x16x32_bf16 v[68:71], a[4:7], a[84:87], v[68:71]
	ds_read_b64_tr_b16 a[16:17], v3 offset:16384
	ds_read_b128 a[48:51], v13 offset:13312
	v_mfma_f32_16x16x32_bf16 v[68:71], a[0:3], a[68:71], v[68:71]
	ds_read_b64_tr_b16 a[18:19], v3 offset:18432
	v_mfma_f32_16x16x32_bf16 v[72:75], a[0:3], a[72:75], v[72:75]
	s_mov_b32 s66, 0x19c400
	ds_read_b64_tr_b16 a[20:21], v3 offset:20480
	ds_read_b128 a[36:39], v13 offset:28672
	v_mfma_f32_16x16x32_bf16 v[72:75], a[4:7], a[88:91], v[72:75]
	buffer_load_dwordx4 v15, s[32:35], s66 offen offset:3072 lds
	v_mfma_f32_16x16x32_bf16 v[76:79], a[4:7], a[92:95], v[76:79]
	s_add_u32 m0, s64, 0x3000
	ds_read_b64_tr_b16 a[22:23], v3 offset:22528
	ds_read_b128 a[52:55], v13 offset:29696
	v_mfma_f32_16x16x32_bf16 v[76:79], a[0:3], a[76:79], v[76:79]
	s_waitcnt lgkmcnt(9)
	v_mfma_f32_16x16x32_bf16 v[92:95], a[8:11], a[76:79], v[92:95]
	s_waitcnt lgkmcnt(8)
	s_mov_b32 s66, 0x1a4000
	ds_read_b128 a[40:43], v13 offset:45056
	v_mfma_f32_16x16x32_bf16 v[92:95], a[12:15], a[92:95], v[92:95]
	buffer_load_dwordx4 v15, s[32:35], s66 offen offset:0 lds
	v_mfma_f32_16x16x32_bf16 v[88:91], a[12:15], a[88:91], v[88:91]
	ds_read_b64_tr_b16 a[24:25], v4 offset:16384
	ds_read_b128 a[56:59], v13 offset:46080
	v_mfma_f32_16x16x32_bf16 v[88:91], a[8:11], a[72:75], v[88:91]
	ds_read_b64_tr_b16 a[26:27], v4 offset:18432
	v_mfma_f32_16x16x32_bf16 v[84:87], a[8:11], a[68:71], v[84:87]
	s_mov_b32 s66, 0x1aac00
	ds_read_b64_tr_b16 a[28:29], v4 offset:20480
	ds_read_b128 a[44:47], v13 offset:61440
	v_mfma_f32_16x16x32_bf16 v[84:87], a[12:15], a[84:87], v[84:87]
	buffer_load_dwordx4 v15, s[32:35], s66 offen offset:1024 lds
	v_mfma_f32_16x16x32_bf16 v[80:83], a[12:15], a[80:83], v[80:83]
	ds_read_b64_tr_b16 a[30:31], v4 offset:22528
	ds_read_b128 a[60:63], v13 offset:62464
	v_mfma_f32_16x16x32_bf16 v[80:83], a[8:11], a[64:67], v[80:83]
	s_waitcnt lgkmcnt(10)
	v_mfma_f32_16x16x32_bf16 v[96:99], a[16:19], a[64:67], v[96:99]
	s_waitcnt lgkmcnt(8)
	s_mov_b32 s66, 0x1b1800
	v_mfma_f32_16x16x32_bf16 v[96:99], a[20:23], a[80:83], v[96:99]
	buffer_load_dwordx4 v15, s[32:35], s66 offen offset:2048 lds
	v_mfma_f32_16x16x32_bf16 v[100:103], a[20:23], a[84:87], v[100:103]
	s_waitcnt vmcnt(11)
	ds_read_b64_tr_b16 a[0:1], v1 offset:0
	v_mfma_f32_16x16x32_bf16 v[100:103], a[16:19], a[68:71], v[100:103]
	ds_read_b64_tr_b16 a[2:3], v1 offset:2048
	v_mfma_f32_16x16x32_bf16 v[104:107], a[16:19], a[72:75], v[104:107]
	s_waitcnt vmcnt(7)
	s_mov_b32 s66, 0x1b8400
	ds_read_b64_tr_b16 a[4:5], v1 offset:4096
	v_mfma_f32_16x16x32_bf16 v[104:107], a[20:23], a[88:91], v[104:107]
	buffer_load_dwordx4 v15, s[32:35], s66 offen offset:3072 lds
	v_mfma_f32_16x16x32_bf16 v[108:111], a[20:23], a[92:95], v[108:111]
	s_add_u32 m0, s64, 0x4000
	ds_read_b64_tr_b16 a[6:7], v1 offset:6144
	v_mfma_f32_16x16x32_bf16 v[108:111], a[16:19], a[76:79], v[108:111]
	s_waitcnt lgkmcnt(6)
	v_mfma_f32_16x16x32_bf16 v[124:127], a[24:27], a[76:79], v[124:127]
	s_waitcnt lgkmcnt(4)
	s_mov_b32 s66, 0x0
	v_mfma_f32_16x16x32_bf16 v[124:127], a[28:31], a[92:95], v[124:127]
	buffer_load_dwordx4 v16, s[36:39], s66 offen offset:0 lds
	v_mfma_f32_16x16x32_bf16 v[120:123], a[28:31], a[88:91], v[120:123]
	ds_read_b64_tr_b16 a[8:9], v2 offset:0
	v_mfma_f32_16x16x32_bf16 v[120:123], a[24:27], a[72:75], v[120:123]
	ds_read_b64_tr_b16 a[10:11], v2 offset:2048
	v_mfma_f32_16x16x32_bf16 v[116:119], a[24:27], a[68:71], v[116:119]
	s_mov_b32 s66, 0x1c00
	ds_read_b64_tr_b16 a[12:13], v2 offset:4096
	v_mfma_f32_16x16x32_bf16 v[116:119], a[28:31], a[84:87], v[116:119]
	buffer_load_dwordx4 v16, s[36:39], s66 offen offset:1024 lds
	v_mfma_f32_16x16x32_bf16 v[112:115], a[28:31], a[80:83], v[112:115]
	ds_read_b64_tr_b16 a[14:15], v2 offset:6144
	v_mfma_f32_16x16x32_bf16 v[112:115], a[24:27], a[64:67], v[112:115]
	s_waitcnt lgkmcnt(5)
	v_mfma_f32_16x16x32_bf16 v[64:67], a[0:3], a[32:35], v[64:67]
	s_waitcnt lgkmcnt(4)
	s_mov_b32 s66, 0x3800
	ds_read_b128 a[64:67], v13 offset:14336
	v_mfma_f32_16x16x32_bf16 v[64:67], a[4:7], a[48:51], v[64:67]
	buffer_load_dwordx4 v16, s[36:39], s66 offen offset:2048 lds
	v_mfma_f32_16x16x32_bf16 v[68:71], a[4:7], a[52:55], v[68:71]
	ds_read_b64_tr_b16 a[16:17], v3 offset:0
	ds_read_b128 a[80:83], v13 offset:15360
	v_mfma_f32_16x16x32_bf16 v[68:71], a[0:3], a[36:39], v[68:71]
	ds_read_b64_tr_b16 a[18:19], v3 offset:2048
	v_mfma_f32_16x16x32_bf16 v[72:75], a[0:3], a[40:43], v[72:75]
	s_mov_b32 s66, 0x5400
	ds_read_b64_tr_b16 a[20:21], v3 offset:4096
	ds_read_b128 a[68:71], v13 offset:30720
	v_mfma_f32_16x16x32_bf16 v[72:75], a[4:7], a[56:59], v[72:75]
	buffer_load_dwordx4 v16, s[36:39], s66 offen offset:3072 lds
	v_mfma_f32_16x16x32_bf16 v[76:79], a[4:7], a[60:63], v[76:79]
	s_add_u32 m0, s64, 0x5000
	ds_read_b64_tr_b16 a[22:23], v3 offset:6144
	ds_read_b128 a[84:87], v13 offset:31744
	v_mfma_f32_16x16x32_bf16 v[76:79], a[0:3], a[44:47], v[76:79]
	s_waitcnt lgkmcnt(9)
	v_mfma_f32_16x16x32_bf16 v[92:95], a[8:11], a[44:47], v[92:95]
	s_waitcnt lgkmcnt(8)
	s_mov_b32 s66, 0x8000
	ds_read_b128 a[72:75], v13 offset:47104
	v_mfma_f32_16x16x32_bf16 v[92:95], a[12:15], a[60:63], v[92:95]
	buffer_load_dwordx4 v16, s[36:39], s66 offen offset:0 lds
	v_mfma_f32_16x16x32_bf16 v[88:91], a[12:15], a[56:59], v[88:91]
	ds_read_b64_tr_b16 a[24:25], v4 offset:0
	ds_read_b128 a[88:91], v13 offset:48128
	v_mfma_f32_16x16x32_bf16 v[88:91], a[8:11], a[40:43], v[88:91]
	ds_read_b64_tr_b16 a[26:27], v4 offset:2048
	v_mfma_f32_16x16x32_bf16 v[84:87], a[8:11], a[36:39], v[84:87]
	s_mov_b32 s66, 0x9c00
	ds_read_b64_tr_b16 a[28:29], v4 offset:4096
	ds_read_b128 a[76:79], v13 offset:63488
	v_mfma_f32_16x16x32_bf16 v[84:87], a[12:15], a[52:55], v[84:87]
	buffer_load_dwordx4 v16, s[36:39], s66 offen offset:1024 lds
	v_mfma_f32_16x16x32_bf16 v[80:83], a[12:15], a[48:51], v[80:83]
	ds_read_b64_tr_b16 a[30:31], v4 offset:6144
	ds_read_b128 a[92:95], v13 offset:64512
	v_mfma_f32_16x16x32_bf16 v[80:83], a[8:11], a[32:35], v[80:83]
	s_waitcnt lgkmcnt(10)
	v_mfma_f32_16x16x32_bf16 v[96:99], a[16:19], a[32:35], v[96:99]
	s_waitcnt lgkmcnt(8)
	s_mov_b32 s66, 0xb800
	v_mfma_f32_16x16x32_bf16 v[96:99], a[20:23], a[48:51], v[96:99]
	buffer_load_dwordx4 v16, s[36:39], s66 offen offset:2048 lds
	v_mfma_f32_16x16x32_bf16 v[100:103], a[20:23], a[52:55], v[100:103]
	s_waitcnt vmcnt(11)
	ds_read_b64_tr_b16 a[0:1], v1 offset:8192
	v_mfma_f32_16x16x32_bf16 v[100:103], a[16:19], a[36:39], v[100:103]
	ds_read_b64_tr_b16 a[2:3], v1 offset:10240
	v_mfma_f32_16x16x32_bf16 v[104:107], a[16:19], a[40:43], v[104:107]
	s_waitcnt vmcnt(7)
	s_mov_b32 s66, 0xd400
	ds_read_b64_tr_b16 a[4:5], v1 offset:12288
	v_mfma_f32_16x16x32_bf16 v[104:107], a[20:23], a[56:59], v[104:107]
	buffer_load_dwordx4 v16, s[36:39], s66 offen offset:3072 lds
	v_mfma_f32_16x16x32_bf16 v[108:111], a[20:23], a[60:63], v[108:111]
	s_add_u32 m0, s64, 0x0
	ds_read_b64_tr_b16 a[6:7], v1 offset:14336
	v_mfma_f32_16x16x32_bf16 v[108:111], a[16:19], a[44:47], v[108:111]
	s_waitcnt lgkmcnt(6)
	v_mfma_f32_16x16x32_bf16 v[124:127], a[24:27], a[44:47], v[124:127]
	s_waitcnt lgkmcnt(4)
	s_mov_b32 s66, 0x10000
	v_mfma_f32_16x16x32_bf16 v[124:127], a[28:31], a[60:63], v[124:127]
	buffer_load_dwordx4 v16, s[36:39], s66 offen offset:0 lds
	v_mfma_f32_16x16x32_bf16 v[120:123], a[28:31], a[56:59], v[120:123]
	ds_read_b64_tr_b16 a[8:9], v2 offset:8192
	v_mfma_f32_16x16x32_bf16 v[120:123], a[24:27], a[40:43], v[120:123]
	ds_read_b64_tr_b16 a[10:11], v2 offset:10240
	v_mfma_f32_16x16x32_bf16 v[116:119], a[24:27], a[36:39], v[116:119]
	s_mov_b32 s66, 0x11c00
	ds_read_b64_tr_b16 a[12:13], v2 offset:12288
	v_mfma_f32_16x16x32_bf16 v[116:119], a[28:31], a[52:55], v[116:119]
	buffer_load_dwordx4 v16, s[36:39], s66 offen offset:1024 lds
	v_mfma_f32_16x16x32_bf16 v[112:115], a[28:31], a[48:51], v[112:115]
	ds_read_b64_tr_b16 a[14:15], v2 offset:14336
	v_mfma_f32_16x16x32_bf16 v[112:115], a[24:27], a[32:35], v[112:115]
	s_waitcnt lgkmcnt(5)
	v_mfma_f32_16x16x32_bf16 v[64:67], a[0:3], a[64:67], v[64:67]
	s_waitcnt lgkmcnt(4)
	s_mov_b32 s66, 0x13800
	v_mfma_f32_16x16x32_bf16 v[64:67], a[4:7], a[80:83], v[64:67]
	buffer_load_dwordx4 v16, s[36:39], s66 offen offset:2048 lds
	v_mfma_f32_16x16x32_bf16 v[68:71], a[4:7], a[84:87], v[68:71]
	ds_read_b64_tr_b16 a[16:17], v3 offset:8192
	v_mfma_f32_16x16x32_bf16 v[68:71], a[0:3], a[68:71], v[68:71]
	ds_read_b64_tr_b16 a[18:19], v3 offset:10240
	v_mfma_f32_16x16x32_bf16 v[72:75], a[0:3], a[72:75], v[72:75]
	s_mov_b32 s66, 0x15400
	ds_read_b64_tr_b16 a[20:21], v3 offset:12288
	v_mfma_f32_16x16x32_bf16 v[72:75], a[4:7], a[88:91], v[72:75]
	buffer_load_dwordx4 v16, s[36:39], s66 offen offset:3072 lds
	v_mfma_f32_16x16x32_bf16 v[76:79], a[4:7], a[92:95], v[76:79]
	s_add_u32 m0, s64, 0x1000
	ds_read_b64_tr_b16 a[22:23], v3 offset:14336
	v_mfma_f32_16x16x32_bf16 v[76:79], a[0:3], a[76:79], v[76:79]
	s_waitcnt lgkmcnt(5)
	v_mfma_f32_16x16x32_bf16 v[92:95], a[8:11], a[76:79], v[92:95]
	s_waitcnt lgkmcnt(4)
	s_mov_b32 s66, 0x18000
	v_mfma_f32_16x16x32_bf16 v[92:95], a[12:15], a[92:95], v[92:95]
	buffer_load_dwordx4 v16, s[36:39], s66 offen offset:0 lds
	v_mfma_f32_16x16x32_bf16 v[88:91], a[12:15], a[88:91], v[88:91]
	ds_read_b64_tr_b16 a[24:25], v4 offset:8192
	v_mfma_f32_16x16x32_bf16 v[88:91], a[8:11], a[72:75], v[88:91]
	ds_read_b64_tr_b16 a[26:27], v4 offset:10240
	v_mfma_f32_16x16x32_bf16 v[84:87], a[8:11], a[68:71], v[84:87]
	s_mov_b32 s66, 0x19c00
	ds_read_b64_tr_b16 a[28:29], v4 offset:12288
	v_mfma_f32_16x16x32_bf16 v[84:87], a[12:15], a[84:87], v[84:87]
	buffer_load_dwordx4 v16, s[36:39], s66 offen offset:1024 lds
	v_mfma_f32_16x16x32_bf16 v[80:83], a[12:15], a[80:83], v[80:83]
	ds_read_b64_tr_b16 a[30:31], v4 offset:14336
	v_mfma_f32_16x16x32_bf16 v[80:83], a[8:11], a[64:67], v[80:83]
	s_waitcnt lgkmcnt(5)
	v_mfma_f32_16x16x32_bf16 v[96:99], a[16:19], a[64:67], v[96:99]
	s_waitcnt lgkmcnt(4)
	s_mov_b32 s66, 0x1b800
	v_mfma_f32_16x16x32_bf16 v[96:99], a[20:23], a[80:83], v[96:99]
	buffer_load_dwordx4 v16, s[36:39], s66 offen offset:2048 lds
	v_mfma_f32_16x16x32_bf16 v[100:103], a[20:23], a[84:87], v[100:103]
	v_mfma_f32_16x16x32_bf16 v[100:103], a[16:19], a[68:71], v[100:103]
	v_mfma_f32_16x16x32_bf16 v[104:107], a[16:19], a[72:75], v[104:107]
	s_mov_b32 s66, 0x1d400
	v_mfma_f32_16x16x32_bf16 v[104:107], a[20:23], a[88:91], v[104:107]
	buffer_load_dwordx4 v16, s[36:39], s66 offen offset:3072 lds
	v_mfma_f32_16x16x32_bf16 v[108:111], a[20:23], a[92:95], v[108:111]
	s_add_u32 m0, s64, 0x2000
	v_mfma_f32_16x16x32_bf16 v[108:111], a[16:19], a[76:79], v[108:111]
	s_waitcnt lgkmcnt(1)
	v_mfma_f32_16x16x32_bf16 v[124:127], a[24:27], a[76:79], v[124:127]
	s_waitcnt lgkmcnt(0)
	s_mov_b32 s66, 0x20000
	v_mfma_f32_16x16x32_bf16 v[124:127], a[28:31], a[92:95], v[124:127]
	buffer_load_dwordx4 v16, s[36:39], s66 offen offset:0 lds
	v_mfma_f32_16x16x32_bf16 v[120:123], a[28:31], a[88:91], v[120:123]
	v_mfma_f32_16x16x32_bf16 v[120:123], a[24:27], a[72:75], v[120:123]
	v_mfma_f32_16x16x32_bf16 v[116:119], a[24:27], a[68:71], v[116:119]
	s_mov_b32 s66, 0x21c00
	v_mfma_f32_16x16x32_bf16 v[116:119], a[28:31], a[84:87], v[116:119]
	buffer_load_dwordx4 v16, s[36:39], s66 offen offset:1024 lds
	v_mfma_f32_16x16x32_bf16 v[112:115], a[28:31], a[80:83], v[112:115]
	v_mfma_f32_16x16x32_bf16 v[112:115], a[24:27], a[64:67], v[112:115]
	s_barrier
	s_nop 0
	v_pk_mul_f32 v[48:49], v[64:65], v[64:65]
	v_pk_mul_f32 v[50:51], v[66:67], v[66:67]
	v_pk_fma_f32 v[48:49], v[48:49], s[76:77], v[28:29] op_sel_hi:[1,1,0]
	v_pk_fma_f32 v[50:51], v[50:51], s[76:77], v[28:29] op_sel_hi:[1,1,0]
	v_pk_mul_f32 v[48:49], v[48:49], v[64:65]
	v_pk_mul_f32 v[50:51], v[50:51], v[66:67]
	v_exp_f32 v48, v48
	v_exp_f32 v49, v49
	v_exp_f32 v50, v50
	v_exp_f32 v51, v51
	v_pk_add_f32 v[48:49], v[48:49], 1.0 op_sel_hi:[1,0]
	v_pk_add_f32 v[50:51], v[50:51], 1.0 op_sel_hi:[1,0]
	v_rcp_f32 v48, v48
	v_rcp_f32 v49, v49
	v_rcp_f32 v50, v50
	v_rcp_f32 v51, v51
	v_pk_mul_f32 v[48:49], v[48:49], v[64:65]
	v_pk_mul_f32 v[50:51], v[50:51], v[66:67]
	v_cvt_pk_bf16_f32 v32, v48, v49
	v_cvt_pk_bf16_f32 v33, v50, v51
	v_pk_mul_f32 v[52:53], v[80:81], v[80:81]
	v_pk_mul_f32 v[54:55], v[82:83], v[82:83]
	v_pk_fma_f32 v[52:53], v[52:53], s[76:77], v[28:29] op_sel_hi:[1,1,0]
	v_pk_fma_f32 v[54:55], v[54:55], s[76:77], v[28:29] op_sel_hi:[1,1,0]
	v_pk_mul_f32 v[52:53], v[52:53], v[80:81]
	v_pk_mul_f32 v[54:55], v[54:55], v[82:83]
	v_exp_f32 v52, v52
	v_exp_f32 v53, v53
	v_exp_f32 v54, v54
	v_exp_f32 v55, v55
	v_pk_add_f32 v[52:53], v[52:53], 1.0 op_sel_hi:[1,0]
	v_pk_add_f32 v[54:55], v[54:55], 1.0 op_sel_hi:[1,0]
	v_rcp_f32 v52, v52
	v_rcp_f32 v53, v53
	v_rcp_f32 v54, v54
	v_rcp_f32 v55, v55
	v_pk_mul_f32 v[52:53], v[52:53], v[80:81]
	v_pk_mul_f32 v[54:55], v[54:55], v[82:83]
	v_cvt_pk_bf16_f32 v34, v52, v53
	v_cvt_pk_bf16_f32 v35, v54, v55
	ds_write_b128 v26, v[32:35] offset:16384
	v_pk_mul_f32 v[48:49], v[68:69], v[68:69]
	v_pk_mul_f32 v[50:51], v[70:71], v[70:71]
	v_pk_fma_f32 v[48:49], v[48:49], s[76:77], v[28:29] op_sel_hi:[1,1,0]
	v_pk_fma_f32 v[50:51], v[50:51], s[76:77], v[28:29] op_sel_hi:[1,1,0]
	v_pk_mul_f32 v[48:49], v[48:49], v[68:69]
	v_pk_mul_f32 v[50:51], v[50:51], v[70:71]
	v_exp_f32 v48, v48
	v_exp_f32 v49, v49
	v_exp_f32 v50, v50
	v_exp_f32 v51, v51
	v_pk_add_f32 v[48:49], v[48:49], 1.0 op_sel_hi:[1,0]
	v_pk_add_f32 v[50:51], v[50:51], 1.0 op_sel_hi:[1,0]
	v_rcp_f32 v48, v48
	v_rcp_f32 v49, v49
	v_rcp_f32 v50, v50
	v_rcp_f32 v51, v51
	v_pk_mul_f32 v[48:49], v[48:49], v[68:69]
	v_pk_mul_f32 v[50:51], v[50:51], v[70:71]
	v_cvt_pk_bf16_f32 v36, v48, v49
	v_cvt_pk_bf16_f32 v37, v50, v51
	v_pk_mul_f32 v[52:53], v[84:85], v[84:85]
	v_pk_mul_f32 v[54:55], v[86:87], v[86:87]
	v_pk_fma_f32 v[52:53], v[52:53], s[76:77], v[28:29] op_sel_hi:[1,1,0]
	v_pk_fma_f32 v[54:55], v[54:55], s[76:77], v[28:29] op_sel_hi:[1,1,0]
	v_pk_mul_f32 v[52:53], v[52:53], v[84:85]
	v_pk_mul_f32 v[54:55], v[54:55], v[86:87]
	v_exp_f32 v52, v52
	v_exp_f32 v53, v53
	v_exp_f32 v54, v54
	v_exp_f32 v55, v55
	v_pk_add_f32 v[52:53], v[52:53], 1.0 op_sel_hi:[1,0]
	v_pk_add_f32 v[54:55], v[54:55], 1.0 op_sel_hi:[1,0]
	v_rcp_f32 v52, v52
	v_rcp_f32 v53, v53
	v_rcp_f32 v54, v54
	v_rcp_f32 v55, v55
	v_pk_mul_f32 v[52:53], v[52:53], v[84:85]
	v_pk_mul_f32 v[54:55], v[54:55], v[86:87]
	v_cvt_pk_bf16_f32 v38, v52, v53
	v_cvt_pk_bf16_f32 v39, v54, v55
	ds_write_b128 v26, v[36:39] offset:24576
	v_pk_mul_f32 v[48:49], v[72:73], v[72:73]
	v_pk_mul_f32 v[50:51], v[74:75], v[74:75]
	v_pk_fma_f32 v[48:49], v[48:49], s[76:77], v[28:29] op_sel_hi:[1,1,0]
	v_pk_fma_f32 v[50:51], v[50:51], s[76:77], v[28:29] op_sel_hi:[1,1,0]
	v_pk_mul_f32 v[48:49], v[48:49], v[72:73]
	v_pk_mul_f32 v[50:51], v[50:51], v[74:75]
	v_exp_f32 v48, v48
	v_exp_f32 v49, v49
	v_exp_f32 v50, v50
	v_exp_f32 v51, v51
	v_pk_add_f32 v[48:49], v[48:49], 1.0 op_sel_hi:[1,0]
	v_pk_add_f32 v[50:51], v[50:51], 1.0 op_sel_hi:[1,0]
	v_rcp_f32 v48, v48
	v_rcp_f32 v49, v49
	v_rcp_f32 v50, v50
	v_rcp_f32 v51, v51
	v_pk_mul_f32 v[48:49], v[48:49], v[72:73]
	v_pk_mul_f32 v[50:51], v[50:51], v[74:75]
	v_cvt_pk_bf16_f32 v40, v48, v49
	v_cvt_pk_bf16_f32 v41, v50, v51
	v_pk_mul_f32 v[52:53], v[88:89], v[88:89]
	v_pk_mul_f32 v[54:55], v[90:91], v[90:91]
	v_pk_fma_f32 v[52:53], v[52:53], s[76:77], v[28:29] op_sel_hi:[1,1,0]
	v_pk_fma_f32 v[54:55], v[54:55], s[76:77], v[28:29] op_sel_hi:[1,1,0]
	v_pk_mul_f32 v[52:53], v[52:53], v[88:89]
	v_pk_mul_f32 v[54:55], v[54:55], v[90:91]
L_pg16:
	s_cbranch_execz L_pg20
	v_exp_f32 v52, v52
	v_exp_f32 v53, v53
	v_exp_f32 v54, v54
	v_exp_f32 v55, v55
	v_pk_add_f32 v[52:53], v[52:53], 1.0 op_sel_hi:[1,0]
	v_pk_add_f32 v[54:55], v[54:55], 1.0 op_sel_hi:[1,0]
	v_rcp_f32 v52, v52
	v_rcp_f32 v53, v53
	v_rcp_f32 v54, v54
	v_rcp_f32_e64 v55, v55
	v_pk_mul_f32 v[52:53], v[52:53], v[88:89]
	v_pk_mul_f32 v[54:55], v[54:55], v[90:91]
	v_cvt_pk_bf16_f32 v42, v52, v53
	v_cvt_pk_bf16_f32 v43, v54, v55
	ds_write_b128 v26, v[40:43] offset:49152
	v_pk_mul_f32 v[48:49], v[76:77], v[76:77]
	v_pk_mul_f32 v[50:51], v[78:79], v[78:79]
	v_pk_fma_f32 v[48:49], v[48:49], s[76:77], v[28:29] op_sel_hi:[1,1,0]
	v_pk_fma_f32 v[50:51], v[50:51], s[76:77], v[28:29] op_sel_hi:[1,1,0]
	v_pk_mul_f32 v[48:49], v[48:49], v[76:77]
	v_pk_mul_f32 v[50:51], v[50:51], v[78:79]
	v_exp_f32 v48, v48
	v_exp_f32 v49, v49
	v_exp_f32 v50, v50
	v_exp_f32 v51, v51
	v_pk_add_f32 v[48:49], v[48:49], 1.0 op_sel_hi:[1,0]
	v_pk_add_f32 v[50:51], v[50:51], 1.0 op_sel_hi:[1,0]
	v_rcp_f32 v48, v48
	v_rcp_f32 v49, v49
	v_rcp_f32 v50, v50
	v_rcp_f32 v51, v51
	v_pk_mul_f32 v[48:49], v[48:49], v[76:77]
	v_pk_mul_f32 v[50:51], v[50:51], v[78:79]
	v_cvt_pk_bf16_f32 v44, v48, v49
	v_cvt_pk_bf16_f32 v45, v50, v51
	v_pk_mul_f32 v[52:53], v[92:93], v[92:93]
	v_pk_mul_f32 v[54:55], v[94:95], v[94:95]
	v_pk_fma_f32 v[52:53], v[52:53], s[76:77], v[28:29] op_sel_hi:[1,1,0]
	v_pk_fma_f32 v[54:55], v[54:55], s[76:77], v[28:29] op_sel_hi:[1,1,0]
	v_pk_mul_f32 v[52:53], v[52:53], v[92:93]
	v_pk_mul_f32 v[54:55], v[54:55], v[94:95]
	v_exp_f32 v52, v52
	v_exp_f32 v53, v53
	v_exp_f32 v54, v54
	v_exp_f32 v55, v55
	v_pk_add_f32 v[52:53], v[52:53], 1.0 op_sel_hi:[1,0]
	v_pk_add_f32 v[54:55], v[54:55], 1.0 op_sel_hi:[1,0]
	v_rcp_f32 v52, v52
	v_rcp_f32 v53, v53
	v_rcp_f32 v54, v54
	v_rcp_f32 v55, v55
	v_pk_mul_f32 v[52:53], v[52:53], v[92:93]
	v_pk_mul_f32 v[54:55], v[54:55], v[94:95]
	v_cvt_pk_bf16_f32 v46, v52, v53
	v_cvt_pk_bf16_f32 v47, v54, v55
	ds_write_b128 v26, v[44:47] offset:57344
	v_pk_mul_f32 v[48:49], v[96:97], v[96:97]
	v_pk_mul_f32 v[50:51], v[98:99], v[98:99]
	v_pk_fma_f32 v[48:49], v[48:49], s[76:77], v[28:29] op_sel_hi:[1,1,0]
	v_pk_fma_f32 v[50:51], v[50:51], s[76:77], v[28:29] op_sel_hi:[1,1,0]
	v_pk_mul_f32 v[48:49], v[48:49], v[96:97]
	v_pk_mul_f32 v[50:51], v[50:51], v[98:99]
	v_exp_f32 v48, v48
	v_exp_f32 v49, v49
	v_exp_f32 v50, v50
	v_exp_f32 v51, v51
	v_pk_add_f32 v[48:49], v[48:49], 1.0 op_sel_hi:[1,0]
	v_pk_add_f32 v[50:51], v[50:51], 1.0 op_sel_hi:[1,0]
	v_rcp_f32 v48, v48
	v_rcp_f32 v49, v49
	v_rcp_f32 v50, v50
	v_rcp_f32 v51, v51
	v_pk_mul_f32 v[48:49], v[48:49], v[96:97]
	v_pk_mul_f32 v[50:51], v[50:51], v[98:99]
	v_cvt_pk_bf16_f32 v32, v48, v49
	v_cvt_pk_bf16_f32 v33, v50, v51
	v_pk_mul_f32 v[52:53], v[112:113], v[112:113]
	v_pk_mul_f32 v[54:55], v[114:115], v[114:115]
	v_pk_fma_f32 v[52:53], v[52:53], s[76:77], v[28:29] op_sel_hi:[1,1,0]
	v_pk_fma_f32 v[54:55], v[54:55], s[76:77], v[28:29] op_sel_hi:[1,1,0]
	v_pk_mul_f32 v[52:53], v[52:53], v[112:113]
	v_pk_mul_f32 v[54:55], v[54:55], v[114:115]
	v_exp_f32 v52, v52
	v_exp_f32 v53, v53
	v_exp_f32 v54, v54
	v_exp_f32 v55, v55
	v_pk_add_f32 v[52:53], v[52:53], 1.0 op_sel_hi:[1,0]
	v_pk_add_f32 v[54:55], v[54:55], 1.0 op_sel_hi:[1,0]
	v_rcp_f32 v52, v52
	v_rcp_f32 v53, v53
	v_rcp_f32 v54, v54
	v_rcp_f32 v55, v55
	v_pk_mul_f32 v[52:53], v[52:53], v[112:113]
	v_pk_mul_f32 v[54:55], v[54:55], v[114:115]
	v_cvt_pk_bf16_f32 v34, v52, v53
	v_cvt_pk_bf16_f32 v35, v54, v55
	ds_write_b128 v26, v[32:35] offset:17408
	v_pk_mul_f32 v[48:49], v[100:101], v[100:101]
	v_pk_mul_f32 v[50:51], v[102:103], v[102:103]
	v_pk_fma_f32 v[48:49], v[48:49], s[76:77], v[28:29] op_sel_hi:[1,1,0]
	v_pk_fma_f32 v[50:51], v[50:51], s[76:77], v[28:29] op_sel_hi:[1,1,0]
	v_pk_mul_f32 v[48:49], v[48:49], v[100:101]
	v_pk_mul_f32 v[50:51], v[50:51], v[102:103]
	v_exp_f32 v48, v48
	v_exp_f32 v49, v49
	v_exp_f32 v50, v50
	v_exp_f32 v51, v51
	v_pk_add_f32 v[48:49], v[48:49], 1.0 op_sel_hi:[1,0]
	v_pk_add_f32 v[50:51], v[50:51], 1.0 op_sel_hi:[1,0]
	v_rcp_f32 v48, v48
	v_rcp_f32 v49, v49
	v_rcp_f32 v50, v50
	v_rcp_f32 v51, v51
	v_pk_mul_f32 v[48:49], v[48:49], v[100:101]
	v_pk_mul_f32 v[50:51], v[50:51], v[102:103]
	v_cvt_pk_bf16_f32 v36, v48, v49
	v_cvt_pk_bf16_f32 v37, v50, v51
	v_pk_mul_f32 v[52:53], v[116:117], v[116:117]
	v_pk_mul_f32 v[54:55], v[118:119], v[118:119]
	v_pk_fma_f32 v[52:53], v[52:53], s[76:77], v[28:29] op_sel_hi:[1,1,0]
	v_pk_fma_f32 v[54:55], v[54:55], s[76:77], v[28:29] op_sel_hi:[1,1,0]
	v_pk_mul_f32 v[52:53], v[52:53], v[116:117]
	v_pk_mul_f32 v[54:55], v[54:55], v[118:119]
	v_exp_f32 v52, v52
	v_exp_f32 v53, v53
	v_exp_f32 v54, v54
	v_exp_f32 v55, v55
	v_pk_add_f32 v[52:53], v[52:53], 1.0 op_sel_hi:[1,0]
	v_pk_add_f32 v[54:55], v[54:55], 1.0 op_sel_hi:[1,0]
	v_rcp_f32 v52, v52
	v_rcp_f32 v53, v53
	v_rcp_f32 v54, v54
	v_rcp_f32 v55, v55
	v_pk_mul_f32 v[52:53], v[52:53], v[116:117]
	v_pk_mul_f32 v[54:55], v[54:55], v[118:119]
	v_cvt_pk_bf16_f32 v38, v52, v53
	v_cvt_pk_bf16_f32 v39, v54, v55
	ds_write_b128 v26, v[36:39] offset:25600
	v_pk_mul_f32 v[48:49], v[104:105], v[104:105]
	v_pk_mul_f32 v[50:51], v[106:107], v[106:107]
	v_pk_fma_f32 v[48:49], v[48:49], s[76:77], v[28:29] op_sel_hi:[1,1,0]
	v_pk_fma_f32 v[50:51], v[50:51], s[76:77], v[28:29] op_sel_hi:[1,1,0]
	v_pk_mul_f32 v[48:49], v[48:49], v[104:105]
	v_pk_mul_f32 v[50:51], v[50:51], v[106:107]
	v_exp_f32 v48, v48
	v_exp_f32 v49, v49
	v_exp_f32 v50, v50
	v_exp_f32 v51, v51
	v_pk_add_f32 v[48:49], v[48:49], 1.0 op_sel_hi:[1,0]
	v_pk_add_f32 v[50:51], v[50:51], 1.0 op_sel_hi:[1,0]
	v_rcp_f32 v48, v48
	v_rcp_f32 v49, v49
	v_rcp_f32 v50, v50
	v_rcp_f32 v51, v51
	v_pk_mul_f32 v[48:49], v[48:49], v[104:105]
	v_pk_mul_f32 v[50:51], v[50:51], v[106:107]
	v_cvt_pk_bf16_f32 v40, v48, v49
	v_cvt_pk_bf16_f32 v41, v50, v51
	v_pk_mul_f32 v[52:53], v[120:121], v[120:121]
	v_pk_mul_f32 v[54:55], v[122:123], v[122:123]
	v_pk_fma_f32 v[52:53], v[52:53], s[76:77], v[28:29] op_sel_hi:[1,1,0]
	v_pk_fma_f32 v[54:55], v[54:55], s[76:77], v[28:29] op_sel_hi:[1,1,0]
	v_pk_mul_f32 v[52:53], v[52:53], v[120:121]
	v_pk_mul_f32 v[54:55], v[54:55], v[122:123]
	v_exp_f32 v52, v52
	v_exp_f32 v53, v53
	v_exp_f32 v54, v54
	v_exp_f32 v55, v55
	v_pk_add_f32 v[52:53], v[52:53], 1.0 op_sel_hi:[1,0]
	v_pk_add_f32 v[54:55], v[54:55], 1.0 op_sel_hi:[1,0]
	v_rcp_f32 v52, v52
	v_rcp_f32 v53, v53
	v_rcp_f32 v54, v54
	v_rcp_f32 v55, v55
	v_pk_mul_f32 v[52:53], v[52:53], v[120:121]
	v_pk_mul_f32 v[54:55], v[54:55], v[122:123]
	v_cvt_pk_bf16_f32 v42, v52, v53
	v_cvt_pk_bf16_f32 v43, v54, v55
	ds_write_b128 v26, v[40:43] offset:50176
	v_pk_mul_f32 v[48:49], v[108:109], v[108:109]
	v_pk_mul_f32 v[50:51], v[110:111], v[110:111]
	v_pk_fma_f32 v[48:49], v[48:49], s[76:77], v[28:29] op_sel_hi:[1,1,0]
	v_pk_fma_f32 v[50:51], v[50:51], s[76:77], v[28:29] op_sel_hi:[1,1,0]
	v_pk_mul_f32 v[48:49], v[48:49], v[108:109]
	v_pk_mul_f32 v[50:51], v[50:51], v[110:111]
	v_exp_f32 v48, v48
	v_exp_f32 v49, v49
	v_exp_f32 v50, v50
	v_exp_f32 v51, v51
	v_pk_add_f32 v[48:49], v[48:49], 1.0 op_sel_hi:[1,0]
	v_pk_add_f32 v[50:51], v[50:51], 1.0 op_sel_hi:[1,0]
	v_rcp_f32 v48, v48
	v_rcp_f32 v49, v49
	v_rcp_f32 v50, v50
	v_rcp_f32 v51, v51
	v_pk_mul_f32 v[48:49], v[48:49], v[108:109]
	v_pk_mul_f32 v[50:51], v[50:51], v[110:111]
	v_cvt_pk_bf16_f32 v44, v48, v49
	v_cvt_pk_bf16_f32 v45, v50, v51
	v_pk_mul_f32 v[52:53], v[124:125], v[124:125]
	v_pk_mul_f32 v[54:55], v[126:127], v[126:127]
	v_pk_fma_f32 v[52:53], v[52:53], s[76:77], v[28:29] op_sel_hi:[1,1,0]
	v_pk_fma_f32 v[54:55], v[54:55], s[76:77], v[28:29] op_sel_hi:[1,1,0]
	v_pk_mul_f32 v[52:53], v[52:53], v[124:125]
	v_pk_mul_f32 v[54:55], v[54:55], v[126:127]
	v_exp_f32 v52, v52
	v_exp_f32 v53, v53
	v_exp_f32 v54, v54
	v_exp_f32 v55, v55
	v_pk_add_f32 v[52:53], v[52:53], 1.0 op_sel_hi:[1,0]
	v_pk_add_f32 v[54:55], v[54:55], 1.0 op_sel_hi:[1,0]
	v_rcp_f32 v52, v52
	v_rcp_f32 v53, v53
	v_rcp_f32 v54, v54
	v_rcp_f32 v55, v55
	v_pk_mul_f32 v[52:53], v[52:53], v[124:125]
	v_pk_mul_f32 v[54:55], v[54:55], v[126:127]
	v_cvt_pk_bf16_f32 v46, v52, v53
	v_cvt_pk_bf16_f32 v47, v54, v55
	ds_write_b128 v26, v[44:47] offset:58368
	s_waitcnt vmcnt(14)
	ds_read_b64_tr_b16 a[0:1], v1 offset:16384
	ds_read_b64_tr_b16 a[2:3], v1 offset:18432
	s_waitcnt vmcnt(10)
	ds_read_b64_tr_b16 a[4:5], v1 offset:20480
	ds_read_b64_tr_b16 a[6:7], v1 offset:22528
	ds_read_b64_tr_b16 a[8:9], v2 offset:16384
	ds_read_b64_tr_b16 a[10:11], v2 offset:18432
	ds_read_b64_tr_b16 a[12:13], v2 offset:20480
	ds_read_b64_tr_b16 a[14:15], v2 offset:22528
	s_waitcnt lgkmcnt(8)
	s_barrier
	ds_read_b128 a[32:35], v13 offset:16384
	ds_read_b128 a[48:51], v13 offset:17408
	ds_read_b128 a[52:55], v13 offset:25600
	ds_read_b128 a[36:39], v13 offset:24576
	ds_read_b128 a[40:43], v13 offset:49152
	ds_read_b128 a[56:59], v13 offset:50176
	ds_read_b128 a[60:63], v13 offset:58368
	ds_read_b128 a[44:47], v13 offset:57344
	s_waitcnt lgkmcnt(7)
	v_mfma_f32_16x16x32_bf16 v[64:67], a[0:3], a[32:35], 0
	s_add_u32 m0, s64, 0x2000
	s_mov_b32 s66, 0x23800
	ds_read_b64_tr_b16 a[16:17], v3 offset:16384
	ds_read_b128 a[64:67], v13 offset:18432
	s_waitcnt lgkmcnt(8)
	v_mfma_f32_16x16x32_bf16 v[64:67], a[4:7], a[48:51], v[64:67]
	s_waitcnt lgkmcnt(7)
	buffer_load_dwordx4 v16, s[36:39], s66 offen offset:2048 lds
	v_mfma_f32_16x16x32_bf16 v[68:71], a[4:7], a[52:55], 0
	s_waitcnt lgkmcnt(6)
	s_mov_b32 s66, 0x25400
	ds_read_b64_tr_b16 a[18:19], v3 offset:18432
	ds_read_b128 a[80:83], v13 offset:19456
	v_mfma_f32_16x16x32_bf16 v[68:71], a[0:3], a[36:39], v[68:71]
	s_waitcnt lgkmcnt(7)
	buffer_load_dwordx4 v16, s[36:39], s66 offen offset:3072 lds
	v_mfma_f32_16x16x32_bf16 v[72:75], a[0:3], a[40:43], 0
	s_add_u32 m0, s64, 0x3000
	s_mov_b32 s66, 0x28000
	ds_read_b64_tr_b16 a[20:21], v3 offset:20480
	ds_read_b128 a[68:71], v13 offset:26624
	s_waitcnt lgkmcnt(8)
	v_mfma_f32_16x16x32_bf16 v[72:75], a[4:7], a[56:59], v[72:75]
	s_waitcnt lgkmcnt(7)
	buffer_load_dwordx4 v16, s[36:39], s66 offen offset:0 lds
	v_mfma_f32_16x16x32_bf16 v[76:79], a[4:7], a[60:63], 0
	s_waitcnt lgkmcnt(6)
	s_mov_b32 s66, 0x29c00
	ds_read_b64_tr_b16 a[22:23], v3 offset:22528
	ds_read_b128 a[84:87], v13 offset:27648
	v_mfma_f32_16x16x32_bf16 v[76:79], a[0:3], a[44:47], v[76:79]
	buffer_load_dwordx4 v16, s[36:39], s66 offen offset:1024 lds
	v_mfma_f32_16x16x32_bf16 v[92:95], a[8:11], a[44:47], 0
	s_mov_b32 s66, 0x2b800
	ds_read_b128 a[72:75], v13 offset:51200
	v_mfma_f32_16x16x32_bf16 v[92:95], a[12:15], a[60:63], v[92:95]
	buffer_load_dwordx4 v16, s[36:39], s66 offen offset:2048 lds
	v_mfma_f32_16x16x32_bf16 v[88:91], a[12:15], a[56:59], 0
	s_mov_b32 s66, 0x2d400
	ds_read_b64_tr_b16 a[24:25], v4 offset:16384
	ds_read_b128 a[88:91], v13 offset:52224
	v_mfma_f32_16x16x32_bf16 v[88:91], a[8:11], a[40:43], v[88:91]
	buffer_load_dwordx4 v16, s[36:39], s66 offen offset:3072 lds
	v_mfma_f32_16x16x32_bf16 v[84:87], a[8:11], a[36:39], 0
	ds_read_b64_tr_b16 a[26:27], v4 offset:18432
	ds_read_b128 a[76:79], v13 offset:59392
	v_mfma_f32_16x16x32_bf16 v[84:87], a[12:15], a[52:55], v[84:87]
	ds_read_b64_tr_b16 a[28:29], v4 offset:20480
	v_mfma_f32_16x16x32_bf16 v[80:83], a[12:15], a[48:51], 0
	ds_read_b64_tr_b16 a[30:31], v4 offset:22528
	ds_read_b128 a[92:95], v13 offset:60416
	v_mfma_f32_16x16x32_bf16 v[80:83], a[8:11], a[32:35], v[80:83]
	s_waitcnt lgkmcnt(10)
	v_mfma_f32_16x16x32_bf16 v[96:99], a[16:19], a[32:35], 0
	s_waitcnt lgkmcnt(8)
	v_mfma_f32_16x16x32_bf16 v[96:99], a[20:23], a[48:51], v[96:99]
	v_mfma_f32_16x16x32_bf16 v[100:103], a[20:23], a[52:55], 0
	v_mfma_f32_16x16x32_bf16 v[100:103], a[16:19], a[36:39], v[100:103]
	s_waitcnt vmcnt(12)
	ds_read_b64_tr_b16 a[0:1], v1 offset:0
	v_mfma_f32_16x16x32_bf16 v[104:107], a[16:19], a[40:43], 0
	ds_read_b64_tr_b16 a[2:3], v1 offset:2048
	v_mfma_f32_16x16x32_bf16 v[104:107], a[20:23], a[56:59], v[104:107]
	s_waitcnt vmcnt(8)
	ds_read_b64_tr_b16 a[4:5], v1 offset:4096
	v_mfma_f32_16x16x32_bf16 v[108:111], a[20:23], a[60:63], 0
	s_add_u32 m0, s64, 0x4000
	ds_read_b64_tr_b16 a[6:7], v1 offset:6144
	v_mfma_f32_16x16x32_bf16 v[108:111], a[16:19], a[44:47], v[108:111]
	s_waitcnt lgkmcnt(6)
	v_mfma_f32_16x16x32_bf16 v[124:127], a[24:27], a[44:47], 0
	s_waitcnt lgkmcnt(4)
	s_mov_b32 s66, 0x30000
	v_mfma_f32_16x16x32_bf16 v[124:127], a[28:31], a[60:63], v[124:127]
	buffer_load_dwordx4 v16, s[36:39], s66 offen offset:0 lds
	v_mfma_f32_16x16x32_bf16 v[120:123], a[28:31], a[56:59], 0
	ds_read_b64_tr_b16 a[8:9], v2 offset:0
	v_mfma_f32_16x16x32_bf16 v[120:123], a[24:27], a[40:43], v[120:123]
	ds_read_b64_tr_b16 a[10:11], v2 offset:2048
	v_mfma_f32_16x16x32_bf16 v[116:119], a[24:27], a[36:39], 0
	s_mov_b32 s66, 0x31c00
	ds_read_b64_tr_b16 a[12:13], v2 offset:4096
	v_mfma_f32_16x16x32_bf16 v[116:119], a[28:31], a[52:55], v[116:119]
	buffer_load_dwordx4 v16, s[36:39], s66 offen offset:1024 lds
	v_mfma_f32_16x16x32_bf16 v[112:115], a[28:31], a[48:51], 0
	ds_read_b64_tr_b16 a[14:15], v2 offset:6144
	v_mfma_f32_16x16x32_bf16 v[112:115], a[24:27], a[32:35], v[112:115]
	s_waitcnt lgkmcnt(5)
	v_mfma_f32_16x16x32_bf16 v[64:67], a[0:3], a[64:67], v[64:67]
	s_waitcnt lgkmcnt(4)
	s_mov_b32 s66, 0x33800
	ds_read_b128 a[32:35], v13 offset:20480
	v_mfma_f32_16x16x32_bf16 v[64:67], a[4:7], a[80:83], v[64:67]
	buffer_load_dwordx4 v16, s[36:39], s66 offen offset:2048 lds
	v_mfma_f32_16x16x32_bf16 v[68:71], a[4:7], a[84:87], v[68:71]
	ds_read_b64_tr_b16 a[16:17], v3 offset:0
	ds_read_b128 a[48:51], v13 offset:21504
	v_mfma_f32_16x16x32_bf16 v[68:71], a[0:3], a[68:71], v[68:71]
	ds_read_b64_tr_b16 a[18:19], v3 offset:2048
	v_mfma_f32_16x16x32_bf16 v[72:75], a[0:3], a[72:75], v[72:75]
	s_mov_b32 s66, 0x35400
	ds_read_b64_tr_b16 a[20:21], v3 offset:4096
	ds_read_b128 a[36:39], v13 offset:28672
	v_mfma_f32_16x16x32_bf16 v[72:75], a[4:7], a[88:91], v[72:75]
	buffer_load_dwordx4 v16, s[36:39], s66 offen offset:3072 lds
	v_mfma_f32_16x16x32_bf16 v[76:79], a[4:7], a[92:95], v[76:79]
	s_add_u32 m0, s64, 0x5000
	ds_read_b64_tr_b16 a[22:23], v3 offset:6144
	ds_read_b128 a[52:55], v13 offset:29696
	v_mfma_f32_16x16x32_bf16 v[76:79], a[0:3], a[76:79], v[76:79]
	s_waitcnt lgkmcnt(9)
	v_mfma_f32_16x16x32_bf16 v[92:95], a[8:11], a[76:79], v[92:95]
	s_waitcnt lgkmcnt(8)
	s_mov_b32 s66, 0x38000
	ds_read_b128 a[40:43], v13 offset:53248
	v_mfma_f32_16x16x32_bf16 v[92:95], a[12:15], a[92:95], v[92:95]
	buffer_load_dwordx4 v16, s[36:39], s66 offen offset:0 lds
	v_mfma_f32_16x16x32_bf16 v[88:91], a[12:15], a[88:91], v[88:91]
	ds_read_b64_tr_b16 a[24:25], v4 offset:0
	ds_read_b128 a[56:59], v13 offset:54272
	v_mfma_f32_16x16x32_bf16 v[88:91], a[8:11], a[72:75], v[88:91]
	ds_read_b64_tr_b16 a[26:27], v4 offset:2048
	v_mfma_f32_16x16x32_bf16 v[84:87], a[8:11], a[68:71], v[84:87]
	s_mov_b32 s66, 0x39c00
	ds_read_b64_tr_b16 a[28:29], v4 offset:4096
	ds_read_b128 a[44:47], v13 offset:61440
	v_mfma_f32_16x16x32_bf16 v[84:87], a[12:15], a[84:87], v[84:87]
	buffer_load_dwordx4 v16, s[36:39], s66 offen offset:1024 lds
	v_mfma_f32_16x16x32_bf16 v[80:83], a[12:15], a[80:83], v[80:83]
	ds_read_b64_tr_b16 a[30:31], v4 offset:6144
	ds_read_b128 a[60:63], v13 offset:62464
	v_mfma_f32_16x16x32_bf16 v[80:83], a[8:11], a[64:67], v[80:83]
	s_waitcnt lgkmcnt(10)
	v_mfma_f32_16x16x32_bf16 v[96:99], a[16:19], a[64:67], v[96:99]
	s_waitcnt lgkmcnt(8)
	s_mov_b32 s66, 0x3b800
	v_mfma_f32_16x16x32_bf16 v[96:99], a[20:23], a[80:83], v[96:99]
	buffer_load_dwordx4 v16, s[36:39], s66 offen offset:2048 lds
	v_mfma_f32_16x16x32_bf16 v[100:103], a[20:23], a[84:87], v[100:103]
	s_waitcnt vmcnt(11)
	ds_read_b64_tr_b16 a[0:1], v1 offset:8192
	v_mfma_f32_16x16x32_bf16 v[100:103], a[16:19], a[68:71], v[100:103]
	ds_read_b64_tr_b16 a[2:3], v1 offset:10240
	v_mfma_f32_16x16x32_bf16 v[104:107], a[16:19], a[72:75], v[104:107]
	s_waitcnt vmcnt(7)
	s_mov_b32 s66, 0x3d400
	ds_read_b64_tr_b16 a[4:5], v1 offset:12288
	v_mfma_f32_16x16x32_bf16 v[104:107], a[20:23], a[88:91], v[104:107]
	buffer_load_dwordx4 v16, s[36:39], s66 offen offset:3072 lds
	v_mfma_f32_16x16x32_bf16 v[108:111], a[20:23], a[92:95], v[108:111]
	s_add_u32 m0, s64, 0x0
	ds_read_b64_tr_b16 a[6:7], v1 offset:14336
	v_mfma_f32_16x16x32_bf16 v[108:111], a[16:19], a[76:79], v[108:111]
	s_waitcnt lgkmcnt(6)
	v_mfma_f32_16x16x32_bf16 v[124:127], a[24:27], a[76:79], v[124:127]
	s_waitcnt lgkmcnt(4)
	s_mov_b32 s66, 0x200
	v_mfma_f32_16x16x32_bf16 v[124:127], a[28:31], a[92:95], v[124:127]
	buffer_load_dwordx4 v16, s[36:39], s66 offen offset:0 lds
	v_mfma_f32_16x16x32_bf16 v[120:123], a[28:31], a[88:91], v[120:123]
	ds_read_b64_tr_b16 a[8:9], v2 offset:8192
	v_mfma_f32_16x16x32_bf16 v[120:123], a[24:27], a[72:75], v[120:123]
	ds_read_b64_tr_b16 a[10:11], v2 offset:10240
	v_mfma_f32_16x16x32_bf16 v[116:119], a[24:27], a[68:71], v[116:119]
	s_mov_b32 s66, 0x1e00
	ds_read_b64_tr_b16 a[12:13], v2 offset:12288
	v_mfma_f32_16x16x32_bf16 v[116:119], a[28:31], a[84:87], v[116:119]
	buffer_load_dwordx4 v16, s[36:39], s66 offen offset:1024 lds
	v_mfma_f32_16x16x32_bf16 v[112:115], a[28:31], a[80:83], v[112:115]
	ds_read_b64_tr_b16 a[14:15], v2 offset:14336
	v_mfma_f32_16x16x32_bf16 v[112:115], a[24:27], a[64:67], v[112:115]
	s_waitcnt lgkmcnt(5)
	v_mfma_f32_16x16x32_bf16 v[64:67], a[0:3], a[32:35], v[64:67]
	s_waitcnt lgkmcnt(4)
	s_mov_b32 s66, 0x3a00
	ds_read_b128 a[64:67], v13 offset:22528
	v_mfma_f32_16x16x32_bf16 v[64:67], a[4:7], a[48:51], v[64:67]
	buffer_load_dwordx4 v16, s[36:39], s66 offen offset:2048 lds
	v_mfma_f32_16x16x32_bf16 v[68:71], a[4:7], a[52:55], v[68:71]
	ds_read_b64_tr_b16 a[16:17], v3 offset:8192
	ds_read_b128 a[80:83], v13 offset:23552
	v_mfma_f32_16x16x32_bf16 v[68:71], a[0:3], a[36:39], v[68:71]
	ds_read_b64_tr_b16 a[18:19], v3 offset:10240
	v_mfma_f32_16x16x32_bf16 v[72:75], a[0:3], a[40:43], v[72:75]
	s_mov_b32 s66, 0x5600
	ds_read_b64_tr_b16 a[20:21], v3 offset:12288
	ds_read_b128 a[68:71], v13 offset:30720
	v_mfma_f32_16x16x32_bf16 v[72:75], a[4:7], a[56:59], v[72:75]
	buffer_load_dwordx4 v16, s[36:39], s66 offen offset:3072 lds
	v_mfma_f32_16x16x32_bf16 v[76:79], a[4:7], a[60:63], v[76:79]
	s_add_u32 m0, s64, 0x1000
	ds_read_b64_tr_b16 a[22:23], v3 offset:14336
	ds_read_b128 a[84:87], v13 offset:31744
	v_mfma_f32_16x16x32_bf16 v[76:79], a[0:3], a[44:47], v[76:79]
	s_waitcnt lgkmcnt(9)
	v_mfma_f32_16x16x32_bf16 v[92:95], a[8:11], a[44:47], v[92:95]
	s_waitcnt lgkmcnt(8)
	s_mov_b32 s66, 0x8200
	ds_read_b128 a[72:75], v13 offset:55296
	v_mfma_f32_16x16x32_bf16 v[92:95], a[12:15], a[60:63], v[92:95]
	buffer_load_dwordx4 v16, s[36:39], s66 offen offset:0 lds
	v_mfma_f32_16x16x32_bf16 v[88:91], a[12:15], a[56:59], v[88:91]
	ds_read_b64_tr_b16 a[24:25], v4 offset:8192
	ds_read_b128 a[88:91], v13 offset:56320
	v_mfma_f32_16x16x32_bf16 v[88:91], a[8:11], a[40:43], v[88:91]
	ds_read_b64_tr_b16 a[26:27], v4 offset:10240
	v_mfma_f32_16x16x32_bf16 v[84:87], a[8:11], a[36:39], v[84:87]
	s_mov_b32 s66, 0x9e00
	ds_read_b64_tr_b16 a[28:29], v4 offset:12288
	ds_read_b128 a[76:79], v13 offset:63488
	v_mfma_f32_16x16x32_bf16 v[84:87], a[12:15], a[52:55], v[84:87]
	buffer_load_dwordx4 v16, s[36:39], s66 offen offset:1024 lds
	v_mfma_f32_16x16x32_bf16 v[80:83], a[12:15], a[48:51], v[80:83]
	ds_read_b64_tr_b16 a[30:31], v4 offset:14336
	ds_read_b128 a[92:95], v13 offset:64512
	v_mfma_f32_16x16x32_bf16 v[80:83], a[8:11], a[32:35], v[80:83]
	s_waitcnt lgkmcnt(10)
	v_mfma_f32_16x16x32_bf16 v[96:99], a[16:19], a[32:35], v[96:99]
	s_waitcnt lgkmcnt(8)
	s_mov_b32 s66, 0xba00
	v_mfma_f32_16x16x32_bf16 v[96:99], a[20:23], a[48:51], v[96:99]
	buffer_load_dwordx4 v16, s[36:39], s66 offen offset:2048 lds
	v_mfma_f32_16x16x32_bf16 v[100:103], a[20:23], a[52:55], v[100:103]
	s_waitcnt vmcnt(11)
	ds_read_b64_tr_b16 a[0:1], v1 offset:16384
	v_mfma_f32_16x16x32_bf16 v[100:103], a[16:19], a[36:39], v[100:103]
	ds_read_b64_tr_b16 a[2:3], v1 offset:18432
	v_mfma_f32_16x16x32_bf16 v[104:107], a[16:19], a[40:43], v[104:107]
	s_waitcnt vmcnt(7)
	s_mov_b32 s66, 0xd600
	ds_read_b64_tr_b16 a[4:5], v1 offset:20480
	v_mfma_f32_16x16x32_bf16 v[104:107], a[20:23], a[56:59], v[104:107]
	buffer_load_dwordx4 v16, s[36:39], s66 offen offset:3072 lds
	v_mfma_f32_16x16x32_bf16 v[108:111], a[20:23], a[60:63], v[108:111]
	s_add_u32 m0, s64, 0x2000
	ds_read_b64_tr_b16 a[6:7], v1 offset:22528
	v_mfma_f32_16x16x32_bf16 v[108:111], a[16:19], a[44:47], v[108:111]
	s_waitcnt lgkmcnt(6)
	v_mfma_f32_16x16x32_bf16 v[124:127], a[24:27], a[44:47], v[124:127]
	s_waitcnt lgkmcnt(4)
	s_mov_b32 s66, 0x10200
	v_mfma_f32_16x16x32_bf16 v[124:127], a[28:31], a[60:63], v[124:127]
	buffer_load_dwordx4 v16, s[36:39], s66 offen offset:0 lds
	v_mfma_f32_16x16x32_bf16 v[120:123], a[28:31], a[56:59], v[120:123]
	ds_read_b64_tr_b16 a[8:9], v2 offset:16384
	v_mfma_f32_16x16x32_bf16 v[120:123], a[24:27], a[40:43], v[120:123]
	ds_read_b64_tr_b16 a[10:11], v2 offset:18432
	v_mfma_f32_16x16x32_bf16 v[116:119], a[24:27], a[36:39], v[116:119]
	s_mov_b32 s66, 0x11e00
	ds_read_b64_tr_b16 a[12:13], v2 offset:20480
	v_mfma_f32_16x16x32_bf16 v[116:119], a[28:31], a[52:55], v[116:119]
	buffer_load_dwordx4 v16, s[36:39], s66 offen offset:1024 lds
	v_mfma_f32_16x16x32_bf16 v[112:115], a[28:31], a[48:51], v[112:115]
	ds_read_b64_tr_b16 a[14:15], v2 offset:22528
	v_mfma_f32_16x16x32_bf16 v[112:115], a[24:27], a[32:35], v[112:115]
	s_waitcnt lgkmcnt(5)
	v_mfma_f32_16x16x32_bf16 v[64:67], a[0:3], a[64:67], v[64:67]
	s_waitcnt lgkmcnt(4)
	s_mov_b32 s66, 0x13a00
	ds_read_b128 a[32:35], v13 offset:16384
	v_mfma_f32_16x16x32_bf16 v[64:67], a[4:7], a[80:83], v[64:67]
	buffer_load_dwordx4 v16, s[36:39], s66 offen offset:2048 lds
	v_mfma_f32_16x16x32_bf16 v[68:71], a[4:7], a[84:87], v[68:71]
	ds_read_b64_tr_b16 a[16:17], v3 offset:16384
	ds_read_b128 a[48:51], v13 offset:17408
	v_mfma_f32_16x16x32_bf16 v[68:71], a[0:3], a[68:71], v[68:71]
	ds_read_b64_tr_b16 a[18:19], v3 offset:18432
	v_mfma_f32_16x16x32_bf16 v[72:75], a[0:3], a[72:75], v[72:75]
	s_mov_b32 s66, 0x15600
	ds_read_b64_tr_b16 a[20:21], v3 offset:20480
	ds_read_b128 a[36:39], v13 offset:24576
	v_mfma_f32_16x16x32_bf16 v[72:75], a[4:7], a[88:91], v[72:75]
	buffer_load_dwordx4 v16, s[36:39], s66 offen offset:3072 lds
	v_mfma_f32_16x16x32_bf16 v[76:79], a[4:7], a[92:95], v[76:79]
	s_add_u32 m0, s64, 0x3000
	ds_read_b64_tr_b16 a[22:23], v3 offset:22528
	ds_read_b128 a[52:55], v13 offset:25600
	v_mfma_f32_16x16x32_bf16 v[76:79], a[0:3], a[76:79], v[76:79]
	s_waitcnt lgkmcnt(9)
	v_mfma_f32_16x16x32_bf16 v[92:95], a[8:11], a[76:79], v[92:95]
	s_waitcnt lgkmcnt(8)
	s_mov_b32 s66, 0x18200
	ds_read_b128 a[40:43], v13 offset:49152
	v_mfma_f32_16x16x32_bf16 v[92:95], a[12:15], a[92:95], v[92:95]
	buffer_load_dwordx4 v16, s[36:39], s66 offen offset:0 lds
	v_mfma_f32_16x16x32_bf16 v[88:91], a[12:15], a[88:91], v[88:91]
	ds_read_b64_tr_b16 a[24:25], v4 offset:16384
	ds_read_b128 a[56:59], v13 offset:50176
	v_mfma_f32_16x16x32_bf16 v[88:91], a[8:11], a[72:75], v[88:91]
	ds_read_b64_tr_b16 a[26:27], v4 offset:18432
	v_mfma_f32_16x16x32_bf16 v[84:87], a[8:11], a[68:71], v[84:87]
	s_mov_b32 s66, 0x19e00
	ds_read_b64_tr_b16 a[28:29], v4 offset:20480
	ds_read_b128 a[44:47], v13 offset:57344
	v_mfma_f32_16x16x32_bf16 v[84:87], a[12:15], a[84:87], v[84:87]
	buffer_load_dwordx4 v16, s[36:39], s66 offen offset:1024 lds
	v_mfma_f32_16x16x32_bf16 v[80:83], a[12:15], a[80:83], v[80:83]
	ds_read_b64_tr_b16 a[30:31], v4 offset:22528
	ds_read_b128 a[60:63], v13 offset:58368
	v_mfma_f32_16x16x32_bf16 v[80:83], a[8:11], a[64:67], v[80:83]
	s_waitcnt lgkmcnt(10)
	v_mfma_f32_16x16x32_bf16 v[96:99], a[16:19], a[64:67], v[96:99]
	s_waitcnt lgkmcnt(8)
	s_mov_b32 s66, 0x1ba00
	v_mfma_f32_16x16x32_bf16 v[96:99], a[20:23], a[80:83], v[96:99]
	buffer_load_dwordx4 v16, s[36:39], s66 offen offset:2048 lds
	v_mfma_f32_16x16x32_bf16 v[100:103], a[20:23], a[84:87], v[100:103]
	s_waitcnt vmcnt(11)
	ds_read_b64_tr_b16 a[0:1], v1 offset:0
	v_cvt_pk_bf16_f32 v95, v94, v95
	v_mfma_f32_16x16x32_bf16 v[100:103], a[16:19], a[68:71], v[100:103]
	ds_read_b64_tr_b16 a[2:3], v1 offset:2048
	v_cvt_pk_bf16_f32 v94, v92, v93
	v_mfma_f32_16x16x32_bf16 v[104:107], a[16:19], a[72:75], v[104:107]
	s_waitcnt vmcnt(7)
	s_mov_b32 s66, 0x1d600
	ds_read_b64_tr_b16 a[4:5], v1 offset:4096
	v_cvt_pk_bf16_f32 v92, v76, v77
	v_mfma_f32_16x16x32_bf16 v[104:107], a[20:23], a[88:91], v[104:107]
	buffer_load_dwordx4 v16, s[36:39], s66 offen offset:3072 lds
	v_mfma_f32_16x16x32_bf16 v[108:111], a[20:23], a[92:95], v[108:111]
	s_add_u32 m0, s64, 0x4000
	ds_read_b64_tr_b16 a[6:7], v1 offset:6144
	v_cvt_pk_bf16_f32 v93, v78, v79
	v_mfma_f32_16x16x32_bf16 v[108:111], a[16:19], a[76:79], v[108:111]
	s_waitcnt lgkmcnt(6)
	v_cvt_pk_bf16_f32 v91, v90, v91
	v_cvt_pk_bf16_f32 v90, v88, v89
	v_mfma_f32_16x16x32_bf16 v[124:127], a[24:27], a[76:79], v[124:127]
	s_waitcnt lgkmcnt(4)
	s_mov_b32 s66, 0x20200
	v_cvt_pk_bf16_f32 v88, v72, v73
	v_cvt_pk_bf16_f32 v89, v74, v75
	v_mfma_f32_16x16x32_bf16 v[124:127], a[28:31], a[92:95], v[124:127]
	buffer_load_dwordx4 v16, s[36:39], s66 offen offset:0 lds
	v_mfma_f32_16x16x32_bf16 v[120:123], a[28:31], a[88:91], v[120:123]
	ds_read_b64_tr_b16 a[8:9], v2 offset:0
	v_cvt_pk_bf16_f32 v87, v86, v87
	v_mfma_f32_16x16x32_bf16 v[120:123], a[24:27], a[72:75], v[120:123]
L_pg17:
	s_cbranch_execz L_pg19
	ds_read_b64_tr_b16 a[10:11], v2 offset:2048
	v_cvt_pk_bf16_f32 v86, v84, v85
	v_mfma_f32_16x16x32_bf16 v[116:119], a[24:27], a[68:71], v[116:119]
	s_mov_b32 s66, 0x21e00
	ds_read_b64_tr_b16 a[12:13], v2 offset:4096
	v_cvt_pk_bf16_f32 v84, v68, v69
	v_mfma_f32_16x16x32_bf16 v[116:119], a[28:31], a[84:87], v[116:119]
	buffer_load_dwordx4 v16, s[36:39], s66 offen offset:1024 lds
	v_mfma_f32_16x16x32_bf16 v[112:115], a[28:31], a[80:83], v[112:115]
	ds_read_b64_tr_b16 a[14:15], v2 offset:6144
	v_cvt_pk_bf16_f32 v85, v70, v71
	v_mfma_f32_16x16x32_bf16 v[112:115], a[24:27], a[64:67], v[112:115]
	s_waitcnt lgkmcnt(5)
	v_cvt_pk_bf16_f32 v83, v82, v83
	v_cvt_pk_bf16_f32 v82, v80, v81
	v_mfma_f32_16x16x32_bf16 v[32:35], a[0:3], a[32:35], 0
	s_waitcnt lgkmcnt(4)
	s_mov_b32 s66, 0x23a00
	ds_read_b128 a[64:67], v13 offset:18432
	v_cvt_pk_bf16_f32 v80, v64, v65
	v_mfma_f32_16x16x32_bf16 v[32:35], a[4:7], a[48:51], v[32:35]
	buffer_load_dwordx4 v16, s[36:39], s66 offen offset:2048 lds
	v_mfma_f32_16x16x32_bf16 v[36:39], a[4:7], a[52:55], 0
	ds_read_b64_tr_b16 a[16:17], v3 offset:0
	ds_read_b128 a[80:83], v13 offset:19456
	v_mfma_f32_16x16x32_bf16 v[36:39], a[0:3], a[36:39], v[36:39]
	ds_read_b64_tr_b16 a[18:19], v3 offset:2048
	v_cvt_pk_bf16_f32 v81, v66, v67
	v_mfma_f32_16x16x32_bf16 v[40:43], a[0:3], a[40:43], 0
	s_mov_b32 s66, 0x25600
	ds_read_b64_tr_b16 a[20:21], v3 offset:4096
	ds_read_b128 a[68:71], v13 offset:26624
	v_mfma_f32_16x16x32_bf16 v[40:43], a[4:7], a[56:59], v[40:43]
	buffer_load_dwordx4 v16, s[36:39], s66 offen offset:3072 lds
	v_mfma_f32_16x16x32_bf16 v[44:47], a[4:7], a[60:63], 0
	s_add_u32 m0, s64, 0x5000
	ds_read_b64_tr_b16 a[22:23], v3 offset:6144
	ds_read_b128 a[84:87], v13 offset:27648
	v_mfma_f32_16x16x32_bf16 v[44:47], a[0:3], a[44:47], v[44:47]
	s_waitcnt lgkmcnt(9)
	v_cvt_pk_bf16_f32 v127, v126, v127
	v_cvt_pk_bf16_f32 v126, v124, v125
	v_mfma_f32_16x16x32_bf16 v[60:63], a[8:11], a[44:47], 0
	s_waitcnt lgkmcnt(8)
	s_mov_b32 s66, 0x28200
	ds_read_b128 a[72:75], v13 offset:51200
	v_cvt_pk_bf16_f32 v124, v108, v109
	v_mfma_f32_16x16x32_bf16 v[60:63], a[12:15], a[60:63], v[60:63]
	buffer_load_dwordx4 v16, s[36:39], s66 offen offset:0 lds
	v_mfma_f32_16x16x32_bf16 v[56:59], a[12:15], a[56:59], 0
	ds_read_b64_tr_b16 a[24:25], v4 offset:0
	ds_read_b128 a[88:91], v13 offset:52224
	v_mfma_f32_16x16x32_bf16 v[56:59], a[8:11], a[40:43], v[56:59]
	ds_read_b64_tr_b16 a[26:27], v4 offset:2048
	v_cvt_pk_bf16_f32 v125, v110, v111
	v_mfma_f32_16x16x32_bf16 v[52:55], a[8:11], a[36:39], 0
	s_mov_b32 s66, 0x29e00
	ds_read_b64_tr_b16 a[28:29], v4 offset:4096
	ds_read_b128 a[76:79], v13 offset:59392
	v_mfma_f32_16x16x32_bf16 v[52:55], a[12:15], a[52:55], v[52:55]
	buffer_load_dwordx4 v16, s[36:39], s66 offen offset:1024 lds
	v_mfma_f32_16x16x32_bf16 v[48:51], a[12:15], a[48:51], 0
	ds_read_b64_tr_b16 a[30:31], v4 offset:6144
	ds_read_b128 a[92:95], v13 offset:60416
	v_mfma_f32_16x16x32_bf16 v[48:51], a[8:11], a[32:35], v[48:51]
	s_waitcnt lgkmcnt(10)
	v_cvt_pk_bf16_f32 v123, v122, v123
	v_cvt_pk_bf16_f32 v122, v120, v121
	v_mfma_f32_16x16x32_bf16 v[64:67], a[16:19], a[32:35], 0
	s_waitcnt lgkmcnt(8)
	s_mov_b32 s66, 0x2ba00
	v_cvt_pk_bf16_f32 v120, v104, v105
	v_cvt_pk_bf16_f32 v121, v106, v107
	v_mfma_f32_16x16x32_bf16 v[64:67], a[20:23], a[48:51], v[64:67]
	buffer_load_dwordx4 v16, s[36:39], s66 offen offset:2048 lds
	v_mfma_f32_16x16x32_bf16 v[68:71], a[20:23], a[52:55], 0
	s_waitcnt vmcnt(11)
	ds_read_b64_tr_b16 a[0:1], v1 offset:8192
	v_cvt_pk_bf16_f32 v119, v118, v119
	v_mfma_f32_16x16x32_bf16 v[68:71], a[16:19], a[36:39], v[68:71]
	ds_read_b64_tr_b16 a[2:3], v1 offset:10240
	v_cvt_pk_bf16_f32 v118, v116, v117
	v_mfma_f32_16x16x32_bf16 v[72:75], a[16:19], a[40:43], 0
	s_waitcnt vmcnt(7)
	s_mov_b32 s66, 0x2d600
	ds_read_b64_tr_b16 a[4:5], v1 offset:12288
	v_cvt_pk_bf16_f32 v116, v100, v101
	v_mfma_f32_16x16x32_bf16 v[72:75], a[20:23], a[56:59], v[72:75]
	buffer_load_dwordx4 v16, s[36:39], s66 offen offset:3072 lds
	v_mfma_f32_16x16x32_bf16 v[76:79], a[20:23], a[60:63], 0
	s_add_u32 m0, s64, 0x0
	ds_read_b64_tr_b16 a[6:7], v1 offset:14336
	v_cvt_pk_bf16_f32 v117, v102, v103
	v_mfma_f32_16x16x32_bf16 v[76:79], a[16:19], a[44:47], v[76:79]
	v_cvt_pk_bf16_f32 v115, v114, v115
	v_cvt_pk_bf16_f32 v114, v112, v113
	v_cvt_pk_bf16_f32 v112, v96, v97
	v_cvt_pk_bf16_f32 v113, v98, v99
	s_waitcnt lgkmcnt(6)
	v_mfma_f32_16x16x32_bf16 v[108:111], a[24:27], a[44:47], 0
	s_waitcnt lgkmcnt(4)
	s_mov_b32 s66, 0x30200
	v_mfma_f32_16x16x32_bf16 v[108:111], a[28:31], a[60:63], v[108:111]
	buffer_load_dwordx4 v16, s[36:39], s66 offen offset:0 lds
	v_mfma_f32_16x16x32_bf16 v[104:107], a[28:31], a[56:59], 0
	ds_read_b64_tr_b16 a[8:9], v2 offset:8192
	v_mfma_f32_16x16x32_bf16 v[104:107], a[24:27], a[40:43], v[104:107]
	ds_read_b64_tr_b16 a[10:11], v2 offset:10240
	v_mfma_f32_16x16x32_bf16 v[100:103], a[24:27], a[36:39], 0
	s_mov_b32 s66, 0x31e00
	ds_read_b64_tr_b16 a[12:13], v2 offset:12288
	v_mfma_f32_16x16x32_bf16 v[100:103], a[28:31], a[52:55], v[100:103]
	buffer_load_dwordx4 v16, s[36:39], s66 offen offset:1024 lds
	v_mfma_f32_16x16x32_bf16 v[96:99], a[28:31], a[48:51], 0
	ds_read_b64_tr_b16 a[14:15], v2 offset:14336
	v_mfma_f32_16x16x32_bf16 v[96:99], a[24:27], a[32:35], v[96:99]
	s_waitcnt lgkmcnt(5)
	v_mfma_f32_16x16x32_bf16 v[32:35], a[0:3], a[64:67], v[32:35]
	s_waitcnt lgkmcnt(4)
	s_mov_b32 s66, 0x33a00
	ds_read_b128 a[32:35], v13 offset:20480
	v_mfma_f32_16x16x32_bf16 v[32:35], a[4:7], a[80:83], v[32:35]
	buffer_load_dwordx4 v16, s[36:39], s66 offen offset:2048 lds
	v_mfma_f32_16x16x32_bf16 v[36:39], a[4:7], a[84:87], v[36:39]
	ds_read_b64_tr_b16 a[16:17], v3 offset:8192
	ds_read_b128 a[48:51], v13 offset:21504
	v_mfma_f32_16x16x32_bf16 v[36:39], a[0:3], a[68:71], v[36:39]
	ds_read_b64_tr_b16 a[18:19], v3 offset:10240
	v_mfma_f32_16x16x32_bf16 v[40:43], a[0:3], a[72:75], v[40:43]
	s_mov_b32 s66, 0x35600
	ds_read_b64_tr_b16 a[20:21], v3 offset:12288
	ds_read_b128 a[36:39], v13 offset:28672
	v_mfma_f32_16x16x32_bf16 v[40:43], a[4:7], a[88:91], v[40:43]
	buffer_load_dwordx4 v16, s[36:39], s66 offen offset:3072 lds
	v_mfma_f32_16x16x32_bf16 v[44:47], a[4:7], a[92:95], v[44:47]
	s_add_u32 m0, s64, 0x1000
	ds_read_b64_tr_b16 a[22:23], v3 offset:14336
	ds_read_b128 a[52:55], v13 offset:29696
	v_mfma_f32_16x16x32_bf16 v[44:47], a[0:3], a[76:79], v[44:47]
	s_waitcnt lgkmcnt(9)
	v_mfma_f32_16x16x32_bf16 v[60:63], a[8:11], a[76:79], v[60:63]
	s_waitcnt lgkmcnt(8)
	s_mov_b32 s66, 0x38200
	ds_read_b128 a[40:43], v13 offset:53248
	v_mfma_f32_16x16x32_bf16 v[60:63], a[12:15], a[92:95], v[60:63]
	buffer_load_dwordx4 v16, s[36:39], s66 offen offset:0 lds
	v_mfma_f32_16x16x32_bf16 v[56:59], a[12:15], a[88:91], v[56:59]
	ds_read_b64_tr_b16 a[24:25], v4 offset:8192
	ds_read_b128 a[56:59], v13 offset:54272
	v_mfma_f32_16x16x32_bf16 v[56:59], a[8:11], a[72:75], v[56:59]
	ds_read_b64_tr_b16 a[26:27], v4 offset:10240
	v_mfma_f32_16x16x32_bf16 v[52:55], a[8:11], a[68:71], v[52:55]
	s_mov_b32 s66, 0x39e00
	ds_read_b64_tr_b16 a[28:29], v4 offset:12288
	ds_read_b128 a[44:47], v13 offset:61440
	v_mfma_f32_16x16x32_bf16 v[52:55], a[12:15], a[84:87], v[52:55]
	buffer_load_dwordx4 v16, s[36:39], s66 offen offset:1024 lds
	v_mfma_f32_16x16x32_bf16 v[48:51], a[12:15], a[80:83], v[48:51]
	ds_read_b64_tr_b16 a[30:31], v4 offset:14336
	ds_read_b128 a[60:63], v13 offset:62464
	v_mfma_f32_16x16x32_bf16 v[48:51], a[8:11], a[64:67], v[48:51]
	s_waitcnt lgkmcnt(10)
	v_mfma_f32_16x16x32_bf16 v[64:67], a[16:19], a[64:67], v[64:67]
	s_waitcnt lgkmcnt(8)
	s_mov_b32 s66, 0x3ba00
	v_mfma_f32_16x16x32_bf16 v[64:67], a[20:23], a[80:83], v[64:67]
	buffer_load_dwordx4 v16, s[36:39], s66 offen offset:2048 lds
	v_mfma_f32_16x16x32_bf16 v[68:71], a[20:23], a[84:87], v[68:71]
	s_waitcnt vmcnt(11)
	ds_read_b64_tr_b16 a[0:1], v1 offset:16384
	v_mfma_f32_16x16x32_bf16 v[68:71], a[16:19], a[68:71], v[68:71]
	ds_read_b64_tr_b16 a[2:3], v1 offset:18432
	v_mfma_f32_16x16x32_bf16 v[72:75], a[16:19], a[72:75], v[72:75]
	s_waitcnt vmcnt(7)
	s_mov_b32 s66, 0x3d600
	ds_read_b64_tr_b16 a[4:5], v1 offset:20480
	v_mfma_f32_16x16x32_bf16 v[72:75], a[20:23], a[88:91], v[72:75]
	buffer_load_dwordx4 v16, s[36:39], s66 offen offset:3072 lds
	v_mfma_f32_16x16x32_bf16 v[76:79], a[20:23], a[92:95], v[76:79]
	ds_read_b64_tr_b16 a[6:7], v1 offset:22528
	v_mfma_f32_16x16x32_bf16 v[76:79], a[16:19], a[76:79], v[76:79]
	s_waitcnt lgkmcnt(6)
	v_mfma_f32_16x16x32_bf16 v[108:111], a[24:27], a[76:79], v[108:111]
	s_waitcnt lgkmcnt(4)
	s_add_u32 m0, s65, 0x0
	v_mfma_f32_16x16x32_bf16 v[108:111], a[28:31], a[92:95], v[108:111]
	buffer_load_dwordx4 v18, s[8:11], s68 offen lds
	v_mfma_f32_16x16x32_bf16 v[104:107], a[28:31], a[88:91], v[104:107]
	ds_read_b64_tr_b16 a[8:9], v2 offset:16384
	v_mfma_f32_16x16x32_bf16 v[104:107], a[24:27], a[72:75], v[104:107]
	ds_read_b64_tr_b16 a[10:11], v2 offset:18432
	v_mfma_f32_16x16x32_bf16 v[100:103], a[24:27], a[68:71], v[100:103]
	ds_read_b64_tr_b16 a[12:13], v2 offset:20480
	v_mfma_f32_16x16x32_bf16 v[100:103], a[28:31], a[84:87], v[100:103]
	buffer_load_dwordx4 v19, s[8:11], s68 offen offset:1024 lds
	v_mfma_f32_16x16x32_bf16 v[96:99], a[28:31], a[80:83], v[96:99]
	s_add_u32 s68, s68, 0x2000
	ds_read_b64_tr_b16 a[14:15], v2 offset:22528
	v_mfma_f32_16x16x32_bf16 v[96:99], a[24:27], a[64:67], v[96:99]
	s_waitcnt lgkmcnt(5)
	s_and_b32 s68, s68, 0x7ffff
	v_mfma_f32_16x16x32_bf16 v[32:35], a[0:3], a[32:35], v[32:35]
	s_waitcnt lgkmcnt(4)
	s_add_u32 m0, s65, 0x2000
	ds_read_b128 a[64:67], v13 offset:22528
	v_mfma_f32_16x16x32_bf16 v[32:35], a[4:7], a[48:51], v[32:35]
	buffer_load_dwordx4 v18, s[8:11], s68 offen lds
	v_mfma_f32_16x16x32_bf16 v[36:39], a[4:7], a[52:55], v[36:39]
	ds_read_b64_tr_b16 a[16:17], v3 offset:16384
	ds_read_b128 a[80:83], v13 offset:23552
	v_mfma_f32_16x16x32_bf16 v[36:39], a[0:3], a[36:39], v[36:39]
	ds_read_b64_tr_b16 a[18:19], v3 offset:18432
	v_mfma_f32_16x16x32_bf16 v[40:43], a[0:3], a[40:43], v[40:43]
	ds_read_b64_tr_b16 a[20:21], v3 offset:20480
	ds_read_b128 a[68:71], v13 offset:30720
	v_mfma_f32_16x16x32_bf16 v[40:43], a[4:7], a[56:59], v[40:43]
	buffer_load_dwordx4 v19, s[8:11], s68 offen offset:1024 lds
	v_mfma_f32_16x16x32_bf16 v[44:47], a[4:7], a[60:63], v[44:47]
	s_add_u32 s68, s68, 0x2000
	ds_read_b64_tr_b16 a[22:23], v3 offset:22528
	ds_read_b128 a[84:87], v13 offset:31744
	v_mfma_f32_16x16x32_bf16 v[44:47], a[0:3], a[44:47], v[44:47]
	s_waitcnt lgkmcnt(9)
	s_and_b32 s68, s68, 0x7ffff
	v_mfma_f32_16x16x32_bf16 v[60:63], a[8:11], a[44:47], v[60:63]
	s_waitcnt lgkmcnt(8)
	s_add_u32 m0, s65, 0x8000
	ds_read_b128 a[72:75], v13 offset:55296
	v_mfma_f32_16x16x32_bf16 v[60:63], a[12:15], a[60:63], v[60:63]
	buffer_load_dwordx4 v20, s[12:15], s69 offen lds
	v_mfma_f32_16x16x32_bf16 v[56:59], a[12:15], a[56:59], v[56:59]
	ds_read_b64_tr_b16 a[24:25], v4 offset:16384
	ds_read_b128 a[88:91], v13 offset:56320
	v_mfma_f32_16x16x32_bf16 v[56:59], a[8:11], a[40:43], v[56:59]
	ds_read_b64_tr_b16 a[26:27], v4 offset:18432
	v_mfma_f32_16x16x32_bf16 v[52:55], a[8:11], a[36:39], v[52:55]
	ds_read_b64_tr_b16 a[28:29], v4 offset:20480
	ds_read_b128 a[76:79], v13 offset:63488
	v_mfma_f32_16x16x32_bf16 v[52:55], a[12:15], a[52:55], v[52:55]
	buffer_load_dwordx4 v21, s[12:15], s69 offen offset:1024 lds
	v_mfma_f32_16x16x32_bf16 v[48:51], a[12:15], a[48:51], v[48:51]
	s_add_u32 s69, s69, 0x2000
	ds_read_b64_tr_b16 a[30:31], v4 offset:22528
	ds_read_b128 a[92:95], v13 offset:64512
	v_mfma_f32_16x16x32_bf16 v[48:51], a[8:11], a[32:35], v[48:51]
	s_waitcnt lgkmcnt(10)
	s_and_b32 s69, s69, 0x7ffff
	v_mfma_f32_16x16x32_bf16 v[64:67], a[16:19], a[32:35], v[64:67]
	s_waitcnt lgkmcnt(8)
	s_add_u32 m0, s65, 0xa000
	v_mfma_f32_16x16x32_bf16 v[64:67], a[20:23], a[48:51], v[64:67]
	buffer_load_dwordx4 v20, s[12:15], s69 offen lds
	v_mfma_f32_16x16x32_bf16 v[68:71], a[20:23], a[52:55], v[68:71]
	s_waitcnt vmcnt(11)
	ds_read_b64_tr_b16 a[0:1], v1 offset:0
	v_mfma_f32_16x16x32_bf16 v[68:71], a[16:19], a[36:39], v[68:71]
	ds_read_b64_tr_b16 a[2:3], v1 offset:2048
	v_mfma_f32_16x16x32_bf16 v[72:75], a[16:19], a[40:43], v[72:75]
	s_waitcnt vmcnt(7)
	ds_read_b64_tr_b16 a[4:5], v1 offset:4096
	v_mfma_f32_16x16x32_bf16 v[72:75], a[20:23], a[56:59], v[72:75]
	buffer_load_dwordx4 v21, s[12:15], s69 offen offset:1024 lds
	v_mfma_f32_16x16x32_bf16 v[76:79], a[20:23], a[60:63], v[76:79]
	s_add_u32 s69, s69, 0x2000
	ds_read_b64_tr_b16 a[6:7], v1 offset:6144
	v_mfma_f32_16x16x32_bf16 v[76:79], a[16:19], a[44:47], v[76:79]
	s_waitcnt lgkmcnt(6)
	s_and_b32 s69, s69, 0x7ffff
	v_mfma_f32_16x16x32_bf16 v[108:111], a[24:27], a[44:47], v[108:111]
	s_waitcnt lgkmcnt(4)
	v_mfma_f32_16x16x32_bf16 v[108:111], a[28:31], a[60:63], v[108:111]
	v_mfma_f32_16x16x32_bf16 v[104:107], a[28:31], a[56:59], v[104:107]
	v_mfma_f32_16x16x32_bf16 v[104:107], a[24:27], a[40:43], v[104:107]
	ds_read_b64_tr_b16 a[8:9], v2 offset:0
	v_mfma_f32_16x16x32_bf16 v[100:103], a[24:27], a[36:39], v[100:103]
	ds_read_b64_tr_b16 a[10:11], v2 offset:2048
	v_mfma_f32_16x16x32_bf16 v[100:103], a[28:31], a[52:55], v[100:103]
	ds_read_b64_tr_b16 a[12:13], v2 offset:4096
	v_mfma_f32_16x16x32_bf16 v[96:99], a[28:31], a[48:51], v[96:99]
	ds_read_b64_tr_b16 a[14:15], v2 offset:6144
	v_mfma_f32_16x16x32_bf16 v[96:99], a[24:27], a[32:35], v[96:99]
	s_waitcnt lgkmcnt(5)
	v_mfma_f32_16x16x32_bf16 v[32:35], a[0:3], a[64:67], v[32:35]
	s_waitcnt lgkmcnt(4)
	v_mfma_f32_16x16x32_bf16 v[32:35], a[4:7], a[80:83], v[32:35]
	v_mfma_f32_16x16x32_bf16 v[36:39], a[4:7], a[84:87], v[36:39]
	v_mfma_f32_16x16x32_bf16 v[36:39], a[0:3], a[68:71], v[36:39]
	ds_read_b64_tr_b16 a[16:17], v3 offset:0
	v_mfma_f32_16x16x32_bf16 v[40:43], a[0:3], a[72:75], v[40:43]
	ds_read_b64_tr_b16 a[18:19], v3 offset:2048
	v_mfma_f32_16x16x32_bf16 v[40:43], a[4:7], a[88:91], v[40:43]
	ds_read_b64_tr_b16 a[20:21], v3 offset:4096
	v_mfma_f32_16x16x32_bf16 v[44:47], a[4:7], a[92:95], v[44:47]
	ds_read_b64_tr_b16 a[22:23], v3 offset:6144
	v_mfma_f32_16x16x32_bf16 v[44:47], a[0:3], a[76:79], v[44:47]
	s_waitcnt lgkmcnt(5)
	v_mfma_f32_16x16x32_bf16 v[60:63], a[8:11], a[76:79], v[60:63]
	s_waitcnt lgkmcnt(4)
	v_mfma_f32_16x16x32_bf16 v[60:63], a[12:15], a[92:95], v[60:63]
	v_mfma_f32_16x16x32_bf16 v[56:59], a[12:15], a[88:91], v[56:59]
	v_mfma_f32_16x16x32_bf16 v[56:59], a[8:11], a[72:75], v[56:59]
	ds_read_b64_tr_b16 a[24:25], v4 offset:0
	v_mfma_f32_16x16x32_bf16 v[52:55], a[8:11], a[68:71], v[52:55]
	ds_read_b64_tr_b16 a[26:27], v4 offset:2048
	v_mfma_f32_16x16x32_bf16 v[52:55], a[12:15], a[84:87], v[52:55]
	ds_read_b64_tr_b16 a[28:29], v4 offset:4096
	v_mfma_f32_16x16x32_bf16 v[48:51], a[12:15], a[80:83], v[48:51]
	ds_read_b64_tr_b16 a[30:31], v4 offset:6144
	v_mfma_f32_16x16x32_bf16 v[48:51], a[8:11], a[64:67], v[48:51]
	s_waitcnt lgkmcnt(5)
	v_mfma_f32_16x16x32_bf16 v[64:67], a[16:19], a[64:67], v[64:67]
	s_waitcnt lgkmcnt(4)
	v_mfma_f32_16x16x32_bf16 v[64:67], a[20:23], a[80:83], v[64:67]
	v_xor_b32 v1, 0x80, v5
	v_xor_b32 v2, 0x80, v6
	v_mfma_f32_16x16x32_bf16 v[68:71], a[20:23], a[84:87], v[68:71]
	v_xor_b32 v3, 0x80, v7
	v_xor_b32 v4, 0x80, v8
	v_mfma_f32_16x16x32_bf16 v[68:71], a[16:19], a[68:71], v[68:71]
	v_cvt_pk_bf16_f32 v63, v62, v63
	v_cvt_pk_bf16_f32 v62, v60, v61
	v_mfma_f32_16x16x32_bf16 v[72:75], a[16:19], a[72:75], v[72:75]
	v_cvt_pk_bf16_f32 v60, v44, v45
	v_cvt_pk_bf16_f32 v61, v46, v47
	v_mfma_f32_16x16x32_bf16 v[72:75], a[20:23], a[88:91], v[72:75]
	v_cvt_pk_bf16_f32 v59, v58, v59
	v_cvt_pk_bf16_f32 v58, v56, v57
	v_mfma_f32_16x16x32_bf16 v[76:79], a[20:23], a[92:95], v[76:79]
	v_cvt_pk_bf16_f32 v56, v40, v41
	v_cvt_pk_bf16_f32 v57, v42, v43
	v_mfma_f32_16x16x32_bf16 v[76:79], a[16:19], a[76:79], v[76:79]
	s_waitcnt lgkmcnt(1)
	v_cvt_pk_bf16_f32 v55, v54, v55
	v_cvt_pk_bf16_f32 v54, v52, v53
	v_mfma_f32_16x16x32_bf16 v[108:111], a[24:27], a[76:79], v[108:111]
	s_waitcnt lgkmcnt(0)
	v_cvt_pk_bf16_f32 v52, v36, v37
	v_cvt_pk_bf16_f32 v53, v38, v39
	v_mfma_f32_16x16x32_bf16 v[108:111], a[28:31], a[92:95], v[108:111]
	v_cvt_pk_bf16_f32 v51, v50, v51
	v_cvt_pk_bf16_f32 v50, v48, v49
	v_mfma_f32_16x16x32_bf16 v[104:107], a[28:31], a[88:91], v[104:107]
	v_cvt_pk_bf16_f32 v48, v32, v33
	v_cvt_pk_bf16_f32 v49, v34, v35
	v_mfma_f32_16x16x32_bf16 v[104:107], a[24:27], a[72:75], v[104:107]
	v_mfma_f32_16x16x32_bf16 v[100:103], a[24:27], a[68:71], v[100:103]
	v_mfma_f32_16x16x32_bf16 v[100:103], a[28:31], a[84:87], v[100:103]
	v_mfma_f32_16x16x32_bf16 v[96:99], a[28:31], a[80:83], v[96:99]
	v_mfma_f32_16x16x32_bf16 v[96:99], a[24:27], a[64:67], v[96:99]
	v_cvt_pk_bf16_f32 v111, v110, v111
	v_cvt_pk_bf16_f32 v110, v108, v109
	v_cvt_pk_bf16_f32 v108, v76, v77
	v_cvt_pk_bf16_f32 v109, v78, v79
	v_cvt_pk_bf16_f32 v107, v106, v107
	v_cvt_pk_bf16_f32 v106, v104, v105
	v_cvt_pk_bf16_f32 v104, v72, v73
	v_cvt_pk_bf16_f32 v105, v74, v75
	v_cvt_pk_bf16_f32 v103, v102, v103
	v_cvt_pk_bf16_f32 v102, v100, v101
	v_cvt_pk_bf16_f32 v100, v68, v69
	v_cvt_pk_bf16_f32 v101, v70, v71
	v_cvt_pk_bf16_f32 v99, v98, v99
	v_cvt_pk_bf16_f32 v98, v96, v97
	v_cvt_pk_bf16_f32 v96, v64, v65
	v_cvt_pk_bf16_f32 v97, v66, v67
	v_pk_mov_b32 v[64:65], v[48:49], v[48:49] op_sel:[0,1]
	v_pk_mov_b32 v[66:67], v[50:51], v[50:51] op_sel:[0,1]
	v_pk_mov_b32 v[68:69], v[52:53], v[52:53] op_sel:[0,1]
	v_pk_mov_b32 v[70:71], v[54:55], v[54:55] op_sel:[0,1]
	v_pk_mov_b32 v[72:73], v[56:57], v[56:57] op_sel:[0,1]
	v_pk_mov_b32 v[74:75], v[58:59], v[58:59] op_sel:[0,1]
	v_pk_mov_b32 v[76:77], v[60:61], v[60:61] op_sel:[0,1]
	v_pk_mov_b32 v[78:79], v[62:63], v[62:63] op_sel:[0,1]
L_mlp_done:
	s_waitcnt vmcnt(0)
	s_barrier
	ds_read_b128 a[0:3], v9 offset:0
	ds_read_b128 a[4:7], v10 offset:0
	ds_read_b128 a[8:11], v11 offset:0
	ds_read_b128 a[12:15], v12 offset:0
	ds_read_b128 a[28:31], v12 offset:4096
	ds_read_b128 a[24:27], v11 offset:4096
	ds_read_b128 a[20:23], v10 offset:4096
	ds_read_b128 a[16:19], v9 offset:4096
	s_waitcnt lgkmcnt(7)
	v_mfma_f32_16x16x32_bf16 v[32:35], a[0:3], a[192:195], -4.0
	s_waitcnt lgkmcnt(6)
	s_add_u32 m0, s65, 0x4000
	s_nop 0
	buffer_load_dwordx4 v18, s[8:11], s68 offen lds
	v_mfma_f32_16x16x32_bf16 v[32:35], a[4:7], a[196:199], v[32:35]
	s_waitcnt lgkmcnt(5)
	ds_read_b128 a[32:35], v9 offset:8192
	ds_read_b128 a[36:39], v10 offset:8192
	v_mfma_f32_16x16x32_bf16 v[32:35], a[8:11], a[200:203], v[32:35]
	s_waitcnt lgkmcnt(6)
	buffer_load_dwordx4 v19, s[8:11], s68 offen offset:1024 lds
	v_mfma_f32_16x16x32_bf16 v[32:35], a[12:15], a[204:207], v[32:35]
	s_add_u32 s68, s68, 0x2000
	s_and_b32 s68, s68, 0x7ffff
	s_add_u32 m0, s65, 0x6000
	ds_read_b128 a[40:43], v11 offset:8192
	ds_read_b128 a[44:47], v12 offset:8192
	s_waitcnt lgkmcnt(7)
	v_mfma_f32_16x16x32_bf16 v[36:39], a[28:31], a[204:207], -4.0
	s_waitcnt lgkmcnt(6)
	buffer_load_dwordx4 v18, s[8:11], s68 offen lds
	v_mfma_f32_16x16x32_bf16 v[36:39], a[24:27], a[200:203], v[36:39]
	s_waitcnt lgkmcnt(5)
	ds_read_b128 a[60:63], v12 offset:12288
	ds_read_b128 a[56:59], v11 offset:12288
	v_mfma_f32_16x16x32_bf16 v[36:39], a[20:23], a[196:199], v[36:39]
	s_waitcnt lgkmcnt(6)
	buffer_load_dwordx4 v19, s[8:11], s68 offen offset:1024 lds
	v_mfma_f32_16x16x32_bf16 v[36:39], a[16:19], a[192:195], v[36:39]
	s_add_u32 s68, s68, 0x2000
	s_and_b32 s68, s68, 0x7ffff
	ds_read_b128 a[52:55], v10 offset:12288
	ds_read_b128 a[48:51], v9 offset:12288
	s_waitcnt lgkmcnt(7)
	v_mfma_f32_16x16x32_bf16 v[40:43], a[32:35], a[192:195], -4.0
	s_waitcnt lgkmcnt(6)
	s_add_u32 m0, s65, 0xc000
	s_nop 0
	buffer_load_dwordx4 v20, s[12:15], s69 offen lds
	v_mfma_f32_16x16x32_bf16 v[40:43], a[36:39], a[196:199], v[40:43]
	s_waitcnt lgkmcnt(5)
	ds_read_b64_tr_b16 a[64:65], v1 offset:0
	ds_read_b64_tr_b16 a[66:67], v1 offset:4096
	v_mfma_f32_16x16x32_bf16 v[40:43], a[40:43], a[200:203], v[40:43]
	s_waitcnt lgkmcnt(6)
	buffer_load_dwordx4 v21, s[12:15], s69 offen offset:1024 lds
	v_exp_f32 v32, v32
	v_mfma_f32_16x16x32_bf16 v[40:43], a[44:47], a[204:207], v[40:43]
	s_add_u32 s69, s69, 0x2000
	s_and_b32 s69, s69, 0x7ffff
	s_add_u32 m0, s65, 0xe000
	ds_read_b64_tr_b16 a[96:97], v1 offset:8192
	ds_read_b64_tr_b16 a[98:99], v1 offset:12288
	v_exp_f32 v33, v33
	s_waitcnt lgkmcnt(7)
	v_mfma_f32_16x16x32_bf16 v[44:47], a[60:63], a[204:207], -4.0
	s_waitcnt lgkmcnt(6)
	buffer_load_dwordx4 v20, s[12:15], s69 offen lds
	v_cvt_pk_bf16_f32 v48, v32, v33
	v_exp_f32 v34, v34
	v_mfma_f32_16x16x32_bf16 v[44:47], a[56:59], a[200:203], v[44:47]
	s_waitcnt lgkmcnt(5)
	ds_read_b64_tr_b16 a[100:101], v2 offset:8192
	ds_read_b64_tr_b16 a[102:103], v2 offset:12288
	v_exp_f32 v35, v35
	v_mfma_f32_16x16x32_bf16 v[44:47], a[52:55], a[196:199], v[44:47]
	s_waitcnt lgkmcnt(6)
	buffer_load_dwordx4 v21, s[12:15], s69 offen offset:1024 lds
	v_cvt_pk_bf16_f32 v49, v34, v35
	v_exp_f32 v36, v36
	v_mfma_f32_16x16x32_bf16 v[44:47], a[48:51], a[192:195], v[44:47]
	s_add_u32 s69, s69, 0x2000
	s_and_b32 s69, s69, 0x7ffff
	ds_read_b64_tr_b16 a[68:69], v2 offset:0
	ds_read_b64_tr_b16 a[70:71], v2 offset:4096
	v_exp_f32 v37, v37
	s_nop 0
	v_cvt_pk_bf16_f32 v50, v36, v37
	v_exp_f32 v38, v38
	v_exp_f32 v39, v39
	s_nop 0
	v_cvt_pk_bf16_f32 v51, v38, v39
	v_mfma_f32_16x16x32_bf16 v[32:35], a[0:3], a[208:211], -4.0
	ds_read_b64_tr_b16 a[72:73], v3 offset:0
	ds_read_b64_tr_b16 a[74:75], v3 offset:4096
	v_mfma_f32_16x16x32_bf16 v[32:35], a[4:7], a[212:215], v[32:35]
	ds_read_b64_tr_b16 a[104:105], v3 offset:8192
	ds_read_b64_tr_b16 a[106:107], v3 offset:12288
	v_mfma_f32_16x16x32_bf16 v[32:35], a[8:11], a[216:219], v[32:35]
	ds_read_b64_tr_b16 a[108:109], v4 offset:8192
	ds_read_b64_tr_b16 a[110:111], v4 offset:12288
	v_exp_f32 v40, v40
	v_mfma_f32_16x16x32_bf16 v[32:35], a[12:15], a[220:223], v[32:35]
	ds_read_b64_tr_b16 a[76:77], v4 offset:0
	ds_read_b64_tr_b16 a[78:79], v4 offset:4096
	v_exp_f32 v41, v41
	v_mfma_f32_16x16x32_bf16 v[36:39], a[28:31], a[220:223], -4.0
	ds_read_b64_tr_b16 a[80:81], v5 offset:0
	ds_read_b64_tr_b16 a[82:83], v5 offset:4096
	v_cvt_pk_bf16_f32 v52, v40, v41
	v_exp_f32 v42, v42
	v_mfma_f32_16x16x32_bf16 v[36:39], a[24:27], a[216:219], v[36:39]
	ds_read_b64_tr_b16 a[112:113], v5 offset:8192
	ds_read_b64_tr_b16 a[114:115], v5 offset:12288
	v_exp_f32 v43, v43
	v_mfma_f32_16x16x32_bf16 v[36:39], a[20:23], a[212:215], v[36:39]
	ds_read_b64_tr_b16 a[116:117], v6 offset:8192
	ds_read_b64_tr_b16 a[118:119], v6 offset:12288
	v_cvt_pk_bf16_f32 v53, v42, v43
	v_exp_f32 v44, v44
	v_mfma_f32_16x16x32_bf16 v[36:39], a[16:19], a[208:211], v[36:39]
	ds_read_b64_tr_b16 a[84:85], v6 offset:0
	ds_read_b64_tr_b16 a[86:87], v6 offset:4096
	v_exp_f32 v45, v45
	s_nop 0
	v_cvt_pk_bf16_f32 v54, v44, v45
	v_exp_f32 v46, v46
	v_exp_f32 v47, v47
	s_nop 0
	v_cvt_pk_bf16_f32 v55, v46, v47
	v_mfma_f32_16x16x32_bf16 v[40:43], a[32:35], a[208:211], -4.0
	v_exp_f32 v32, v32
	v_mfma_f32_16x16x32_bf16 v[40:43], a[36:39], a[212:215], v[40:43]
	ds_read_b64_tr_b16 a[88:89], v7 offset:0
	ds_read_b64_tr_b16 a[90:91], v7 offset:4096
	v_mfma_f32_16x16x32_bf16 v[40:43], a[40:43], a[216:219], v[40:43]
	v_exp_f32 v33, v33
	v_mfma_f32_16x16x32_bf16 v[40:43], a[44:47], a[220:223], v[40:43]
	ds_read_b64_tr_b16 a[120:121], v7 offset:8192
	v_cvt_pk_bf16_f32 v56, v32, v33
	v_mfma_f32_16x16x32_bf16 v[44:47], a[60:63], a[220:223], -4.0
	v_exp_f32 v34, v34
	v_mfma_f32_16x16x32_bf16 v[44:47], a[56:59], a[216:219], v[44:47]
	ds_read_b64_tr_b16 a[122:123], v7 offset:12288
	ds_read_b64_tr_b16 a[124:125], v8 offset:8192
	v_mfma_f32_16x16x32_bf16 v[44:47], a[52:55], a[212:215], v[44:47]
	v_exp_f32 v35, v35
	v_mfma_f32_16x16x32_bf16 v[44:47], a[48:51], a[208:211], v[44:47]
	ds_read_b64_tr_b16 a[126:127], v8 offset:12288
	v_cvt_pk_bf16_f32 v57, v34, v35
	v_smfmac_f32_16x16x64_bf16 a[132:135], a[128:131], v[48:55], v31
	s_waitcnt lgkmcnt(8)
	v_mfma_f32_16x16x32_bf16 v[128:131], a[64:67], v[48:51], v[128:131]
	v_exp_f32 v36, v36
	v_mfma_f32_16x16x32_bf16 v[128:131], a[96:99], v[52:55], v[128:131]
	ds_read_b64_tr_b16 a[92:93], v8 offset:0
	ds_read_b64_tr_b16 a[94:95], v8 offset:4096
	v_mfma_f32_16x16x32_bf16 v[144:147], a[100:103], v[52:55], v[144:147]
	v_exp_f32 v37, v37
	v_mfma_f32_16x16x32_bf16 v[144:147], a[68:71], v[48:51], v[144:147]
	v_cvt_pk_bf16_f32 v58, v36, v37
	v_mfma_f32_16x16x32_bf16 v[160:163], a[72:75], v[48:51], v[160:163]
	v_exp_f32 v38, v38
	v_mfma_f32_16x16x32_bf16 v[160:163], a[104:107], v[52:55], v[160:163]
	v_mfma_f32_16x16x32_bf16 v[176:179], a[108:111], v[52:55], v[176:179]
	v_exp_f32 v39, v39
	v_mfma_f32_16x16x32_bf16 v[176:179], a[76:79], v[48:51], v[176:179]
	v_cvt_pk_bf16_f32 v59, v38, v39
	v_mfma_f32_16x16x32_bf16 v[32:35], a[0:3], a[224:227], -4.0
	v_exp_f32 v40, v40
	v_mfma_f32_16x16x32_bf16 v[32:35], a[4:7], a[228:231], v[32:35]
	v_mfma_f32_16x16x32_bf16 v[32:35], a[8:11], a[232:235], v[32:35]
	v_exp_f32 v41, v41
	v_mfma_f32_16x16x32_bf16 v[32:35], a[12:15], a[236:239], v[32:35]
	v_cvt_pk_bf16_f32 v60, v40, v41
	v_mfma_f32_16x16x32_bf16 v[36:39], a[28:31], a[236:239], -4.0
	v_exp_f32 v42, v42
	v_mfma_f32_16x16x32_bf16 v[36:39], a[24:27], a[232:235], v[36:39]
	v_mfma_f32_16x16x32_bf16 v[36:39], a[20:23], a[228:231], v[36:39]
	v_exp_f32 v43, v43
	v_mfma_f32_16x16x32_bf16 v[36:39], a[16:19], a[224:227], v[36:39]
	v_cvt_pk_bf16_f32 v61, v42, v43
	v_mfma_f32_16x16x32_bf16 v[192:195], a[80:83], v[48:51], v[192:195]
L_pg18:
	s_cbranch_execz L_pg22
	s_add_u32 s73, s85, 0x2000000
	v_exp_f32 v44, v44
	v_mfma_f32_16x16x32_bf16 v[192:195], a[112:115], v[52:55], v[192:195]
	buffer_store_dwordx4 v[80:83], v13, s[48:51], s73 offen sc1
	v_mfma_f32_16x16x32_bf16 v[208:211], a[116:119], v[52:55], v[208:211]
	s_waitcnt lgkmcnt(0)
	v_exp_f32 v45, v45
	v_mfma_f32_16x16x32_bf16 v[208:211], a[84:87], v[48:51], v[208:211]
	v_cvt_pk_bf16_f32 v62, v44, v45
	v_mfma_f32_16x16x32_bf16 v[224:227], a[88:91], v[48:51], v[224:227]
	s_add_u32 s73, s85, 0x2004000
	v_exp_f32 v46, v46
	v_mfma_f32_16x16x32_bf16 v[224:227], a[120:123], v[52:55], v[224:227]
	buffer_store_dwordx4 v[84:87], v13, s[48:51], s73 offen sc1
	v_mfma_f32_16x16x32_bf16 v[240:243], a[124:127], v[52:55], v[240:243]
	s_waitcnt vmcnt(6)
	v_exp_f32 v47, v47
	v_mfma_f32_16x16x32_bf16 v[240:243], a[92:95], v[48:51], v[240:243]
	s_barrier
	v_cvt_pk_bf16_f32 v63, v46, v47
	v_mfma_f32_16x16x32_bf16 v[40:43], a[32:35], a[224:227], -4.0
	s_add_u32 m0, s65, 0x0
	v_exp_f32 v32, v32
	v_mfma_f32_16x16x32_bf16 v[40:43], a[36:39], a[228:231], v[40:43]
	buffer_load_dwordx4 v18, s[8:11], s68 offen lds
	v_mfma_f32_16x16x32_bf16 v[40:43], a[40:43], a[232:235], v[40:43]
	v_exp_f32 v33, v33
	v_mfma_f32_16x16x32_bf16 v[40:43], a[44:47], a[236:239], v[40:43]
	v_cvt_pk_bf16_f32 v48, v32, v33
	v_mfma_f32_16x16x32_bf16 v[44:47], a[60:63], a[236:239], -4.0
	v_exp_f32 v34, v34
	v_mfma_f32_16x16x32_bf16 v[44:47], a[56:59], a[232:235], v[44:47]
	buffer_load_dwordx4 v19, s[8:11], s68 offen offset:1024 lds
	v_mfma_f32_16x16x32_bf16 v[44:47], a[52:55], a[228:231], v[44:47]
	s_add_u32 s68, s68, 0x2000
	v_exp_f32 v35, v35
	v_mfma_f32_16x16x32_bf16 v[44:47], a[48:51], a[224:227], v[44:47]
	s_and_b32 s68, s68, 0x7ffff
	v_cvt_pk_bf16_f32 v49, v34, v35
	v_smfmac_f32_16x16x64_bf16 a[132:135], a[168:171], v[56:63], v31
	v_mfma_f32_16x16x32_bf16 v[132:135], a[64:67], v[56:59], v[132:135]
	s_add_u32 m0, s65, 0x2000
	v_exp_f32 v36, v36
	v_mfma_f32_16x16x32_bf16 v[132:135], a[96:99], v[60:63], v[132:135]
	buffer_load_dwordx4 v18, s[8:11], s68 offen lds
	v_mfma_f32_16x16x32_bf16 v[148:151], a[100:103], v[60:63], v[148:151]
	v_exp_f32 v37, v37
	v_mfma_f32_16x16x32_bf16 v[148:151], a[68:71], v[56:59], v[148:151]
	v_cvt_pk_bf16_f32 v50, v36, v37
	v_mfma_f32_16x16x32_bf16 v[164:167], a[72:75], v[56:59], v[164:167]
	v_exp_f32 v38, v38
	v_mfma_f32_16x16x32_bf16 v[164:167], a[104:107], v[60:63], v[164:167]
	buffer_load_dwordx4 v19, s[8:11], s68 offen offset:1024 lds
	v_mfma_f32_16x16x32_bf16 v[180:183], a[108:111], v[60:63], v[180:183]
	s_add_u32 s68, s68, 0x2000
	v_exp_f32 v39, v39
	v_mfma_f32_16x16x32_bf16 v[180:183], a[76:79], v[56:59], v[180:183]
	s_and_b32 s68, s68, 0x7ffff
	v_cvt_pk_bf16_f32 v51, v38, v39
	v_mfma_f32_16x16x32_bf16 v[32:35], a[0:3], a[240:243], -4.0
	s_add_u32 m0, s65, 0x8000
	v_exp_f32 v40, v40
	v_mfma_f32_16x16x32_bf16 v[32:35], a[4:7], a[244:247], v[32:35]
	buffer_load_dwordx4 v20, s[12:15], s69 offen lds
	v_mfma_f32_16x16x32_bf16 v[32:35], a[8:11], a[248:251], v[32:35]
	v_exp_f32 v41, v41
	v_mfma_f32_16x16x32_bf16 v[32:35], a[12:15], a[252:255], v[32:35]
	ds_read_b128 a[0:3], v9 offset:16384
	v_cvt_pk_bf16_f32 v52, v40, v41
	v_mfma_f32_16x16x32_bf16 v[36:39], a[28:31], a[252:255], -4.0
	v_exp_f32 v42, v42
	v_mfma_f32_16x16x32_bf16 v[36:39], a[24:27], a[248:251], v[36:39]
	buffer_load_dwordx4 v21, s[12:15], s69 offen offset:1024 lds
	v_mfma_f32_16x16x32_bf16 v[36:39], a[20:23], a[244:247], v[36:39]
	v_exp_f32 v43, v43
	v_mfma_f32_16x16x32_bf16 v[36:39], a[16:19], a[240:243], v[36:39]
	ds_read_b128 a[4:7], v10 offset:16384
	v_cvt_pk_bf16_f32 v53, v42, v43
	v_mfma_f32_16x16x32_bf16 v[196:199], a[80:83], v[56:59], v[196:199]
	v_exp_f32 v44, v44
	v_mfma_f32_16x16x32_bf16 v[196:199], a[112:115], v[60:63], v[196:199]
	ds_read_b128 a[8:11], v11 offset:16384
	ds_read_b128 a[12:15], v12 offset:16384
	v_mfma_f32_16x16x32_bf16 v[212:215], a[116:119], v[60:63], v[212:215]
	s_add_u32 s69, s69, 0x2000
	v_exp_f32 v45, v45
	v_mfma_f32_16x16x32_bf16 v[212:215], a[84:87], v[56:59], v[212:215]
	s_and_b32 s69, s69, 0x7ffff
	ds_read_b128 a[28:31], v12 offset:20480
	v_cvt_pk_bf16_f32 v54, v44, v45
	v_mfma_f32_16x16x32_bf16 v[228:231], a[88:91], v[56:59], v[228:231]
	s_add_u32 m0, s65, 0xa000
	v_exp_f32 v46, v46
	v_mfma_f32_16x16x32_bf16 v[228:231], a[120:123], v[60:63], v[228:231]
	buffer_load_dwordx4 v20, s[12:15], s69 offen lds
	v_mfma_f32_16x16x32_bf16 v[244:247], a[124:127], v[60:63], v[244:247]
	v_exp_f32 v47, v47
	v_mfma_f32_16x16x32_bf16 v[244:247], a[92:95], v[56:59], v[244:247]
	ds_read_b128 a[24:27], v11 offset:20480
	v_cvt_pk_bf16_f32 v55, v46, v47
	v_mfma_f32_16x16x32_bf16 v[40:43], a[32:35], a[240:243], -4.0
	s_add_u32 m0, s65, 0xa000
	v_exp_f32 v32, v32
	v_mfma_f32_16x16x32_bf16 v[40:43], a[36:39], a[244:247], v[40:43]
	buffer_load_dwordx4 v21, s[12:15], s69 offen offset:1024 lds
	v_mfma_f32_16x16x32_bf16 v[40:43], a[40:43], a[248:251], v[40:43]
	s_add_u32 s69, s69, 0x2000
	v_exp_f32 v33, v33
	v_mfma_f32_16x16x32_bf16 v[40:43], a[44:47], a[252:255], v[40:43]
	s_and_b32 s69, s69, 0x7ffff
	ds_read_b128 a[20:23], v10 offset:20480
	v_cvt_pk_bf16_f32 v56, v32, v33
	v_mfma_f32_16x16x32_bf16 v[44:47], a[60:63], a[252:255], -4.0
	s_add_u32 s73, s85, 0x2008000
	v_exp_f32 v34, v34
	v_mfma_f32_16x16x32_bf16 v[44:47], a[56:59], a[248:251], v[44:47]
	buffer_store_dwordx4 v[88:91], v13, s[48:51], s73 offen sc1
	v_mfma_f32_16x16x32_bf16 v[44:47], a[52:55], a[244:247], v[44:47]
	v_exp_f32 v35, v35
	v_mfma_f32_16x16x32_bf16 v[44:47], a[48:51], a[240:243], v[44:47]
	ds_read_b128 a[16:19], v9 offset:20480
	v_cvt_pk_bf16_f32 v57, v34, v35
	v_smfmac_f32_16x16x64_bf16 a[136:139], a[128:131], v[48:55], v31
	v_mfma_f32_16x16x32_bf16 v[136:139], a[64:67], v[48:51], v[136:139]
	v_exp_f32 v36, v36
	v_mfma_f32_16x16x32_bf16 v[136:139], a[96:99], v[52:55], v[136:139]
	ds_read_b128 a[32:35], v9 offset:24576
	ds_read_b128 a[36:39], v10 offset:24576
	v_mfma_f32_16x16x32_bf16 v[152:155], a[100:103], v[52:55], v[152:155]
	v_exp_f32 v37, v37
	v_mfma_f32_16x16x32_bf16 v[152:155], a[68:71], v[48:51], v[152:155]
	ds_read_b128 a[40:43], v11 offset:24576
	v_cvt_pk_bf16_f32 v58, v36, v37
	v_mfma_f32_16x16x32_bf16 v[168:171], a[72:75], v[48:51], v[168:171]
	v_exp_f32 v38, v38
	v_mfma_f32_16x16x32_bf16 v[168:171], a[104:107], v[52:55], v[168:171]
	ds_read_b128 a[44:47], v12 offset:24576
	ds_read_b128 a[60:63], v12 offset:28672
	v_mfma_f32_16x16x32_bf16 v[184:187], a[108:111], v[52:55], v[184:187]
	v_exp_f32 v39, v39
	v_mfma_f32_16x16x32_bf16 v[184:187], a[76:79], v[48:51], v[184:187]
	s_waitcnt lgkmcnt(6)
	ds_read_b128 a[56:59], v11 offset:28672
	v_cvt_pk_bf16_f32 v59, v38, v39
	v_mfma_f32_16x16x32_bf16 v[32:35], a[0:3], a[192:195], -4.0
	s_add_u32 s73, s85, 0x200c000
	v_exp_f32 v40, v40
	v_mfma_f32_16x16x32_bf16 v[32:35], a[4:7], a[196:199], v[32:35]
	buffer_store_dwordx4 v[92:95], v13, s[48:51], s73 offen sc1
	v_mfma_f32_16x16x32_bf16 v[32:35], a[8:11], a[200:203], v[32:35]
	v_exp_f32 v41, v41
	v_mfma_f32_16x16x32_bf16 v[32:35], a[12:15], a[204:207], v[32:35]
	ds_read_b128 a[52:55], v10 offset:28672
	v_cvt_pk_bf16_f32 v60, v40, v41
	v_mfma_f32_16x16x32_bf16 v[36:39], a[28:31], a[204:207], -4.0
	s_add_u32 s73, s85, 0x2010000
	v_exp_f32 v42, v42
	v_mfma_f32_16x16x32_bf16 v[36:39], a[24:27], a[200:203], v[36:39]
	buffer_store_dwordx4 v[112:115], v13, s[48:51], s73 offen sc1
	v_mfma_f32_16x16x32_bf16 v[36:39], a[20:23], a[196:199], v[36:39]
	s_waitcnt lgkmcnt(4)
	v_exp_f32 v43, v43
	v_mfma_f32_16x16x32_bf16 v[36:39], a[16:19], a[192:195], v[36:39]
	ds_read_b128 a[48:51], v9 offset:28672
	v_cvt_pk_bf16_f32 v61, v42, v43
	v_mfma_f32_16x16x32_bf16 v[200:203], a[80:83], v[48:51], v[200:203]
	v_exp_f32 v44, v44
	v_mfma_f32_16x16x32_bf16 v[200:203], a[112:115], v[52:55], v[200:203]
	v_mfma_f32_16x16x32_bf16 v[216:219], a[116:119], v[52:55], v[216:219]
	v_exp_f32 v45, v45
	v_mfma_f32_16x16x32_bf16 v[216:219], a[84:87], v[48:51], v[216:219]
	v_cvt_pk_bf16_f32 v62, v44, v45
	v_mfma_f32_16x16x32_bf16 v[232:235], a[88:91], v[48:51], v[232:235]
	v_exp_f32 v46, v46
	v_mfma_f32_16x16x32_bf16 v[232:235], a[120:123], v[52:55], v[232:235]
	v_mfma_f32_16x16x32_bf16 v[248:251], a[124:127], v[52:55], v[248:251]
	v_exp_f32 v47, v47
	v_mfma_f32_16x16x32_bf16 v[248:251], a[92:95], v[48:51], v[248:251]
	v_cvt_pk_bf16_f32 v63, v46, v47
	v_mfma_f32_16x16x32_bf16 v[40:43], a[32:35], a[192:195], -4.0
	s_waitcnt vmcnt(13)
	s_barrier
	s_add_u32 s73, s85, 0x2014000
	v_exp_f32 v32, v32
	v_mfma_f32_16x16x32_bf16 v[40:43], a[36:39], a[196:199], v[40:43]
	buffer_store_dwordx4 v[116:119], v13, s[48:51], s73 offen sc1
	v_mfma_f32_16x16x32_bf16 v[40:43], a[40:43], a[200:203], v[40:43]
	s_waitcnt lgkmcnt(0)
	v_exp_f32 v33, v33
	v_mfma_f32_16x16x32_bf16 v[40:43], a[44:47], a[204:207], v[40:43]
	v_cvt_pk_bf16_f32 v48, v32, v33
	v_mfma_f32_16x16x32_bf16 v[44:47], a[60:63], a[204:207], -4.0
	v_exp_f32 v34, v34
	v_mfma_f32_16x16x32_bf16 v[44:47], a[56:59], a[200:203], v[44:47]
	v_mfma_f32_16x16x32_bf16 v[44:47], a[52:55], a[196:199], v[44:47]
	v_exp_f32 v35, v35
	v_mfma_f32_16x16x32_bf16 v[44:47], a[48:51], a[192:195], v[44:47]
	v_cvt_pk_bf16_f32 v49, v34, v35
	v_smfmac_f32_16x16x64_bf16 a[136:139], a[168:171], v[56:63], v31
	v_mfma_f32_16x16x32_bf16 v[140:143], a[64:67], v[56:59], v[140:143]
	v_exp_f32 v36, v36
	v_mfma_f32_16x16x32_bf16 v[140:143], a[96:99], v[60:63], v[140:143]
	ds_read_b64_tr_b16 a[64:65], v1 offset:16384
	ds_read_b64_tr_b16 a[66:67], v1 offset:20480
	v_mfma_f32_16x16x32_bf16 v[156:159], a[100:103], v[60:63], v[156:159]
	v_exp_f32 v37, v37
	v_mfma_f32_16x16x32_bf16 v[156:159], a[68:71], v[56:59], v[156:159]
	ds_read_b64_tr_b16 a[96:97], v1 offset:24576
	v_cvt_pk_bf16_f32 v50, v36, v37
	v_mfma_f32_16x16x32_bf16 v[172:175], a[72:75], v[56:59], v[172:175]
	v_exp_f32 v38, v38
	v_mfma_f32_16x16x32_bf16 v[172:175], a[104:107], v[60:63], v[172:175]
	ds_read_b64_tr_b16 a[98:99], v1 offset:28672
	ds_read_b64_tr_b16 a[100:101], v2 offset:24576
	v_mfma_f32_16x16x32_bf16 v[188:191], a[108:111], v[60:63], v[188:191]
	v_exp_f32 v39, v39
	v_mfma_f32_16x16x32_bf16 v[188:191], a[76:79], v[56:59], v[188:191]
	ds_read_b64_tr_b16 a[102:103], v2 offset:28672
	v_cvt_pk_bf16_f32 v51, v38, v39
	v_mfma_f32_16x16x32_bf16 v[32:35], a[0:3], a[208:211], -4.0
	v_exp_f32 v40, v40
	v_mfma_f32_16x16x32_bf16 v[32:35], a[4:7], a[212:215], v[32:35]
	ds_read_b64_tr_b16 a[68:69], v2 offset:16384
	ds_read_b64_tr_b16 a[70:71], v2 offset:20480
	v_mfma_f32_16x16x32_bf16 v[32:35], a[8:11], a[216:219], v[32:35]
	v_exp_f32 v41, v41
	v_mfma_f32_16x16x32_bf16 v[32:35], a[12:15], a[220:223], v[32:35]
	ds_read_b64_tr_b16 a[72:73], v3 offset:16384
	v_cvt_pk_bf16_f32 v52, v40, v41
	v_mfma_f32_16x16x32_bf16 v[36:39], a[28:31], a[220:223], -4.0
	v_exp_f32 v42, v42
	v_mfma_f32_16x16x32_bf16 v[36:39], a[24:27], a[216:219], v[36:39]
	ds_read_b64_tr_b16 a[74:75], v3 offset:20480
	ds_read_b64_tr_b16 a[104:105], v3 offset:24576
	v_mfma_f32_16x16x32_bf16 v[36:39], a[20:23], a[212:215], v[36:39]
	v_exp_f32 v43, v43
	v_mfma_f32_16x16x32_bf16 v[36:39], a[16:19], a[208:211], v[36:39]
	ds_read_b64_tr_b16 a[106:107], v3 offset:28672
	v_cvt_pk_bf16_f32 v53, v42, v43
	v_mfma_f32_16x16x32_bf16 v[204:207], a[80:83], v[56:59], v[204:207]
	v_exp_f32 v44, v44
	v_mfma_f32_16x16x32_bf16 v[204:207], a[112:115], v[60:63], v[204:207]
	ds_read_b64_tr_b16 a[108:109], v4 offset:24576
	ds_read_b64_tr_b16 a[110:111], v4 offset:28672
	v_mfma_f32_16x16x32_bf16 v[220:223], a[116:119], v[60:63], v[220:223]
	v_exp_f32 v45, v45
	v_mfma_f32_16x16x32_bf16 v[220:223], a[84:87], v[56:59], v[220:223]
	ds_read_b64_tr_b16 a[76:77], v4 offset:16384
	v_cvt_pk_bf16_f32 v54, v44, v45
	v_mfma_f32_16x16x32_bf16 v[236:239], a[88:91], v[56:59], v[236:239]
	v_exp_f32 v46, v46
	v_mfma_f32_16x16x32_bf16 v[236:239], a[120:123], v[60:63], v[236:239]
	ds_read_b64_tr_b16 a[78:79], v4 offset:20480
	ds_read_b64_tr_b16 a[80:81], v5 offset:16384
	v_mfma_f32_16x16x32_bf16 v[252:255], a[124:127], v[60:63], v[252:255]
	v_exp_f32 v47, v47
	v_mfma_f32_16x16x32_bf16 v[252:255], a[92:95], v[56:59], v[252:255]
	ds_read_b64_tr_b16 a[82:83], v5 offset:20480
	v_cvt_pk_bf16_f32 v55, v46, v47
	v_mfma_f32_16x16x32_bf16 v[40:43], a[32:35], a[208:211], -4.0
	v_exp_f32 v32, v32
	v_mfma_f32_16x16x32_bf16 v[40:43], a[36:39], a[212:215], v[40:43]
	ds_read_b64_tr_b16 a[112:113], v5 offset:24576
	ds_read_b64_tr_b16 a[114:115], v5 offset:28672
	v_mfma_f32_16x16x32_bf16 v[40:43], a[40:43], a[216:219], v[40:43]
	v_exp_f32 v33, v33
	v_mfma_f32_16x16x32_bf16 v[40:43], a[44:47], a[220:223], v[40:43]
	ds_read_b64_tr_b16 a[116:117], v6 offset:24576
	v_cvt_pk_bf16_f32 v56, v32, v33
	v_mfma_f32_16x16x32_bf16 v[44:47], a[60:63], a[220:223], -4.0
	v_exp_f32 v34, v34
	v_mfma_f32_16x16x32_bf16 v[44:47], a[56:59], a[216:219], v[44:47]
	ds_read_b64_tr_b16 a[118:119], v6 offset:28672
	ds_read_b64_tr_b16 a[84:85], v6 offset:16384
	v_mfma_f32_16x16x32_bf16 v[44:47], a[52:55], a[212:215], v[44:47]
	v_exp_f32 v35, v35
	v_mfma_f32_16x16x32_bf16 v[44:47], a[48:51], a[208:211], v[44:47]
	ds_read_b64_tr_b16 a[86:87], v6 offset:20480
	v_cvt_pk_bf16_f32 v57, v34, v35
	v_smfmac_f32_16x16x64_bf16 a[132:135], a[128:131], v[48:55], v31
	s_waitcnt lgkmcnt(7)
	v_mfma_f32_16x16x32_bf16 v[128:131], a[64:67], v[48:51], v[128:131]
	v_exp_f32 v36, v36
	v_mfma_f32_16x16x32_bf16 v[128:131], a[96:99], v[52:55], v[128:131]
	ds_read_b64_tr_b16 a[88:89], v7 offset:16384
	ds_read_b64_tr_b16 a[90:91], v7 offset:20480
	v_mfma_f32_16x16x32_bf16 v[144:147], a[100:103], v[52:55], v[144:147]
	v_exp_f32 v37, v37
	v_mfma_f32_16x16x32_bf16 v[144:147], a[68:71], v[48:51], v[144:147]
	ds_read_b64_tr_b16 a[120:121], v7 offset:24576
	v_cvt_pk_bf16_f32 v58, v36, v37
	v_mfma_f32_16x16x32_bf16 v[160:163], a[72:75], v[48:51], v[160:163]
	v_exp_f32 v38, v38
	v_mfma_f32_16x16x32_bf16 v[160:163], a[104:107], v[52:55], v[160:163]
	ds_read_b64_tr_b16 a[122:123], v7 offset:28672
	ds_read_b64_tr_b16 a[124:125], v8 offset:24576
	v_mfma_f32_16x16x32_bf16 v[176:179], a[108:111], v[52:55], v[176:179]
	v_exp_f32 v39, v39
	v_mfma_f32_16x16x32_bf16 v[176:179], a[76:79], v[48:51], v[176:179]
	ds_read_b64_tr_b16 a[126:127], v8 offset:28672
	v_cvt_pk_bf16_f32 v59, v38, v39
	v_mfma_f32_16x16x32_bf16 v[32:35], a[0:3], a[224:227], -4.0
	v_exp_f32 v40, v40
	v_mfma_f32_16x16x32_bf16 v[32:35], a[4:7], a[228:231], v[32:35]
	ds_read_b64_tr_b16 a[92:93], v8 offset:16384
	ds_read_b64_tr_b16 a[94:95], v8 offset:20480
	v_mfma_f32_16x16x32_bf16 v[32:35], a[8:11], a[232:235], v[32:35]
	v_exp_f32 v41, v41
	v_mfma_f32_16x16x32_bf16 v[32:35], a[12:15], a[236:239], v[32:35]
	v_cvt_pk_bf16_f32 v60, v40, v41
	v_mfma_f32_16x16x32_bf16 v[36:39], a[28:31], a[236:239], -4.0
	v_exp_f32 v42, v42
	v_mfma_f32_16x16x32_bf16 v[36:39], a[24:27], a[232:235], v[36:39]
	v_mfma_f32_16x16x32_bf16 v[36:39], a[20:23], a[228:231], v[36:39]
	v_exp_f32 v43, v43
	v_mfma_f32_16x16x32_bf16 v[36:39], a[16:19], a[224:227], v[36:39]
	s_waitcnt lgkmcnt(3)
	v_cvt_pk_bf16_f32 v61, v42, v43
	v_mfma_f32_16x16x32_bf16 v[192:195], a[80:83], v[48:51], v[192:195]
	s_add_u32 s73, s85, 0x2018000
	v_exp_f32 v44, v44
	v_mfma_f32_16x16x32_bf16 v[192:195], a[112:115], v[52:55], v[192:195]
	buffer_store_dwordx4 v[120:123], v13, s[48:51], s73 offen sc1
	v_mfma_f32_16x16x32_bf16 v[208:211], a[116:119], v[52:55], v[208:211]
	v_exp_f32 v45, v45
	v_mfma_f32_16x16x32_bf16 v[208:211], a[84:87], v[48:51], v[208:211]
	v_cvt_pk_bf16_f32 v62, v44, v45
	v_mfma_f32_16x16x32_bf16 v[224:227], a[88:91], v[48:51], v[224:227]
	s_add_u32 s73, s85, 0x201c000
	v_exp_f32 v46, v46
	v_mfma_f32_16x16x32_bf16 v[224:227], a[120:123], v[52:55], v[224:227]
	s_waitcnt lgkmcnt(0)
	buffer_store_dwordx4 v[124:127], v13, s[48:51], s73 offen sc1
	v_mfma_f32_16x16x32_bf16 v[240:243], a[124:127], v[52:55], v[240:243]
	s_waitcnt vmcnt(6)
	v_exp_f32 v47, v47
	v_mfma_f32_16x16x32_bf16 v[240:243], a[92:95], v[48:51], v[240:243]
	s_barrier
	v_cvt_pk_bf16_f32 v63, v46, v47
	v_mfma_f32_16x16x32_bf16 v[40:43], a[32:35], a[224:227], -4.0
	s_add_u32 m0, s65, 0x4000
	v_exp_f32 v32, v32
	v_mfma_f32_16x16x32_bf16 v[40:43], a[36:39], a[228:231], v[40:43]
	buffer_load_dwordx4 v18, s[8:11], s68 offen lds
	v_mfma_f32_16x16x32_bf16 v[40:43], a[40:43], a[232:235], v[40:43]
	v_exp_f32 v33, v33
	v_mfma_f32_16x16x32_bf16 v[40:43], a[44:47], a[236:239], v[40:43]
	v_cvt_pk_bf16_f32 v48, v32, v33
	v_mfma_f32_16x16x32_bf16 v[44:47], a[60:63], a[236:239], -4.0
	v_exp_f32 v34, v34
	v_mfma_f32_16x16x32_bf16 v[44:47], a[56:59], a[232:235], v[44:47]
	buffer_load_dwordx4 v19, s[8:11], s68 offen offset:1024 lds
	v_mfma_f32_16x16x32_bf16 v[44:47], a[52:55], a[228:231], v[44:47]
	s_add_u32 s68, s68, 0x2000
	v_exp_f32 v35, v35
	v_mfma_f32_16x16x32_bf16 v[44:47], a[48:51], a[224:227], v[44:47]
	s_and_b32 s68, s68, 0x7ffff
	v_cvt_pk_bf16_f32 v49, v34, v35
	v_smfmac_f32_16x16x64_bf16 a[132:135], a[168:171], v[56:63], v31
	v_mfma_f32_16x16x32_bf16 v[132:135], a[64:67], v[56:59], v[132:135]
	s_add_u32 m0, s65, 0x6000
	v_exp_f32 v36, v36
	v_mfma_f32_16x16x32_bf16 v[132:135], a[96:99], v[60:63], v[132:135]
	buffer_load_dwordx4 v18, s[8:11], s68 offen lds
	v_mfma_f32_16x16x32_bf16 v[148:151], a[100:103], v[60:63], v[148:151]
	v_exp_f32 v37, v37
	v_mfma_f32_16x16x32_bf16 v[148:151], a[68:71], v[56:59], v[148:151]
	v_cvt_pk_bf16_f32 v50, v36, v37
	v_mfma_f32_16x16x32_bf16 v[164:167], a[72:75], v[56:59], v[164:167]
	v_exp_f32 v38, v38
	v_mfma_f32_16x16x32_bf16 v[164:167], a[104:107], v[60:63], v[164:167]
	buffer_load_dwordx4 v19, s[8:11], s68 offen offset:1024 lds
	v_mfma_f32_16x16x32_bf16 v[180:183], a[108:111], v[60:63], v[180:183]
	s_add_u32 s68, s68, 0x2000
	v_exp_f32 v39, v39
	v_mfma_f32_16x16x32_bf16 v[180:183], a[76:79], v[56:59], v[180:183]
	s_and_b32 s68, s68, 0x7ffff
	v_cvt_pk_bf16_f32 v51, v38, v39
	v_mfma_f32_16x16x32_bf16 v[32:35], a[0:3], a[240:243], -4.0
	s_add_u32 m0, s65, 0xc000
	v_exp_f32 v40, v40
	v_mfma_f32_16x16x32_bf16 v[32:35], a[4:7], a[244:247], v[32:35]
	buffer_load_dwordx4 v20, s[12:15], s69 offen lds
	v_mfma_f32_16x16x32_bf16 v[32:35], a[8:11], a[248:251], v[32:35]
	v_exp_f32 v41, v41
	v_mfma_f32_16x16x32_bf16 v[32:35], a[12:15], a[252:255], v[32:35]
	ds_read_b128 a[0:3], v9 offset:0
	v_cvt_pk_bf16_f32 v52, v40, v41
	v_mfma_f32_16x16x32_bf16 v[36:39], a[28:31], a[252:255], -4.0
	v_exp_f32 v42, v42
	v_mfma_f32_16x16x32_bf16 v[36:39], a[24:27], a[248:251], v[36:39]
	buffer_load_dwordx4 v21, s[12:15], s69 offen offset:1024 lds
	v_mfma_f32_16x16x32_bf16 v[36:39], a[20:23], a[244:247], v[36:39]
	v_exp_f32 v43, v43
	v_mfma_f32_16x16x32_bf16 v[36:39], a[16:19], a[240:243], v[36:39]
	ds_read_b128 a[4:7], v10 offset:0
	v_cvt_pk_bf16_f32 v53, v42, v43
	v_mfma_f32_16x16x32_bf16 v[196:199], a[80:83], v[56:59], v[196:199]
	v_exp_f32 v44, v44
	v_mfma_f32_16x16x32_bf16 v[196:199], a[112:115], v[60:63], v[196:199]
	ds_read_b128 a[8:11], v11 offset:0
	ds_read_b128 a[12:15], v12 offset:0
	v_mfma_f32_16x16x32_bf16 v[212:215], a[116:119], v[60:63], v[212:215]
	s_add_u32 s69, s69, 0x2000
	v_exp_f32 v45, v45
	v_mfma_f32_16x16x32_bf16 v[212:215], a[84:87], v[56:59], v[212:215]
	s_and_b32 s69, s69, 0x7ffff
	ds_read_b128 a[28:31], v12 offset:4096
	v_cvt_pk_bf16_f32 v54, v44, v45
	v_mfma_f32_16x16x32_bf16 v[228:231], a[88:91], v[56:59], v[228:231]
	s_add_u32 m0, s65, 0xe000
	v_exp_f32 v46, v46
	v_mfma_f32_16x16x32_bf16 v[228:231], a[120:123], v[60:63], v[228:231]
	buffer_load_dwordx4 v20, s[12:15], s69 offen lds
	v_mfma_f32_16x16x32_bf16 v[244:247], a[124:127], v[60:63], v[244:247]
	v_exp_f32 v47, v47
	v_mfma_f32_16x16x32_bf16 v[244:247], a[92:95], v[56:59], v[244:247]
	ds_read_b128 a[24:27], v11 offset:4096
	v_cvt_pk_bf16_f32 v55, v46, v47
	v_mfma_f32_16x16x32_bf16 v[40:43], a[32:35], a[240:243], -4.0
	s_add_u32 m0, s65, 0xe000
	v_exp_f32 v32, v32
	v_mfma_f32_16x16x32_bf16 v[40:43], a[36:39], a[244:247], v[40:43]
	buffer_load_dwordx4 v21, s[12:15], s69 offen offset:1024 lds
	v_mfma_f32_16x16x32_bf16 v[40:43], a[40:43], a[248:251], v[40:43]
	s_add_u32 s69, s69, 0x2000
	v_exp_f32 v33, v33
	v_mfma_f32_16x16x32_bf16 v[40:43], a[44:47], a[252:255], v[40:43]
	s_and_b32 s69, s69, 0x7ffff
	ds_read_b128 a[20:23], v10 offset:4096
	v_cvt_pk_bf16_f32 v56, v32, v33
	v_mfma_f32_16x16x32_bf16 v[44:47], a[60:63], a[252:255], -4.0
	s_add_u32 s73, s85, 0x2000400
	v_exp_f32 v34, v34
	v_mfma_f32_16x16x32_bf16 v[44:47], a[56:59], a[248:251], v[44:47]
	buffer_store_dwordx4 v[64:67], v13, s[48:51], s73 offen sc1
	v_mfma_f32_16x16x32_bf16 v[44:47], a[52:55], a[244:247], v[44:47]
	v_exp_f32 v35, v35
	v_mfma_f32_16x16x32_bf16 v[44:47], a[48:51], a[240:243], v[44:47]
	ds_read_b128 a[16:19], v9 offset:4096
	v_cvt_pk_bf16_f32 v57, v34, v35
	v_smfmac_f32_16x16x64_bf16 a[136:139], a[128:131], v[48:55], v31
	v_mfma_f32_16x16x32_bf16 v[136:139], a[64:67], v[48:51], v[136:139]
	v_exp_f32 v36, v36
	v_mfma_f32_16x16x32_bf16 v[136:139], a[96:99], v[52:55], v[136:139]
	ds_read_b128 a[32:35], v9 offset:8192
	ds_read_b128 a[36:39], v10 offset:8192
	v_mfma_f32_16x16x32_bf16 v[152:155], a[100:103], v[52:55], v[152:155]
	v_exp_f32 v37, v37
	v_mfma_f32_16x16x32_bf16 v[152:155], a[68:71], v[48:51], v[152:155]
	ds_read_b128 a[40:43], v11 offset:8192
	v_cvt_pk_bf16_f32 v58, v36, v37
	v_mfma_f32_16x16x32_bf16 v[168:171], a[72:75], v[48:51], v[168:171]
	v_exp_f32 v38, v38
	v_mfma_f32_16x16x32_bf16 v[168:171], a[104:107], v[52:55], v[168:171]
	ds_read_b128 a[44:47], v12 offset:8192
	ds_read_b128 a[60:63], v12 offset:12288
	v_mfma_f32_16x16x32_bf16 v[184:187], a[108:111], v[52:55], v[184:187]
	v_exp_f32 v39, v39
	v_mfma_f32_16x16x32_bf16 v[184:187], a[76:79], v[48:51], v[184:187]
	s_waitcnt lgkmcnt(6)
	ds_read_b128 a[56:59], v11 offset:12288
	v_cvt_pk_bf16_f32 v59, v38, v39
	v_mfma_f32_16x16x32_bf16 v[32:35], a[0:3], a[192:195], -4.0
	s_add_u32 s73, s85, 0x2004400
	v_exp_f32 v40, v40
	v_mfma_f32_16x16x32_bf16 v[32:35], a[4:7], a[196:199], v[32:35]
	buffer_store_dwordx4 v[68:71], v13, s[48:51], s73 offen sc1
	v_mfma_f32_16x16x32_bf16 v[32:35], a[8:11], a[200:203], v[32:35]
	v_exp_f32 v41, v41
	v_mfma_f32_16x16x32_bf16 v[32:35], a[12:15], a[204:207], v[32:35]
	ds_read_b128 a[52:55], v10 offset:12288
	v_cvt_pk_bf16_f32 v60, v40, v41
	v_mfma_f32_16x16x32_bf16 v[36:39], a[28:31], a[204:207], -4.0
	s_add_u32 s73, s85, 0x2008400
	v_exp_f32 v42, v42
	v_mfma_f32_16x16x32_bf16 v[36:39], a[24:27], a[200:203], v[36:39]
	buffer_store_dwordx4 v[72:75], v13, s[48:51], s73 offen sc1
	v_mfma_f32_16x16x32_bf16 v[36:39], a[20:23], a[196:199], v[36:39]
	s_waitcnt lgkmcnt(4)
	v_exp_f32 v43, v43
	v_mfma_f32_16x16x32_bf16 v[36:39], a[16:19], a[192:195], v[36:39]
	ds_read_b128 a[48:51], v9 offset:12288
	v_cvt_pk_bf16_f32 v61, v42, v43
	v_mfma_f32_16x16x32_bf16 v[200:203], a[80:83], v[48:51], v[200:203]
	v_exp_f32 v44, v44
	v_mfma_f32_16x16x32_bf16 v[200:203], a[112:115], v[52:55], v[200:203]
	v_mfma_f32_16x16x32_bf16 v[216:219], a[116:119], v[52:55], v[216:219]
	v_exp_f32 v45, v45
	v_mfma_f32_16x16x32_bf16 v[216:219], a[84:87], v[48:51], v[216:219]
	v_cvt_pk_bf16_f32 v62, v44, v45
	v_mfma_f32_16x16x32_bf16 v[232:235], a[88:91], v[48:51], v[232:235]
	v_exp_f32 v46, v46
	v_mfma_f32_16x16x32_bf16 v[232:235], a[120:123], v[52:55], v[232:235]
	v_mfma_f32_16x16x32_bf16 v[248:251], a[124:127], v[52:55], v[248:251]
	v_exp_f32 v47, v47
	v_mfma_f32_16x16x32_bf16 v[248:251], a[92:95], v[48:51], v[248:251]
	v_cvt_pk_bf16_f32 v63, v46, v47
	v_mfma_f32_16x16x32_bf16 v[40:43], a[32:35], a[192:195], -4.0
	s_add_u32 s73, s85, 0x200c400
	v_exp_f32 v32, v32
	v_mfma_f32_16x16x32_bf16 v[40:43], a[36:39], a[196:199], v[40:43]
	buffer_store_dwordx4 v[76:79], v13, s[48:51], s73 offen sc1
	v_mfma_f32_16x16x32_bf16 v[40:43], a[40:43], a[200:203], v[40:43]
	s_waitcnt lgkmcnt(0)
	v_exp_f32 v33, v33
	v_mfma_f32_16x16x32_bf16 v[40:43], a[44:47], a[204:207], v[40:43]
	v_cvt_pk_bf16_f32 v48, v32, v33
	v_mfma_f32_16x16x32_bf16 v[44:47], a[60:63], a[204:207], -4.0
	v_exp_f32 v34, v34
	v_mfma_f32_16x16x32_bf16 v[44:47], a[56:59], a[200:203], v[44:47]
	v_mfma_f32_16x16x32_bf16 v[44:47], a[52:55], a[196:199], v[44:47]
	v_exp_f32 v35, v35
	v_mfma_f32_16x16x32_bf16 v[44:47], a[48:51], a[192:195], v[44:47]
	v_cvt_pk_bf16_f32 v49, v34, v35
	v_smfmac_f32_16x16x64_bf16 a[136:139], a[168:171], v[56:63], v31
	v_mfma_f32_16x16x32_bf16 v[140:143], a[64:67], v[56:59], v[140:143]
	v_exp_f32 v36, v36
	v_mfma_f32_16x16x32_bf16 v[140:143], a[96:99], v[60:63], v[140:143]
	ds_read_b64_tr_b16 a[64:65], v1 offset:0
	ds_read_b64_tr_b16 a[66:67], v1 offset:4096
	v_mfma_f32_16x16x32_bf16 v[156:159], a[100:103], v[60:63], v[156:159]
	v_exp_f32 v37, v37
	v_mfma_f32_16x16x32_bf16 v[156:159], a[68:71], v[56:59], v[156:159]
	ds_read_b64_tr_b16 a[96:97], v1 offset:8192
	v_cvt_pk_bf16_f32 v50, v36, v37
	v_mfma_f32_16x16x32_bf16 v[172:175], a[72:75], v[56:59], v[172:175]
	v_exp_f32 v38, v38
	v_mfma_f32_16x16x32_bf16 v[172:175], a[104:107], v[60:63], v[172:175]
	ds_read_b64_tr_b16 a[98:99], v1 offset:12288
	ds_read_b64_tr_b16 a[100:101], v2 offset:8192
	v_mfma_f32_16x16x32_bf16 v[188:191], a[108:111], v[60:63], v[188:191]
	v_exp_f32 v39, v39
	v_mfma_f32_16x16x32_bf16 v[188:191], a[76:79], v[56:59], v[188:191]
	ds_read_b64_tr_b16 a[102:103], v2 offset:12288
	v_cvt_pk_bf16_f32 v51, v38, v39
	v_mfma_f32_16x16x32_bf16 v[32:35], a[0:3], a[208:211], -4.0
	v_exp_f32 v40, v40
	v_mfma_f32_16x16x32_bf16 v[32:35], a[4:7], a[212:215], v[32:35]
	ds_read_b64_tr_b16 a[68:69], v2 offset:0
	ds_read_b64_tr_b16 a[70:71], v2 offset:4096
	v_mfma_f32_16x16x32_bf16 v[32:35], a[8:11], a[216:219], v[32:35]
	v_exp_f32 v41, v41
	v_mfma_f32_16x16x32_bf16 v[32:35], a[12:15], a[220:223], v[32:35]
	ds_read_b64_tr_b16 a[72:73], v3 offset:0
	v_cvt_pk_bf16_f32 v52, v40, v41
	v_mfma_f32_16x16x32_bf16 v[36:39], a[28:31], a[220:223], -4.0
	v_exp_f32 v42, v42
	v_mfma_f32_16x16x32_bf16 v[36:39], a[24:27], a[216:219], v[36:39]
	ds_read_b64_tr_b16 a[74:75], v3 offset:4096
	ds_read_b64_tr_b16 a[104:105], v3 offset:8192
	v_mfma_f32_16x16x32_bf16 v[36:39], a[20:23], a[212:215], v[36:39]
	v_exp_f32 v43, v43
	v_mfma_f32_16x16x32_bf16 v[36:39], a[16:19], a[208:211], v[36:39]
	ds_read_b64_tr_b16 a[106:107], v3 offset:12288
	v_cvt_pk_bf16_f32 v53, v42, v43
	v_mfma_f32_16x16x32_bf16 v[204:207], a[80:83], v[56:59], v[204:207]
	v_exp_f32 v44, v44
	v_mfma_f32_16x16x32_bf16 v[204:207], a[112:115], v[60:63], v[204:207]
	ds_read_b64_tr_b16 a[108:109], v4 offset:8192
	ds_read_b64_tr_b16 a[110:111], v4 offset:12288
	v_mfma_f32_16x16x32_bf16 v[220:223], a[116:119], v[60:63], v[220:223]
	v_exp_f32 v45, v45
	v_mfma_f32_16x16x32_bf16 v[220:223], a[84:87], v[56:59], v[220:223]
	ds_read_b64_tr_b16 a[76:77], v4 offset:0
	v_cvt_pk_bf16_f32 v54, v44, v45
	v_mfma_f32_16x16x32_bf16 v[236:239], a[88:91], v[56:59], v[236:239]
	v_exp_f32 v46, v46
	v_mfma_f32_16x16x32_bf16 v[236:239], a[120:123], v[60:63], v[236:239]
	ds_read_b64_tr_b16 a[78:79], v4 offset:4096
	ds_read_b64_tr_b16 a[80:81], v5 offset:0
	v_mfma_f32_16x16x32_bf16 v[252:255], a[124:127], v[60:63], v[252:255]
	v_exp_f32 v47, v47
	v_mfma_f32_16x16x32_bf16 v[252:255], a[92:95], v[56:59], v[252:255]
	ds_read_b64_tr_b16 a[82:83], v5 offset:4096
	v_cvt_pk_bf16_f32 v55, v46, v47
	v_mfma_f32_16x16x32_bf16 v[40:43], a[32:35], a[208:211], -4.0
L_pg19:
	s_cbranch_execz L_pg23
	v_exp_f32 v32, v32
	v_mfma_f32_16x16x32_bf16 v[40:43], a[36:39], a[212:215], v[40:43]
	ds_read_b64_tr_b16 a[112:113], v5 offset:8192
	ds_read_b64_tr_b16 a[114:115], v5 offset:12288
	v_mfma_f32_16x16x32_bf16 v[40:43], a[40:43], a[216:219], v[40:43]
	v_exp_f32 v33, v33
	v_mfma_f32_16x16x32_bf16 v[40:43], a[44:47], a[220:223], v[40:43]
	ds_read_b64_tr_b16 a[116:117], v6 offset:8192
	v_cvt_pk_bf16_f32 v56, v32, v33
	v_mfma_f32_16x16x32_bf16 v[44:47], a[60:63], a[220:223], -4.0
	v_exp_f32 v34, v34
	v_mfma_f32_16x16x32_bf16 v[44:47], a[56:59], a[216:219], v[44:47]
	ds_read_b64_tr_b16 a[118:119], v6 offset:12288
	ds_read_b64_tr_b16 a[84:85], v6 offset:0
	v_mfma_f32_16x16x32_bf16 v[44:47], a[52:55], a[212:215], v[44:47]
	v_exp_f32 v35, v35
	v_mfma_f32_16x16x32_bf16 v[44:47], a[48:51], a[208:211], v[44:47]
	ds_read_b64_tr_b16 a[86:87], v6 offset:4096
	v_cvt_pk_bf16_f32 v57, v34, v35
	v_smfmac_f32_16x16x64_bf16 a[132:135], a[128:131], v[48:55], v31
	s_waitcnt lgkmcnt(7)
	v_mfma_f32_16x16x32_bf16 v[128:131], a[64:67], v[48:51], v[128:131]
	v_exp_f32 v36, v36
	v_mfma_f32_16x16x32_bf16 v[128:131], a[96:99], v[52:55], v[128:131]
	ds_read_b64_tr_b16 a[88:89], v7 offset:0
	ds_read_b64_tr_b16 a[90:91], v7 offset:4096
	v_mfma_f32_16x16x32_bf16 v[144:147], a[100:103], v[52:55], v[144:147]
	v_exp_f32 v37, v37
	v_mfma_f32_16x16x32_bf16 v[144:147], a[68:71], v[48:51], v[144:147]
	ds_read_b64_tr_b16 a[120:121], v7 offset:8192
	v_cvt_pk_bf16_f32 v58, v36, v37
	v_mfma_f32_16x16x32_bf16 v[160:163], a[72:75], v[48:51], v[160:163]
	v_exp_f32 v38, v38
	v_mfma_f32_16x16x32_bf16 v[160:163], a[104:107], v[52:55], v[160:163]
	ds_read_b64_tr_b16 a[122:123], v7 offset:12288
	ds_read_b64_tr_b16 a[124:125], v8 offset:8192
	v_mfma_f32_16x16x32_bf16 v[176:179], a[108:111], v[52:55], v[176:179]
	v_exp_f32 v39, v39
	v_mfma_f32_16x16x32_bf16 v[176:179], a[76:79], v[48:51], v[176:179]
	ds_read_b64_tr_b16 a[126:127], v8 offset:12288
	v_cvt_pk_bf16_f32 v59, v38, v39
	v_mfma_f32_16x16x32_bf16 v[32:35], a[0:3], a[224:227], -4.0
	v_exp_f32 v40, v40
	v_mfma_f32_16x16x32_bf16 v[32:35], a[4:7], a[228:231], v[32:35]
	ds_read_b64_tr_b16 a[92:93], v8 offset:0
	ds_read_b64_tr_b16 a[94:95], v8 offset:4096
	v_mfma_f32_16x16x32_bf16 v[32:35], a[8:11], a[232:235], v[32:35]
	v_exp_f32 v41, v41
	v_mfma_f32_16x16x32_bf16 v[32:35], a[12:15], a[236:239], v[32:35]
	v_cvt_pk_bf16_f32 v60, v40, v41
	v_add_u32 v26, s93, v13
	v_mfma_f32_16x16x32_bf16 v[36:39], a[28:31], a[236:239], -4.0
	v_exp_f32 v42, v42
	v_mfma_f32_16x16x32_bf16 v[36:39], a[24:27], a[232:235], v[36:39]
	v_min_u32 v26, s58, v26
	v_mov_b32 v27, 0
	v_mfma_f32_16x16x32_bf16 v[36:39], a[20:23], a[228:231], v[36:39]
	v_exp_f32 v43, v43
	v_mfma_f32_16x16x32_bf16 v[36:39], a[16:19], a[224:227], v[36:39]
	s_waitcnt lgkmcnt(3)
	v_cvt_pk_bf16_f32 v61, v42, v43
	v_lshl_add_u64 v[26:27], v[26:27], 0, s[56:57]
	v_mfma_f32_16x16x32_bf16 v[192:195], a[80:83], v[48:51], v[192:195]
	s_add_u32 s73, s85, 0x2010400
	v_exp_f32 v44, v44
	v_mfma_f32_16x16x32_bf16 v[192:195], a[112:115], v[52:55], v[192:195]
	buffer_store_dwordx4 v[96:99], v13, s[48:51], s73 offen sc1
	v_mfma_f32_16x16x32_bf16 v[208:211], a[116:119], v[52:55], v[208:211]
	v_exp_f32 v45, v45
	v_mfma_f32_16x16x32_bf16 v[208:211], a[84:87], v[48:51], v[208:211]
	v_cvt_pk_bf16_f32 v62, v44, v45
	v_mfma_f32_16x16x32_bf16 v[224:227], a[88:91], v[48:51], v[224:227]
	s_add_u32 s73, s85, 0x2014400
	v_exp_f32 v46, v46
	v_mfma_f32_16x16x32_bf16 v[224:227], a[120:123], v[52:55], v[224:227]
	s_waitcnt lgkmcnt(0)
	buffer_store_dwordx4 v[100:103], v13, s[48:51], s73 offen sc1
	v_mfma_f32_16x16x32_bf16 v[240:243], a[124:127], v[52:55], v[240:243]
	s_waitcnt vmcnt(6)
	v_exp_f32 v47, v47
	v_mfma_f32_16x16x32_bf16 v[240:243], a[92:95], v[48:51], v[240:243]
	s_barrier
	v_cvt_pk_bf16_f32 v63, v46, v47
	v_mfma_f32_16x16x32_bf16 v[40:43], a[32:35], a[224:227], -4.0
	s_add_u32 m0, s65, 0x0
	v_exp_f32 v32, v32
	v_mfma_f32_16x16x32_bf16 v[40:43], a[36:39], a[228:231], v[40:43]
	buffer_load_dwordx4 v18, s[8:11], s68 offen lds
	v_mfma_f32_16x16x32_bf16 v[40:43], a[40:43], a[232:235], v[40:43]
	v_exp_f32 v33, v33
	v_mfma_f32_16x16x32_bf16 v[40:43], a[44:47], a[236:239], v[40:43]
	v_cvt_pk_bf16_f32 v48, v32, v33
	v_mfma_f32_16x16x32_bf16 v[44:47], a[60:63], a[236:239], -4.0
	v_exp_f32 v34, v34
	v_mfma_f32_16x16x32_bf16 v[44:47], a[56:59], a[232:235], v[44:47]
	buffer_load_dwordx4 v19, s[8:11], s68 offen offset:1024 lds
	v_mfma_f32_16x16x32_bf16 v[44:47], a[52:55], a[228:231], v[44:47]
	s_add_u32 s68, s68, 0x2000
	v_exp_f32 v35, v35
	v_mfma_f32_16x16x32_bf16 v[44:47], a[48:51], a[224:227], v[44:47]
	s_and_b32 s68, s68, 0x7ffff
	v_cvt_pk_bf16_f32 v49, v34, v35
	v_smfmac_f32_16x16x64_bf16 a[132:135], a[168:171], v[56:63], v31
	v_mfma_f32_16x16x32_bf16 v[132:135], a[64:67], v[56:59], v[132:135]
	s_add_u32 m0, s65, 0x2000
	v_exp_f32 v36, v36
	v_mfma_f32_16x16x32_bf16 v[132:135], a[96:99], v[60:63], v[132:135]
	buffer_load_dwordx4 v18, s[8:11], s68 offen lds
	v_mfma_f32_16x16x32_bf16 v[148:151], a[100:103], v[60:63], v[148:151]
	v_exp_f32 v37, v37
	v_mfma_f32_16x16x32_bf16 v[148:151], a[68:71], v[56:59], v[148:151]
	v_cvt_pk_bf16_f32 v50, v36, v37
	v_mfma_f32_16x16x32_bf16 v[164:167], a[72:75], v[56:59], v[164:167]
	v_exp_f32 v38, v38
	v_mfma_f32_16x16x32_bf16 v[164:167], a[104:107], v[60:63], v[164:167]
	buffer_load_dwordx4 v19, s[8:11], s68 offen offset:1024 lds
	v_mfma_f32_16x16x32_bf16 v[180:183], a[108:111], v[60:63], v[180:183]
	s_add_u32 s68, s68, 0x2000
	v_exp_f32 v39, v39
	v_mfma_f32_16x16x32_bf16 v[180:183], a[76:79], v[56:59], v[180:183]
	s_and_b32 s68, s68, 0x7ffff
	v_cvt_pk_bf16_f32 v51, v38, v39
	v_mfma_f32_16x16x32_bf16 v[32:35], a[0:3], a[240:243], -4.0
	s_add_u32 m0, s65, 0x8000
	v_exp_f32 v40, v40
	v_mfma_f32_16x16x32_bf16 v[32:35], a[4:7], a[244:247], v[32:35]
	buffer_load_dwordx4 v20, s[12:15], s69 offen lds
	v_mfma_f32_16x16x32_bf16 v[32:35], a[8:11], a[248:251], v[32:35]
	v_exp_f32 v41, v41
	v_mfma_f32_16x16x32_bf16 v[32:35], a[12:15], a[252:255], v[32:35]
	ds_read_b128 a[0:3], v9 offset:16384
	v_cvt_pk_bf16_f32 v52, v40, v41
	v_mfma_f32_16x16x32_bf16 v[36:39], a[28:31], a[252:255], -4.0
	v_exp_f32 v42, v42
	v_mfma_f32_16x16x32_bf16 v[36:39], a[24:27], a[248:251], v[36:39]
	buffer_load_dwordx4 v21, s[12:15], s69 offen offset:1024 lds
	v_mfma_f32_16x16x32_bf16 v[36:39], a[20:23], a[244:247], v[36:39]
	v_exp_f32 v43, v43
	v_mfma_f32_16x16x32_bf16 v[36:39], a[16:19], a[240:243], v[36:39]
	ds_read_b128 a[4:7], v10 offset:16384
	v_cvt_pk_bf16_f32 v53, v42, v43
	v_mfma_f32_16x16x32_bf16 v[196:199], a[80:83], v[56:59], v[196:199]
	v_exp_f32 v44, v44
	v_mfma_f32_16x16x32_bf16 v[196:199], a[112:115], v[60:63], v[196:199]
	ds_read_b128 a[8:11], v11 offset:16384
	ds_read_b128 a[12:15], v12 offset:16384
	v_mfma_f32_16x16x32_bf16 v[212:215], a[116:119], v[60:63], v[212:215]
	s_add_u32 s69, s69, 0x2000
	v_exp_f32 v45, v45
	v_mfma_f32_16x16x32_bf16 v[212:215], a[84:87], v[56:59], v[212:215]
	s_and_b32 s69, s69, 0x7ffff
	ds_read_b128 a[28:31], v12 offset:20480
	v_cvt_pk_bf16_f32 v54, v44, v45
	v_mfma_f32_16x16x32_bf16 v[228:231], a[88:91], v[56:59], v[228:231]
	s_add_u32 m0, s65, 0xa000
	v_exp_f32 v46, v46
	v_mfma_f32_16x16x32_bf16 v[228:231], a[120:123], v[60:63], v[228:231]
	buffer_load_dwordx4 v20, s[12:15], s69 offen lds
	v_mfma_f32_16x16x32_bf16 v[244:247], a[124:127], v[60:63], v[244:247]
	v_exp_f32 v47, v47
	v_mfma_f32_16x16x32_bf16 v[244:247], a[92:95], v[56:59], v[244:247]
	ds_read_b128 a[24:27], v11 offset:20480
	v_cvt_pk_bf16_f32 v55, v46, v47
	v_mfma_f32_16x16x32_bf16 v[40:43], a[32:35], a[240:243], -4.0
	s_add_u32 m0, s65, 0xa000
	v_exp_f32 v32, v32
	v_mfma_f32_16x16x32_bf16 v[40:43], a[36:39], a[244:247], v[40:43]
	buffer_load_dwordx4 v21, s[12:15], s69 offen offset:1024 lds
	v_mfma_f32_16x16x32_bf16 v[40:43], a[40:43], a[248:251], v[40:43]
	s_add_u32 s69, s69, 0x2000
	v_exp_f32 v33, v33
	v_mfma_f32_16x16x32_bf16 v[40:43], a[44:47], a[252:255], v[40:43]
	s_and_b32 s69, s69, 0x7ffff
	ds_read_b128 a[20:23], v10 offset:20480
	v_cvt_pk_bf16_f32 v56, v32, v33
	v_mfma_f32_16x16x32_bf16 v[44:47], a[60:63], a[252:255], -4.0
	s_add_u32 s73, s85, 0x2018400
	v_exp_f32 v34, v34
	v_mfma_f32_16x16x32_bf16 v[44:47], a[56:59], a[248:251], v[44:47]
	buffer_store_dwordx4 v[104:107], v13, s[48:51], s73 offen sc1
	v_mfma_f32_16x16x32_bf16 v[44:47], a[52:55], a[244:247], v[44:47]
	v_exp_f32 v35, v35
	v_mfma_f32_16x16x32_bf16 v[44:47], a[48:51], a[240:243], v[44:47]
	ds_read_b128 a[16:19], v9 offset:20480
	v_cvt_pk_bf16_f32 v57, v34, v35
	v_smfmac_f32_16x16x64_bf16 a[136:139], a[128:131], v[48:55], v31
	v_mfma_f32_16x16x32_bf16 v[136:139], a[64:67], v[48:51], v[136:139]
	v_exp_f32 v36, v36
	v_mfma_f32_16x16x32_bf16 v[136:139], a[96:99], v[52:55], v[136:139]
	ds_read_b128 a[32:35], v9 offset:24576
	ds_read_b128 a[36:39], v10 offset:24576
	v_mfma_f32_16x16x32_bf16 v[152:155], a[100:103], v[52:55], v[152:155]
	v_exp_f32 v37, v37
	v_mfma_f32_16x16x32_bf16 v[152:155], a[68:71], v[48:51], v[152:155]
	ds_read_b128 a[40:43], v11 offset:24576
	v_cvt_pk_bf16_f32 v58, v36, v37
	v_mfma_f32_16x16x32_bf16 v[168:171], a[72:75], v[48:51], v[168:171]
	v_exp_f32 v38, v38
	v_mfma_f32_16x16x32_bf16 v[168:171], a[104:107], v[52:55], v[168:171]
	ds_read_b128 a[44:47], v12 offset:24576
	ds_read_b128 a[60:63], v12 offset:28672
	v_mfma_f32_16x16x32_bf16 v[184:187], a[108:111], v[52:55], v[184:187]
	v_exp_f32 v39, v39
	v_mfma_f32_16x16x32_bf16 v[184:187], a[76:79], v[48:51], v[184:187]
	s_waitcnt lgkmcnt(6)
	ds_read_b128 a[56:59], v11 offset:28672
	v_cvt_pk_bf16_f32 v59, v38, v39
	v_mfma_f32_16x16x32_bf16 v[32:35], a[0:3], a[192:195], -4.0
	s_add_u32 s73, s85, 0x201c400
	v_exp_f32 v40, v40
	v_mfma_f32_16x16x32_bf16 v[32:35], a[4:7], a[196:199], v[32:35]
	buffer_store_dwordx4 v[108:111], v13, s[48:51], s73 offen sc1
	v_mfma_f32_16x16x32_bf16 v[32:35], a[8:11], a[200:203], v[32:35]
	v_exp_f32 v41, v41
	v_mfma_f32_16x16x32_bf16 v[32:35], a[12:15], a[204:207], v[32:35]
	ds_read_b128 a[52:55], v10 offset:28672
	v_cvt_pk_bf16_f32 v60, v40, v41
	v_mfma_f32_16x16x32_bf16 v[36:39], a[28:31], a[204:207], -4.0
	v_exp_f32 v42, v42
	v_mfma_f32_16x16x32_bf16 v[36:39], a[24:27], a[200:203], v[36:39]
	global_load_dwordx4 a[152:155], v[26:27], off
	v_mfma_f32_16x16x32_bf16 v[36:39], a[20:23], a[196:199], v[36:39]
	s_waitcnt lgkmcnt(4)
	v_exp_f32 v43, v43
	v_mfma_f32_16x16x32_bf16 v[36:39], a[16:19], a[192:195], v[36:39]
	ds_read_b128 a[48:51], v9 offset:28672
	v_cvt_pk_bf16_f32 v61, v42, v43
	v_mfma_f32_16x16x32_bf16 v[200:203], a[80:83], v[48:51], v[200:203]
	v_exp_f32 v44, v44
	v_mfma_f32_16x16x32_bf16 v[200:203], a[112:115], v[52:55], v[200:203]
	buffer_load_dwordx4 a[152:155], v13, s[20:23], s96 offen offset:0
	v_mfma_f32_16x16x32_bf16 v[216:219], a[116:119], v[52:55], v[216:219]
	v_exp_f32 v45, v45
	v_mfma_f32_16x16x32_bf16 v[216:219], a[84:87], v[48:51], v[216:219]
	v_cvt_pk_bf16_f32 v62, v44, v45
	v_mfma_f32_16x16x32_bf16 v[232:235], a[88:91], v[48:51], v[232:235]
	v_exp_f32 v46, v46
	v_mfma_f32_16x16x32_bf16 v[232:235], a[120:123], v[52:55], v[232:235]
	v_mfma_f32_16x16x32_bf16 v[248:251], a[124:127], v[52:55], v[248:251]
	v_exp_f32 v47, v47
	v_mfma_f32_16x16x32_bf16 v[248:251], a[92:95], v[48:51], v[248:251]
	v_cvt_pk_bf16_f32 v63, v46, v47
	v_mfma_f32_16x16x32_bf16 v[40:43], a[32:35], a[192:195], -4.0
	v_exp_f32 v32, v32
	v_mfma_f32_16x16x32_bf16 v[40:43], a[36:39], a[196:199], v[40:43]
	buffer_load_dwordx4 a[152:155], v13, s[20:23], s96 offen offset:1024
	v_mfma_f32_16x16x32_bf16 v[40:43], a[40:43], a[200:203], v[40:43]
	s_waitcnt lgkmcnt(0)
	v_exp_f32 v33, v33
	v_mfma_f32_16x16x32_bf16 v[40:43], a[44:47], a[204:207], v[40:43]
	v_cvt_pk_bf16_f32 v48, v32, v33
	v_mfma_f32_16x16x32_bf16 v[44:47], a[60:63], a[204:207], -4.0
	v_exp_f32 v34, v34
	v_mfma_f32_16x16x32_bf16 v[44:47], a[56:59], a[200:203], v[44:47]
	buffer_load_dwordx4 a[152:155], v13, s[20:23], s96 offen offset:2048
	v_mfma_f32_16x16x32_bf16 v[44:47], a[52:55], a[196:199], v[44:47]
	v_exp_f32 v35, v35
	v_mfma_f32_16x16x32_bf16 v[44:47], a[48:51], a[192:195], v[44:47]
	v_cvt_pk_bf16_f32 v49, v34, v35
	v_smfmac_f32_16x16x64_bf16 a[136:139], a[168:171], v[56:63], v31
	v_mfma_f32_16x16x32_bf16 v[140:143], a[64:67], v[56:59], v[140:143]
	v_exp_f32 v36, v36
	v_mfma_f32_16x16x32_bf16 v[140:143], a[96:99], v[60:63], v[140:143]
	ds_read_b64_tr_b16 a[64:65], v1 offset:16384
	ds_read_b64_tr_b16 a[66:67], v1 offset:20480
	v_mfma_f32_16x16x32_bf16 v[156:159], a[100:103], v[60:63], v[156:159]
	v_exp_f32 v37, v37
	v_mfma_f32_16x16x32_bf16 v[156:159], a[68:71], v[56:59], v[156:159]
	ds_read_b64_tr_b16 a[96:97], v1 offset:24576
	v_cvt_pk_bf16_f32 v50, v36, v37
	v_mfma_f32_16x16x32_bf16 v[172:175], a[72:75], v[56:59], v[172:175]
	v_exp_f32 v38, v38
	v_mfma_f32_16x16x32_bf16 v[172:175], a[104:107], v[60:63], v[172:175]
	ds_read_b64_tr_b16 a[98:99], v1 offset:28672
	ds_read_b64_tr_b16 a[100:101], v2 offset:24576
	v_mfma_f32_16x16x32_bf16 v[188:191], a[108:111], v[60:63], v[188:191]
	v_exp_f32 v39, v39
	v_mfma_f32_16x16x32_bf16 v[188:191], a[76:79], v[56:59], v[188:191]
	ds_read_b64_tr_b16 a[102:103], v2 offset:28672
	v_cvt_pk_bf16_f32 v51, v38, v39
	v_mfma_f32_16x16x32_bf16 v[32:35], a[0:3], a[208:211], -4.0
	v_exp_f32 v40, v40
	v_mfma_f32_16x16x32_bf16 v[32:35], a[4:7], a[212:215], v[32:35]
	ds_read_b64_tr_b16 a[68:69], v2 offset:16384
	ds_read_b64_tr_b16 a[70:71], v2 offset:20480
	v_mfma_f32_16x16x32_bf16 v[32:35], a[8:11], a[216:219], v[32:35]
	v_exp_f32 v41, v41
	v_mfma_f32_16x16x32_bf16 v[32:35], a[12:15], a[220:223], v[32:35]
	ds_read_b64_tr_b16 a[72:73], v3 offset:16384
	v_cvt_pk_bf16_f32 v52, v40, v41
	v_mfma_f32_16x16x32_bf16 v[36:39], a[28:31], a[220:223], -4.0
	v_exp_f32 v42, v42
	v_mfma_f32_16x16x32_bf16 v[36:39], a[24:27], a[216:219], v[36:39]
	ds_read_b64_tr_b16 a[74:75], v3 offset:20480
	ds_read_b64_tr_b16 a[104:105], v3 offset:24576
	v_mfma_f32_16x16x32_bf16 v[36:39], a[20:23], a[212:215], v[36:39]
	v_exp_f32 v43, v43
	v_mfma_f32_16x16x32_bf16 v[36:39], a[16:19], a[208:211], v[36:39]
	ds_read_b64_tr_b16 a[106:107], v3 offset:28672
	v_cvt_pk_bf16_f32 v53, v42, v43
	v_mfma_f32_16x16x32_bf16 v[204:207], a[80:83], v[56:59], v[204:207]
	v_exp_f32 v44, v44
	v_mfma_f32_16x16x32_bf16 v[204:207], a[112:115], v[60:63], v[204:207]
	ds_read_b64_tr_b16 a[108:109], v4 offset:24576
	ds_read_b64_tr_b16 a[110:111], v4 offset:28672
	v_mfma_f32_16x16x32_bf16 v[220:223], a[116:119], v[60:63], v[220:223]
	v_exp_f32 v45, v45
	v_mfma_f32_16x16x32_bf16 v[220:223], a[84:87], v[56:59], v[220:223]
	ds_read_b64_tr_b16 a[76:77], v4 offset:16384
	v_cvt_pk_bf16_f32 v54, v44, v45
	v_mfma_f32_16x16x32_bf16 v[236:239], a[88:91], v[56:59], v[236:239]
	v_exp_f32 v46, v46
	v_mfma_f32_16x16x32_bf16 v[236:239], a[120:123], v[60:63], v[236:239]
	ds_read_b64_tr_b16 a[78:79], v4 offset:20480
	ds_read_b64_tr_b16 a[80:81], v5 offset:16384
	v_mfma_f32_16x16x32_bf16 v[252:255], a[124:127], v[60:63], v[252:255]
	v_exp_f32 v47, v47
	v_mfma_f32_16x16x32_bf16 v[252:255], a[92:95], v[56:59], v[252:255]
	ds_read_b64_tr_b16 a[82:83], v5 offset:20480
	v_cvt_pk_bf16_f32 v55, v46, v47
	v_mfma_f32_16x16x32_bf16 v[40:43], a[32:35], a[208:211], -4.0
	v_exp_f32 v32, v32
	v_mfma_f32_16x16x32_bf16 v[40:43], a[36:39], a[212:215], v[40:43]
	ds_read_b64_tr_b16 a[112:113], v5 offset:24576
	ds_read_b64_tr_b16 a[114:115], v5 offset:28672
	v_mfma_f32_16x16x32_bf16 v[40:43], a[40:43], a[216:219], v[40:43]
	v_exp_f32 v33, v33
	v_mfma_f32_16x16x32_bf16 v[40:43], a[44:47], a[220:223], v[40:43]
	ds_read_b64_tr_b16 a[116:117], v6 offset:24576
	v_cvt_pk_bf16_f32 v56, v32, v33
	v_mfma_f32_16x16x32_bf16 v[44:47], a[60:63], a[220:223], -4.0
	v_exp_f32 v34, v34
	v_mfma_f32_16x16x32_bf16 v[44:47], a[56:59], a[216:219], v[44:47]
	ds_read_b64_tr_b16 a[118:119], v6 offset:28672
	ds_read_b64_tr_b16 a[84:85], v6 offset:16384
	v_mfma_f32_16x16x32_bf16 v[44:47], a[52:55], a[212:215], v[44:47]
	v_exp_f32 v35, v35
	v_mfma_f32_16x16x32_bf16 v[44:47], a[48:51], a[208:211], v[44:47]
	ds_read_b64_tr_b16 a[86:87], v6 offset:20480
	v_cvt_pk_bf16_f32 v57, v34, v35
	v_smfmac_f32_16x16x64_bf16 a[132:135], a[128:131], v[48:55], v31
	s_waitcnt lgkmcnt(7)
	v_mfma_f32_16x16x32_bf16 v[128:131], a[64:67], v[48:51], v[128:131]
	v_exp_f32 v36, v36
	v_mfma_f32_16x16x32_bf16 v[128:131], a[96:99], v[52:55], v[128:131]
	ds_read_b64_tr_b16 a[88:89], v7 offset:16384
	ds_read_b64_tr_b16 a[90:91], v7 offset:20480
	v_mfma_f32_16x16x32_bf16 v[144:147], a[100:103], v[52:55], v[144:147]
	v_exp_f32 v37, v37
	v_mfma_f32_16x16x32_bf16 v[144:147], a[68:71], v[48:51], v[144:147]
	ds_read_b64_tr_b16 a[120:121], v7 offset:24576
	v_cvt_pk_bf16_f32 v58, v36, v37
	v_mfma_f32_16x16x32_bf16 v[160:163], a[72:75], v[48:51], v[160:163]
	v_exp_f32 v38, v38
	v_mfma_f32_16x16x32_bf16 v[160:163], a[104:107], v[52:55], v[160:163]
	ds_read_b64_tr_b16 a[122:123], v7 offset:28672
	ds_read_b64_tr_b16 a[124:125], v8 offset:24576
	v_mfma_f32_16x16x32_bf16 v[176:179], a[108:111], v[52:55], v[176:179]
	v_exp_f32 v39, v39
	v_mfma_f32_16x16x32_bf16 v[176:179], a[76:79], v[48:51], v[176:179]
	ds_read_b64_tr_b16 a[126:127], v8 offset:28672
	v_cvt_pk_bf16_f32 v59, v38, v39
	v_mfma_f32_16x16x32_bf16 v[32:35], a[0:3], a[224:227], -4.0
	v_exp_f32 v40, v40
	v_mfma_f32_16x16x32_bf16 v[32:35], a[4:7], a[228:231], v[32:35]
	ds_read_b64_tr_b16 a[92:93], v8 offset:16384
	ds_read_b64_tr_b16 a[94:95], v8 offset:20480
	v_mfma_f32_16x16x32_bf16 v[32:35], a[8:11], a[232:235], v[32:35]
	v_exp_f32 v41, v41
	v_mfma_f32_16x16x32_bf16 v[32:35], a[12:15], a[236:239], v[32:35]
	v_cvt_pk_bf16_f32 v60, v40, v41
	v_lshrrev_b32 v26, 2, v0
	v_mfma_f32_16x16x32_bf16 v[36:39], a[28:31], a[236:239], -4.0
	v_exp_f32 v42, v42
	v_mfma_f32_16x16x32_bf16 v[36:39], a[24:27], a[232:235], v[36:39]
	v_bfe_u32 v30, v0, 3, 2
	v_lshlrev_b32 v30, 5, v30
	v_mfma_f32_16x16x32_bf16 v[36:39], a[20:23], a[228:231], v[36:39]
	v_exp_f32 v43, v43
	v_mfma_f32_16x16x32_bf16 v[36:39], a[16:19], a[224:227], v[36:39]
	s_waitcnt lgkmcnt(3)
	v_cvt_pk_bf16_f32 v61, v42, v43
	v_lshl_or_b32 v26, v26, 7, v30
	v_mfma_f32_16x16x32_bf16 v[192:195], a[80:83], v[48:51], v[192:195]
	v_exp_f32 v44, v44
	v_mfma_f32_16x16x32_bf16 v[192:195], a[112:115], v[52:55], v[192:195]
	buffer_load_dwordx4 a[152:155], v13, s[20:23], s96 offen offset:3072
	v_mfma_f32_16x16x32_bf16 v[208:211], a[116:119], v[52:55], v[208:211]
	v_exp_f32 v45, v45
	v_mfma_f32_16x16x32_bf16 v[208:211], a[84:87], v[48:51], v[208:211]
	v_cvt_pk_bf16_f32 v62, v44, v45
	v_and_b32 v30, 3, v0
	v_mfma_f32_16x16x32_bf16 v[224:227], a[88:91], v[48:51], v[224:227]
	v_exp_f32 v46, v46
	v_mfma_f32_16x16x32_bf16 v[224:227], a[120:123], v[52:55], v[224:227]
	s_waitcnt vmcnt(5) lgkmcnt(0)
	buffer_store_dword v23, v22, s[48:51], s91 offen offset:0 sc1
	v_mfma_f32_16x16x32_bf16 v[240:243], a[124:127], v[52:55], v[240:243]
	v_exp_f32 v47, v47
	v_mfma_f32_16x16x32_bf16 v[240:243], a[92:95], v[48:51], v[240:243]
	s_barrier
	v_cvt_pk_bf16_f32 v63, v46, v47
	v_lshl_or_b32 v26, v30, 3, v26
	v_mfma_f32_16x16x32_bf16 v[40:43], a[32:35], a[224:227], -4.0
	s_add_u32 m0, s65, 0x4000
	v_exp_f32 v32, v32
	v_mfma_f32_16x16x32_bf16 v[40:43], a[36:39], a[228:231], v[40:43]
	buffer_load_dwordx4 v18, s[8:11], s68 offen lds
	v_mfma_f32_16x16x32_bf16 v[40:43], a[40:43], a[232:235], v[40:43]
	v_exp_f32 v33, v33
	v_mfma_f32_16x16x32_bf16 v[40:43], a[44:47], a[236:239], v[40:43]
	v_cvt_pk_bf16_f32 v48, v32, v33
	v_add_u32 v26, s64, v26
	v_mfma_f32_16x16x32_bf16 v[44:47], a[60:63], a[236:239], -4.0
	v_exp_f32 v34, v34
	v_mfma_f32_16x16x32_bf16 v[44:47], a[56:59], a[232:235], v[44:47]
	buffer_load_dwordx4 v19, s[8:11], s68 offen offset:1024 lds
	v_mfma_f32_16x16x32_bf16 v[44:47], a[52:55], a[228:231], v[44:47]
	s_add_u32 s68, s68, 0x2000
	v_exp_f32 v35, v35
	v_mfma_f32_16x16x32_bf16 v[44:47], a[48:51], a[224:227], v[44:47]
	s_and_b32 s68, s68, 0x7ffff
	v_cvt_pk_bf16_f32 v49, v34, v35
	v_xor_b32 v27, 0x20, v26
	v_smfmac_f32_16x16x64_bf16 a[132:135], a[168:171], v[56:63], v31
	v_mfma_f32_16x16x32_bf16 v[132:135], a[64:67], v[56:59], v[132:135]
	s_add_u32 m0, s65, 0x6000
	v_exp_f32 v36, v36
	v_mfma_f32_16x16x32_bf16 v[132:135], a[96:99], v[60:63], v[132:135]
	buffer_load_dwordx4 v18, s[8:11], s68 offen lds
	v_mfma_f32_16x16x32_bf16 v[148:151], a[100:103], v[60:63], v[148:151]
	v_exp_f32 v37, v37
	v_mfma_f32_16x16x32_bf16 v[148:151], a[68:71], v[56:59], v[148:151]
	v_cvt_pk_bf16_f32 v50, v36, v37
	v_xor_b32 v28, 0x40, v26
	v_mfma_f32_16x16x32_bf16 v[164:167], a[72:75], v[56:59], v[164:167]
	v_exp_f32 v38, v38
	v_mfma_f32_16x16x32_bf16 v[164:167], a[104:107], v[60:63], v[164:167]
	buffer_load_dwordx4 v19, s[8:11], s68 offen offset:1024 lds
	v_mfma_f32_16x16x32_bf16 v[180:183], a[108:111], v[60:63], v[180:183]
	s_add_u32 s68, s68, 0x2000
	v_exp_f32 v39, v39
	v_mfma_f32_16x16x32_bf16 v[180:183], a[76:79], v[56:59], v[180:183]
	s_and_b32 s68, s68, 0x7ffff
	v_cvt_pk_bf16_f32 v51, v38, v39
	v_xor_b32 v29, 0x60, v26
	v_mfma_f32_16x16x32_bf16 v[32:35], a[0:3], a[240:243], -4.0
	s_add_u32 m0, s65, 0xc000
	v_exp_f32 v40, v40
	v_mfma_f32_16x16x32_bf16 v[32:35], a[4:7], a[244:247], v[32:35]
	buffer_load_dwordx4 v20, s[12:15], s69 offen lds
	v_mfma_f32_16x16x32_bf16 v[32:35], a[8:11], a[248:251], v[32:35]
	v_exp_f32 v41, v41
	v_mfma_f32_16x16x32_bf16 v[32:35], a[12:15], a[252:255], v[32:35]
	ds_read_b128 a[0:3], v9 offset:0
	v_cvt_pk_bf16_f32 v52, v40, v41
	v_mfma_f32_16x16x32_bf16 v[36:39], a[28:31], a[252:255], -4.0
	v_exp_f32 v42, v42
	v_mfma_f32_16x16x32_bf16 v[36:39], a[24:27], a[248:251], v[36:39]
	buffer_load_dwordx4 v21, s[12:15], s69 offen offset:1024 lds
	v_mfma_f32_16x16x32_bf16 v[36:39], a[20:23], a[244:247], v[36:39]
	v_exp_f32 v43, v43
	v_mfma_f32_16x16x32_bf16 v[36:39], a[16:19], a[240:243], v[36:39]
	ds_read_b128 a[4:7], v10 offset:0
	v_cvt_pk_bf16_f32 v53, v42, v43
	v_mfma_f32_16x16x32_bf16 v[196:199], a[80:83], v[56:59], v[196:199]
	v_exp_f32 v44, v44
	v_mfma_f32_16x16x32_bf16 v[196:199], a[112:115], v[60:63], v[196:199]
	ds_read_b128 a[8:11], v11 offset:0
	ds_read_b128 a[12:15], v12 offset:0
	v_mfma_f32_16x16x32_bf16 v[212:215], a[116:119], v[60:63], v[212:215]
	s_add_u32 s69, s69, 0x2000
	v_exp_f32 v45, v45
	v_mfma_f32_16x16x32_bf16 v[212:215], a[84:87], v[56:59], v[212:215]
	s_and_b32 s69, s69, 0x7ffff
	ds_read_b128 a[28:31], v12 offset:4096
	v_cvt_pk_bf16_f32 v54, v44, v45
	v_mfma_f32_16x16x32_bf16 v[228:231], a[88:91], v[56:59], v[228:231]
	s_add_u32 m0, s65, 0xe000
	v_exp_f32 v46, v46
	v_mfma_f32_16x16x32_bf16 v[228:231], a[120:123], v[60:63], v[228:231]
	buffer_load_dwordx4 v20, s[12:15], s69 offen lds
	v_mfma_f32_16x16x32_bf16 v[244:247], a[124:127], v[60:63], v[244:247]
	v_exp_f32 v47, v47
	v_mfma_f32_16x16x32_bf16 v[244:247], a[92:95], v[56:59], v[244:247]
	ds_read_b128 a[24:27], v11 offset:4096
	v_cvt_pk_bf16_f32 v55, v46, v47
	v_mfma_f32_16x16x32_bf16 v[40:43], a[32:35], a[240:243], -4.0
	s_add_u32 m0, s65, 0xe000
	v_exp_f32 v32, v32
	v_mfma_f32_16x16x32_bf16 v[40:43], a[36:39], a[244:247], v[40:43]
	buffer_load_dwordx4 v21, s[12:15], s69 offen offset:1024 lds
	v_mfma_f32_16x16x32_bf16 v[40:43], a[40:43], a[248:251], v[40:43]
	v_exp_f32 v33, v33
	v_mfma_f32_16x16x32_bf16 v[40:43], a[44:47], a[252:255], v[40:43]
	s_add_u32 s69, s69, 0x2000
	ds_read_b128 a[20:23], v10 offset:4096
	v_cvt_pk_bf16_f32 v56, v32, v33
	v_mfma_f32_16x16x32_bf16 v[44:47], a[60:63], a[252:255], -4.0
	s_and_b32 s69, s69, 0x7ffff
	v_exp_f32 v34, v34
	v_mfma_f32_16x16x32_bf16 v[44:47], a[56:59], a[248:251], v[44:47]
	buffer_load_dwordx2 a[160:161], v17, s[4:7], s92 offen offset:0
	v_mfma_f32_16x16x32_bf16 v[44:47], a[52:55], a[244:247], v[44:47]
	v_exp_f32 v35, v35
	v_mfma_f32_16x16x32_bf16 v[44:47], a[48:51], a[240:243], v[44:47]
	ds_read_b128 a[16:19], v9 offset:4096
	v_cvt_pk_bf16_f32 v57, v34, v35
	v_smfmac_f32_16x16x64_bf16 a[136:139], a[128:131], v[48:55], v31
	v_mfma_f32_16x16x32_bf16 v[136:139], a[64:67], v[48:51], v[136:139]
	v_exp_f32 v36, v36
	v_mfma_f32_16x16x32_bf16 v[136:139], a[96:99], v[52:55], v[136:139]
	ds_read_b128 a[32:35], v9 offset:8192
	ds_read_b128 a[36:39], v10 offset:8192
	v_mfma_f32_16x16x32_bf16 v[152:155], a[100:103], v[52:55], v[152:155]
	v_exp_f32 v37, v37
	v_mfma_f32_16x16x32_bf16 v[152:155], a[68:71], v[48:51], v[152:155]
	ds_read_b128 a[40:43], v11 offset:8192
	v_cvt_pk_bf16_f32 v58, v36, v37
	v_mfma_f32_16x16x32_bf16 v[168:171], a[72:75], v[48:51], v[168:171]
	v_exp_f32 v38, v38
	v_mfma_f32_16x16x32_bf16 v[168:171], a[104:107], v[52:55], v[168:171]
	buffer_load_dwordx2 a[162:163], v17, s[4:7], s92 offen offset:32
	v_mfma_f32_16x16x32_bf16 v[184:187], a[108:111], v[52:55], v[184:187]
	v_exp_f32 v39, v39
	v_mfma_f32_16x16x32_bf16 v[184:187], a[76:79], v[48:51], v[184:187]
	s_waitcnt lgkmcnt(4)
	ds_read_b128 a[44:47], v12 offset:8192
	v_cvt_pk_bf16_f32 v59, v38, v39
	v_mfma_f32_16x16x32_bf16 v[32:35], a[0:3], a[192:195], -4.0
	v_exp_f32 v40, v40
	v_mfma_f32_16x16x32_bf16 v[32:35], a[4:7], a[196:199], v[32:35]
	buffer_load_dwordx2 a[164:165], v17, s[4:7], s92 offen offset:512
	v_mfma_f32_16x16x32_bf16 v[32:35], a[8:11], a[200:203], v[32:35]
	v_exp_f32 v41, v41
	v_mfma_f32_16x16x32_bf16 v[32:35], a[12:15], a[204:207], v[32:35]
	ds_read_b128 a[60:63], v12 offset:12288
	v_cvt_pk_bf16_f32 v60, v40, v41
	v_mfma_f32_16x16x32_bf16 v[36:39], a[28:31], a[204:207], -4.0
	v_exp_f32 v42, v42
	v_mfma_f32_16x16x32_bf16 v[36:39], a[24:27], a[200:203], v[36:39]
	buffer_load_dwordx2 a[166:167], v17, s[4:7], s92 offen offset:544
	v_mfma_f32_16x16x32_bf16 v[36:39], a[20:23], a[196:199], v[36:39]
	s_waitcnt lgkmcnt(2)
	v_exp_f32 v43, v43
	v_mfma_f32_16x16x32_bf16 v[36:39], a[16:19], a[192:195], v[36:39]
	ds_read_b128 a[56:59], v11 offset:12288
	v_cvt_pk_bf16_f32 v61, v42, v43
	v_mfma_f32_16x16x32_bf16 v[200:203], a[80:83], v[48:51], v[200:203]
	v_exp_f32 v44, v44
	v_mfma_f32_16x16x32_bf16 v[200:203], a[112:115], v[52:55], v[200:203]
	ds_read_b128 a[52:55], v10 offset:12288
	ds_read_b128 a[48:51], v9 offset:12288
	v_mfma_f32_16x16x32_bf16 v[216:219], a[116:119], v[52:55], v[216:219]
	v_exp_f32 v45, v45
	v_mfma_f32_16x16x32_bf16 v[216:219], a[84:87], v[48:51], v[216:219]
	v_cvt_pk_bf16_f32 v62, v44, v45
	v_mfma_f32_16x16x32_bf16 v[232:235], a[88:91], v[48:51], v[232:235]
	v_exp_f32 v46, v46
	v_mfma_f32_16x16x32_bf16 v[232:235], a[120:123], v[52:55], v[232:235]
	v_mfma_f32_16x16x32_bf16 v[248:251], a[124:127], v[52:55], v[248:251]
	v_exp_f32 v47, v47
	v_mfma_f32_16x16x32_bf16 v[248:251], a[92:95], v[48:51], v[248:251]
	v_cvt_pk_bf16_f32 v63, v46, v47
	v_mfma_f32_16x16x32_bf16 v[40:43], a[32:35], a[192:195], -4.0
	s_add_u32 m0, s64, 0x0
	s_xor_b32 s66, s87, 0x50200
	v_exp_f32 v32, v32
	v_mfma_f32_16x16x32_bf16 v[40:43], a[36:39], a[196:199], v[40:43]
	buffer_load_dwordx4 v14, s[20:23], s66 offen offset:0 lds
	v_mfma_f32_16x16x32_bf16 v[40:43], a[40:43], a[200:203], v[40:43]
	s_waitcnt lgkmcnt(2)
	v_exp_f32 v33, v33
	v_mfma_f32_16x16x32_bf16 v[40:43], a[44:47], a[204:207], v[40:43]
	v_cvt_pk_bf16_f32 v48, v32, v33
	v_mfma_f32_16x16x32_bf16 v[44:47], a[60:63], a[204:207], -4.0
	s_xor_b32 s66, s87, 0x51e00
	v_exp_f32 v34, v34
	v_mfma_f32_16x16x32_bf16 v[44:47], a[56:59], a[200:203], v[44:47]
	s_waitcnt lgkmcnt(0)
	buffer_load_dwordx4 v14, s[20:23], s66 offen offset:1024 lds
	v_mfma_f32_16x16x32_bf16 v[44:47], a[52:55], a[196:199], v[44:47]
L_pg20:
	s_cbranch_execz L_pg24
	v_exp_f32 v35, v35
	v_mfma_f32_16x16x32_bf16 v[44:47], a[48:51], a[192:195], v[44:47]
	v_cvt_pk_bf16_f32 v49, v34, v35
	v_smfmac_f32_16x16x64_bf16 a[136:139], a[168:171], v[56:63], v31
	v_mfma_f32_16x16x32_bf16 v[140:143], a[64:67], v[56:59], v[140:143]
	v_exp_f32 v36, v36
	v_mfma_f32_16x16x32_bf16 v[140:143], a[96:99], v[60:63], v[140:143]
	ds_read_b64_tr_b16 a[64:65], v1 offset:0
	ds_read_b64_tr_b16 a[66:67], v1 offset:4096
	v_mfma_f32_16x16x32_bf16 v[156:159], a[100:103], v[60:63], v[156:159]
	v_exp_f32 v37, v37
	v_mfma_f32_16x16x32_bf16 v[156:159], a[68:71], v[56:59], v[156:159]
	ds_read_b64_tr_b16 a[96:97], v1 offset:8192
	v_cvt_pk_bf16_f32 v50, v36, v37
	v_mfma_f32_16x16x32_bf16 v[172:175], a[72:75], v[56:59], v[172:175]
	v_exp_f32 v38, v38
	v_mfma_f32_16x16x32_bf16 v[172:175], a[104:107], v[60:63], v[172:175]
	ds_read_b64_tr_b16 a[98:99], v1 offset:12288
	ds_read_b64_tr_b16 a[100:101], v2 offset:8192
	v_mfma_f32_16x16x32_bf16 v[188:191], a[108:111], v[60:63], v[188:191]
	v_exp_f32 v39, v39
	v_mfma_f32_16x16x32_bf16 v[188:191], a[76:79], v[56:59], v[188:191]
	ds_read_b64_tr_b16 a[102:103], v2 offset:12288
	v_cvt_pk_bf16_f32 v51, v38, v39
	v_mfma_f32_16x16x32_bf16 v[32:35], a[0:3], a[208:211], -4.0
	v_exp_f32 v40, v40
	v_mfma_f32_16x16x32_bf16 v[32:35], a[4:7], a[212:215], v[32:35]
	ds_read_b64_tr_b16 a[68:69], v2 offset:0
	ds_read_b64_tr_b16 a[70:71], v2 offset:4096
	v_mfma_f32_16x16x32_bf16 v[32:35], a[8:11], a[216:219], v[32:35]
	v_exp_f32 v41, v41
	v_mfma_f32_16x16x32_bf16 v[32:35], a[12:15], a[220:223], v[32:35]
	ds_read_b64_tr_b16 a[72:73], v3 offset:0
	v_cvt_pk_bf16_f32 v52, v40, v41
	v_mfma_f32_16x16x32_bf16 v[36:39], a[28:31], a[220:223], -4.0
	v_exp_f32 v42, v42
	v_mfma_f32_16x16x32_bf16 v[36:39], a[24:27], a[216:219], v[36:39]
	ds_read_b64_tr_b16 a[74:75], v3 offset:4096
	ds_read_b64_tr_b16 a[104:105], v3 offset:8192
	v_mfma_f32_16x16x32_bf16 v[36:39], a[20:23], a[212:215], v[36:39]
	v_exp_f32 v43, v43
	v_mfma_f32_16x16x32_bf16 v[36:39], a[16:19], a[208:211], v[36:39]
	ds_read_b64_tr_b16 a[106:107], v3 offset:12288
	v_cvt_pk_bf16_f32 v53, v42, v43
	v_mfma_f32_16x16x32_bf16 v[204:207], a[80:83], v[56:59], v[204:207]
	v_exp_f32 v44, v44
	v_mfma_f32_16x16x32_bf16 v[204:207], a[112:115], v[60:63], v[204:207]
	ds_read_b64_tr_b16 a[108:109], v4 offset:8192
	ds_read_b64_tr_b16 a[110:111], v4 offset:12288
	v_mfma_f32_16x16x32_bf16 v[220:223], a[116:119], v[60:63], v[220:223]
	v_exp_f32 v45, v45
	v_mfma_f32_16x16x32_bf16 v[220:223], a[84:87], v[56:59], v[220:223]
	ds_read_b64_tr_b16 a[76:77], v4 offset:0
	v_cvt_pk_bf16_f32 v54, v44, v45
	v_mfma_f32_16x16x32_bf16 v[236:239], a[88:91], v[56:59], v[236:239]
	v_exp_f32 v46, v46
	v_mfma_f32_16x16x32_bf16 v[236:239], a[120:123], v[60:63], v[236:239]
	ds_read_b64_tr_b16 a[78:79], v4 offset:4096
	ds_read_b64_tr_b16 a[80:81], v5 offset:0
	v_mfma_f32_16x16x32_bf16 v[252:255], a[124:127], v[60:63], v[252:255]
	v_exp_f32 v47, v47
	v_mfma_f32_16x16x32_bf16 v[252:255], a[92:95], v[56:59], v[252:255]
	ds_read_b64_tr_b16 a[82:83], v5 offset:4096
	v_cvt_pk_bf16_f32 v55, v46, v47
	v_mfma_f32_16x16x32_bf16 v[40:43], a[32:35], a[208:211], -4.0
	v_exp_f32 v32, v32
	v_mfma_f32_16x16x32_bf16 v[40:43], a[36:39], a[212:215], v[40:43]
	ds_read_b64_tr_b16 a[112:113], v5 offset:8192
	ds_read_b64_tr_b16 a[114:115], v5 offset:12288
	v_mfma_f32_16x16x32_bf16 v[40:43], a[40:43], a[216:219], v[40:43]
	v_exp_f32 v33, v33
	v_mfma_f32_16x16x32_bf16 v[40:43], a[44:47], a[220:223], v[40:43]
	ds_read_b64_tr_b16 a[116:117], v6 offset:8192
	v_cvt_pk_bf16_f32 v56, v32, v33
	v_mfma_f32_16x16x32_bf16 v[44:47], a[60:63], a[220:223], -4.0
	v_exp_f32 v34, v34
	v_mfma_f32_16x16x32_bf16 v[44:47], a[56:59], a[216:219], v[44:47]
	ds_read_b64_tr_b16 a[118:119], v6 offset:12288
	ds_read_b64_tr_b16 a[84:85], v6 offset:0
	v_mfma_f32_16x16x32_bf16 v[44:47], a[52:55], a[212:215], v[44:47]
	v_exp_f32 v35, v35
	v_mfma_f32_16x16x32_bf16 v[44:47], a[48:51], a[208:211], v[44:47]
	ds_read_b64_tr_b16 a[86:87], v6 offset:4096
	v_cvt_pk_bf16_f32 v57, v34, v35
	v_smfmac_f32_16x16x64_bf16 a[132:135], a[128:131], v[48:55], v31
	s_waitcnt lgkmcnt(7)
	v_mfma_f32_16x16x32_bf16 v[128:131], a[64:67], v[48:51], v[128:131]
	v_exp_f32 v36, v36
	v_mfma_f32_16x16x32_bf16 v[128:131], a[96:99], v[52:55], v[128:131]
	ds_read_b64_tr_b16 a[88:89], v7 offset:0
	ds_read_b64_tr_b16 a[90:91], v7 offset:4096
	v_mfma_f32_16x16x32_bf16 v[144:147], a[100:103], v[52:55], v[144:147]
	v_exp_f32 v37, v37
	v_mfma_f32_16x16x32_bf16 v[144:147], a[68:71], v[48:51], v[144:147]
	ds_read_b64_tr_b16 a[120:121], v7 offset:8192
	v_cvt_pk_bf16_f32 v58, v36, v37
	v_mfma_f32_16x16x32_bf16 v[160:163], a[72:75], v[48:51], v[160:163]
	v_exp_f32 v38, v38
	v_mfma_f32_16x16x32_bf16 v[160:163], a[104:107], v[52:55], v[160:163]
	ds_read_b64_tr_b16 a[122:123], v7 offset:12288
	ds_read_b64_tr_b16 a[124:125], v8 offset:8192
	v_mfma_f32_16x16x32_bf16 v[176:179], a[108:111], v[52:55], v[176:179]
	v_exp_f32 v39, v39
	v_mfma_f32_16x16x32_bf16 v[176:179], a[76:79], v[48:51], v[176:179]
	ds_read_b64_tr_b16 a[126:127], v8 offset:12288
	v_cvt_pk_bf16_f32 v59, v38, v39
	v_mfma_f32_16x16x32_bf16 v[32:35], a[0:3], a[224:227], -4.0
	v_exp_f32 v40, v40
	v_mfma_f32_16x16x32_bf16 v[32:35], a[4:7], a[228:231], v[32:35]
	ds_read_b64_tr_b16 a[92:93], v8 offset:0
	ds_read_b64_tr_b16 a[94:95], v8 offset:4096
	v_mfma_f32_16x16x32_bf16 v[32:35], a[8:11], a[232:235], v[32:35]
	v_exp_f32 v41, v41
	v_mfma_f32_16x16x32_bf16 v[32:35], a[12:15], a[236:239], v[32:35]
	v_cvt_pk_bf16_f32 v60, v40, v41
	v_mfma_f32_16x16x32_bf16 v[36:39], a[28:31], a[236:239], -4.0
	v_exp_f32 v42, v42
	v_mfma_f32_16x16x32_bf16 v[36:39], a[24:27], a[232:235], v[36:39]
	v_mfma_f32_16x16x32_bf16 v[36:39], a[20:23], a[228:231], v[36:39]
	v_exp_f32 v43, v43
	v_mfma_f32_16x16x32_bf16 v[36:39], a[16:19], a[224:227], v[36:39]
	s_waitcnt lgkmcnt(3)
	s_add_u32 m0, s64, 0x0
	v_cvt_pk_bf16_f32 v61, v42, v43
	v_mfma_f32_16x16x32_bf16 v[192:195], a[80:83], v[48:51], v[192:195]
	s_xor_b32 s66, s87, 0x53a00
	v_exp_f32 v44, v44
	v_mfma_f32_16x16x32_bf16 v[192:195], a[112:115], v[52:55], v[192:195]
	buffer_load_dwordx4 v14, s[20:23], s66 offen offset:2048 lds
	v_mfma_f32_16x16x32_bf16 v[208:211], a[116:119], v[52:55], v[208:211]
	v_exp_f32 v45, v45
	v_mfma_f32_16x16x32_bf16 v[208:211], a[84:87], v[48:51], v[208:211]
	v_cvt_pk_bf16_f32 v62, v44, v45
	v_mfma_f32_16x16x32_bf16 v[224:227], a[88:91], v[48:51], v[224:227]
	s_xor_b32 s66, s87, 0x55600
	v_exp_f32 v46, v46
	v_mfma_f32_16x16x32_bf16 v[224:227], a[120:123], v[52:55], v[224:227]
	s_waitcnt lgkmcnt(0)
	buffer_load_dwordx4 v14, s[20:23], s66 offen offset:3072 lds
	v_mfma_f32_16x16x32_bf16 v[240:243], a[124:127], v[52:55], v[240:243]
	s_waitcnt vmcnt(8)
	v_exp_f32 v47, v47
	v_mfma_f32_16x16x32_bf16 v[240:243], a[92:95], v[48:51], v[240:243]
	s_barrier
	v_cvt_pk_bf16_f32 v63, v46, v47
	v_mfma_f32_16x16x32_bf16 v[40:43], a[32:35], a[224:227], -4.0
	s_add_u32 m0, s65, 0x0
	v_exp_f32 v32, v32
	v_mfma_f32_16x16x32_bf16 v[40:43], a[36:39], a[228:231], v[40:43]
	buffer_load_dwordx4 v18, s[8:11], s68 offen lds
	v_mfma_f32_16x16x32_bf16 v[40:43], a[40:43], a[232:235], v[40:43]
	v_exp_f32 v33, v33
	v_mfma_f32_16x16x32_bf16 v[40:43], a[44:47], a[236:239], v[40:43]
	v_cvt_pk_bf16_f32 v48, v32, v33
	v_mfma_f32_16x16x32_bf16 v[44:47], a[60:63], a[236:239], -4.0
	v_exp_f32 v34, v34
	v_mfma_f32_16x16x32_bf16 v[44:47], a[56:59], a[232:235], v[44:47]
	buffer_load_dwordx4 v19, s[8:11], s68 offen offset:1024 lds
	v_mfma_f32_16x16x32_bf16 v[44:47], a[52:55], a[228:231], v[44:47]
	s_add_u32 s68, s68, 0x2000
	v_exp_f32 v35, v35
	v_mfma_f32_16x16x32_bf16 v[44:47], a[48:51], a[224:227], v[44:47]
	s_and_b32 s68, s68, 0x7ffff
	v_cvt_pk_bf16_f32 v49, v34, v35
	v_smfmac_f32_16x16x64_bf16 a[132:135], a[168:171], v[56:63], v31
	v_mfma_f32_16x16x32_bf16 v[132:135], a[64:67], v[56:59], v[132:135]
	s_add_u32 m0, s65, 0x2000
	v_exp_f32 v36, v36
	v_mfma_f32_16x16x32_bf16 v[132:135], a[96:99], v[60:63], v[132:135]
	buffer_load_dwordx4 v18, s[8:11], s68 offen lds
	v_mfma_f32_16x16x32_bf16 v[148:151], a[100:103], v[60:63], v[148:151]
	v_exp_f32 v37, v37
	v_mfma_f32_16x16x32_bf16 v[148:151], a[68:71], v[56:59], v[148:151]
	v_cvt_pk_bf16_f32 v50, v36, v37
	v_mfma_f32_16x16x32_bf16 v[164:167], a[72:75], v[56:59], v[164:167]
	v_exp_f32 v38, v38
	v_mfma_f32_16x16x32_bf16 v[164:167], a[104:107], v[60:63], v[164:167]
	buffer_load_dwordx4 v19, s[8:11], s68 offen offset:1024 lds
	v_mfma_f32_16x16x32_bf16 v[180:183], a[108:111], v[60:63], v[180:183]
	s_add_u32 s68, s68, 0x2000
	v_exp_f32 v39, v39
	v_mfma_f32_16x16x32_bf16 v[180:183], a[76:79], v[56:59], v[180:183]
	s_and_b32 s68, s68, 0x7ffff
	v_cvt_pk_bf16_f32 v51, v38, v39
	v_mfma_f32_16x16x32_bf16 v[32:35], a[0:3], a[240:243], -4.0
	s_add_u32 m0, s65, 0x8000
	v_exp_f32 v40, v40
	v_mfma_f32_16x16x32_bf16 v[32:35], a[4:7], a[244:247], v[32:35]
	buffer_load_dwordx4 v20, s[12:15], s69 offen lds
	v_mfma_f32_16x16x32_bf16 v[32:35], a[8:11], a[248:251], v[32:35]
	v_exp_f32 v41, v41
	v_mfma_f32_16x16x32_bf16 v[32:35], a[12:15], a[252:255], v[32:35]
	ds_read_b128 a[0:3], v9 offset:16384
	v_cvt_pk_bf16_f32 v52, v40, v41
	v_mfma_f32_16x16x32_bf16 v[36:39], a[28:31], a[252:255], -4.0
	v_exp_f32 v42, v42
	v_mfma_f32_16x16x32_bf16 v[36:39], a[24:27], a[248:251], v[36:39]
	buffer_load_dwordx4 v21, s[12:15], s69 offen offset:1024 lds
	v_mfma_f32_16x16x32_bf16 v[36:39], a[20:23], a[244:247], v[36:39]
	v_exp_f32 v43, v43
	v_mfma_f32_16x16x32_bf16 v[36:39], a[16:19], a[240:243], v[36:39]
	ds_read_b128 a[4:7], v10 offset:16384
	v_cvt_pk_bf16_f32 v53, v42, v43
	v_mfma_f32_16x16x32_bf16 v[196:199], a[80:83], v[56:59], v[196:199]
	v_exp_f32 v44, v44
	v_mfma_f32_16x16x32_bf16 v[196:199], a[112:115], v[60:63], v[196:199]
	ds_read_b128 a[8:11], v11 offset:16384
	ds_read_b128 a[12:15], v12 offset:16384
	v_mfma_f32_16x16x32_bf16 v[212:215], a[116:119], v[60:63], v[212:215]
	s_add_u32 s69, s69, 0x2000
	v_exp_f32 v45, v45
	v_mfma_f32_16x16x32_bf16 v[212:215], a[84:87], v[56:59], v[212:215]
	s_and_b32 s69, s69, 0x7ffff
	ds_read_b128 a[28:31], v12 offset:20480
	v_cvt_pk_bf16_f32 v54, v44, v45
	v_mfma_f32_16x16x32_bf16 v[228:231], a[88:91], v[56:59], v[228:231]
	s_add_u32 m0, s65, 0xa000
	v_exp_f32 v46, v46
	v_mfma_f32_16x16x32_bf16 v[228:231], a[120:123], v[60:63], v[228:231]
	buffer_load_dwordx4 v20, s[12:15], s69 offen lds
	v_mfma_f32_16x16x32_bf16 v[244:247], a[124:127], v[60:63], v[244:247]
	v_exp_f32 v47, v47
	v_mfma_f32_16x16x32_bf16 v[244:247], a[92:95], v[56:59], v[244:247]
	ds_read_b128 a[24:27], v11 offset:20480
	v_cvt_pk_bf16_f32 v55, v46, v47
	v_mfma_f32_16x16x32_bf16 v[40:43], a[32:35], a[240:243], -4.0
	s_add_u32 m0, s65, 0xa000
	v_exp_f32 v32, v32
	v_mfma_f32_16x16x32_bf16 v[40:43], a[36:39], a[244:247], v[40:43]
	buffer_load_dwordx4 v21, s[12:15], s69 offen offset:1024 lds
	v_mfma_f32_16x16x32_bf16 v[40:43], a[40:43], a[248:251], v[40:43]
	s_add_u32 s69, s69, 0x2000
	v_exp_f32 v33, v33
	v_mfma_f32_16x16x32_bf16 v[40:43], a[44:47], a[252:255], v[40:43]
	s_and_b32 s69, s69, 0x7ffff
	ds_read_b128 a[20:23], v10 offset:20480
	v_cvt_pk_bf16_f32 v56, v32, v33
	v_mfma_f32_16x16x32_bf16 v[44:47], a[60:63], a[252:255], -4.0
	s_add_u32 m0, s64, 0x1000
	s_xor_b32 s66, s87, 0x58200
	v_exp_f32 v34, v34
	v_mfma_f32_16x16x32_bf16 v[44:47], a[56:59], a[248:251], v[44:47]
	buffer_load_dwordx4 v14, s[20:23], s66 offen offset:0 lds
	v_mfma_f32_16x16x32_bf16 v[44:47], a[52:55], a[244:247], v[44:47]
	v_exp_f32 v35, v35
	v_mfma_f32_16x16x32_bf16 v[44:47], a[48:51], a[240:243], v[44:47]
	ds_read_b128 a[16:19], v9 offset:20480
	v_cvt_pk_bf16_f32 v57, v34, v35
	v_smfmac_f32_16x16x64_bf16 a[136:139], a[128:131], v[48:55], v31
	v_mfma_f32_16x16x32_bf16 v[136:139], a[64:67], v[48:51], v[136:139]
	v_exp_f32 v36, v36
	v_mfma_f32_16x16x32_bf16 v[136:139], a[96:99], v[52:55], v[136:139]
	ds_read_b128 a[32:35], v9 offset:24576
	ds_read_b128 a[36:39], v10 offset:24576
	v_mfma_f32_16x16x32_bf16 v[152:155], a[100:103], v[52:55], v[152:155]
	v_exp_f32 v37, v37
	v_mfma_f32_16x16x32_bf16 v[152:155], a[68:71], v[48:51], v[152:155]
	ds_read_b128 a[40:43], v11 offset:24576
	v_cvt_pk_bf16_f32 v58, v36, v37
	v_mfma_f32_16x16x32_bf16 v[168:171], a[72:75], v[48:51], v[168:171]
	s_xor_b32 s66, s87, 0x59e00
	v_exp_f32 v38, v38
	v_mfma_f32_16x16x32_bf16 v[168:171], a[104:107], v[52:55], v[168:171]
	buffer_load_dwordx4 v14, s[20:23], s66 offen offset:1024 lds
	v_mfma_f32_16x16x32_bf16 v[184:187], a[108:111], v[52:55], v[184:187]
	v_exp_f32 v39, v39
	v_mfma_f32_16x16x32_bf16 v[184:187], a[76:79], v[48:51], v[184:187]
	s_waitcnt lgkmcnt(4)
	ds_read_b128 a[44:47], v12 offset:24576
	v_cvt_pk_bf16_f32 v59, v38, v39
	v_mfma_f32_16x16x32_bf16 v[32:35], a[0:3], a[192:195], -4.0
	s_add_u32 m0, s64, 0x1000
	s_xor_b32 s66, s87, 0x5ba00
	v_exp_f32 v40, v40
	v_mfma_f32_16x16x32_bf16 v[32:35], a[4:7], a[196:199], v[32:35]
	buffer_load_dwordx4 v14, s[20:23], s66 offen offset:2048 lds
	v_mfma_f32_16x16x32_bf16 v[32:35], a[8:11], a[200:203], v[32:35]
	v_exp_f32 v41, v41
	v_mfma_f32_16x16x32_bf16 v[32:35], a[12:15], a[204:207], v[32:35]
	ds_read_b128 a[60:63], v12 offset:28672
	v_cvt_pk_bf16_f32 v60, v40, v41
	v_mfma_f32_16x16x32_bf16 v[36:39], a[28:31], a[204:207], -4.0
	s_xor_b32 s66, s87, 0x5d600
	v_exp_f32 v42, v42
	v_mfma_f32_16x16x32_bf16 v[36:39], a[24:27], a[200:203], v[36:39]
	buffer_load_dwordx4 v14, s[20:23], s66 offen offset:3072 lds
	v_mfma_f32_16x16x32_bf16 v[36:39], a[20:23], a[196:199], v[36:39]
	s_waitcnt lgkmcnt(2)
	v_exp_f32 v43, v43
	v_mfma_f32_16x16x32_bf16 v[36:39], a[16:19], a[192:195], v[36:39]
	s_add_u32 m0, s64, 0x4000
	ds_read_b128 a[56:59], v11 offset:28672
	v_cvt_pk_bf16_f32 v61, v42, v43
	v_mfma_f32_16x16x32_bf16 v[200:203], a[80:83], v[48:51], v[200:203]
	s_xor_b32 s66, s87, 0x60200
	v_exp_f32 v44, v44
	v_mfma_f32_16x16x32_bf16 v[200:203], a[112:115], v[52:55], v[200:203]
	buffer_load_dwordx4 v14, s[20:23], s66 offen offset:0 lds
	v_mfma_f32_16x16x32_bf16 v[216:219], a[116:119], v[52:55], v[216:219]
	v_exp_f32 v45, v45
	v_mfma_f32_16x16x32_bf16 v[216:219], a[84:87], v[48:51], v[216:219]
	ds_read_b128 a[52:55], v10 offset:28672
	v_cvt_pk_bf16_f32 v62, v44, v45
	v_mfma_f32_16x16x32_bf16 v[232:235], a[88:91], v[48:51], v[232:235]
	s_xor_b32 s66, s87, 0x61e00
	v_exp_f32 v46, v46
	v_mfma_f32_16x16x32_bf16 v[232:235], a[120:123], v[52:55], v[232:235]
	buffer_load_dwordx4 v14, s[20:23], s66 offen offset:1024 lds
	v_mfma_f32_16x16x32_bf16 v[248:251], a[124:127], v[52:55], v[248:251]
	v_exp_f32 v47, v47
	v_mfma_f32_16x16x32_bf16 v[248:251], a[92:95], v[48:51], v[248:251]
	ds_read_b128 a[48:51], v9 offset:28672
	v_cvt_pk_bf16_f32 v63, v46, v47
	v_mfma_f32_16x16x32_bf16 v[40:43], a[32:35], a[192:195], -4.0
	s_add_u32 m0, s64, 0x4000
	s_xor_b32 s66, s87, 0x63a00
	v_exp_f32 v32, v32
	v_mfma_f32_16x16x32_bf16 v[40:43], a[36:39], a[196:199], v[40:43]
	buffer_load_dwordx4 v14, s[20:23], s66 offen offset:2048 lds
	v_mfma_f32_16x16x32_bf16 v[40:43], a[40:43], a[200:203], v[40:43]
	s_waitcnt lgkmcnt(2)
	v_exp_f32 v33, v33
	v_mfma_f32_16x16x32_bf16 v[40:43], a[44:47], a[204:207], v[40:43]
	v_cvt_pk_bf16_f32 v48, v32, v33
	v_mfma_f32_16x16x32_bf16 v[44:47], a[60:63], a[204:207], -4.0
	s_xor_b32 s66, s87, 0x65600
	v_exp_f32 v34, v34
	v_mfma_f32_16x16x32_bf16 v[44:47], a[56:59], a[200:203], v[44:47]
	s_waitcnt lgkmcnt(1)
	buffer_load_dwordx4 v14, s[20:23], s66 offen offset:3072 lds
	v_mfma_f32_16x16x32_bf16 v[44:47], a[52:55], a[196:199], v[44:47]
	s_waitcnt lgkmcnt(0)
	v_exp_f32 v35, v35
	v_mfma_f32_16x16x32_bf16 v[44:47], a[48:51], a[192:195], v[44:47]
	v_cvt_pk_bf16_f32 v49, v34, v35
	v_smfmac_f32_16x16x64_bf16 a[136:139], a[168:171], v[56:63], v31
	v_mfma_f32_16x16x32_bf16 v[140:143], a[64:67], v[56:59], v[140:143]
	v_exp_f32 v36, v36
	v_mfma_f32_16x16x32_bf16 v[140:143], a[96:99], v[60:63], v[140:143]
	ds_read_b64_tr_b16 a[64:65], v1 offset:16384
	ds_read_b64_tr_b16 a[66:67], v1 offset:20480
	v_mfma_f32_16x16x32_bf16 v[156:159], a[100:103], v[60:63], v[156:159]
	v_exp_f32 v37, v37
	v_mfma_f32_16x16x32_bf16 v[156:159], a[68:71], v[56:59], v[156:159]
	ds_read_b64_tr_b16 a[96:97], v1 offset:24576
	v_cvt_pk_bf16_f32 v50, v36, v37
	v_mfma_f32_16x16x32_bf16 v[172:175], a[72:75], v[56:59], v[172:175]
	v_exp_f32 v38, v38
	v_mfma_f32_16x16x32_bf16 v[172:175], a[104:107], v[60:63], v[172:175]
	ds_read_b64_tr_b16 a[98:99], v1 offset:28672
	ds_read_b64_tr_b16 a[100:101], v2 offset:24576
	v_mfma_f32_16x16x32_bf16 v[188:191], a[108:111], v[60:63], v[188:191]
	v_exp_f32 v39, v39
	v_mfma_f32_16x16x32_bf16 v[188:191], a[76:79], v[56:59], v[188:191]
	ds_read_b64_tr_b16 a[102:103], v2 offset:28672
	v_cvt_pk_bf16_f32 v51, v38, v39
	v_mfma_f32_16x16x32_bf16 v[32:35], a[0:3], a[208:211], -4.0
	v_exp_f32 v40, v40
	v_mfma_f32_16x16x32_bf16 v[32:35], a[4:7], a[212:215], v[32:35]
	ds_read_b64_tr_b16 a[68:69], v2 offset:16384
	ds_read_b64_tr_b16 a[70:71], v2 offset:20480
	v_mfma_f32_16x16x32_bf16 v[32:35], a[8:11], a[216:219], v[32:35]
	v_exp_f32 v41, v41
	v_mfma_f32_16x16x32_bf16 v[32:35], a[12:15], a[220:223], v[32:35]
	ds_read_b64_tr_b16 a[72:73], v3 offset:16384
	v_cvt_pk_bf16_f32 v52, v40, v41
	v_mfma_f32_16x16x32_bf16 v[36:39], a[28:31], a[220:223], -4.0
	v_exp_f32 v42, v42
	v_mfma_f32_16x16x32_bf16 v[36:39], a[24:27], a[216:219], v[36:39]
	ds_read_b64_tr_b16 a[74:75], v3 offset:20480
	ds_read_b64_tr_b16 a[104:105], v3 offset:24576
	v_mfma_f32_16x16x32_bf16 v[36:39], a[20:23], a[212:215], v[36:39]
	v_exp_f32 v43, v43
	v_mfma_f32_16x16x32_bf16 v[36:39], a[16:19], a[208:211], v[36:39]
	ds_read_b64_tr_b16 a[106:107], v3 offset:28672
	v_cvt_pk_bf16_f32 v53, v42, v43
	v_mfma_f32_16x16x32_bf16 v[204:207], a[80:83], v[56:59], v[204:207]
	v_exp_f32 v44, v44
	v_mfma_f32_16x16x32_bf16 v[204:207], a[112:115], v[60:63], v[204:207]
	ds_read_b64_tr_b16 a[108:109], v4 offset:24576
	ds_read_b64_tr_b16 a[110:111], v4 offset:28672
	v_mfma_f32_16x16x32_bf16 v[220:223], a[116:119], v[60:63], v[220:223]
	v_exp_f32 v45, v45
	v_mfma_f32_16x16x32_bf16 v[220:223], a[84:87], v[56:59], v[220:223]
	ds_read_b64_tr_b16 a[76:77], v4 offset:16384
	v_cvt_pk_bf16_f32 v54, v44, v45
	v_mfma_f32_16x16x32_bf16 v[236:239], a[88:91], v[56:59], v[236:239]
	v_exp_f32 v46, v46
	v_mfma_f32_16x16x32_bf16 v[236:239], a[120:123], v[60:63], v[236:239]
	ds_read_b64_tr_b16 a[78:79], v4 offset:20480
	ds_read_b64_tr_b16 a[80:81], v5 offset:16384
	v_mfma_f32_16x16x32_bf16 v[252:255], a[124:127], v[60:63], v[252:255]
	v_exp_f32 v47, v47
	v_mfma_f32_16x16x32_bf16 v[252:255], a[92:95], v[56:59], v[252:255]
	ds_read_b64_tr_b16 a[82:83], v5 offset:20480
	v_cvt_pk_bf16_f32 v55, v46, v47
	v_mfma_f32_16x16x32_bf16 v[40:43], a[32:35], a[208:211], -4.0
	v_exp_f32 v32, v32
	v_mfma_f32_16x16x32_bf16 v[40:43], a[36:39], a[212:215], v[40:43]
	ds_read_b64_tr_b16 a[112:113], v5 offset:24576
	ds_read_b64_tr_b16 a[114:115], v5 offset:28672
	v_mfma_f32_16x16x32_bf16 v[40:43], a[40:43], a[216:219], v[40:43]
	v_exp_f32 v33, v33
	v_mfma_f32_16x16x32_bf16 v[40:43], a[44:47], a[220:223], v[40:43]
	ds_read_b64_tr_b16 a[116:117], v6 offset:24576
	v_cvt_pk_bf16_f32 v56, v32, v33
	v_mfma_f32_16x16x32_bf16 v[44:47], a[60:63], a[220:223], -4.0
	v_exp_f32 v34, v34
	v_mfma_f32_16x16x32_bf16 v[44:47], a[56:59], a[216:219], v[44:47]
	ds_read_b64_tr_b16 a[118:119], v6 offset:28672
	ds_read_b64_tr_b16 a[84:85], v6 offset:16384
	v_mfma_f32_16x16x32_bf16 v[44:47], a[52:55], a[212:215], v[44:47]
	v_exp_f32 v35, v35
	v_mfma_f32_16x16x32_bf16 v[44:47], a[48:51], a[208:211], v[44:47]
	ds_read_b64_tr_b16 a[86:87], v6 offset:20480
	v_cvt_pk_bf16_f32 v57, v34, v35
	v_smfmac_f32_16x16x64_bf16 a[132:135], a[128:131], v[48:55], v31
	s_waitcnt lgkmcnt(7)
	v_mfma_f32_16x16x32_bf16 v[128:131], a[64:67], v[48:51], v[128:131]
	v_exp_f32 v36, v36
	v_mfma_f32_16x16x32_bf16 v[128:131], a[96:99], v[52:55], v[128:131]
	ds_read_b64_tr_b16 a[88:89], v7 offset:16384
	ds_read_b64_tr_b16 a[90:91], v7 offset:20480
	v_mfma_f32_16x16x32_bf16 v[144:147], a[100:103], v[52:55], v[144:147]
	v_exp_f32 v37, v37
	v_mfma_f32_16x16x32_bf16 v[144:147], a[68:71], v[48:51], v[144:147]
	ds_read_b64_tr_b16 a[120:121], v7 offset:24576
	v_cvt_pk_bf16_f32 v58, v36, v37
	v_mfma_f32_16x16x32_bf16 v[160:163], a[72:75], v[48:51], v[160:163]
	v_exp_f32 v38, v38
	v_mfma_f32_16x16x32_bf16 v[160:163], a[104:107], v[52:55], v[160:163]
	ds_read_b64_tr_b16 a[122:123], v7 offset:28672
	ds_read_b64_tr_b16 a[124:125], v8 offset:24576
	v_mfma_f32_16x16x32_bf16 v[176:179], a[108:111], v[52:55], v[176:179]
	v_exp_f32 v39, v39
	v_mfma_f32_16x16x32_bf16 v[176:179], a[76:79], v[48:51], v[176:179]
	ds_read_b64_tr_b16 a[126:127], v8 offset:28672
	v_cvt_pk_bf16_f32 v59, v38, v39
	v_mfma_f32_16x16x32_bf16 v[32:35], a[0:3], a[224:227], -4.0
	v_exp_f32 v40, v40
	v_mfma_f32_16x16x32_bf16 v[32:35], a[4:7], a[228:231], v[32:35]
	ds_read_b64_tr_b16 a[92:93], v8 offset:16384
	ds_read_b64_tr_b16 a[94:95], v8 offset:20480
	v_mfma_f32_16x16x32_bf16 v[32:35], a[8:11], a[232:235], v[32:35]
	v_exp_f32 v41, v41
	v_mfma_f32_16x16x32_bf16 v[32:35], a[12:15], a[236:239], v[32:35]
	v_cvt_pk_bf16_f32 v60, v40, v41
	v_mfma_f32_16x16x32_bf16 v[36:39], a[28:31], a[236:239], -4.0
	v_exp_f32 v42, v42
	v_mfma_f32_16x16x32_bf16 v[36:39], a[24:27], a[232:235], v[36:39]
	v_mfma_f32_16x16x32_bf16 v[36:39], a[20:23], a[228:231], v[36:39]
	v_exp_f32 v43, v43
	v_mfma_f32_16x16x32_bf16 v[36:39], a[16:19], a[224:227], v[36:39]
	s_waitcnt lgkmcnt(3)
	s_add_u32 m0, s64, 0x5000
	v_cvt_pk_bf16_f32 v61, v42, v43
	v_mfma_f32_16x16x32_bf16 v[192:195], a[80:83], v[48:51], v[192:195]
	s_xor_b32 s66, s87, 0x68200
	v_exp_f32 v44, v44
	v_mfma_f32_16x16x32_bf16 v[192:195], a[112:115], v[52:55], v[192:195]
	buffer_load_dwordx4 v14, s[20:23], s66 offen offset:0 lds
	v_mfma_f32_16x16x32_bf16 v[208:211], a[116:119], v[52:55], v[208:211]
	v_exp_f32 v45, v45
	v_mfma_f32_16x16x32_bf16 v[208:211], a[84:87], v[48:51], v[208:211]
	v_cvt_pk_bf16_f32 v62, v44, v45
	v_mfma_f32_16x16x32_bf16 v[224:227], a[88:91], v[48:51], v[224:227]
	s_xor_b32 s66, s87, 0x69e00
	v_exp_f32 v46, v46
	v_mfma_f32_16x16x32_bf16 v[224:227], a[120:123], v[52:55], v[224:227]
	s_waitcnt lgkmcnt(0)
	buffer_load_dwordx4 v14, s[20:23], s66 offen offset:1024 lds
	v_mfma_f32_16x16x32_bf16 v[240:243], a[124:127], v[52:55], v[240:243]
	s_waitcnt vmcnt(10)
	v_exp_f32 v47, v47
	v_mfma_f32_16x16x32_bf16 v[240:243], a[92:95], v[48:51], v[240:243]
	s_barrier
	v_cvt_pk_bf16_f32 v63, v46, v47
	v_mfma_f32_16x16x32_bf16 v[40:43], a[32:35], a[224:227], -4.0
	s_add_u32 m0, s65, 0x4000
	v_exp_f32 v32, v32
	v_mfma_f32_16x16x32_bf16 v[40:43], a[36:39], a[228:231], v[40:43]
	buffer_load_dwordx4 v18, s[8:11], s68 offen lds
	v_mfma_f32_16x16x32_bf16 v[40:43], a[40:43], a[232:235], v[40:43]
	v_exp_f32 v33, v33
	v_mfma_f32_16x16x32_bf16 v[40:43], a[44:47], a[236:239], v[40:43]
	ds_read_b64_tr_b16 a[148:149], v26 offset:0
	v_cvt_pk_bf16_f32 v48, v32, v33
	v_mfma_f32_16x16x32_bf16 v[44:47], a[60:63], a[236:239], -4.0
	v_exp_f32 v34, v34
	v_mfma_f32_16x16x32_bf16 v[44:47], a[56:59], a[232:235], v[44:47]
	buffer_load_dwordx4 v19, s[8:11], s68 offen offset:1024 lds
	v_mfma_f32_16x16x32_bf16 v[44:47], a[52:55], a[228:231], v[44:47]
	s_add_u32 s68, s68, 0x2000
	v_exp_f32 v35, v35
	v_mfma_f32_16x16x32_bf16 v[44:47], a[48:51], a[224:227], v[44:47]
	s_and_b32 s68, s68, 0x7ffff
	ds_read_b64_tr_b16 a[150:151], v26 offset:2048
	v_cvt_pk_bf16_f32 v49, v34, v35
	v_smfmac_f32_16x16x64_bf16 a[132:135], a[168:171], v[56:63], v31
	v_mfma_f32_16x16x32_bf16 v[132:135], a[64:67], v[56:59], v[132:135]
	s_add_u32 m0, s65, 0x6000
	v_exp_f32 v36, v36
	v_mfma_f32_16x16x32_bf16 v[132:135], a[96:99], v[60:63], v[132:135]
	buffer_load_dwordx4 v18, s[8:11], s68 offen lds
	v_mfma_f32_16x16x32_bf16 v[148:151], a[100:103], v[60:63], v[148:151]
	v_exp_f32 v37, v37
	v_mfma_f32_16x16x32_bf16 v[148:151], a[68:71], v[56:59], v[148:151]
	s_waitcnt vmcnt(9)
	ds_read_b64_tr_b16 a[152:153], v26 offset:4096
	v_cvt_pk_bf16_f32 v50, v36, v37
	v_mfma_f32_16x16x32_bf16 v[164:167], a[72:75], v[56:59], v[164:167]
	v_exp_f32 v38, v38
	v_mfma_f32_16x16x32_bf16 v[164:167], a[104:107], v[60:63], v[164:167]
	buffer_load_dwordx4 v19, s[8:11], s68 offen offset:1024 lds
	v_mfma_f32_16x16x32_bf16 v[180:183], a[108:111], v[60:63], v[180:183]
	s_add_u32 s68, s68, 0x2000
	v_exp_f32 v39, v39
	v_mfma_f32_16x16x32_bf16 v[180:183], a[76:79], v[56:59], v[180:183]
	s_and_b32 s68, s68, 0x7ffff
	ds_read_b64_tr_b16 a[154:155], v26 offset:6144
	v_cvt_pk_bf16_f32 v51, v38, v39
	v_mfma_f32_16x16x32_bf16 v[32:35], a[0:3], a[240:243], -4.0
	s_add_u32 m0, s65, 0xc000
	v_exp_f32 v40, v40
	v_mfma_f32_16x16x32_bf16 v[32:35], a[4:7], a[244:247], v[32:35]
	buffer_load_dwordx4 v20, s[12:15], s69 offen lds
	v_mfma_f32_16x16x32_bf16 v[32:35], a[8:11], a[248:251], v[32:35]
	v_exp_f32 v41, v41
	v_mfma_f32_16x16x32_bf16 v[32:35], a[12:15], a[252:255], v[32:35]
	ds_read_b128 a[0:3], v9 offset:0
	v_cvt_pk_bf16_f32 v52, v40, v41
	v_mfma_f32_16x16x32_bf16 v[36:39], a[28:31], a[252:255], -4.0
	v_exp_f32 v42, v42
	v_mfma_f32_16x16x32_bf16 v[36:39], a[24:27], a[248:251], v[36:39]
	buffer_load_dwordx4 v21, s[12:15], s69 offen offset:1024 lds
	v_mfma_f32_16x16x32_bf16 v[36:39], a[20:23], a[244:247], v[36:39]
	v_exp_f32 v43, v43
	v_mfma_f32_16x16x32_bf16 v[36:39], a[16:19], a[240:243], v[36:39]
	ds_read_b128 a[4:7], v10 offset:0
	v_cvt_pk_bf16_f32 v53, v42, v43
	v_mfma_f32_16x16x32_bf16 v[196:199], a[80:83], v[56:59], v[196:199]
	v_exp_f32 v44, v44
	v_mfma_f32_16x16x32_bf16 v[196:199], a[112:115], v[60:63], v[196:199]
	ds_read_b128 a[8:11], v11 offset:0
	ds_read_b128 a[12:15], v12 offset:0
	v_mfma_f32_16x16x32_bf16 v[212:215], a[116:119], v[60:63], v[212:215]
	s_add_u32 s69, s69, 0x2000
	v_exp_f32 v45, v45
	v_mfma_f32_16x16x32_bf16 v[212:215], a[84:87], v[56:59], v[212:215]
	s_and_b32 s69, s69, 0x7ffff
	ds_read_b128 a[28:31], v12 offset:4096
	v_cvt_pk_bf16_f32 v54, v44, v45
	v_mfma_f32_16x16x32_bf16 v[228:231], a[88:91], v[56:59], v[228:231]
	s_add_u32 m0, s65, 0xe000
	v_exp_f32 v46, v46
	v_mfma_f32_16x16x32_bf16 v[228:231], a[120:123], v[60:63], v[228:231]
	buffer_load_dwordx4 v20, s[12:15], s69 offen lds
	v_mfma_f32_16x16x32_bf16 v[244:247], a[124:127], v[60:63], v[244:247]
	v_exp_f32 v47, v47
	v_mfma_f32_16x16x32_bf16 v[244:247], a[92:95], v[56:59], v[244:247]
	ds_read_b128 a[24:27], v11 offset:4096
	v_cvt_pk_bf16_f32 v55, v46, v47
	v_mfma_f32_16x16x32_bf16 v[40:43], a[32:35], a[240:243], -4.0
	s_add_u32 m0, s65, 0xe000
	v_exp_f32 v32, v32
	v_mfma_f32_16x16x32_bf16 v[40:43], a[36:39], a[244:247], v[40:43]
	buffer_load_dwordx4 v21, s[12:15], s69 offen offset:1024 lds
	v_mfma_f32_16x16x32_bf16 v[40:43], a[40:43], a[248:251], v[40:43]
	s_add_u32 s69, s69, 0x2000
	v_exp_f32 v33, v33
	v_mfma_f32_16x16x32_bf16 v[40:43], a[44:47], a[252:255], v[40:43]
	s_and_b32 s69, s69, 0x7ffff
	ds_read_b128 a[20:23], v10 offset:4096
	v_cvt_pk_bf16_f32 v56, v32, v33
	v_mfma_f32_16x16x32_bf16 v[44:47], a[60:63], a[252:255], -4.0
	s_add_u32 m0, s64, 0x5000
	s_xor_b32 s66, s87, 0x6ba00
	v_exp_f32 v34, v34
	v_mfma_f32_16x16x32_bf16 v[44:47], a[56:59], a[248:251], v[44:47]
L_pg21:
	s_cbranch_execz L_pg25
	buffer_load_dwordx4 v14, s[20:23], s66 offen offset:2048 lds
	v_mfma_f32_16x16x32_bf16 v[44:47], a[52:55], a[244:247], v[44:47]
	v_exp_f32 v35, v35
	v_mfma_f32_16x16x32_bf16 v[44:47], a[48:51], a[240:243], v[44:47]
	ds_read_b128 a[16:19], v9 offset:4096
	v_cvt_pk_bf16_f32 v57, v34, v35
	v_smfmac_f32_16x16x64_bf16 a[136:139], a[128:131], v[48:55], v31
	v_mfma_f32_16x16x32_bf16 v[136:139], a[64:67], v[48:51], v[136:139]
	v_exp_f32 v36, v36
	v_mfma_f32_16x16x32_bf16 v[136:139], a[96:99], v[52:55], v[136:139]
	ds_read_b128 a[32:35], v9 offset:8192
	ds_read_b128 a[36:39], v10 offset:8192
	v_mfma_f32_16x16x32_bf16 v[152:155], a[100:103], v[52:55], v[152:155]
	v_exp_f32 v37, v37
	v_mfma_f32_16x16x32_bf16 v[152:155], a[68:71], v[48:51], v[152:155]
	ds_read_b128 a[40:43], v11 offset:8192
	v_cvt_pk_bf16_f32 v58, v36, v37
	v_mfma_f32_16x16x32_bf16 v[168:171], a[72:75], v[48:51], v[168:171]
	s_xor_b32 s66, s87, 0x6d600
	v_exp_f32 v38, v38
	v_mfma_f32_16x16x32_bf16 v[168:171], a[104:107], v[52:55], v[168:171]
	buffer_load_dwordx4 v14, s[20:23], s66 offen offset:3072 lds
	v_mfma_f32_16x16x32_bf16 v[184:187], a[108:111], v[52:55], v[184:187]
	v_exp_f32 v39, v39
	v_mfma_f32_16x16x32_bf16 v[184:187], a[76:79], v[48:51], v[184:187]
	s_waitcnt lgkmcnt(4)
	ds_read_b128 a[44:47], v12 offset:8192
	v_cvt_pk_bf16_f32 v59, v38, v39
	v_mfma_f32_16x16x32_bf16 v[32:35], a[0:3], a[192:195], -4.0
	v_exp_f32 v40, v40
	v_mfma_f32_16x16x32_bf16 v[32:35], a[4:7], a[196:199], v[32:35]
	buffer_load_dword v25, v24, s[48:51], 0 offen sc1
	v_mfma_f32_16x16x32_bf16 v[32:35], a[8:11], a[200:203], v[32:35]
	v_exp_f32 v41, v41
	v_mfma_f32_16x16x32_bf16 v[32:35], a[12:15], a[204:207], v[32:35]
	s_add_u32 m0, s64, 0x2000
	ds_read_b128 a[60:63], v12 offset:12288
	v_cvt_pk_bf16_f32 v60, v40, v41
	v_mfma_f32_16x16x32_bf16 v[36:39], a[28:31], a[204:207], -4.0
	s_xor_b32 s66, s87, 0x70200
	v_exp_f32 v42, v42
	v_mfma_f32_16x16x32_bf16 v[36:39], a[24:27], a[200:203], v[36:39]
	buffer_load_dwordx4 v14, s[20:23], s66 offen offset:0 lds
	v_mfma_f32_16x16x32_bf16 v[36:39], a[20:23], a[196:199], v[36:39]
	s_waitcnt lgkmcnt(2)
	v_exp_f32 v43, v43
	v_mfma_f32_16x16x32_bf16 v[36:39], a[16:19], a[192:195], v[36:39]
	ds_read_b128 a[56:59], v11 offset:12288
	v_cvt_pk_bf16_f32 v61, v42, v43
	v_mfma_f32_16x16x32_bf16 v[200:203], a[80:83], v[48:51], v[200:203]
	s_xor_b32 s66, s87, 0x71e00
	v_exp_f32 v44, v44
	v_mfma_f32_16x16x32_bf16 v[200:203], a[112:115], v[52:55], v[200:203]
	buffer_load_dwordx4 v14, s[20:23], s66 offen offset:1024 lds
	v_mfma_f32_16x16x32_bf16 v[216:219], a[116:119], v[52:55], v[216:219]
	v_exp_f32 v45, v45
	v_mfma_f32_16x16x32_bf16 v[216:219], a[84:87], v[48:51], v[216:219]
	ds_read_b128 a[52:55], v10 offset:12288
	v_cvt_pk_bf16_f32 v62, v44, v45
	v_mfma_f32_16x16x32_bf16 v[232:235], a[88:91], v[48:51], v[232:235]
	s_xor_b32 s66, s87, 0x73a00
	v_exp_f32 v46, v46
	v_mfma_f32_16x16x32_bf16 v[232:235], a[120:123], v[52:55], v[232:235]
	buffer_load_dwordx4 v14, s[20:23], s66 offen offset:2048 lds
	v_mfma_f32_16x16x32_bf16 v[248:251], a[124:127], v[52:55], v[248:251]
	v_exp_f32 v47, v47
	v_mfma_f32_16x16x32_bf16 v[248:251], a[92:95], v[48:51], v[248:251]
	ds_read_b128 a[48:51], v9 offset:12288
	v_cvt_pk_bf16_f32 v63, v46, v47
	v_mfma_f32_16x16x32_bf16 v[40:43], a[32:35], a[192:195], -4.0
	s_add_u32 m0, s64, 0x2000
	s_xor_b32 s66, s87, 0x75600
	v_exp_f32 v32, v32
	v_mfma_f32_16x16x32_bf16 v[40:43], a[36:39], a[196:199], v[40:43]
	buffer_load_dwordx4 v14, s[20:23], s66 offen offset:3072 lds
	v_mfma_f32_16x16x32_bf16 v[40:43], a[40:43], a[200:203], v[40:43]
	s_waitcnt lgkmcnt(2)
	v_exp_f32 v33, v33
	v_mfma_f32_16x16x32_bf16 v[40:43], a[44:47], a[204:207], v[40:43]
	s_add_u32 m0, s64, 0x3000
	ds_read_b64_tr_b16 a[156:157], v27 offset:0
	v_cvt_pk_bf16_f32 v48, v32, v33
	v_mfma_f32_16x16x32_bf16 v[44:47], a[60:63], a[204:207], -4.0
	s_xor_b32 s66, s87, 0x78200
	v_exp_f32 v34, v34
	v_mfma_f32_16x16x32_bf16 v[44:47], a[56:59], a[200:203], v[44:47]
	s_waitcnt lgkmcnt(2)
	buffer_load_dwordx4 v14, s[20:23], s66 offen offset:0 lds
	v_mfma_f32_16x16x32_bf16 v[44:47], a[52:55], a[196:199], v[44:47]
	s_waitcnt lgkmcnt(1)
	v_exp_f32 v35, v35
	v_mfma_f32_16x16x32_bf16 v[44:47], a[48:51], a[192:195], v[44:47]
	ds_read_b64_tr_b16 a[158:159], v27 offset:2048
	v_cvt_pk_bf16_f32 v49, v34, v35
	v_smfmac_f32_16x16x64_bf16 a[136:139], a[168:171], v[56:63], v31
	v_mfma_f32_16x16x32_bf16 v[140:143], a[64:67], v[56:59], v[140:143]
	v_exp_f32 v36, v36
	v_mfma_f32_16x16x32_bf16 v[140:143], a[96:99], v[60:63], v[140:143]
	ds_read_b64_tr_b16 a[64:65], v1 offset:0
	ds_read_b64_tr_b16 a[66:67], v1 offset:4096
	v_mfma_f32_16x16x32_bf16 v[156:159], a[100:103], v[60:63], v[156:159]
	v_exp_f32 v37, v37
	v_mfma_f32_16x16x32_bf16 v[156:159], a[68:71], v[56:59], v[156:159]
	ds_read_b64_tr_b16 a[96:97], v1 offset:8192
	v_cvt_pk_bf16_f32 v50, v36, v37
	v_mfma_f32_16x16x32_bf16 v[172:175], a[72:75], v[56:59], v[172:175]
	v_exp_f32 v38, v38
	v_mfma_f32_16x16x32_bf16 v[172:175], a[104:107], v[60:63], v[172:175]
	ds_read_b64_tr_b16 a[98:99], v1 offset:12288
	ds_read_b64_tr_b16 a[100:101], v2 offset:8192
	v_mfma_f32_16x16x32_bf16 v[188:191], a[108:111], v[60:63], v[188:191]
	v_exp_f32 v39, v39
	v_mfma_f32_16x16x32_bf16 v[188:191], a[76:79], v[56:59], v[188:191]
	ds_read_b64_tr_b16 a[102:103], v2 offset:12288
	v_cvt_pk_bf16_f32 v51, v38, v39
	v_mfma_f32_16x16x32_bf16 v[32:35], a[0:3], a[208:211], -4.0
	v_exp_f32 v40, v40
	v_mfma_f32_16x16x32_bf16 v[32:35], a[4:7], a[212:215], v[32:35]
	ds_read_b64_tr_b16 a[68:69], v2 offset:0
	ds_read_b64_tr_b16 a[70:71], v2 offset:4096
	v_mfma_f32_16x16x32_bf16 v[32:35], a[8:11], a[216:219], v[32:35]
	v_exp_f32 v41, v41
	v_mfma_f32_16x16x32_bf16 v[32:35], a[12:15], a[220:223], v[32:35]
	ds_read_b64_tr_b16 a[72:73], v3 offset:0
	v_cvt_pk_bf16_f32 v52, v40, v41
	v_mfma_f32_16x16x32_bf16 v[36:39], a[28:31], a[220:223], -4.0
	v_exp_f32 v42, v42
	v_mfma_f32_16x16x32_bf16 v[36:39], a[24:27], a[216:219], v[36:39]
	ds_read_b64_tr_b16 a[74:75], v3 offset:4096
	ds_read_b64_tr_b16 a[104:105], v3 offset:8192
	v_mfma_f32_16x16x32_bf16 v[36:39], a[20:23], a[212:215], v[36:39]
	v_exp_f32 v43, v43
	v_mfma_f32_16x16x32_bf16 v[36:39], a[16:19], a[208:211], v[36:39]
	ds_read_b64_tr_b16 a[106:107], v3 offset:12288
	v_cvt_pk_bf16_f32 v53, v42, v43
	v_mfma_f32_16x16x32_bf16 v[204:207], a[80:83], v[56:59], v[204:207]
	v_exp_f32 v44, v44
	v_mfma_f32_16x16x32_bf16 v[204:207], a[112:115], v[60:63], v[204:207]
	ds_read_b64_tr_b16 a[108:109], v4 offset:8192
	ds_read_b64_tr_b16 a[110:111], v4 offset:12288
	v_mfma_f32_16x16x32_bf16 v[220:223], a[116:119], v[60:63], v[220:223]
	v_exp_f32 v45, v45
	v_mfma_f32_16x16x32_bf16 v[220:223], a[84:87], v[56:59], v[220:223]
	ds_read_b64_tr_b16 a[76:77], v4 offset:0
	v_cvt_pk_bf16_f32 v54, v44, v45
	v_mfma_f32_16x16x32_bf16 v[236:239], a[88:91], v[56:59], v[236:239]
	v_exp_f32 v46, v46
	v_mfma_f32_16x16x32_bf16 v[236:239], a[120:123], v[60:63], v[236:239]
	ds_read_b64_tr_b16 a[78:79], v4 offset:4096
	ds_read_b64_tr_b16 a[80:81], v5 offset:0
	v_mfma_f32_16x16x32_bf16 v[252:255], a[124:127], v[60:63], v[252:255]
	v_exp_f32 v47, v47
	v_mfma_f32_16x16x32_bf16 v[252:255], a[92:95], v[56:59], v[252:255]
	ds_read_b64_tr_b16 a[82:83], v5 offset:4096
	v_cvt_pk_bf16_f32 v55, v46, v47
	v_mfma_f32_16x16x32_bf16 v[40:43], a[32:35], a[208:211], -4.0
	v_exp_f32 v32, v32
	v_mfma_f32_16x16x32_bf16 v[40:43], a[36:39], a[212:215], v[40:43]
	ds_read_b64_tr_b16 a[112:113], v5 offset:8192
	ds_read_b64_tr_b16 a[114:115], v5 offset:12288
	v_mfma_f32_16x16x32_bf16 v[40:43], a[40:43], a[216:219], v[40:43]
	v_exp_f32 v33, v33
	v_mfma_f32_16x16x32_bf16 v[40:43], a[44:47], a[220:223], v[40:43]
	ds_read_b64_tr_b16 a[116:117], v6 offset:8192
	v_cvt_pk_bf16_f32 v56, v32, v33
	v_mfma_f32_16x16x32_bf16 v[44:47], a[60:63], a[220:223], -4.0
	v_exp_f32 v34, v34
	v_mfma_f32_16x16x32_bf16 v[44:47], a[56:59], a[216:219], v[44:47]
	ds_read_b64_tr_b16 a[118:119], v6 offset:12288
	ds_read_b64_tr_b16 a[84:85], v6 offset:0
	v_mfma_f32_16x16x32_bf16 v[44:47], a[52:55], a[212:215], v[44:47]
	v_exp_f32 v35, v35
	v_mfma_f32_16x16x32_bf16 v[44:47], a[48:51], a[208:211], v[44:47]
	ds_read_b64_tr_b16 a[86:87], v6 offset:4096
	v_cvt_pk_bf16_f32 v57, v34, v35
	v_smfmac_f32_16x16x64_bf16 a[132:135], a[128:131], v[48:55], v31
	s_waitcnt lgkmcnt(7)
	v_mfma_f32_16x16x32_bf16 v[128:131], a[64:67], v[48:51], v[128:131]
	v_exp_f32 v36, v36
	v_mfma_f32_16x16x32_bf16 v[128:131], a[96:99], v[52:55], v[128:131]
	ds_read_b64_tr_b16 a[88:89], v7 offset:0
	ds_read_b64_tr_b16 a[90:91], v7 offset:4096
	v_mfma_f32_16x16x32_bf16 v[144:147], a[100:103], v[52:55], v[144:147]
	v_exp_f32 v37, v37
	v_mfma_f32_16x16x32_bf16 v[144:147], a[68:71], v[48:51], v[144:147]
	ds_read_b64_tr_b16 a[120:121], v7 offset:8192
	v_cvt_pk_bf16_f32 v58, v36, v37
	v_mfma_f32_16x16x32_bf16 v[160:163], a[72:75], v[48:51], v[160:163]
	v_exp_f32 v38, v38
	v_mfma_f32_16x16x32_bf16 v[160:163], a[104:107], v[52:55], v[160:163]
	ds_read_b64_tr_b16 a[122:123], v7 offset:12288
	ds_read_b64_tr_b16 a[124:125], v8 offset:8192
	v_mfma_f32_16x16x32_bf16 v[176:179], a[108:111], v[52:55], v[176:179]
	v_exp_f32 v39, v39
	v_mfma_f32_16x16x32_bf16 v[176:179], a[76:79], v[48:51], v[176:179]
	ds_read_b64_tr_b16 a[126:127], v8 offset:12288
	v_cvt_pk_bf16_f32 v59, v38, v39
	v_mfma_f32_16x16x32_bf16 v[32:35], a[0:3], a[224:227], -4.0
	v_exp_f32 v40, v40
	v_mfma_f32_16x16x32_bf16 v[32:35], a[4:7], a[228:231], v[32:35]
	ds_read_b64_tr_b16 a[92:93], v8 offset:0
	ds_read_b64_tr_b16 a[94:95], v8 offset:4096
	v_mfma_f32_16x16x32_bf16 v[32:35], a[8:11], a[232:235], v[32:35]
	v_exp_f32 v41, v41
	v_mfma_f32_16x16x32_bf16 v[32:35], a[12:15], a[236:239], v[32:35]
	ds_read_b64_tr_b16 a[172:173], v27 offset:4096
	v_cvt_pk_bf16_f32 v60, v40, v41
	v_mfma_f32_16x16x32_bf16 v[36:39], a[28:31], a[236:239], -4.0
	v_exp_f32 v42, v42
	v_mfma_f32_16x16x32_bf16 v[36:39], a[24:27], a[232:235], v[36:39]
	ds_read_b64_tr_b16 a[174:175], v27 offset:6144
	ds_read_b64_tr_b16 a[176:177], v28 offset:0
	v_mfma_f32_16x16x32_bf16 v[36:39], a[20:23], a[228:231], v[36:39]
	v_exp_f32 v43, v43
	v_mfma_f32_16x16x32_bf16 v[36:39], a[16:19], a[224:227], v[36:39]
	s_waitcnt lgkmcnt(6)
	s_add_u32 m0, s64, 0x3000
	ds_read_b64_tr_b16 a[178:179], v28 offset:2048
	v_cvt_pk_bf16_f32 v61, v42, v43
	v_mfma_f32_16x16x32_bf16 v[192:195], a[80:83], v[48:51], v[192:195]
	s_xor_b32 s66, s87, 0x79e00
	v_exp_f32 v44, v44
	v_mfma_f32_16x16x32_bf16 v[192:195], a[112:115], v[52:55], v[192:195]
	buffer_load_dwordx4 v14, s[20:23], s66 offen offset:1024 lds
	v_mfma_f32_16x16x32_bf16 v[208:211], a[116:119], v[52:55], v[208:211]
	v_exp_f32 v45, v45
	v_mfma_f32_16x16x32_bf16 v[208:211], a[84:87], v[48:51], v[208:211]
	v_cvt_pk_bf16_f32 v62, v44, v45
	v_mfma_f32_16x16x32_bf16 v[224:227], a[88:91], v[48:51], v[224:227]
	v_exp_f32 v46, v46
	v_mfma_f32_16x16x32_bf16 v[224:227], a[120:123], v[52:55], v[224:227]
	s_waitcnt vmcnt(6)
	v_cmp_ne_u32 vcc, 1, v25
	s_cbranch_vccnz L_spin5
L_back5:
	s_waitcnt lgkmcnt(3)
	v_mfma_f32_16x16x32_bf16 v[240:243], a[124:127], v[52:55], v[240:243]
	s_waitcnt lgkmcnt(0)
	v_exp_f32 v47, v47
	v_mfma_f32_16x16x32_bf16 v[240:243], a[92:95], v[48:51], v[240:243]
	s_barrier
	v_cvt_pk_bf16_f32 v63, v46, v47
	v_mfma_f32_16x16x32_bf16 v[40:43], a[32:35], a[224:227], -4.0
	s_add_u32 m0, s65, 0x0
	v_exp_f32 v32, v32
	v_mfma_f32_16x16x32_bf16 v[40:43], a[36:39], a[228:231], v[40:43]
	buffer_load_dwordx4 v18, s[8:11], s68 offen lds
	v_mfma_f32_16x16x32_bf16 v[40:43], a[40:43], a[232:235], v[40:43]
	v_exp_f32 v33, v33
	v_mfma_f32_16x16x32_bf16 v[40:43], a[44:47], a[236:239], v[40:43]
	ds_read_b64_tr_b16 a[180:181], v28 offset:4096
	v_cvt_pk_bf16_f32 v48, v32, v33
	v_mfma_f32_16x16x32_bf16 v[44:47], a[60:63], a[236:239], -4.0
	v_exp_f32 v34, v34
	v_mfma_f32_16x16x32_bf16 v[44:47], a[56:59], a[232:235], v[44:47]
	buffer_load_dwordx4 v19, s[8:11], s68 offen offset:1024 lds
	v_mfma_f32_16x16x32_bf16 v[44:47], a[52:55], a[228:231], v[44:47]
	s_add_u32 s68, s68, 0x2000
	v_exp_f32 v35, v35
	v_mfma_f32_16x16x32_bf16 v[44:47], a[48:51], a[224:227], v[44:47]
	s_and_b32 s68, s68, 0x7ffff
	ds_read_b64_tr_b16 a[182:183], v28 offset:6144
	v_cvt_pk_bf16_f32 v49, v34, v35
	v_smfmac_f32_16x16x64_bf16 a[132:135], a[168:171], v[56:63], v31
	v_mfma_f32_16x16x32_bf16 v[132:135], a[64:67], v[56:59], v[132:135]
	s_add_u32 m0, s65, 0x2000
	v_exp_f32 v36, v36
	v_mfma_f32_16x16x32_bf16 v[132:135], a[96:99], v[60:63], v[132:135]
	buffer_load_dwordx4 v18, s[8:11], s68 offen lds
	v_mfma_f32_16x16x32_bf16 v[148:151], a[100:103], v[60:63], v[148:151]
	v_exp_f32 v37, v37
	v_mfma_f32_16x16x32_bf16 v[148:151], a[68:71], v[56:59], v[148:151]
	ds_read_b64_tr_b16 a[184:185], v29 offset:0
	v_cvt_pk_bf16_f32 v50, v36, v37
	v_mfma_f32_16x16x32_bf16 v[164:167], a[72:75], v[56:59], v[164:167]
	v_exp_f32 v38, v38
	v_mfma_f32_16x16x32_bf16 v[164:167], a[104:107], v[60:63], v[164:167]
	buffer_load_dwordx4 v19, s[8:11], s68 offen offset:1024 lds
	v_mfma_f32_16x16x32_bf16 v[180:183], a[108:111], v[60:63], v[180:183]
	s_add_u32 s68, s68, 0x2000
	v_exp_f32 v39, v39
	v_mfma_f32_16x16x32_bf16 v[180:183], a[76:79], v[56:59], v[180:183]
	s_and_b32 s68, s68, 0x7ffff
	ds_read_b64_tr_b16 a[186:187], v29 offset:2048
	v_cvt_pk_bf16_f32 v51, v38, v39
	v_mfma_f32_16x16x32_bf16 v[32:35], a[0:3], a[240:243], -4.0
	s_add_u32 m0, s65, 0x8000
	v_exp_f32 v40, v40
	v_mfma_f32_16x16x32_bf16 v[32:35], a[4:7], a[244:247], v[32:35]
	buffer_load_dwordx4 v20, s[12:15], s69 offen lds
	v_mfma_f32_16x16x32_bf16 v[32:35], a[8:11], a[248:251], v[32:35]
	v_exp_f32 v41, v41
	v_mfma_f32_16x16x32_bf16 v[32:35], a[12:15], a[252:255], v[32:35]
	ds_read_b128 a[0:3], v9 offset:16384
	v_cvt_pk_bf16_f32 v52, v40, v41
	v_mfma_f32_16x16x32_bf16 v[36:39], a[28:31], a[252:255], -4.0
	v_exp_f32 v42, v42
	v_mfma_f32_16x16x32_bf16 v[36:39], a[24:27], a[248:251], v[36:39]
	buffer_load_dwordx4 v21, s[12:15], s69 offen offset:1024 lds
	v_mfma_f32_16x16x32_bf16 v[36:39], a[20:23], a[244:247], v[36:39]
	v_exp_f32 v43, v43
	v_mfma_f32_16x16x32_bf16 v[36:39], a[16:19], a[240:243], v[36:39]
	ds_read_b128 a[4:7], v10 offset:16384
	v_cvt_pk_bf16_f32 v53, v42, v43
	v_mfma_f32_16x16x32_bf16 v[196:199], a[80:83], v[56:59], v[196:199]
	v_exp_f32 v44, v44
	v_mfma_f32_16x16x32_bf16 v[196:199], a[112:115], v[60:63], v[196:199]
	ds_read_b128 a[8:11], v11 offset:16384
	ds_read_b128 a[12:15], v12 offset:16384
	v_mfma_f32_16x16x32_bf16 v[212:215], a[116:119], v[60:63], v[212:215]
	s_add_u32 s69, s69, 0x2000
	v_exp_f32 v45, v45
	v_mfma_f32_16x16x32_bf16 v[212:215], a[84:87], v[56:59], v[212:215]
	s_and_b32 s69, s69, 0x7ffff
	ds_read_b128 a[28:31], v12 offset:20480
	v_cvt_pk_bf16_f32 v54, v44, v45
	v_mfma_f32_16x16x32_bf16 v[228:231], a[88:91], v[56:59], v[228:231]
	s_add_u32 m0, s65, 0xa000
	v_exp_f32 v46, v46
	v_mfma_f32_16x16x32_bf16 v[228:231], a[120:123], v[60:63], v[228:231]
	buffer_load_dwordx4 v20, s[12:15], s69 offen lds
	v_mfma_f32_16x16x32_bf16 v[244:247], a[124:127], v[60:63], v[244:247]
	v_exp_f32 v47, v47
	v_mfma_f32_16x16x32_bf16 v[244:247], a[92:95], v[56:59], v[244:247]
	ds_read_b128 a[24:27], v11 offset:20480
	v_cvt_pk_bf16_f32 v55, v46, v47
	v_mfma_f32_16x16x32_bf16 v[40:43], a[32:35], a[240:243], -4.0
	s_add_u32 m0, s65, 0xa000
	v_exp_f32 v32, v32
	v_mfma_f32_16x16x32_bf16 v[40:43], a[36:39], a[244:247], v[40:43]
	buffer_load_dwordx4 v21, s[12:15], s69 offen offset:1024 lds
	v_mfma_f32_16x16x32_bf16 v[40:43], a[40:43], a[248:251], v[40:43]
	s_add_u32 s69, s69, 0x2000
	v_exp_f32 v33, v33
	v_mfma_f32_16x16x32_bf16 v[40:43], a[44:47], a[252:255], v[40:43]
	s_and_b32 s69, s69, 0x7ffff
	ds_read_b128 a[20:23], v10 offset:20480
	v_cvt_pk_bf16_f32 v56, v32, v33
	v_mfma_f32_16x16x32_bf16 v[44:47], a[60:63], a[252:255], -4.0
	s_add_u32 s71, s89, 0x2000000
	v_exp_f32 v34, v34
	v_mfma_f32_16x16x32_bf16 v[44:47], a[56:59], a[248:251], v[44:47]
	buffer_load_dwordx4 v[64:67], v13, s[48:51], s71 offen offset:0 sc1 nt
	v_mfma_f32_16x16x32_bf16 v[44:47], a[52:55], a[244:247], v[44:47]
	v_exp_f32 v35, v35
	v_mfma_f32_16x16x32_bf16 v[44:47], a[48:51], a[240:243], v[44:47]
	ds_read_b128 a[16:19], v9 offset:20480
	v_cvt_pk_bf16_f32 v57, v34, v35
	v_smfmac_f32_16x16x64_bf16 a[136:139], a[128:131], v[48:55], v31
	v_mfma_f32_16x16x32_bf16 v[136:139], a[64:67], v[48:51], v[136:139]
	v_exp_f32 v36, v36
	v_mfma_f32_16x16x32_bf16 v[136:139], a[96:99], v[52:55], v[136:139]
	ds_read_b128 a[32:35], v9 offset:24576
	ds_read_b128 a[36:39], v10 offset:24576
	v_mfma_f32_16x16x32_bf16 v[152:155], a[100:103], v[52:55], v[152:155]
	v_exp_f32 v37, v37
	v_mfma_f32_16x16x32_bf16 v[152:155], a[68:71], v[48:51], v[152:155]
	s_add_u32 m0, s64, 0x3000
	ds_read_b128 a[40:43], v11 offset:24576
	v_cvt_pk_bf16_f32 v58, v36, v37
	v_mfma_f32_16x16x32_bf16 v[168:171], a[72:75], v[48:51], v[168:171]
	s_xor_b32 s66, s87, 0x7ba00
	v_exp_f32 v38, v38
	v_mfma_f32_16x16x32_bf16 v[168:171], a[104:107], v[52:55], v[168:171]
	buffer_load_dwordx4 v14, s[20:23], s66 offen offset:2048 lds
	v_mfma_f32_16x16x32_bf16 v[184:187], a[108:111], v[52:55], v[184:187]
	v_exp_f32 v39, v39
	v_mfma_f32_16x16x32_bf16 v[184:187], a[76:79], v[48:51], v[184:187]
	s_waitcnt lgkmcnt(4)
	ds_read_b128 a[44:47], v12 offset:24576
	v_cvt_pk_bf16_f32 v59, v38, v39
	v_mfma_f32_16x16x32_bf16 v[32:35], a[0:3], a[192:195], -4.0
	v_exp_f32 v40, v40
	v_mfma_f32_16x16x32_bf16 v[32:35], a[4:7], a[196:199], v[32:35]
	buffer_load_dwordx4 v[68:71], v13, s[48:51], s71 offen offset:1024 sc1 nt
	v_mfma_f32_16x16x32_bf16 v[32:35], a[8:11], a[200:203], v[32:35]
	v_exp_f32 v41, v41
	v_mfma_f32_16x16x32_bf16 v[32:35], a[12:15], a[204:207], v[32:35]
	ds_read_b128 a[60:63], v12 offset:28672
	v_cvt_pk_bf16_f32 v60, v40, v41
	v_mfma_f32_16x16x32_bf16 v[36:39], a[28:31], a[204:207], -4.0
	v_exp_f32 v42, v42
	v_mfma_f32_16x16x32_bf16 v[36:39], a[24:27], a[200:203], v[36:39]
	buffer_load_dwordx4 v[72:75], v13, s[48:51], s71 offen offset:2048 sc1 nt
	v_mfma_f32_16x16x32_bf16 v[36:39], a[20:23], a[196:199], v[36:39]
	s_waitcnt lgkmcnt(2)
	v_exp_f32 v43, v43
	v_mfma_f32_16x16x32_bf16 v[36:39], a[16:19], a[192:195], v[36:39]
	s_add_u32 m0, s64, 0x3000
	ds_read_b128 a[56:59], v11 offset:28672
	v_cvt_pk_bf16_f32 v61, v42, v43
	v_mfma_f32_16x16x32_bf16 v[200:203], a[80:83], v[48:51], v[200:203]
	s_xor_b32 s66, s87, 0x7d600
	v_exp_f32 v44, v44
	v_mfma_f32_16x16x32_bf16 v[200:203], a[112:115], v[52:55], v[200:203]
	buffer_load_dwordx4 v14, s[20:23], s66 offen offset:3072 lds
	v_mfma_f32_16x16x32_bf16 v[216:219], a[116:119], v[52:55], v[216:219]
	v_exp_f32 v45, v45
	v_mfma_f32_16x16x32_bf16 v[216:219], a[84:87], v[48:51], v[216:219]
	ds_read_b128 a[52:55], v10 offset:28672
	v_cvt_pk_bf16_f32 v62, v44, v45
	v_mfma_f32_16x16x32_bf16 v[232:235], a[88:91], v[48:51], v[232:235]
	v_exp_f32 v46, v46
	v_mfma_f32_16x16x32_bf16 v[232:235], a[120:123], v[52:55], v[232:235]
	ds_read_b128 a[48:51], v9 offset:28672
	ds_read_b64_tr_b16 a[188:189], v29 offset:4096
	v_mfma_f32_16x16x32_bf16 v[248:251], a[124:127], v[52:55], v[248:251]
	v_exp_f32 v47, v47
	v_mfma_f32_16x16x32_bf16 v[248:251], a[92:95], v[48:51], v[248:251]
	ds_read_b64_tr_b16 a[190:191], v29 offset:6144
	v_cvt_pk_bf16_f32 v63, v46, v47
	v_mfma_f32_16x16x32_bf16 v[40:43], a[32:35], a[192:195], -4.0
	v_exp_f32 v32, v32
	v_mfma_f32_16x16x32_bf16 v[40:43], a[36:39], a[196:199], v[40:43]
	buffer_load_dwordx4 v[76:79], v13, s[48:51], s71 offen offset:3072 sc1 nt
	v_mfma_f32_16x16x32_bf16 v[40:43], a[40:43], a[200:203], v[40:43]
	s_waitcnt lgkmcnt(4)
	v_exp_f32 v33, v33
	v_mfma_f32_16x16x32_bf16 v[40:43], a[44:47], a[204:207], v[40:43]
	v_cvt_pk_bf16_f32 v48, v32, v33
	v_mfma_f32_16x16x32_bf16 v[44:47], a[60:63], a[204:207], -4.0
	v_exp_f32 v34, v34
	v_mfma_f32_16x16x32_bf16 v[44:47], a[56:59], a[200:203], v[44:47]
	s_waitcnt lgkmcnt(3)
	v_mfma_f32_16x16x32_bf16 v[44:47], a[52:55], a[196:199], v[44:47]
	s_waitcnt lgkmcnt(2)
	v_exp_f32 v35, v35
	v_mfma_f32_16x16x32_bf16 v[44:47], a[48:51], a[192:195], v[44:47]
	v_cvt_pk_bf16_f32 v49, v34, v35
	v_smfmac_f32_16x16x64_bf16 a[136:139], a[168:171], v[56:63], v31
	v_mfma_f32_16x16x32_bf16 v[140:143], a[64:67], v[56:59], v[140:143]
	v_exp_f32 v36, v36
	v_mfma_f32_16x16x32_bf16 v[140:143], a[96:99], v[60:63], v[140:143]
	ds_read_b64_tr_b16 a[64:65], v1 offset:16384
	ds_read_b64_tr_b16 a[66:67], v1 offset:20480
	v_mfma_f32_16x16x32_bf16 v[156:159], a[100:103], v[60:63], v[156:159]
	v_exp_f32 v37, v37
	v_mfma_f32_16x16x32_bf16 v[156:159], a[68:71], v[56:59], v[156:159]
	ds_read_b64_tr_b16 a[96:97], v1 offset:24576
	v_cvt_pk_bf16_f32 v50, v36, v37
	v_mfma_f32_16x16x32_bf16 v[172:175], a[72:75], v[56:59], v[172:175]
	v_exp_f32 v38, v38
	v_mfma_f32_16x16x32_bf16 v[172:175], a[104:107], v[60:63], v[172:175]
	ds_read_b64_tr_b16 a[98:99], v1 offset:28672
	ds_read_b64_tr_b16 a[100:101], v2 offset:24576
	v_mfma_f32_16x16x32_bf16 v[188:191], a[108:111], v[60:63], v[188:191]
	v_exp_f32 v39, v39
	v_mfma_f32_16x16x32_bf16 v[188:191], a[76:79], v[56:59], v[188:191]
	ds_read_b64_tr_b16 a[102:103], v2 offset:28672
	v_cvt_pk_bf16_f32 v51, v38, v39
	v_mfma_f32_16x16x32_bf16 v[32:35], a[0:3], a[208:211], -4.0
	v_exp_f32 v40, v40
	v_mfma_f32_16x16x32_bf16 v[32:35], a[4:7], a[212:215], v[32:35]
	ds_read_b64_tr_b16 a[68:69], v2 offset:16384
	ds_read_b64_tr_b16 a[70:71], v2 offset:20480
	v_mfma_f32_16x16x32_bf16 v[32:35], a[8:11], a[216:219], v[32:35]
	v_exp_f32 v41, v41
	v_mfma_f32_16x16x32_bf16 v[32:35], a[12:15], a[220:223], v[32:35]
	ds_read_b64_tr_b16 a[72:73], v3 offset:16384
	v_cvt_pk_bf16_f32 v52, v40, v41
	v_mfma_f32_16x16x32_bf16 v[36:39], a[28:31], a[220:223], -4.0
	v_exp_f32 v42, v42
	v_mfma_f32_16x16x32_bf16 v[36:39], a[24:27], a[216:219], v[36:39]
	ds_read_b64_tr_b16 a[74:75], v3 offset:20480
	ds_read_b64_tr_b16 a[104:105], v3 offset:24576
	v_mfma_f32_16x16x32_bf16 v[36:39], a[20:23], a[212:215], v[36:39]
	v_exp_f32 v43, v43
	v_mfma_f32_16x16x32_bf16 v[36:39], a[16:19], a[208:211], v[36:39]
	ds_read_b64_tr_b16 a[106:107], v3 offset:28672
	v_cvt_pk_bf16_f32 v53, v42, v43
	v_mfma_f32_16x16x32_bf16 v[204:207], a[80:83], v[56:59], v[204:207]
	v_exp_f32 v44, v44
	v_mfma_f32_16x16x32_bf16 v[204:207], a[112:115], v[60:63], v[204:207]
	ds_read_b64_tr_b16 a[108:109], v4 offset:24576
	ds_read_b64_tr_b16 a[110:111], v4 offset:28672
	v_mfma_f32_16x16x32_bf16 v[220:223], a[116:119], v[60:63], v[220:223]
	v_exp_f32 v45, v45
	v_mfma_f32_16x16x32_bf16 v[220:223], a[84:87], v[56:59], v[220:223]
	ds_read_b64_tr_b16 a[76:77], v4 offset:16384
	v_cvt_pk_bf16_f32 v54, v44, v45
	v_mfma_f32_16x16x32_bf16 v[236:239], a[88:91], v[56:59], v[236:239]
	v_exp_f32 v46, v46
	v_mfma_f32_16x16x32_bf16 v[236:239], a[120:123], v[60:63], v[236:239]
	ds_read_b64_tr_b16 a[78:79], v4 offset:20480
	ds_read_b64_tr_b16 a[80:81], v5 offset:16384
	v_mfma_f32_16x16x32_bf16 v[252:255], a[124:127], v[60:63], v[252:255]
	v_exp_f32 v47, v47
	v_mfma_f32_16x16x32_bf16 v[252:255], a[92:95], v[56:59], v[252:255]
	ds_read_b64_tr_b16 a[82:83], v5 offset:20480
	v_cvt_pk_bf16_f32 v55, v46, v47
	v_mfma_f32_16x16x32_bf16 v[40:43], a[32:35], a[208:211], -4.0
	v_exp_f32 v32, v32
	v_mfma_f32_16x16x32_bf16 v[40:43], a[36:39], a[212:215], v[40:43]
	ds_read_b64_tr_b16 a[112:113], v5 offset:24576
	ds_read_b64_tr_b16 a[114:115], v5 offset:28672
	v_mfma_f32_16x16x32_bf16 v[40:43], a[40:43], a[216:219], v[40:43]
	v_exp_f32 v33, v33
	v_mfma_f32_16x16x32_bf16 v[40:43], a[44:47], a[220:223], v[40:43]
	ds_read_b64_tr_b16 a[116:117], v6 offset:24576
	v_cvt_pk_bf16_f32 v56, v32, v33
	v_mfma_f32_16x16x32_bf16 v[44:47], a[60:63], a[220:223], -4.0
	v_exp_f32 v34, v34
	v_mfma_f32_16x16x32_bf16 v[44:47], a[56:59], a[216:219], v[44:47]
	ds_read_b64_tr_b16 a[118:119], v6 offset:28672
	ds_read_b64_tr_b16 a[84:85], v6 offset:16384
	v_mfma_f32_16x16x32_bf16 v[44:47], a[52:55], a[212:215], v[44:47]
	v_exp_f32 v35, v35
	v_mfma_f32_16x16x32_bf16 v[44:47], a[48:51], a[208:211], v[44:47]
	ds_read_b64_tr_b16 a[86:87], v6 offset:20480
	v_cvt_pk_bf16_f32 v57, v34, v35
	v_smfmac_f32_16x16x64_bf16 a[132:135], a[128:131], v[48:55], v31
	s_waitcnt lgkmcnt(7)
	v_mfma_f32_16x16x32_bf16 v[128:131], a[64:67], v[48:51], v[128:131]
	v_exp_f32 v36, v36
	v_mfma_f32_16x16x32_bf16 v[128:131], a[96:99], v[52:55], v[128:131]
	ds_read_b64_tr_b16 a[88:89], v7 offset:16384
	ds_read_b64_tr_b16 a[90:91], v7 offset:20480
	v_mfma_f32_16x16x32_bf16 v[144:147], a[100:103], v[52:55], v[144:147]
	v_exp_f32 v37, v37
	v_mfma_f32_16x16x32_bf16 v[144:147], a[68:71], v[48:51], v[144:147]
	ds_read_b64_tr_b16 a[120:121], v7 offset:24576
	v_cvt_pk_bf16_f32 v58, v36, v37
	v_mfma_f32_16x16x32_bf16 v[160:163], a[72:75], v[48:51], v[160:163]
	v_exp_f32 v38, v38
	v_mfma_f32_16x16x32_bf16 v[160:163], a[104:107], v[52:55], v[160:163]
	ds_read_b64_tr_b16 a[122:123], v7 offset:28672
	ds_read_b64_tr_b16 a[124:125], v8 offset:24576
	v_mfma_f32_16x16x32_bf16 v[176:179], a[108:111], v[52:55], v[176:179]
	v_exp_f32 v39, v39
	v_mfma_f32_16x16x32_bf16 v[176:179], a[76:79], v[48:51], v[176:179]
	ds_read_b64_tr_b16 a[126:127], v8 offset:28672
	v_cvt_pk_bf16_f32 v59, v38, v39
	v_mfma_f32_16x16x32_bf16 v[32:35], a[0:3], a[224:227], -4.0
	v_exp_f32 v40, v40
	v_mfma_f32_16x16x32_bf16 v[32:35], a[4:7], a[228:231], v[32:35]
	ds_read_b64_tr_b16 a[92:93], v8 offset:16384
	ds_read_b64_tr_b16 a[94:95], v8 offset:20480
	v_mfma_f32_16x16x32_bf16 v[32:35], a[8:11], a[232:235], v[32:35]
	v_exp_f32 v41, v41
	v_mfma_f32_16x16x32_bf16 v[32:35], a[12:15], a[236:239], v[32:35]
	v_cvt_pk_bf16_f32 v60, v40, v41
	v_mfma_f32_16x16x32_bf16 v[36:39], a[28:31], a[236:239], -4.0
	v_exp_f32 v42, v42
	v_mfma_f32_16x16x32_bf16 v[36:39], a[24:27], a[232:235], v[36:39]
	v_mfma_f32_16x16x32_bf16 v[36:39], a[20:23], a[228:231], v[36:39]
	v_exp_f32 v43, v43
	v_mfma_f32_16x16x32_bf16 v[36:39], a[16:19], a[224:227], v[36:39]
	s_waitcnt lgkmcnt(3)
	v_cvt_pk_bf16_f32 v61, v42, v43
	v_mfma_f32_16x16x32_bf16 v[192:195], a[80:83], v[48:51], v[192:195]
	s_add_u32 s71, s89, 0x2001000
	v_exp_f32 v44, v44
	v_mfma_f32_16x16x32_bf16 v[192:195], a[112:115], v[52:55], v[192:195]
	buffer_load_dwordx4 v[80:83], v13, s[48:51], s71 offen offset:0 sc1 nt
	v_mfma_f32_16x16x32_bf16 v[208:211], a[116:119], v[52:55], v[208:211]
	v_exp_f32 v45, v45
	v_mfma_f32_16x16x32_bf16 v[208:211], a[84:87], v[48:51], v[208:211]
	v_cvt_pk_bf16_f32 v62, v44, v45
	v_mfma_f32_16x16x32_bf16 v[224:227], a[88:91], v[48:51], v[224:227]
	v_exp_f32 v46, v46
	v_mfma_f32_16x16x32_bf16 v[224:227], a[120:123], v[52:55], v[224:227]
	s_waitcnt lgkmcnt(0)
	buffer_load_dwordx4 v[84:87], v13, s[48:51], s71 offen offset:1024 sc1 nt
	v_mfma_f32_16x16x32_bf16 v[240:243], a[124:127], v[52:55], v[240:243]
	s_waitcnt vmcnt(8)
	v_exp_f32 v47, v47
	v_mfma_f32_16x16x32_bf16 v[240:243], a[92:95], v[48:51], v[240:243]
	s_barrier
	v_cvt_pk_bf16_f32 v63, v46, v47
	v_mfma_f32_16x16x32_bf16 v[40:43], a[32:35], a[224:227], -4.0
	s_add_u32 m0, s65, 0x4000
	v_exp_f32 v32, v32
	v_mfma_f32_16x16x32_bf16 v[40:43], a[36:39], a[228:231], v[40:43]
	buffer_load_dwordx4 v18, s[8:11], s68 offen lds
	v_mfma_f32_16x16x32_bf16 v[40:43], a[40:43], a[232:235], v[40:43]
	v_exp_f32 v33, v33
	v_mfma_f32_16x16x32_bf16 v[40:43], a[44:47], a[236:239], v[40:43]
	v_cvt_pk_bf16_f32 v48, v32, v33
	v_mfma_f32_16x16x32_bf16 v[44:47], a[60:63], a[236:239], -4.0
L_pg22:
	s_cbranch_execz L_pg26
	v_exp_f32 v34, v34
	v_mfma_f32_16x16x32_bf16 v[44:47], a[56:59], a[232:235], v[44:47]
	buffer_load_dwordx4 v19, s[8:11], s68 offen offset:1024 lds
	v_mfma_f32_16x16x32_bf16 v[44:47], a[52:55], a[228:231], v[44:47]
	s_add_u32 s68, s68, 0x2000
	v_exp_f32 v35, v35
	v_mfma_f32_16x16x32_bf16 v[44:47], a[48:51], a[224:227], v[44:47]
	s_and_b32 s68, s68, 0x7ffff
	v_cvt_pk_bf16_f32 v49, v34, v35
	v_smfmac_f32_16x16x64_bf16 a[132:135], a[168:171], v[56:63], v31
	v_mfma_f32_16x16x32_bf16 v[132:135], a[64:67], v[56:59], v[132:135]
	s_add_u32 m0, s65, 0x6000
	v_exp_f32 v36, v36
	v_mfma_f32_16x16x32_bf16 v[132:135], a[96:99], v[60:63], v[132:135]
	buffer_load_dwordx4 v18, s[8:11], s68 offen lds
	v_mfma_f32_16x16x32_bf16 v[148:151], a[100:103], v[60:63], v[148:151]
	v_exp_f32 v37, v37
	v_mfma_f32_16x16x32_bf16 v[148:151], a[68:71], v[56:59], v[148:151]
	v_cvt_pk_bf16_f32 v50, v36, v37
	v_mfma_f32_16x16x32_bf16 v[164:167], a[72:75], v[56:59], v[164:167]
	v_exp_f32 v38, v38
	v_mfma_f32_16x16x32_bf16 v[164:167], a[104:107], v[60:63], v[164:167]
	buffer_load_dwordx4 v19, s[8:11], s68 offen offset:1024 lds
	v_mfma_f32_16x16x32_bf16 v[180:183], a[108:111], v[60:63], v[180:183]
	s_add_u32 s68, s68, 0x2000
	v_exp_f32 v39, v39
	v_mfma_f32_16x16x32_bf16 v[180:183], a[76:79], v[56:59], v[180:183]
	s_and_b32 s68, s68, 0x7ffff
	v_cvt_pk_bf16_f32 v51, v38, v39
	v_mfma_f32_16x16x32_bf16 v[32:35], a[0:3], a[240:243], -4.0
	s_add_u32 m0, s65, 0xc000
	v_exp_f32 v40, v40
	v_mfma_f32_16x16x32_bf16 v[32:35], a[4:7], a[244:247], v[32:35]
	buffer_load_dwordx4 v20, s[12:15], s69 offen lds
	v_mfma_f32_16x16x32_bf16 v[32:35], a[8:11], a[248:251], v[32:35]
	v_exp_f32 v41, v41
	v_mfma_f32_16x16x32_bf16 v[32:35], a[12:15], a[252:255], v[32:35]
	ds_read_b128 a[0:3], v9 offset:0
	v_cvt_pk_bf16_f32 v52, v40, v41
	v_mfma_f32_16x16x32_bf16 v[36:39], a[28:31], a[252:255], -4.0
	v_exp_f32 v42, v42
	v_mfma_f32_16x16x32_bf16 v[36:39], a[24:27], a[248:251], v[36:39]
	buffer_load_dwordx4 v21, s[12:15], s69 offen offset:1024 lds
	v_mfma_f32_16x16x32_bf16 v[36:39], a[20:23], a[244:247], v[36:39]
	v_exp_f32 v43, v43
	v_mfma_f32_16x16x32_bf16 v[36:39], a[16:19], a[240:243], v[36:39]
	ds_read_b128 a[4:7], v10 offset:0
	v_cvt_pk_bf16_f32 v53, v42, v43
	v_mfma_f32_16x16x32_bf16 v[196:199], a[80:83], v[56:59], v[196:199]
	v_exp_f32 v44, v44
	v_mfma_f32_16x16x32_bf16 v[196:199], a[112:115], v[60:63], v[196:199]
	ds_read_b128 a[8:11], v11 offset:0
	ds_read_b128 a[12:15], v12 offset:0
	v_mfma_f32_16x16x32_bf16 v[212:215], a[116:119], v[60:63], v[212:215]
	s_add_u32 s69, s69, 0x2000
	v_exp_f32 v45, v45
	v_mfma_f32_16x16x32_bf16 v[212:215], a[84:87], v[56:59], v[212:215]
	s_and_b32 s69, s69, 0x7ffff
	ds_read_b128 a[28:31], v12 offset:4096
	v_cvt_pk_bf16_f32 v54, v44, v45
	v_mfma_f32_16x16x32_bf16 v[228:231], a[88:91], v[56:59], v[228:231]
	s_add_u32 m0, s65, 0xe000
	v_exp_f32 v46, v46
	v_mfma_f32_16x16x32_bf16 v[228:231], a[120:123], v[60:63], v[228:231]
	buffer_load_dwordx4 v20, s[12:15], s69 offen lds
	v_mfma_f32_16x16x32_bf16 v[244:247], a[124:127], v[60:63], v[244:247]
	v_exp_f32 v47, v47
	v_mfma_f32_16x16x32_bf16 v[244:247], a[92:95], v[56:59], v[244:247]
	ds_read_b128 a[24:27], v11 offset:4096
	v_cvt_pk_bf16_f32 v55, v46, v47
	v_mfma_f32_16x16x32_bf16 v[40:43], a[32:35], a[240:243], -4.0
	s_add_u32 m0, s65, 0xe000
	v_exp_f32 v32, v32
	v_mfma_f32_16x16x32_bf16 v[40:43], a[36:39], a[244:247], v[40:43]
	buffer_load_dwordx4 v21, s[12:15], s69 offen offset:1024 lds
	v_mfma_f32_16x16x32_bf16 v[40:43], a[40:43], a[248:251], v[40:43]
	v_exp_f32 v33, v33
	v_mfma_f32_16x16x32_bf16 v[40:43], a[44:47], a[252:255], v[40:43]
	s_add_u32 s69, s69, 0x2000
	ds_read_b128 a[20:23], v10 offset:4096
	v_cvt_pk_bf16_f32 v56, v32, v33
	v_mfma_f32_16x16x32_bf16 v[44:47], a[60:63], a[252:255], -4.0
	s_and_b32 s69, s69, 0x7ffff
	v_exp_f32 v34, v34
	v_mfma_f32_16x16x32_bf16 v[44:47], a[56:59], a[248:251], v[44:47]
	buffer_load_dwordx4 v[88:91], v13, s[48:51], s71 offen offset:2048 sc1 nt
	v_mfma_f32_16x16x32_bf16 v[44:47], a[52:55], a[244:247], v[44:47]
	v_exp_f32 v35, v35
	v_mfma_f32_16x16x32_bf16 v[44:47], a[48:51], a[240:243], v[44:47]
	ds_read_b128 a[16:19], v9 offset:4096
	v_cvt_pk_bf16_f32 v57, v34, v35
	v_smfmac_f32_16x16x64_bf16 a[136:139], a[128:131], v[48:55], v31
	v_mfma_f32_16x16x32_bf16 v[136:139], a[64:67], v[48:51], v[136:139]
	v_exp_f32 v36, v36
	v_mfma_f32_16x16x32_bf16 v[136:139], a[96:99], v[52:55], v[136:139]
	ds_read_b128 a[32:35], v9 offset:8192
	ds_read_b128 a[36:39], v10 offset:8192
	v_mfma_f32_16x16x32_bf16 v[152:155], a[100:103], v[52:55], v[152:155]
	v_exp_f32 v37, v37
	v_mfma_f32_16x16x32_bf16 v[152:155], a[68:71], v[48:51], v[152:155]
	ds_read_b128 a[40:43], v11 offset:8192
	v_cvt_pk_bf16_f32 v58, v36, v37
	v_mfma_f32_16x16x32_bf16 v[168:171], a[72:75], v[48:51], v[168:171]
	v_exp_f32 v38, v38
	v_mfma_f32_16x16x32_bf16 v[168:171], a[104:107], v[52:55], v[168:171]
	ds_read_b128 a[44:47], v12 offset:8192
	ds_read_b128 a[60:63], v12 offset:12288
	v_mfma_f32_16x16x32_bf16 v[184:187], a[108:111], v[52:55], v[184:187]
	v_exp_f32 v39, v39
	v_mfma_f32_16x16x32_bf16 v[184:187], a[76:79], v[48:51], v[184:187]
	s_waitcnt lgkmcnt(6)
	ds_read_b128 a[56:59], v11 offset:12288
	v_cvt_pk_bf16_f32 v59, v38, v39
	v_mfma_f32_16x16x32_bf16 v[32:35], a[0:3], a[192:195], -4.0
	v_exp_f32 v40, v40
	v_mfma_f32_16x16x32_bf16 v[32:35], a[4:7], a[196:199], v[32:35]
	buffer_load_dwordx4 v[92:95], v13, s[48:51], s71 offen offset:3072 sc1 nt
	v_mfma_f32_16x16x32_bf16 v[32:35], a[8:11], a[200:203], v[32:35]
	v_exp_f32 v41, v41
	v_mfma_f32_16x16x32_bf16 v[32:35], a[12:15], a[204:207], v[32:35]
	ds_read_b128 a[52:55], v10 offset:12288
	v_cvt_pk_bf16_f32 v60, v40, v41
	v_mfma_f32_16x16x32_bf16 v[36:39], a[28:31], a[204:207], -4.0
	s_add_u32 s71, s89, 0x2002000
	v_exp_f32 v42, v42
	v_mfma_f32_16x16x32_bf16 v[36:39], a[24:27], a[200:203], v[36:39]
	buffer_load_dwordx4 v[96:99], v13, s[48:51], s71 offen offset:0 sc1 nt
	v_mfma_f32_16x16x32_bf16 v[36:39], a[20:23], a[196:199], v[36:39]
	s_waitcnt lgkmcnt(4)
	v_exp_f32 v43, v43
	v_mfma_f32_16x16x32_bf16 v[36:39], a[16:19], a[192:195], v[36:39]
	ds_read_b128 a[48:51], v9 offset:12288
	v_cvt_pk_bf16_f32 v61, v42, v43
	v_mfma_f32_16x16x32_bf16 v[200:203], a[80:83], v[48:51], v[200:203]
	v_exp_f32 v44, v44
	v_mfma_f32_16x16x32_bf16 v[200:203], a[112:115], v[52:55], v[200:203]
	v_mfma_f32_16x16x32_bf16 v[216:219], a[116:119], v[52:55], v[216:219]
	v_exp_f32 v45, v45
	v_mfma_f32_16x16x32_bf16 v[216:219], a[84:87], v[48:51], v[216:219]
	v_cvt_pk_bf16_f32 v62, v44, v45
	v_mfma_f32_16x16x32_bf16 v[232:235], a[88:91], v[48:51], v[232:235]
	v_exp_f32 v46, v46
	v_mfma_f32_16x16x32_bf16 v[232:235], a[120:123], v[52:55], v[232:235]
	v_mfma_f32_16x16x32_bf16 v[248:251], a[124:127], v[52:55], v[248:251]
	v_exp_f32 v47, v47
	v_mfma_f32_16x16x32_bf16 v[248:251], a[92:95], v[48:51], v[248:251]
	v_cvt_pk_bf16_f32 v63, v46, v47
	v_mfma_f32_16x16x32_bf16 v[40:43], a[32:35], a[192:195], -4.0
	v_exp_f32 v32, v32
	v_mfma_f32_16x16x32_bf16 v[40:43], a[36:39], a[196:199], v[40:43]
	buffer_load_dwordx4 v[100:103], v13, s[48:51], s71 offen offset:1024 sc1 nt
	v_mfma_f32_16x16x32_bf16 v[40:43], a[40:43], a[200:203], v[40:43]
	s_waitcnt lgkmcnt(0)
	v_exp_f32 v33, v33
	v_mfma_f32_16x16x32_bf16 v[40:43], a[44:47], a[204:207], v[40:43]
	v_cvt_pk_bf16_f32 v48, v32, v33
	v_mfma_f32_16x16x32_bf16 v[44:47], a[60:63], a[204:207], -4.0
	v_exp_f32 v34, v34
	v_mfma_f32_16x16x32_bf16 v[44:47], a[56:59], a[200:203], v[44:47]
	v_mfma_f32_16x16x32_bf16 v[44:47], a[52:55], a[196:199], v[44:47]
	v_exp_f32 v35, v35
	v_mfma_f32_16x16x32_bf16 v[44:47], a[48:51], a[192:195], v[44:47]
	v_cvt_pk_bf16_f32 v49, v34, v35
	v_smfmac_f32_16x16x64_bf16 a[136:139], a[168:171], v[56:63], v31
	v_mfma_f32_16x16x32_bf16 v[140:143], a[64:67], v[56:59], v[140:143]
	v_exp_f32 v36, v36
	v_mfma_f32_16x16x32_bf16 v[140:143], a[96:99], v[60:63], v[140:143]
	ds_read_b64_tr_b16 a[64:65], v1 offset:0
	ds_read_b64_tr_b16 a[66:67], v1 offset:4096
	v_mfma_f32_16x16x32_bf16 v[156:159], a[100:103], v[60:63], v[156:159]
	v_exp_f32 v37, v37
	v_mfma_f32_16x16x32_bf16 v[156:159], a[68:71], v[56:59], v[156:159]
	ds_read_b64_tr_b16 a[96:97], v1 offset:8192
	v_cvt_pk_bf16_f32 v50, v36, v37
	v_mfma_f32_16x16x32_bf16 v[172:175], a[72:75], v[56:59], v[172:175]
	v_exp_f32 v38, v38
	v_mfma_f32_16x16x32_bf16 v[172:175], a[104:107], v[60:63], v[172:175]
	ds_read_b64_tr_b16 a[98:99], v1 offset:12288
	ds_read_b64_tr_b16 a[100:101], v2 offset:8192
	v_mfma_f32_16x16x32_bf16 v[188:191], a[108:111], v[60:63], v[188:191]
	v_exp_f32 v39, v39
	v_mfma_f32_16x16x32_bf16 v[188:191], a[76:79], v[56:59], v[188:191]
	ds_read_b64_tr_b16 a[102:103], v2 offset:12288
	v_cvt_pk_bf16_f32 v51, v38, v39
	v_mfma_f32_16x16x32_bf16 v[32:35], a[0:3], a[208:211], -4.0
	v_exp_f32 v40, v40
	v_mfma_f32_16x16x32_bf16 v[32:35], a[4:7], a[212:215], v[32:35]
	ds_read_b64_tr_b16 a[68:69], v2 offset:0
	ds_read_b64_tr_b16 a[70:71], v2 offset:4096
	v_mfma_f32_16x16x32_bf16 v[32:35], a[8:11], a[216:219], v[32:35]
	v_exp_f32 v41, v41
	v_mfma_f32_16x16x32_bf16 v[32:35], a[12:15], a[220:223], v[32:35]
	ds_read_b64_tr_b16 a[72:73], v3 offset:0
	v_cvt_pk_bf16_f32 v52, v40, v41
	v_mfma_f32_16x16x32_bf16 v[36:39], a[28:31], a[220:223], -4.0
	v_exp_f32 v42, v42
	v_mfma_f32_16x16x32_bf16 v[36:39], a[24:27], a[216:219], v[36:39]
	ds_read_b64_tr_b16 a[74:75], v3 offset:4096
	ds_read_b64_tr_b16 a[104:105], v3 offset:8192
	v_mfma_f32_16x16x32_bf16 v[36:39], a[20:23], a[212:215], v[36:39]
	v_exp_f32 v43, v43
	v_mfma_f32_16x16x32_bf16 v[36:39], a[16:19], a[208:211], v[36:39]
	ds_read_b64_tr_b16 a[106:107], v3 offset:12288
	v_cvt_pk_bf16_f32 v53, v42, v43
	v_mfma_f32_16x16x32_bf16 v[204:207], a[80:83], v[56:59], v[204:207]
	v_exp_f32 v44, v44
	v_mfma_f32_16x16x32_bf16 v[204:207], a[112:115], v[60:63], v[204:207]
	ds_read_b64_tr_b16 a[108:109], v4 offset:8192
	ds_read_b64_tr_b16 a[110:111], v4 offset:12288
	v_mfma_f32_16x16x32_bf16 v[220:223], a[116:119], v[60:63], v[220:223]
	v_exp_f32 v45, v45
	v_mfma_f32_16x16x32_bf16 v[220:223], a[84:87], v[56:59], v[220:223]
	ds_read_b64_tr_b16 a[76:77], v4 offset:0
	v_cvt_pk_bf16_f32 v54, v44, v45
	v_mfma_f32_16x16x32_bf16 v[236:239], a[88:91], v[56:59], v[236:239]
	v_exp_f32 v46, v46
	v_mfma_f32_16x16x32_bf16 v[236:239], a[120:123], v[60:63], v[236:239]
	ds_read_b64_tr_b16 a[78:79], v4 offset:4096
	ds_read_b64_tr_b16 a[80:81], v5 offset:0
	v_mfma_f32_16x16x32_bf16 v[252:255], a[124:127], v[60:63], v[252:255]
	v_exp_f32 v47, v47
	v_mfma_f32_16x16x32_bf16 v[252:255], a[92:95], v[56:59], v[252:255]
	ds_read_b64_tr_b16 a[82:83], v5 offset:4096
	v_cvt_pk_bf16_f32 v55, v46, v47
	v_mfma_f32_16x16x32_bf16 v[40:43], a[32:35], a[208:211], -4.0
	v_exp_f32 v32, v32
	v_mfma_f32_16x16x32_bf16 v[40:43], a[36:39], a[212:215], v[40:43]
	ds_read_b64_tr_b16 a[112:113], v5 offset:8192
	ds_read_b64_tr_b16 a[114:115], v5 offset:12288
	v_mfma_f32_16x16x32_bf16 v[40:43], a[40:43], a[216:219], v[40:43]
	v_exp_f32 v33, v33
	v_mfma_f32_16x16x32_bf16 v[40:43], a[44:47], a[220:223], v[40:43]
	ds_read_b64_tr_b16 a[116:117], v6 offset:8192
	v_cvt_pk_bf16_f32 v56, v32, v33
	v_mfma_f32_16x16x32_bf16 v[44:47], a[60:63], a[220:223], -4.0
	v_exp_f32 v34, v34
	v_mfma_f32_16x16x32_bf16 v[44:47], a[56:59], a[216:219], v[44:47]
	ds_read_b64_tr_b16 a[118:119], v6 offset:12288
	ds_read_b64_tr_b16 a[84:85], v6 offset:0
	v_mfma_f32_16x16x32_bf16 v[44:47], a[52:55], a[212:215], v[44:47]
	v_exp_f32 v35, v35
	v_mfma_f32_16x16x32_bf16 v[44:47], a[48:51], a[208:211], v[44:47]
	ds_read_b64_tr_b16 a[86:87], v6 offset:4096
	v_cvt_pk_bf16_f32 v57, v34, v35
	v_smfmac_f32_16x16x64_bf16 a[132:135], a[128:131], v[48:55], v31
	s_waitcnt lgkmcnt(7)
	v_mfma_f32_16x16x32_bf16 v[128:131], a[64:67], v[48:51], v[128:131]
	v_exp_f32 v36, v36
	v_mfma_f32_16x16x32_bf16 v[128:131], a[96:99], v[52:55], v[128:131]
	ds_read_b64_tr_b16 a[88:89], v7 offset:0
	ds_read_b64_tr_b16 a[90:91], v7 offset:4096
	v_mfma_f32_16x16x32_bf16 v[144:147], a[100:103], v[52:55], v[144:147]
	v_exp_f32 v37, v37
	v_mfma_f32_16x16x32_bf16 v[144:147], a[68:71], v[48:51], v[144:147]
	ds_read_b64_tr_b16 a[120:121], v7 offset:8192
	v_cvt_pk_bf16_f32 v58, v36, v37
	v_mfma_f32_16x16x32_bf16 v[160:163], a[72:75], v[48:51], v[160:163]
	v_exp_f32 v38, v38
	v_mfma_f32_16x16x32_bf16 v[160:163], a[104:107], v[52:55], v[160:163]
	ds_read_b64_tr_b16 a[122:123], v7 offset:12288
	ds_read_b64_tr_b16 a[124:125], v8 offset:8192
	v_mfma_f32_16x16x32_bf16 v[176:179], a[108:111], v[52:55], v[176:179]
	v_exp_f32 v39, v39
	v_mfma_f32_16x16x32_bf16 v[176:179], a[76:79], v[48:51], v[176:179]
	ds_read_b64_tr_b16 a[126:127], v8 offset:12288
	v_cvt_pk_bf16_f32 v59, v38, v39
	v_mfma_f32_16x16x32_bf16 v[32:35], a[0:3], a[224:227], -4.0
	v_exp_f32 v40, v40
	v_mfma_f32_16x16x32_bf16 v[32:35], a[4:7], a[228:231], v[32:35]
	ds_read_b64_tr_b16 a[92:93], v8 offset:0
	ds_read_b64_tr_b16 a[94:95], v8 offset:4096
	v_mfma_f32_16x16x32_bf16 v[32:35], a[8:11], a[232:235], v[32:35]
	v_exp_f32 v41, v41
	v_mfma_f32_16x16x32_bf16 v[32:35], a[12:15], a[236:239], v[32:35]
	v_cvt_pk_bf16_f32 v60, v40, v41
	v_mfma_f32_16x16x32_bf16 v[36:39], a[28:31], a[236:239], -4.0
	v_exp_f32 v42, v42
	v_mfma_f32_16x16x32_bf16 v[36:39], a[24:27], a[232:235], v[36:39]
	v_mfma_f32_16x16x32_bf16 v[36:39], a[20:23], a[228:231], v[36:39]
	v_exp_f32 v43, v43
	v_mfma_f32_16x16x32_bf16 v[36:39], a[16:19], a[224:227], v[36:39]
	s_waitcnt lgkmcnt(3)
	v_cvt_pk_bf16_f32 v61, v42, v43
	v_mfma_f32_16x16x32_bf16 v[192:195], a[80:83], v[48:51], v[192:195]
	v_exp_f32 v44, v44
	v_mfma_f32_16x16x32_bf16 v[192:195], a[112:115], v[52:55], v[192:195]
	buffer_load_dwordx4 v[104:107], v13, s[48:51], s71 offen offset:2048 sc1 nt
	v_mfma_f32_16x16x32_bf16 v[208:211], a[116:119], v[52:55], v[208:211]
	v_exp_f32 v45, v45
	v_mfma_f32_16x16x32_bf16 v[208:211], a[84:87], v[48:51], v[208:211]
	v_cvt_pk_bf16_f32 v62, v44, v45
	v_mfma_f32_16x16x32_bf16 v[224:227], a[88:91], v[48:51], v[224:227]
	v_exp_f32 v46, v46
	v_mfma_f32_16x16x32_bf16 v[224:227], a[120:123], v[52:55], v[224:227]
	s_waitcnt lgkmcnt(0)
	buffer_load_dwordx4 v[108:111], v13, s[48:51], s71 offen offset:3072 sc1 nt
	v_mfma_f32_16x16x32_bf16 v[240:243], a[124:127], v[52:55], v[240:243]
	s_waitcnt vmcnt(6)
	v_exp_f32 v47, v47
	v_mfma_f32_16x16x32_bf16 v[240:243], a[92:95], v[48:51], v[240:243]
	s_barrier
	v_cvt_pk_bf16_f32 v63, v46, v47
	v_mfma_f32_16x16x32_bf16 v[40:43], a[32:35], a[224:227], -4.0
	s_add_u32 s71, s89, 0x2003000
	v_exp_f32 v32, v32
	v_mfma_f32_16x16x32_bf16 v[40:43], a[36:39], a[228:231], v[40:43]
	buffer_load_dwordx4 v[112:115], v13, s[48:51], s71 offen offset:0 sc1 nt
	v_mfma_f32_16x16x32_bf16 v[40:43], a[40:43], a[232:235], v[40:43]
	v_exp_f32 v33, v33
	v_mfma_f32_16x16x32_bf16 v[40:43], a[44:47], a[236:239], v[40:43]
	v_cvt_pk_bf16_f32 v48, v32, v33
	v_mfma_f32_16x16x32_bf16 v[44:47], a[60:63], a[236:239], -4.0
	v_exp_f32 v34, v34
	v_mfma_f32_16x16x32_bf16 v[44:47], a[56:59], a[232:235], v[44:47]
	v_mfma_f32_16x16x32_bf16 v[44:47], a[52:55], a[228:231], v[44:47]
	v_exp_f32 v35, v35
	v_mfma_f32_16x16x32_bf16 v[44:47], a[48:51], a[224:227], v[44:47]
	v_cvt_pk_bf16_f32 v49, v34, v35
	v_smfmac_f32_16x16x64_bf16 a[132:135], a[168:171], v[56:63], v31
	v_mfma_f32_16x16x32_bf16 v[132:135], a[64:67], v[56:59], v[132:135]
	v_exp_f32 v36, v36
	v_mfma_f32_16x16x32_bf16 v[132:135], a[96:99], v[60:63], v[132:135]
	v_mfma_f32_16x16x32_bf16 v[148:151], a[100:103], v[60:63], v[148:151]
	v_exp_f32 v37, v37
	v_mfma_f32_16x16x32_bf16 v[148:151], a[68:71], v[56:59], v[148:151]
	v_cvt_pk_bf16_f32 v50, v36, v37
	v_mfma_f32_16x16x32_bf16 v[164:167], a[72:75], v[56:59], v[164:167]
	v_exp_f32 v38, v38
	v_mfma_f32_16x16x32_bf16 v[164:167], a[104:107], v[60:63], v[164:167]
	v_mfma_f32_16x16x32_bf16 v[180:183], a[108:111], v[60:63], v[180:183]
	v_exp_f32 v39, v39
	v_mfma_f32_16x16x32_bf16 v[180:183], a[76:79], v[56:59], v[180:183]
	v_cvt_pk_bf16_f32 v51, v38, v39
	v_mfma_f32_16x16x32_bf16 v[32:35], a[0:3], a[240:243], -4.0
	v_exp_f32 v40, v40
	v_mfma_f32_16x16x32_bf16 v[32:35], a[4:7], a[244:247], v[32:35]
	buffer_load_dwordx4 v[116:119], v13, s[48:51], s71 offen offset:1024 sc1 nt
	v_mfma_f32_16x16x32_bf16 v[32:35], a[8:11], a[248:251], v[32:35]
	v_exp_f32 v41, v41
	v_mfma_f32_16x16x32_bf16 v[32:35], a[12:15], a[252:255], v[32:35]
	ds_read_b128 a[0:3], v9 offset:16384
	v_cvt_pk_bf16_f32 v52, v40, v41
	v_mfma_f32_16x16x32_bf16 v[36:39], a[28:31], a[252:255], -4.0
	v_exp_f32 v42, v42
	v_mfma_f32_16x16x32_bf16 v[36:39], a[24:27], a[248:251], v[36:39]
	ds_read_b128 a[4:7], v10 offset:16384
	ds_read_b128 a[8:11], v11 offset:16384
	v_mfma_f32_16x16x32_bf16 v[36:39], a[20:23], a[244:247], v[36:39]
	v_exp_f32 v43, v43
	v_mfma_f32_16x16x32_bf16 v[36:39], a[16:19], a[240:243], v[36:39]
	ds_read_b128 a[12:15], v12 offset:16384
	v_cvt_pk_bf16_f32 v53, v42, v43
	v_mfma_f32_16x16x32_bf16 v[196:199], a[80:83], v[56:59], v[196:199]
	v_exp_f32 v44, v44
	v_mfma_f32_16x16x32_bf16 v[196:199], a[112:115], v[60:63], v[196:199]
	ds_read_b128 a[28:31], v12 offset:20480
	ds_read_b128 a[24:27], v11 offset:20480
	v_mfma_f32_16x16x32_bf16 v[212:215], a[116:119], v[60:63], v[212:215]
	v_exp_f32 v45, v45
	v_mfma_f32_16x16x32_bf16 v[212:215], a[84:87], v[56:59], v[212:215]
	ds_read_b128 a[20:23], v10 offset:20480
	v_cvt_pk_bf16_f32 v54, v44, v45
	v_mfma_f32_16x16x32_bf16 v[228:231], a[88:91], v[56:59], v[228:231]
	v_exp_f32 v46, v46
	v_mfma_f32_16x16x32_bf16 v[228:231], a[120:123], v[60:63], v[228:231]
	ds_read_b128 a[16:19], v9 offset:20480
	v_mfma_f32_16x16x32_bf16 v[244:247], a[124:127], v[60:63], v[244:247]
	v_exp_f32 v47, v47
	v_mfma_f32_16x16x32_bf16 v[244:247], a[92:95], v[56:59], v[244:247]
	v_cvt_pk_bf16_f32 v55, v46, v47
	v_mfma_f32_16x16x32_bf16 v[40:43], a[32:35], a[240:243], -4.0
	v_exp_f32 v32, v32
	v_mfma_f32_16x16x32_bf16 v[40:43], a[36:39], a[244:247], v[40:43]
	buffer_load_dwordx4 v[120:123], v13, s[48:51], s71 offen offset:2048 sc1 nt
	v_mfma_f32_16x16x32_bf16 v[40:43], a[40:43], a[248:251], v[40:43]
	v_exp_f32 v33, v33
	v_mfma_f32_16x16x32_bf16 v[40:43], a[44:47], a[252:255], v[40:43]
	ds_read_b128 a[32:35], v9 offset:24576
	v_cvt_pk_bf16_f32 v56, v32, v33
	v_mfma_f32_16x16x32_bf16 v[44:47], a[60:63], a[252:255], -4.0
	v_exp_f32 v34, v34
	v_mfma_f32_16x16x32_bf16 v[44:47], a[56:59], a[248:251], v[44:47]
	ds_read_b128 a[36:39], v10 offset:24576
	ds_read_b128 a[40:43], v11 offset:24576
	v_mfma_f32_16x16x32_bf16 v[44:47], a[52:55], a[244:247], v[44:47]
	v_exp_f32 v35, v35
	v_mfma_f32_16x16x32_bf16 v[44:47], a[48:51], a[240:243], v[44:47]
	ds_read_b128 a[44:47], v12 offset:24576
	v_cvt_pk_bf16_f32 v57, v34, v35
	v_smfmac_f32_16x16x64_bf16 a[136:139], a[128:131], v[48:55], v31
	v_mfma_f32_16x16x32_bf16 v[136:139], a[64:67], v[48:51], v[136:139]
	v_exp_f32 v36, v36
	v_mfma_f32_16x16x32_bf16 v[136:139], a[96:99], v[52:55], v[136:139]
	ds_read_b128 a[60:63], v12 offset:28672
	ds_read_b128 a[56:59], v11 offset:28672
	v_mfma_f32_16x16x32_bf16 v[152:155], a[100:103], v[52:55], v[152:155]
	v_exp_f32 v37, v37
	v_mfma_f32_16x16x32_bf16 v[152:155], a[68:71], v[48:51], v[152:155]
	ds_read_b128 a[52:55], v10 offset:28672
	v_cvt_pk_bf16_f32 v58, v36, v37
	v_mfma_f32_16x16x32_bf16 v[168:171], a[72:75], v[48:51], v[168:171]
	v_exp_f32 v38, v38
	v_mfma_f32_16x16x32_bf16 v[168:171], a[104:107], v[52:55], v[168:171]
	ds_read_b128 a[48:51], v9 offset:28672
	v_mfma_f32_16x16x32_bf16 v[184:187], a[108:111], v[52:55], v[184:187]
	v_exp_f32 v39, v39
	v_mfma_f32_16x16x32_bf16 v[184:187], a[76:79], v[48:51], v[184:187]
	s_waitcnt lgkmcnt(5)
	v_cvt_pk_bf16_f32 v59, v38, v39
	v_mfma_f32_16x16x32_bf16 v[32:35], a[0:3], a[192:195], -4.0
	v_exp_f32 v40, v40
	v_mfma_f32_16x16x32_bf16 v[32:35], a[4:7], a[196:199], v[32:35]
	buffer_load_dwordx4 v[124:127], v13, s[48:51], s71 offen offset:3072 sc1 nt
	v_mfma_f32_16x16x32_bf16 v[32:35], a[8:11], a[200:203], v[32:35]
	v_exp_f32 v41, v41
	v_mfma_f32_16x16x32_bf16 v[32:35], a[12:15], a[204:207], v[32:35]
	s_add_u32 m0, s64, 0x0
	v_cvt_pk_bf16_f32 v60, v40, v41
	v_mfma_f32_16x16x32_bf16 v[36:39], a[28:31], a[204:207], -4.0
	s_xor_b32 s66, s87, 0x0
	v_exp_f32 v42, v42
	v_mfma_f32_16x16x32_bf16 v[36:39], a[24:27], a[200:203], v[36:39]
	buffer_load_dwordx4 v14, s[20:23], s66 offen offset:0 lds
	v_mfma_f32_16x16x32_bf16 v[36:39], a[20:23], a[196:199], v[36:39]
	v_exp_f32 v43, v43
	v_mfma_f32_16x16x32_bf16 v[36:39], a[16:19], a[192:195], v[36:39]
	v_cvt_pk_bf16_f32 v61, v42, v43
	v_mfma_f32_16x16x32_bf16 v[200:203], a[80:83], v[48:51], v[200:203]
	s_xor_b32 s66, s87, 0x1c00
	v_exp_f32 v44, v44
	v_mfma_f32_16x16x32_bf16 v[200:203], a[112:115], v[52:55], v[200:203]
	buffer_load_dwordx4 v14, s[20:23], s66 offen offset:1024 lds
	v_mfma_f32_16x16x32_bf16 v[216:219], a[116:119], v[52:55], v[216:219]
	v_exp_f32 v45, v45
	v_mfma_f32_16x16x32_bf16 v[216:219], a[84:87], v[48:51], v[216:219]
	v_cvt_pk_bf16_f32 v62, v44, v45
	v_mfma_f32_16x16x32_bf16 v[232:235], a[88:91], v[48:51], v[232:235]
	s_xor_b32 s66, s87, 0x3800
	v_exp_f32 v46, v46
	v_mfma_f32_16x16x32_bf16 v[232:235], a[120:123], v[52:55], v[232:235]
	buffer_load_dwordx4 v14, s[20:23], s66 offen offset:2048 lds
	v_mfma_f32_16x16x32_bf16 v[248:251], a[124:127], v[52:55], v[248:251]
	v_exp_f32 v47, v47
	v_mfma_f32_16x16x32_bf16 v[248:251], a[92:95], v[48:51], v[248:251]
	v_cvt_pk_bf16_f32 v63, v46, v47
	v_mfma_f32_16x16x32_bf16 v[40:43], a[32:35], a[192:195], -4.0
	s_add_u32 m0, s64, 0x0
	s_xor_b32 s66, s87, 0x5400
	v_exp_f32 v32, v32
	v_mfma_f32_16x16x32_bf16 v[40:43], a[36:39], a[196:199], v[40:43]
	buffer_load_dwordx4 v14, s[20:23], s66 offen offset:3072 lds
	v_mfma_f32_16x16x32_bf16 v[40:43], a[40:43], a[200:203], v[40:43]
	s_waitcnt lgkmcnt(0)
	v_exp_f32 v33, v33
	v_mfma_f32_16x16x32_bf16 v[40:43], a[44:47], a[204:207], v[40:43]
	s_add_u32 m0, s64, 0x1000
	v_cvt_pk_bf16_f32 v48, v32, v33
	v_mfma_f32_16x16x32_bf16 v[44:47], a[60:63], a[204:207], -4.0
	s_xor_b32 s66, s87, 0x8000
	v_exp_f32 v34, v34
	v_mfma_f32_16x16x32_bf16 v[44:47], a[56:59], a[200:203], v[44:47]
	buffer_load_dwordx4 v14, s[20:23], s66 offen offset:0 lds
	v_mfma_f32_16x16x32_bf16 v[44:47], a[52:55], a[196:199], v[44:47]
	v_exp_f32 v35, v35
	v_mfma_f32_16x16x32_bf16 v[44:47], a[48:51], a[192:195], v[44:47]
	v_cvt_pk_bf16_f32 v49, v34, v35
	v_smfmac_f32_16x16x64_bf16 a[136:139], a[168:171], v[56:63], v31
	v_mfma_f32_16x16x32_bf16 v[140:143], a[64:67], v[56:59], v[140:143]
	v_exp_f32 v36, v36
	v_mfma_f32_16x16x32_bf16 v[140:143], a[96:99], v[60:63], v[140:143]
	ds_read_b64_tr_b16 a[64:65], v1 offset:16384
	ds_read_b64_tr_b16 a[66:67], v1 offset:20480
	v_mfma_f32_16x16x32_bf16 v[156:159], a[100:103], v[60:63], v[156:159]
	v_exp_f32 v37, v37
	v_mfma_f32_16x16x32_bf16 v[156:159], a[68:71], v[56:59], v[156:159]
	ds_read_b64_tr_b16 a[96:97], v1 offset:24576
	v_cvt_pk_bf16_f32 v50, v36, v37
	v_mfma_f32_16x16x32_bf16 v[172:175], a[72:75], v[56:59], v[172:175]
	v_exp_f32 v38, v38
	v_mfma_f32_16x16x32_bf16 v[172:175], a[104:107], v[60:63], v[172:175]
	ds_read_b64_tr_b16 a[98:99], v1 offset:28672
	ds_read_b64_tr_b16 a[100:101], v2 offset:24576
	v_mfma_f32_16x16x32_bf16 v[188:191], a[108:111], v[60:63], v[188:191]
	v_exp_f32 v39, v39
	v_mfma_f32_16x16x32_bf16 v[188:191], a[76:79], v[56:59], v[188:191]
	ds_read_b64_tr_b16 a[102:103], v2 offset:28672
	v_cvt_pk_bf16_f32 v51, v38, v39
	v_mfma_f32_16x16x32_bf16 v[32:35], a[0:3], a[208:211], -4.0
	v_exp_f32 v40, v40
	v_mfma_f32_16x16x32_bf16 v[32:35], a[4:7], a[212:215], v[32:35]
	ds_read_b64_tr_b16 a[68:69], v2 offset:16384
	ds_read_b64_tr_b16 a[70:71], v2 offset:20480
	v_mfma_f32_16x16x32_bf16 v[32:35], a[8:11], a[216:219], v[32:35]
	v_exp_f32 v41, v41
	v_mfma_f32_16x16x32_bf16 v[32:35], a[12:15], a[220:223], v[32:35]
	ds_read_b64_tr_b16 a[72:73], v3 offset:16384
	v_cvt_pk_bf16_f32 v52, v40, v41
	v_mfma_f32_16x16x32_bf16 v[36:39], a[28:31], a[220:223], -4.0
	v_exp_f32 v42, v42
	v_mfma_f32_16x16x32_bf16 v[36:39], a[24:27], a[216:219], v[36:39]
	ds_read_b64_tr_b16 a[74:75], v3 offset:20480
	ds_read_b64_tr_b16 a[104:105], v3 offset:24576
	v_mfma_f32_16x16x32_bf16 v[36:39], a[20:23], a[212:215], v[36:39]
	v_exp_f32 v43, v43
	v_mfma_f32_16x16x32_bf16 v[36:39], a[16:19], a[208:211], v[36:39]
	ds_read_b64_tr_b16 a[106:107], v3 offset:28672
	v_cvt_pk_bf16_f32 v53, v42, v43
	v_mfma_f32_16x16x32_bf16 v[204:207], a[80:83], v[56:59], v[204:207]
	v_exp_f32 v44, v44
	v_mfma_f32_16x16x32_bf16 v[204:207], a[112:115], v[60:63], v[204:207]
	ds_read_b64_tr_b16 a[108:109], v4 offset:24576
	ds_read_b64_tr_b16 a[110:111], v4 offset:28672
	v_mfma_f32_16x16x32_bf16 v[220:223], a[116:119], v[60:63], v[220:223]
	v_exp_f32 v45, v45
	v_mfma_f32_16x16x32_bf16 v[220:223], a[84:87], v[56:59], v[220:223]
	ds_read_b64_tr_b16 a[76:77], v4 offset:16384
	v_cvt_pk_bf16_f32 v54, v44, v45
	v_mfma_f32_16x16x32_bf16 v[236:239], a[88:91], v[56:59], v[236:239]
	v_exp_f32 v46, v46
	v_mfma_f32_16x16x32_bf16 v[236:239], a[120:123], v[60:63], v[236:239]
	ds_read_b64_tr_b16 a[78:79], v4 offset:20480
	ds_read_b64_tr_b16 a[80:81], v5 offset:16384
	v_mfma_f32_16x16x32_bf16 v[252:255], a[124:127], v[60:63], v[252:255]
	v_exp_f32 v47, v47
	v_mfma_f32_16x16x32_bf16 v[252:255], a[92:95], v[56:59], v[252:255]
	ds_read_b64_tr_b16 a[82:83], v5 offset:20480
	v_cvt_pk_bf16_f32 v55, v46, v47
	v_mfma_f32_16x16x32_bf16 v[40:43], a[32:35], a[208:211], -4.0
	v_exp_f32 v32, v32
	v_mfma_f32_16x16x32_bf16 v[40:43], a[36:39], a[212:215], v[40:43]
	ds_read_b64_tr_b16 a[112:113], v5 offset:24576
	ds_read_b64_tr_b16 a[114:115], v5 offset:28672
	v_mfma_f32_16x16x32_bf16 v[40:43], a[40:43], a[216:219], v[40:43]
	v_exp_f32 v33, v33
	v_mfma_f32_16x16x32_bf16 v[40:43], a[44:47], a[220:223], v[40:43]
	ds_read_b64_tr_b16 a[116:117], v6 offset:24576
	v_cvt_pk_bf16_f32 v56, v32, v33
	v_mfma_f32_16x16x32_bf16 v[44:47], a[60:63], a[220:223], -4.0
	v_exp_f32 v34, v34
	v_mfma_f32_16x16x32_bf16 v[44:47], a[56:59], a[216:219], v[44:47]
	ds_read_b64_tr_b16 a[118:119], v6 offset:28672
	ds_read_b64_tr_b16 a[84:85], v6 offset:16384
	v_mfma_f32_16x16x32_bf16 v[44:47], a[52:55], a[212:215], v[44:47]
	v_exp_f32 v35, v35
	v_mfma_f32_16x16x32_bf16 v[44:47], a[48:51], a[208:211], v[44:47]
	ds_read_b64_tr_b16 a[86:87], v6 offset:20480
	v_cvt_pk_bf16_f32 v57, v34, v35
	v_smfmac_f32_16x16x64_bf16 a[132:135], a[128:131], v[48:55], v31
	s_waitcnt lgkmcnt(7)
	v_mfma_f32_16x16x32_bf16 v[128:131], a[64:67], v[48:51], v[128:131]
	v_exp_f32 v36, v36
	v_mfma_f32_16x16x32_bf16 v[128:131], a[96:99], v[52:55], v[128:131]
	ds_read_b64_tr_b16 a[88:89], v7 offset:16384
	ds_read_b64_tr_b16 a[90:91], v7 offset:20480
	v_mfma_f32_16x16x32_bf16 v[144:147], a[100:103], v[52:55], v[144:147]
	v_exp_f32 v37, v37
	v_mfma_f32_16x16x32_bf16 v[144:147], a[68:71], v[48:51], v[144:147]
	ds_read_b64_tr_b16 a[120:121], v7 offset:24576
	v_cvt_pk_bf16_f32 v58, v36, v37
	v_mfma_f32_16x16x32_bf16 v[160:163], a[72:75], v[48:51], v[160:163]
	v_exp_f32 v38, v38
	v_mfma_f32_16x16x32_bf16 v[160:163], a[104:107], v[52:55], v[160:163]
	ds_read_b64_tr_b16 a[122:123], v7 offset:28672
	ds_read_b64_tr_b16 a[124:125], v8 offset:24576
	v_mfma_f32_16x16x32_bf16 v[176:179], a[108:111], v[52:55], v[176:179]
	v_exp_f32 v39, v39
	v_mfma_f32_16x16x32_bf16 v[176:179], a[76:79], v[48:51], v[176:179]
	ds_read_b64_tr_b16 a[126:127], v8 offset:28672
	v_cvt_pk_bf16_f32 v59, v38, v39
	v_mfma_f32_16x16x32_bf16 v[32:35], a[0:3], a[224:227], -4.0
	v_exp_f32 v40, v40
	v_mfma_f32_16x16x32_bf16 v[32:35], a[4:7], a[228:231], v[32:35]
	ds_read_b64_tr_b16 a[92:93], v8 offset:16384
	ds_read_b64_tr_b16 a[94:95], v8 offset:20480
	v_mfma_f32_16x16x32_bf16 v[32:35], a[8:11], a[232:235], v[32:35]
	v_exp_f32 v41, v41
	v_mfma_f32_16x16x32_bf16 v[32:35], a[12:15], a[236:239], v[32:35]
L_pg23:
	s_cbranch_execz L_touched1
	s_add_u32 m0, s64, 0x1000
	v_cvt_pk_bf16_f32 v60, v40, v41
	v_mfma_f32_16x16x32_bf16 v[36:39], a[28:31], a[236:239], -4.0
	s_xor_b32 s66, s87, 0x9c00
	v_exp_f32 v42, v42
	v_mfma_f32_16x16x32_bf16 v[36:39], a[24:27], a[232:235], v[36:39]
	buffer_load_dwordx4 v14, s[20:23], s66 offen offset:1024 lds
	v_mfma_f32_16x16x32_bf16 v[36:39], a[20:23], a[228:231], v[36:39]
	v_exp_f32 v43, v43
	v_mfma_f32_16x16x32_bf16 v[36:39], a[16:19], a[224:227], v[36:39]
	s_waitcnt lgkmcnt(3)
	v_cvt_pk_bf16_f32 v61, v42, v43
	v_mfma_f32_16x16x32_bf16 v[192:195], a[80:83], v[48:51], v[192:195]
	s_xor_b32 s66, s87, 0xb800
	v_exp_f32 v44, v44
	v_mfma_f32_16x16x32_bf16 v[192:195], a[112:115], v[52:55], v[192:195]
	buffer_load_dwordx4 v14, s[20:23], s66 offen offset:2048 lds
	v_mfma_f32_16x16x32_bf16 v[208:211], a[116:119], v[52:55], v[208:211]
	v_exp_f32 v45, v45
	v_mfma_f32_16x16x32_bf16 v[208:211], a[84:87], v[48:51], v[208:211]
	v_cvt_pk_bf16_f32 v62, v44, v45
	v_mfma_f32_16x16x32_bf16 v[224:227], a[88:91], v[48:51], v[224:227]
	s_xor_b32 s66, s87, 0xd400
	v_exp_f32 v46, v46
	v_mfma_f32_16x16x32_bf16 v[224:227], a[120:123], v[52:55], v[224:227]
	s_waitcnt lgkmcnt(0)
	buffer_load_dwordx4 v14, s[20:23], s66 offen offset:3072 lds
	v_mfma_f32_16x16x32_bf16 v[240:243], a[124:127], v[52:55], v[240:243]
	v_exp_f32 v47, v47
	v_mfma_f32_16x16x32_bf16 v[240:243], a[92:95], v[48:51], v[240:243]
	s_barrier
	v_cvt_pk_bf16_f32 v63, v46, v47
	v_mfma_f32_16x16x32_bf16 v[40:43], a[32:35], a[224:227], -4.0
	v_exp_f32 v32, v32
	v_mfma_f32_16x16x32_bf16 v[40:43], a[36:39], a[228:231], v[40:43]
	v_mfma_f32_16x16x32_bf16 v[40:43], a[40:43], a[232:235], v[40:43]
	v_exp_f32 v33, v33
	v_mfma_f32_16x16x32_bf16 v[40:43], a[44:47], a[236:239], v[40:43]
	v_cvt_pk_bf16_f32 v48, v32, v33
	v_mfma_f32_16x16x32_bf16 v[44:47], a[60:63], a[236:239], -4.0
	v_exp_f32 v34, v34
	v_mfma_f32_16x16x32_bf16 v[44:47], a[56:59], a[232:235], v[44:47]
	v_mfma_f32_16x16x32_bf16 v[44:47], a[52:55], a[228:231], v[44:47]
	v_exp_f32 v35, v35
	v_mfma_f32_16x16x32_bf16 v[44:47], a[48:51], a[224:227], v[44:47]
	v_cvt_pk_bf16_f32 v49, v34, v35
	v_smfmac_f32_16x16x64_bf16 a[132:135], a[168:171], v[56:63], v31
	v_mfma_f32_16x16x32_bf16 v[132:135], a[64:67], v[56:59], v[132:135]
	v_exp_f32 v36, v36
	v_mfma_f32_16x16x32_bf16 v[132:135], a[96:99], v[60:63], v[132:135]
	v_mfma_f32_16x16x32_bf16 v[148:151], a[100:103], v[60:63], v[148:151]
	v_exp_f32 v37, v37
	v_mfma_f32_16x16x32_bf16 v[148:151], a[68:71], v[56:59], v[148:151]
	v_cvt_pk_bf16_f32 v50, v36, v37
	v_mfma_f32_16x16x32_bf16 v[164:167], a[72:75], v[56:59], v[164:167]
	v_exp_f32 v38, v38
	v_mfma_f32_16x16x32_bf16 v[164:167], a[104:107], v[60:63], v[164:167]
	v_mfma_f32_16x16x32_bf16 v[180:183], a[108:111], v[60:63], v[180:183]
	v_exp_f32 v39, v39
	v_mfma_f32_16x16x32_bf16 v[180:183], a[76:79], v[56:59], v[180:183]
	v_cvt_pk_bf16_f32 v51, v38, v39
	v_mfma_f32_16x16x32_bf16 v[32:35], a[0:3], a[240:243], -4.0
	v_exp_f32 v40, v40
	v_mfma_f32_16x16x32_bf16 v[32:35], a[4:7], a[244:247], v[32:35]
	v_mfma_f32_16x16x32_bf16 v[32:35], a[8:11], a[248:251], v[32:35]
	v_exp_f32 v41, v41
	v_mfma_f32_16x16x32_bf16 v[32:35], a[12:15], a[252:255], v[32:35]
	v_cvt_pk_bf16_f32 v52, v40, v41
	v_mfma_f32_16x16x32_bf16 v[36:39], a[28:31], a[252:255], -4.0
	v_exp_f32 v42, v42
	v_mfma_f32_16x16x32_bf16 v[36:39], a[24:27], a[248:251], v[36:39]
	v_mfma_f32_16x16x32_bf16 v[36:39], a[20:23], a[244:247], v[36:39]
	v_exp_f32 v43, v43
	v_mfma_f32_16x16x32_bf16 v[36:39], a[16:19], a[240:243], v[36:39]
	v_cvt_pk_bf16_f32 v53, v42, v43
	v_mfma_f32_16x16x32_bf16 v[196:199], a[80:83], v[56:59], v[196:199]
	v_exp_f32 v44, v44
	v_mfma_f32_16x16x32_bf16 v[196:199], a[112:115], v[60:63], v[196:199]
	ds_read_b64_tr_b16 a[0:1], v26 offset:16384
	ds_read_b64_tr_b16 a[2:3], v26 offset:18432
	v_mfma_f32_16x16x32_bf16 v[212:215], a[116:119], v[60:63], v[212:215]
	v_exp_f32 v45, v45
	v_mfma_f32_16x16x32_bf16 v[212:215], a[84:87], v[56:59], v[212:215]
	ds_read_b64_tr_b16 a[4:5], v26 offset:20480
	v_cvt_pk_bf16_f32 v54, v44, v45
	v_mfma_f32_16x16x32_bf16 v[228:231], a[88:91], v[56:59], v[228:231]
	v_exp_f32 v46, v46
	v_mfma_f32_16x16x32_bf16 v[228:231], a[120:123], v[60:63], v[228:231]
	ds_read_b64_tr_b16 a[6:7], v26 offset:22528
	ds_read_b64_tr_b16 a[8:9], v27 offset:16384
	v_mfma_f32_16x16x32_bf16 v[244:247], a[124:127], v[60:63], v[244:247]
	v_exp_f32 v47, v47
	v_mfma_f32_16x16x32_bf16 v[244:247], a[92:95], v[56:59], v[244:247]
	ds_read_b64_tr_b16 a[10:11], v27 offset:18432
	v_cvt_pk_bf16_f32 v55, v46, v47
	v_mfma_f32_16x16x32_bf16 v[40:43], a[32:35], a[240:243], -4.0
	v_exp_f32 v32, v32
	v_mfma_f32_16x16x32_bf16 v[40:43], a[36:39], a[244:247], v[40:43]
	ds_read_b64_tr_b16 a[12:13], v27 offset:20480
	ds_read_b64_tr_b16 a[14:15], v27 offset:22528
	v_mfma_f32_16x16x32_bf16 v[40:43], a[40:43], a[248:251], v[40:43]
	v_exp_f32 v33, v33
	v_mfma_f32_16x16x32_bf16 v[40:43], a[44:47], a[252:255], v[40:43]
	ds_read_b64_tr_b16 a[16:17], v28 offset:16384
	v_cvt_pk_bf16_f32 v56, v32, v33
	v_mfma_f32_16x16x32_bf16 v[44:47], a[60:63], a[252:255], -4.0
	v_exp_f32 v34, v34
	v_mfma_f32_16x16x32_bf16 v[44:47], a[56:59], a[248:251], v[44:47]
	ds_read_b64_tr_b16 a[18:19], v28 offset:18432
	ds_read_b64_tr_b16 a[20:21], v28 offset:20480
	v_mfma_f32_16x16x32_bf16 v[44:47], a[52:55], a[244:247], v[44:47]
	v_exp_f32 v35, v35
	v_mfma_f32_16x16x32_bf16 v[44:47], a[48:51], a[240:243], v[44:47]
	ds_read_b64_tr_b16 a[22:23], v28 offset:22528
	v_cvt_pk_bf16_f32 v57, v34, v35
	v_smfmac_f32_16x16x64_bf16 a[136:139], a[128:131], v[48:55], v31
	v_mfma_f32_16x16x32_bf16 v[136:139], a[64:67], v[48:51], v[136:139]
	v_exp_f32 v36, v36
	v_mfma_f32_16x16x32_bf16 v[136:139], a[96:99], v[52:55], v[136:139]
	ds_read_b64_tr_b16 a[24:25], v29 offset:16384
	ds_read_b64_tr_b16 a[26:27], v29 offset:18432
	v_mfma_f32_16x16x32_bf16 v[152:155], a[100:103], v[52:55], v[152:155]
	v_exp_f32 v37, v37
	v_mfma_f32_16x16x32_bf16 v[152:155], a[68:71], v[48:51], v[152:155]
	ds_read_b64_tr_b16 a[28:29], v29 offset:20480
	v_cvt_pk_bf16_f32 v58, v36, v37
	v_mfma_f32_16x16x32_bf16 v[168:171], a[72:75], v[48:51], v[168:171]
	v_exp_f32 v38, v38
	v_mfma_f32_16x16x32_bf16 v[168:171], a[104:107], v[52:55], v[168:171]
	ds_read_b64_tr_b16 a[30:31], v29 offset:22528
	ds_read_b64_tr_b16 a[32:33], v26 offset:8192
	v_mfma_f32_16x16x32_bf16 v[184:187], a[108:111], v[52:55], v[184:187]
	v_exp_f32 v39, v39
	v_mfma_f32_16x16x32_bf16 v[184:187], a[76:79], v[48:51], v[184:187]
	ds_read_b64_tr_b16 a[34:35], v26 offset:10240
	v_cvt_pk_bf16_f32 v59, v38, v39
	v_mfma_f32_16x16x32_bf16 v[200:203], a[80:83], v[48:51], v[200:203]
	ds_read_b64_tr_b16 a[36:37], v26 offset:12288
	ds_read_b64_tr_b16 a[38:39], v26 offset:14336
	v_exp_f32 v40, v40
	v_mfma_f32_16x16x32_bf16 v[200:203], a[112:115], v[52:55], v[200:203]
	ds_read_b64_tr_b16 a[40:41], v27 offset:8192
	ds_read_b64_tr_b16 a[42:43], v27 offset:10240
	v_exp_f32 v41, v41
	v_mfma_f32_16x16x32_bf16 v[216:219], a[116:119], v[52:55], v[216:219]
	ds_read_b64_tr_b16 a[44:45], v27 offset:12288
	ds_read_b64_tr_b16 a[46:47], v27 offset:14336
	v_cvt_pk_bf16_f32 v60, v40, v41
	v_exp_f32 v42, v42
	v_mfma_f32_16x16x32_bf16 v[216:219], a[84:87], v[48:51], v[216:219]
	ds_read_b64_tr_b16 a[48:49], v28 offset:8192
	ds_read_b64_tr_b16 a[50:51], v28 offset:10240
	v_exp_f32 v43, v43
	v_mfma_f32_16x16x32_bf16 v[232:235], a[88:91], v[48:51], v[232:235]
	ds_read_b64_tr_b16 a[52:53], v28 offset:12288
	ds_read_b64_tr_b16 a[54:55], v28 offset:14336
	v_cvt_pk_bf16_f32 v61, v42, v43
	v_exp_f32 v44, v44
	v_mfma_f32_16x16x32_bf16 v[232:235], a[120:123], v[52:55], v[232:235]
	ds_read_b64_tr_b16 a[56:57], v29 offset:8192
	ds_read_b64_tr_b16 a[58:59], v29 offset:10240
	v_exp_f32 v45, v45
	v_mfma_f32_16x16x32_bf16 v[248:251], a[124:127], v[52:55], v[248:251]
	ds_read_b64_tr_b16 a[60:61], v29 offset:12288
	ds_read_b64_tr_b16 a[62:63], v29 offset:14336
	v_cvt_pk_bf16_f32 v62, v44, v45
	v_exp_f32 v46, v46
	v_mfma_f32_16x16x32_bf16 v[248:251], a[92:95], v[48:51], v[248:251]
	v_exp_f32 v47, v47
	s_nop 0
	v_cvt_pk_bf16_f32 v63, v46, v47
	v_mfma_f32_16x16x32_bf16 v[140:143], a[64:67], v[56:59], v[140:143]
	s_add_u32 m0, s64, 0x4000
	s_xor_b32 s66, s87, 0x40200
	v_mfma_f32_16x16x32_bf16 v[140:143], a[96:99], v[60:63], v[140:143]
	s_waitcnt lgkmcnt(14)
	buffer_load_dwordx4 v14, s[20:23], s66 offen offset:0 lds
	v_mfma_f32_16x16x32_bf16 v[156:159], a[100:103], v[60:63], v[156:159]
	s_xor_b32 s66, s87, 0x41e00
	v_mfma_f32_16x16x32_bf16 v[156:159], a[68:71], v[56:59], v[156:159]
	buffer_load_dwordx4 v14, s[20:23], s66 offen offset:1024 lds
	v_smfmac_f32_16x16x64_bf16 a[136:139], a[168:171], v[56:63], v31
	v_mfma_f32_16x16x32_bf16 v[172:175], a[72:75], v[56:59], v[172:175]
	s_xor_b32 s66, s87, 0x43a00
	v_mfma_f32_16x16x32_bf16 v[172:175], a[104:107], v[60:63], v[172:175]
	buffer_load_dwordx4 v14, s[20:23], s66 offen offset:2048 lds
	v_mfma_f32_16x16x32_bf16 v[188:191], a[108:111], v[60:63], v[188:191]
	s_xor_b32 s66, s87, 0x45600
	v_mfma_f32_16x16x32_bf16 v[188:191], a[76:79], v[56:59], v[188:191]
	buffer_load_dwordx4 v14, s[20:23], s66 offen offset:3072 lds
	v_mfma_f32_16x16x32_bf16 v[204:207], a[80:83], v[56:59], v[204:207]
	s_add_u32 m0, s64, 0x5000
	s_xor_b32 s66, s87, 0x48200
	v_mfma_f32_16x16x32_bf16 v[204:207], a[112:115], v[60:63], v[204:207]
	buffer_load_dwordx4 v14, s[20:23], s66 offen offset:0 lds
	v_mfma_f32_16x16x32_bf16 v[220:223], a[116:119], v[60:63], v[220:223]
	s_xor_b32 s66, s87, 0x49e00
	v_mfma_f32_16x16x32_bf16 v[220:223], a[84:87], v[56:59], v[220:223]
	buffer_load_dwordx4 v14, s[20:23], s66 offen offset:1024 lds
	v_mfma_f32_16x16x32_bf16 v[236:239], a[88:91], v[56:59], v[236:239]
	s_xor_b32 s66, s87, 0x4ba00
	v_mfma_f32_16x16x32_bf16 v[236:239], a[120:123], v[60:63], v[236:239]
	buffer_load_dwordx4 v14, s[20:23], s66 offen offset:2048 lds
	v_mfma_f32_16x16x32_bf16 v[252:255], a[124:127], v[60:63], v[252:255]
	s_xor_b32 s66, s87, 0x4d600
	v_mfma_f32_16x16x32_bf16 v[252:255], a[92:95], v[56:59], v[252:255]
	buffer_load_dwordx4 v14, s[20:23], s66 offen offset:3072 lds
L_oepi:
	v_accvgpr_read_b32 v32, a132
	v_accvgpr_read_b32 v33, a133
	v_accvgpr_read_b32 v34, a134
	v_accvgpr_read_b32 v35, a135
	v_accvgpr_read_b32 v36, a136
	v_accvgpr_read_b32 v37, a137
	v_accvgpr_read_b32 v38, a138
	v_accvgpr_read_b32 v39, a139
	v_add_f32 v32, v32, v33
	v_add_f32 v34, v34, v35
	v_add_f32 v36, v36, v37
	v_add_f32 v38, v38, v39
	v_subrev_u32 v40, 0x2b800000, v32
	v_subrev_u32 v41, 0x2b800000, v34
	v_subrev_u32 v42, 0x2b800000, v36
	v_subrev_u32 v43, 0x2b800000, v38
	v_max3_u32 v40, v40, v41, v42
	v_max_u32 v40, v40, v43
	v_cmp_lt_u32 vcc, 0x28000000, v40
	v_and_b32 v41, 3, v0
	v_lshlrev_b32 v41, 12, v41
	v_lshl_add_u32 v41, s62, 2, v41
	s_or_b32 s72, vcc_lo, vcc_hi
	v_mov_b32 v40, s72
	ds_write_b32 v41, v40 offset:16384
	v_rcp_f32 v32, v32
	v_rcp_f32 v34, v34
	v_rcp_f32 v36, v36
	v_rcp_f32 v38, v38
	s_lshl_b32 s72, s62, 17
	s_xor_b32 s72, s72, s87
	s_lshr_b32 s72, s72, 5
	v_add_u32 v48, s72, v13
	v_mov_b32 v41, s72
	s_waitcnt lgkmcnt(0)
	s_barrier
	ds_read_b128 v[44:47], v41 offset:16384
	v_pk_mul_f32 v[132:133], v[132:133], v[34:35] op_sel_hi:[1,0]
	v_pk_mul_f32 v[134:135], v[134:135], v[34:35] op_sel_hi:[1,0]
	v_pk_mul_f32 v[148:149], v[148:149], v[34:35] op_sel_hi:[1,0]
	v_pk_mul_f32 v[150:151], v[150:151], v[34:35] op_sel_hi:[1,0]
	v_cvt_pk_bf16_f32 v151, v150, v151
	v_cvt_pk_bf16_f32 v150, v148, v149
	v_cvt_pk_bf16_f32 v148, v132, v133
	v_cvt_pk_bf16_f32 v149, v134, v135
	v_pk_mul_f32 v[164:165], v[164:165], v[34:35] op_sel_hi:[1,0]
	v_pk_mul_f32 v[166:167], v[166:167], v[34:35] op_sel_hi:[1,0]
	v_pk_mul_f32 v[180:181], v[180:181], v[34:35] op_sel_hi:[1,0]
	v_pk_mul_f32 v[182:183], v[182:183], v[34:35] op_sel_hi:[1,0]
	v_cvt_pk_bf16_f32 v183, v182, v183
	v_cvt_pk_bf16_f32 v182, v180, v181
	v_cvt_pk_bf16_f32 v180, v164, v165
	v_cvt_pk_bf16_f32 v181, v166, v167
	s_waitcnt lgkmcnt(0)
	v_or3_b32 v40, v44, v45, v46
	v_or_b32 v40, v40, v47
	v_cmp_ne_u32 vcc, 0, v40
	s_cbranch_vccnz L_slow
L_ofine:
	ds_write_b128 v48, v[148:151] offset:16384
	v_lshrrev_b32 v1, 2, v0
	v_bfe_u32 v26, v0, 3, 2
	v_lshlrev_b32 v26, 5, v26
	v_lshl_or_b32 v1, v1, 7, v26
	v_and_b32 v26, 3, v0
	v_lshl_or_b32 v1, v26, 3, v1
	v_add_u32 v1, s64, v1
	v_xor_b32 v2, 0x20, v1
	v_xor_b32 v3, 0x40, v1
	v_xor_b32 v4, 0x60, v1
	s_sub_u32 s72, s72, s64
	v_add_u32 v26, s72, v1
	v_add_u32 v27, s72, v2
	v_add_u32 v28, s72, v3
	v_add_u32 v29, s72, v4
	ds_write_b128 v48, v[180:183] offset:17408
	s_add_u32 m0, s64, 0x2000
	s_xor_b32 s66, s87, 0x200
	buffer_load_dwordx4 v14, s[20:23], s66 offen offset:0 lds
	s_nop 0
	v_pk_mul_f32 v[196:197], v[196:197], v[34:35] op_sel_hi:[1,0]
	v_pk_mul_f32 v[198:199], v[198:199], v[34:35] op_sel_hi:[1,0]
	v_pk_mul_f32 v[212:213], v[212:213], v[34:35] op_sel_hi:[1,0]
	v_pk_mul_f32 v[214:215], v[214:215], v[34:35] op_sel_hi:[1,0]
	v_cvt_pk_bf16_f32 v215, v214, v215
	v_cvt_pk_bf16_f32 v214, v212, v213
	v_cvt_pk_bf16_f32 v212, v196, v197
	v_cvt_pk_bf16_f32 v213, v198, v199
	ds_write_b128 v48, v[212:215] offset:18432
	s_xor_b32 s66, s87, 0x1e00
	buffer_load_dwordx4 v14, s[20:23], s66 offen offset:1024 lds
	v_pk_mul_f32 v[228:229], v[228:229], v[34:35] op_sel_hi:[1,0]
	v_pk_mul_f32 v[230:231], v[230:231], v[34:35] op_sel_hi:[1,0]
	v_pk_mul_f32 v[244:245], v[244:245], v[34:35] op_sel_hi:[1,0]
	v_pk_mul_f32 v[246:247], v[246:247], v[34:35] op_sel_hi:[1,0]
	v_cvt_pk_bf16_f32 v247, v246, v247
	v_cvt_pk_bf16_f32 v246, v244, v245
	v_cvt_pk_bf16_f32 v244, v228, v229
	v_cvt_pk_bf16_f32 v245, v230, v231
	ds_write_b128 v48, v[244:247] offset:19456
	s_xor_b32 s66, s87, 0x3a00
	buffer_load_dwordx4 v14, s[20:23], s66 offen offset:2048 lds
	v_pk_mul_f32 v[140:141], v[140:141], v[38:39] op_sel_hi:[1,0]
	v_pk_mul_f32 v[142:143], v[142:143], v[38:39] op_sel_hi:[1,0]
	v_pk_mul_f32 v[156:157], v[156:157], v[38:39] op_sel_hi:[1,0]
	v_pk_mul_f32 v[158:159], v[158:159], v[38:39] op_sel_hi:[1,0]
	v_cvt_pk_bf16_f32 v159, v158, v159
	v_cvt_pk_bf16_f32 v158, v156, v157
	v_cvt_pk_bf16_f32 v156, v140, v141
	v_cvt_pk_bf16_f32 v157, v142, v143
	ds_write_b128 v48, v[156:159] offset:49152
	s_xor_b32 s66, s87, 0x5600
	buffer_load_dwordx4 v14, s[20:23], s66 offen offset:3072 lds
	v_pk_mul_f32 v[172:173], v[172:173], v[38:39] op_sel_hi:[1,0]
	v_pk_mul_f32 v[174:175], v[174:175], v[38:39] op_sel_hi:[1,0]
	v_pk_mul_f32 v[188:189], v[188:189], v[38:39] op_sel_hi:[1,0]
	v_pk_mul_f32 v[190:191], v[190:191], v[38:39] op_sel_hi:[1,0]
	v_cvt_pk_bf16_f32 v191, v190, v191
	v_cvt_pk_bf16_f32 v190, v188, v189
	v_cvt_pk_bf16_f32 v188, v172, v173
	v_cvt_pk_bf16_f32 v189, v174, v175
	ds_write_b128 v48, v[188:191] offset:50176
	s_add_u32 m0, s64, 0x3000
	s_xor_b32 s66, s87, 0x8200
	buffer_load_dwordx4 v14, s[20:23], s66 offen offset:0 lds
	v_pk_mul_f32 v[204:205], v[204:205], v[38:39] op_sel_hi:[1,0]
	v_pk_mul_f32 v[206:207], v[206:207], v[38:39] op_sel_hi:[1,0]
	v_pk_mul_f32 v[220:221], v[220:221], v[38:39] op_sel_hi:[1,0]
	v_pk_mul_f32 v[222:223], v[222:223], v[38:39] op_sel_hi:[1,0]
	v_cvt_pk_bf16_f32 v223, v222, v223
	v_cvt_pk_bf16_f32 v222, v220, v221
	v_cvt_pk_bf16_f32 v220, v204, v205
	v_cvt_pk_bf16_f32 v221, v206, v207
	ds_write_b128 v48, v[220:223] offset:51200
	s_xor_b32 s66, s87, 0x9e00
	buffer_load_dwordx4 v14, s[20:23], s66 offen offset:1024 lds
	v_pk_mul_f32 v[236:237], v[236:237], v[38:39] op_sel_hi:[1,0]
	v_pk_mul_f32 v[238:239], v[238:239], v[38:39] op_sel_hi:[1,0]
	v_pk_mul_f32 v[252:253], v[252:253], v[38:39] op_sel_hi:[1,0]
	v_pk_mul_f32 v[254:255], v[254:255], v[38:39] op_sel_hi:[1,0]
	v_cvt_pk_bf16_f32 v255, v254, v255
	v_cvt_pk_bf16_f32 v254, v252, v253
	v_cvt_pk_bf16_f32 v252, v236, v237
	v_cvt_pk_bf16_f32 v253, v238, v239
	ds_write_b128 v48, v[252:255] offset:52224
	s_xor_b32 s66, s87, 0xba00
	buffer_load_dwordx4 v14, s[20:23], s66 offen offset:2048 lds
	v_pk_mul_f32 v[128:129], v[128:129], v[32:33] op_sel_hi:[1,0]
	v_pk_mul_f32 v[130:131], v[130:131], v[32:33] op_sel_hi:[1,0]
	v_pk_mul_f32 v[144:145], v[144:145], v[32:33] op_sel_hi:[1,0]
	v_pk_mul_f32 v[146:147], v[146:147], v[32:33] op_sel_hi:[1,0]
	v_cvt_pk_bf16_f32 v147, v146, v147
	v_cvt_pk_bf16_f32 v146, v144, v145
	v_cvt_pk_bf16_f32 v144, v128, v129
	v_cvt_pk_bf16_f32 v145, v130, v131
	ds_write_b128 v48, v[144:147] offset:0
	s_xor_b32 s66, s87, 0xd600
	buffer_load_dwordx4 v14, s[20:23], s66 offen offset:3072 lds
	v_pk_mul_f32 v[160:161], v[160:161], v[32:33] op_sel_hi:[1,0]
	v_pk_mul_f32 v[162:163], v[162:163], v[32:33] op_sel_hi:[1,0]
	v_pk_mul_f32 v[176:177], v[176:177], v[32:33] op_sel_hi:[1,0]
	v_pk_mul_f32 v[178:179], v[178:179], v[32:33] op_sel_hi:[1,0]
	v_cvt_pk_bf16_f32 v179, v178, v179
	v_cvt_pk_bf16_f32 v178, v176, v177
	v_cvt_pk_bf16_f32 v176, v160, v161
	v_cvt_pk_bf16_f32 v177, v162, v163
	ds_write_b128 v48, v[176:179] offset:1024
	v_pk_mul_f32 v[192:193], v[192:193], v[32:33] op_sel_hi:[1,0]
	v_pk_mul_f32 v[194:195], v[194:195], v[32:33] op_sel_hi:[1,0]
	v_pk_mul_f32 v[208:209], v[208:209], v[32:33] op_sel_hi:[1,0]
	v_pk_mul_f32 v[210:211], v[210:211], v[32:33] op_sel_hi:[1,0]
	v_cvt_pk_bf16_f32 v211, v210, v211
	v_cvt_pk_bf16_f32 v210, v208, v209
	v_cvt_pk_bf16_f32 v208, v192, v193
	v_cvt_pk_bf16_f32 v209, v194, v195
	ds_write_b128 v48, v[208:211] offset:2048
	v_pk_mul_f32 v[224:225], v[224:225], v[32:33] op_sel_hi:[1,0]
	v_pk_mul_f32 v[226:227], v[226:227], v[32:33] op_sel_hi:[1,0]
	v_pk_mul_f32 v[240:241], v[240:241], v[32:33] op_sel_hi:[1,0]
	v_pk_mul_f32 v[242:243], v[242:243], v[32:33] op_sel_hi:[1,0]
	v_cvt_pk_bf16_f32 v243, v242, v243
	v_cvt_pk_bf16_f32 v242, v240, v241
	v_cvt_pk_bf16_f32 v240, v224, v225
	v_cvt_pk_bf16_f32 v241, v226, v227
	ds_write_b128 v48, v[240:243] offset:3072
	v_pk_mul_f32 v[136:137], v[136:137], v[36:37] op_sel_hi:[1,0]
	v_pk_mul_f32 v[138:139], v[138:139], v[36:37] op_sel_hi:[1,0]
	v_pk_mul_f32 v[152:153], v[152:153], v[36:37] op_sel_hi:[1,0]
	v_pk_mul_f32 v[154:155], v[154:155], v[36:37] op_sel_hi:[1,0]
	v_cvt_pk_bf16_f32 v155, v154, v155
	v_cvt_pk_bf16_f32 v154, v152, v153
	v_cvt_pk_bf16_f32 v152, v136, v137
	v_cvt_pk_bf16_f32 v153, v138, v139
	ds_write_b128 v48, v[152:155] offset:32768
	v_pk_mul_f32 v[168:169], v[168:169], v[36:37] op_sel_hi:[1,0]
	v_pk_mul_f32 v[170:171], v[170:171], v[36:37] op_sel_hi:[1,0]
	v_pk_mul_f32 v[184:185], v[184:185], v[36:37] op_sel_hi:[1,0]
	v_pk_mul_f32 v[186:187], v[186:187], v[36:37] op_sel_hi:[1,0]
	v_cvt_pk_bf16_f32 v187, v186, v187
	v_cvt_pk_bf16_f32 v186, v184, v185
	v_cvt_pk_bf16_f32 v184, v168, v169
	v_cvt_pk_bf16_f32 v185, v170, v171
	ds_write_b128 v48, v[184:187] offset:33792
	v_pk_mul_f32 v[200:201], v[200:201], v[36:37] op_sel_hi:[1,0]
	v_pk_mul_f32 v[202:203], v[202:203], v[36:37] op_sel_hi:[1,0]
	v_pk_mul_f32 v[216:217], v[216:217], v[36:37] op_sel_hi:[1,0]
	v_pk_mul_f32 v[218:219], v[218:219], v[36:37] op_sel_hi:[1,0]
	v_cvt_pk_bf16_f32 v219, v218, v219
	v_cvt_pk_bf16_f32 v218, v216, v217
	v_cvt_pk_bf16_f32 v216, v200, v201
	v_cvt_pk_bf16_f32 v217, v202, v203
	ds_write_b128 v48, v[216:219] offset:34816
	v_pk_mul_f32 v[232:233], v[232:233], v[36:37] op_sel_hi:[1,0]
	v_pk_mul_f32 v[234:235], v[234:235], v[36:37] op_sel_hi:[1,0]
	v_pk_mul_f32 v[248:249], v[248:249], v[36:37] op_sel_hi:[1,0]
	v_pk_mul_f32 v[250:251], v[250:251], v[36:37] op_sel_hi:[1,0]
	v_cvt_pk_bf16_f32 v251, v250, v251
	v_cvt_pk_bf16_f32 v250, v248, v249
	v_cvt_pk_bf16_f32 v248, v232, v233
	v_cvt_pk_bf16_f32 v249, v234, v235
	ds_write_b128 v48, v[248:251] offset:35840
	s_waitcnt vmcnt(12)
	ds_read_b64_tr_b16 a[224:225], v1 offset:16384
	ds_read_b64_tr_b16 a[226:227], v1 offset:18432
	s_waitcnt vmcnt(8)
	ds_read_b64_tr_b16 a[228:229], v1 offset:20480
	ds_read_b64_tr_b16 a[230:231], v1 offset:22528
	ds_read_b64_tr_b16 a[232:233], v2 offset:16384
	ds_read_b64_tr_b16 a[234:235], v2 offset:18432
	ds_read_b64_tr_b16 a[236:237], v2 offset:20480
	ds_read_b64_tr_b16 a[238:239], v2 offset:22528
	ds_read_b64_tr_b16 a[240:241], v3 offset:16384
	ds_read_b64_tr_b16 a[242:243], v3 offset:18432
	ds_read_b64_tr_b16 a[244:245], v3 offset:20480
	ds_read_b64_tr_b16 a[246:247], v3 offset:22528
	ds_read_b64_tr_b16 a[248:249], v4 offset:16384
	ds_read_b64_tr_b16 a[250:251], v4 offset:18432
	ds_read_b64_tr_b16 a[252:253], v4 offset:20480
	ds_read_b64_tr_b16 a[254:255], v4 offset:22528
	ds_read_b64_tr_b16 v[32:33], v1 offset:0
	ds_read_b64_tr_b16 v[34:35], v1 offset:2048
	ds_read_b64_tr_b16 v[36:37], v1 offset:4096
	ds_read_b64_tr_b16 v[38:39], v1 offset:6144
	ds_read_b64_tr_b16 v[40:41], v2 offset:0
	ds_read_b64_tr_b16 v[42:43], v2 offset:2048
	ds_read_b64_tr_b16 v[44:45], v2 offset:4096
	ds_read_b64_tr_b16 v[46:47], v2 offset:6144
	s_waitcnt lgkmcnt(8)
	s_barrier
	ds_read_b128 a[64:67], v13 offset:0
	ds_read_b128 a[80:83], v13 offset:1024
	ds_read_b128 a[84:87], v13 offset:17408
	ds_read_b128 a[68:71], v13 offset:16384
	ds_read_b128 a[72:75], v13 offset:32768
	ds_read_b128 a[88:91], v13 offset:33792
	ds_read_b128 a[92:95], v13 offset:50176
	ds_read_b128 a[76:79], v13 offset:49152
	s_waitcnt lgkmcnt(7)
	v_mfma_f32_16x16x32_bf16 v[128:131], v[32:35], a[64:67], 0
	s_add_u32 m0, s64, 0x4000
	s_xor_b32 s66, s87, 0x10000
	s_lshl_b32 s69, s62, 1
	ds_read_b64_tr_b16 v[48:49], v3 offset:0
	ds_read_b128 a[96:99], v13 offset:2048
	s_waitcnt lgkmcnt(8)
	v_mfma_f32_16x16x32_bf16 v[128:131], v[36:39], a[80:83], v[128:131]
	s_waitcnt lgkmcnt(7)
	buffer_load_dwordx4 v14, s[20:23], s66 offen offset:0 lds
	v_mfma_f32_16x16x32_bf16 v[132:135], v[36:39], a[84:87], 0
	s_waitcnt lgkmcnt(6)
	s_xor_b32 s66, s87, 0x11c00
	s_sub_u32 s69, s61, s69
	ds_read_b64_tr_b16 v[50:51], v3 offset:2048
	v_mfma_f32_16x16x32_bf16 v[132:135], v[32:35], a[68:71], v[132:135]
	s_waitcnt lgkmcnt(6)
	buffer_load_dwordx4 v14, s[20:23], s66 offen offset:1024 lds
	v_mfma_f32_16x16x32_bf16 v[136:139], v[32:35], a[72:75], 0
	s_waitcnt lgkmcnt(5)
	s_xor_b32 s66, s87, 0x13800
	s_lshr_b32 s70, s61, 1
	ds_read_b64_tr_b16 v[52:53], v3 offset:4096
	v_mfma_f32_16x16x32_bf16 v[136:139], v[36:39], a[88:91], v[136:139]
	s_waitcnt lgkmcnt(5)
	buffer_load_dwordx4 v14, s[20:23], s66 offen offset:2048 lds
	v_mfma_f32_16x16x32_bf16 v[140:143], v[36:39], a[92:95], 0
	s_xor_b32 s66, s87, 0x15400
	s_mul_i32 s70, s70, 24576
	ds_read_b64_tr_b16 v[54:55], v3 offset:6144
	ds_read_b128 a[112:115], v13 offset:3072
	s_waitcnt lgkmcnt(6)
	v_mfma_f32_16x16x32_bf16 v[140:143], v[32:35], a[76:79], v[140:143]
	buffer_load_dwordx4 v14, s[20:23], s66 offen offset:3072 lds
	v_mfma_f32_16x16x32_bf16 v[156:159], v[40:43], a[76:79], 0
	s_add_u32 m0, s64, 0x5000
	s_xor_b32 s66, s87, 0x18000
	s_add_u32 s70, s70, s65
	ds_read_b64_tr_b16 v[56:57], v4 offset:0
	v_mfma_f32_16x16x32_bf16 v[156:159], v[44:47], a[92:95], v[156:159]
	buffer_load_dwordx4 v14, s[20:23], s66 offen offset:0 lds
	v_mfma_f32_16x16x32_bf16 v[152:155], v[44:47], a[88:91], 0
	s_xor_b32 s66, s87, 0x19c00
	s_add_u32 s70, s70, 65536
	ds_read_b64_tr_b16 v[58:59], v4 offset:2048
	v_mfma_f32_16x16x32_bf16 v[152:155], v[40:43], a[72:75], v[152:155]
	buffer_load_dwordx4 v14, s[20:23], s66 offen offset:1024 lds
	v_mfma_f32_16x16x32_bf16 v[148:151], v[40:43], a[68:71], 0
	s_xor_b32 s66, s87, 0x1b800
	ds_read_b64_tr_b16 v[60:61], v4 offset:4096
	ds_read_b128 a[100:103], v13 offset:18432
	v_mfma_f32_16x16x32_bf16 v[148:151], v[44:47], a[84:87], v[148:151]
	buffer_load_dwordx4 v14, s[20:23], s66 offen offset:2048 lds
	v_mfma_f32_16x16x32_bf16 v[144:147], v[44:47], a[80:83], 0
	s_xor_b32 s66, s87, 0x1d400
	ds_read_b64_tr_b16 v[62:63], v4 offset:6144
	v_lshrrev_b32 v10, 4, v0
	v_mfma_f32_16x16x32_bf16 v[144:147], v[40:43], a[64:67], v[144:147]
	s_waitcnt lgkmcnt(7)
	buffer_load_dwordx4 v14, s[20:23], s66 offen offset:3072 lds
	v_mfma_f32_16x16x32_bf16 v[160:163], v[48:51], a[64:67], 0
	s_waitcnt lgkmcnt(5)
	s_lshl_b32 s67, 1, s61
	v_bfe_u32 v9, v0, 2, 2
	v_and_b32 v11, 1, v0
	v_mfma_f32_16x16x32_bf16 v[160:163], v[52:55], a[80:83], v[160:163]
	s_add_u32 s68, s89, 0x1000000
	v_lshlrev_b32 v11, 4, v11
	v_mov_b32 v12, 0x3f80
	v_mfma_f32_16x16x32_bf16 v[164:167], v[52:55], a[84:87], 0
	ds_read_b128 a[116:119], v13 offset:19456
	v_lshlrev_b32 v11, v11, v12
	v_mfma_f32_16x16x32_bf16 v[164:167], v[48:51], a[68:71], v[164:167]
	s_waitcnt vmcnt(12)
	ds_read_b64_tr_b16 v[32:33], v1 offset:8192
	v_cmp_eq_u32 vcc, v9, v10
	v_mfma_f32_16x16x32_bf16 v[168:171], v[48:51], a[72:75], 0
	ds_read_b64_tr_b16 v[34:35], v1 offset:10240
	v_mov_b32 v26, 0
	v_mfma_f32_16x16x32_bf16 v[168:171], v[52:55], a[88:91], v[168:171]
	s_waitcnt vmcnt(8)
	ds_read_b64_tr_b16 v[36:37], v1 offset:12288
	v_mov_b32 v27, 0
	v_mfma_f32_16x16x32_bf16 v[172:175], v[52:55], a[92:95], 0
	s_add_u32 m0, s64, 0x0
	ds_read_b64_tr_b16 v[38:39], v1 offset:14336
	v_cndmask_b32 v11, 0, v11, vcc
	v_mfma_f32_16x16x32_bf16 v[172:175], v[48:51], a[76:79], v[172:175]
	s_waitcnt lgkmcnt(6)
	v_and_b32 v9, 2, v0
	v_cmp_eq_u32 vcc, 0, v9
	v_mfma_f32_16x16x32_bf16 v[188:191], v[56:59], a[76:79], 0
	s_waitcnt lgkmcnt(5)
	s_xor_b32 s66, s87, 0x10200
	ds_read_b128 a[104:107], v13 offset:34816
	v_mov_b32 v30, 0
	v_mfma_f32_16x16x32_bf16 v[188:191], v[60:63], a[92:95], v[188:191]
	buffer_load_dwordx4 v14, s[20:23], s66 offen offset:0 lds
	v_mfma_f32_16x16x32_bf16 v[184:187], v[60:63], a[88:91], 0
	ds_read_b64_tr_b16 v[40:41], v2 offset:8192
	v_mov_b32 v31, 0
	v_mfma_f32_16x16x32_bf16 v[184:187], v[56:59], a[72:75], v[184:187]
	ds_read_b64_tr_b16 v[42:43], v2 offset:10240
	v_cndmask_b32 v28, 0, v11, vcc
	v_mfma_f32_16x16x32_bf16 v[180:183], v[56:59], a[68:71], 0
	s_xor_b32 s66, s87, 0x11e00
	ds_read_b64_tr_b16 v[44:45], v2 offset:12288
	v_sub_u32 v29, v11, v28
	v_mfma_f32_16x16x32_bf16 v[180:183], v[60:63], a[84:87], v[180:183]
L_pg24:
	s_cbranch_execz L_touched1
	buffer_load_dwordx4 v14, s[20:23], s66 offen offset:1024 lds
	v_mfma_f32_16x16x32_bf16 v[176:179], v[60:63], a[80:83], 0
	ds_read_b64_tr_b16 v[46:47], v2 offset:14336
	ds_read_b128 a[120:123], v13 offset:35840
	v_mfma_f32_16x16x32_bf16 v[176:179], v[56:59], a[64:67], v[176:179]
	s_waitcnt lgkmcnt(7)
	v_lshl_add_u32 v16, v10, 3, v17
	v_mov_b32 v9, 0x40000000
	v_mfma_f32_16x16x32_bf16 v[192:195], v[32:35], a[64:67], 0
	s_waitcnt lgkmcnt(6)
	s_xor_b32 s66, s87, 0x13a00
	v_mov_b32 v10, s69
	v_cmp_eq_u32 vcc, 0, v10
	v_mfma_f32_16x16x32_bf16 v[192:195], v[36:39], a[80:83], v[192:195]
	buffer_load_dwordx4 v14, s[20:23], s66 offen offset:2048 lds
	v_mfma_f32_16x16x32_bf16 v[196:199], v[36:39], a[84:87], 0
	ds_read_b64_tr_b16 v[48:49], v3 offset:8192
	v_add_u32 v20, s64, v13
	v_mfma_f32_16x16x32_bf16 v[196:199], v[32:35], a[68:71], v[196:199]
	ds_read_b64_tr_b16 v[50:51], v3 offset:10240
	v_add_u32 v21, s70, v13
	v_mfma_f32_16x16x32_bf16 v[200:203], v[32:35], a[72:75], 0
	s_xor_b32 s66, s87, 0x15600
	ds_read_b64_tr_b16 v[52:53], v3 offset:12288
	ds_read_b128 a[108:111], v13 offset:51200
	v_mfma_f32_16x16x32_bf16 v[200:203], v[36:39], a[88:91], v[200:203]
	buffer_load_dwordx4 v14, s[20:23], s66 offen offset:3072 lds
	v_mfma_f32_16x16x32_bf16 v[204:207], v[36:39], a[92:95], 0
	s_add_u32 m0, s64, 0x1000
	ds_read_b64_tr_b16 v[54:55], v3 offset:14336
	v_cndmask_b32 v18, v13, v9, vcc
	v_mfma_f32_16x16x32_bf16 v[204:207], v[32:35], a[76:79], v[204:207]
	s_waitcnt lgkmcnt(7)
	v_cmp_eq_u32 vcc, 1, v10
	v_and_b32 v11, 8, v0
	v_mfma_f32_16x16x32_bf16 v[220:223], v[40:43], a[76:79], 0
	s_waitcnt lgkmcnt(5)
	s_xor_b32 s66, s87, 0x18200
	v_lshl_add_u32 v24, v11, 2, v24
	v_add_u32 v24, 32, v24
	v_mfma_f32_16x16x32_bf16 v[220:223], v[44:47], a[92:95], v[220:223]
	buffer_load_dwordx4 v14, s[20:23], s66 offen offset:0 lds
	v_mfma_f32_16x16x32_bf16 v[216:219], v[44:47], a[88:91], 0
	ds_read_b64_tr_b16 v[56:57], v4 offset:8192
	ds_read_b128 a[124:127], v13 offset:52224
	v_mfma_f32_16x16x32_bf16 v[216:219], v[40:43], a[72:75], v[216:219]
	ds_read_b64_tr_b16 v[58:59], v4 offset:10240
	v_cndmask_b32 v19, v13, v9, vcc
	v_mfma_f32_16x16x32_bf16 v[212:215], v[40:43], a[68:71], 0
	s_xor_b32 s66, s87, 0x19e00
	ds_read_b64_tr_b16 v[60:61], v4 offset:12288
	v_mfma_f32_16x16x32_bf16 v[212:215], v[44:47], a[84:87], v[212:215]
	buffer_load_dwordx4 v14, s[20:23], s66 offen offset:1024 lds
	v_mfma_f32_16x16x32_bf16 v[208:211], v[44:47], a[80:83], 0
	ds_read_b64_tr_b16 v[62:63], v4 offset:14336
	v_mfma_f32_16x16x32_bf16 v[208:211], v[40:43], a[64:67], v[208:211]
	s_waitcnt lgkmcnt(6)
	v_mfma_f32_16x16x32_bf16 v[224:227], v[48:51], a[64:67], 0
	s_waitcnt lgkmcnt(5)
	s_xor_b32 s66, s87, 0x1ba00
	v_mfma_f32_16x16x32_bf16 v[224:227], v[52:55], a[80:83], v[224:227]
	buffer_load_dwordx4 v14, s[20:23], s66 offen offset:2048 lds
	v_mfma_f32_16x16x32_bf16 v[228:231], v[52:55], a[84:87], 0
	s_waitcnt vmcnt(11)
	ds_read_b64_tr_b16 v[32:33], v1 offset:16384
	v_mfma_f32_16x16x32_bf16 v[228:231], v[48:51], a[68:71], v[228:231]
	ds_read_b64_tr_b16 v[34:35], v1 offset:18432
	v_mfma_f32_16x16x32_bf16 v[232:235], v[48:51], a[72:75], 0
	s_waitcnt vmcnt(7)
	s_xor_b32 s66, s87, 0x1d600
	ds_read_b64_tr_b16 v[36:37], v1 offset:20480
	v_mfma_f32_16x16x32_bf16 v[232:235], v[52:55], a[88:91], v[232:235]
	buffer_load_dwordx4 v14, s[20:23], s66 offen offset:3072 lds
	v_mfma_f32_16x16x32_bf16 v[236:239], v[52:55], a[92:95], 0
	s_add_u32 m0, s64, 0x2000
	ds_read_b64_tr_b16 v[38:39], v1 offset:22528
	v_mfma_f32_16x16x32_bf16 v[236:239], v[48:51], a[76:79], v[236:239]
	s_waitcnt lgkmcnt(5)
	v_mfma_f32_16x16x32_bf16 v[252:255], v[56:59], a[76:79], 0
	s_waitcnt lgkmcnt(4)
	s_xor_b32 s66, s87, 0x20000
	v_mfma_f32_16x16x32_bf16 v[252:255], v[60:63], a[92:95], v[252:255]
	buffer_load_dwordx4 v14, s[20:23], s66 offen offset:0 lds
	v_mfma_f32_16x16x32_bf16 v[248:251], v[60:63], a[88:91], 0
	ds_read_b64_tr_b16 v[40:41], v2 offset:16384
	v_mfma_f32_16x16x32_bf16 v[248:251], v[56:59], a[72:75], v[248:251]
	ds_read_b64_tr_b16 v[42:43], v2 offset:18432
	v_mfma_f32_16x16x32_bf16 v[244:247], v[56:59], a[68:71], 0
	s_xor_b32 s66, s87, 0x21c00
	ds_read_b64_tr_b16 v[44:45], v2 offset:20480
	v_mfma_f32_16x16x32_bf16 v[244:247], v[60:63], a[84:87], v[244:247]
	buffer_load_dwordx4 v14, s[20:23], s66 offen offset:1024 lds
	v_mfma_f32_16x16x32_bf16 v[240:243], v[60:63], a[80:83], 0
	ds_read_b64_tr_b16 v[46:47], v2 offset:22528
	v_mfma_f32_16x16x32_bf16 v[240:243], v[56:59], a[64:67], v[240:243]
	s_waitcnt lgkmcnt(5)
	v_mfma_f32_16x16x32_bf16 v[128:131], v[32:35], a[96:99], v[128:131]
	s_waitcnt lgkmcnt(4)
	s_xor_b32 s66, s87, 0x23800
	ds_read_b128 a[64:67], v13 offset:4096
	v_mfma_f32_16x16x32_bf16 v[128:131], v[36:39], a[112:115], v[128:131]
	buffer_load_dwordx4 v14, s[20:23], s66 offen offset:2048 lds
	v_mfma_f32_16x16x32_bf16 v[132:135], v[36:39], a[116:119], v[132:135]
	ds_read_b64_tr_b16 v[48:49], v3 offset:16384
	v_mfma_f32_16x16x32_bf16 v[132:135], v[32:35], a[100:103], v[132:135]
	ds_read_b64_tr_b16 v[50:51], v3 offset:18432
	v_mfma_f32_16x16x32_bf16 v[136:139], v[32:35], a[104:107], v[136:139]
	s_xor_b32 s66, s87, 0x25400
	ds_read_b64_tr_b16 v[52:53], v3 offset:20480
	v_mfma_f32_16x16x32_bf16 v[136:139], v[36:39], a[120:123], v[136:139]
	buffer_load_dwordx4 v14, s[20:23], s66 offen offset:3072 lds
	v_mfma_f32_16x16x32_bf16 v[140:143], v[36:39], a[124:127], v[140:143]
	s_add_u32 m0, s64, 0x3000
	ds_read_b64_tr_b16 v[54:55], v3 offset:22528
	ds_read_b128 a[80:83], v13 offset:5120
	v_mfma_f32_16x16x32_bf16 v[140:143], v[32:35], a[108:111], v[140:143]
	s_waitcnt lgkmcnt(7)
	v_mfma_f32_16x16x32_bf16 v[156:159], v[40:43], a[108:111], v[156:159]
	s_waitcnt lgkmcnt(6)
	s_xor_b32 s66, s87, 0x28000
	v_mfma_f32_16x16x32_bf16 v[156:159], v[44:47], a[124:127], v[156:159]
	buffer_load_dwordx4 v14, s[20:23], s66 offen offset:0 lds
	v_mfma_f32_16x16x32_bf16 v[152:155], v[44:47], a[120:123], v[152:155]
	ds_read_b64_tr_b16 v[56:57], v4 offset:16384
	v_mfma_f32_16x16x32_bf16 v[152:155], v[40:43], a[104:107], v[152:155]
	ds_read_b64_tr_b16 v[58:59], v4 offset:18432
	v_mfma_f32_16x16x32_bf16 v[148:151], v[40:43], a[100:103], v[148:151]
	s_xor_b32 s66, s87, 0x29c00
	ds_read_b64_tr_b16 v[60:61], v4 offset:20480
	ds_read_b128 a[68:71], v13 offset:20480
	v_mfma_f32_16x16x32_bf16 v[148:151], v[44:47], a[116:119], v[148:151]
	buffer_load_dwordx4 v14, s[20:23], s66 offen offset:1024 lds
	v_mfma_f32_16x16x32_bf16 v[144:147], v[44:47], a[112:115], v[144:147]
	ds_read_b64_tr_b16 v[62:63], v4 offset:22528
	v_mfma_f32_16x16x32_bf16 v[144:147], v[40:43], a[96:99], v[144:147]
	s_waitcnt lgkmcnt(7)
	v_mfma_f32_16x16x32_bf16 v[160:163], v[48:51], a[96:99], v[160:163]
	s_waitcnt lgkmcnt(5)
	s_xor_b32 s66, s87, 0x2b800
	v_mfma_f32_16x16x32_bf16 v[160:163], v[52:55], a[112:115], v[160:163]
	buffer_load_dwordx4 v14, s[20:23], s66 offen offset:2048 lds
	v_mfma_f32_16x16x32_bf16 v[164:167], v[52:55], a[116:119], v[164:167]
	s_waitcnt vmcnt(11)
	ds_read_b64_tr_b16 v[32:33], v1 offset:0
	ds_read_b128 a[84:87], v13 offset:21504
	v_mfma_f32_16x16x32_bf16 v[164:167], v[48:51], a[100:103], v[164:167]
	ds_read_b64_tr_b16 v[34:35], v1 offset:2048
	v_mfma_f32_16x16x32_bf16 v[168:171], v[48:51], a[104:107], v[168:171]
	s_waitcnt vmcnt(7)
	s_xor_b32 s66, s87, 0x2d400
	ds_read_b64_tr_b16 v[36:37], v1 offset:4096
	v_mfma_f32_16x16x32_bf16 v[168:171], v[52:55], a[120:123], v[168:171]
	buffer_load_dwordx4 v14, s[20:23], s66 offen offset:3072 lds
	v_mfma_f32_16x16x32_bf16 v[172:175], v[52:55], a[124:127], v[172:175]
	s_add_u32 m0, s64, 0x4000
	ds_read_b64_tr_b16 v[38:39], v1 offset:6144
	v_mfma_f32_16x16x32_bf16 v[172:175], v[48:51], a[108:111], v[172:175]
	s_waitcnt lgkmcnt(6)
	v_mfma_f32_16x16x32_bf16 v[188:191], v[56:59], a[108:111], v[188:191]
	s_waitcnt lgkmcnt(5)
	s_xor_b32 s66, s87, 0x30000
	ds_read_b128 a[72:75], v13 offset:36864
	v_mfma_f32_16x16x32_bf16 v[188:191], v[60:63], a[124:127], v[188:191]
	buffer_load_dwordx4 v14, s[20:23], s66 offen offset:0 lds
	v_mfma_f32_16x16x32_bf16 v[184:187], v[60:63], a[120:123], v[184:187]
	ds_read_b64_tr_b16 v[40:41], v2 offset:0
	v_mfma_f32_16x16x32_bf16 v[184:187], v[56:59], a[104:107], v[184:187]
	ds_read_b64_tr_b16 v[42:43], v2 offset:2048
	v_mfma_f32_16x16x32_bf16 v[180:183], v[56:59], a[100:103], v[180:183]
	s_xor_b32 s66, s87, 0x31c00
	ds_read_b64_tr_b16 v[44:45], v2 offset:4096
	v_mfma_f32_16x16x32_bf16 v[180:183], v[60:63], a[116:119], v[180:183]
	buffer_load_dwordx4 v14, s[20:23], s66 offen offset:1024 lds
	v_mfma_f32_16x16x32_bf16 v[176:179], v[60:63], a[112:115], v[176:179]
	ds_read_b64_tr_b16 v[46:47], v2 offset:6144
	ds_read_b128 a[88:91], v13 offset:37888
	v_mfma_f32_16x16x32_bf16 v[176:179], v[56:59], a[96:99], v[176:179]
	s_waitcnt lgkmcnt(7)
	v_mfma_f32_16x16x32_bf16 v[192:195], v[32:35], a[96:99], v[192:195]
	s_waitcnt lgkmcnt(6)
	s_xor_b32 s66, s87, 0x33800
	v_mfma_f32_16x16x32_bf16 v[192:195], v[36:39], a[112:115], v[192:195]
	buffer_load_dwordx4 v14, s[20:23], s66 offen offset:2048 lds
	v_mfma_f32_16x16x32_bf16 v[196:199], v[36:39], a[116:119], v[196:199]
	ds_read_b64_tr_b16 v[48:49], v3 offset:0
	v_mfma_f32_16x16x32_bf16 v[196:199], v[32:35], a[100:103], v[196:199]
	ds_read_b64_tr_b16 v[50:51], v3 offset:2048
	v_mfma_f32_16x16x32_bf16 v[200:203], v[32:35], a[104:107], v[200:203]
	s_xor_b32 s66, s87, 0x35400
	ds_read_b64_tr_b16 v[52:53], v3 offset:4096
	ds_read_b128 a[76:79], v13 offset:53248
	v_mfma_f32_16x16x32_bf16 v[200:203], v[36:39], a[120:123], v[200:203]
	buffer_load_dwordx4 v14, s[20:23], s66 offen offset:3072 lds
	v_mfma_f32_16x16x32_bf16 v[204:207], v[36:39], a[124:127], v[204:207]
	s_add_u32 m0, s64, 0x5000
	ds_read_b64_tr_b16 v[54:55], v3 offset:6144
	v_mfma_f32_16x16x32_bf16 v[204:207], v[32:35], a[108:111], v[204:207]
	s_waitcnt lgkmcnt(7)
	v_mfma_f32_16x16x32_bf16 v[220:223], v[40:43], a[108:111], v[220:223]
	s_waitcnt lgkmcnt(5)
	s_xor_b32 s66, s87, 0x38000
	v_mfma_f32_16x16x32_bf16 v[220:223], v[44:47], a[124:127], v[220:223]
	buffer_load_dwordx4 v14, s[20:23], s66 offen offset:0 lds
	v_mfma_f32_16x16x32_bf16 v[216:219], v[44:47], a[120:123], v[216:219]
	ds_read_b64_tr_b16 v[56:57], v4 offset:0
	ds_read_b128 a[92:95], v13 offset:54272
	v_mfma_f32_16x16x32_bf16 v[216:219], v[40:43], a[104:107], v[216:219]
	ds_read_b64_tr_b16 v[58:59], v4 offset:2048
	v_mfma_f32_16x16x32_bf16 v[212:215], v[40:43], a[100:103], v[212:215]
	s_xor_b32 s66, s87, 0x39c00
	ds_read_b64_tr_b16 v[60:61], v4 offset:4096
	v_mfma_f32_16x16x32_bf16 v[212:215], v[44:47], a[116:119], v[212:215]
	buffer_load_dwordx4 v14, s[20:23], s66 offen offset:1024 lds
	v_mfma_f32_16x16x32_bf16 v[208:211], v[44:47], a[112:115], v[208:211]
	ds_read_b64_tr_b16 v[62:63], v4 offset:6144
	v_mfma_f32_16x16x32_bf16 v[208:211], v[40:43], a[96:99], v[208:211]
	s_waitcnt lgkmcnt(6)
	v_mfma_f32_16x16x32_bf16 v[224:227], v[48:51], a[96:99], v[224:227]
	s_waitcnt lgkmcnt(5)
	s_xor_b32 s66, s87, 0x3b800
	v_mfma_f32_16x16x32_bf16 v[224:227], v[52:55], a[112:115], v[224:227]
	buffer_load_dwordx4 v14, s[20:23], s66 offen offset:2048 lds
	v_mfma_f32_16x16x32_bf16 v[228:231], v[52:55], a[116:119], v[228:231]
	s_waitcnt vmcnt(11)
	ds_read_b64_tr_b16 v[32:33], v1 offset:8192
	v_mfma_f32_16x16x32_bf16 v[228:231], v[48:51], a[100:103], v[228:231]
	ds_read_b64_tr_b16 v[34:35], v1 offset:10240
	v_mfma_f32_16x16x32_bf16 v[232:235], v[48:51], a[104:107], v[232:235]
	s_waitcnt vmcnt(7)
	s_xor_b32 s66, s87, 0x3d400
	ds_read_b64_tr_b16 v[36:37], v1 offset:12288
	v_mfma_f32_16x16x32_bf16 v[232:235], v[52:55], a[120:123], v[232:235]
	buffer_load_dwordx4 v14, s[20:23], s66 offen offset:3072 lds
	v_mfma_f32_16x16x32_bf16 v[236:239], v[52:55], a[124:127], v[236:239]
	s_add_u32 m0, s64, 0x0
	ds_read_b64_tr_b16 v[38:39], v1 offset:14336
	v_mfma_f32_16x16x32_bf16 v[236:239], v[48:51], a[108:111], v[236:239]
	s_waitcnt lgkmcnt(5)
	v_mfma_f32_16x16x32_bf16 v[252:255], v[56:59], a[108:111], v[252:255]
	s_waitcnt lgkmcnt(4)
	s_xor_b32 s66, s87, 0x40000
	v_mfma_f32_16x16x32_bf16 v[252:255], v[60:63], a[124:127], v[252:255]
	buffer_load_dwordx4 v14, s[20:23], s66 offen offset:0 lds
	v_mfma_f32_16x16x32_bf16 v[248:251], v[60:63], a[120:123], v[248:251]
	ds_read_b64_tr_b16 v[40:41], v2 offset:8192
	v_mfma_f32_16x16x32_bf16 v[248:251], v[56:59], a[104:107], v[248:251]
	ds_read_b64_tr_b16 v[42:43], v2 offset:10240
	v_mfma_f32_16x16x32_bf16 v[244:247], v[56:59], a[100:103], v[244:247]
	s_xor_b32 s66, s87, 0x41c00
	ds_read_b64_tr_b16 v[44:45], v2 offset:12288
	v_mfma_f32_16x16x32_bf16 v[244:247], v[60:63], a[116:119], v[244:247]
	buffer_load_dwordx4 v14, s[20:23], s66 offen offset:1024 lds
	v_mfma_f32_16x16x32_bf16 v[240:243], v[60:63], a[112:115], v[240:243]
	ds_read_b64_tr_b16 v[46:47], v2 offset:14336
	v_mfma_f32_16x16x32_bf16 v[240:243], v[56:59], a[96:99], v[240:243]
	s_waitcnt lgkmcnt(5)
	v_mfma_f32_16x16x32_bf16 v[128:131], v[32:35], a[64:67], v[128:131]
	s_waitcnt lgkmcnt(4)
	s_xor_b32 s66, s87, 0x43800
	ds_read_b128 a[96:99], v13 offset:6144
	v_mfma_f32_16x16x32_bf16 v[128:131], v[36:39], a[80:83], v[128:131]
	buffer_load_dwordx4 v14, s[20:23], s66 offen offset:2048 lds
	v_mfma_f32_16x16x32_bf16 v[132:135], v[36:39], a[84:87], v[132:135]
	ds_read_b64_tr_b16 v[48:49], v3 offset:8192
	ds_read_b128 a[112:115], v13 offset:7168
	v_mfma_f32_16x16x32_bf16 v[132:135], v[32:35], a[68:71], v[132:135]
	ds_read_b64_tr_b16 v[50:51], v3 offset:10240
	v_mfma_f32_16x16x32_bf16 v[136:139], v[32:35], a[72:75], v[136:139]
	s_xor_b32 s66, s87, 0x45400
	ds_read_b64_tr_b16 v[52:53], v3 offset:12288
	ds_read_b128 a[100:103], v13 offset:22528
	v_mfma_f32_16x16x32_bf16 v[136:139], v[36:39], a[88:91], v[136:139]
	buffer_load_dwordx4 v14, s[20:23], s66 offen offset:3072 lds
	v_mfma_f32_16x16x32_bf16 v[140:143], v[36:39], a[92:95], v[140:143]
	s_add_u32 m0, s64, 0x1000
	ds_read_b64_tr_b16 v[54:55], v3 offset:14336
	ds_read_b128 a[116:119], v13 offset:23552
	v_mfma_f32_16x16x32_bf16 v[140:143], v[32:35], a[76:79], v[140:143]
	s_waitcnt lgkmcnt(9)
	v_mfma_f32_16x16x32_bf16 v[156:159], v[40:43], a[76:79], v[156:159]
	s_waitcnt lgkmcnt(8)
	s_xor_b32 s66, s87, 0x48000
	ds_read_b128 a[104:107], v13 offset:38912
	v_mfma_f32_16x16x32_bf16 v[156:159], v[44:47], a[92:95], v[156:159]
	buffer_load_dwordx4 v14, s[20:23], s66 offen offset:0 lds
	v_mfma_f32_16x16x32_bf16 v[152:155], v[44:47], a[88:91], v[152:155]
	ds_read_b64_tr_b16 v[56:57], v4 offset:8192
	ds_read_b128 a[120:123], v13 offset:39936
	v_mfma_f32_16x16x32_bf16 v[152:155], v[40:43], a[72:75], v[152:155]
	ds_read_b64_tr_b16 v[58:59], v4 offset:10240
	v_mfma_f32_16x16x32_bf16 v[148:151], v[40:43], a[68:71], v[148:151]
	s_xor_b32 s66, s87, 0x49c00
	ds_read_b64_tr_b16 v[60:61], v4 offset:12288
	ds_read_b128 a[108:111], v13 offset:55296
	v_mfma_f32_16x16x32_bf16 v[148:151], v[44:47], a[84:87], v[148:151]
	buffer_load_dwordx4 v14, s[20:23], s66 offen offset:1024 lds
	v_mfma_f32_16x16x32_bf16 v[144:147], v[44:47], a[80:83], v[144:147]
	ds_read_b64_tr_b16 v[62:63], v4 offset:14336
	ds_read_b128 a[124:127], v13 offset:56320
	v_mfma_f32_16x16x32_bf16 v[144:147], v[40:43], a[64:67], v[144:147]
	s_waitcnt lgkmcnt(10)
	v_mfma_f32_16x16x32_bf16 v[160:163], v[48:51], a[64:67], v[160:163]
	s_waitcnt lgkmcnt(8)
	s_xor_b32 s66, s87, 0x4b800
	v_mfma_f32_16x16x32_bf16 v[160:163], v[52:55], a[80:83], v[160:163]
	buffer_load_dwordx4 v14, s[20:23], s66 offen offset:2048 lds
	v_mfma_f32_16x16x32_bf16 v[164:167], v[52:55], a[84:87], v[164:167]
	s_waitcnt vmcnt(11)
	ds_read_b64_tr_b16 v[32:33], v1 offset:16384
	v_mfma_f32_16x16x32_bf16 v[164:167], v[48:51], a[68:71], v[164:167]
	ds_read_b64_tr_b16 v[34:35], v1 offset:18432
	v_mfma_f32_16x16x32_bf16 v[168:171], v[48:51], a[72:75], v[168:171]
	s_waitcnt vmcnt(7)
	s_xor_b32 s66, s87, 0x4d400
	ds_read_b64_tr_b16 v[36:37], v1 offset:20480
	v_mfma_f32_16x16x32_bf16 v[168:171], v[52:55], a[88:91], v[168:171]
	buffer_load_dwordx4 v14, s[20:23], s66 offen offset:3072 lds
	v_mfma_f32_16x16x32_bf16 v[172:175], v[52:55], a[92:95], v[172:175]
	s_add_u32 m0, s64, 0x2000
	ds_read_b64_tr_b16 v[38:39], v1 offset:22528
	v_mfma_f32_16x16x32_bf16 v[172:175], v[48:51], a[76:79], v[172:175]
	s_waitcnt lgkmcnt(6)
	v_mfma_f32_16x16x32_bf16 v[188:191], v[56:59], a[76:79], v[188:191]
	s_waitcnt lgkmcnt(4)
	s_xor_b32 s66, s87, 0x50000
	v_mfma_f32_16x16x32_bf16 v[188:191], v[60:63], a[92:95], v[188:191]
	buffer_load_dwordx4 v14, s[20:23], s66 offen offset:0 lds
	v_mfma_f32_16x16x32_bf16 v[184:187], v[60:63], a[88:91], v[184:187]
	ds_read_b64_tr_b16 v[40:41], v2 offset:16384
	v_mfma_f32_16x16x32_bf16 v[184:187], v[56:59], a[72:75], v[184:187]
	ds_read_b64_tr_b16 v[42:43], v2 offset:18432
	v_mfma_f32_16x16x32_bf16 v[180:183], v[56:59], a[68:71], v[180:183]
	s_xor_b32 s66, s87, 0x51c00
	ds_read_b64_tr_b16 v[44:45], v2 offset:20480
	v_mfma_f32_16x16x32_bf16 v[180:183], v[60:63], a[84:87], v[180:183]
	buffer_load_dwordx4 v14, s[20:23], s66 offen offset:1024 lds
	v_mfma_f32_16x16x32_bf16 v[176:179], v[60:63], a[80:83], v[176:179]
	ds_read_b64_tr_b16 v[46:47], v2 offset:22528
	v_mfma_f32_16x16x32_bf16 v[176:179], v[56:59], a[64:67], v[176:179]
	s_waitcnt lgkmcnt(5)
	v_mfma_f32_16x16x32_bf16 v[128:131], v[32:35], a[96:99], v[128:131]
	s_waitcnt lgkmcnt(4)
	s_xor_b32 s66, s87, 0x53800
	ds_read_b128 a[64:67], v13 offset:8192
	v_mfma_f32_16x16x32_bf16 v[128:131], v[36:39], a[112:115], v[128:131]
	buffer_load_dwordx4 v14, s[20:23], s66 offen offset:2048 lds
	v_mfma_f32_16x16x32_bf16 v[132:135], v[36:39], a[116:119], v[132:135]
	ds_read_b64_tr_b16 v[48:49], v3 offset:16384
	ds_read_b128 a[80:83], v13 offset:9216
	v_mfma_f32_16x16x32_bf16 v[132:135], v[32:35], a[100:103], v[132:135]
	ds_read_b64_tr_b16 v[50:51], v3 offset:18432
	v_mfma_f32_16x16x32_bf16 v[136:139], v[32:35], a[104:107], v[136:139]
	s_xor_b32 s66, s87, 0x55400
	ds_read_b64_tr_b16 v[52:53], v3 offset:20480
	ds_read_b128 a[68:71], v13 offset:24576
	v_mfma_f32_16x16x32_bf16 v[136:139], v[36:39], a[120:123], v[136:139]
	buffer_load_dwordx4 v14, s[20:23], s66 offen offset:3072 lds
	v_mfma_f32_16x16x32_bf16 v[140:143], v[36:39], a[124:127], v[140:143]
	s_add_u32 m0, s64, 0x3000
	ds_read_b64_tr_b16 v[54:55], v3 offset:22528
	ds_read_b128 a[84:87], v13 offset:25600
	v_mfma_f32_16x16x32_bf16 v[140:143], v[32:35], a[108:111], v[140:143]
	s_waitcnt lgkmcnt(9)
	v_mfma_f32_16x16x32_bf16 v[156:159], v[40:43], a[108:111], v[156:159]
	s_waitcnt lgkmcnt(8)
	s_xor_b32 s66, s87, 0x58000
	ds_read_b128 a[72:75], v13 offset:40960
	v_mfma_f32_16x16x32_bf16 v[156:159], v[44:47], a[124:127], v[156:159]
	buffer_load_dwordx4 v14, s[20:23], s66 offen offset:0 lds
	v_mfma_f32_16x16x32_bf16 v[152:155], v[44:47], a[120:123], v[152:155]
	ds_read_b64_tr_b16 v[56:57], v4 offset:16384
	ds_read_b128 a[88:91], v13 offset:41984
	v_mfma_f32_16x16x32_bf16 v[152:155], v[40:43], a[104:107], v[152:155]
	ds_read_b64_tr_b16 v[58:59], v4 offset:18432
	v_mfma_f32_16x16x32_bf16 v[148:151], v[40:43], a[100:103], v[148:151]
	s_xor_b32 s66, s87, 0x59c00
	ds_read_b64_tr_b16 v[60:61], v4 offset:20480
	ds_read_b128 a[76:79], v13 offset:57344
	v_mfma_f32_16x16x32_bf16 v[148:151], v[44:47], a[116:119], v[148:151]
	buffer_load_dwordx4 v14, s[20:23], s66 offen offset:1024 lds
	v_mfma_f32_16x16x32_bf16 v[144:147], v[44:47], a[112:115], v[144:147]
	ds_read_b64_tr_b16 v[62:63], v4 offset:22528
	ds_read_b128 a[92:95], v13 offset:58368
	v_mfma_f32_16x16x32_bf16 v[144:147], v[40:43], a[96:99], v[144:147]
	s_waitcnt lgkmcnt(10)
	v_mfma_f32_16x16x32_bf16 v[160:163], v[48:51], a[96:99], v[160:163]
	s_waitcnt lgkmcnt(8)
	s_xor_b32 s66, s87, 0x5b800
	v_mfma_f32_16x16x32_bf16 v[160:163], v[52:55], a[112:115], v[160:163]
	buffer_load_dwordx4 v14, s[20:23], s66 offen offset:2048 lds
	v_mfma_f32_16x16x32_bf16 v[164:167], v[52:55], a[116:119], v[164:167]
	s_waitcnt vmcnt(11)
	ds_read_b64_tr_b16 v[32:33], v1 offset:0
	v_mfma_f32_16x16x32_bf16 v[164:167], v[48:51], a[100:103], v[164:167]
	ds_read_b64_tr_b16 v[34:35], v1 offset:2048
	v_mfma_f32_16x16x32_bf16 v[168:171], v[48:51], a[104:107], v[168:171]
	s_waitcnt vmcnt(7)
	s_xor_b32 s66, s87, 0x5d400
	ds_read_b64_tr_b16 v[36:37], v1 offset:4096
	v_mfma_f32_16x16x32_bf16 v[168:171], v[52:55], a[120:123], v[168:171]
	buffer_load_dwordx4 v14, s[20:23], s66 offen offset:3072 lds
	v_mfma_f32_16x16x32_bf16 v[172:175], v[52:55], a[124:127], v[172:175]
	s_add_u32 m0, s64, 0x4000
	ds_read_b64_tr_b16 v[38:39], v1 offset:6144
	v_mfma_f32_16x16x32_bf16 v[172:175], v[48:51], a[108:111], v[172:175]
	s_waitcnt lgkmcnt(6)
	v_mfma_f32_16x16x32_bf16 v[188:191], v[56:59], a[108:111], v[188:191]
	s_waitcnt lgkmcnt(4)
	s_xor_b32 s66, s87, 0x60000
	v_mfma_f32_16x16x32_bf16 v[188:191], v[60:63], a[124:127], v[188:191]
	buffer_load_dwordx4 v14, s[20:23], s66 offen offset:0 lds
	v_mfma_f32_16x16x32_bf16 v[184:187], v[60:63], a[120:123], v[184:187]
	ds_read_b64_tr_b16 v[40:41], v2 offset:0
	v_mfma_f32_16x16x32_bf16 v[184:187], v[56:59], a[104:107], v[184:187]
	ds_read_b64_tr_b16 v[42:43], v2 offset:2048
	v_mfma_f32_16x16x32_bf16 v[180:183], v[56:59], a[100:103], v[180:183]
	s_xor_b32 s66, s87, 0x61c00
	ds_read_b64_tr_b16 v[44:45], v2 offset:4096
	v_mfma_f32_16x16x32_bf16 v[180:183], v[60:63], a[116:119], v[180:183]
	buffer_load_dwordx4 v14, s[20:23], s66 offen offset:1024 lds
	v_mfma_f32_16x16x32_bf16 v[176:179], v[60:63], a[112:115], v[176:179]
	ds_read_b64_tr_b16 v[46:47], v2 offset:6144
	v_mfma_f32_16x16x32_bf16 v[176:179], v[56:59], a[96:99], v[176:179]
	s_waitcnt lgkmcnt(5)
	v_mfma_f32_16x16x32_bf16 v[128:131], v[32:35], a[64:67], v[128:131]
	s_waitcnt lgkmcnt(4)
	s_xor_b32 s66, s87, 0x63800
	ds_read_b128 a[96:99], v13 offset:10240
	v_mfma_f32_16x16x32_bf16 v[128:131], v[36:39], a[80:83], v[128:131]
	buffer_load_dwordx4 v14, s[20:23], s66 offen offset:2048 lds
	v_mfma_f32_16x16x32_bf16 v[132:135], v[36:39], a[84:87], v[132:135]
	ds_read_b64_tr_b16 v[48:49], v3 offset:0
	ds_read_b128 a[112:115], v13 offset:11264
	v_mfma_f32_16x16x32_bf16 v[132:135], v[32:35], a[68:71], v[132:135]
	ds_read_b64_tr_b16 v[50:51], v3 offset:2048
	v_mfma_f32_16x16x32_bf16 v[136:139], v[32:35], a[72:75], v[136:139]
	s_xor_b32 s66, s87, 0x65400
	ds_read_b64_tr_b16 v[52:53], v3 offset:4096
	ds_read_b128 a[100:103], v13 offset:26624
	v_mfma_f32_16x16x32_bf16 v[136:139], v[36:39], a[88:91], v[136:139]
	buffer_load_dwordx4 v14, s[20:23], s66 offen offset:3072 lds
	v_mfma_f32_16x16x32_bf16 v[140:143], v[36:39], a[92:95], v[140:143]
	s_add_u32 m0, s64, 0x5000
	ds_read_b64_tr_b16 v[54:55], v3 offset:6144
	ds_read_b128 a[116:119], v13 offset:27648
	v_mfma_f32_16x16x32_bf16 v[140:143], v[32:35], a[76:79], v[140:143]
	s_waitcnt lgkmcnt(9)
	v_mfma_f32_16x16x32_bf16 v[156:159], v[40:43], a[76:79], v[156:159]
	s_waitcnt lgkmcnt(8)
	s_xor_b32 s66, s87, 0x68000
	ds_read_b128 a[104:107], v13 offset:43008
	v_mfma_f32_16x16x32_bf16 v[156:159], v[44:47], a[92:95], v[156:159]
	buffer_load_dwordx4 v14, s[20:23], s66 offen offset:0 lds
	v_mfma_f32_16x16x32_bf16 v[152:155], v[44:47], a[88:91], v[152:155]
	ds_read_b64_tr_b16 v[56:57], v4 offset:0
	ds_read_b128 a[120:123], v13 offset:44032
	v_mfma_f32_16x16x32_bf16 v[152:155], v[40:43], a[72:75], v[152:155]
	ds_read_b64_tr_b16 v[58:59], v4 offset:2048
	v_mfma_f32_16x16x32_bf16 v[148:151], v[40:43], a[68:71], v[148:151]
	s_xor_b32 s66, s87, 0x69c00
	ds_read_b64_tr_b16 v[60:61], v4 offset:4096
	ds_read_b128 a[108:111], v13 offset:59392
	v_mfma_f32_16x16x32_bf16 v[148:151], v[44:47], a[84:87], v[148:151]
	buffer_load_dwordx4 v14, s[20:23], s66 offen offset:1024 lds
	v_mfma_f32_16x16x32_bf16 v[144:147], v[44:47], a[80:83], v[144:147]
	ds_read_b64_tr_b16 v[62:63], v4 offset:6144
	ds_read_b128 a[124:127], v13 offset:60416
	v_mfma_f32_16x16x32_bf16 v[144:147], v[40:43], a[64:67], v[144:147]
	s_waitcnt lgkmcnt(10)
	v_mfma_f32_16x16x32_bf16 v[160:163], v[48:51], a[64:67], v[160:163]
	s_waitcnt lgkmcnt(8)
	s_xor_b32 s66, s87, 0x6b800
	v_mfma_f32_16x16x32_bf16 v[160:163], v[52:55], a[80:83], v[160:163]
	buffer_load_dwordx4 v14, s[20:23], s66 offen offset:2048 lds
	v_mfma_f32_16x16x32_bf16 v[164:167], v[52:55], a[84:87], v[164:167]
	s_waitcnt vmcnt(11)
	ds_read_b64_tr_b16 v[32:33], v1 offset:8192
	v_mfma_f32_16x16x32_bf16 v[164:167], v[48:51], a[68:71], v[164:167]
	ds_read_b64_tr_b16 v[34:35], v1 offset:10240
	v_mfma_f32_16x16x32_bf16 v[168:171], v[48:51], a[72:75], v[168:171]
	s_waitcnt vmcnt(7)
	s_xor_b32 s66, s87, 0x6d400
	ds_read_b64_tr_b16 v[36:37], v1 offset:12288
	v_mfma_f32_16x16x32_bf16 v[168:171], v[52:55], a[88:91], v[168:171]
	buffer_load_dwordx4 v14, s[20:23], s66 offen offset:3072 lds
	v_mfma_f32_16x16x32_bf16 v[172:175], v[52:55], a[92:95], v[172:175]
	s_add_u32 m0, s64, 0x0
	ds_read_b64_tr_b16 v[38:39], v1 offset:14336
	v_mfma_f32_16x16x32_bf16 v[172:175], v[48:51], a[76:79], v[172:175]
	s_waitcnt lgkmcnt(6)
	v_mfma_f32_16x16x32_bf16 v[188:191], v[56:59], a[76:79], v[188:191]
	s_waitcnt lgkmcnt(4)
	s_xor_b32 s66, s87, 0x70000
	v_mfma_f32_16x16x32_bf16 v[188:191], v[60:63], a[92:95], v[188:191]
	buffer_load_dwordx4 v14, s[20:23], s66 offen offset:0 lds
	v_mfma_f32_16x16x32_bf16 v[184:187], v[60:63], a[88:91], v[184:187]
	ds_read_b64_tr_b16 v[40:41], v2 offset:8192
	v_mfma_f32_16x16x32_bf16 v[184:187], v[56:59], a[72:75], v[184:187]
	ds_read_b64_tr_b16 v[42:43], v2 offset:10240
	v_mfma_f32_16x16x32_bf16 v[180:183], v[56:59], a[68:71], v[180:183]
	s_xor_b32 s66, s87, 0x71c00
	ds_read_b64_tr_b16 v[44:45], v2 offset:12288
	v_mfma_f32_16x16x32_bf16 v[180:183], v[60:63], a[84:87], v[180:183]
	buffer_load_dwordx4 v14, s[20:23], s66 offen offset:1024 lds
	v_mfma_f32_16x16x32_bf16 v[176:179], v[60:63], a[80:83], v[176:179]
	ds_read_b64_tr_b16 v[46:47], v2 offset:14336
	v_mfma_f32_16x16x32_bf16 v[176:179], v[56:59], a[64:67], v[176:179]
	s_waitcnt lgkmcnt(5)
	v_mfma_f32_16x16x32_bf16 v[128:131], v[32:35], a[96:99], v[128:131]
	s_waitcnt lgkmcnt(4)
	s_xor_b32 s66, s87, 0x73800
	ds_read_b128 a[64:67], v13 offset:12288
	v_mfma_f32_16x16x32_bf16 v[128:131], v[36:39], a[112:115], v[128:131]
	buffer_load_dwordx4 v14, s[20:23], s66 offen offset:2048 lds
	v_mfma_f32_16x16x32_bf16 v[132:135], v[36:39], a[116:119], v[132:135]
	ds_read_b64_tr_b16 v[48:49], v3 offset:8192
	ds_read_b128 a[80:83], v13 offset:13312
	v_mfma_f32_16x16x32_bf16 v[132:135], v[32:35], a[100:103], v[132:135]
	ds_read_b64_tr_b16 v[50:51], v3 offset:10240
	v_mfma_f32_16x16x32_bf16 v[136:139], v[32:35], a[104:107], v[136:139]
	s_xor_b32 s66, s87, 0x75400
	ds_read_b64_tr_b16 v[52:53], v3 offset:12288
	ds_read_b128 a[68:71], v13 offset:28672
	v_mfma_f32_16x16x32_bf16 v[136:139], v[36:39], a[120:123], v[136:139]
	buffer_load_dwordx4 v14, s[20:23], s66 offen offset:3072 lds
	v_mfma_f32_16x16x32_bf16 v[140:143], v[36:39], a[124:127], v[140:143]
	s_add_u32 m0, s64, 0x1000
	ds_read_b64_tr_b16 v[54:55], v3 offset:14336
	ds_read_b128 a[84:87], v13 offset:29696
	v_mfma_f32_16x16x32_bf16 v[140:143], v[32:35], a[108:111], v[140:143]
	s_waitcnt lgkmcnt(9)
	v_mfma_f32_16x16x32_bf16 v[156:159], v[40:43], a[108:111], v[156:159]
	s_waitcnt lgkmcnt(8)
	s_xor_b32 s66, s87, 0x78000
	ds_read_b128 a[72:75], v13 offset:45056
	v_mfma_f32_16x16x32_bf16 v[156:159], v[44:47], a[124:127], v[156:159]
	buffer_load_dwordx4 v14, s[20:23], s66 offen offset:0 lds
	v_mfma_f32_16x16x32_bf16 v[152:155], v[44:47], a[120:123], v[152:155]
	ds_read_b64_tr_b16 v[56:57], v4 offset:8192
	ds_read_b128 a[88:91], v13 offset:46080
	v_mfma_f32_16x16x32_bf16 v[152:155], v[40:43], a[104:107], v[152:155]
	ds_read_b64_tr_b16 v[58:59], v4 offset:10240
	v_mfma_f32_16x16x32_bf16 v[148:151], v[40:43], a[100:103], v[148:151]
	s_xor_b32 s66, s87, 0x79c00
	ds_read_b64_tr_b16 v[60:61], v4 offset:12288
	ds_read_b128 a[76:79], v13 offset:61440
	v_mfma_f32_16x16x32_bf16 v[148:151], v[44:47], a[116:119], v[148:151]
L_pg25:
	s_cbranch_execz L_touched1
	buffer_load_dwordx4 v14, s[20:23], s66 offen offset:1024 lds
	v_mfma_f32_16x16x32_bf16 v[144:147], v[44:47], a[112:115], v[144:147]
	ds_read_b64_tr_b16 v[62:63], v4 offset:14336
	ds_read_b128 a[92:95], v13 offset:62464
	v_mfma_f32_16x16x32_bf16 v[144:147], v[40:43], a[96:99], v[144:147]
	s_waitcnt lgkmcnt(10)
	v_mfma_f32_16x16x32_bf16 v[160:163], v[48:51], a[96:99], v[160:163]
	s_waitcnt lgkmcnt(8)
	s_xor_b32 s66, s87, 0x7b800
	v_mfma_f32_16x16x32_bf16 v[160:163], v[52:55], a[112:115], v[160:163]
	buffer_load_dwordx4 v14, s[20:23], s66 offen offset:2048 lds
	v_mfma_f32_16x16x32_bf16 v[164:167], v[52:55], a[116:119], v[164:167]
	s_waitcnt vmcnt(11)
	ds_read_b64_tr_b16 v[32:33], v1 offset:16384
	v_mfma_f32_16x16x32_bf16 v[164:167], v[48:51], a[100:103], v[164:167]
	ds_read_b64_tr_b16 v[34:35], v1 offset:18432
	v_mfma_f32_16x16x32_bf16 v[168:171], v[48:51], a[104:107], v[168:171]
	s_waitcnt vmcnt(7)
	s_xor_b32 s66, s87, 0x7d400
	ds_read_b64_tr_b16 v[36:37], v1 offset:20480
	v_mfma_f32_16x16x32_bf16 v[168:171], v[52:55], a[120:123], v[168:171]
	buffer_load_dwordx4 v14, s[20:23], s66 offen offset:3072 lds
	v_mfma_f32_16x16x32_bf16 v[172:175], v[52:55], a[124:127], v[172:175]
	s_add_u32 m0, s64, 0x2000
	ds_read_b64_tr_b16 v[38:39], v1 offset:22528
	v_mfma_f32_16x16x32_bf16 v[172:175], v[48:51], a[108:111], v[172:175]
	s_waitcnt lgkmcnt(6)
	v_mfma_f32_16x16x32_bf16 v[188:191], v[56:59], a[108:111], v[188:191]
	s_waitcnt lgkmcnt(4)
	s_xor_b32 s66, s87, 0x20200
	v_mfma_f32_16x16x32_bf16 v[188:191], v[60:63], a[124:127], v[188:191]
	buffer_load_dwordx4 v14, s[20:23], s66 offen offset:0 lds
	v_mfma_f32_16x16x32_bf16 v[184:187], v[60:63], a[120:123], v[184:187]
	ds_read_b64_tr_b16 v[40:41], v2 offset:16384
	v_mfma_f32_16x16x32_bf16 v[184:187], v[56:59], a[104:107], v[184:187]
	ds_read_b64_tr_b16 v[42:43], v2 offset:18432
	v_mfma_f32_16x16x32_bf16 v[180:183], v[56:59], a[100:103], v[180:183]
	s_xor_b32 s66, s87, 0x21e00
	ds_read_b64_tr_b16 v[44:45], v2 offset:20480
	v_mfma_f32_16x16x32_bf16 v[180:183], v[60:63], a[116:119], v[180:183]
	buffer_load_dwordx4 v14, s[20:23], s66 offen offset:1024 lds
	v_mfma_f32_16x16x32_bf16 v[176:179], v[60:63], a[112:115], v[176:179]
	ds_read_b64_tr_b16 v[46:47], v2 offset:22528
	v_mfma_f32_16x16x32_bf16 v[176:179], v[56:59], a[96:99], v[176:179]
	s_waitcnt lgkmcnt(5)
	v_mfma_f32_16x16x32_bf16 v[128:131], v[32:35], a[64:67], v[128:131]
	s_waitcnt lgkmcnt(4)
	s_xor_b32 s66, s87, 0x23a00
	ds_read_b128 a[96:99], v13 offset:14336
	v_mfma_f32_16x16x32_bf16 v[128:131], v[36:39], a[80:83], v[128:131]
	buffer_load_dwordx4 v14, s[20:23], s66 offen offset:2048 lds
	v_mfma_f32_16x16x32_bf16 v[132:135], v[36:39], a[84:87], v[132:135]
	ds_read_b64_tr_b16 v[48:49], v3 offset:16384
	ds_read_b128 a[112:115], v13 offset:15360
	v_mfma_f32_16x16x32_bf16 v[132:135], v[32:35], a[68:71], v[132:135]
	ds_read_b64_tr_b16 v[50:51], v3 offset:18432
	v_mfma_f32_16x16x32_bf16 v[136:139], v[32:35], a[72:75], v[136:139]
	s_xor_b32 s66, s87, 0x25600
	ds_read_b64_tr_b16 v[52:53], v3 offset:20480
	ds_read_b128 a[100:103], v13 offset:30720
	v_mfma_f32_16x16x32_bf16 v[136:139], v[36:39], a[88:91], v[136:139]
	buffer_load_dwordx4 v14, s[20:23], s66 offen offset:3072 lds
	v_mfma_f32_16x16x32_bf16 v[140:143], v[36:39], a[92:95], v[140:143]
	s_add_u32 m0, s64, 0x3000
	ds_read_b64_tr_b16 v[54:55], v3 offset:22528
	ds_read_b128 a[116:119], v13 offset:31744
	v_mfma_f32_16x16x32_bf16 v[140:143], v[32:35], a[76:79], v[140:143]
	s_waitcnt lgkmcnt(9)
	v_mfma_f32_16x16x32_bf16 v[156:159], v[40:43], a[76:79], v[156:159]
	s_waitcnt lgkmcnt(8)
	s_xor_b32 s66, s87, 0x28200
	ds_read_b128 a[104:107], v13 offset:47104
	v_mfma_f32_16x16x32_bf16 v[156:159], v[44:47], a[92:95], v[156:159]
	buffer_load_dwordx4 v14, s[20:23], s66 offen offset:0 lds
	v_mfma_f32_16x16x32_bf16 v[152:155], v[44:47], a[88:91], v[152:155]
	ds_read_b64_tr_b16 v[56:57], v4 offset:16384
	ds_read_b128 a[120:123], v13 offset:48128
	v_mfma_f32_16x16x32_bf16 v[152:155], v[40:43], a[72:75], v[152:155]
	ds_read_b64_tr_b16 v[58:59], v4 offset:18432
	v_mfma_f32_16x16x32_bf16 v[148:151], v[40:43], a[68:71], v[148:151]
	s_xor_b32 s66, s87, 0x29e00
	ds_read_b64_tr_b16 v[60:61], v4 offset:20480
	ds_read_b128 a[108:111], v13 offset:63488
	v_mfma_f32_16x16x32_bf16 v[148:151], v[44:47], a[84:87], v[148:151]
	buffer_load_dwordx4 v14, s[20:23], s66 offen offset:1024 lds
	v_mfma_f32_16x16x32_bf16 v[144:147], v[44:47], a[80:83], v[144:147]
	ds_read_b64_tr_b16 v[62:63], v4 offset:22528
	ds_read_b128 a[124:127], v13 offset:64512
	v_mfma_f32_16x16x32_bf16 v[144:147], v[40:43], a[64:67], v[144:147]
	s_waitcnt lgkmcnt(10)
	v_mfma_f32_16x16x32_bf16 v[160:163], v[48:51], a[64:67], v[160:163]
	s_waitcnt lgkmcnt(8)
	s_xor_b32 s66, s87, 0x2ba00
	v_mfma_f32_16x16x32_bf16 v[160:163], v[52:55], a[80:83], v[160:163]
	buffer_load_dwordx4 v14, s[20:23], s66 offen offset:2048 lds
	v_mfma_f32_16x16x32_bf16 v[164:167], v[52:55], a[84:87], v[164:167]
	s_waitcnt vmcnt(11)
	ds_read_b64_tr_b16 v[32:33], v1 offset:0
	v_mfma_f32_16x16x32_bf16 v[164:167], v[48:51], a[68:71], v[164:167]
	ds_read_b64_tr_b16 v[34:35], v1 offset:2048
	v_mfma_f32_16x16x32_bf16 v[168:171], v[48:51], a[72:75], v[168:171]
	s_waitcnt vmcnt(7)
	s_xor_b32 s66, s87, 0x2d600
	ds_read_b64_tr_b16 v[36:37], v1 offset:4096
	v_mfma_f32_16x16x32_bf16 v[168:171], v[52:55], a[88:91], v[168:171]
	buffer_load_dwordx4 v14, s[20:23], s66 offen offset:3072 lds
	v_mfma_f32_16x16x32_bf16 v[172:175], v[52:55], a[92:95], v[172:175]
	s_add_u32 m0, s64, 0x4000
	ds_read_b64_tr_b16 v[38:39], v1 offset:6144
	v_mfma_f32_16x16x32_bf16 v[172:175], v[48:51], a[76:79], v[172:175]
	s_waitcnt lgkmcnt(6)
	v_mfma_f32_16x16x32_bf16 v[188:191], v[56:59], a[76:79], v[188:191]
	s_waitcnt lgkmcnt(4)
	s_xor_b32 s66, s87, 0x30200
	v_mfma_f32_16x16x32_bf16 v[188:191], v[60:63], a[92:95], v[188:191]
	buffer_load_dwordx4 v14, s[20:23], s66 offen offset:0 lds
	v_mfma_f32_16x16x32_bf16 v[184:187], v[60:63], a[88:91], v[184:187]
	ds_read_b64_tr_b16 v[40:41], v2 offset:0
	v_mfma_f32_16x16x32_bf16 v[184:187], v[56:59], a[72:75], v[184:187]
	ds_read_b64_tr_b16 v[42:43], v2 offset:2048
	v_mfma_f32_16x16x32_bf16 v[180:183], v[56:59], a[68:71], v[180:183]
	s_xor_b32 s66, s87, 0x31e00
	ds_read_b64_tr_b16 v[44:45], v2 offset:4096
	v_mfma_f32_16x16x32_bf16 v[180:183], v[60:63], a[84:87], v[180:183]
	buffer_load_dwordx4 v14, s[20:23], s66 offen offset:1024 lds
	v_mfma_f32_16x16x32_bf16 v[176:179], v[60:63], a[80:83], v[176:179]
	ds_read_b64_tr_b16 v[46:47], v2 offset:6144
	v_mfma_f32_16x16x32_bf16 v[176:179], v[56:59], a[64:67], v[176:179]
	s_waitcnt lgkmcnt(5)
	v_mfma_f32_16x16x32_bf16 v[128:131], v[32:35], a[96:99], v[128:131]
	s_waitcnt lgkmcnt(4)
	s_xor_b32 s66, s87, 0x33a00
	ds_read_b128 a[64:67], v13 offset:4096
	v_mfma_f32_16x16x32_bf16 v[128:131], v[36:39], a[112:115], v[128:131]
	buffer_load_dwordx4 v14, s[20:23], s66 offen offset:2048 lds
	v_mfma_f32_16x16x32_bf16 v[132:135], v[36:39], a[116:119], v[132:135]
	ds_read_b64_tr_b16 v[48:49], v3 offset:0
	ds_read_b128 a[80:83], v13 offset:5120
	v_mfma_f32_16x16x32_bf16 v[132:135], v[32:35], a[100:103], v[132:135]
	ds_read_b64_tr_b16 v[50:51], v3 offset:2048
	v_mfma_f32_16x16x32_bf16 v[136:139], v[32:35], a[104:107], v[136:139]
	s_xor_b32 s66, s87, 0x35600
	ds_read_b64_tr_b16 v[52:53], v3 offset:4096
	ds_read_b128 a[68:71], v13 offset:20480
	v_mfma_f32_16x16x32_bf16 v[136:139], v[36:39], a[120:123], v[136:139]
	buffer_load_dwordx4 v14, s[20:23], s66 offen offset:3072 lds
	v_mfma_f32_16x16x32_bf16 v[140:143], v[36:39], a[124:127], v[140:143]
	s_add_u32 m0, s64, 0x5000
	ds_read_b64_tr_b16 v[54:55], v3 offset:6144
	ds_read_b128 a[84:87], v13 offset:21504
	v_mfma_f32_16x16x32_bf16 v[140:143], v[32:35], a[108:111], v[140:143]
	s_waitcnt lgkmcnt(9)
	v_mfma_f32_16x16x32_bf16 v[156:159], v[40:43], a[108:111], v[156:159]
	s_waitcnt lgkmcnt(8)
	s_xor_b32 s66, s87, 0x38200
	ds_read_b128 a[72:75], v13 offset:36864
	v_mfma_f32_16x16x32_bf16 v[156:159], v[44:47], a[124:127], v[156:159]
	buffer_load_dwordx4 v14, s[20:23], s66 offen offset:0 lds
	v_mfma_f32_16x16x32_bf16 v[152:155], v[44:47], a[120:123], v[152:155]
	ds_read_b64_tr_b16 v[56:57], v4 offset:0
	ds_read_b128 a[88:91], v13 offset:37888
	v_mfma_f32_16x16x32_bf16 v[152:155], v[40:43], a[104:107], v[152:155]
	ds_read_b64_tr_b16 v[58:59], v4 offset:2048
	v_mfma_f32_16x16x32_bf16 v[148:151], v[40:43], a[100:103], v[148:151]
	s_xor_b32 s66, s87, 0x39e00
	ds_read_b64_tr_b16 v[60:61], v4 offset:4096
	ds_read_b128 a[76:79], v13 offset:53248
	v_mfma_f32_16x16x32_bf16 v[148:151], v[44:47], a[116:119], v[148:151]
	buffer_load_dwordx4 v14, s[20:23], s66 offen offset:1024 lds
	v_mfma_f32_16x16x32_bf16 v[144:147], v[44:47], a[112:115], v[144:147]
	ds_read_b64_tr_b16 v[62:63], v4 offset:6144
	ds_read_b128 a[92:95], v13 offset:54272
	v_mfma_f32_16x16x32_bf16 v[144:147], v[40:43], a[96:99], v[144:147]
	s_waitcnt lgkmcnt(10)
	v_mfma_f32_16x16x32_bf16 v[160:163], v[48:51], a[96:99], v[160:163]
	s_waitcnt lgkmcnt(8)
	s_xor_b32 s66, s87, 0x3ba00
	v_mfma_f32_16x16x32_bf16 v[160:163], v[52:55], a[112:115], v[160:163]
	buffer_load_dwordx4 v14, s[20:23], s66 offen offset:2048 lds
	v_mfma_f32_16x16x32_bf16 v[164:167], v[52:55], a[116:119], v[164:167]
	s_waitcnt vmcnt(11)
	ds_read_b64_tr_b16 v[32:33], v1 offset:8192
	v_mfma_f32_16x16x32_bf16 v[164:167], v[48:51], a[100:103], v[164:167]
	ds_read_b64_tr_b16 v[34:35], v1 offset:10240
	v_mfma_f32_16x16x32_bf16 v[168:171], v[48:51], a[104:107], v[168:171]
	s_waitcnt vmcnt(7)
	s_xor_b32 s66, s87, 0x3d600
	ds_read_b64_tr_b16 v[36:37], v1 offset:12288
	v_mfma_f32_16x16x32_bf16 v[168:171], v[52:55], a[120:123], v[168:171]
	buffer_load_dwordx4 v14, s[20:23], s66 offen offset:3072 lds
	v_mfma_f32_16x16x32_bf16 v[172:175], v[52:55], a[124:127], v[172:175]
	ds_read_b64_tr_b16 v[38:39], v1 offset:14336
	v_mfma_f32_16x16x32_bf16 v[172:175], v[48:51], a[108:111], v[172:175]
	s_waitcnt lgkmcnt(6)
	v_mfma_f32_16x16x32_bf16 v[188:191], v[56:59], a[108:111], v[188:191]
	s_waitcnt lgkmcnt(4)
	v_mfma_f32_16x16x32_bf16 v[188:191], v[60:63], a[124:127], v[188:191]
	v_mfma_f32_16x16x32_bf16 v[184:187], v[60:63], a[120:123], v[184:187]
	v_mfma_f32_16x16x32_bf16 v[184:187], v[56:59], a[104:107], v[184:187]
	ds_read_b64_tr_b16 v[40:41], v2 offset:8192
	v_mfma_f32_16x16x32_bf16 v[180:183], v[56:59], a[100:103], v[180:183]
	ds_read_b64_tr_b16 v[42:43], v2 offset:10240
	v_mfma_f32_16x16x32_bf16 v[180:183], v[60:63], a[116:119], v[180:183]
	ds_read_b64_tr_b16 v[44:45], v2 offset:12288
	v_mfma_f32_16x16x32_bf16 v[176:179], v[60:63], a[112:115], v[176:179]
	ds_read_b64_tr_b16 v[46:47], v2 offset:14336
	v_mfma_f32_16x16x32_bf16 v[176:179], v[56:59], a[96:99], v[176:179]
	s_waitcnt lgkmcnt(5)
	v_mfma_f32_16x16x32_bf16 v[192:195], v[32:35], a[64:67], v[192:195]
	s_waitcnt lgkmcnt(4)
	ds_read_b128 a[96:99], v13 offset:6144
	v_mfma_f32_16x16x32_bf16 v[192:195], v[36:39], a[80:83], v[192:195]
	v_mfma_f32_16x16x32_bf16 v[196:199], v[36:39], a[84:87], v[196:199]
	ds_read_b128 a[112:115], v13 offset:7168
	v_cvt_pk_bf16_f32 v159, v158, v159
	v_mfma_f32_16x16x32_bf16 v[196:199], v[32:35], a[68:71], v[196:199]
	ds_read_b64_tr_b16 v[48:49], v3 offset:8192
	v_cvt_pk_bf16_f32 v158, v156, v157
	v_mfma_f32_16x16x32_bf16 v[200:203], v[32:35], a[72:75], v[200:203]
	ds_read_b64_tr_b16 v[50:51], v3 offset:10240
	ds_read_b128 a[100:103], v13 offset:22528
	v_mfma_f32_16x16x32_bf16 v[200:203], v[36:39], a[88:91], v[200:203]
	ds_read_b64_tr_b16 v[52:53], v3 offset:12288
	v_cvt_pk_bf16_f32 v156, v140, v141
	v_mfma_f32_16x16x32_bf16 v[204:207], v[36:39], a[92:95], v[204:207]
	ds_read_b64_tr_b16 v[54:55], v3 offset:14336
	ds_read_b128 a[116:119], v13 offset:23552
	v_mfma_f32_16x16x32_bf16 v[204:207], v[32:35], a[76:79], v[204:207]
	s_waitcnt lgkmcnt(9)
	v_cvt_pk_bf16_f32 v157, v142, v143
	v_cvt_pk_bf16_f32 v155, v154, v155
	v_mfma_f32_16x16x32_bf16 v[220:223], v[40:43], a[76:79], v[220:223]
	s_waitcnt lgkmcnt(8)
	s_add_u32 s73, s88, 0x100c000
	ds_read_b128 a[104:107], v13 offset:38912
	v_cvt_pk_bf16_f32 v154, v152, v153
	v_mfma_f32_16x16x32_bf16 v[220:223], v[44:47], a[92:95], v[220:223]
	buffer_store_dwordx4 v[156:159], v18, s[48:51], s73 offen sc1
	v_mfma_f32_16x16x32_bf16 v[216:219], v[44:47], a[88:91], v[216:219]
	ds_read_b128 a[120:123], v13 offset:39936
	v_cvt_pk_bf16_f32 v152, v136, v137
	v_mfma_f32_16x16x32_bf16 v[216:219], v[40:43], a[72:75], v[216:219]
	ds_read_b64_tr_b16 v[56:57], v4 offset:8192
	v_cvt_pk_bf16_f32 v153, v138, v139
	v_mfma_f32_16x16x32_bf16 v[212:215], v[40:43], a[68:71], v[212:215]
	ds_read_b64_tr_b16 v[58:59], v4 offset:10240
	ds_read_b128 a[108:111], v13 offset:55296
	v_mfma_f32_16x16x32_bf16 v[212:215], v[44:47], a[84:87], v[212:215]
	ds_read_b64_tr_b16 v[60:61], v4 offset:12288
	v_cvt_pk_bf16_f32 v151, v150, v151
	v_mfma_f32_16x16x32_bf16 v[208:211], v[44:47], a[80:83], v[208:211]
	ds_read_b64_tr_b16 v[62:63], v4 offset:14336
	ds_read_b128 a[124:127], v13 offset:56320
	v_mfma_f32_16x16x32_bf16 v[208:211], v[40:43], a[64:67], v[208:211]
	s_waitcnt lgkmcnt(10)
	v_cvt_pk_bf16_f32 v150, v148, v149
	v_cvt_pk_bf16_f32 v148, v132, v133
	v_mfma_f32_16x16x32_bf16 v[224:227], v[48:51], a[64:67], v[224:227]
	s_waitcnt lgkmcnt(8)
	s_add_u32 s73, s88, 0x1008000
	v_cvt_pk_bf16_f32 v149, v134, v135
	v_cvt_pk_bf16_f32 v147, v146, v147
	v_mfma_f32_16x16x32_bf16 v[224:227], v[52:55], a[80:83], v[224:227]
	buffer_store_dwordx4 v[152:155], v18, s[48:51], s73 offen sc1
	v_mfma_f32_16x16x32_bf16 v[228:231], v[52:55], a[84:87], v[228:231]
	v_cvt_pk_bf16_f32 v146, v144, v145
	v_cvt_pk_bf16_f32 v144, v128, v129
	v_mfma_f32_16x16x32_bf16 v[228:231], v[48:51], a[68:71], v[228:231]
	s_waitcnt vmcnt(6)
	ds_read_b64_tr_b16 v[32:33], v1 offset:16384
	v_cvt_pk_bf16_f32 v145, v130, v131
	v_mfma_f32_16x16x32_bf16 v[232:235], v[48:51], a[72:75], v[232:235]
	ds_read_b64_tr_b16 v[34:35], v1 offset:18432
	v_cvt_pk_bf16_f32 v191, v190, v191
	v_mfma_f32_16x16x32_bf16 v[232:235], v[52:55], a[88:91], v[232:235]
	s_waitcnt vmcnt(2)
	ds_read_b64_tr_b16 v[36:37], v1 offset:20480
	v_cvt_pk_bf16_f32 v190, v188, v189
	v_mfma_f32_16x16x32_bf16 v[236:239], v[52:55], a[92:95], v[236:239]
	ds_read_b64_tr_b16 v[38:39], v1 offset:22528
	v_cvt_pk_bf16_f32 v188, v172, v173
	v_mfma_f32_16x16x32_bf16 v[236:239], v[48:51], a[76:79], v[236:239]
	s_waitcnt lgkmcnt(6)
	v_cvt_pk_bf16_f32 v189, v174, v175
	v_cvt_pk_bf16_f32 v187, v186, v187
	v_mfma_f32_16x16x32_bf16 v[252:255], v[56:59], a[76:79], v[252:255]
	s_waitcnt lgkmcnt(4)
	s_add_u32 s73, s88, 0x1004000
	v_cvt_pk_bf16_f32 v186, v184, v185
	v_cvt_pk_bf16_f32 v184, v168, v169
	v_mfma_f32_16x16x32_bf16 v[252:255], v[60:63], a[92:95], v[252:255]
	buffer_store_dwordx4 v[148:151], v18, s[48:51], s73 offen sc1
	v_mfma_f32_16x16x32_bf16 v[248:251], v[60:63], a[88:91], v[248:251]
	v_cvt_pk_bf16_f32 v185, v170, v171
	v_cvt_pk_bf16_f32 v183, v182, v183
	v_mfma_f32_16x16x32_bf16 v[248:251], v[56:59], a[72:75], v[248:251]
	ds_read_b64_tr_b16 v[40:41], v2 offset:16384
	v_cvt_pk_bf16_f32 v182, v180, v181
	v_mfma_f32_16x16x32_bf16 v[244:247], v[56:59], a[68:71], v[244:247]
	ds_read_b64_tr_b16 v[42:43], v2 offset:18432
	v_cvt_pk_bf16_f32 v180, v164, v165
	v_mfma_f32_16x16x32_bf16 v[244:247], v[60:63], a[84:87], v[244:247]
	ds_read_b64_tr_b16 v[44:45], v2 offset:20480
	v_cvt_pk_bf16_f32 v181, v166, v167
	v_mfma_f32_16x16x32_bf16 v[240:243], v[60:63], a[80:83], v[240:243]
	ds_read_b64_tr_b16 v[46:47], v2 offset:22528
	v_cvt_pk_bf16_f32 v179, v178, v179
	v_mfma_f32_16x16x32_bf16 v[240:243], v[56:59], a[64:67], v[240:243]
	s_waitcnt lgkmcnt(5)
	v_cvt_pk_bf16_f32 v178, v176, v177
	v_cvt_pk_bf16_f32 v176, v160, v161
	v_mfma_f32_16x16x32_bf16 v[192:195], v[32:35], a[96:99], v[192:195]
	s_waitcnt lgkmcnt(4)
	s_add_u32 s73, s88, 0x1000000
	ds_read_b128 a[64:67], v13 offset:8192
	v_cvt_pk_bf16_f32 v177, v162, v163
	v_mfma_f32_16x16x32_bf16 v[192:195], v[36:39], a[112:115], v[192:195]
	buffer_store_dwordx4 v[144:147], v18, s[48:51], s73 offen sc1
	v_mfma_f32_16x16x32_bf16 v[196:199], v[36:39], a[116:119], v[196:199]
	ds_read_b128 a[80:83], v13 offset:9216
	v_mfma_f32_16x16x32_bf16 v[196:199], v[32:35], a[100:103], v[196:199]
	ds_read_b64_tr_b16 v[48:49], v3 offset:16384
	v_mfma_f32_16x16x32_bf16 v[200:203], v[32:35], a[104:107], v[200:203]
	ds_read_b64_tr_b16 v[50:51], v3 offset:18432
	ds_read_b128 a[68:71], v13 offset:24576
	v_mfma_f32_16x16x32_bf16 v[200:203], v[36:39], a[120:123], v[200:203]
	ds_read_b64_tr_b16 v[52:53], v3 offset:20480
	v_mfma_f32_16x16x32_bf16 v[204:207], v[36:39], a[124:127], v[204:207]
	ds_read_b64_tr_b16 v[54:55], v3 offset:22528
	ds_read_b128 a[84:87], v13 offset:25600
	v_mfma_f32_16x16x32_bf16 v[204:207], v[32:35], a[108:111], v[204:207]
	s_waitcnt lgkmcnt(9)
	v_mfma_f32_16x16x32_bf16 v[220:223], v[40:43], a[108:111], v[220:223]
	s_waitcnt lgkmcnt(8)
	s_add_u32 s73, s88, 0x101c000
	ds_read_b128 a[72:75], v13 offset:40960
	v_mfma_f32_16x16x32_bf16 v[220:223], v[44:47], a[124:127], v[220:223]
	buffer_store_dwordx4 v[188:191], v19, s[48:51], s73 offen sc1
	v_mfma_f32_16x16x32_bf16 v[216:219], v[44:47], a[120:123], v[216:219]
	ds_read_b128 a[88:91], v13 offset:41984
	v_mfma_f32_16x16x32_bf16 v[216:219], v[40:43], a[104:107], v[216:219]
	ds_read_b64_tr_b16 v[56:57], v4 offset:16384
	v_mfma_f32_16x16x32_bf16 v[212:215], v[40:43], a[100:103], v[212:215]
	ds_read_b64_tr_b16 v[58:59], v4 offset:18432
	ds_read_b128 a[76:79], v13 offset:57344
	v_mfma_f32_16x16x32_bf16 v[212:215], v[44:47], a[116:119], v[212:215]
	ds_read_b64_tr_b16 v[60:61], v4 offset:20480
	v_mfma_f32_16x16x32_bf16 v[208:211], v[44:47], a[112:115], v[208:211]
	ds_read_b64_tr_b16 v[62:63], v4 offset:22528
	ds_read_b128 a[92:95], v13 offset:58368
	v_mfma_f32_16x16x32_bf16 v[208:211], v[40:43], a[96:99], v[208:211]
	s_waitcnt lgkmcnt(10)
	v_mfma_f32_16x16x32_bf16 v[224:227], v[48:51], a[96:99], v[224:227]
	s_waitcnt lgkmcnt(8)
	s_add_u32 s73, s88, 0x1018000
	v_mfma_f32_16x16x32_bf16 v[224:227], v[52:55], a[112:115], v[224:227]
	buffer_store_dwordx4 v[184:187], v19, s[48:51], s73 offen sc1
	v_mfma_f32_16x16x32_bf16 v[228:231], v[52:55], a[116:119], v[228:231]
	v_mfma_f32_16x16x32_bf16 v[228:231], v[48:51], a[100:103], v[228:231]
	v_mfma_f32_16x16x32_bf16 v[232:235], v[48:51], a[104:107], v[232:235]
	v_mfma_f32_16x16x32_bf16 v[232:235], v[52:55], a[120:123], v[232:235]
	v_mfma_f32_16x16x32_bf16 v[236:239], v[52:55], a[124:127], v[236:239]
	v_mfma_f32_16x16x32_bf16 v[236:239], v[48:51], a[108:111], v[236:239]
	s_waitcnt lgkmcnt(2)
	v_mfma_f32_16x16x32_bf16 v[252:255], v[56:59], a[108:111], v[252:255]
	s_waitcnt lgkmcnt(0)
	s_add_u32 s73, s88, 0x1014000
	v_mfma_f32_16x16x32_bf16 v[252:255], v[60:63], a[124:127], v[252:255]
	buffer_store_dwordx4 v[180:183], v19, s[48:51], s73 offen sc1
	v_mfma_f32_16x16x32_bf16 v[248:251], v[60:63], a[120:123], v[248:251]
	v_mfma_f32_16x16x32_bf16 v[248:251], v[56:59], a[104:107], v[248:251]
	v_mfma_f32_16x16x32_bf16 v[244:247], v[56:59], a[100:103], v[244:247]
	v_mfma_f32_16x16x32_bf16 v[244:247], v[60:63], a[116:119], v[244:247]
	v_mfma_f32_16x16x32_bf16 v[240:243], v[60:63], a[112:115], v[240:243]
	v_mfma_f32_16x16x32_bf16 v[240:243], v[56:59], a[96:99], v[240:243]
	v_mfma_f32_16x16x32_bf16 v[192:195], a[224:227], a[64:67], v[192:195]
	s_add_u32 s73, s88, 0x1010000
	ds_read_b128 a[96:99], v13 offset:10240
	v_mfma_f32_16x16x32_bf16 v[192:195], a[228:231], a[80:83], v[192:195]
	buffer_store_dwordx4 v[176:179], v19, s[48:51], s73 offen sc1
	ds_read_b128 a[112:115], v13 offset:11264
	v_mfma_f32_16x16x32_bf16 v[196:199], a[228:231], a[84:87], v[196:199]
	ds_read_b128 a[100:103], v13 offset:26624
	v_mfma_f32_16x16x32_bf16 v[196:199], a[224:227], a[68:71], v[196:199]
	ds_read_b128 a[116:119], v13 offset:27648
	v_mfma_f32_16x16x32_bf16 v[200:203], a[224:227], a[72:75], v[200:203]
	ds_read_b128 a[104:107], v13 offset:43008
	v_mfma_f32_16x16x32_bf16 v[200:203], a[228:231], a[88:91], v[200:203]
	ds_read_b128 a[120:123], v13 offset:44032
	v_mfma_f32_16x16x32_bf16 v[204:207], a[228:231], a[92:95], v[204:207]
	ds_read_b128 a[108:111], v13 offset:59392
	v_mfma_f32_16x16x32_bf16 v[204:207], a[224:227], a[76:79], v[204:207]
	ds_read_b128 a[124:127], v13 offset:60416
	v_mfma_f32_16x16x32_bf16 v[220:223], a[232:235], a[76:79], v[220:223]
	v_mfma_f32_16x16x32_bf16 v[220:223], a[236:239], a[92:95], v[220:223]
	v_mfma_f32_16x16x32_bf16 v[216:219], a[236:239], a[88:91], v[216:219]
	v_mfma_f32_16x16x32_bf16 v[216:219], a[232:235], a[72:75], v[216:219]
	v_mfma_f32_16x16x32_bf16 v[212:215], a[232:235], a[68:71], v[212:215]
	v_mfma_f32_16x16x32_bf16 v[212:215], a[236:239], a[84:87], v[212:215]
	v_mfma_f32_16x16x32_bf16 v[208:211], a[236:239], a[80:83], v[208:211]
	v_mfma_f32_16x16x32_bf16 v[208:211], a[232:235], a[64:67], v[208:211]
	s_waitcnt lgkmcnt(2)
	v_mfma_f32_16x16x32_bf16 v[192:195], a[148:151], a[96:99], v[192:195]
	ds_read_b128 a[64:67], v13 offset:12288
	v_mfma_f32_16x16x32_bf16 v[192:195], a[152:155], a[112:115], v[192:195]
	ds_read_b128 a[80:83], v13 offset:13312
	v_mfma_f32_16x16x32_bf16 v[196:199], a[152:155], a[116:119], v[196:199]
	ds_read_b128 a[68:71], v13 offset:28672
	v_mfma_f32_16x16x32_bf16 v[196:199], a[148:151], a[100:103], v[196:199]
	ds_read_b128 a[84:87], v13 offset:29696
	v_mfma_f32_16x16x32_bf16 v[200:203], a[148:151], a[104:107], v[200:203]
	ds_read_b128 a[72:75], v13 offset:45056
	v_mfma_f32_16x16x32_bf16 v[200:203], a[152:155], a[120:123], v[200:203]
	s_waitcnt lgkmcnt(5)
	ds_read_b128 a[88:91], v13 offset:46080
	v_mfma_f32_16x16x32_bf16 v[204:207], a[152:155], a[124:127], v[204:207]
	ds_read_b128 a[76:79], v13 offset:61440
	v_mfma_f32_16x16x32_bf16 v[204:207], a[148:151], a[108:111], v[204:207]
	ds_read_b128 a[92:95], v13 offset:62464
	v_mfma_f32_16x16x32_bf16 v[220:223], a[156:159], a[108:111], v[220:223]
	v_mfma_f32_16x16x32_bf16 v[220:223], a[172:175], a[124:127], v[220:223]
	v_mfma_f32_16x16x32_bf16 v[216:219], a[172:175], a[120:123], v[216:219]
	v_mfma_f32_16x16x32_bf16 v[216:219], a[156:159], a[104:107], v[216:219]
	v_mfma_f32_16x16x32_bf16 v[212:215], a[156:159], a[100:103], v[212:215]
	v_mfma_f32_16x16x32_bf16 v[212:215], a[172:175], a[116:119], v[212:215]
	v_mfma_f32_16x16x32_bf16 v[208:211], a[172:175], a[112:115], v[208:211]
	v_mfma_f32_16x16x32_bf16 v[208:211], a[156:159], a[96:99], v[208:211]
	s_waitcnt lgkmcnt(2)
	v_mfma_f32_16x16x32_bf16 v[192:195], a[0:3], a[64:67], v[192:195]
	ds_read_b128 a[96:99], v13 offset:14336
	v_mfma_f32_16x16x32_bf16 v[192:195], a[4:7], a[80:83], v[192:195]
	ds_read_b128 a[112:115], v13 offset:15360
	v_mfma_f32_16x16x32_bf16 v[196:199], a[4:7], a[84:87], v[196:199]
	ds_read_b128 a[100:103], v13 offset:30720
	v_mfma_f32_16x16x32_bf16 v[196:199], a[0:3], a[68:71], v[196:199]
	ds_read_b128 a[116:119], v13 offset:31744
	v_mfma_f32_16x16x32_bf16 v[200:203], a[0:3], a[72:75], v[200:203]
	ds_read_b128 a[104:107], v13 offset:47104
	v_mfma_f32_16x16x32_bf16 v[200:203], a[4:7], a[88:91], v[200:203]
	s_waitcnt lgkmcnt(5)
	ds_read_b128 a[120:123], v13 offset:48128
	v_mfma_f32_16x16x32_bf16 v[204:207], a[4:7], a[92:95], v[204:207]
	ds_read_b128 a[108:111], v13 offset:63488
	v_mfma_f32_16x16x32_bf16 v[204:207], a[0:3], a[76:79], v[204:207]
	ds_read_b128 a[124:127], v13 offset:64512
	v_mfma_f32_16x16x32_bf16 v[220:223], a[8:11], a[76:79], v[220:223]
	v_mfma_f32_16x16x32_bf16 v[220:223], a[12:15], a[92:95], v[220:223]
	v_mfma_f32_16x16x32_bf16 v[216:219], a[12:15], a[88:91], v[216:219]
	v_mfma_f32_16x16x32_bf16 v[216:219], a[8:11], a[72:75], v[216:219]
	v_mfma_f32_16x16x32_bf16 v[212:215], a[8:11], a[68:71], v[212:215]
	v_mfma_f32_16x16x32_bf16 v[212:215], a[12:15], a[84:87], v[212:215]
	v_mfma_f32_16x16x32_bf16 v[208:211], a[12:15], a[80:83], v[208:211]
	v_mfma_f32_16x16x32_bf16 v[208:211], a[8:11], a[64:67], v[208:211]
	s_waitcnt lgkmcnt(2)
	v_mfma_f32_16x16x32_bf16 v[192:195], a[32:35], a[96:99], v[192:195]
	ds_read_b128 a[64:67], v13 offset:12288
	v_mfma_f32_16x16x32_bf16 v[192:195], a[36:39], a[112:115], v[192:195]
	v_mfma_f32_16x16x32_bf16 v[196:199], a[36:39], a[116:119], v[196:199]
	ds_read_b128 a[80:83], v13 offset:13312
	v_mfma_f32_16x16x32_bf16 v[196:199], a[32:35], a[100:103], v[196:199]
	v_mfma_f32_16x16x32_bf16 v[200:203], a[32:35], a[104:107], v[200:203]
	ds_read_b128 a[68:71], v13 offset:28672
	v_mfma_f32_16x16x32_bf16 v[200:203], a[36:39], a[120:123], v[200:203]
	s_waitcnt lgkmcnt(3)
	v_mfma_f32_16x16x32_bf16 v[204:207], a[36:39], a[124:127], v[204:207]
	ds_read_b128 a[84:87], v13 offset:29696
	v_mfma_f32_16x16x32_bf16 v[204:207], a[32:35], a[108:111], v[204:207]
	v_mfma_f32_16x16x32_bf16 v[220:223], a[40:43], a[108:111], v[220:223]
	s_waitcnt vmcnt(0)
	buffer_store_dword v23, v22, s[48:51], s91 offen offset:32 sc1
	ds_read_b128 a[72:75], v13 offset:45056
	v_mfma_f32_16x16x32_bf16 v[220:223], a[44:47], a[124:127], v[220:223]
	v_mfma_f32_16x16x32_bf16 v[216:219], a[44:47], a[120:123], v[216:219]
	ds_read_b128 a[88:91], v13 offset:46080
	v_mfma_f32_16x16x32_bf16 v[216:219], a[40:43], a[104:107], v[216:219]
	v_mfma_f32_16x16x32_bf16 v[212:215], a[40:43], a[100:103], v[212:215]
	ds_read_b128 a[76:79], v13 offset:61440
	v_mfma_f32_16x16x32_bf16 v[212:215], a[44:47], a[116:119], v[212:215]
	v_mfma_f32_16x16x32_bf16 v[208:211], a[44:47], a[112:115], v[208:211]
	ds_read_b128 a[92:95], v13 offset:62464
	v_mfma_f32_16x16x32_bf16 v[208:211], a[40:43], a[96:99], v[208:211]
	v_mfma_f32_16x16x32_bf16 v[224:227], a[48:51], a[96:99], v[224:227]
	v_mfma_f32_16x16x32_bf16 v[224:227], a[52:55], a[112:115], v[224:227]
	v_mfma_f32_16x16x32_bf16 v[228:231], a[52:55], a[116:119], v[228:231]
	v_cvt_pk_bf16_f32 v223, v222, v223
	v_cvt_pk_bf16_f32 v222, v220, v221
	v_mfma_f32_16x16x32_bf16 v[228:231], a[48:51], a[100:103], v[228:231]
	v_cvt_pk_bf16_f32 v220, v204, v205
	v_cvt_pk_bf16_f32 v221, v206, v207
	v_mfma_f32_16x16x32_bf16 v[232:235], a[48:51], a[104:107], v[232:235]
	v_cvt_pk_bf16_f32 v219, v218, v219
	v_cvt_pk_bf16_f32 v218, v216, v217
	v_mfma_f32_16x16x32_bf16 v[232:235], a[52:55], a[120:123], v[232:235]
	v_cvt_pk_bf16_f32 v216, v200, v201
	v_cvt_pk_bf16_f32 v217, v202, v203
	v_mfma_f32_16x16x32_bf16 v[236:239], a[52:55], a[124:127], v[236:239]
	v_cvt_pk_bf16_f32 v215, v214, v215
	v_cvt_pk_bf16_f32 v214, v212, v213
	v_mfma_f32_16x16x32_bf16 v[236:239], a[48:51], a[108:111], v[236:239]
	s_add_u32 s73, s88, 0x100c400
	v_cvt_pk_bf16_f32 v212, v196, v197
	v_cvt_pk_bf16_f32 v213, v198, v199
	v_mfma_f32_16x16x32_bf16 v[252:255], a[56:59], a[108:111], v[252:255]
	buffer_store_dwordx4 v[220:223], v18, s[48:51], s73 offen sc1
	v_mfma_f32_16x16x32_bf16 v[252:255], a[60:63], a[124:127], v[252:255]
	v_cvt_pk_bf16_f32 v211, v210, v211
	v_cvt_pk_bf16_f32 v210, v208, v209
	v_mfma_f32_16x16x32_bf16 v[248:251], a[60:63], a[120:123], v[248:251]
	v_cvt_pk_bf16_f32 v208, v192, v193
	v_cvt_pk_bf16_f32 v209, v194, v195
	v_mfma_f32_16x16x32_bf16 v[248:251], a[56:59], a[104:107], v[248:251]
	v_mfma_f32_16x16x32_bf16 v[244:247], a[56:59], a[100:103], v[244:247]
	v_mfma_f32_16x16x32_bf16 v[244:247], a[60:63], a[116:119], v[244:247]
	v_mfma_f32_16x16x32_bf16 v[240:243], a[60:63], a[112:115], v[240:243]
	v_mfma_f32_16x16x32_bf16 v[240:243], a[56:59], a[96:99], v[240:243]
	s_waitcnt lgkmcnt(0)
	s_add_u32 s73, s88, 0x1008400
	v_mfma_f32_16x16x32_bf16 v[224:227], a[16:19], a[64:67], v[224:227]
	buffer_store_dwordx4 v[216:219], v18, s[48:51], s73 offen sc1
	ds_read_b128 a[96:99], v13 offset:10240
	v_mfma_f32_16x16x32_bf16 v[224:227], a[20:23], a[80:83], v[224:227]
	ds_read_b128 a[112:115], v13 offset:11264
	v_mfma_f32_16x16x32_bf16 v[228:231], a[20:23], a[84:87], v[228:231]
	ds_read_b128 a[100:103], v13 offset:26624
	v_mfma_f32_16x16x32_bf16 v[228:231], a[16:19], a[68:71], v[228:231]
	ds_read_b128 a[116:119], v13 offset:27648
	v_mfma_f32_16x16x32_bf16 v[232:235], a[16:19], a[72:75], v[232:235]
	ds_read_b128 a[104:107], v13 offset:43008
	v_mfma_f32_16x16x32_bf16 v[232:235], a[20:23], a[88:91], v[232:235]
	ds_read_b128 a[120:123], v13 offset:44032
	v_mfma_f32_16x16x32_bf16 v[236:239], a[20:23], a[92:95], v[236:239]
	ds_read_b128 a[108:111], v13 offset:59392
	v_mfma_f32_16x16x32_bf16 v[236:239], a[16:19], a[76:79], v[236:239]
	s_add_u32 s73, s88, 0x1004400
	ds_read_b128 a[124:127], v13 offset:60416
	v_mfma_f32_16x16x32_bf16 v[252:255], a[24:27], a[76:79], v[252:255]
	buffer_store_dwordx4 v[212:215], v18, s[48:51], s73 offen sc1
	v_mfma_f32_16x16x32_bf16 v[252:255], a[28:31], a[92:95], v[252:255]
L_pg26:
	s_cbranch_execz L_touched1
	v_mfma_f32_16x16x32_bf16 v[248:251], a[28:31], a[88:91], v[248:251]
	v_mfma_f32_16x16x32_bf16 v[248:251], a[24:27], a[72:75], v[248:251]
	v_mfma_f32_16x16x32_bf16 v[244:247], a[24:27], a[68:71], v[244:247]
	v_mfma_f32_16x16x32_bf16 v[244:247], a[28:31], a[84:87], v[244:247]
	v_mfma_f32_16x16x32_bf16 v[240:243], a[28:31], a[80:83], v[240:243]
	v_mfma_f32_16x16x32_bf16 v[240:243], a[24:27], a[64:67], v[240:243]
	s_waitcnt lgkmcnt(2)
	s_add_u32 s73, s88, 0x1000400
	v_mfma_f32_16x16x32_bf16 v[224:227], a[176:179], a[96:99], v[224:227]
	buffer_store_dwordx4 v[208:211], v18, s[48:51], s73 offen sc1
	ds_read_b128 a[64:67], v13 offset:8192
	v_mfma_f32_16x16x32_bf16 v[224:227], a[180:183], a[112:115], v[224:227]
	ds_read_b128 a[80:83], v13 offset:9216
	v_mfma_f32_16x16x32_bf16 v[228:231], a[180:183], a[116:119], v[228:231]
	ds_read_b128 a[68:71], v13 offset:24576
	v_mfma_f32_16x16x32_bf16 v[228:231], a[176:179], a[100:103], v[228:231]
	ds_read_b128 a[84:87], v13 offset:25600
	v_mfma_f32_16x16x32_bf16 v[232:235], a[176:179], a[104:107], v[232:235]
	ds_read_b128 a[72:75], v13 offset:40960
	v_mfma_f32_16x16x32_bf16 v[232:235], a[180:183], a[120:123], v[232:235]
	s_waitcnt lgkmcnt(5)
	ds_read_b128 a[88:91], v13 offset:41984
	v_mfma_f32_16x16x32_bf16 v[236:239], a[180:183], a[124:127], v[236:239]
	ds_read_b128 a[76:79], v13 offset:57344
	v_mfma_f32_16x16x32_bf16 v[236:239], a[176:179], a[108:111], v[236:239]
	ds_read_b128 a[92:95], v13 offset:58368
	v_mfma_f32_16x16x32_bf16 v[252:255], a[184:187], a[108:111], v[252:255]
	v_mfma_f32_16x16x32_bf16 v[252:255], a[188:191], a[124:127], v[252:255]
	v_mfma_f32_16x16x32_bf16 v[248:251], a[188:191], a[120:123], v[248:251]
	v_mfma_f32_16x16x32_bf16 v[248:251], a[184:187], a[104:107], v[248:251]
	v_mfma_f32_16x16x32_bf16 v[244:247], a[184:187], a[100:103], v[244:247]
	v_mfma_f32_16x16x32_bf16 v[244:247], a[188:191], a[116:119], v[244:247]
	v_mfma_f32_16x16x32_bf16 v[240:243], a[188:191], a[112:115], v[240:243]
	v_mfma_f32_16x16x32_bf16 v[240:243], a[184:187], a[96:99], v[240:243]
	s_waitcnt lgkmcnt(2)
	v_mfma_f32_16x16x32_bf16 v[224:227], a[240:243], a[64:67], v[224:227]
	v_mfma_f32_16x16x32_bf16 v[224:227], a[244:247], a[80:83], v[224:227]
	v_mfma_f32_16x16x32_bf16 v[228:231], a[244:247], a[84:87], v[228:231]
	v_mfma_f32_16x16x32_bf16 v[228:231], a[240:243], a[68:71], v[228:231]
	v_mfma_f32_16x16x32_bf16 v[232:235], a[240:243], a[72:75], v[232:235]
	v_mfma_f32_16x16x32_bf16 v[232:235], a[244:247], a[88:91], v[232:235]
	s_waitcnt lgkmcnt(0)
	v_mfma_f32_16x16x32_bf16 v[236:239], a[244:247], a[92:95], v[236:239]
	v_mfma_f32_16x16x32_bf16 v[236:239], a[240:243], a[76:79], v[236:239]
	v_mfma_f32_16x16x32_bf16 v[252:255], a[248:251], a[76:79], v[252:255]
	v_mfma_f32_16x16x32_bf16 v[252:255], a[252:255], a[92:95], v[252:255]
	v_mfma_f32_16x16x32_bf16 v[248:251], a[252:255], a[88:91], v[248:251]
	buffer_load_dword v25, v24, s[48:51], 0 offen sc1
	v_mfma_f32_16x16x32_bf16 v[248:251], a[248:251], a[72:75], v[248:251]
	v_mfma_f32_16x16x32_bf16 v[244:247], a[248:251], a[68:71], v[244:247]
	v_mfma_f32_16x16x32_bf16 v[244:247], a[252:255], a[84:87], v[244:247]
	v_mfma_f32_16x16x32_bf16 v[240:243], a[252:255], a[80:83], v[240:243]
	v_mfma_f32_16x16x32_bf16 v[240:243], a[248:251], a[64:67], v[240:243]
	s_nop 0
	v_cvt_pk_bf16_f32 v255, v254, v255
	v_cvt_pk_bf16_f32 v254, v252, v253
	v_cvt_pk_bf16_f32 v252, v236, v237
	v_cvt_pk_bf16_f32 v253, v238, v239
	s_add_u32 s73, s88, 0x101c400
	buffer_store_dwordx4 v[252:255], v19, s[48:51], s73 offen sc1
	v_cvt_pk_bf16_f32 v251, v250, v251
	v_cvt_pk_bf16_f32 v250, v248, v249
	v_cvt_pk_bf16_f32 v248, v232, v233
	v_cvt_pk_bf16_f32 v249, v234, v235
	s_add_u32 s73, s88, 0x1018400
	buffer_store_dwordx4 v[248:251], v19, s[48:51], s73 offen sc1
	v_cvt_pk_bf16_f32 v247, v246, v247
	v_cvt_pk_bf16_f32 v246, v244, v245
	v_cvt_pk_bf16_f32 v244, v228, v229
	v_cvt_pk_bf16_f32 v245, v230, v231
	s_add_u32 s73, s88, 0x1014400
	buffer_store_dwordx4 v[244:247], v19, s[48:51], s73 offen sc1
	v_cvt_pk_bf16_f32 v243, v242, v243
	v_cvt_pk_bf16_f32 v242, v240, v241
	v_cvt_pk_bf16_f32 v240, v224, v225
	v_cvt_pk_bf16_f32 v241, v226, v227
	s_add_u32 s73, s88, 0x1010400
	buffer_store_dwordx4 v[240:243], v19, s[48:51], s73 offen sc1
	s_cmp_lg_u32 s69, 0
	s_cbranch_scc1 L_other0
	ds_write_b128 v20, v[144:147] offset:0
	ds_write_b128 v20, v[148:151] offset:2048
	ds_write_b128 v20, v[152:155] offset:4096
	ds_write_b128 v20, v[156:159] offset:6144
	ds_write_b128 v20, v[208:211] offset:1024
	ds_write_b128 v20, v[212:215] offset:3072
	ds_write_b128 v20, v[216:219] offset:5120
	ds_write_b128 v20, v[220:223] offset:7168
L_other0:
	s_cmp_lg_u32 s69, 1
	s_cbranch_scc1 L_other1
	ds_write_b128 v20, v[176:179] offset:0
	ds_write_b128 v20, v[180:183] offset:2048
	ds_write_b128 v20, v[184:187] offset:4096
	ds_write_b128 v20, v[188:191] offset:6144
	ds_write_b128 v20, v[240:243] offset:1024
	ds_write_b128 v20, v[244:247] offset:3072
	ds_write_b128 v20, v[248:251] offset:5120
	ds_write_b128 v20, v[252:255] offset:7168
L_other1:
	s_waitcnt lgkmcnt(0)
	s_barrier
	ds_read_b128 a[0:3], v21 offset:0
	ds_read_b128 a[4:7], v21 offset:1024
	s_waitcnt vmcnt(4)
	v_cmp_eq_u32 vcc, 1, v25
	s_nop 0
	s_and_b32 s74, vcc_lo, 0xff
	s_orn2_b32 s72, s67, s74
	s_or_b32 s70, s67, s74
	s_add_u32 s71, s89, 0x1000000
	s_nop 0
	v_bfe_u32 v192, s72, 0, 1
	v_lshl_or_b32 v192, v192, 30, v13
	buffer_load_dwordx4 a[64:67], v192, s[48:51], s71 offen offset:0 sc1
	v_bfe_u32 v193, s72, 1, 1
	v_lshl_or_b32 v193, v193, 30, v13
	buffer_load_dwordx4 a[72:75], v193, s[48:51], s71 offen offset:2048 sc1
	s_add_u32 s71, s89, 0x1001000
	v_bfe_u32 v194, s72, 2, 1
	v_lshl_or_b32 v194, v194, 30, v13
	buffer_load_dwordx4 a[80:83], v194, s[48:51], s71 offen offset:0 sc1
	v_bfe_u32 v195, s72, 3, 1
	v_lshl_or_b32 v195, v195, 30, v13
	buffer_load_dwordx4 a[88:91], v195, s[48:51], s71 offen offset:2048 sc1
	s_waitcnt vmcnt(4)
	buffer_store_dword v23, v22, s[48:51], s91 offen offset:64 sc1
	s_add_u32 s71, s89, 0x1002000
	s_nop 0
	v_bfe_u32 v196, s72, 4, 1
	v_lshl_or_b32 v196, v196, 30, v13
	buffer_load_dwordx4 a[96:99], v196, s[48:51], s71 offen offset:0 sc1
	v_bfe_u32 v197, s72, 5, 1
	v_lshl_or_b32 v197, v197, 30, v13
	buffer_load_dwordx4 a[104:107], v197, s[48:51], s71 offen offset:2048 sc1
	s_add_u32 s71, s89, 0x1003000
	v_bfe_u32 v198, s72, 6, 1
	v_lshl_or_b32 v198, v198, 30, v13
	buffer_load_dwordx4 a[112:115], v198, s[48:51], s71 offen offset:0 sc1
	v_bfe_u32 v199, s72, 7, 1
	v_lshl_or_b32 v199, v199, 30, v13
	buffer_load_dwordx4 a[120:123], v199, s[48:51], s71 offen offset:2048 sc1
	s_waitcnt lgkmcnt(1)
	v_mfma_f32_16x16x32_bf16 v[128:131], v[28:31], a[0:3], 0
	v_mfma_f32_16x16x32_bf16 v[132:135], v[26:29], a[0:3], 0
	s_waitcnt lgkmcnt(0)
	v_mfma_f32_16x16x32_bf16 v[136:139], v[28:31], a[4:7], 0
	v_mfma_f32_16x16x32_bf16 v[140:143], v[26:29], a[4:7], 0
	v_mfma_f32_16x16x32_bf16 v[48:51], v[28:31], a[160:163], 0
	v_mfma_f32_16x16x32_bf16 v[52:55], v[26:29], a[160:163], 0
	v_mfma_f32_16x16x32_bf16 v[56:59], v[28:31], a[164:167], 0
	v_mfma_f32_16x16x32_bf16 v[60:63], v[26:29], a[164:167], 0
	v_mfma_f32_16x16x32_bf16 v[32:35], v[28:31], a[140:143], 0
	v_mfma_f32_16x16x32_bf16 v[36:39], v[26:29], a[140:143], 0
	v_mfma_f32_16x16x32_bf16 v[40:43], v[28:31], a[144:147], 0
	v_mfma_f32_16x16x32_bf16 v[44:47], v[26:29], a[144:147], 0
	v_mfma_f32_16x16x32_bf16 v[32:35], v[28:31], v[64:67], v[32:35]
	v_mfma_f32_16x16x32_bf16 v[36:39], v[26:29], v[64:67], v[36:39]
	v_mfma_f32_16x16x32_bf16 v[40:43], v[28:31], v[68:71], v[40:43]
	v_mfma_f32_16x16x32_bf16 v[44:47], v[26:29], v[68:71], v[44:47]
	v_mfma_f32_16x16x32_bf16 v[32:35], v[28:31], v[72:75], v[32:35]
	v_mfma_f32_16x16x32_bf16 v[36:39], v[26:29], v[72:75], v[36:39]
	v_mfma_f32_16x16x32_bf16 v[40:43], v[28:31], v[76:79], v[40:43]
	v_mfma_f32_16x16x32_bf16 v[44:47], v[26:29], v[76:79], v[44:47]
	v_mfma_f32_16x16x32_bf16 v[32:35], v[28:31], v[80:83], v[32:35]
	v_mfma_f32_16x16x32_bf16 v[36:39], v[26:29], v[80:83], v[36:39]
	v_mfma_f32_16x16x32_bf16 v[40:43], v[28:31], v[84:87], v[40:43]
	v_mfma_f32_16x16x32_bf16 v[44:47], v[26:29], v[84:87], v[44:47]
	v_mfma_f32_16x16x32_bf16 v[32:35], v[28:31], v[88:91], v[32:35]
	v_mfma_f32_16x16x32_bf16 v[36:39], v[26:29], v[88:91], v[36:39]
	v_mfma_f32_16x16x32_bf16 v[40:43], v[28:31], v[92:95], v[40:43]
	v_mfma_f32_16x16x32_bf16 v[44:47], v[26:29], v[92:95], v[44:47]
	v_mfma_f32_16x16x32_bf16 v[32:35], v[28:31], v[96:99], v[32:35]
	v_mfma_f32_16x16x32_bf16 v[36:39], v[26:29], v[96:99], v[36:39]
	v_mfma_f32_16x16x32_bf16 v[40:43], v[28:31], v[100:103], v[40:43]
	v_mfma_f32_16x16x32_bf16 v[44:47], v[26:29], v[100:103], v[44:47]
	v_mfma_f32_16x16x32_bf16 v[32:35], v[28:31], v[104:107], v[32:35]
	v_mfma_f32_16x16x32_bf16 v[36:39], v[26:29], v[104:107], v[36:39]
	v_mfma_f32_16x16x32_bf16 v[40:43], v[28:31], v[108:111], v[40:43]
	v_mfma_f32_16x16x32_bf16 v[44:47], v[26:29], v[108:111], v[44:47]
	v_mfma_f32_16x16x32_bf16 v[32:35], v[28:31], v[112:115], v[32:35]
	v_mfma_f32_16x16x32_bf16 v[36:39], v[26:29], v[112:115], v[36:39]
	v_mfma_f32_16x16x32_bf16 v[40:43], v[28:31], v[116:119], v[40:43]
	v_mfma_f32_16x16x32_bf16 v[44:47], v[26:29], v[116:119], v[44:47]
	v_mfma_f32_16x16x32_bf16 v[32:35], v[28:31], v[120:123], v[32:35]
	v_mfma_f32_16x16x32_bf16 v[36:39], v[26:29], v[120:123], v[36:39]
	v_mfma_f32_16x16x32_bf16 v[40:43], v[28:31], v[124:127], v[40:43]
	v_mfma_f32_16x16x32_bf16 v[44:47], v[26:29], v[124:127], v[44:47]
	buffer_load_dword v25, v24, s[48:51], 0 offen sc1
	s_mov_b32 s76, 0xbfb8aa3b
	s_mov_b32 s77, 0xbfb8aa3b
	s_nop 1
	s_nop 0
	v_pk_mul_f32 v[160:161], v[32:33], s[76:77]
	v_pk_mul_f32 v[162:163], v[34:35], s[76:77]
	v_pk_mul_f32 v[164:165], v[36:37], s[76:77]
	v_pk_mul_f32 v[166:167], v[38:39], s[76:77]
	v_pk_mul_f32 v[168:169], v[40:41], s[76:77]
	v_pk_mul_f32 v[170:171], v[42:43], s[76:77]
	v_pk_mul_f32 v[172:173], v[44:45], s[76:77]
	v_pk_mul_f32 v[174:175], v[46:47], s[76:77]
	v_exp_f32 v160, v160
	v_exp_f32 v161, v161
	v_exp_f32 v162, v162
	v_exp_f32 v163, v163
	v_exp_f32 v164, v164
	v_exp_f32 v165, v165
	v_exp_f32 v166, v166
	v_exp_f32 v167, v167
	v_exp_f32 v168, v168
	v_exp_f32 v169, v169
	v_exp_f32 v170, v170
	v_exp_f32 v171, v171
	v_exp_f32 v172, v172
	v_exp_f32 v173, v173
	v_exp_f32 v174, v174
	v_exp_f32 v175, v175
	v_pk_add_f32 v[160:161], v[160:161], 1.0 op_sel_hi:[1,0]
	v_pk_add_f32 v[162:163], v[162:163], 1.0 op_sel_hi:[1,0]
	v_pk_add_f32 v[164:165], v[164:165], 1.0 op_sel_hi:[1,0]
	v_pk_add_f32 v[166:167], v[166:167], 1.0 op_sel_hi:[1,0]
	v_pk_add_f32 v[168:169], v[168:169], 1.0 op_sel_hi:[1,0]
	v_pk_add_f32 v[170:171], v[170:171], 1.0 op_sel_hi:[1,0]
	v_pk_add_f32 v[172:173], v[172:173], 1.0 op_sel_hi:[1,0]
	v_pk_add_f32 v[174:175], v[174:175], 1.0 op_sel_hi:[1,0]
	v_rcp_f32 v160, v160
	v_rcp_f32 v161, v161
	v_rcp_f32 v162, v162
	v_rcp_f32 v163, v163
	v_rcp_f32 v164, v164
	v_rcp_f32 v165, v165
	v_rcp_f32 v166, v166
	v_rcp_f32 v167, v167
	v_rcp_f32 v168, v168
	v_rcp_f32 v169, v169
	v_rcp_f32 v170, v170
	v_rcp_f32 v171, v171
	v_rcp_f32 v172, v172
	v_rcp_f32 v173, v173
	v_rcp_f32 v174, v174
	v_rcp_f32 v175, v175
	v_pk_mul_f32 v[32:33], v[32:33], v[160:161]
	v_pk_mul_f32 v[34:35], v[34:35], v[162:163]
	v_pk_mul_f32 v[36:37], v[36:37], v[164:165]
	v_pk_mul_f32 v[38:39], v[38:39], v[166:167]
	v_pk_mul_f32 v[40:41], v[40:41], v[168:169]
	v_pk_mul_f32 v[42:43], v[42:43], v[170:171]
	v_pk_mul_f32 v[44:45], v[44:45], v[172:173]
	v_pk_mul_f32 v[46:47], v[46:47], v[174:175]
	s_waitcnt vmcnt(9)
	v_mfma_f32_16x16x32_bf16 v[128:131], v[28:31], a[64:67], v[128:131]
	v_mfma_f32_16x16x32_bf16 v[132:135], v[26:29], a[64:67], v[132:135]
	s_waitcnt vmcnt(8)
	v_mfma_f32_16x16x32_bf16 v[128:131], v[28:31], a[72:75], v[128:131]
	v_mfma_f32_16x16x32_bf16 v[132:135], v[26:29], a[72:75], v[132:135]
	s_waitcnt vmcnt(7)
	v_mfma_f32_16x16x32_bf16 v[128:131], v[28:31], a[80:83], v[128:131]
	v_mfma_f32_16x16x32_bf16 v[132:135], v[26:29], a[80:83], v[132:135]
	s_waitcnt vmcnt(6)
	v_mfma_f32_16x16x32_bf16 v[128:131], v[28:31], a[88:91], v[128:131]
	v_mfma_f32_16x16x32_bf16 v[132:135], v[26:29], a[88:91], v[132:135]
	s_waitcnt vmcnt(4)
	v_mfma_f32_16x16x32_bf16 v[128:131], v[28:31], a[96:99], v[128:131]
	v_mfma_f32_16x16x32_bf16 v[132:135], v[26:29], a[96:99], v[132:135]
	s_waitcnt vmcnt(3)
	v_mfma_f32_16x16x32_bf16 v[128:131], v[28:31], a[104:107], v[128:131]
	v_mfma_f32_16x16x32_bf16 v[132:135], v[26:29], a[104:107], v[132:135]
	s_waitcnt vmcnt(2)
	v_mfma_f32_16x16x32_bf16 v[128:131], v[28:31], a[112:115], v[128:131]
	v_mfma_f32_16x16x32_bf16 v[132:135], v[26:29], a[112:115], v[132:135]
	s_waitcnt vmcnt(1)
	v_mfma_f32_16x16x32_bf16 v[128:131], v[28:31], a[120:123], v[128:131]
	v_mfma_f32_16x16x32_bf16 v[132:135], v[26:29], a[120:123], v[132:135]
	s_mov_b32 s75, 0x80000
	s_branch L_c0_test
L_c0_wait:
	s_waitcnt vmcnt(0)
L_c0_got:
	v_cmp_eq_u32 vcc, 1, v25
	s_nop 0
	s_bfe_u32 s72, vcc_lo, 0x80000
	s_andn2_b32 s72, s72, s70
	s_cbranch_scc0 L_c0_poll
	s_or_b32 s70, s70, s72
	s_bcnt1_i32_b32 s73, s72
	s_cmp_eq_u32 s73, 1
	s_cbranch_scc1 L_c0_ld6
	s_cmp_eq_u32 s73, 2
	s_cbranch_scc1 L_c0_ld5
	s_cmp_eq_u32 s73, 3
	s_cbranch_scc1 L_c0_ld4
	s_cmp_eq_u32 s73, 4
	s_cbranch_scc1 L_c0_ld3
	s_cmp_eq_u32 s73, 5
	s_cbranch_scc1 L_c0_ld2
	s_cmp_eq_u32 s73, 6
	s_cbranch_scc1 L_c0_ld1
L_c0_ld0:
	s_ff1_i32_b32 s74, s72
	s_bitset0_b32 s72, s74
	s_lshl_b32 s74, s74, 11
	s_add_u32 s74, s74, s68
	buffer_load_dwordx4 a[64:67], v13, s[48:51], s74 offen offset:0 sc1
L_c0_ld1:
	s_ff1_i32_b32 s74, s72
	s_bitset0_b32 s72, s74
	s_lshl_b32 s74, s74, 11
	s_add_u32 s74, s74, s68
	buffer_load_dwordx4 a[72:75], v13, s[48:51], s74 offen offset:0 sc1
L_c0_ld2:
	s_ff1_i32_b32 s74, s72
	s_bitset0_b32 s72, s74
	s_lshl_b32 s74, s74, 11
	s_add_u32 s74, s74, s68
	buffer_load_dwordx4 a[80:83], v13, s[48:51], s74 offen offset:0 sc1
L_c0_ld3:
	s_ff1_i32_b32 s74, s72
	s_bitset0_b32 s72, s74
	s_lshl_b32 s74, s74, 11
	s_add_u32 s74, s74, s68
	buffer_load_dwordx4 a[88:91], v13, s[48:51], s74 offen offset:0 sc1
L_c0_ld4:
	s_ff1_i32_b32 s74, s72
	s_bitset0_b32 s72, s74
	s_lshl_b32 s74, s74, 11
	s_add_u32 s74, s74, s68
	buffer_load_dwordx4 a[96:99], v13, s[48:51], s74 offen offset:0 sc1
L_c0_ld5:
	s_ff1_i32_b32 s74, s72
	s_bitset0_b32 s72, s74
	s_lshl_b32 s74, s74, 11
	s_add_u32 s74, s74, s68
	buffer_load_dwordx4 a[104:107], v13, s[48:51], s74 offen offset:0 sc1
L_c0_ld6:
	s_ff1_i32_b32 s74, s72
	s_bitset0_b32 s72, s74
	s_lshl_b32 s74, s74, 11
	s_add_u32 s74, s74, s68
	buffer_load_dwordx4 a[112:115], v13, s[48:51], s74 offen offset:0 sc1
	buffer_load_dword v25, v24, s[48:51], 0 offen sc1
	s_cmp_eq_u32 s73, 1
	s_cbranch_scc1 L_c0_mm6
	s_cmp_eq_u32 s73, 2
	s_cbranch_scc1 L_c0_mm5
	s_cmp_eq_u32 s73, 3
	s_cbranch_scc1 L_c0_mm4
	s_cmp_eq_u32 s73, 4
	s_cbranch_scc1 L_c0_mm3
	s_cmp_eq_u32 s73, 5
	s_cbranch_scc1 L_c0_mm2
	s_cmp_eq_u32 s73, 6
	s_cbranch_scc1 L_c0_mm1
L_c0_mm0:
	s_waitcnt vmcnt(7)
	v_mfma_f32_16x16x32_bf16 v[128:131], v[28:31], a[64:67], v[128:131]
	v_mfma_f32_16x16x32_bf16 v[132:135], v[26:29], a[64:67], v[132:135]
L_c0_mm1:
	s_waitcnt vmcnt(6)
	v_mfma_f32_16x16x32_bf16 v[128:131], v[28:31], a[72:75], v[128:131]
	v_mfma_f32_16x16x32_bf16 v[132:135], v[26:29], a[72:75], v[132:135]
L_c0_mm2:
	s_waitcnt vmcnt(5)
	v_mfma_f32_16x16x32_bf16 v[128:131], v[28:31], a[80:83], v[128:131]
	v_mfma_f32_16x16x32_bf16 v[132:135], v[26:29], a[80:83], v[132:135]
L_c0_mm3:
	s_waitcnt vmcnt(4)
	v_mfma_f32_16x16x32_bf16 v[128:131], v[28:31], a[88:91], v[128:131]
	v_mfma_f32_16x16x32_bf16 v[132:135], v[26:29], a[88:91], v[132:135]
L_c0_mm4:
	s_waitcnt vmcnt(3)
	v_mfma_f32_16x16x32_bf16 v[128:131], v[28:31], a[96:99], v[128:131]
	v_mfma_f32_16x16x32_bf16 v[132:135], v[26:29], a[96:99], v[132:135]
L_c0_mm5:
	s_waitcnt vmcnt(2)
	v_mfma_f32_16x16x32_bf16 v[128:131], v[28:31], a[104:107], v[128:131]
	v_mfma_f32_16x16x32_bf16 v[132:135], v[26:29], a[104:107], v[132:135]
L_c0_mm6:
	s_waitcnt vmcnt(1)
	v_mfma_f32_16x16x32_bf16 v[128:131], v[28:31], a[112:115], v[128:131]
	v_mfma_f32_16x16x32_bf16 v[132:135], v[26:29], a[112:115], v[132:135]
L_c0_test:
	s_cmp_lg_u32 s70, 0xff
	s_cbranch_scc1 L_c0_wait
L_c0_end:
	s_mov_b32 s75, 0x80000
	s_branch L_c1_test
L_c1_wait:
	s_waitcnt vmcnt(0)
L_c1_got:
	v_cmp_eq_u32 vcc, 1, v25
	s_nop 0
	s_bfe_u32 s72, vcc_lo, 0x80008
	s_andn2_b32 s72, s72, s67
	s_cbranch_scc0 L_c1_poll
	s_or_b32 s67, s67, s72
	s_bcnt1_i32_b32 s73, s72
	s_cmp_eq_u32 s73, 1
	s_cbranch_scc1 L_c1_ld6
	s_cmp_eq_u32 s73, 2
	s_cbranch_scc1 L_c1_ld5
	s_cmp_eq_u32 s73, 3
	s_cbranch_scc1 L_c1_ld4
	s_cmp_eq_u32 s73, 4
	s_cbranch_scc1 L_c1_ld3
	s_cmp_eq_u32 s73, 5
	s_cbranch_scc1 L_c1_ld2
	s_cmp_eq_u32 s73, 6
	s_cbranch_scc1 L_c1_ld1
L_c1_ld0:
	s_ff1_i32_b32 s74, s72
	s_bitset0_b32 s72, s74
	s_lshl_b32 s74, s74, 11
	s_add_u32 s74, s74, s68
	buffer_load_dwordx4 a[68:71], v13, s[48:51], s74 offen offset:1024 sc1
L_c1_ld1:
	s_ff1_i32_b32 s74, s72
	s_bitset0_b32 s72, s74
	s_lshl_b32 s74, s74, 11
	s_add_u32 s74, s74, s68
	buffer_load_dwordx4 a[76:79], v13, s[48:51], s74 offen offset:1024 sc1
L_c1_ld2:
	s_ff1_i32_b32 s74, s72
	s_bitset0_b32 s72, s74
	s_lshl_b32 s74, s74, 11
	s_add_u32 s74, s74, s68
	buffer_load_dwordx4 a[84:87], v13, s[48:51], s74 offen offset:1024 sc1
L_c1_ld3:
	s_ff1_i32_b32 s74, s72
	s_bitset0_b32 s72, s74
	s_lshl_b32 s74, s74, 11
	s_add_u32 s74, s74, s68
	buffer_load_dwordx4 a[92:95], v13, s[48:51], s74 offen offset:1024 sc1
L_c1_ld4:
	s_ff1_i32_b32 s74, s72
	s_bitset0_b32 s72, s74
	s_lshl_b32 s74, s74, 11
	s_add_u32 s74, s74, s68
	buffer_load_dwordx4 a[100:103], v13, s[48:51], s74 offen offset:1024 sc1
L_c1_ld5:
	s_ff1_i32_b32 s74, s72
	s_bitset0_b32 s72, s74
	s_lshl_b32 s74, s74, 11
	s_add_u32 s74, s74, s68
	buffer_load_dwordx4 a[108:111], v13, s[48:51], s74 offen offset:1024 sc1
L_c1_ld6:
	s_ff1_i32_b32 s74, s72
	s_bitset0_b32 s72, s74
	s_lshl_b32 s74, s74, 11
	s_add_u32 s74, s74, s68
	buffer_load_dwordx4 a[116:119], v13, s[48:51], s74 offen offset:1024 sc1
	buffer_load_dword v25, v24, s[48:51], 0 offen sc1
	s_cmp_eq_u32 s73, 1
	s_cbranch_scc1 L_c1_mm6
	s_cmp_eq_u32 s73, 2
	s_cbranch_scc1 L_c1_mm5
	s_cmp_eq_u32 s73, 3
	s_cbranch_scc1 L_c1_mm4
	s_cmp_eq_u32 s73, 4
	s_cbranch_scc1 L_c1_mm3
	s_cmp_eq_u32 s73, 5
	s_cbranch_scc1 L_c1_mm2
	s_cmp_eq_u32 s73, 6
	s_cbranch_scc1 L_c1_mm1
L_c1_mm0:
	s_waitcnt vmcnt(7)
	v_mfma_f32_16x16x32_bf16 v[136:139], v[28:31], a[68:71], v[136:139]
	v_mfma_f32_16x16x32_bf16 v[140:143], v[26:29], a[68:71], v[140:143]
L_c1_mm1:
	s_waitcnt vmcnt(6)
	v_mfma_f32_16x16x32_bf16 v[136:139], v[28:31], a[76:79], v[136:139]
	v_mfma_f32_16x16x32_bf16 v[140:143], v[26:29], a[76:79], v[140:143]
L_c1_mm2:
	s_waitcnt vmcnt(5)
	v_mfma_f32_16x16x32_bf16 v[136:139], v[28:31], a[84:87], v[136:139]
	v_mfma_f32_16x16x32_bf16 v[140:143], v[26:29], a[84:87], v[140:143]
L_c1_mm3:
	s_waitcnt vmcnt(4)
	v_mfma_f32_16x16x32_bf16 v[136:139], v[28:31], a[92:95], v[136:139]
	v_mfma_f32_16x16x32_bf16 v[140:143], v[26:29], a[92:95], v[140:143]
L_c1_mm4:
	s_waitcnt vmcnt(3)
	v_mfma_f32_16x16x32_bf16 v[136:139], v[28:31], a[100:103], v[136:139]
	v_mfma_f32_16x16x32_bf16 v[140:143], v[26:29], a[100:103], v[140:143]
L_c1_mm5:
	s_waitcnt vmcnt(2)
	v_mfma_f32_16x16x32_bf16 v[136:139], v[28:31], a[108:111], v[136:139]
	v_mfma_f32_16x16x32_bf16 v[140:143], v[26:29], a[108:111], v[140:143]
L_c1_mm6:
	s_waitcnt vmcnt(1)
	v_mfma_f32_16x16x32_bf16 v[136:139], v[28:31], a[116:119], v[136:139]
	v_mfma_f32_16x16x32_bf16 v[140:143], v[26:29], a[116:119], v[140:143]
L_c1_test:
	s_cmp_lg_u32 s67, 0xff
	s_cbranch_scc1 L_c1_wait
L_c1_end:
	v_pk_fma_f32 v[48:49], v[128:129], v[32:33], v[48:49]
	v_pk_fma_f32 v[50:51], v[130:131], v[34:35], v[50:51]
	v_pk_fma_f32 v[52:53], v[132:133], v[36:37], v[52:53]
	v_pk_fma_f32 v[54:55], v[134:135], v[38:39], v[54:55]
	v_cvt_pk_bf16_f32 v160, v48, v49
	v_cvt_pk_bf16_f32 v162, v52, v53
	v_cvt_pk_bf16_f32 v161, v50, v51
	v_cvt_pk_bf16_f32 v163, v54, v55
	v_permlane32_swap_b32 v160, v162
	s_nop 0
	v_permlane32_swap_b32 v161, v163
	v_permlane16_swap_b32 v160, v162
	s_nop 0
	v_permlane16_swap_b32 v161, v163
	buffer_store_dwordx4 v[160:163], v16, s[40:43], s92 offen offset:0 sc1
	v_pk_fma_f32 v[56:57], v[136:137], v[40:41], v[56:57]
	v_pk_fma_f32 v[58:59], v[138:139], v[42:43], v[58:59]
	v_pk_fma_f32 v[60:61], v[140:141], v[44:45], v[60:61]
	v_pk_fma_f32 v[62:63], v[142:143], v[46:47], v[62:63]
	v_cvt_pk_bf16_f32 v164, v56, v57
	v_cvt_pk_bf16_f32 v166, v60, v61
	v_cvt_pk_bf16_f32 v165, v58, v59
	v_cvt_pk_bf16_f32 v167, v62, v63
	v_permlane32_swap_b32 v164, v166
	s_nop 0
	v_permlane32_swap_b32 v165, v167
	v_permlane16_swap_b32 v164, v166
	s_nop 0
	v_permlane16_swap_b32 v165, v167
	buffer_store_dwordx4 v[164:167], v16, s[40:43], s92 offen offset:512 sc1
L_end:
	s_endpgm
L_mlp6:
	s_waitcnt vmcnt(0) lgkmcnt(0)
	s_and_b32 s72, s62, 1
	v_lshl_add_u32 v56, s72, 15, v13
	v_xor_b32 v57, 0x8000, v56
	s_lshr_b32 s72, s62, 1
	s_add_u32 s72, s72, 4
	ds_read_b64_tr_b16 a[0:1], v1 offset:0
	ds_read_b64_tr_b16 a[2:3], v1 offset:2048
	ds_read_b64_tr_b16 a[4:5], v1 offset:4096
	ds_read_b64_tr_b16 a[6:7], v1 offset:6144
	ds_read_b64_tr_b16 a[8:9], v2 offset:0
	ds_read_b64_tr_b16 a[10:11], v2 offset:2048
	ds_read_b64_tr_b16 a[12:13], v2 offset:4096
	ds_read_b64_tr_b16 a[14:15], v2 offset:6144
	s_barrier
	ds_read_b128 a[32:35], v56 offset:0
	ds_read_b128 a[48:51], v56 offset:1024
	ds_read_b128 a[52:55], v56 offset:17408
	ds_read_b128 a[36:39], v56 offset:16384
	ds_read_b128 a[40:43], v57 offset:0
	ds_read_b128 a[56:59], v57 offset:1024
	ds_read_b128 a[60:63], v57 offset:17408
	ds_read_b128 a[44:47], v57 offset:16384
	s_waitcnt lgkmcnt(7)
	v_mfma_f32_16x16x32_bf16 v[64:67], a[0:3], a[32:35], 0
	s_waitcnt lgkmcnt(6)
	ds_read_b128 a[64:67], v56 offset:2048
	v_lshl_add_u32 v26, s62, 10, v56
	v_mfma_f32_16x16x32_bf16 v[64:67], a[4:7], a[48:51], v[64:67]
	s_waitcnt lgkmcnt(6)
	ds_read_b128 a[80:83], v56 offset:3072
	v_mov_b32 v28, 0xc0135761
	v_mfma_f32_16x16x32_bf16 v[68:71], a[4:7], a[52:55], 0
	s_waitcnt lgkmcnt(6)
	ds_read_b128 a[68:71], v56 offset:18432
	v_xor_b32 v27, 0x8000, v26
	v_mfma_f32_16x16x32_bf16 v[68:71], a[0:3], a[36:39], v[68:71]
	s_waitcnt lgkmcnt(6)
	ds_read_b64_tr_b16 a[16:17], v3 offset:0
	ds_read_b128 a[84:87], v56 offset:19456
	v_mfma_f32_16x16x32_bf16 v[72:75], a[0:3], a[40:43], 0
	s_waitcnt lgkmcnt(7)
	ds_read_b64_tr_b16 a[18:19], v3 offset:2048
	ds_read_b128 a[72:75], v57 offset:2048
	v_mfma_f32_16x16x32_bf16 v[72:75], a[4:7], a[56:59], v[72:75]
	s_waitcnt lgkmcnt(8)
	ds_read_b64_tr_b16 a[20:21], v3 offset:4096
	ds_read_b128 a[88:91], v57 offset:3072
	v_mfma_f32_16x16x32_bf16 v[76:79], a[4:7], a[60:63], 0
	s_waitcnt lgkmcnt(9)
	ds_read_b64_tr_b16 a[22:23], v3 offset:6144
	ds_read_b128 a[76:79], v57 offset:18432
	v_mfma_f32_16x16x32_bf16 v[76:79], a[0:3], a[44:47], v[76:79]
	ds_read_b128 a[92:95], v57 offset:19456
	v_lshl_add_u32 v30, s72, 10, v56
	v_mfma_f32_16x16x32_bf16 v[92:95], a[8:11], a[44:47], 0
	ds_read_b64_tr_b16 a[24:25], v4 offset:0
	v_lshlrev_b32 v32, 7, v0
	v_mfma_f32_16x16x32_bf16 v[92:95], a[12:15], a[60:63], v[92:95]
	ds_read_b64_tr_b16 a[26:27], v4 offset:2048
	v_mov_b32 v33, 0x40000000
	v_mfma_f32_16x16x32_bf16 v[88:91], a[12:15], a[56:59], 0
	ds_read_b64_tr_b16 a[28:29], v4 offset:4096
	v_cmp_gt_u32 vcc, 2, v0
	v_mfma_f32_16x16x32_bf16 v[88:91], a[8:11], a[40:43], v[88:91]
	ds_read_b64_tr_b16 a[30:31], v4 offset:6144
	v_and_b32 v34, 7, v0
	v_mfma_f32_16x16x32_bf16 v[84:87], a[8:11], a[36:39], 0
	v_lshl_add_u32 v24, v34, 2, s90
	v_cndmask_b32 v22, v33, v32, vcc
	v_mfma_f32_16x16x32_bf16 v[84:87], a[12:15], a[52:55], v[84:87]
	v_and_b32 v32, 15, v0
	v_lshlrev_b32 v32, 10, v32
	v_mfma_f32_16x16x32_bf16 v[80:83], a[12:15], a[48:51], 0
	ds_read_b64_tr_b16 a[0:1], v1 offset:8192
	ds_read_b64_tr_b16 a[2:3], v1 offset:10240
	v_mfma_f32_16x16x32_bf16 v[80:83], a[8:11], a[32:35], v[80:83]
	s_waitcnt lgkmcnt(9)
	ds_read_b64_tr_b16 a[4:5], v1 offset:12288
	ds_read_b64_tr_b16 a[6:7], v1 offset:14336
	v_mfma_f32_16x16x32_bf16 v[96:99], a[16:19], a[32:35], 0
	s_waitcnt lgkmcnt(9)
	v_lshrrev_b32 v33, 4, v0
	v_lshl_or_b32 v17, v33, 3, v32
	v_mfma_f32_16x16x32_bf16 v[96:99], a[20:23], a[48:51], v[96:99]
	ds_read_b64_tr_b16 a[8:9], v2 offset:8192
	v_mfma_f32_16x16x32_bf16 v[100:103], a[20:23], a[52:55], 0
	ds_read_b64_tr_b16 a[10:11], v2 offset:10240
	v_mfma_f32_16x16x32_bf16 v[100:103], a[16:19], a[36:39], v[100:103]
	s_waitcnt lgkmcnt(8)
	v_mfma_f32_16x16x32_bf16 v[116:119], a[24:27], a[36:39], 0
	s_waitcnt lgkmcnt(6)
	s_add_u32 m0, s64, 0x0
	ds_read_b64_tr_b16 a[12:13], v2 offset:12288
	v_mfma_f32_16x16x32_bf16 v[116:119], a[28:31], a[52:55], v[116:119]
	s_mov_b32 s66, 0xa8000
	ds_read_b64_tr_b16 a[14:15], v2 offset:14336
	v_mfma_f32_16x16x32_bf16 v[112:115], a[28:31], a[48:51], 0
	buffer_load_dwordx4 v15, s[32:35], s66 offen offset:0 lds
	v_mfma_f32_16x16x32_bf16 v[112:115], a[24:27], a[32:35], v[112:115]
	s_waitcnt lgkmcnt(6)
	v_mfma_f32_16x16x32_bf16 v[64:67], a[0:3], a[64:67], v[64:67]
	s_waitcnt lgkmcnt(4)
	s_mov_b32 s66, 0xaec00
	ds_read_b64_tr_b16 a[24:25], v4 offset:8192
	ds_read_b128 a[32:35], v56 offset:4096
	v_mfma_f32_16x16x32_bf16 v[64:67], a[4:7], a[80:83], v[64:67]
	buffer_load_dwordx4 v15, s[32:35], s66 offen offset:1024 lds
	v_mfma_f32_16x16x32_bf16 v[68:71], a[4:7], a[84:87], v[68:71]
	ds_read_b64_tr_b16 a[16:17], v3 offset:8192
	ds_read_b128 a[48:51], v56 offset:5120
	v_mfma_f32_16x16x32_bf16 v[68:71], a[0:3], a[68:71], v[68:71]
	s_mov_b32 s66, 0xb5800
	ds_read_b64_tr_b16 a[18:19], v3 offset:10240
	ds_read_b128 a[36:39], v56 offset:20480
	v_mfma_f32_16x16x32_bf16 v[72:75], a[0:3], a[72:75], v[72:75]
	buffer_load_dwordx4 v15, s[32:35], s66 offen offset:2048 lds
	v_mfma_f32_16x16x32_bf16 v[72:75], a[4:7], a[88:91], v[72:75]
	ds_read_b64_tr_b16 a[20:21], v3 offset:12288
	ds_read_b128 a[52:55], v56 offset:21504
	v_mfma_f32_16x16x32_bf16 v[76:79], a[4:7], a[92:95], v[76:79]
	s_mov_b32 s66, 0xbc400
	ds_read_b64_tr_b16 a[22:23], v3 offset:14336
	ds_read_b128 a[40:43], v57 offset:4096
	v_mfma_f32_16x16x32_bf16 v[76:79], a[0:3], a[76:79], v[76:79]
	s_waitcnt lgkmcnt(10)
	buffer_load_dwordx4 v15, s[32:35], s66 offen offset:3072 lds
	v_mfma_f32_16x16x32_bf16 v[92:95], a[8:11], a[76:79], v[92:95]
	s_add_u32 m0, s64, 0x1000
	ds_read_b64_tr_b16 a[26:27], v4 offset:10240
	ds_read_b128 a[56:59], v57 offset:5120
	v_mfma_f32_16x16x32_bf16 v[92:95], a[12:15], a[92:95], v[92:95]
	s_mov_b32 s66, 0xc4000
	ds_read_b64_tr_b16 a[28:29], v4 offset:12288
	ds_read_b128 a[44:47], v57 offset:20480
	v_mfma_f32_16x16x32_bf16 v[88:91], a[12:15], a[88:91], v[88:91]
	buffer_load_dwordx4 v15, s[32:35], s66 offen offset:0 lds
	v_mfma_f32_16x16x32_bf16 v[88:91], a[8:11], a[72:75], v[88:91]
	ds_read_b64_tr_b16 a[30:31], v4 offset:14336
	ds_read_b128 a[60:63], v57 offset:21504
	v_mfma_f32_16x16x32_bf16 v[84:87], a[8:11], a[68:71], v[84:87]
	s_mov_b32 s66, 0xcac00
	v_mfma_f32_16x16x32_bf16 v[84:87], a[12:15], a[84:87], v[84:87]
L_pg27:
	s_cbranch_execz L_pg21
	buffer_load_dwordx4 v15, s[32:35], s66 offen offset:1024 lds
	v_mfma_f32_16x16x32_bf16 v[80:83], a[12:15], a[80:83], v[80:83]
	s_mov_b32 s66, 0xd1800
	ds_read_b64_tr_b16 a[0:1], v1 offset:16384
	ds_read_b64_tr_b16 a[2:3], v1 offset:18432
	v_mfma_f32_16x16x32_bf16 v[80:83], a[8:11], a[64:67], v[80:83]
	s_waitcnt lgkmcnt(10)
	ds_read_b64_tr_b16 a[4:5], v1 offset:20480
	ds_read_b64_tr_b16 a[6:7], v1 offset:22528
	v_mfma_f32_16x16x32_bf16 v[96:99], a[16:19], a[64:67], v[96:99]
	s_waitcnt lgkmcnt(10)
	buffer_load_dwordx4 v15, s[32:35], s66 offen offset:2048 lds
	v_mfma_f32_16x16x32_bf16 v[96:99], a[20:23], a[80:83], v[96:99]
	ds_read_b64_tr_b16 a[8:9], v2 offset:16384
	v_mfma_f32_16x16x32_bf16 v[100:103], a[20:23], a[84:87], v[100:103]
	s_mov_b32 s66, 0xd8400
	ds_read_b64_tr_b16 a[10:11], v2 offset:18432
	v_mfma_f32_16x16x32_bf16 v[100:103], a[16:19], a[68:71], v[100:103]
	s_waitcnt lgkmcnt(8)
	buffer_load_dwordx4 v15, s[32:35], s66 offen offset:3072 lds
	v_mfma_f32_16x16x32_bf16 v[116:119], a[24:27], a[68:71], v[116:119]
	s_waitcnt lgkmcnt(7)
	s_add_u32 m0, s64, 0x2000
	ds_read_b64_tr_b16 a[12:13], v2 offset:20480
	v_mfma_f32_16x16x32_bf16 v[116:119], a[28:31], a[84:87], v[116:119]
	s_mov_b32 s66, 0xe0000
	ds_read_b64_tr_b16 a[14:15], v2 offset:22528
	v_mfma_f32_16x16x32_bf16 v[112:115], a[28:31], a[80:83], v[112:115]
	buffer_load_dwordx4 v15, s[32:35], s66 offen offset:0 lds
	v_mfma_f32_16x16x32_bf16 v[112:115], a[24:27], a[64:67], v[112:115]
	s_waitcnt lgkmcnt(6)
	v_mfma_f32_16x16x32_bf16 v[64:67], a[0:3], a[32:35], v[64:67]
	s_waitcnt lgkmcnt(4)
	s_mov_b32 s66, 0xe6c00
	ds_read_b64_tr_b16 a[24:25], v4 offset:16384
	ds_read_b128 a[64:67], v56 offset:6144
	v_mfma_f32_16x16x32_bf16 v[64:67], a[4:7], a[48:51], v[64:67]
	buffer_load_dwordx4 v15, s[32:35], s66 offen offset:1024 lds
	v_mfma_f32_16x16x32_bf16 v[68:71], a[4:7], a[52:55], v[68:71]
	ds_read_b64_tr_b16 a[16:17], v3 offset:16384
	ds_read_b128 a[80:83], v56 offset:7168
	v_mfma_f32_16x16x32_bf16 v[68:71], a[0:3], a[36:39], v[68:71]
	s_mov_b32 s66, 0xed800
	ds_read_b64_tr_b16 a[18:19], v3 offset:18432
	ds_read_b128 a[68:71], v56 offset:22528
	v_mfma_f32_16x16x32_bf16 v[72:75], a[0:3], a[40:43], v[72:75]
	buffer_load_dwordx4 v15, s[32:35], s66 offen offset:2048 lds
	v_mfma_f32_16x16x32_bf16 v[72:75], a[4:7], a[56:59], v[72:75]
	ds_read_b64_tr_b16 a[20:21], v3 offset:20480
	ds_read_b128 a[84:87], v56 offset:23552
	v_mfma_f32_16x16x32_bf16 v[76:79], a[4:7], a[60:63], v[76:79]
	s_mov_b32 s66, 0xf4400
	ds_read_b64_tr_b16 a[22:23], v3 offset:22528
	ds_read_b128 a[72:75], v57 offset:6144
	v_mfma_f32_16x16x32_bf16 v[76:79], a[0:3], a[44:47], v[76:79]
	s_waitcnt lgkmcnt(10)
	buffer_load_dwordx4 v15, s[32:35], s66 offen offset:3072 lds
	v_mfma_f32_16x16x32_bf16 v[92:95], a[8:11], a[44:47], v[92:95]
	s_add_u32 m0, s64, 0x3000
	ds_read_b64_tr_b16 a[26:27], v4 offset:18432
	ds_read_b128 a[88:91], v57 offset:7168
	v_mfma_f32_16x16x32_bf16 v[92:95], a[12:15], a[60:63], v[92:95]
	s_mov_b32 s66, 0xfc000
	ds_read_b64_tr_b16 a[28:29], v4 offset:20480
	ds_read_b128 a[76:79], v57 offset:22528
	v_mfma_f32_16x16x32_bf16 v[88:91], a[12:15], a[56:59], v[88:91]
	buffer_load_dwordx4 v15, s[32:35], s66 offen offset:0 lds
	v_mfma_f32_16x16x32_bf16 v[88:91], a[8:11], a[40:43], v[88:91]
	ds_read_b64_tr_b16 a[30:31], v4 offset:22528
	ds_read_b128 a[92:95], v57 offset:23552
	v_mfma_f32_16x16x32_bf16 v[84:87], a[8:11], a[36:39], v[84:87]
	s_mov_b32 s66, 0x102c00
	v_mfma_f32_16x16x32_bf16 v[84:87], a[12:15], a[52:55], v[84:87]
	buffer_load_dwordx4 v15, s[32:35], s66 offen offset:1024 lds
	v_mfma_f32_16x16x32_bf16 v[80:83], a[12:15], a[48:51], v[80:83]
	s_waitcnt vmcnt(10)
	s_mov_b32 s66, 0x109800
	ds_read_b64_tr_b16 a[0:1], v1 offset:0
	ds_read_b64_tr_b16 a[2:3], v1 offset:2048
	v_mfma_f32_16x16x32_bf16 v[80:83], a[8:11], a[32:35], v[80:83]
	s_waitcnt vmcnt(6) lgkmcnt(10)
	ds_read_b64_tr_b16 a[4:5], v1 offset:4096
	ds_read_b64_tr_b16 a[6:7], v1 offset:6144
	v_mfma_f32_16x16x32_bf16 v[96:99], a[16:19], a[32:35], v[96:99]
	s_waitcnt lgkmcnt(10)
	buffer_load_dwordx4 v15, s[32:35], s66 offen offset:2048 lds
	v_mfma_f32_16x16x32_bf16 v[96:99], a[20:23], a[48:51], v[96:99]
	ds_read_b64_tr_b16 a[8:9], v2 offset:0
	v_mfma_f32_16x16x32_bf16 v[100:103], a[20:23], a[52:55], v[100:103]
	s_mov_b32 s66, 0x110400
	ds_read_b64_tr_b16 a[10:11], v2 offset:2048
	v_mfma_f32_16x16x32_bf16 v[100:103], a[16:19], a[36:39], v[100:103]
	s_waitcnt lgkmcnt(8)
	buffer_load_dwordx4 v15, s[32:35], s66 offen offset:3072 lds
	v_mfma_f32_16x16x32_bf16 v[116:119], a[24:27], a[36:39], v[116:119]
	s_waitcnt lgkmcnt(7)
	s_add_u32 m0, s64, 0x4000
	ds_read_b64_tr_b16 a[12:13], v2 offset:4096
	v_mfma_f32_16x16x32_bf16 v[116:119], a[28:31], a[52:55], v[116:119]
	s_mov_b32 s66, 0x118000
	ds_read_b64_tr_b16 a[14:15], v2 offset:6144
	v_mfma_f32_16x16x32_bf16 v[112:115], a[28:31], a[48:51], v[112:115]
	buffer_load_dwordx4 v15, s[32:35], s66 offen offset:0 lds
	v_mfma_f32_16x16x32_bf16 v[112:115], a[24:27], a[32:35], v[112:115]
	s_waitcnt lgkmcnt(6)
	v_mfma_f32_16x16x32_bf16 v[64:67], a[0:3], a[64:67], v[64:67]
	s_waitcnt lgkmcnt(4)
	s_mov_b32 s66, 0x11ec00
	ds_read_b64_tr_b16 a[24:25], v4 offset:0
	ds_read_b128 a[32:35], v56 offset:8192
	v_mfma_f32_16x16x32_bf16 v[64:67], a[4:7], a[80:83], v[64:67]
	buffer_load_dwordx4 v15, s[32:35], s66 offen offset:1024 lds
	v_mfma_f32_16x16x32_bf16 v[68:71], a[4:7], a[84:87], v[68:71]
	ds_read_b64_tr_b16 a[16:17], v3 offset:0
	ds_read_b128 a[48:51], v56 offset:9216
	v_mfma_f32_16x16x32_bf16 v[68:71], a[0:3], a[68:71], v[68:71]
	s_mov_b32 s66, 0x125800
	ds_read_b64_tr_b16 a[18:19], v3 offset:2048
	ds_read_b128 a[36:39], v56 offset:24576
	v_mfma_f32_16x16x32_bf16 v[72:75], a[0:3], a[72:75], v[72:75]
	buffer_load_dwordx4 v15, s[32:35], s66 offen offset:2048 lds
	v_mfma_f32_16x16x32_bf16 v[72:75], a[4:7], a[88:91], v[72:75]
	ds_read_b64_tr_b16 a[20:21], v3 offset:4096
	ds_read_b128 a[52:55], v56 offset:25600
	v_mfma_f32_16x16x32_bf16 v[76:79], a[4:7], a[92:95], v[76:79]
	s_mov_b32 s66, 0x12c400
	ds_read_b64_tr_b16 a[22:23], v3 offset:6144
	ds_read_b128 a[40:43], v57 offset:8192
	v_mfma_f32_16x16x32_bf16 v[76:79], a[0:3], a[76:79], v[76:79]
	s_waitcnt lgkmcnt(10)
	buffer_load_dwordx4 v15, s[32:35], s66 offen offset:3072 lds
	v_mfma_f32_16x16x32_bf16 v[92:95], a[8:11], a[76:79], v[92:95]
	s_add_u32 m0, s64, 0x5000
	ds_read_b64_tr_b16 a[26:27], v4 offset:2048
	ds_read_b128 a[56:59], v57 offset:9216
	v_mfma_f32_16x16x32_bf16 v[92:95], a[12:15], a[92:95], v[92:95]
	s_mov_b32 s66, 0x134000
	ds_read_b64_tr_b16 a[28:29], v4 offset:4096
	ds_read_b128 a[44:47], v57 offset:24576
	v_mfma_f32_16x16x32_bf16 v[88:91], a[12:15], a[88:91], v[88:91]
	buffer_load_dwordx4 v15, s[32:35], s66 offen offset:0 lds
	v_mfma_f32_16x16x32_bf16 v[88:91], a[8:11], a[72:75], v[88:91]
	ds_read_b64_tr_b16 a[30:31], v4 offset:6144
	ds_read_b128 a[60:63], v57 offset:25600
	v_mfma_f32_16x16x32_bf16 v[84:87], a[8:11], a[68:71], v[84:87]
	s_mov_b32 s66, 0x13ac00
	v_mfma_f32_16x16x32_bf16 v[84:87], a[12:15], a[84:87], v[84:87]
	buffer_load_dwordx4 v15, s[32:35], s66 offen offset:1024 lds
	v_mfma_f32_16x16x32_bf16 v[80:83], a[12:15], a[80:83], v[80:83]
	s_waitcnt vmcnt(10)
	s_mov_b32 s66, 0x141800
	ds_read_b64_tr_b16 a[0:1], v1 offset:8192
	ds_read_b64_tr_b16 a[2:3], v1 offset:10240
	v_mfma_f32_16x16x32_bf16 v[80:83], a[8:11], a[64:67], v[80:83]
	s_waitcnt vmcnt(6) lgkmcnt(10)
	ds_read_b64_tr_b16 a[4:5], v1 offset:12288
	ds_read_b64_tr_b16 a[6:7], v1 offset:14336
	v_mfma_f32_16x16x32_bf16 v[96:99], a[16:19], a[64:67], v[96:99]
	s_waitcnt lgkmcnt(10)
	buffer_load_dwordx4 v15, s[32:35], s66 offen offset:2048 lds
	v_mfma_f32_16x16x32_bf16 v[96:99], a[20:23], a[80:83], v[96:99]
	ds_read_b64_tr_b16 a[8:9], v2 offset:8192
	v_mfma_f32_16x16x32_bf16 v[100:103], a[20:23], a[84:87], v[100:103]
	s_mov_b32 s66, 0x148400
	ds_read_b64_tr_b16 a[10:11], v2 offset:10240
	v_mfma_f32_16x16x32_bf16 v[100:103], a[16:19], a[68:71], v[100:103]
	s_waitcnt lgkmcnt(8)
	buffer_load_dwordx4 v15, s[32:35], s66 offen offset:3072 lds
	v_mfma_f32_16x16x32_bf16 v[116:119], a[24:27], a[68:71], v[116:119]
	s_waitcnt lgkmcnt(7)
	s_add_u32 m0, s64, 0x0
	ds_read_b64_tr_b16 a[12:13], v2 offset:12288
	v_mfma_f32_16x16x32_bf16 v[116:119], a[28:31], a[84:87], v[116:119]
	s_mov_b32 s66, 0x150000
	ds_read_b64_tr_b16 a[14:15], v2 offset:14336
	v_mfma_f32_16x16x32_bf16 v[112:115], a[28:31], a[80:83], v[112:115]
	buffer_load_dwordx4 v15, s[32:35], s66 offen offset:0 lds
	v_mfma_f32_16x16x32_bf16 v[112:115], a[24:27], a[64:67], v[112:115]
	s_waitcnt lgkmcnt(6)
	v_mfma_f32_16x16x32_bf16 v[64:67], a[0:3], a[32:35], v[64:67]
	s_waitcnt lgkmcnt(4)
	s_mov_b32 s66, 0x156c00
	ds_read_b64_tr_b16 a[24:25], v4 offset:8192
	ds_read_b128 a[64:67], v56 offset:10240
	v_mfma_f32_16x16x32_bf16 v[64:67], a[4:7], a[48:51], v[64:67]
	buffer_load_dwordx4 v15, s[32:35], s66 offen offset:1024 lds
	v_mfma_f32_16x16x32_bf16 v[68:71], a[4:7], a[52:55], v[68:71]
	ds_read_b64_tr_b16 a[16:17], v3 offset:8192
	ds_read_b128 a[80:83], v56 offset:11264
	v_mfma_f32_16x16x32_bf16 v[68:71], a[0:3], a[36:39], v[68:71]
	s_mov_b32 s66, 0x15d800
	ds_read_b64_tr_b16 a[18:19], v3 offset:10240
	ds_read_b128 a[68:71], v56 offset:26624
	v_mfma_f32_16x16x32_bf16 v[72:75], a[0:3], a[40:43], v[72:75]
	buffer_load_dwordx4 v15, s[32:35], s66 offen offset:2048 lds
	v_mfma_f32_16x16x32_bf16 v[72:75], a[4:7], a[56:59], v[72:75]
	ds_read_b64_tr_b16 a[20:21], v3 offset:12288
	ds_read_b128 a[84:87], v56 offset:27648
	v_mfma_f32_16x16x32_bf16 v[76:79], a[4:7], a[60:63], v[76:79]
	s_mov_b32 s66, 0x164400
	ds_read_b64_tr_b16 a[22:23], v3 offset:14336
	ds_read_b128 a[72:75], v57 offset:10240
	v_mfma_f32_16x16x32_bf16 v[76:79], a[0:3], a[44:47], v[76:79]
	s_waitcnt lgkmcnt(10)
	buffer_load_dwordx4 v15, s[32:35], s66 offen offset:3072 lds
	v_mfma_f32_16x16x32_bf16 v[92:95], a[8:11], a[44:47], v[92:95]
	s_add_u32 m0, s64, 0x1000
	ds_read_b64_tr_b16 a[26:27], v4 offset:10240
	ds_read_b128 a[88:91], v57 offset:11264
	v_mfma_f32_16x16x32_bf16 v[92:95], a[12:15], a[60:63], v[92:95]
	s_mov_b32 s66, 0x16c000
	ds_read_b64_tr_b16 a[28:29], v4 offset:12288
	ds_read_b128 a[76:79], v57 offset:26624
	v_mfma_f32_16x16x32_bf16 v[88:91], a[12:15], a[56:59], v[88:91]
	buffer_load_dwordx4 v15, s[32:35], s66 offen offset:0 lds
	v_mfma_f32_16x16x32_bf16 v[88:91], a[8:11], a[40:43], v[88:91]
	ds_read_b64_tr_b16 a[30:31], v4 offset:14336
	ds_read_b128 a[92:95], v57 offset:27648
	v_mfma_f32_16x16x32_bf16 v[84:87], a[8:11], a[36:39], v[84:87]
	s_mov_b32 s66, 0x172c00
	v_mfma_f32_16x16x32_bf16 v[84:87], a[12:15], a[52:55], v[84:87]
	buffer_load_dwordx4 v15, s[32:35], s66 offen offset:1024 lds
	v_mfma_f32_16x16x32_bf16 v[80:83], a[12:15], a[48:51], v[80:83]
	s_waitcnt vmcnt(10)
	s_mov_b32 s66, 0x179800
	ds_read_b64_tr_b16 a[0:1], v1 offset:16384
	ds_read_b64_tr_b16 a[2:3], v1 offset:18432
	v_mfma_f32_16x16x32_bf16 v[80:83], a[8:11], a[32:35], v[80:83]
	s_waitcnt vmcnt(6) lgkmcnt(10)
	ds_read_b64_tr_b16 a[4:5], v1 offset:20480
	ds_read_b64_tr_b16 a[6:7], v1 offset:22528
	v_mfma_f32_16x16x32_bf16 v[96:99], a[16:19], a[32:35], v[96:99]
	s_waitcnt lgkmcnt(10)
	buffer_load_dwordx4 v15, s[32:35], s66 offen offset:2048 lds
	v_mfma_f32_16x16x32_bf16 v[96:99], a[20:23], a[48:51], v[96:99]
	ds_read_b64_tr_b16 a[8:9], v2 offset:16384
	v_mfma_f32_16x16x32_bf16 v[100:103], a[20:23], a[52:55], v[100:103]
	s_mov_b32 s66, 0x180400
	ds_read_b64_tr_b16 a[10:11], v2 offset:18432
	v_mfma_f32_16x16x32_bf16 v[100:103], a[16:19], a[36:39], v[100:103]
	s_waitcnt lgkmcnt(8)
	buffer_load_dwordx4 v15, s[32:35], s66 offen offset:3072 lds
	v_mfma_f32_16x16x32_bf16 v[116:119], a[24:27], a[36:39], v[116:119]
	s_waitcnt lgkmcnt(7)
	s_add_u32 m0, s64, 0x2000
	ds_read_b64_tr_b16 a[12:13], v2 offset:20480
	v_mfma_f32_16x16x32_bf16 v[116:119], a[28:31], a[52:55], v[116:119]
	s_mov_b32 s66, 0x188000
	ds_read_b64_tr_b16 a[14:15], v2 offset:22528
	v_mfma_f32_16x16x32_bf16 v[112:115], a[28:31], a[48:51], v[112:115]
	buffer_load_dwordx4 v15, s[32:35], s66 offen offset:0 lds
	v_mfma_f32_16x16x32_bf16 v[112:115], a[24:27], a[32:35], v[112:115]
	s_waitcnt lgkmcnt(6)
	v_mfma_f32_16x16x32_bf16 v[64:67], a[0:3], a[64:67], v[64:67]
	s_waitcnt lgkmcnt(4)
	s_mov_b32 s66, 0x18ec00
	ds_read_b64_tr_b16 a[24:25], v4 offset:16384
	ds_read_b128 a[32:35], v56 offset:12288
	v_mfma_f32_16x16x32_bf16 v[64:67], a[4:7], a[80:83], v[64:67]
	buffer_load_dwordx4 v15, s[32:35], s66 offen offset:1024 lds
	v_mfma_f32_16x16x32_bf16 v[68:71], a[4:7], a[84:87], v[68:71]
	ds_read_b64_tr_b16 a[16:17], v3 offset:16384
	ds_read_b128 a[48:51], v56 offset:13312
	v_mfma_f32_16x16x32_bf16 v[68:71], a[0:3], a[68:71], v[68:71]
	s_mov_b32 s66, 0x195800
	ds_read_b64_tr_b16 a[18:19], v3 offset:18432
	ds_read_b128 a[36:39], v56 offset:28672
	v_mfma_f32_16x16x32_bf16 v[72:75], a[0:3], a[72:75], v[72:75]
	buffer_load_dwordx4 v15, s[32:35], s66 offen offset:2048 lds
	v_mfma_f32_16x16x32_bf16 v[72:75], a[4:7], a[88:91], v[72:75]
	ds_read_b64_tr_b16 a[20:21], v3 offset:20480
	ds_read_b128 a[52:55], v56 offset:29696
	v_mfma_f32_16x16x32_bf16 v[76:79], a[4:7], a[92:95], v[76:79]
	s_mov_b32 s66, 0x19c400
	ds_read_b64_tr_b16 a[22:23], v3 offset:22528
	ds_read_b128 a[40:43], v57 offset:12288
	v_mfma_f32_16x16x32_bf16 v[76:79], a[0:3], a[76:79], v[76:79]
	s_waitcnt lgkmcnt(10)
	buffer_load_dwordx4 v15, s[32:35], s66 offen offset:3072 lds
	v_mfma_f32_16x16x32_bf16 v[92:95], a[8:11], a[76:79], v[92:95]
	s_add_u32 m0, s64, 0x3000
	ds_read_b64_tr_b16 a[26:27], v4 offset:18432
	ds_read_b128 a[56:59], v57 offset:13312
	v_mfma_f32_16x16x32_bf16 v[92:95], a[12:15], a[92:95], v[92:95]
	s_mov_b32 s66, 0x1a4000
	ds_read_b64_tr_b16 a[28:29], v4 offset:20480
	ds_read_b128 a[44:47], v57 offset:28672
	v_mfma_f32_16x16x32_bf16 v[88:91], a[12:15], a[88:91], v[88:91]
	buffer_load_dwordx4 v15, s[32:35], s66 offen offset:0 lds
	v_mfma_f32_16x16x32_bf16 v[88:91], a[8:11], a[72:75], v[88:91]
	ds_read_b64_tr_b16 a[30:31], v4 offset:22528
	ds_read_b128 a[60:63], v57 offset:29696
	v_mfma_f32_16x16x32_bf16 v[84:87], a[8:11], a[68:71], v[84:87]
	s_mov_b32 s66, 0x1aac00
	v_mfma_f32_16x16x32_bf16 v[84:87], a[12:15], a[84:87], v[84:87]
	buffer_load_dwordx4 v15, s[32:35], s66 offen offset:1024 lds
	v_mfma_f32_16x16x32_bf16 v[80:83], a[12:15], a[80:83], v[80:83]
	s_waitcnt vmcnt(10)
	s_mov_b32 s66, 0x1b1800
	ds_read_b64_tr_b16 a[0:1], v1 offset:0
	ds_read_b64_tr_b16 a[2:3], v1 offset:2048
	v_mfma_f32_16x16x32_bf16 v[80:83], a[8:11], a[64:67], v[80:83]
	s_waitcnt vmcnt(6) lgkmcnt(10)
	ds_read_b64_tr_b16 a[4:5], v1 offset:4096
	ds_read_b64_tr_b16 a[6:7], v1 offset:6144
	v_mfma_f32_16x16x32_bf16 v[96:99], a[16:19], a[64:67], v[96:99]
	s_waitcnt lgkmcnt(10)
	buffer_load_dwordx4 v15, s[32:35], s66 offen offset:2048 lds
	v_mfma_f32_16x16x32_bf16 v[96:99], a[20:23], a[80:83], v[96:99]
	ds_read_b64_tr_b16 a[8:9], v2 offset:0
	v_mfma_f32_16x16x32_bf16 v[100:103], a[20:23], a[84:87], v[100:103]
	s_mov_b32 s66, 0x1b8400
	ds_read_b64_tr_b16 a[10:11], v2 offset:2048
	v_mfma_f32_16x16x32_bf16 v[100:103], a[16:19], a[68:71], v[100:103]
	s_waitcnt lgkmcnt(8)
	buffer_load_dwordx4 v15, s[32:35], s66 offen offset:3072 lds
	v_mfma_f32_16x16x32_bf16 v[116:119], a[24:27], a[68:71], v[116:119]
	s_waitcnt lgkmcnt(7)
	s_add_u32 m0, s64, 0x4000
	ds_read_b64_tr_b16 a[12:13], v2 offset:4096
	v_mfma_f32_16x16x32_bf16 v[116:119], a[28:31], a[84:87], v[116:119]
	s_mov_b32 s66, 0x0
	ds_read_b64_tr_b16 a[14:15], v2 offset:6144
	v_mfma_f32_16x16x32_bf16 v[112:115], a[28:31], a[80:83], v[112:115]
	buffer_load_dwordx4 v16, s[36:39], s66 offen offset:0 lds
	v_mfma_f32_16x16x32_bf16 v[112:115], a[24:27], a[64:67], v[112:115]
	s_waitcnt lgkmcnt(6)
	v_mfma_f32_16x16x32_bf16 v[64:67], a[0:3], a[32:35], v[64:67]
	s_waitcnt lgkmcnt(4)
	s_mov_b32 s66, 0x1c00
	ds_read_b64_tr_b16 a[24:25], v4 offset:0
	ds_read_b128 a[64:67], v56 offset:14336
	v_mfma_f32_16x16x32_bf16 v[64:67], a[4:7], a[48:51], v[64:67]
	buffer_load_dwordx4 v16, s[36:39], s66 offen offset:1024 lds
	v_mfma_f32_16x16x32_bf16 v[68:71], a[4:7], a[52:55], v[68:71]
	ds_read_b64_tr_b16 a[16:17], v3 offset:0
	ds_read_b128 a[80:83], v56 offset:15360
	v_mfma_f32_16x16x32_bf16 v[68:71], a[0:3], a[36:39], v[68:71]
	s_mov_b32 s66, 0x3800
	ds_read_b64_tr_b16 a[18:19], v3 offset:2048
	ds_read_b128 a[68:71], v56 offset:30720
	v_mfma_f32_16x16x32_bf16 v[72:75], a[0:3], a[40:43], v[72:75]
	buffer_load_dwordx4 v16, s[36:39], s66 offen offset:2048 lds
	v_mfma_f32_16x16x32_bf16 v[72:75], a[4:7], a[56:59], v[72:75]
	ds_read_b64_tr_b16 a[20:21], v3 offset:4096
	ds_read_b128 a[84:87], v56 offset:31744
	v_mfma_f32_16x16x32_bf16 v[76:79], a[4:7], a[60:63], v[76:79]
	s_mov_b32 s66, 0x5400
	ds_read_b64_tr_b16 a[22:23], v3 offset:6144
	ds_read_b128 a[72:75], v57 offset:14336
	v_mfma_f32_16x16x32_bf16 v[76:79], a[0:3], a[44:47], v[76:79]
	s_waitcnt lgkmcnt(10)
	buffer_load_dwordx4 v16, s[36:39], s66 offen offset:3072 lds
	v_mfma_f32_16x16x32_bf16 v[92:95], a[8:11], a[44:47], v[92:95]
	s_add_u32 m0, s64, 0x5000
	ds_read_b64_tr_b16 a[26:27], v4 offset:2048
	ds_read_b128 a[88:91], v57 offset:15360
	v_mfma_f32_16x16x32_bf16 v[92:95], a[12:15], a[60:63], v[92:95]
	s_mov_b32 s66, 0x8000
	ds_read_b64_tr_b16 a[28:29], v4 offset:4096
	ds_read_b128 a[76:79], v57 offset:30720
	v_mfma_f32_16x16x32_bf16 v[88:91], a[12:15], a[56:59], v[88:91]
	buffer_load_dwordx4 v16, s[36:39], s66 offen offset:0 lds
	v_mfma_f32_16x16x32_bf16 v[88:91], a[8:11], a[40:43], v[88:91]
	ds_read_b64_tr_b16 a[30:31], v4 offset:6144
	ds_read_b128 a[92:95], v57 offset:31744
	v_mfma_f32_16x16x32_bf16 v[84:87], a[8:11], a[36:39], v[84:87]
	s_mov_b32 s66, 0x9c00
	v_mfma_f32_16x16x32_bf16 v[84:87], a[12:15], a[52:55], v[84:87]
	buffer_load_dwordx4 v16, s[36:39], s66 offen offset:1024 lds
	v_mfma_f32_16x16x32_bf16 v[80:83], a[12:15], a[48:51], v[80:83]
	s_waitcnt vmcnt(10)
	s_mov_b32 s66, 0xb800
	ds_read_b64_tr_b16 a[0:1], v1 offset:8192
	ds_read_b64_tr_b16 a[2:3], v1 offset:10240
	v_mfma_f32_16x16x32_bf16 v[80:83], a[8:11], a[32:35], v[80:83]
	s_waitcnt vmcnt(6) lgkmcnt(10)
	ds_read_b64_tr_b16 a[4:5], v1 offset:12288
	ds_read_b64_tr_b16 a[6:7], v1 offset:14336
	v_mfma_f32_16x16x32_bf16 v[96:99], a[16:19], a[32:35], v[96:99]
	s_waitcnt lgkmcnt(10)
	buffer_load_dwordx4 v16, s[36:39], s66 offen offset:2048 lds
	v_mfma_f32_16x16x32_bf16 v[96:99], a[20:23], a[48:51], v[96:99]
	ds_read_b64_tr_b16 a[8:9], v2 offset:8192
	v_mfma_f32_16x16x32_bf16 v[100:103], a[20:23], a[52:55], v[100:103]
	s_mov_b32 s66, 0xd400
	ds_read_b64_tr_b16 a[10:11], v2 offset:10240
	v_mfma_f32_16x16x32_bf16 v[100:103], a[16:19], a[36:39], v[100:103]
	s_waitcnt lgkmcnt(8)
	buffer_load_dwordx4 v16, s[36:39], s66 offen offset:3072 lds
	v_mfma_f32_16x16x32_bf16 v[116:119], a[24:27], a[36:39], v[116:119]
	s_waitcnt lgkmcnt(7)
	s_add_u32 m0, s64, 0x0
	ds_read_b64_tr_b16 a[12:13], v2 offset:12288
	v_mfma_f32_16x16x32_bf16 v[116:119], a[28:31], a[52:55], v[116:119]
	s_mov_b32 s66, 0x10000
	ds_read_b64_tr_b16 a[14:15], v2 offset:14336
	v_mfma_f32_16x16x32_bf16 v[112:115], a[28:31], a[48:51], v[112:115]
	buffer_load_dwordx4 v16, s[36:39], s66 offen offset:0 lds
	v_mfma_f32_16x16x32_bf16 v[112:115], a[24:27], a[32:35], v[112:115]
	s_waitcnt lgkmcnt(6)
	v_mfma_f32_16x16x32_bf16 v[64:67], a[0:3], a[64:67], v[64:67]
	s_waitcnt lgkmcnt(4)
	s_mov_b32 s66, 0x11c00
	ds_read_b64_tr_b16 a[24:25], v4 offset:8192
	v_mfma_f32_16x16x32_bf16 v[64:67], a[4:7], a[80:83], v[64:67]
	buffer_load_dwordx4 v16, s[36:39], s66 offen offset:1024 lds
	v_mfma_f32_16x16x32_bf16 v[68:71], a[4:7], a[84:87], v[68:71]
	ds_read_b64_tr_b16 a[16:17], v3 offset:8192
	v_mfma_f32_16x16x32_bf16 v[68:71], a[0:3], a[68:71], v[68:71]
	s_mov_b32 s66, 0x13800
	ds_read_b64_tr_b16 a[18:19], v3 offset:10240
	v_mfma_f32_16x16x32_bf16 v[72:75], a[0:3], a[72:75], v[72:75]
	buffer_load_dwordx4 v16, s[36:39], s66 offen offset:2048 lds
	v_mfma_f32_16x16x32_bf16 v[72:75], a[4:7], a[88:91], v[72:75]
	ds_read_b64_tr_b16 a[20:21], v3 offset:12288
	v_mfma_f32_16x16x32_bf16 v[76:79], a[4:7], a[92:95], v[76:79]
	s_mov_b32 s66, 0x15400
	ds_read_b64_tr_b16 a[22:23], v3 offset:14336
	v_mfma_f32_16x16x32_bf16 v[76:79], a[0:3], a[76:79], v[76:79]
	s_waitcnt lgkmcnt(5)
	buffer_load_dwordx4 v16, s[36:39], s66 offen offset:3072 lds
	v_mfma_f32_16x16x32_bf16 v[92:95], a[8:11], a[76:79], v[92:95]
	s_add_u32 m0, s64, 0x1000
	ds_read_b64_tr_b16 a[26:27], v4 offset:10240
	v_mfma_f32_16x16x32_bf16 v[92:95], a[12:15], a[92:95], v[92:95]
	s_mov_b32 s66, 0x18000
	ds_read_b64_tr_b16 a[28:29], v4 offset:12288
	v_mfma_f32_16x16x32_bf16 v[88:91], a[12:15], a[88:91], v[88:91]
	buffer_load_dwordx4 v16, s[36:39], s66 offen offset:0 lds
	v_mfma_f32_16x16x32_bf16 v[88:91], a[8:11], a[72:75], v[88:91]
	ds_read_b64_tr_b16 a[30:31], v4 offset:14336
	v_mfma_f32_16x16x32_bf16 v[84:87], a[8:11], a[68:71], v[84:87]
	s_mov_b32 s66, 0x19c00
	v_mfma_f32_16x16x32_bf16 v[84:87], a[12:15], a[84:87], v[84:87]
	buffer_load_dwordx4 v16, s[36:39], s66 offen offset:1024 lds
	v_mfma_f32_16x16x32_bf16 v[80:83], a[12:15], a[80:83], v[80:83]
	s_mov_b32 s66, 0x1b800
	v_mfma_f32_16x16x32_bf16 v[80:83], a[8:11], a[64:67], v[80:83]
	s_waitcnt lgkmcnt(4)
	v_mfma_f32_16x16x32_bf16 v[96:99], a[16:19], a[64:67], v[96:99]
	s_waitcnt lgkmcnt(3)
	buffer_load_dwordx4 v16, s[36:39], s66 offen offset:2048 lds
	v_mfma_f32_16x16x32_bf16 v[96:99], a[20:23], a[80:83], v[96:99]
	v_mfma_f32_16x16x32_bf16 v[100:103], a[20:23], a[84:87], v[100:103]
	s_mov_b32 s66, 0x1d400
	v_mfma_f32_16x16x32_bf16 v[100:103], a[16:19], a[68:71], v[100:103]
	s_waitcnt lgkmcnt(1)
	buffer_load_dwordx4 v16, s[36:39], s66 offen offset:3072 lds
	v_mfma_f32_16x16x32_bf16 v[116:119], a[24:27], a[68:71], v[116:119]
	s_waitcnt lgkmcnt(0)
	s_add_u32 m0, s64, 0x2000
	v_mfma_f32_16x16x32_bf16 v[116:119], a[28:31], a[84:87], v[116:119]
	s_mov_b32 s66, 0x20000
	v_mfma_f32_16x16x32_bf16 v[112:115], a[28:31], a[80:83], v[112:115]
	buffer_load_dwordx4 v16, s[36:39], s66 offen offset:0 lds
	v_mfma_f32_16x16x32_bf16 v[112:115], a[24:27], a[64:67], v[112:115]
	s_barrier
	v_pk_mul_f32 v[48:49], v[64:65], v[64:65]
	v_pk_mul_f32 v[50:51], v[66:67], v[66:67]
	v_pk_fma_f32 v[48:49], v[48:49], s[76:77], v[28:29] op_sel_hi:[1,1,0]
	v_pk_fma_f32 v[50:51], v[50:51], s[76:77], v[28:29] op_sel_hi:[1,1,0]
	v_pk_mul_f32 v[48:49], v[48:49], v[64:65]
	v_pk_mul_f32 v[50:51], v[50:51], v[66:67]
	v_exp_f32 v48, v48
	v_exp_f32 v49, v49
	v_exp_f32 v50, v50
	v_exp_f32 v51, v51
	v_pk_add_f32 v[48:49], v[48:49], 1.0 op_sel_hi:[1,0]
	v_pk_add_f32 v[50:51], v[50:51], 1.0 op_sel_hi:[1,0]
	v_rcp_f32 v48, v48
	v_rcp_f32 v49, v49
	v_rcp_f32 v50, v50
	v_rcp_f32 v51, v51
	v_pk_mul_f32 v[48:49], v[48:49], v[64:65]
	v_pk_mul_f32 v[50:51], v[50:51], v[66:67]
	v_cvt_pk_bf16_f32 v32, v48, v49
	v_cvt_pk_bf16_f32 v33, v50, v51
	v_pk_mul_f32 v[52:53], v[80:81], v[80:81]
	v_pk_mul_f32 v[54:55], v[82:83], v[82:83]
	v_pk_fma_f32 v[52:53], v[52:53], s[76:77], v[28:29] op_sel_hi:[1,1,0]
	v_pk_fma_f32 v[54:55], v[54:55], s[76:77], v[28:29] op_sel_hi:[1,1,0]
	v_pk_mul_f32 v[52:53], v[52:53], v[80:81]
	v_pk_mul_f32 v[54:55], v[54:55], v[82:83]
	v_exp_f32 v52, v52
	v_exp_f32 v53, v53
	v_exp_f32 v54, v54
	v_exp_f32 v55, v55
	v_pk_add_f32 v[52:53], v[52:53], 1.0 op_sel_hi:[1,0]
	v_pk_add_f32 v[54:55], v[54:55], 1.0 op_sel_hi:[1,0]
	v_rcp_f32 v52, v52
	v_rcp_f32 v53, v53
	v_rcp_f32 v54, v54
	v_rcp_f32 v55, v55
	v_pk_mul_f32 v[52:53], v[52:53], v[80:81]
	v_pk_mul_f32 v[54:55], v[54:55], v[82:83]
	v_cvt_pk_bf16_f32 v34, v52, v53
	v_cvt_pk_bf16_f32 v35, v54, v55
	ds_write_b128 v26, v[32:35] offset:16384
	v_pk_mul_f32 v[48:49], v[68:69], v[68:69]
	v_pk_mul_f32 v[50:51], v[70:71], v[70:71]
	v_pk_fma_f32 v[48:49], v[48:49], s[76:77], v[28:29] op_sel_hi:[1,1,0]
	v_pk_fma_f32 v[50:51], v[50:51], s[76:77], v[28:29] op_sel_hi:[1,1,0]
	v_pk_mul_f32 v[48:49], v[48:49], v[68:69]
	v_pk_mul_f32 v[50:51], v[50:51], v[70:71]
	v_exp_f32 v48, v48
	v_exp_f32 v49, v49
	v_exp_f32 v50, v50
	v_exp_f32 v51, v51
	v_pk_add_f32 v[48:49], v[48:49], 1.0 op_sel_hi:[1,0]
	v_pk_add_f32 v[50:51], v[50:51], 1.0 op_sel_hi:[1,0]
	v_rcp_f32 v48, v48
	v_rcp_f32 v49, v49
	v_rcp_f32 v50, v50
	v_rcp_f32 v51, v51
	v_pk_mul_f32 v[48:49], v[48:49], v[68:69]
	v_pk_mul_f32 v[50:51], v[50:51], v[70:71]
	v_cvt_pk_bf16_f32 v36, v48, v49
	v_cvt_pk_bf16_f32 v37, v50, v51
	v_pk_mul_f32 v[52:53], v[84:85], v[84:85]
	v_pk_mul_f32 v[54:55], v[86:87], v[86:87]
	v_pk_fma_f32 v[52:53], v[52:53], s[76:77], v[28:29] op_sel_hi:[1,1,0]
	v_pk_fma_f32 v[54:55], v[54:55], s[76:77], v[28:29] op_sel_hi:[1,1,0]
	v_pk_mul_f32 v[52:53], v[52:53], v[84:85]
	v_pk_mul_f32 v[54:55], v[54:55], v[86:87]
	v_exp_f32 v52, v52
	v_exp_f32 v53, v53
	v_exp_f32 v54, v54
	v_exp_f32 v55, v55
	v_pk_add_f32 v[52:53], v[52:53], 1.0 op_sel_hi:[1,0]
	v_pk_add_f32 v[54:55], v[54:55], 1.0 op_sel_hi:[1,0]
	v_rcp_f32 v52, v52
	v_rcp_f32 v53, v53
	v_rcp_f32 v54, v54
	v_rcp_f32 v55, v55
	v_pk_mul_f32 v[52:53], v[52:53], v[84:85]
	v_pk_mul_f32 v[54:55], v[54:55], v[86:87]
	v_cvt_pk_bf16_f32 v38, v52, v53
	v_cvt_pk_bf16_f32 v39, v54, v55
	ds_write_b128 v26, v[36:39] offset:24576
	v_pk_mul_f32 v[48:49], v[72:73], v[72:73]
	v_pk_mul_f32 v[50:51], v[74:75], v[74:75]
	v_pk_fma_f32 v[48:49], v[48:49], s[76:77], v[28:29] op_sel_hi:[1,1,0]
	v_pk_fma_f32 v[50:51], v[50:51], s[76:77], v[28:29] op_sel_hi:[1,1,0]
	v_pk_mul_f32 v[48:49], v[48:49], v[72:73]
	v_pk_mul_f32 v[50:51], v[50:51], v[74:75]
	v_exp_f32 v48, v48
	v_exp_f32 v49, v49
	v_exp_f32 v50, v50
	v_exp_f32 v51, v51
	v_pk_add_f32 v[48:49], v[48:49], 1.0 op_sel_hi:[1,0]
	v_pk_add_f32 v[50:51], v[50:51], 1.0 op_sel_hi:[1,0]
	v_rcp_f32 v48, v48
	v_rcp_f32 v49, v49
	v_rcp_f32 v50, v50
	v_rcp_f32 v51, v51
	v_pk_mul_f32 v[48:49], v[48:49], v[72:73]
	v_pk_mul_f32 v[50:51], v[50:51], v[74:75]
	v_cvt_pk_bf16_f32 v40, v48, v49
L_pg28:
	s_cbranch_execz L_pg20
	s_nop 0
	v_cvt_pk_bf16_f32 v41, v50, v51
	v_pk_mul_f32 v[52:53], v[88:89], v[88:89]
	v_pk_mul_f32 v[54:55], v[90:91], v[90:91]
	v_pk_fma_f32 v[52:53], v[52:53], s[76:77], v[28:29] op_sel_hi:[1,1,0]
	v_pk_fma_f32 v[54:55], v[54:55], s[76:77], v[28:29] op_sel_hi:[1,1,0]
	v_pk_mul_f32 v[52:53], v[52:53], v[88:89]
	v_pk_mul_f32 v[54:55], v[54:55], v[90:91]
	v_exp_f32 v52, v52
	v_exp_f32 v53, v53
	v_exp_f32 v54, v54
	v_exp_f32 v55, v55
	v_pk_add_f32 v[52:53], v[52:53], 1.0 op_sel_hi:[1,0]
	v_pk_add_f32 v[54:55], v[54:55], 1.0 op_sel_hi:[1,0]
	v_rcp_f32 v52, v52
	v_rcp_f32 v53, v53
	v_rcp_f32 v54, v54
	v_rcp_f32 v55, v55
	v_pk_mul_f32 v[52:53], v[52:53], v[88:89]
	v_pk_mul_f32 v[54:55], v[54:55], v[90:91]
	v_cvt_pk_bf16_f32 v42, v52, v53
	v_cvt_pk_bf16_f32 v43, v54, v55
	ds_write_b128 v27, v[40:43] offset:16384
	v_pk_mul_f32 v[48:49], v[76:77], v[76:77]
	v_pk_mul_f32 v[50:51], v[78:79], v[78:79]
	v_pk_fma_f32 v[48:49], v[48:49], s[76:77], v[28:29] op_sel_hi:[1,1,0]
	v_pk_fma_f32 v[50:51], v[50:51], s[76:77], v[28:29] op_sel_hi:[1,1,0]
	v_pk_mul_f32 v[48:49], v[48:49], v[76:77]
	v_pk_mul_f32 v[50:51], v[50:51], v[78:79]
	v_exp_f32 v48, v48
	v_exp_f32 v49, v49
	v_exp_f32 v50, v50
	v_exp_f32 v51, v51
	v_pk_add_f32 v[48:49], v[48:49], 1.0 op_sel_hi:[1,0]
	v_pk_add_f32 v[50:51], v[50:51], 1.0 op_sel_hi:[1,0]
	v_rcp_f32 v48, v48
	v_rcp_f32 v49, v49
	v_rcp_f32 v50, v50
	v_rcp_f32 v51, v51
	v_pk_mul_f32 v[48:49], v[48:49], v[76:77]
	v_pk_mul_f32 v[50:51], v[50:51], v[78:79]
	v_cvt_pk_bf16_f32 v44, v48, v49
	v_cvt_pk_bf16_f32 v45, v50, v51
	v_pk_mul_f32 v[52:53], v[92:93], v[92:93]
	v_pk_mul_f32 v[54:55], v[94:95], v[94:95]
	v_pk_fma_f32 v[52:53], v[52:53], s[76:77], v[28:29] op_sel_hi:[1,1,0]
	v_pk_fma_f32 v[54:55], v[54:55], s[76:77], v[28:29] op_sel_hi:[1,1,0]
	v_pk_mul_f32 v[52:53], v[52:53], v[92:93]
	v_pk_mul_f32 v[54:55], v[54:55], v[94:95]
	v_exp_f32 v52, v52
	v_exp_f32 v53, v53
	v_exp_f32 v54, v54
	v_exp_f32 v55, v55
	v_pk_add_f32 v[52:53], v[52:53], 1.0 op_sel_hi:[1,0]
	v_pk_add_f32 v[54:55], v[54:55], 1.0 op_sel_hi:[1,0]
	v_rcp_f32 v52, v52
	v_rcp_f32 v53, v53
	v_rcp_f32 v54, v54
	v_rcp_f32 v55, v55
	v_pk_mul_f32 v[52:53], v[52:53], v[92:93]
	v_pk_mul_f32 v[54:55], v[54:55], v[94:95]
	v_cvt_pk_bf16_f32 v46, v52, v53
	v_cvt_pk_bf16_f32 v47, v54, v55
	ds_write_b128 v27, v[44:47] offset:24576
	v_pk_mul_f32 v[48:49], v[96:97], v[96:97]
	v_pk_mul_f32 v[50:51], v[98:99], v[98:99]
	v_pk_fma_f32 v[48:49], v[48:49], s[76:77], v[28:29] op_sel_hi:[1,1,0]
	v_pk_fma_f32 v[50:51], v[50:51], s[76:77], v[28:29] op_sel_hi:[1,1,0]
	v_pk_mul_f32 v[48:49], v[48:49], v[96:97]
	v_pk_mul_f32 v[50:51], v[50:51], v[98:99]
	v_exp_f32 v48, v48
	v_exp_f32 v49, v49
	v_exp_f32 v50, v50
	v_exp_f32 v51, v51
	v_pk_add_f32 v[48:49], v[48:49], 1.0 op_sel_hi:[1,0]
	v_pk_add_f32 v[50:51], v[50:51], 1.0 op_sel_hi:[1,0]
	v_rcp_f32 v48, v48
	v_rcp_f32 v49, v49
	v_rcp_f32 v50, v50
	v_rcp_f32 v51, v51
	v_pk_mul_f32 v[48:49], v[48:49], v[96:97]
	v_pk_mul_f32 v[50:51], v[50:51], v[98:99]
	v_cvt_pk_bf16_f32 v32, v48, v49
	v_cvt_pk_bf16_f32 v33, v50, v51
	v_pk_mul_f32 v[52:53], v[112:113], v[112:113]
	v_pk_mul_f32 v[54:55], v[114:115], v[114:115]
	v_pk_fma_f32 v[52:53], v[52:53], s[76:77], v[28:29] op_sel_hi:[1,1,0]
	v_pk_fma_f32 v[54:55], v[54:55], s[76:77], v[28:29] op_sel_hi:[1,1,0]
	v_pk_mul_f32 v[52:53], v[52:53], v[112:113]
	v_pk_mul_f32 v[54:55], v[54:55], v[114:115]
	v_exp_f32 v52, v52
	v_exp_f32 v53, v53
	v_exp_f32 v54, v54
	v_exp_f32 v55, v55
	v_pk_add_f32 v[52:53], v[52:53], 1.0 op_sel_hi:[1,0]
	v_pk_add_f32 v[54:55], v[54:55], 1.0 op_sel_hi:[1,0]
	v_rcp_f32 v52, v52
	v_rcp_f32 v53, v53
	v_rcp_f32 v54, v54
	v_rcp_f32 v55, v55
	v_pk_mul_f32 v[52:53], v[52:53], v[112:113]
	v_pk_mul_f32 v[54:55], v[54:55], v[114:115]
	v_cvt_pk_bf16_f32 v34, v52, v53
	v_cvt_pk_bf16_f32 v35, v54, v55
	ds_write_b128 v30, v[32:35] offset:16384
	v_pk_mul_f32 v[48:49], v[100:101], v[100:101]
	v_pk_mul_f32 v[50:51], v[102:103], v[102:103]
	v_pk_fma_f32 v[48:49], v[48:49], s[76:77], v[28:29] op_sel_hi:[1,1,0]
	v_pk_fma_f32 v[50:51], v[50:51], s[76:77], v[28:29] op_sel_hi:[1,1,0]
	v_pk_mul_f32 v[48:49], v[48:49], v[100:101]
	v_pk_mul_f32 v[50:51], v[50:51], v[102:103]
	v_exp_f32 v48, v48
	v_exp_f32 v49, v49
	v_exp_f32 v50, v50
	v_exp_f32 v51, v51
	v_pk_add_f32 v[48:49], v[48:49], 1.0 op_sel_hi:[1,0]
	v_pk_add_f32 v[50:51], v[50:51], 1.0 op_sel_hi:[1,0]
	v_rcp_f32 v48, v48
	v_rcp_f32 v49, v49
	v_rcp_f32 v50, v50
	v_rcp_f32 v51, v51
	v_pk_mul_f32 v[48:49], v[48:49], v[100:101]
	v_pk_mul_f32 v[50:51], v[50:51], v[102:103]
	v_cvt_pk_bf16_f32 v36, v48, v49
	v_cvt_pk_bf16_f32 v37, v50, v51
	v_pk_mul_f32 v[52:53], v[116:117], v[116:117]
	v_pk_mul_f32 v[54:55], v[118:119], v[118:119]
	v_pk_fma_f32 v[52:53], v[52:53], s[76:77], v[28:29] op_sel_hi:[1,1,0]
	v_pk_fma_f32 v[54:55], v[54:55], s[76:77], v[28:29] op_sel_hi:[1,1,0]
	v_pk_mul_f32 v[52:53], v[52:53], v[116:117]
	v_pk_mul_f32 v[54:55], v[54:55], v[118:119]
	v_exp_f32 v52, v52
	v_exp_f32 v53, v53
	v_exp_f32 v54, v54
	v_exp_f32 v55, v55
	v_pk_add_f32 v[52:53], v[52:53], 1.0 op_sel_hi:[1,0]
	v_pk_add_f32 v[54:55], v[54:55], 1.0 op_sel_hi:[1,0]
	v_rcp_f32 v52, v52
	v_rcp_f32 v53, v53
	v_rcp_f32 v54, v54
	v_rcp_f32 v55, v55
	v_pk_mul_f32 v[52:53], v[52:53], v[116:117]
	v_pk_mul_f32 v[54:55], v[54:55], v[118:119]
	v_cvt_pk_bf16_f32 v38, v52, v53
	v_cvt_pk_bf16_f32 v39, v54, v55
	ds_write_b128 v30, v[36:39] offset:24576
	s_waitcnt vmcnt(13)
	ds_read_b64_tr_b16 a[0:1], v1 offset:16384
	ds_read_b64_tr_b16 a[2:3], v1 offset:18432
	s_waitcnt vmcnt(9)
	ds_read_b64_tr_b16 a[4:5], v1 offset:20480
	ds_read_b64_tr_b16 a[6:7], v1 offset:22528
	ds_read_b64_tr_b16 a[8:9], v2 offset:16384
	ds_read_b64_tr_b16 a[10:11], v2 offset:18432
	ds_read_b64_tr_b16 a[12:13], v2 offset:20480
	ds_read_b64_tr_b16 a[14:15], v2 offset:22528
	s_waitcnt lgkmcnt(8)
	s_barrier
	ds_read_b128 a[32:35], v13 offset:16384
	ds_read_b128 a[48:51], v13 offset:17408
	ds_read_b128 a[52:55], v13 offset:25600
	ds_read_b128 a[36:39], v13 offset:24576
	ds_read_b128 a[40:43], v13 offset:49152
	ds_read_b128 a[56:59], v13 offset:50176
	ds_read_b128 a[60:63], v13 offset:58368
	ds_read_b128 a[44:47], v13 offset:57344
	s_waitcnt lgkmcnt(7)
	v_mfma_f32_16x16x32_bf16 v[64:67], a[0:3], a[32:35], 0
	s_add_u32 m0, s64, 0x2000
	s_mov_b32 s66, 0x21c00
	ds_read_b64_tr_b16 a[16:17], v3 offset:16384
	ds_read_b128 a[64:67], v13 offset:18432
	s_waitcnt lgkmcnt(8)
	v_mfma_f32_16x16x32_bf16 v[64:67], a[4:7], a[48:51], v[64:67]
	s_waitcnt lgkmcnt(7)
	buffer_load_dwordx4 v16, s[36:39], s66 offen offset:1024 lds
	v_mfma_f32_16x16x32_bf16 v[68:71], a[4:7], a[52:55], 0
	s_waitcnt lgkmcnt(6)
	s_mov_b32 s66, 0x23800
	ds_read_b64_tr_b16 a[18:19], v3 offset:18432
	ds_read_b128 a[80:83], v13 offset:19456
	v_mfma_f32_16x16x32_bf16 v[68:71], a[0:3], a[36:39], v[68:71]
	s_waitcnt lgkmcnt(7)
	buffer_load_dwordx4 v16, s[36:39], s66 offen offset:2048 lds
	v_mfma_f32_16x16x32_bf16 v[72:75], a[0:3], a[40:43], 0
	s_waitcnt lgkmcnt(6)
	s_mov_b32 s66, 0x25400
	ds_read_b64_tr_b16 a[20:21], v3 offset:20480
	ds_read_b128 a[68:71], v13 offset:26624
	v_mfma_f32_16x16x32_bf16 v[72:75], a[4:7], a[56:59], v[72:75]
	s_waitcnt lgkmcnt(7)
	buffer_load_dwordx4 v16, s[36:39], s66 offen offset:3072 lds
	v_mfma_f32_16x16x32_bf16 v[76:79], a[4:7], a[60:63], 0
	s_add_u32 m0, s64, 0x3000
	s_mov_b32 s66, 0x28000
	ds_read_b64_tr_b16 a[22:23], v3 offset:22528
	ds_read_b128 a[84:87], v13 offset:27648
	s_waitcnt lgkmcnt(8)
	v_mfma_f32_16x16x32_bf16 v[76:79], a[0:3], a[44:47], v[76:79]
	buffer_load_dwordx4 v16, s[36:39], s66 offen offset:0 lds
	v_mfma_f32_16x16x32_bf16 v[92:95], a[8:11], a[44:47], 0
	s_mov_b32 s66, 0x29c00
	ds_read_b64_tr_b16 a[24:25], v4 offset:16384
	ds_read_b128 a[72:75], v13 offset:51200
	v_mfma_f32_16x16x32_bf16 v[92:95], a[12:15], a[60:63], v[92:95]
	buffer_load_dwordx4 v16, s[36:39], s66 offen offset:1024 lds
	v_mfma_f32_16x16x32_bf16 v[88:91], a[12:15], a[56:59], 0
	s_mov_b32 s66, 0x2b800
	ds_read_b64_tr_b16 a[26:27], v4 offset:18432
	ds_read_b128 a[88:91], v13 offset:52224
	v_mfma_f32_16x16x32_bf16 v[88:91], a[8:11], a[40:43], v[88:91]
	buffer_load_dwordx4 v16, s[36:39], s66 offen offset:2048 lds
	v_mfma_f32_16x16x32_bf16 v[84:87], a[8:11], a[36:39], 0
	s_mov_b32 s66, 0x2d400
	ds_read_b64_tr_b16 a[28:29], v4 offset:20480
	ds_read_b128 a[76:79], v13 offset:59392
	v_mfma_f32_16x16x32_bf16 v[84:87], a[12:15], a[52:55], v[84:87]
	buffer_load_dwordx4 v16, s[36:39], s66 offen offset:3072 lds
	v_mfma_f32_16x16x32_bf16 v[80:83], a[12:15], a[48:51], 0
	ds_read_b64_tr_b16 a[30:31], v4 offset:22528
	ds_read_b128 a[92:95], v13 offset:60416
	v_mfma_f32_16x16x32_bf16 v[80:83], a[8:11], a[32:35], v[80:83]
	s_waitcnt lgkmcnt(10)
	v_mfma_f32_16x16x32_bf16 v[96:99], a[16:19], a[32:35], 0
	s_waitcnt lgkmcnt(8)
	v_mfma_f32_16x16x32_bf16 v[96:99], a[20:23], a[48:51], v[96:99]
	v_mfma_f32_16x16x32_bf16 v[100:103], a[20:23], a[52:55], 0
	v_mfma_f32_16x16x32_bf16 v[100:103], a[16:19], a[36:39], v[100:103]
	s_waitcnt vmcnt(12)
	ds_read_b64_tr_b16 a[0:1], v1 offset:0
	v_mfma_f32_16x16x32_bf16 v[104:107], a[16:19], a[40:43], 0
	ds_read_b64_tr_b16 a[2:3], v1 offset:2048
	v_mfma_f32_16x16x32_bf16 v[104:107], a[20:23], a[56:59], v[104:107]
	s_waitcnt vmcnt(8)
	ds_read_b64_tr_b16 a[4:5], v1 offset:4096
	v_mfma_f32_16x16x32_bf16 v[108:111], a[20:23], a[60:63], 0
	s_add_u32 m0, s64, 0x4000
	ds_read_b64_tr_b16 a[6:7], v1 offset:6144
	v_mfma_f32_16x16x32_bf16 v[108:111], a[16:19], a[44:47], v[108:111]
	s_waitcnt lgkmcnt(6)
	v_mfma_f32_16x16x32_bf16 v[124:127], a[24:27], a[44:47], 0
	s_waitcnt lgkmcnt(4)
	s_mov_b32 s66, 0x200
	v_mfma_f32_16x16x32_bf16 v[124:127], a[28:31], a[60:63], v[124:127]
	buffer_load_dwordx4 v16, s[36:39], s66 offen offset:0 lds
	v_mfma_f32_16x16x32_bf16 v[120:123], a[28:31], a[56:59], 0
	ds_read_b64_tr_b16 a[8:9], v2 offset:0
	v_mfma_f32_16x16x32_bf16 v[120:123], a[24:27], a[40:43], v[120:123]
	ds_read_b64_tr_b16 a[10:11], v2 offset:2048
	v_mfma_f32_16x16x32_bf16 v[116:119], a[24:27], a[36:39], 0
	s_mov_b32 s66, 0x1e00
	ds_read_b64_tr_b16 a[12:13], v2 offset:4096
	v_mfma_f32_16x16x32_bf16 v[116:119], a[28:31], a[52:55], v[116:119]
	buffer_load_dwordx4 v16, s[36:39], s66 offen offset:1024 lds
	v_mfma_f32_16x16x32_bf16 v[112:115], a[28:31], a[48:51], 0
	ds_read_b64_tr_b16 a[14:15], v2 offset:6144
	v_mfma_f32_16x16x32_bf16 v[112:115], a[24:27], a[32:35], v[112:115]
	s_waitcnt lgkmcnt(5)
	v_mfma_f32_16x16x32_bf16 v[64:67], a[0:3], a[64:67], v[64:67]
	s_waitcnt lgkmcnt(4)
	s_mov_b32 s66, 0x3a00
	ds_read_b128 a[32:35], v13 offset:20480
	v_mfma_f32_16x16x32_bf16 v[64:67], a[4:7], a[80:83], v[64:67]
	buffer_load_dwordx4 v16, s[36:39], s66 offen offset:2048 lds
	v_mfma_f32_16x16x32_bf16 v[68:71], a[4:7], a[84:87], v[68:71]
	ds_read_b64_tr_b16 a[16:17], v3 offset:0
	ds_read_b128 a[48:51], v13 offset:21504
	v_mfma_f32_16x16x32_bf16 v[68:71], a[0:3], a[68:71], v[68:71]
	ds_read_b64_tr_b16 a[18:19], v3 offset:2048
	v_mfma_f32_16x16x32_bf16 v[72:75], a[0:3], a[72:75], v[72:75]
	s_mov_b32 s66, 0x5600
	ds_read_b64_tr_b16 a[20:21], v3 offset:4096
	ds_read_b128 a[36:39], v13 offset:28672
	v_mfma_f32_16x16x32_bf16 v[72:75], a[4:7], a[88:91], v[72:75]
	buffer_load_dwordx4 v16, s[36:39], s66 offen offset:3072 lds
	v_mfma_f32_16x16x32_bf16 v[76:79], a[4:7], a[92:95], v[76:79]
	s_add_u32 m0, s64, 0x5000
	ds_read_b64_tr_b16 a[22:23], v3 offset:6144
	ds_read_b128 a[52:55], v13 offset:29696
	v_mfma_f32_16x16x32_bf16 v[76:79], a[0:3], a[76:79], v[76:79]
	s_waitcnt lgkmcnt(9)
	v_mfma_f32_16x16x32_bf16 v[92:95], a[8:11], a[76:79], v[92:95]
	s_waitcnt lgkmcnt(8)
	s_mov_b32 s66, 0x8200
	ds_read_b128 a[40:43], v13 offset:53248
	v_mfma_f32_16x16x32_bf16 v[92:95], a[12:15], a[92:95], v[92:95]
	buffer_load_dwordx4 v16, s[36:39], s66 offen offset:0 lds
	v_mfma_f32_16x16x32_bf16 v[88:91], a[12:15], a[88:91], v[88:91]
	ds_read_b64_tr_b16 a[24:25], v4 offset:0
	ds_read_b128 a[56:59], v13 offset:54272
	v_mfma_f32_16x16x32_bf16 v[88:91], a[8:11], a[72:75], v[88:91]
	ds_read_b64_tr_b16 a[26:27], v4 offset:2048
	v_mfma_f32_16x16x32_bf16 v[84:87], a[8:11], a[68:71], v[84:87]
	s_mov_b32 s66, 0x9e00
	ds_read_b64_tr_b16 a[28:29], v4 offset:4096
	ds_read_b128 a[44:47], v13 offset:61440
	v_mfma_f32_16x16x32_bf16 v[84:87], a[12:15], a[84:87], v[84:87]
	buffer_load_dwordx4 v16, s[36:39], s66 offen offset:1024 lds
	v_mfma_f32_16x16x32_bf16 v[80:83], a[12:15], a[80:83], v[80:83]
	ds_read_b64_tr_b16 a[30:31], v4 offset:6144
	ds_read_b128 a[60:63], v13 offset:62464
	v_mfma_f32_16x16x32_bf16 v[80:83], a[8:11], a[64:67], v[80:83]
	s_waitcnt lgkmcnt(10)
	v_mfma_f32_16x16x32_bf16 v[96:99], a[16:19], a[64:67], v[96:99]
	s_waitcnt lgkmcnt(8)
	s_mov_b32 s66, 0xba00
	v_mfma_f32_16x16x32_bf16 v[96:99], a[20:23], a[80:83], v[96:99]
	buffer_load_dwordx4 v16, s[36:39], s66 offen offset:2048 lds
	v_mfma_f32_16x16x32_bf16 v[100:103], a[20:23], a[84:87], v[100:103]
	s_waitcnt vmcnt(11)
	ds_read_b64_tr_b16 a[0:1], v1 offset:8192
	v_mfma_f32_16x16x32_bf16 v[100:103], a[16:19], a[68:71], v[100:103]
	ds_read_b64_tr_b16 a[2:3], v1 offset:10240
	v_mfma_f32_16x16x32_bf16 v[104:107], a[16:19], a[72:75], v[104:107]
	s_waitcnt vmcnt(7)
	s_mov_b32 s66, 0xd600
	ds_read_b64_tr_b16 a[4:5], v1 offset:12288
	v_mfma_f32_16x16x32_bf16 v[104:107], a[20:23], a[88:91], v[104:107]
	buffer_load_dwordx4 v16, s[36:39], s66 offen offset:3072 lds
	v_mfma_f32_16x16x32_bf16 v[108:111], a[20:23], a[92:95], v[108:111]
	s_add_u32 m0, s64, 0x0
	ds_read_b64_tr_b16 a[6:7], v1 offset:14336
	v_mfma_f32_16x16x32_bf16 v[108:111], a[16:19], a[76:79], v[108:111]
	s_waitcnt lgkmcnt(6)
	v_mfma_f32_16x16x32_bf16 v[124:127], a[24:27], a[76:79], v[124:127]
	s_waitcnt lgkmcnt(4)
	s_mov_b32 s66, 0x10200
	v_mfma_f32_16x16x32_bf16 v[124:127], a[28:31], a[92:95], v[124:127]
	buffer_load_dwordx4 v16, s[36:39], s66 offen offset:0 lds
	v_mfma_f32_16x16x32_bf16 v[120:123], a[28:31], a[88:91], v[120:123]
	ds_read_b64_tr_b16 a[8:9], v2 offset:8192
	v_mfma_f32_16x16x32_bf16 v[120:123], a[24:27], a[72:75], v[120:123]
	ds_read_b64_tr_b16 a[10:11], v2 offset:10240
	v_mfma_f32_16x16x32_bf16 v[116:119], a[24:27], a[68:71], v[116:119]
	s_mov_b32 s66, 0x11e00
	ds_read_b64_tr_b16 a[12:13], v2 offset:12288
	v_mfma_f32_16x16x32_bf16 v[116:119], a[28:31], a[84:87], v[116:119]
	buffer_load_dwordx4 v16, s[36:39], s66 offen offset:1024 lds
	v_mfma_f32_16x16x32_bf16 v[112:115], a[28:31], a[80:83], v[112:115]
	ds_read_b64_tr_b16 a[14:15], v2 offset:14336
	v_mfma_f32_16x16x32_bf16 v[112:115], a[24:27], a[64:67], v[112:115]
	s_waitcnt lgkmcnt(5)
	v_mfma_f32_16x16x32_bf16 v[64:67], a[0:3], a[32:35], v[64:67]
	s_waitcnt lgkmcnt(4)
	s_mov_b32 s66, 0x13a00
	ds_read_b128 a[64:67], v13 offset:16384
	v_mfma_f32_16x16x32_bf16 v[64:67], a[4:7], a[48:51], v[64:67]
	buffer_load_dwordx4 v16, s[36:39], s66 offen offset:2048 lds
	v_mfma_f32_16x16x32_bf16 v[68:71], a[4:7], a[52:55], v[68:71]
	ds_read_b64_tr_b16 a[16:17], v3 offset:8192
	ds_read_b128 a[80:83], v13 offset:17408
	v_mfma_f32_16x16x32_bf16 v[68:71], a[0:3], a[36:39], v[68:71]
	ds_read_b64_tr_b16 a[18:19], v3 offset:10240
	v_mfma_f32_16x16x32_bf16 v[72:75], a[0:3], a[40:43], v[72:75]
	s_mov_b32 s66, 0x15600
	ds_read_b64_tr_b16 a[20:21], v3 offset:12288
	ds_read_b128 a[68:71], v13 offset:24576
	v_mfma_f32_16x16x32_bf16 v[72:75], a[4:7], a[56:59], v[72:75]
	buffer_load_dwordx4 v16, s[36:39], s66 offen offset:3072 lds
	v_mfma_f32_16x16x32_bf16 v[76:79], a[4:7], a[60:63], v[76:79]
	s_add_u32 m0, s64, 0x1000
	ds_read_b64_tr_b16 a[22:23], v3 offset:14336
	ds_read_b128 a[84:87], v13 offset:25600
	v_mfma_f32_16x16x32_bf16 v[76:79], a[0:3], a[44:47], v[76:79]
	s_waitcnt lgkmcnt(9)
	v_mfma_f32_16x16x32_bf16 v[92:95], a[8:11], a[44:47], v[92:95]
	s_waitcnt lgkmcnt(8)
	s_mov_b32 s66, 0x18200
	ds_read_b128 a[72:75], v13 offset:49152
	v_mfma_f32_16x16x32_bf16 v[92:95], a[12:15], a[60:63], v[92:95]
	buffer_load_dwordx4 v16, s[36:39], s66 offen offset:0 lds
	v_mfma_f32_16x16x32_bf16 v[88:91], a[12:15], a[56:59], v[88:91]
	ds_read_b64_tr_b16 a[24:25], v4 offset:8192
	ds_read_b128 a[88:91], v13 offset:50176
	v_mfma_f32_16x16x32_bf16 v[88:91], a[8:11], a[40:43], v[88:91]
	ds_read_b64_tr_b16 a[26:27], v4 offset:10240
	v_mfma_f32_16x16x32_bf16 v[84:87], a[8:11], a[36:39], v[84:87]
	s_mov_b32 s66, 0x19e00
	ds_read_b64_tr_b16 a[28:29], v4 offset:12288
	ds_read_b128 a[76:79], v13 offset:57344
	v_mfma_f32_16x16x32_bf16 v[84:87], a[12:15], a[52:55], v[84:87]
	buffer_load_dwordx4 v16, s[36:39], s66 offen offset:1024 lds
	v_mfma_f32_16x16x32_bf16 v[80:83], a[12:15], a[48:51], v[80:83]
	ds_read_b64_tr_b16 a[30:31], v4 offset:14336
	ds_read_b128 a[92:95], v13 offset:58368
	v_mfma_f32_16x16x32_bf16 v[80:83], a[8:11], a[32:35], v[80:83]
	s_waitcnt lgkmcnt(10)
	v_mfma_f32_16x16x32_bf16 v[96:99], a[16:19], a[32:35], v[96:99]
	s_waitcnt lgkmcnt(8)
	s_mov_b32 s66, 0x1ba00
	v_mfma_f32_16x16x32_bf16 v[96:99], a[20:23], a[48:51], v[96:99]
	buffer_load_dwordx4 v16, s[36:39], s66 offen offset:2048 lds
	v_mfma_f32_16x16x32_bf16 v[100:103], a[20:23], a[52:55], v[100:103]
	s_waitcnt vmcnt(11)
	ds_read_b64_tr_b16 a[0:1], v1 offset:16384
	v_cvt_pk_bf16_f32 v95, v94, v95
	v_mfma_f32_16x16x32_bf16 v[100:103], a[16:19], a[36:39], v[100:103]
	ds_read_b64_tr_b16 a[2:3], v1 offset:18432
	v_cvt_pk_bf16_f32 v94, v92, v93
	v_mfma_f32_16x16x32_bf16 v[104:107], a[16:19], a[40:43], v[104:107]
	s_waitcnt vmcnt(7)
	s_mov_b32 s66, 0x1d600
	ds_read_b64_tr_b16 a[4:5], v1 offset:20480
	v_cvt_pk_bf16_f32 v92, v76, v77
	v_mfma_f32_16x16x32_bf16 v[104:107], a[20:23], a[56:59], v[104:107]
	buffer_load_dwordx4 v16, s[36:39], s66 offen offset:3072 lds
	v_mfma_f32_16x16x32_bf16 v[108:111], a[20:23], a[60:63], v[108:111]
	s_add_u32 m0, s64, 0x2000
	ds_read_b64_tr_b16 a[6:7], v1 offset:22528
	v_cvt_pk_bf16_f32 v93, v78, v79
	v_mfma_f32_16x16x32_bf16 v[108:111], a[16:19], a[44:47], v[108:111]
	s_waitcnt lgkmcnt(6)
	v_cvt_pk_bf16_f32 v91, v90, v91
	v_cvt_pk_bf16_f32 v90, v88, v89
	v_mfma_f32_16x16x32_bf16 v[124:127], a[24:27], a[44:47], v[124:127]
	s_waitcnt lgkmcnt(4)
	s_mov_b32 s66, 0x20200
	v_cvt_pk_bf16_f32 v88, v72, v73
	v_cvt_pk_bf16_f32 v89, v74, v75
	v_mfma_f32_16x16x32_bf16 v[124:127], a[28:31], a[60:63], v[124:127]
	buffer_load_dwordx4 v16, s[36:39], s66 offen offset:0 lds
	v_mfma_f32_16x16x32_bf16 v[120:123], a[28:31], a[56:59], v[120:123]
	ds_read_b64_tr_b16 a[8:9], v2 offset:16384
	v_cvt_pk_bf16_f32 v87, v86, v87
	v_mfma_f32_16x16x32_bf16 v[120:123], a[24:27], a[40:43], v[120:123]
	ds_read_b64_tr_b16 a[10:11], v2 offset:18432
	v_cvt_pk_bf16_f32 v86, v84, v85
	v_mfma_f32_16x16x32_bf16 v[116:119], a[24:27], a[36:39], v[116:119]
	s_mov_b32 s66, 0x21e00
	ds_read_b64_tr_b16 a[12:13], v2 offset:20480
	v_cvt_pk_bf16_f32 v84, v68, v69
	v_mfma_f32_16x16x32_bf16 v[116:119], a[28:31], a[52:55], v[116:119]
	buffer_load_dwordx4 v16, s[36:39], s66 offen offset:1024 lds
	v_mfma_f32_16x16x32_bf16 v[112:115], a[28:31], a[48:51], v[112:115]
	ds_read_b64_tr_b16 a[14:15], v2 offset:22528
	v_cvt_pk_bf16_f32 v85, v70, v71
	v_mfma_f32_16x16x32_bf16 v[112:115], a[24:27], a[32:35], v[112:115]
	s_waitcnt lgkmcnt(5)
	v_cvt_pk_bf16_f32 v83, v82, v83
	v_cvt_pk_bf16_f32 v82, v80, v81
	v_mfma_f32_16x16x32_bf16 v[32:35], a[0:3], a[64:67], 0
	s_waitcnt lgkmcnt(4)
	s_mov_b32 s66, 0x23a00
	ds_read_b128 a[32:35], v13 offset:18432
	v_cvt_pk_bf16_f32 v80, v64, v65
	v_mfma_f32_16x16x32_bf16 v[32:35], a[4:7], a[80:83], v[32:35]
	buffer_load_dwordx4 v16, s[36:39], s66 offen offset:2048 lds
	v_mfma_f32_16x16x32_bf16 v[36:39], a[4:7], a[84:87], 0
	ds_read_b64_tr_b16 a[16:17], v3 offset:16384
	ds_read_b128 a[48:51], v13 offset:19456
	v_mfma_f32_16x16x32_bf16 v[36:39], a[0:3], a[68:71], v[36:39]
	ds_read_b64_tr_b16 a[18:19], v3 offset:18432
	v_cvt_pk_bf16_f32 v81, v66, v67
	v_mfma_f32_16x16x32_bf16 v[40:43], a[0:3], a[72:75], 0
	s_mov_b32 s66, 0x25600
	ds_read_b64_tr_b16 a[20:21], v3 offset:20480
	ds_read_b128 a[36:39], v13 offset:26624
	v_mfma_f32_16x16x32_bf16 v[40:43], a[4:7], a[88:91], v[40:43]
	buffer_load_dwordx4 v16, s[36:39], s66 offen offset:3072 lds
	v_mfma_f32_16x16x32_bf16 v[44:47], a[4:7], a[92:95], 0
	s_add_u32 m0, s64, 0x3000
	ds_read_b64_tr_b16 a[22:23], v3 offset:22528
	ds_read_b128 a[52:55], v13 offset:27648
	v_mfma_f32_16x16x32_bf16 v[44:47], a[0:3], a[76:79], v[44:47]
	s_waitcnt lgkmcnt(9)
	v_cvt_pk_bf16_f32 v127, v126, v127
	v_cvt_pk_bf16_f32 v126, v124, v125
	v_mfma_f32_16x16x32_bf16 v[60:63], a[8:11], a[76:79], 0
	s_waitcnt lgkmcnt(8)
	s_mov_b32 s66, 0x28200
	ds_read_b128 a[40:43], v13 offset:51200
	v_cvt_pk_bf16_f32 v124, v108, v109
	v_mfma_f32_16x16x32_bf16 v[60:63], a[12:15], a[92:95], v[60:63]
	buffer_load_dwordx4 v16, s[36:39], s66 offen offset:0 lds
	v_mfma_f32_16x16x32_bf16 v[56:59], a[12:15], a[88:91], 0
	ds_read_b64_tr_b16 a[24:25], v4 offset:16384
	ds_read_b128 a[56:59], v13 offset:52224
	v_mfma_f32_16x16x32_bf16 v[56:59], a[8:11], a[72:75], v[56:59]
	ds_read_b64_tr_b16 a[26:27], v4 offset:18432
	v_cvt_pk_bf16_f32 v125, v110, v111
	v_mfma_f32_16x16x32_bf16 v[52:55], a[8:11], a[68:71], 0
	s_mov_b32 s66, 0x29e00
	ds_read_b64_tr_b16 a[28:29], v4 offset:20480
	ds_read_b128 a[44:47], v13 offset:59392
	v_mfma_f32_16x16x32_bf16 v[52:55], a[12:15], a[84:87], v[52:55]
	buffer_load_dwordx4 v16, s[36:39], s66 offen offset:1024 lds
	v_mfma_f32_16x16x32_bf16 v[48:51], a[12:15], a[80:83], 0
	ds_read_b64_tr_b16 a[30:31], v4 offset:22528
	ds_read_b128 a[60:63], v13 offset:60416
	v_mfma_f32_16x16x32_bf16 v[48:51], a[8:11], a[64:67], v[48:51]
	s_waitcnt lgkmcnt(10)
	v_cvt_pk_bf16_f32 v123, v122, v123
	v_cvt_pk_bf16_f32 v122, v120, v121
	v_mfma_f32_16x16x32_bf16 v[64:67], a[16:19], a[64:67], 0
	s_waitcnt lgkmcnt(8)
	s_mov_b32 s66, 0x2ba00
	v_cvt_pk_bf16_f32 v120, v104, v105
	v_cvt_pk_bf16_f32 v121, v106, v107
	v_mfma_f32_16x16x32_bf16 v[64:67], a[20:23], a[80:83], v[64:67]
	buffer_load_dwordx4 v16, s[36:39], s66 offen offset:2048 lds
	v_mfma_f32_16x16x32_bf16 v[68:71], a[20:23], a[84:87], 0
	s_waitcnt vmcnt(11)
	ds_read_b64_tr_b16 a[0:1], v1 offset:0
	v_cvt_pk_bf16_f32 v119, v118, v119
	v_mfma_f32_16x16x32_bf16 v[68:71], a[16:19], a[68:71], v[68:71]
	ds_read_b64_tr_b16 a[2:3], v1 offset:2048
	v_cvt_pk_bf16_f32 v118, v116, v117
	v_mfma_f32_16x16x32_bf16 v[72:75], a[16:19], a[72:75], 0
	s_waitcnt vmcnt(7)
	s_mov_b32 s66, 0x2d600
	ds_read_b64_tr_b16 a[4:5], v1 offset:4096
	v_cvt_pk_bf16_f32 v116, v100, v101
	v_mfma_f32_16x16x32_bf16 v[72:75], a[20:23], a[88:91], v[72:75]
	buffer_load_dwordx4 v16, s[36:39], s66 offen offset:3072 lds
	v_mfma_f32_16x16x32_bf16 v[76:79], a[20:23], a[92:95], 0
	ds_read_b64_tr_b16 a[6:7], v1 offset:6144
	v_cvt_pk_bf16_f32 v117, v102, v103
	v_mfma_f32_16x16x32_bf16 v[76:79], a[16:19], a[76:79], v[76:79]
	v_cvt_pk_bf16_f32 v115, v114, v115
	v_cvt_pk_bf16_f32 v114, v112, v113
	v_cvt_pk_bf16_f32 v112, v96, v97
	v_cvt_pk_bf16_f32 v113, v98, v99
	s_waitcnt lgkmcnt(6)
	v_mfma_f32_16x16x32_bf16 v[108:111], a[24:27], a[76:79], 0
	s_waitcnt lgkmcnt(4)
	s_add_u32 m0, s65, 0x0
	v_mfma_f32_16x16x32_bf16 v[108:111], a[28:31], a[92:95], v[108:111]
	buffer_load_dwordx4 v18, s[8:11], s68 offen lds
	v_mfma_f32_16x16x32_bf16 v[104:107], a[28:31], a[88:91], 0
	ds_read_b64_tr_b16 a[8:9], v2 offset:0
	v_mfma_f32_16x16x32_bf16 v[104:107], a[24:27], a[72:75], v[104:107]
	ds_read_b64_tr_b16 a[10:11], v2 offset:2048
	v_mfma_f32_16x16x32_bf16 v[100:103], a[24:27], a[68:71], 0
	ds_read_b64_tr_b16 a[12:13], v2 offset:4096
	v_mfma_f32_16x16x32_bf16 v[100:103], a[28:31], a[84:87], v[100:103]
	buffer_load_dwordx4 v19, s[8:11], s68 offen offset:1024 lds
	v_mfma_f32_16x16x32_bf16 v[96:99], a[28:31], a[80:83], 0
	s_add_u32 s68, s68, 0x2000
	ds_read_b64_tr_b16 a[14:15], v2 offset:6144
	v_mfma_f32_16x16x32_bf16 v[96:99], a[24:27], a[64:67], v[96:99]
	s_waitcnt lgkmcnt(5)
	s_and_b32 s68, s68, 0x7ffff
	v_mfma_f32_16x16x32_bf16 v[32:35], a[0:3], a[32:35], v[32:35]
	s_waitcnt lgkmcnt(4)
	s_add_u32 m0, s65, 0x2000
	ds_read_b128 a[64:67], v13 offset:20480
	v_mfma_f32_16x16x32_bf16 v[32:35], a[4:7], a[48:51], v[32:35]
	buffer_load_dwordx4 v18, s[8:11], s68 offen lds
	v_mfma_f32_16x16x32_bf16 v[36:39], a[4:7], a[52:55], v[36:39]
	ds_read_b64_tr_b16 a[16:17], v3 offset:0
	ds_read_b128 a[80:83], v13 offset:21504
	v_mfma_f32_16x16x32_bf16 v[36:39], a[0:3], a[36:39], v[36:39]
	ds_read_b64_tr_b16 a[18:19], v3 offset:2048
	v_mfma_f32_16x16x32_bf16 v[40:43], a[0:3], a[40:43], v[40:43]
	ds_read_b64_tr_b16 a[20:21], v3 offset:4096
	ds_read_b128 a[68:71], v13 offset:28672
	v_mfma_f32_16x16x32_bf16 v[40:43], a[4:7], a[56:59], v[40:43]
	buffer_load_dwordx4 v19, s[8:11], s68 offen offset:1024 lds
	v_mfma_f32_16x16x32_bf16 v[44:47], a[4:7], a[60:63], v[44:47]
	s_add_u32 s68, s68, 0x2000
	ds_read_b64_tr_b16 a[22:23], v3 offset:6144
	ds_read_b128 a[84:87], v13 offset:29696
	v_mfma_f32_16x16x32_bf16 v[44:47], a[0:3], a[44:47], v[44:47]
	s_waitcnt lgkmcnt(9)
	s_and_b32 s68, s68, 0x7ffff
	v_mfma_f32_16x16x32_bf16 v[60:63], a[8:11], a[44:47], v[60:63]
	s_waitcnt lgkmcnt(8)
	s_add_u32 m0, s65, 0x8000
	ds_read_b128 a[72:75], v13 offset:53248
	v_mfma_f32_16x16x32_bf16 v[60:63], a[12:15], a[60:63], v[60:63]
L_pg29:
	s_cbranch_execz L_pg19
	buffer_load_dwordx4 v20, s[12:15], s69 offen lds
	v_mfma_f32_16x16x32_bf16 v[56:59], a[12:15], a[56:59], v[56:59]
	ds_read_b64_tr_b16 a[24:25], v4 offset:0
	ds_read_b128 a[88:91], v13 offset:54272
	v_mfma_f32_16x16x32_bf16 v[56:59], a[8:11], a[40:43], v[56:59]
	ds_read_b64_tr_b16 a[26:27], v4 offset:2048
	v_mfma_f32_16x16x32_bf16 v[52:55], a[8:11], a[36:39], v[52:55]
	ds_read_b64_tr_b16 a[28:29], v4 offset:4096
	ds_read_b128 a[76:79], v13 offset:61440
	v_mfma_f32_16x16x32_bf16 v[52:55], a[12:15], a[52:55], v[52:55]
	buffer_load_dwordx4 v21, s[12:15], s69 offen offset:1024 lds
	v_mfma_f32_16x16x32_bf16 v[48:51], a[12:15], a[48:51], v[48:51]
	s_add_u32 s69, s69, 0x2000
	ds_read_b64_tr_b16 a[30:31], v4 offset:6144
	ds_read_b128 a[92:95], v13 offset:62464
	v_mfma_f32_16x16x32_bf16 v[48:51], a[8:11], a[32:35], v[48:51]
	s_waitcnt lgkmcnt(10)
	s_and_b32 s69, s69, 0x7ffff
	v_mfma_f32_16x16x32_bf16 v[64:67], a[16:19], a[32:35], v[64:67]
	s_waitcnt lgkmcnt(8)
	s_add_u32 m0, s65, 0xa000
	v_mfma_f32_16x16x32_bf16 v[64:67], a[20:23], a[48:51], v[64:67]
	buffer_load_dwordx4 v20, s[12:15], s69 offen lds
	v_mfma_f32_16x16x32_bf16 v[68:71], a[20:23], a[52:55], v[68:71]
	s_waitcnt vmcnt(11)
	ds_read_b64_tr_b16 a[0:1], v1 offset:8192
	v_mfma_f32_16x16x32_bf16 v[68:71], a[16:19], a[36:39], v[68:71]
	ds_read_b64_tr_b16 a[2:3], v1 offset:10240
	v_mfma_f32_16x16x32_bf16 v[72:75], a[16:19], a[40:43], v[72:75]
	s_waitcnt vmcnt(7)
	ds_read_b64_tr_b16 a[4:5], v1 offset:12288
	v_mfma_f32_16x16x32_bf16 v[72:75], a[20:23], a[56:59], v[72:75]
	buffer_load_dwordx4 v21, s[12:15], s69 offen offset:1024 lds
	v_mfma_f32_16x16x32_bf16 v[76:79], a[20:23], a[60:63], v[76:79]
	s_add_u32 s69, s69, 0x2000
	ds_read_b64_tr_b16 a[6:7], v1 offset:14336
	v_mfma_f32_16x16x32_bf16 v[76:79], a[16:19], a[44:47], v[76:79]
	s_waitcnt lgkmcnt(6)
	s_and_b32 s69, s69, 0x7ffff
	v_mfma_f32_16x16x32_bf16 v[108:111], a[24:27], a[44:47], v[108:111]
	s_waitcnt lgkmcnt(4)
	v_mfma_f32_16x16x32_bf16 v[108:111], a[28:31], a[60:63], v[108:111]
	v_mfma_f32_16x16x32_bf16 v[104:107], a[28:31], a[56:59], v[104:107]
	v_mfma_f32_16x16x32_bf16 v[104:107], a[24:27], a[40:43], v[104:107]
	ds_read_b64_tr_b16 a[8:9], v2 offset:8192
	v_mfma_f32_16x16x32_bf16 v[100:103], a[24:27], a[36:39], v[100:103]
	ds_read_b64_tr_b16 a[10:11], v2 offset:10240
	v_mfma_f32_16x16x32_bf16 v[100:103], a[28:31], a[52:55], v[100:103]
	ds_read_b64_tr_b16 a[12:13], v2 offset:12288
	v_mfma_f32_16x16x32_bf16 v[96:99], a[28:31], a[48:51], v[96:99]
	ds_read_b64_tr_b16 a[14:15], v2 offset:14336
	v_mfma_f32_16x16x32_bf16 v[96:99], a[24:27], a[32:35], v[96:99]
	s_waitcnt lgkmcnt(5)
	v_mfma_f32_16x16x32_bf16 v[32:35], a[0:3], a[64:67], v[32:35]
	s_waitcnt lgkmcnt(4)
	v_mfma_f32_16x16x32_bf16 v[32:35], a[4:7], a[80:83], v[32:35]
	v_mfma_f32_16x16x32_bf16 v[36:39], a[4:7], a[84:87], v[36:39]
	v_mfma_f32_16x16x32_bf16 v[36:39], a[0:3], a[68:71], v[36:39]
	ds_read_b64_tr_b16 a[16:17], v3 offset:8192
	v_mfma_f32_16x16x32_bf16 v[40:43], a[0:3], a[72:75], v[40:43]
	ds_read_b64_tr_b16 a[18:19], v3 offset:10240
	v_mfma_f32_16x16x32_bf16 v[40:43], a[4:7], a[88:91], v[40:43]
	ds_read_b64_tr_b16 a[20:21], v3 offset:12288
	v_mfma_f32_16x16x32_bf16 v[44:47], a[4:7], a[92:95], v[44:47]
	ds_read_b64_tr_b16 a[22:23], v3 offset:14336
	v_mfma_f32_16x16x32_bf16 v[44:47], a[0:3], a[76:79], v[44:47]
	s_waitcnt lgkmcnt(5)
	v_mfma_f32_16x16x32_bf16 v[60:63], a[8:11], a[76:79], v[60:63]
	s_waitcnt lgkmcnt(4)
	v_mfma_f32_16x16x32_bf16 v[60:63], a[12:15], a[92:95], v[60:63]
	v_mfma_f32_16x16x32_bf16 v[56:59], a[12:15], a[88:91], v[56:59]
	v_mfma_f32_16x16x32_bf16 v[56:59], a[8:11], a[72:75], v[56:59]
	ds_read_b64_tr_b16 a[24:25], v4 offset:8192
	v_mfma_f32_16x16x32_bf16 v[52:55], a[8:11], a[68:71], v[52:55]
	ds_read_b64_tr_b16 a[26:27], v4 offset:10240
	v_mfma_f32_16x16x32_bf16 v[52:55], a[12:15], a[84:87], v[52:55]
	ds_read_b64_tr_b16 a[28:29], v4 offset:12288
	v_mfma_f32_16x16x32_bf16 v[48:51], a[12:15], a[80:83], v[48:51]
	ds_read_b64_tr_b16 a[30:31], v4 offset:14336
	v_mfma_f32_16x16x32_bf16 v[48:51], a[8:11], a[64:67], v[48:51]
	s_waitcnt lgkmcnt(5)
	v_mfma_f32_16x16x32_bf16 v[64:67], a[16:19], a[64:67], v[64:67]
	s_waitcnt lgkmcnt(4)
	v_mfma_f32_16x16x32_bf16 v[64:67], a[20:23], a[80:83], v[64:67]
	v_xor_b32 v1, 0x80, v5
	v_xor_b32 v2, 0x80, v6
	v_mfma_f32_16x16x32_bf16 v[68:71], a[20:23], a[84:87], v[68:71]
	v_xor_b32 v3, 0x80, v7
	v_xor_b32 v4, 0x80, v8
	v_mfma_f32_16x16x32_bf16 v[68:71], a[16:19], a[68:71], v[68:71]
	v_cvt_pk_bf16_f32 v63, v62, v63
	v_cvt_pk_bf16_f32 v62, v60, v61
	v_mfma_f32_16x16x32_bf16 v[72:75], a[16:19], a[72:75], v[72:75]
	v_cvt_pk_bf16_f32 v60, v44, v45
	v_cvt_pk_bf16_f32 v61, v46, v47
	v_mfma_f32_16x16x32_bf16 v[72:75], a[20:23], a[88:91], v[72:75]
	v_cvt_pk_bf16_f32 v59, v58, v59
	v_cvt_pk_bf16_f32 v58, v56, v57
	v_mfma_f32_16x16x32_bf16 v[76:79], a[20:23], a[92:95], v[76:79]
	v_cvt_pk_bf16_f32 v56, v40, v41
	v_cvt_pk_bf16_f32 v57, v42, v43
	v_mfma_f32_16x16x32_bf16 v[76:79], a[16:19], a[76:79], v[76:79]
	s_waitcnt lgkmcnt(1)
	v_cvt_pk_bf16_f32 v55, v54, v55
	v_cvt_pk_bf16_f32 v54, v52, v53
	v_mfma_f32_16x16x32_bf16 v[108:111], a[24:27], a[76:79], v[108:111]
	s_waitcnt lgkmcnt(0)
	v_cvt_pk_bf16_f32 v52, v36, v37
	v_cvt_pk_bf16_f32 v53, v38, v39
	v_mfma_f32_16x16x32_bf16 v[108:111], a[28:31], a[92:95], v[108:111]
	v_cvt_pk_bf16_f32 v51, v50, v51
	v_cvt_pk_bf16_f32 v50, v48, v49
	v_mfma_f32_16x16x32_bf16 v[104:107], a[28:31], a[88:91], v[104:107]
	v_cvt_pk_bf16_f32 v48, v32, v33
	v_cvt_pk_bf16_f32 v49, v34, v35
	v_mfma_f32_16x16x32_bf16 v[104:107], a[24:27], a[72:75], v[104:107]
	v_mfma_f32_16x16x32_bf16 v[100:103], a[24:27], a[68:71], v[100:103]
	v_mfma_f32_16x16x32_bf16 v[100:103], a[28:31], a[84:87], v[100:103]
	v_mfma_f32_16x16x32_bf16 v[96:99], a[28:31], a[80:83], v[96:99]
	v_mfma_f32_16x16x32_bf16 v[96:99], a[24:27], a[64:67], v[96:99]
	s_nop 0
	v_cvt_pk_bf16_f32 v111, v110, v111
	v_cvt_pk_bf16_f32 v110, v108, v109
	v_cvt_pk_bf16_f32 v108, v76, v77
	v_cvt_pk_bf16_f32 v109, v78, v79
	v_cvt_pk_bf16_f32 v107, v106, v107
	v_cvt_pk_bf16_f32 v106, v104, v105
	v_cvt_pk_bf16_f32 v104, v72, v73
	v_cvt_pk_bf16_f32 v105, v74, v75
	v_cvt_pk_bf16_f32 v103, v102, v103
	v_cvt_pk_bf16_f32 v102, v100, v101
	v_cvt_pk_bf16_f32 v100, v68, v69
	v_cvt_pk_bf16_f32 v101, v70, v71
	v_cvt_pk_bf16_f32 v99, v98, v99
	v_cvt_pk_bf16_f32 v98, v96, v97
	v_cvt_pk_bf16_f32 v96, v64, v65
	v_cvt_pk_bf16_f32 v97, v66, v67
	v_pk_mov_b32 v[64:65], v[48:49], v[48:49] op_sel:[0,1]
	v_pk_mov_b32 v[66:67], v[50:51], v[50:51] op_sel:[0,1]
	v_pk_mov_b32 v[68:69], v[52:53], v[52:53] op_sel:[0,1]
	v_pk_mov_b32 v[70:71], v[54:55], v[54:55] op_sel:[0,1]
	v_pk_mov_b32 v[72:73], v[56:57], v[56:57] op_sel:[0,1]
	v_pk_mov_b32 v[74:75], v[58:59], v[58:59] op_sel:[0,1]
	v_pk_mov_b32 v[76:77], v[60:61], v[60:61] op_sel:[0,1]
	v_pk_mov_b32 v[78:79], v[62:63], v[62:63] op_sel:[0,1]
	s_waitcnt vmcnt(0) lgkmcnt(0)
	s_branch L_mlp_done
L_mlp4:
	s_waitcnt vmcnt(0) lgkmcnt(0)
	ds_read_b64_tr_b16 a[0:1], v1 offset:0
	ds_read_b64_tr_b16 a[2:3], v1 offset:2048
	ds_read_b64_tr_b16 a[4:5], v3 offset:0
	ds_read_b64_tr_b16 a[6:7], v3 offset:2048
	ds_read_b64_tr_b16 a[8:9], v2 offset:0
	ds_read_b64_tr_b16 a[10:11], v2 offset:2048
	ds_read_b64_tr_b16 a[12:13], v4 offset:0
	ds_read_b64_tr_b16 a[14:15], v4 offset:2048
	s_barrier
	ds_read_b128 a[32:35], v13 offset:0
	ds_read_b128 a[48:51], v13 offset:1024
	ds_read_b128 a[52:55], v13 offset:17408
	ds_read_b128 a[36:39], v13 offset:16384
	ds_read_b128 a[40:43], v13 offset:32768
	ds_read_b128 a[56:59], v13 offset:33792
	ds_read_b128 a[60:63], v13 offset:50176
	ds_read_b128 a[44:47], v13 offset:49152
	s_waitcnt lgkmcnt(7)
	v_mfma_f32_16x16x32_bf16 v[64:67], a[0:3], a[32:35], 0
	s_waitcnt lgkmcnt(6)
	ds_read_b128 a[64:67], v13 offset:2048
	v_lshl_add_u32 v26, s62, 10, v13
	v_mfma_f32_16x16x32_bf16 v[64:67], a[4:7], a[48:51], v[64:67]
	s_waitcnt lgkmcnt(6)
	ds_read_b128 a[80:83], v13 offset:3072
	v_mov_b32 v28, 0xc0135761
	v_mfma_f32_16x16x32_bf16 v[68:71], a[4:7], a[52:55], 0
	s_waitcnt lgkmcnt(6)
	ds_read_b128 a[68:71], v13 offset:18432
	v_lshlrev_b32 v32, 7, v0
	v_mfma_f32_16x16x32_bf16 v[68:71], a[0:3], a[36:39], v[68:71]
	s_waitcnt lgkmcnt(6)
	ds_read_b64_tr_b16 a[16:17], v1 offset:4096
	ds_read_b128 a[84:87], v13 offset:19456
	v_mfma_f32_16x16x32_bf16 v[72:75], a[0:3], a[40:43], 0
	s_waitcnt lgkmcnt(7)
	ds_read_b64_tr_b16 a[18:19], v1 offset:6144
	ds_read_b128 a[72:75], v13 offset:34816
	v_mfma_f32_16x16x32_bf16 v[72:75], a[4:7], a[56:59], v[72:75]
	s_waitcnt lgkmcnt(8)
	ds_read_b64_tr_b16 a[20:21], v3 offset:4096
	ds_read_b128 a[88:91], v13 offset:35840
	v_mfma_f32_16x16x32_bf16 v[76:79], a[4:7], a[60:63], 0
	s_waitcnt lgkmcnt(9)
	s_add_u32 m0, s64, 0x0
	ds_read_b64_tr_b16 a[22:23], v3 offset:6144
	ds_read_b128 a[76:79], v13 offset:51200
	v_mfma_f32_16x16x32_bf16 v[76:79], a[0:3], a[44:47], v[76:79]
	ds_read_b128 a[92:95], v13 offset:52224
	v_mov_b32 v33, 0x40000000
	v_mfma_f32_16x16x32_bf16 v[92:95], a[8:11], a[44:47], 0
	s_mov_b32 s66, 0x150000
	v_cmp_gt_u32 vcc, 2, v0
	v_and_b32 v34, 7, v0
	v_mfma_f32_16x16x32_bf16 v[92:95], a[12:15], a[60:63], v[92:95]
	buffer_load_dwordx4 v15, s[32:35], s66 offen offset:0 lds
	v_mfma_f32_16x16x32_bf16 v[88:91], a[12:15], a[56:59], 0
	ds_read_b64_tr_b16 a[24:25], v2 offset:4096
	v_lshl_add_u32 v24, v34, 2, s90
	v_mfma_f32_16x16x32_bf16 v[88:91], a[8:11], a[40:43], v[88:91]
	ds_read_b64_tr_b16 a[26:27], v2 offset:6144
	v_cndmask_b32 v22, v33, v32, vcc
	v_mfma_f32_16x16x32_bf16 v[84:87], a[8:11], a[36:39], 0
	s_mov_b32 s66, 0x156c00
	ds_read_b64_tr_b16 a[28:29], v4 offset:4096
	v_and_b32 v32, 15, v0
	v_mfma_f32_16x16x32_bf16 v[84:87], a[12:15], a[52:55], v[84:87]
	buffer_load_dwordx4 v15, s[32:35], s66 offen offset:1024 lds
	v_mfma_f32_16x16x32_bf16 v[80:83], a[12:15], a[48:51], 0
	ds_read_b64_tr_b16 a[30:31], v4 offset:6144
	v_lshlrev_b32 v32, 10, v32
	v_mfma_f32_16x16x32_bf16 v[80:83], a[8:11], a[32:35], v[80:83]
	s_waitcnt lgkmcnt(7)
	v_lshrrev_b32 v33, 4, v0
	v_lshl_or_b32 v17, v33, 3, v32
	v_mfma_f32_16x16x32_bf16 v[64:67], a[16:19], a[64:67], v[64:67]
	s_waitcnt lgkmcnt(5)
	s_mov_b32 s66, 0x15d800
	ds_read_b128 a[32:35], v13 offset:4096
	v_mfma_f32_16x16x32_bf16 v[64:67], a[20:23], a[80:83], v[64:67]
	buffer_load_dwordx4 v15, s[32:35], s66 offen offset:2048 lds
	v_mfma_f32_16x16x32_bf16 v[68:71], a[20:23], a[84:87], v[68:71]
	ds_read_b64_tr_b16 a[0:1], v1 offset:8192
	ds_read_b128 a[48:51], v13 offset:5120
	v_mfma_f32_16x16x32_bf16 v[68:71], a[16:19], a[68:71], v[68:71]
	ds_read_b64_tr_b16 a[2:3], v1 offset:10240
	ds_read_b128 a[36:39], v13 offset:20480
	v_mfma_f32_16x16x32_bf16 v[72:75], a[16:19], a[72:75], v[72:75]
	s_mov_b32 s66, 0x164400
	ds_read_b64_tr_b16 a[4:5], v3 offset:8192
	ds_read_b128 a[52:55], v13 offset:21504
	v_mfma_f32_16x16x32_bf16 v[72:75], a[20:23], a[88:91], v[72:75]
	s_waitcnt lgkmcnt(9)
	buffer_load_dwordx4 v15, s[32:35], s66 offen offset:3072 lds
	v_mfma_f32_16x16x32_bf16 v[76:79], a[20:23], a[92:95], v[76:79]
	s_add_u32 m0, s64, 0x1000
	ds_read_b64_tr_b16 a[6:7], v3 offset:10240
	ds_read_b128 a[40:43], v13 offset:36864
	v_mfma_f32_16x16x32_bf16 v[76:79], a[16:19], a[76:79], v[76:79]
	ds_read_b128 a[56:59], v13 offset:37888
	ds_read_b128 a[44:47], v13 offset:53248
	v_mfma_f32_16x16x32_bf16 v[92:95], a[24:27], a[76:79], v[92:95]
	s_waitcnt lgkmcnt(11)
	s_mov_b32 s66, 0x188000
	ds_read_b128 a[60:63], v13 offset:54272
	v_mfma_f32_16x16x32_bf16 v[92:95], a[28:31], a[92:95], v[92:95]
	buffer_load_dwordx4 v15, s[32:35], s66 offen offset:0 lds
	v_mfma_f32_16x16x32_bf16 v[88:91], a[28:31], a[88:91], v[88:91]
	ds_read_b64_tr_b16 a[8:9], v2 offset:8192
	v_mfma_f32_16x16x32_bf16 v[88:91], a[24:27], a[72:75], v[88:91]
	ds_read_b64_tr_b16 a[10:11], v2 offset:10240
	v_mfma_f32_16x16x32_bf16 v[84:87], a[24:27], a[68:71], v[84:87]
	s_mov_b32 s66, 0x18ec00
	ds_read_b64_tr_b16 a[12:13], v4 offset:8192
	v_mfma_f32_16x16x32_bf16 v[84:87], a[28:31], a[84:87], v[84:87]
	buffer_load_dwordx4 v15, s[32:35], s66 offen offset:1024 lds
	v_mfma_f32_16x16x32_bf16 v[80:83], a[28:31], a[80:83], v[80:83]
	ds_read_b64_tr_b16 a[14:15], v4 offset:10240
	v_mfma_f32_16x16x32_bf16 v[80:83], a[24:27], a[64:67], v[80:83]
	s_waitcnt lgkmcnt(9)
	v_mfma_f32_16x16x32_bf16 v[64:67], a[0:3], a[32:35], v[64:67]
	s_waitcnt lgkmcnt(7)
	s_mov_b32 s66, 0x195800
	ds_read_b128 a[64:67], v13 offset:6144
	v_mfma_f32_16x16x32_bf16 v[64:67], a[4:7], a[48:51], v[64:67]
	buffer_load_dwordx4 v15, s[32:35], s66 offen offset:2048 lds
	v_mfma_f32_16x16x32_bf16 v[68:71], a[4:7], a[52:55], v[68:71]
	ds_read_b64_tr_b16 a[16:17], v1 offset:12288
	ds_read_b128 a[80:83], v13 offset:7168
	v_mfma_f32_16x16x32_bf16 v[68:71], a[0:3], a[36:39], v[68:71]
	ds_read_b64_tr_b16 a[18:19], v1 offset:14336
	ds_read_b128 a[68:71], v13 offset:22528
	v_mfma_f32_16x16x32_bf16 v[72:75], a[0:3], a[40:43], v[72:75]
	s_waitcnt lgkmcnt(8)
	s_mov_b32 s66, 0x19c400
	ds_read_b64_tr_b16 a[20:21], v3 offset:12288
	ds_read_b128 a[84:87], v13 offset:23552
	v_mfma_f32_16x16x32_bf16 v[72:75], a[4:7], a[56:59], v[72:75]
	buffer_load_dwordx4 v15, s[32:35], s66 offen offset:3072 lds
	v_mfma_f32_16x16x32_bf16 v[76:79], a[4:7], a[60:63], v[76:79]
	s_add_u32 m0, s64, 0x2000
	ds_read_b64_tr_b16 a[22:23], v3 offset:14336
	ds_read_b128 a[72:75], v13 offset:38912
	v_mfma_f32_16x16x32_bf16 v[76:79], a[0:3], a[44:47], v[76:79]
	s_waitcnt lgkmcnt(10)
	ds_read_b128 a[88:91], v13 offset:39936
	ds_read_b128 a[76:79], v13 offset:55296
	v_mfma_f32_16x16x32_bf16 v[92:95], a[8:11], a[44:47], v[92:95]
	s_waitcnt lgkmcnt(11)
	s_mov_b32 s66, 0x0
	ds_read_b128 a[92:95], v13 offset:56320
	v_mfma_f32_16x16x32_bf16 v[92:95], a[12:15], a[60:63], v[92:95]
	buffer_load_dwordx4 v16, s[36:39], s66 offen offset:0 lds
	v_mfma_f32_16x16x32_bf16 v[88:91], a[12:15], a[56:59], v[88:91]
	ds_read_b64_tr_b16 a[24:25], v2 offset:12288
	v_mfma_f32_16x16x32_bf16 v[88:91], a[8:11], a[40:43], v[88:91]
	ds_read_b64_tr_b16 a[26:27], v2 offset:14336
	v_mfma_f32_16x16x32_bf16 v[84:87], a[8:11], a[36:39], v[84:87]
	s_mov_b32 s66, 0x1c00
	ds_read_b64_tr_b16 a[28:29], v4 offset:12288
	v_mfma_f32_16x16x32_bf16 v[84:87], a[12:15], a[52:55], v[84:87]
	buffer_load_dwordx4 v16, s[36:39], s66 offen offset:1024 lds
	v_mfma_f32_16x16x32_bf16 v[80:83], a[12:15], a[48:51], v[80:83]
	ds_read_b64_tr_b16 a[30:31], v4 offset:14336
	v_mfma_f32_16x16x32_bf16 v[80:83], a[8:11], a[32:35], v[80:83]
	s_waitcnt lgkmcnt(9)
	v_mfma_f32_16x16x32_bf16 v[64:67], a[16:19], a[64:67], v[64:67]
	s_waitcnt lgkmcnt(7)
	s_mov_b32 s66, 0x3800
	ds_read_b128 a[32:35], v13 offset:8192
	v_mfma_f32_16x16x32_bf16 v[64:67], a[20:23], a[80:83], v[64:67]
	buffer_load_dwordx4 v16, s[36:39], s66 offen offset:2048 lds
	v_mfma_f32_16x16x32_bf16 v[68:71], a[20:23], a[84:87], v[68:71]
	ds_read_b64_tr_b16 a[0:1], v1 offset:16384
	ds_read_b128 a[48:51], v13 offset:9216
	v_mfma_f32_16x16x32_bf16 v[68:71], a[16:19], a[68:71], v[68:71]
	ds_read_b64_tr_b16 a[2:3], v1 offset:18432
	ds_read_b128 a[36:39], v13 offset:24576
	v_mfma_f32_16x16x32_bf16 v[72:75], a[16:19], a[72:75], v[72:75]
	s_waitcnt lgkmcnt(8)
	s_mov_b32 s66, 0x5400
	ds_read_b64_tr_b16 a[4:5], v3 offset:16384
	ds_read_b128 a[52:55], v13 offset:25600
	v_mfma_f32_16x16x32_bf16 v[72:75], a[20:23], a[88:91], v[72:75]
	buffer_load_dwordx4 v16, s[36:39], s66 offen offset:3072 lds
	v_mfma_f32_16x16x32_bf16 v[76:79], a[20:23], a[92:95], v[76:79]
	s_add_u32 m0, s64, 0x3000
	ds_read_b64_tr_b16 a[6:7], v3 offset:18432
	ds_read_b128 a[40:43], v13 offset:40960
	v_mfma_f32_16x16x32_bf16 v[76:79], a[16:19], a[76:79], v[76:79]
	s_waitcnt lgkmcnt(10)
	ds_read_b128 a[56:59], v13 offset:41984
	ds_read_b128 a[44:47], v13 offset:57344
	v_mfma_f32_16x16x32_bf16 v[92:95], a[24:27], a[76:79], v[92:95]
	s_waitcnt lgkmcnt(11)
	s_mov_b32 s66, 0x8000
	ds_read_b128 a[60:63], v13 offset:58368
	v_mfma_f32_16x16x32_bf16 v[92:95], a[28:31], a[92:95], v[92:95]
	buffer_load_dwordx4 v16, s[36:39], s66 offen offset:0 lds
	v_mfma_f32_16x16x32_bf16 v[88:91], a[28:31], a[88:91], v[88:91]
	ds_read_b64_tr_b16 a[8:9], v2 offset:16384
	v_mfma_f32_16x16x32_bf16 v[88:91], a[24:27], a[72:75], v[88:91]
	ds_read_b64_tr_b16 a[10:11], v2 offset:18432
	v_mfma_f32_16x16x32_bf16 v[84:87], a[24:27], a[68:71], v[84:87]
	s_mov_b32 s66, 0x9c00
	ds_read_b64_tr_b16 a[12:13], v4 offset:16384
	v_mfma_f32_16x16x32_bf16 v[84:87], a[28:31], a[84:87], v[84:87]
	buffer_load_dwordx4 v16, s[36:39], s66 offen offset:1024 lds
	v_mfma_f32_16x16x32_bf16 v[80:83], a[28:31], a[80:83], v[80:83]
	ds_read_b64_tr_b16 a[14:15], v4 offset:18432
	v_mfma_f32_16x16x32_bf16 v[80:83], a[24:27], a[64:67], v[80:83]
	s_waitcnt lgkmcnt(9)
	v_mfma_f32_16x16x32_bf16 v[64:67], a[0:3], a[32:35], v[64:67]
	s_waitcnt lgkmcnt(7)
	s_mov_b32 s66, 0xb800
	ds_read_b128 a[64:67], v13 offset:10240
	v_mfma_f32_16x16x32_bf16 v[64:67], a[4:7], a[48:51], v[64:67]
	buffer_load_dwordx4 v16, s[36:39], s66 offen offset:2048 lds
	v_mfma_f32_16x16x32_bf16 v[68:71], a[4:7], a[52:55], v[68:71]
	ds_read_b64_tr_b16 a[16:17], v1 offset:20480
	ds_read_b128 a[80:83], v13 offset:11264
	v_mfma_f32_16x16x32_bf16 v[68:71], a[0:3], a[36:39], v[68:71]
	ds_read_b64_tr_b16 a[18:19], v1 offset:22528
	ds_read_b128 a[68:71], v13 offset:26624
	v_mfma_f32_16x16x32_bf16 v[72:75], a[0:3], a[40:43], v[72:75]
	s_waitcnt lgkmcnt(8)
	s_mov_b32 s66, 0xd400
	ds_read_b64_tr_b16 a[20:21], v3 offset:20480
	ds_read_b128 a[84:87], v13 offset:27648
	v_mfma_f32_16x16x32_bf16 v[72:75], a[4:7], a[56:59], v[72:75]
	buffer_load_dwordx4 v16, s[36:39], s66 offen offset:3072 lds
	v_mfma_f32_16x16x32_bf16 v[76:79], a[4:7], a[60:63], v[76:79]
	s_add_u32 m0, s64, 0x4000
	ds_read_b64_tr_b16 a[22:23], v3 offset:22528
	ds_read_b128 a[72:75], v13 offset:43008
	v_mfma_f32_16x16x32_bf16 v[76:79], a[0:3], a[44:47], v[76:79]
	s_waitcnt lgkmcnt(10)
	ds_read_b128 a[88:91], v13 offset:44032
	ds_read_b128 a[76:79], v13 offset:59392
	v_mfma_f32_16x16x32_bf16 v[92:95], a[8:11], a[44:47], v[92:95]
	s_waitcnt lgkmcnt(11)
	s_mov_b32 s66, 0x10000
	ds_read_b128 a[92:95], v13 offset:60416
	v_mfma_f32_16x16x32_bf16 v[92:95], a[12:15], a[60:63], v[92:95]
	buffer_load_dwordx4 v16, s[36:39], s66 offen offset:0 lds
	v_mfma_f32_16x16x32_bf16 v[88:91], a[12:15], a[56:59], v[88:91]
	ds_read_b64_tr_b16 a[24:25], v2 offset:20480
	v_mfma_f32_16x16x32_bf16 v[88:91], a[8:11], a[40:43], v[88:91]
	ds_read_b64_tr_b16 a[26:27], v2 offset:22528
	v_mfma_f32_16x16x32_bf16 v[84:87], a[8:11], a[36:39], v[84:87]
	s_mov_b32 s66, 0x11c00
	ds_read_b64_tr_b16 a[28:29], v4 offset:20480
	v_mfma_f32_16x16x32_bf16 v[84:87], a[12:15], a[52:55], v[84:87]
	buffer_load_dwordx4 v16, s[36:39], s66 offen offset:1024 lds
	v_mfma_f32_16x16x32_bf16 v[80:83], a[12:15], a[48:51], v[80:83]
	ds_read_b64_tr_b16 a[30:31], v4 offset:22528
	v_mfma_f32_16x16x32_bf16 v[80:83], a[8:11], a[32:35], v[80:83]
	s_waitcnt lgkmcnt(9)
	v_mfma_f32_16x16x32_bf16 v[64:67], a[16:19], a[64:67], v[64:67]
	s_waitcnt lgkmcnt(7)
	s_mov_b32 s66, 0x13800
	ds_read_b128 a[32:35], v13 offset:12288
	v_mfma_f32_16x16x32_bf16 v[64:67], a[20:23], a[80:83], v[64:67]
	buffer_load_dwordx4 v16, s[36:39], s66 offen offset:2048 lds
	v_mfma_f32_16x16x32_bf16 v[68:71], a[20:23], a[84:87], v[68:71]
	s_waitcnt vmcnt(15)
	ds_read_b64_tr_b16 a[0:1], v1 offset:0
	ds_read_b128 a[48:51], v13 offset:13312
	v_mfma_f32_16x16x32_bf16 v[68:71], a[16:19], a[68:71], v[68:71]
	ds_read_b64_tr_b16 a[2:3], v1 offset:2048
	ds_read_b128 a[36:39], v13 offset:28672
	v_mfma_f32_16x16x32_bf16 v[72:75], a[16:19], a[72:75], v[72:75]
	s_waitcnt lgkmcnt(8)
	s_mov_b32 s66, 0x15400
	ds_read_b64_tr_b16 a[4:5], v3 offset:0
	ds_read_b128 a[52:55], v13 offset:29696
	v_mfma_f32_16x16x32_bf16 v[72:75], a[20:23], a[88:91], v[72:75]
	buffer_load_dwordx4 v16, s[36:39], s66 offen offset:3072 lds
	v_mfma_f32_16x16x32_bf16 v[76:79], a[20:23], a[92:95], v[76:79]
	s_add_u32 m0, s64, 0x5000
	ds_read_b64_tr_b16 a[6:7], v3 offset:2048
	ds_read_b128 a[40:43], v13 offset:45056
	v_mfma_f32_16x16x32_bf16 v[76:79], a[16:19], a[76:79], v[76:79]
	s_waitcnt lgkmcnt(10)
	ds_read_b128 a[56:59], v13 offset:46080
	ds_read_b128 a[44:47], v13 offset:61440
	v_mfma_f32_16x16x32_bf16 v[92:95], a[24:27], a[76:79], v[92:95]
	s_waitcnt lgkmcnt(11)
	s_mov_b32 s66, 0x18000
	ds_read_b128 a[60:63], v13 offset:62464
	v_mfma_f32_16x16x32_bf16 v[92:95], a[28:31], a[92:95], v[92:95]
	buffer_load_dwordx4 v16, s[36:39], s66 offen offset:0 lds
	v_mfma_f32_16x16x32_bf16 v[88:91], a[28:31], a[88:91], v[88:91]
	ds_read_b64_tr_b16 a[8:9], v2 offset:0
	v_mfma_f32_16x16x32_bf16 v[88:91], a[24:27], a[72:75], v[88:91]
	ds_read_b64_tr_b16 a[10:11], v2 offset:2048
	v_mfma_f32_16x16x32_bf16 v[84:87], a[24:27], a[68:71], v[84:87]
	s_mov_b32 s66, 0x19c00
	ds_read_b64_tr_b16 a[12:13], v4 offset:0
	v_mfma_f32_16x16x32_bf16 v[84:87], a[28:31], a[84:87], v[84:87]
	buffer_load_dwordx4 v16, s[36:39], s66 offen offset:1024 lds
	v_mfma_f32_16x16x32_bf16 v[80:83], a[28:31], a[80:83], v[80:83]
	ds_read_b64_tr_b16 a[14:15], v4 offset:2048
	v_mfma_f32_16x16x32_bf16 v[80:83], a[24:27], a[64:67], v[80:83]
	s_waitcnt lgkmcnt(9)
	v_mfma_f32_16x16x32_bf16 v[64:67], a[0:3], a[32:35], v[64:67]
	s_waitcnt lgkmcnt(7)
	s_mov_b32 s66, 0x1b800
	ds_read_b128 a[64:67], v13 offset:14336
	v_mfma_f32_16x16x32_bf16 v[64:67], a[4:7], a[48:51], v[64:67]
	buffer_load_dwordx4 v16, s[36:39], s66 offen offset:2048 lds
	v_mfma_f32_16x16x32_bf16 v[68:71], a[4:7], a[52:55], v[68:71]
	s_waitcnt vmcnt(15)
	ds_read_b64_tr_b16 a[16:17], v1 offset:4096
	ds_read_b128 a[80:83], v13 offset:15360
	v_mfma_f32_16x16x32_bf16 v[68:71], a[0:3], a[36:39], v[68:71]
	ds_read_b64_tr_b16 a[18:19], v1 offset:6144
	ds_read_b128 a[68:71], v13 offset:30720
	v_mfma_f32_16x16x32_bf16 v[72:75], a[0:3], a[40:43], v[72:75]
	s_waitcnt lgkmcnt(8)
	s_mov_b32 s66, 0x1d400
	ds_read_b64_tr_b16 a[20:21], v3 offset:4096
	ds_read_b128 a[84:87], v13 offset:31744
	v_mfma_f32_16x16x32_bf16 v[72:75], a[4:7], a[56:59], v[72:75]
	buffer_load_dwordx4 v16, s[36:39], s66 offen offset:3072 lds
	v_mfma_f32_16x16x32_bf16 v[76:79], a[4:7], a[60:63], v[76:79]
	s_add_u32 m0, s64, 0x0
	ds_read_b64_tr_b16 a[22:23], v3 offset:6144
	ds_read_b128 a[72:75], v13 offset:47104
	v_mfma_f32_16x16x32_bf16 v[76:79], a[0:3], a[44:47], v[76:79]
	s_waitcnt lgkmcnt(10)
	ds_read_b128 a[88:91], v13 offset:48128
	ds_read_b128 a[76:79], v13 offset:63488
	v_mfma_f32_16x16x32_bf16 v[92:95], a[8:11], a[44:47], v[92:95]
	s_waitcnt lgkmcnt(11)
	s_mov_b32 s66, 0x200
	ds_read_b128 a[92:95], v13 offset:64512
	v_mfma_f32_16x16x32_bf16 v[92:95], a[12:15], a[60:63], v[92:95]
	buffer_load_dwordx4 v16, s[36:39], s66 offen offset:0 lds
	v_mfma_f32_16x16x32_bf16 v[88:91], a[12:15], a[56:59], v[88:91]
	ds_read_b64_tr_b16 a[24:25], v2 offset:4096
	v_mfma_f32_16x16x32_bf16 v[88:91], a[8:11], a[40:43], v[88:91]
	ds_read_b64_tr_b16 a[26:27], v2 offset:6144
	v_mfma_f32_16x16x32_bf16 v[84:87], a[8:11], a[36:39], v[84:87]
	s_mov_b32 s66, 0x1e00
	ds_read_b64_tr_b16 a[28:29], v4 offset:4096
	v_mfma_f32_16x16x32_bf16 v[84:87], a[12:15], a[52:55], v[84:87]
	buffer_load_dwordx4 v16, s[36:39], s66 offen offset:1024 lds
	v_mfma_f32_16x16x32_bf16 v[80:83], a[12:15], a[48:51], v[80:83]
	ds_read_b64_tr_b16 a[30:31], v4 offset:6144
	v_mfma_f32_16x16x32_bf16 v[80:83], a[8:11], a[32:35], v[80:83]
	s_waitcnt lgkmcnt(9)
	v_mfma_f32_16x16x32_bf16 v[64:67], a[16:19], a[64:67], v[64:67]
	s_waitcnt lgkmcnt(7)
	s_mov_b32 s66, 0x3a00
	v_mfma_f32_16x16x32_bf16 v[64:67], a[20:23], a[80:83], v[64:67]
	buffer_load_dwordx4 v16, s[36:39], s66 offen offset:2048 lds
	v_mfma_f32_16x16x32_bf16 v[68:71], a[20:23], a[84:87], v[68:71]
	v_mfma_f32_16x16x32_bf16 v[68:71], a[16:19], a[68:71], v[68:71]
	v_mfma_f32_16x16x32_bf16 v[72:75], a[16:19], a[72:75], v[72:75]
	s_waitcnt lgkmcnt(3)
	s_mov_b32 s66, 0x5600
	v_mfma_f32_16x16x32_bf16 v[72:75], a[20:23], a[88:91], v[72:75]
	buffer_load_dwordx4 v16, s[36:39], s66 offen offset:3072 lds
	v_mfma_f32_16x16x32_bf16 v[76:79], a[20:23], a[92:95], v[76:79]
	s_add_u32 m0, s64, 0x1000
	v_mfma_f32_16x16x32_bf16 v[76:79], a[16:19], a[76:79], v[76:79]
	s_waitcnt lgkmcnt(1)
	v_mfma_f32_16x16x32_bf16 v[92:95], a[24:27], a[76:79], v[92:95]
	s_waitcnt lgkmcnt(0)
	s_mov_b32 s66, 0x8200
	v_mfma_f32_16x16x32_bf16 v[92:95], a[28:31], a[92:95], v[92:95]
	buffer_load_dwordx4 v16, s[36:39], s66 offen offset:0 lds
	v_mfma_f32_16x16x32_bf16 v[88:91], a[28:31], a[88:91], v[88:91]
	v_mfma_f32_16x16x32_bf16 v[88:91], a[24:27], a[72:75], v[88:91]
	v_mfma_f32_16x16x32_bf16 v[84:87], a[24:27], a[68:71], v[84:87]
	s_mov_b32 s66, 0x9e00
	v_mfma_f32_16x16x32_bf16 v[84:87], a[28:31], a[84:87], v[84:87]
	buffer_load_dwordx4 v16, s[36:39], s66 offen offset:1024 lds
	v_mfma_f32_16x16x32_bf16 v[80:83], a[28:31], a[80:83], v[80:83]
	v_mfma_f32_16x16x32_bf16 v[80:83], a[24:27], a[64:67], v[80:83]
	s_barrier
	v_pk_mul_f32 v[48:49], v[64:65], v[64:65]
	v_pk_mul_f32 v[50:51], v[66:67], v[66:67]
	v_pk_fma_f32 v[48:49], v[48:49], s[76:77], v[28:29] op_sel_hi:[1,1,0]
	v_pk_fma_f32 v[50:51], v[50:51], s[76:77], v[28:29] op_sel_hi:[1,1,0]
	v_pk_mul_f32 v[48:49], v[48:49], v[64:65]
	v_pk_mul_f32 v[50:51], v[50:51], v[66:67]
	v_exp_f32 v48, v48
	v_exp_f32 v49, v49
	v_exp_f32 v50, v50
	v_exp_f32 v51, v51
	v_pk_add_f32 v[48:49], v[48:49], 1.0 op_sel_hi:[1,0]
	v_pk_add_f32 v[50:51], v[50:51], 1.0 op_sel_hi:[1,0]
	v_rcp_f32 v48, v48
	v_rcp_f32 v49, v49
	v_rcp_f32 v50, v50
	v_rcp_f32 v51, v51
	v_pk_mul_f32 v[48:49], v[48:49], v[64:65]
	v_pk_mul_f32 v[50:51], v[50:51], v[66:67]
	v_cvt_pk_bf16_f32 v32, v48, v49
	v_cvt_pk_bf16_f32 v33, v50, v51
L_pg30:
	s_cbranch_execz L_pg21
	s_nop 0
	v_pk_mul_f32 v[52:53], v[80:81], v[80:81]
	v_pk_mul_f32 v[54:55], v[82:83], v[82:83]
	v_pk_fma_f32 v[52:53], v[52:53], s[76:77], v[28:29] op_sel_hi:[1,1,0]
	v_pk_fma_f32 v[54:55], v[54:55], s[76:77], v[28:29] op_sel_hi:[1,1,0]
	v_pk_mul_f32 v[52:53], v[52:53], v[80:81]
	v_pk_mul_f32 v[54:55], v[54:55], v[82:83]
	v_exp_f32 v52, v52
	v_exp_f32 v53, v53
	v_exp_f32 v54, v54
	v_exp_f32 v55, v55
	v_pk_add_f32 v[52:53], v[52:53], 1.0 op_sel_hi:[1,0]
	v_pk_add_f32 v[54:55], v[54:55], 1.0 op_sel_hi:[1,0]
	v_rcp_f32 v52, v52
	v_rcp_f32 v53, v53
	v_rcp_f32 v54, v54
	v_rcp_f32 v55, v55
	v_pk_mul_f32 v[52:53], v[52:53], v[80:81]
	v_pk_mul_f32 v[54:55], v[54:55], v[82:83]
	v_cvt_pk_bf16_f32 v34, v52, v53
	v_cvt_pk_bf16_f32 v35, v54, v55
	ds_write_b128 v26, v[32:35] offset:16384
	v_pk_mul_f32 v[48:49], v[68:69], v[68:69]
	v_pk_mul_f32 v[50:51], v[70:71], v[70:71]
	v_pk_fma_f32 v[48:49], v[48:49], s[76:77], v[28:29] op_sel_hi:[1,1,0]
	v_pk_fma_f32 v[50:51], v[50:51], s[76:77], v[28:29] op_sel_hi:[1,1,0]
	v_pk_mul_f32 v[48:49], v[48:49], v[68:69]
	v_pk_mul_f32 v[50:51], v[50:51], v[70:71]
	v_exp_f32 v48, v48
	v_exp_f32 v49, v49
	v_exp_f32 v50, v50
	v_exp_f32 v51, v51
	v_pk_add_f32 v[48:49], v[48:49], 1.0 op_sel_hi:[1,0]
	v_pk_add_f32 v[50:51], v[50:51], 1.0 op_sel_hi:[1,0]
	v_rcp_f32 v48, v48
	v_rcp_f32 v49, v49
	v_rcp_f32 v50, v50
	v_rcp_f32 v51, v51
	v_pk_mul_f32 v[48:49], v[48:49], v[68:69]
	v_pk_mul_f32 v[50:51], v[50:51], v[70:71]
	v_cvt_pk_bf16_f32 v36, v48, v49
	v_cvt_pk_bf16_f32 v37, v50, v51
	v_pk_mul_f32 v[52:53], v[84:85], v[84:85]
	v_pk_mul_f32 v[54:55], v[86:87], v[86:87]
	v_pk_fma_f32 v[52:53], v[52:53], s[76:77], v[28:29] op_sel_hi:[1,1,0]
	v_pk_fma_f32 v[54:55], v[54:55], s[76:77], v[28:29] op_sel_hi:[1,1,0]
	v_pk_mul_f32 v[52:53], v[52:53], v[84:85]
	v_pk_mul_f32 v[54:55], v[54:55], v[86:87]
	v_exp_f32 v52, v52
	v_exp_f32 v53, v53
	v_exp_f32 v54, v54
	v_exp_f32 v55, v55
	v_pk_add_f32 v[52:53], v[52:53], 1.0 op_sel_hi:[1,0]
	v_pk_add_f32 v[54:55], v[54:55], 1.0 op_sel_hi:[1,0]
	v_rcp_f32 v52, v52
	v_rcp_f32 v53, v53
	v_rcp_f32 v54, v54
	v_rcp_f32 v55, v55
	v_pk_mul_f32 v[52:53], v[52:53], v[84:85]
	v_pk_mul_f32 v[54:55], v[54:55], v[86:87]
	v_cvt_pk_bf16_f32 v38, v52, v53
	v_cvt_pk_bf16_f32 v39, v54, v55
	ds_write_b128 v26, v[36:39] offset:24576
	v_pk_mul_f32 v[48:49], v[72:73], v[72:73]
	v_pk_mul_f32 v[50:51], v[74:75], v[74:75]
	v_pk_fma_f32 v[48:49], v[48:49], s[76:77], v[28:29] op_sel_hi:[1,1,0]
	v_pk_fma_f32 v[50:51], v[50:51], s[76:77], v[28:29] op_sel_hi:[1,1,0]
	v_pk_mul_f32 v[48:49], v[48:49], v[72:73]
	v_pk_mul_f32 v[50:51], v[50:51], v[74:75]
	v_exp_f32 v48, v48
	v_exp_f32 v49, v49
	v_exp_f32 v50, v50
	v_exp_f32 v51, v51
	v_pk_add_f32 v[48:49], v[48:49], 1.0 op_sel_hi:[1,0]
	v_pk_add_f32 v[50:51], v[50:51], 1.0 op_sel_hi:[1,0]
	v_rcp_f32 v48, v48
	v_rcp_f32 v49, v49
	v_rcp_f32 v50, v50
	v_rcp_f32 v51, v51
	v_pk_mul_f32 v[48:49], v[48:49], v[72:73]
	v_pk_mul_f32 v[50:51], v[50:51], v[74:75]
	v_cvt_pk_bf16_f32 v40, v48, v49
	v_cvt_pk_bf16_f32 v41, v50, v51
	v_pk_mul_f32 v[52:53], v[88:89], v[88:89]
	v_pk_mul_f32 v[54:55], v[90:91], v[90:91]
	v_pk_fma_f32 v[52:53], v[52:53], s[76:77], v[28:29] op_sel_hi:[1,1,0]
	v_pk_fma_f32 v[54:55], v[54:55], s[76:77], v[28:29] op_sel_hi:[1,1,0]
	v_pk_mul_f32 v[52:53], v[52:53], v[88:89]
	v_pk_mul_f32 v[54:55], v[54:55], v[90:91]
	v_exp_f32 v52, v52
	v_exp_f32 v53, v53
	v_exp_f32 v54, v54
	v_exp_f32 v55, v55
	v_pk_add_f32 v[52:53], v[52:53], 1.0 op_sel_hi:[1,0]
	v_pk_add_f32 v[54:55], v[54:55], 1.0 op_sel_hi:[1,0]
	v_rcp_f32 v52, v52
	v_rcp_f32 v53, v53
	v_rcp_f32 v54, v54
	v_rcp_f32 v55, v55
	v_pk_mul_f32 v[52:53], v[52:53], v[88:89]
	v_pk_mul_f32 v[54:55], v[54:55], v[90:91]
	v_cvt_pk_bf16_f32 v42, v52, v53
	v_cvt_pk_bf16_f32 v43, v54, v55
	ds_write_b128 v26, v[40:43] offset:49152
	v_pk_mul_f32 v[48:49], v[76:77], v[76:77]
	v_pk_mul_f32 v[50:51], v[78:79], v[78:79]
	v_pk_fma_f32 v[48:49], v[48:49], s[76:77], v[28:29] op_sel_hi:[1,1,0]
	v_pk_fma_f32 v[50:51], v[50:51], s[76:77], v[28:29] op_sel_hi:[1,1,0]
	v_pk_mul_f32 v[48:49], v[48:49], v[76:77]
	v_pk_mul_f32 v[50:51], v[50:51], v[78:79]
	v_exp_f32 v48, v48
	v_exp_f32 v49, v49
	v_exp_f32 v50, v50
	v_exp_f32 v51, v51
	v_pk_add_f32 v[48:49], v[48:49], 1.0 op_sel_hi:[1,0]
	v_pk_add_f32 v[50:51], v[50:51], 1.0 op_sel_hi:[1,0]
	v_rcp_f32 v48, v48
	v_rcp_f32 v49, v49
	v_rcp_f32 v50, v50
	v_rcp_f32 v51, v51
	v_pk_mul_f32 v[48:49], v[48:49], v[76:77]
	v_pk_mul_f32 v[50:51], v[50:51], v[78:79]
	v_cvt_pk_bf16_f32 v44, v48, v49
	v_cvt_pk_bf16_f32 v45, v50, v51
	v_pk_mul_f32 v[52:53], v[92:93], v[92:93]
	v_pk_mul_f32 v[54:55], v[94:95], v[94:95]
	v_pk_fma_f32 v[52:53], v[52:53], s[76:77], v[28:29] op_sel_hi:[1,1,0]
	v_pk_fma_f32 v[54:55], v[54:55], s[76:77], v[28:29] op_sel_hi:[1,1,0]
	v_pk_mul_f32 v[52:53], v[52:53], v[92:93]
	v_pk_mul_f32 v[54:55], v[54:55], v[94:95]
	v_exp_f32 v52, v52
	v_exp_f32 v53, v53
	v_exp_f32 v54, v54
	v_exp_f32 v55, v55
	v_pk_add_f32 v[52:53], v[52:53], 1.0 op_sel_hi:[1,0]
	v_pk_add_f32 v[54:55], v[54:55], 1.0 op_sel_hi:[1,0]
	v_rcp_f32 v52, v52
	v_rcp_f32 v53, v53
	v_rcp_f32 v54, v54
	v_rcp_f32 v55, v55
	v_pk_mul_f32 v[52:53], v[52:53], v[92:93]
	v_pk_mul_f32 v[54:55], v[54:55], v[94:95]
	v_cvt_pk_bf16_f32 v46, v52, v53
	v_cvt_pk_bf16_f32 v47, v54, v55
	ds_write_b128 v26, v[44:47] offset:57344
	s_waitcnt vmcnt(18)
	ds_read_b64_tr_b16 a[0:1], v1 offset:8192
	ds_read_b64_tr_b16 a[2:3], v1 offset:10240
	s_waitcnt vmcnt(14)
	ds_read_b64_tr_b16 a[4:5], v1 offset:12288
	ds_read_b64_tr_b16 a[6:7], v1 offset:14336
	ds_read_b64_tr_b16 a[8:9], v2 offset:8192
	ds_read_b64_tr_b16 a[10:11], v2 offset:10240
	ds_read_b64_tr_b16 a[12:13], v2 offset:12288
	ds_read_b64_tr_b16 a[14:15], v2 offset:14336
	s_waitcnt lgkmcnt(8)
	s_barrier
	ds_read_b128 a[32:35], v13 offset:16384
	ds_read_b128 a[48:51], v13 offset:17408
	ds_read_b128 a[52:55], v13 offset:25600
	ds_read_b128 a[36:39], v13 offset:24576
	ds_read_b128 a[40:43], v13 offset:49152
	ds_read_b128 a[56:59], v13 offset:50176
	ds_read_b128 a[60:63], v13 offset:58368
	ds_read_b128 a[44:47], v13 offset:57344
	s_waitcnt lgkmcnt(7)
	v_mfma_f32_16x16x32_bf16 v[64:67], a[0:3], a[32:35], 0
	s_waitcnt lgkmcnt(6)
	s_add_u32 m0, s64, 0x1000
	s_mov_b32 s66, 0xba00
	ds_read_b128 a[64:67], v13 offset:18432
	v_mfma_f32_16x16x32_bf16 v[64:67], a[4:7], a[48:51], v[64:67]
	s_waitcnt lgkmcnt(6)
	buffer_load_dwordx4 v16, s[36:39], s66 offen offset:2048 lds
	v_mfma_f32_16x16x32_bf16 v[68:71], a[4:7], a[52:55], 0
	s_waitcnt lgkmcnt(5)
	s_mov_b32 s66, 0xd600
	ds_read_b64_tr_b16 a[16:17], v3 offset:8192
	ds_read_b128 a[80:83], v13 offset:19456
	v_mfma_f32_16x16x32_bf16 v[68:71], a[0:3], a[36:39], v[68:71]
	s_waitcnt lgkmcnt(6)
	buffer_load_dwordx4 v16, s[36:39], s66 offen offset:3072 lds
	v_mfma_f32_16x16x32_bf16 v[72:75], a[0:3], a[40:43], 0
	s_waitcnt lgkmcnt(5)
	ds_read_b64_tr_b16 a[18:19], v3 offset:10240
	ds_read_b128 a[68:71], v13 offset:26624
	v_mfma_f32_16x16x32_bf16 v[72:75], a[4:7], a[56:59], v[72:75]
	s_waitcnt lgkmcnt(6)
	ds_read_b64_tr_b16 a[20:21], v3 offset:12288
	v_mfma_f32_16x16x32_bf16 v[76:79], a[4:7], a[60:63], 0
	s_waitcnt lgkmcnt(6)
	ds_read_b64_tr_b16 a[22:23], v3 offset:14336
	ds_read_b128 a[84:87], v13 offset:27648
	v_mfma_f32_16x16x32_bf16 v[76:79], a[0:3], a[44:47], v[76:79]
	v_mfma_f32_16x16x32_bf16 v[92:95], a[8:11], a[44:47], 0
	ds_read_b128 a[72:75], v13 offset:51200
	v_mfma_f32_16x16x32_bf16 v[92:95], a[12:15], a[60:63], v[92:95]
	v_mfma_f32_16x16x32_bf16 v[88:91], a[12:15], a[56:59], 0
	ds_read_b128 a[88:91], v13 offset:52224
	v_mfma_f32_16x16x32_bf16 v[88:91], a[8:11], a[40:43], v[88:91]
	ds_read_b64_tr_b16 a[24:25], v4 offset:8192
	v_mfma_f32_16x16x32_bf16 v[84:87], a[8:11], a[36:39], 0
	ds_read_b64_tr_b16 a[26:27], v4 offset:10240
	ds_read_b128 a[76:79], v13 offset:59392
	v_mfma_f32_16x16x32_bf16 v[84:87], a[12:15], a[52:55], v[84:87]
	ds_read_b64_tr_b16 a[28:29], v4 offset:12288
	v_mfma_f32_16x16x32_bf16 v[80:83], a[12:15], a[48:51], 0
	ds_read_b64_tr_b16 a[30:31], v4 offset:14336
	ds_read_b128 a[92:95], v13 offset:60416
	v_mfma_f32_16x16x32_bf16 v[80:83], a[8:11], a[32:35], v[80:83]
	s_waitcnt lgkmcnt(10)
	v_mfma_f32_16x16x32_bf16 v[96:99], a[16:19], a[32:35], 0
	s_waitcnt lgkmcnt(8)
	v_mfma_f32_16x16x32_bf16 v[96:99], a[20:23], a[48:51], v[96:99]
	v_mfma_f32_16x16x32_bf16 v[100:103], a[20:23], a[52:55], 0
	v_mfma_f32_16x16x32_bf16 v[100:103], a[16:19], a[36:39], v[100:103]
	s_waitcnt vmcnt(12)
	ds_read_b64_tr_b16 a[0:1], v1 offset:16384
	v_mfma_f32_16x16x32_bf16 v[104:107], a[16:19], a[40:43], 0
	ds_read_b64_tr_b16 a[2:3], v1 offset:18432
	v_mfma_f32_16x16x32_bf16 v[104:107], a[20:23], a[56:59], v[104:107]
	s_waitcnt vmcnt(8)
	ds_read_b64_tr_b16 a[4:5], v1 offset:20480
	v_mfma_f32_16x16x32_bf16 v[108:111], a[20:23], a[60:63], 0
	s_add_u32 m0, s64, 0x2000
	ds_read_b64_tr_b16 a[6:7], v1 offset:22528
	v_mfma_f32_16x16x32_bf16 v[108:111], a[16:19], a[44:47], v[108:111]
	s_waitcnt lgkmcnt(6)
	v_mfma_f32_16x16x32_bf16 v[124:127], a[24:27], a[44:47], 0
	s_waitcnt lgkmcnt(4)
	s_mov_b32 s66, 0x10200
	v_mfma_f32_16x16x32_bf16 v[124:127], a[28:31], a[60:63], v[124:127]
	buffer_load_dwordx4 v16, s[36:39], s66 offen offset:0 lds
	v_mfma_f32_16x16x32_bf16 v[120:123], a[28:31], a[56:59], 0
	ds_read_b64_tr_b16 a[8:9], v2 offset:16384
	v_mfma_f32_16x16x32_bf16 v[120:123], a[24:27], a[40:43], v[120:123]
	ds_read_b64_tr_b16 a[10:11], v2 offset:18432
	v_mfma_f32_16x16x32_bf16 v[116:119], a[24:27], a[36:39], 0
	s_mov_b32 s66, 0x11e00
	ds_read_b64_tr_b16 a[12:13], v2 offset:20480
	v_mfma_f32_16x16x32_bf16 v[116:119], a[28:31], a[52:55], v[116:119]
	buffer_load_dwordx4 v16, s[36:39], s66 offen offset:1024 lds
	v_mfma_f32_16x16x32_bf16 v[112:115], a[28:31], a[48:51], 0
	ds_read_b64_tr_b16 a[14:15], v2 offset:22528
	v_mfma_f32_16x16x32_bf16 v[112:115], a[24:27], a[32:35], v[112:115]
	s_waitcnt lgkmcnt(5)
	v_mfma_f32_16x16x32_bf16 v[64:67], a[0:3], a[64:67], v[64:67]
	s_waitcnt lgkmcnt(4)
	s_mov_b32 s66, 0x13a00
	ds_read_b128 a[32:35], v13 offset:16384
	v_mfma_f32_16x16x32_bf16 v[64:67], a[4:7], a[80:83], v[64:67]
	buffer_load_dwordx4 v16, s[36:39], s66 offen offset:2048 lds
	v_mfma_f32_16x16x32_bf16 v[68:71], a[4:7], a[84:87], v[68:71]
	ds_read_b64_tr_b16 a[16:17], v3 offset:16384
	ds_read_b128 a[48:51], v13 offset:17408
	v_mfma_f32_16x16x32_bf16 v[68:71], a[0:3], a[68:71], v[68:71]
	ds_read_b64_tr_b16 a[18:19], v3 offset:18432
	v_mfma_f32_16x16x32_bf16 v[72:75], a[0:3], a[72:75], v[72:75]
	s_mov_b32 s66, 0x15600
	ds_read_b64_tr_b16 a[20:21], v3 offset:20480
	ds_read_b128 a[36:39], v13 offset:24576
	v_mfma_f32_16x16x32_bf16 v[72:75], a[4:7], a[88:91], v[72:75]
	buffer_load_dwordx4 v16, s[36:39], s66 offen offset:3072 lds
	v_mfma_f32_16x16x32_bf16 v[76:79], a[4:7], a[92:95], v[76:79]
	s_add_u32 m0, s64, 0x3000
	ds_read_b64_tr_b16 a[22:23], v3 offset:22528
	ds_read_b128 a[52:55], v13 offset:25600
	v_mfma_f32_16x16x32_bf16 v[76:79], a[0:3], a[76:79], v[76:79]
	s_waitcnt lgkmcnt(9)
	v_mfma_f32_16x16x32_bf16 v[92:95], a[8:11], a[76:79], v[92:95]
	s_waitcnt lgkmcnt(8)
	s_mov_b32 s66, 0x18200
	ds_read_b128 a[40:43], v13 offset:49152
	v_mfma_f32_16x16x32_bf16 v[92:95], a[12:15], a[92:95], v[92:95]
	buffer_load_dwordx4 v16, s[36:39], s66 offen offset:0 lds
	v_mfma_f32_16x16x32_bf16 v[88:91], a[12:15], a[88:91], v[88:91]
	ds_read_b64_tr_b16 a[24:25], v4 offset:16384
	ds_read_b128 a[56:59], v13 offset:50176
	v_mfma_f32_16x16x32_bf16 v[88:91], a[8:11], a[72:75], v[88:91]
	ds_read_b64_tr_b16 a[26:27], v4 offset:18432
	v_mfma_f32_16x16x32_bf16 v[84:87], a[8:11], a[68:71], v[84:87]
	s_mov_b32 s66, 0x19e00
	ds_read_b64_tr_b16 a[28:29], v4 offset:20480
	ds_read_b128 a[44:47], v13 offset:57344
	v_mfma_f32_16x16x32_bf16 v[84:87], a[12:15], a[84:87], v[84:87]
	buffer_load_dwordx4 v16, s[36:39], s66 offen offset:1024 lds
	v_mfma_f32_16x16x32_bf16 v[80:83], a[12:15], a[80:83], v[80:83]
	ds_read_b64_tr_b16 a[30:31], v4 offset:22528
	ds_read_b128 a[60:63], v13 offset:58368
	v_mfma_f32_16x16x32_bf16 v[80:83], a[8:11], a[64:67], v[80:83]
	s_waitcnt lgkmcnt(10)
	v_mfma_f32_16x16x32_bf16 v[96:99], a[16:19], a[64:67], v[96:99]
	s_waitcnt lgkmcnt(8)
	s_mov_b32 s66, 0x1ba00
	v_mfma_f32_16x16x32_bf16 v[96:99], a[20:23], a[80:83], v[96:99]
	buffer_load_dwordx4 v16, s[36:39], s66 offen offset:2048 lds
	v_mfma_f32_16x16x32_bf16 v[100:103], a[20:23], a[84:87], v[100:103]
	s_waitcnt vmcnt(11)
	ds_read_b64_tr_b16 a[0:1], v1 offset:0
	v_cvt_pk_bf16_f32 v95, v94, v95
	v_mfma_f32_16x16x32_bf16 v[100:103], a[16:19], a[68:71], v[100:103]
	ds_read_b64_tr_b16 a[2:3], v1 offset:2048
	v_cvt_pk_bf16_f32 v94, v92, v93
	v_mfma_f32_16x16x32_bf16 v[104:107], a[16:19], a[72:75], v[104:107]
	s_waitcnt vmcnt(7)
	s_mov_b32 s66, 0x1d600
	ds_read_b64_tr_b16 a[4:5], v1 offset:4096
	v_cvt_pk_bf16_f32 v92, v76, v77
	v_mfma_f32_16x16x32_bf16 v[104:107], a[20:23], a[88:91], v[104:107]
	buffer_load_dwordx4 v16, s[36:39], s66 offen offset:3072 lds
	v_mfma_f32_16x16x32_bf16 v[108:111], a[20:23], a[92:95], v[108:111]
	ds_read_b64_tr_b16 a[6:7], v1 offset:6144
	v_cvt_pk_bf16_f32 v93, v78, v79
	v_mfma_f32_16x16x32_bf16 v[108:111], a[16:19], a[76:79], v[108:111]
	s_waitcnt lgkmcnt(6)
	v_cvt_pk_bf16_f32 v91, v90, v91
	v_cvt_pk_bf16_f32 v90, v88, v89
	v_mfma_f32_16x16x32_bf16 v[124:127], a[24:27], a[76:79], v[124:127]
	s_waitcnt lgkmcnt(4)
	s_add_u32 m0, s65, 0x0
	v_cvt_pk_bf16_f32 v88, v72, v73
	v_cvt_pk_bf16_f32 v89, v74, v75
	v_mfma_f32_16x16x32_bf16 v[124:127], a[28:31], a[92:95], v[124:127]
	buffer_load_dwordx4 v18, s[8:11], s68 offen lds
	v_mfma_f32_16x16x32_bf16 v[120:123], a[28:31], a[88:91], v[120:123]
	ds_read_b64_tr_b16 a[8:9], v2 offset:0
	v_cvt_pk_bf16_f32 v87, v86, v87
	v_mfma_f32_16x16x32_bf16 v[120:123], a[24:27], a[72:75], v[120:123]
	ds_read_b64_tr_b16 a[10:11], v2 offset:2048
	v_cvt_pk_bf16_f32 v86, v84, v85
	v_mfma_f32_16x16x32_bf16 v[116:119], a[24:27], a[68:71], v[116:119]
	ds_read_b64_tr_b16 a[12:13], v2 offset:4096
	v_cvt_pk_bf16_f32 v84, v68, v69
	v_mfma_f32_16x16x32_bf16 v[116:119], a[28:31], a[84:87], v[116:119]
	buffer_load_dwordx4 v19, s[8:11], s68 offen offset:1024 lds
	v_mfma_f32_16x16x32_bf16 v[112:115], a[28:31], a[80:83], v[112:115]
	s_add_u32 s68, s68, 0x2000
	ds_read_b64_tr_b16 a[14:15], v2 offset:6144
	v_cvt_pk_bf16_f32 v85, v70, v71
	v_mfma_f32_16x16x32_bf16 v[112:115], a[24:27], a[64:67], v[112:115]
	s_waitcnt lgkmcnt(5)
	s_and_b32 s68, s68, 0x7ffff
	v_cvt_pk_bf16_f32 v83, v82, v83
	v_cvt_pk_bf16_f32 v82, v80, v81
	v_mfma_f32_16x16x32_bf16 v[32:35], a[0:3], a[32:35], 0
	s_waitcnt lgkmcnt(4)
	s_add_u32 m0, s65, 0x2000
	ds_read_b128 a[64:67], v13 offset:18432
	v_cvt_pk_bf16_f32 v80, v64, v65
	v_mfma_f32_16x16x32_bf16 v[32:35], a[4:7], a[48:51], v[32:35]
	buffer_load_dwordx4 v18, s[8:11], s68 offen lds
	v_mfma_f32_16x16x32_bf16 v[36:39], a[4:7], a[52:55], 0
	ds_read_b64_tr_b16 a[16:17], v3 offset:0
	ds_read_b128 a[80:83], v13 offset:19456
	v_mfma_f32_16x16x32_bf16 v[36:39], a[0:3], a[36:39], v[36:39]
	ds_read_b64_tr_b16 a[18:19], v3 offset:2048
	v_cvt_pk_bf16_f32 v81, v66, v67
	v_mfma_f32_16x16x32_bf16 v[40:43], a[0:3], a[40:43], 0
	ds_read_b64_tr_b16 a[20:21], v3 offset:4096
	ds_read_b128 a[68:71], v13 offset:26624
	v_mfma_f32_16x16x32_bf16 v[40:43], a[4:7], a[56:59], v[40:43]
	buffer_load_dwordx4 v19, s[8:11], s68 offen offset:1024 lds
	v_mfma_f32_16x16x32_bf16 v[44:47], a[4:7], a[60:63], 0
	s_add_u32 s68, s68, 0x2000
	ds_read_b64_tr_b16 a[22:23], v3 offset:6144
	ds_read_b128 a[84:87], v13 offset:27648
	v_mfma_f32_16x16x32_bf16 v[44:47], a[0:3], a[44:47], v[44:47]
	s_waitcnt lgkmcnt(9)
	s_and_b32 s68, s68, 0x7ffff
	v_cvt_pk_bf16_f32 v127, v126, v127
	v_cvt_pk_bf16_f32 v126, v124, v125
	v_mfma_f32_16x16x32_bf16 v[60:63], a[8:11], a[44:47], 0
	s_waitcnt lgkmcnt(8)
	s_add_u32 m0, s65, 0x8000
	ds_read_b128 a[72:75], v13 offset:51200
	v_cvt_pk_bf16_f32 v124, v108, v109
	v_mfma_f32_16x16x32_bf16 v[60:63], a[12:15], a[60:63], v[60:63]
	buffer_load_dwordx4 v20, s[12:15], s69 offen lds
	v_mfma_f32_16x16x32_bf16 v[56:59], a[12:15], a[56:59], 0
	ds_read_b64_tr_b16 a[24:25], v4 offset:0
	ds_read_b128 a[88:91], v13 offset:52224
	v_mfma_f32_16x16x32_bf16 v[56:59], a[8:11], a[40:43], v[56:59]
	ds_read_b64_tr_b16 a[26:27], v4 offset:2048
	v_cvt_pk_bf16_f32 v125, v110, v111
	v_mfma_f32_16x16x32_bf16 v[52:55], a[8:11], a[36:39], 0
	ds_read_b64_tr_b16 a[28:29], v4 offset:4096
	ds_read_b128 a[76:79], v13 offset:59392
	v_mfma_f32_16x16x32_bf16 v[52:55], a[12:15], a[52:55], v[52:55]
	buffer_load_dwordx4 v21, s[12:15], s69 offen offset:1024 lds
	v_mfma_f32_16x16x32_bf16 v[48:51], a[12:15], a[48:51], 0
	s_add_u32 s69, s69, 0x2000
	ds_read_b64_tr_b16 a[30:31], v4 offset:6144
	ds_read_b128 a[92:95], v13 offset:60416
	v_mfma_f32_16x16x32_bf16 v[48:51], a[8:11], a[32:35], v[48:51]
	s_waitcnt lgkmcnt(10)
	s_and_b32 s69, s69, 0x7ffff
	v_cvt_pk_bf16_f32 v123, v122, v123
	v_cvt_pk_bf16_f32 v122, v120, v121
	v_mfma_f32_16x16x32_bf16 v[64:67], a[16:19], a[32:35], 0
	s_waitcnt lgkmcnt(8)
	s_add_u32 m0, s65, 0xa000
	v_cvt_pk_bf16_f32 v120, v104, v105
	v_cvt_pk_bf16_f32 v121, v106, v107
	v_mfma_f32_16x16x32_bf16 v[64:67], a[20:23], a[48:51], v[64:67]
	buffer_load_dwordx4 v20, s[12:15], s69 offen lds
	v_mfma_f32_16x16x32_bf16 v[68:71], a[20:23], a[52:55], 0
	s_waitcnt vmcnt(11)
	ds_read_b64_tr_b16 a[0:1], v1 offset:8192
	v_cvt_pk_bf16_f32 v119, v118, v119
	v_mfma_f32_16x16x32_bf16 v[68:71], a[16:19], a[36:39], v[68:71]
	ds_read_b64_tr_b16 a[2:3], v1 offset:10240
	v_cvt_pk_bf16_f32 v118, v116, v117
	v_mfma_f32_16x16x32_bf16 v[72:75], a[16:19], a[40:43], 0
	s_waitcnt vmcnt(7)
	ds_read_b64_tr_b16 a[4:5], v1 offset:12288
	v_cvt_pk_bf16_f32 v116, v100, v101
	v_mfma_f32_16x16x32_bf16 v[72:75], a[20:23], a[56:59], v[72:75]
	buffer_load_dwordx4 v21, s[12:15], s69 offen offset:1024 lds
	v_mfma_f32_16x16x32_bf16 v[76:79], a[20:23], a[60:63], 0
	s_add_u32 s69, s69, 0x2000
	ds_read_b64_tr_b16 a[6:7], v1 offset:14336
	v_cvt_pk_bf16_f32 v117, v102, v103
	v_mfma_f32_16x16x32_bf16 v[76:79], a[16:19], a[44:47], v[76:79]
	s_and_b32 s69, s69, 0x7ffff
	v_cvt_pk_bf16_f32 v115, v114, v115
	v_cvt_pk_bf16_f32 v114, v112, v113
	v_cvt_pk_bf16_f32 v112, v96, v97
	v_cvt_pk_bf16_f32 v113, v98, v99
	s_waitcnt lgkmcnt(6)
	v_mfma_f32_16x16x32_bf16 v[108:111], a[24:27], a[44:47], 0
	s_waitcnt lgkmcnt(4)
	v_mfma_f32_16x16x32_bf16 v[108:111], a[28:31], a[60:63], v[108:111]
	v_mfma_f32_16x16x32_bf16 v[104:107], a[28:31], a[56:59], 0
	v_mfma_f32_16x16x32_bf16 v[104:107], a[24:27], a[40:43], v[104:107]
	ds_read_b64_tr_b16 a[8:9], v2 offset:8192
	v_mfma_f32_16x16x32_bf16 v[100:103], a[24:27], a[36:39], 0
	ds_read_b64_tr_b16 a[10:11], v2 offset:10240
	v_mfma_f32_16x16x32_bf16 v[100:103], a[28:31], a[52:55], v[100:103]
	ds_read_b64_tr_b16 a[12:13], v2 offset:12288
	v_mfma_f32_16x16x32_bf16 v[96:99], a[28:31], a[48:51], 0
	ds_read_b64_tr_b16 a[14:15], v2 offset:14336
	v_mfma_f32_16x16x32_bf16 v[96:99], a[24:27], a[32:35], v[96:99]
	s_waitcnt lgkmcnt(5)
	v_mfma_f32_16x16x32_bf16 v[32:35], a[0:3], a[64:67], v[32:35]
	s_waitcnt lgkmcnt(4)
	v_mfma_f32_16x16x32_bf16 v[32:35], a[4:7], a[80:83], v[32:35]
	v_mfma_f32_16x16x32_bf16 v[36:39], a[4:7], a[84:87], v[36:39]
	v_mfma_f32_16x16x32_bf16 v[36:39], a[0:3], a[68:71], v[36:39]
	ds_read_b64_tr_b16 a[16:17], v3 offset:8192
	v_mfma_f32_16x16x32_bf16 v[40:43], a[0:3], a[72:75], v[40:43]
	ds_read_b64_tr_b16 a[18:19], v3 offset:10240
	v_mfma_f32_16x16x32_bf16 v[40:43], a[4:7], a[88:91], v[40:43]
	ds_read_b64_tr_b16 a[20:21], v3 offset:12288
	v_mfma_f32_16x16x32_bf16 v[44:47], a[4:7], a[92:95], v[44:47]
	ds_read_b64_tr_b16 a[22:23], v3 offset:14336
	v_mfma_f32_16x16x32_bf16 v[44:47], a[0:3], a[76:79], v[44:47]
	s_waitcnt lgkmcnt(5)
	v_mfma_f32_16x16x32_bf16 v[60:63], a[8:11], a[76:79], v[60:63]
	s_waitcnt lgkmcnt(4)
	v_mfma_f32_16x16x32_bf16 v[60:63], a[12:15], a[92:95], v[60:63]
	v_mfma_f32_16x16x32_bf16 v[56:59], a[12:15], a[88:91], v[56:59]
	v_mfma_f32_16x16x32_bf16 v[56:59], a[8:11], a[72:75], v[56:59]
	ds_read_b64_tr_b16 a[24:25], v4 offset:8192
	v_mfma_f32_16x16x32_bf16 v[52:55], a[8:11], a[68:71], v[52:55]
	ds_read_b64_tr_b16 a[26:27], v4 offset:10240
	v_mfma_f32_16x16x32_bf16 v[52:55], a[12:15], a[84:87], v[52:55]
	ds_read_b64_tr_b16 a[28:29], v4 offset:12288
	v_mfma_f32_16x16x32_bf16 v[48:51], a[12:15], a[80:83], v[48:51]
	ds_read_b64_tr_b16 a[30:31], v4 offset:14336
	v_mfma_f32_16x16x32_bf16 v[48:51], a[8:11], a[64:67], v[48:51]
	s_waitcnt lgkmcnt(5)
	v_mfma_f32_16x16x32_bf16 v[64:67], a[16:19], a[64:67], v[64:67]
	s_waitcnt lgkmcnt(4)
	v_mfma_f32_16x16x32_bf16 v[64:67], a[20:23], a[80:83], v[64:67]
	v_xor_b32 v1, 0x80, v5
	v_xor_b32 v2, 0x80, v6
	v_mfma_f32_16x16x32_bf16 v[68:71], a[20:23], a[84:87], v[68:71]
	v_xor_b32 v3, 0x80, v7
	v_xor_b32 v4, 0x80, v8
	v_mfma_f32_16x16x32_bf16 v[68:71], a[16:19], a[68:71], v[68:71]
	v_cvt_pk_bf16_f32 v63, v62, v63
	v_cvt_pk_bf16_f32 v62, v60, v61
	v_mfma_f32_16x16x32_bf16 v[72:75], a[16:19], a[72:75], v[72:75]
	v_cvt_pk_bf16_f32 v60, v44, v45
	v_cvt_pk_bf16_f32 v61, v46, v47
	v_mfma_f32_16x16x32_bf16 v[72:75], a[20:23], a[88:91], v[72:75]
	v_cvt_pk_bf16_f32 v59, v58, v59
	v_cvt_pk_bf16_f32 v58, v56, v57
	v_mfma_f32_16x16x32_bf16 v[76:79], a[20:23], a[92:95], v[76:79]
	v_cvt_pk_bf16_f32 v56, v40, v41
	v_cvt_pk_bf16_f32 v57, v42, v43
	v_mfma_f32_16x16x32_bf16 v[76:79], a[16:19], a[76:79], v[76:79]
	s_waitcnt lgkmcnt(1)
	v_cvt_pk_bf16_f32 v55, v54, v55
	v_cvt_pk_bf16_f32 v54, v52, v53
	v_mfma_f32_16x16x32_bf16 v[108:111], a[24:27], a[76:79], v[108:111]
	s_waitcnt lgkmcnt(0)
	v_cvt_pk_bf16_f32 v52, v36, v37
	v_cvt_pk_bf16_f32 v53, v38, v39
	v_mfma_f32_16x16x32_bf16 v[108:111], a[28:31], a[92:95], v[108:111]
	v_cvt_pk_bf16_f32 v51, v50, v51
	v_cvt_pk_bf16_f32 v50, v48, v49
	v_mfma_f32_16x16x32_bf16 v[104:107], a[28:31], a[88:91], v[104:107]
	v_cvt_pk_bf16_f32 v48, v32, v33
	v_cvt_pk_bf16_f32 v49, v34, v35
	v_mfma_f32_16x16x32_bf16 v[104:107], a[24:27], a[72:75], v[104:107]
	v_mfma_f32_16x16x32_bf16 v[100:103], a[24:27], a[68:71], v[100:103]
	v_mfma_f32_16x16x32_bf16 v[100:103], a[28:31], a[84:87], v[100:103]
	v_mfma_f32_16x16x32_bf16 v[96:99], a[28:31], a[80:83], v[96:99]
	v_mfma_f32_16x16x32_bf16 v[96:99], a[24:27], a[64:67], v[96:99]
	s_nop 0
	v_cvt_pk_bf16_f32 v111, v110, v111
	v_cvt_pk_bf16_f32 v110, v108, v109
	v_cvt_pk_bf16_f32 v108, v76, v77
	v_cvt_pk_bf16_f32 v109, v78, v79
	v_cvt_pk_bf16_f32 v107, v106, v107
	v_cvt_pk_bf16_f32 v106, v104, v105
	v_cvt_pk_bf16_f32 v104, v72, v73
	v_cvt_pk_bf16_f32 v105, v74, v75
	v_cvt_pk_bf16_f32 v103, v102, v103
	v_cvt_pk_bf16_f32 v102, v100, v101
	v_cvt_pk_bf16_f32 v100, v68, v69
	v_cvt_pk_bf16_f32 v101, v70, v71
	v_cvt_pk_bf16_f32 v99, v98, v99
	v_cvt_pk_bf16_f32 v98, v96, v97
	v_cvt_pk_bf16_f32 v96, v64, v65
	v_cvt_pk_bf16_f32 v97, v66, v67
	v_pk_mov_b32 v[64:65], v[48:49], v[48:49] op_sel:[0,1]
	v_pk_mov_b32 v[66:67], v[50:51], v[50:51] op_sel:[0,1]
	v_pk_mov_b32 v[68:69], v[52:53], v[52:53] op_sel:[0,1]
	v_pk_mov_b32 v[70:71], v[54:55], v[54:55] op_sel:[0,1]
	v_pk_mov_b32 v[72:73], v[56:57], v[56:57] op_sel:[0,1]
	v_pk_mov_b32 v[74:75], v[58:59], v[58:59] op_sel:[0,1]
	v_pk_mov_b32 v[76:77], v[60:61], v[60:61] op_sel:[0,1]
	v_pk_mov_b32 v[78:79], v[62:63], v[62:63] op_sel:[0,1]
	s_waitcnt vmcnt(0) lgkmcnt(0)
	s_branch L_mlp_done

L_slow:
	s_cmp_lg_u32 s78, 0
	s_cbranch_scc1 L_ofine
	s_mov_b32 s78, 1
	s_waitcnt vmcnt(0) lgkmcnt(0)
	s_mov_b32 s68, 0
	s_mov_b32 s69, 0
	s_mov_b32 s70, 64
	v_mov_b32 v26, 0xff800000
	v_mov_b32 v27, 0xff800000
	v_mov_b32 v28, 0xff800000
	v_mov_b32 v29, 0xff800000
L_slow0:
	s_barrier
	s_add_u32 m0, s65, 0x4000
	s_nop 0
	buffer_load_dwordx4 v18, s[8:11], s68 offen lds
	buffer_load_dwordx4 v19, s[8:11], s68 offen offset:1024 lds
	s_add_u32 s68, s68, 0x2000
	s_and_b32 s68, s68, 0x7ffff
	s_waitcnt vmcnt(0)
	s_barrier
	ds_read_b128 a[96:99], v9 offset:16384
	ds_read_b128 a[100:103], v10 offset:16384
	ds_read_b128 a[104:107], v11 offset:16384
	ds_read_b128 a[108:111], v12 offset:16384
	ds_read_b128 a[112:115], v9 offset:20480
	ds_read_b128 a[116:119], v10 offset:20480
	ds_read_b128 a[120:123], v11 offset:20480
	ds_read_b128 a[124:127], v12 offset:20480
	s_waitcnt lgkmcnt(0)
	v_mfma_f32_16x16x32_bf16 v[32:35], a[96:99], a[192:195], 0
	v_mfma_f32_16x16x32_bf16 v[32:35], a[100:103], a[196:199], v[32:35]
	v_mfma_f32_16x16x32_bf16 v[32:35], a[104:107], a[200:203], v[32:35]
	v_mfma_f32_16x16x32_bf16 v[32:35], a[108:111], a[204:207], v[32:35]
	v_mfma_f32_16x16x32_bf16 v[36:39], a[112:115], a[192:195], 0
	v_mfma_f32_16x16x32_bf16 v[36:39], a[116:119], a[196:199], v[36:39]
	v_mfma_f32_16x16x32_bf16 v[36:39], a[120:123], a[200:203], v[36:39]
	v_mfma_f32_16x16x32_bf16 v[36:39], a[124:127], a[204:207], v[36:39]
	s_nop 3
	v_max3_f32 v26, v26, v32, v33
	v_max3_f32 v26, v26, v34, v35
	s_nop 1
	v_max3_f32 v26, v26, v36, v37
	v_max3_f32 v26, v26, v38, v39
	v_mfma_f32_16x16x32_bf16 v[32:35], a[96:99], a[208:211], 0
	v_mfma_f32_16x16x32_bf16 v[32:35], a[100:103], a[212:215], v[32:35]
	v_mfma_f32_16x16x32_bf16 v[32:35], a[104:107], a[216:219], v[32:35]
	v_mfma_f32_16x16x32_bf16 v[32:35], a[108:111], a[220:223], v[32:35]
	v_mfma_f32_16x16x32_bf16 v[36:39], a[112:115], a[208:211], 0
	v_mfma_f32_16x16x32_bf16 v[36:39], a[116:119], a[212:215], v[36:39]
	v_mfma_f32_16x16x32_bf16 v[36:39], a[120:123], a[216:219], v[36:39]
	v_mfma_f32_16x16x32_bf16 v[36:39], a[124:127], a[220:223], v[36:39]
	s_nop 3
	v_max3_f32 v27, v27, v32, v33
	v_max3_f32 v27, v27, v34, v35
	s_nop 1
	v_max3_f32 v27, v27, v36, v37
	v_max3_f32 v27, v27, v38, v39
	v_mfma_f32_16x16x32_bf16 v[32:35], a[96:99], a[224:227], 0
	v_mfma_f32_16x16x32_bf16 v[32:35], a[100:103], a[228:231], v[32:35]
	v_mfma_f32_16x16x32_bf16 v[32:35], a[104:107], a[232:235], v[32:35]
	v_mfma_f32_16x16x32_bf16 v[32:35], a[108:111], a[236:239], v[32:35]
	v_mfma_f32_16x16x32_bf16 v[36:39], a[112:115], a[224:227], 0
	v_mfma_f32_16x16x32_bf16 v[36:39], a[116:119], a[228:231], v[36:39]
	v_mfma_f32_16x16x32_bf16 v[36:39], a[120:123], a[232:235], v[36:39]
	v_mfma_f32_16x16x32_bf16 v[36:39], a[124:127], a[236:239], v[36:39]
	s_nop 3
	v_max3_f32 v28, v28, v32, v33
	v_max3_f32 v28, v28, v34, v35
	s_nop 1
	v_max3_f32 v28, v28, v36, v37
	v_max3_f32 v28, v28, v38, v39
	v_mfma_f32_16x16x32_bf16 v[32:35], a[96:99], a[240:243], 0
	v_mfma_f32_16x16x32_bf16 v[32:35], a[100:103], a[244:247], v[32:35]
	v_mfma_f32_16x16x32_bf16 v[32:35], a[104:107], a[248:251], v[32:35]
	v_mfma_f32_16x16x32_bf16 v[32:35], a[108:111], a[252:255], v[32:35]
	v_mfma_f32_16x16x32_bf16 v[36:39], a[112:115], a[240:243], 0
	v_mfma_f32_16x16x32_bf16 v[36:39], a[116:119], a[244:247], v[36:39]
	v_mfma_f32_16x16x32_bf16 v[36:39], a[120:123], a[248:251], v[36:39]
	v_mfma_f32_16x16x32_bf16 v[36:39], a[124:127], a[252:255], v[36:39]
	s_nop 3
	v_max3_f32 v29, v29, v32, v33
	v_max3_f32 v29, v29, v34, v35
	s_nop 1
	v_max3_f32 v29, v29, v36, v37
	v_max3_f32 v29, v29, v38, v39
	s_nop 7
	s_sub_u32 s70, s70, 1
	s_cmp_lg_u32 s70, 0
	s_cbranch_scc1 L_slow0
	s_mov_b32 s68, 0
	s_mov_b32 s69, 0
	s_mov_b32 s70, 64
	v_mov_b32 v32, v26
	s_nop 1
	v_permlane32_swap_b32 v32, v26
	v_max_f32 v26, v26, v32
	v_mov_b32 v32, v26
	s_nop 1
	v_permlane16_swap_b32 v32, v26
	v_max_f32 v26, v26, v32
	v_mov_b32 v32, v27
	s_nop 1
	v_permlane32_swap_b32 v32, v27
	v_max_f32 v27, v27, v32
	v_mov_b32 v32, v27
	s_nop 1
	v_permlane16_swap_b32 v32, v27
	v_max_f32 v27, v27, v32
	v_mov_b32 v32, v28
	s_nop 1
	v_permlane32_swap_b32 v32, v28
	v_max_f32 v28, v28, v32
	v_mov_b32 v32, v28
	s_nop 1
	v_permlane16_swap_b32 v32, v28
	v_max_f32 v28, v28, v32
	v_mov_b32 v32, v29
	s_nop 1
	v_permlane32_swap_b32 v32, v29
	v_max_f32 v29, v29, v32
	v_mov_b32 v32, v29
	s_nop 1
	v_permlane16_swap_b32 v32, v29
	v_max_f32 v29, v29, v32
	v_lshrrev_b32 v32, 4, v0
	v_xor_b32 v32, v32, v0
	v_bfe_i32 v32, v32, 1, 1
	v_not_b32 v32, v32
	v_and_b32 v32, 0x3f803f80, v32
	v_accvgpr_write_b32 a128, v32
	v_accvgpr_write_b32 a129, v32
	v_accvgpr_write_b32 a130, v32
	v_accvgpr_write_b32 a131, v32
	v_mov_b32 v128, 0
	v_mov_b32 v129, 0
	v_mov_b32 v130, 0
	v_mov_b32 v131, 0
	v_mov_b32 v132, 0
	v_mov_b32 v133, 0
	v_mov_b32 v134, 0
	v_mov_b32 v135, 0
	v_mov_b32 v136, 0
	v_mov_b32 v137, 0
	v_mov_b32 v138, 0
	v_mov_b32 v139, 0
	v_mov_b32 v140, 0
	v_mov_b32 v141, 0
	v_mov_b32 v142, 0
	v_mov_b32 v143, 0
	v_mov_b32 v144, 0
	v_mov_b32 v145, 0
	v_mov_b32 v146, 0
	v_mov_b32 v147, 0
	v_mov_b32 v148, 0
	v_mov_b32 v149, 0
	v_mov_b32 v150, 0
	v_mov_b32 v151, 0
	v_mov_b32 v152, 0
	v_mov_b32 v153, 0
	v_mov_b32 v154, 0
	v_mov_b32 v155, 0
	v_mov_b32 v156, 0
	v_mov_b32 v157, 0
	v_mov_b32 v158, 0
	v_mov_b32 v159, 0
	v_mov_b32 v160, 0
	v_mov_b32 v161, 0
	v_mov_b32 v162, 0
	v_mov_b32 v163, 0
	v_mov_b32 v164, 0
	v_mov_b32 v165, 0
	v_mov_b32 v166, 0
	v_mov_b32 v167, 0
	v_mov_b32 v168, 0
	v_mov_b32 v169, 0
	v_mov_b32 v170, 0
	v_mov_b32 v171, 0
	v_mov_b32 v172, 0
	v_mov_b32 v173, 0
	v_mov_b32 v174, 0
	v_mov_b32 v175, 0
	v_mov_b32 v176, 0
	v_mov_b32 v177, 0
	v_mov_b32 v178, 0
	v_mov_b32 v179, 0
	v_mov_b32 v180, 0
	v_mov_b32 v181, 0
	v_mov_b32 v182, 0
	v_mov_b32 v183, 0
	v_mov_b32 v184, 0
	v_mov_b32 v185, 0
	v_mov_b32 v186, 0
	v_mov_b32 v187, 0
	v_mov_b32 v188, 0
	v_mov_b32 v189, 0
	v_mov_b32 v190, 0
	v_mov_b32 v191, 0
	v_mov_b32 v192, 0
	v_mov_b32 v193, 0
	v_mov_b32 v194, 0
	v_mov_b32 v195, 0
	v_mov_b32 v196, 0
	v_mov_b32 v197, 0
	v_mov_b32 v198, 0
	v_mov_b32 v199, 0
	v_mov_b32 v200, 0
	v_mov_b32 v201, 0
	v_mov_b32 v202, 0
	v_mov_b32 v203, 0
	v_mov_b32 v204, 0
	v_mov_b32 v205, 0
	v_mov_b32 v206, 0
	v_mov_b32 v207, 0
	v_mov_b32 v208, 0
	v_mov_b32 v209, 0
	v_mov_b32 v210, 0
	v_mov_b32 v211, 0
	v_mov_b32 v212, 0
	v_mov_b32 v213, 0
	v_mov_b32 v214, 0
	v_mov_b32 v215, 0
	v_mov_b32 v216, 0
	v_mov_b32 v217, 0
	v_mov_b32 v218, 0
	v_mov_b32 v219, 0
	v_mov_b32 v220, 0
	v_mov_b32 v221, 0
	v_mov_b32 v222, 0
	v_mov_b32 v223, 0
	v_mov_b32 v224, 0
	v_mov_b32 v225, 0
	v_mov_b32 v226, 0
	v_mov_b32 v227, 0
	v_mov_b32 v228, 0
	v_mov_b32 v229, 0
	v_mov_b32 v230, 0
	v_mov_b32 v231, 0
	v_mov_b32 v232, 0
	v_mov_b32 v233, 0
	v_mov_b32 v234, 0
	v_mov_b32 v235, 0
	v_mov_b32 v236, 0
	v_mov_b32 v237, 0
	v_mov_b32 v238, 0
	v_mov_b32 v239, 0
	v_mov_b32 v240, 0
	v_mov_b32 v241, 0
	v_mov_b32 v242, 0
	v_mov_b32 v243, 0
	v_mov_b32 v244, 0
	v_mov_b32 v245, 0
	v_mov_b32 v246, 0
	v_mov_b32 v247, 0
	v_mov_b32 v248, 0
	v_mov_b32 v249, 0
	v_mov_b32 v250, 0
	v_mov_b32 v251, 0
	v_mov_b32 v252, 0
	v_mov_b32 v253, 0
	v_mov_b32 v254, 0
	v_mov_b32 v255, 0
	v_accvgpr_write_b32 a132, 0
	v_accvgpr_write_b32 a133, 0
	v_accvgpr_write_b32 a134, 0
	v_accvgpr_write_b32 a135, 0
	v_accvgpr_write_b32 a136, 0
	v_accvgpr_write_b32 a137, 0
	v_accvgpr_write_b32 a138, 0
	v_accvgpr_write_b32 a139, 0
L_slow1:
	s_barrier
	s_add_u32 m0, s65, 0x4000
	s_nop 0
	buffer_load_dwordx4 v18, s[8:11], s68 offen lds
	buffer_load_dwordx4 v19, s[8:11], s68 offen offset:1024 lds
	s_add_u32 s68, s68, 0x2000
	s_and_b32 s68, s68, 0x7ffff
	s_add_u32 m0, s65, 0xc000
	s_nop 0
	buffer_load_dwordx4 v20, s[12:15], s69 offen lds
	buffer_load_dwordx4 v21, s[12:15], s69 offen offset:1024 lds
	s_add_u32 s69, s69, 0x2000
	s_and_b32 s69, s69, 0x7ffff
	s_waitcnt vmcnt(0)
	s_barrier
	ds_read_b128 a[96:99], v9 offset:16384
	ds_read_b128 a[100:103], v10 offset:16384
	ds_read_b128 a[104:107], v11 offset:16384
	ds_read_b128 a[108:111], v12 offset:16384
	ds_read_b128 a[112:115], v9 offset:20480
	ds_read_b128 a[116:119], v10 offset:20480
	ds_read_b128 a[120:123], v11 offset:20480
	ds_read_b128 a[124:127], v12 offset:20480
	ds_read_b64_tr_b16 a[64:65], v1 offset:16384
	ds_read_b64_tr_b16 a[66:67], v1 offset:20480
	ds_read_b64_tr_b16 a[68:69], v2 offset:16384
	ds_read_b64_tr_b16 a[70:71], v2 offset:20480
	ds_read_b64_tr_b16 a[72:73], v3 offset:16384
	ds_read_b64_tr_b16 a[74:75], v3 offset:20480
	ds_read_b64_tr_b16 a[76:77], v4 offset:16384
	ds_read_b64_tr_b16 a[78:79], v4 offset:20480
	ds_read_b64_tr_b16 a[80:81], v5 offset:16384
	ds_read_b64_tr_b16 a[82:83], v5 offset:20480
	ds_read_b64_tr_b16 a[84:85], v6 offset:16384
	ds_read_b64_tr_b16 a[86:87], v6 offset:20480
	ds_read_b64_tr_b16 a[88:89], v7 offset:16384
	ds_read_b64_tr_b16 a[90:91], v7 offset:20480
	ds_read_b64_tr_b16 a[92:93], v8 offset:16384
	ds_read_b64_tr_b16 a[94:95], v8 offset:20480
	s_waitcnt lgkmcnt(0)
	v_mfma_f32_16x16x32_bf16 v[32:35], a[96:99], a[192:195], 0
	v_mfma_f32_16x16x32_bf16 v[32:35], a[100:103], a[196:199], v[32:35]
	v_mfma_f32_16x16x32_bf16 v[32:35], a[104:107], a[200:203], v[32:35]
	v_mfma_f32_16x16x32_bf16 v[32:35], a[108:111], a[204:207], v[32:35]
	v_mfma_f32_16x16x32_bf16 v[36:39], a[112:115], a[192:195], 0
	v_mfma_f32_16x16x32_bf16 v[36:39], a[116:119], a[196:199], v[36:39]
	v_mfma_f32_16x16x32_bf16 v[36:39], a[120:123], a[200:203], v[36:39]
	v_mfma_f32_16x16x32_bf16 v[36:39], a[124:127], a[204:207], v[36:39]
	s_nop 3
	v_sub_f32 v32, v32, v26
	v_sub_f32 v33, v33, v26
	v_sub_f32 v34, v34, v26
	v_sub_f32 v35, v35, v26
	v_sub_f32 v36, v36, v26
	v_sub_f32 v37, v37, v26
	v_sub_f32 v38, v38, v26
	v_sub_f32 v39, v39, v26
	v_exp_f32 v32, v32
	v_exp_f32 v33, v33
	v_exp_f32 v34, v34
	v_exp_f32 v35, v35
	v_exp_f32 v36, v36
	v_exp_f32 v37, v37
	v_exp_f32 v38, v38
	v_exp_f32 v39, v39
	v_cvt_pk_bf16_f32 v48, v32, v33
	v_cvt_pk_bf16_f32 v49, v34, v35
	v_cvt_pk_bf16_f32 v50, v36, v37
	v_cvt_pk_bf16_f32 v51, v38, v39
	s_nop 1
	v_mfma_f32_16x16x32_bf16 v[128:131], a[64:67], v[48:51], v[128:131]
	v_mfma_f32_16x16x32_bf16 v[144:147], a[68:71], v[48:51], v[144:147]
	v_mfma_f32_16x16x32_bf16 v[160:163], a[72:75], v[48:51], v[160:163]
	v_mfma_f32_16x16x32_bf16 v[176:179], a[76:79], v[48:51], v[176:179]
	v_mfma_f32_16x16x32_bf16 v[192:195], a[80:83], v[48:51], v[192:195]
	v_mfma_f32_16x16x32_bf16 v[208:211], a[84:87], v[48:51], v[208:211]
	v_mfma_f32_16x16x32_bf16 v[224:227], a[88:91], v[48:51], v[224:227]
	v_mfma_f32_16x16x32_bf16 v[240:243], a[92:95], v[48:51], v[240:243]
	v_mfma_f32_16x16x32_bf16 v[32:35], a[96:99], a[208:211], 0
	v_mfma_f32_16x16x32_bf16 v[32:35], a[100:103], a[212:215], v[32:35]
	v_mfma_f32_16x16x32_bf16 v[32:35], a[104:107], a[216:219], v[32:35]
	v_mfma_f32_16x16x32_bf16 v[32:35], a[108:111], a[220:223], v[32:35]
	v_mfma_f32_16x16x32_bf16 v[36:39], a[112:115], a[208:211], 0
	v_mfma_f32_16x16x32_bf16 v[36:39], a[116:119], a[212:215], v[36:39]
	v_mfma_f32_16x16x32_bf16 v[36:39], a[120:123], a[216:219], v[36:39]
	v_mfma_f32_16x16x32_bf16 v[36:39], a[124:127], a[220:223], v[36:39]
	s_nop 3
	v_sub_f32 v32, v32, v27
	v_sub_f32 v33, v33, v27
	v_sub_f32 v34, v34, v27
	v_sub_f32 v35, v35, v27
	v_sub_f32 v36, v36, v27
	v_sub_f32 v37, v37, v27
	v_sub_f32 v38, v38, v27
	v_sub_f32 v39, v39, v27
	v_exp_f32 v32, v32
	v_exp_f32 v33, v33
	v_exp_f32 v34, v34
	v_exp_f32 v35, v35
	v_exp_f32 v36, v36
	v_exp_f32 v37, v37
	v_exp_f32 v38, v38
	v_exp_f32 v39, v39
	v_cvt_pk_bf16_f32 v52, v32, v33
	v_cvt_pk_bf16_f32 v53, v34, v35
	v_cvt_pk_bf16_f32 v54, v36, v37
	v_cvt_pk_bf16_f32 v55, v38, v39
	s_nop 1
	v_mfma_f32_16x16x32_bf16 v[132:135], a[64:67], v[52:55], v[132:135]
	v_mfma_f32_16x16x32_bf16 v[148:151], a[68:71], v[52:55], v[148:151]
	v_mfma_f32_16x16x32_bf16 v[164:167], a[72:75], v[52:55], v[164:167]
	v_mfma_f32_16x16x32_bf16 v[180:183], a[76:79], v[52:55], v[180:183]
	v_mfma_f32_16x16x32_bf16 v[196:199], a[80:83], v[52:55], v[196:199]
	v_mfma_f32_16x16x32_bf16 v[212:215], a[84:87], v[52:55], v[212:215]
	v_mfma_f32_16x16x32_bf16 v[228:231], a[88:91], v[52:55], v[228:231]
	v_mfma_f32_16x16x32_bf16 v[244:247], a[92:95], v[52:55], v[244:247]
	v_smfmac_f32_16x16x64_bf16 a[132:135], a[128:131], v[48:55], v31
	v_mfma_f32_16x16x32_bf16 v[32:35], a[96:99], a[224:227], 0
	v_mfma_f32_16x16x32_bf16 v[32:35], a[100:103], a[228:231], v[32:35]
	v_mfma_f32_16x16x32_bf16 v[32:35], a[104:107], a[232:235], v[32:35]
	v_mfma_f32_16x16x32_bf16 v[32:35], a[108:111], a[236:239], v[32:35]
	v_mfma_f32_16x16x32_bf16 v[36:39], a[112:115], a[224:227], 0
	v_mfma_f32_16x16x32_bf16 v[36:39], a[116:119], a[228:231], v[36:39]
	v_mfma_f32_16x16x32_bf16 v[36:39], a[120:123], a[232:235], v[36:39]
	v_mfma_f32_16x16x32_bf16 v[36:39], a[124:127], a[236:239], v[36:39]
	s_nop 3
	v_sub_f32 v32, v32, v28
	v_sub_f32 v33, v33, v28
	v_sub_f32 v34, v34, v28
	v_sub_f32 v35, v35, v28
	v_sub_f32 v36, v36, v28
	v_sub_f32 v37, v37, v28
	v_sub_f32 v38, v38, v28
	v_sub_f32 v39, v39, v28
	v_exp_f32 v32, v32
	v_exp_f32 v33, v33
	v_exp_f32 v34, v34
	v_exp_f32 v35, v35
	v_exp_f32 v36, v36
	v_exp_f32 v37, v37
	v_exp_f32 v38, v38
	v_exp_f32 v39, v39
	v_cvt_pk_bf16_f32 v56, v32, v33
	v_cvt_pk_bf16_f32 v57, v34, v35
	v_cvt_pk_bf16_f32 v58, v36, v37
	v_cvt_pk_bf16_f32 v59, v38, v39
	s_nop 1
	v_mfma_f32_16x16x32_bf16 v[136:139], a[64:67], v[56:59], v[136:139]
	v_mfma_f32_16x16x32_bf16 v[152:155], a[68:71], v[56:59], v[152:155]
	v_mfma_f32_16x16x32_bf16 v[168:171], a[72:75], v[56:59], v[168:171]
	v_mfma_f32_16x16x32_bf16 v[184:187], a[76:79], v[56:59], v[184:187]
	v_mfma_f32_16x16x32_bf16 v[200:203], a[80:83], v[56:59], v[200:203]
	v_mfma_f32_16x16x32_bf16 v[216:219], a[84:87], v[56:59], v[216:219]
	v_mfma_f32_16x16x32_bf16 v[232:235], a[88:91], v[56:59], v[232:235]
	v_mfma_f32_16x16x32_bf16 v[248:251], a[92:95], v[56:59], v[248:251]
	v_mfma_f32_16x16x32_bf16 v[32:35], a[96:99], a[240:243], 0
	v_mfma_f32_16x16x32_bf16 v[32:35], a[100:103], a[244:247], v[32:35]
	v_mfma_f32_16x16x32_bf16 v[32:35], a[104:107], a[248:251], v[32:35]
	v_mfma_f32_16x16x32_bf16 v[32:35], a[108:111], a[252:255], v[32:35]
	v_mfma_f32_16x16x32_bf16 v[36:39], a[112:115], a[240:243], 0
	v_mfma_f32_16x16x32_bf16 v[36:39], a[116:119], a[244:247], v[36:39]
	v_mfma_f32_16x16x32_bf16 v[36:39], a[120:123], a[248:251], v[36:39]
	v_mfma_f32_16x16x32_bf16 v[36:39], a[124:127], a[252:255], v[36:39]
	s_nop 3
	v_sub_f32 v32, v32, v29
	v_sub_f32 v33, v33, v29
	v_sub_f32 v34, v34, v29
	v_sub_f32 v35, v35, v29
	v_sub_f32 v36, v36, v29
	v_sub_f32 v37, v37, v29
	v_sub_f32 v38, v38, v29
	v_sub_f32 v39, v39, v29
	v_exp_f32 v32, v32
	v_exp_f32 v33, v33
	v_exp_f32 v34, v34
	v_exp_f32 v35, v35
	v_exp_f32 v36, v36
	v_exp_f32 v37, v37
	v_exp_f32 v38, v38
	v_exp_f32 v39, v39
	v_cvt_pk_bf16_f32 v60, v32, v33
	v_cvt_pk_bf16_f32 v61, v34, v35
	v_cvt_pk_bf16_f32 v62, v36, v37
	v_cvt_pk_bf16_f32 v63, v38, v39
	s_nop 1
	v_mfma_f32_16x16x32_bf16 v[140:143], a[64:67], v[60:63], v[140:143]
	v_mfma_f32_16x16x32_bf16 v[156:159], a[68:71], v[60:63], v[156:159]
	v_mfma_f32_16x16x32_bf16 v[172:175], a[72:75], v[60:63], v[172:175]
	v_mfma_f32_16x16x32_bf16 v[188:191], a[76:79], v[60:63], v[188:191]
	v_mfma_f32_16x16x32_bf16 v[204:207], a[80:83], v[60:63], v[204:207]
	v_mfma_f32_16x16x32_bf16 v[220:223], a[84:87], v[60:63], v[220:223]
	v_mfma_f32_16x16x32_bf16 v[236:239], a[88:91], v[60:63], v[236:239]
	v_mfma_f32_16x16x32_bf16 v[252:255], a[92:95], v[60:63], v[252:255]
	v_smfmac_f32_16x16x64_bf16 a[136:139], a[128:131], v[56:63], v31
	s_nop 7
	s_sub_u32 s70, s70, 1
	s_cmp_lg_u32 s70, 0
	s_cbranch_scc1 L_slow1
	s_barrier
	s_branch L_oepi

L_code_end:
	s_endpgm
.section .rodata,"a"
.p2align 6
.amdhsa_kernel recurrent_scan__gqa_block_cached__mixer_s_mlp__prompt_kernel
  .amdhsa_next_free_vgpr 512
  .amdhsa_next_free_sgpr 102
  .amdhsa_accum_offset 256
  .amdhsa_group_segment_fixed_size 0
  .amdhsa_kernarg_size 104
  .amdhsa_user_sgpr_count 2
  .amdhsa_user_sgpr_kernarg_segment_ptr 1
  .amdhsa_system_sgpr_workgroup_id_x 1
  .amdhsa_float_denorm_mode_32 3
.end_amdhsa_kernel
```
